```python
import torch

def _softmax(x, axis=-1):
    return torch.softmax(x, dim=axis)

def _gelu(x):
    return torch.nn.functional.gelu(x, approximate='tanh')

def _silu(x):
    return torch.nn.functional.silu(x)

def _sigmoid(x):
    return torch.sigmoid(x)

def _layernorm(x, axis=-1, eps=1e-05):
    m = x.mean(dim=axis, keepdim=True)
    v = x.var(dim=axis, keepdim=True, unbiased=False)
    return (x - m) / torch.sqrt(v + eps)

def _scatter_add(tgt, idx, src, axis=0):
    return tgt.clone().index_add_(axis, idx, src)

def _segment_sum(src, seg, n):
    out = torch.zeros((n,) + src.shape[1:], dtype=src.dtype)
    return out.index_add_(0, seg, src)

def _pad(x, pw):
    flat = tuple((v for pair in reversed(pw) for v in pair))
    return torch.nn.functional.pad(x, flat)
kernel_name = 'standalone__neighborhood_dinat__vision'

def setup_inputs():

    _w = lambda a: (lambda t: t.to(torch.bfloat16) if t.is_floating_point() else t)(torch.as_tensor(a))
    ks, dil, nh = (7, 2, 4)
    H = W = max(ks * dil, 224 // dil * dil)
    C = max(nh, 192 // nh * nh)
    return {'x': _w((lambda *s: torch.randn(*s, dtype=torch.bfloat16) * 0.2)(1, H, W, C)), 'wqkv': _w((lambda *s: torch.randn(*s, dtype=torch.bfloat16) * 0.2)(C, 3 * C)), 'wo': _w((lambda *s: torch.randn(*s, dtype=torch.bfloat16) * 0.4)(C, C)), 'rpb': _w((lambda *s: torch.randn(*s, dtype=torch.bfloat16) * 0.4)(nh, 2 * ks - 1, 2 * ks - 1))}

def reference(x, wqkv, wo, rpb):
    B, H, W, C = x.shape
    ks, dil, nh = (7, 2, 4)
    hd = C // nh
    scale = hd ** (-0.5)
    qkv = (x @ wqkv).reshape(B, H, W, 3, nh, hd)
    q = qkv[:, :, :, 0].clone()
    k = qkv[:, :, :, 1].clone()
    v = qkv[:, :, :, 2].clone()
    ih = torch.arange(H)
    iw = torch.arange(W)
    m = torch.arange(ks)
    sh = torch.clip(ih // dil - ks // 2, 0, H // dil - ks)
    sw = torch.clip(iw // dil - ks // 2, 0, W // dil - ks)
    kh = (sh[:, None] + m[None, :]) * dil + (ih % dil)[:, None]
    kw = (sw[:, None] + m[None, :]) * dil + (iw % dil)[:, None]
    rh = sh[:, None] + m[None, :] - (ih // dil)[:, None] + (ks - 1)
    rw = sw[:, None] + m[None, :] - (iw // dil)[:, None] + (ks - 1)
    ih4 = kh[:, :, None, None].clone()
    iw4 = kw[None, None, :, :].clone()
    kg = (lambda x, *d: x.permute(*d))(k[:, ih4, iw4, :, :], 0, 1, 3, 5, 2, 4, 6).reshape(B, H, W, nh, ks * ks, hd)
    vg = (lambda x, *d: x.permute(*d))(v[:, ih4, iw4, :, :], 0, 1, 3, 5, 2, 4, 6).reshape(B, H, W, nh, ks * ks, hd)
    bg = (lambda x, *d: x.permute(*d))(rpb[:, rh[:, :, None, None], rw[None, None, :, :]], 1, 3, 0, 2, 4).reshape(1, H, W, nh, ks * ks)
    logits = torch.einsum('bhwnd,bhwnkd->bhwnk', q, kg) * scale + bg
    attn = _softmax(logits, axis=-1)
    out = torch.einsum('bhwnk,bhwnkd->bhwnd', attn, vg).reshape(B, H, W, C)
    return out @ wo
```

```asm
; @launch grid=(256,1,1) block=(256,1,1) lds=162048
.amdgcn_target "amdgcn-amd-amdhsa--gfx950"
.text
.globl standalone__neighborhood_dinat__vision_kernel
.p2align 8
.type standalone__neighborhood_dinat__vision_kernel,@function
standalone__neighborhood_dinat__vision_kernel:
    s_cmp_ge_u32 s2, 256
    s_cbranch_scc0 L_go
    s_endpgm
L_go:
    s_load_dwordx4 s[24:27], s[0:1], 0
    s_load_dwordx4 s[28:31], s[0:1], 16
    s_load_dwordx2 s[32:33], s[0:1], 32
    v_lshrrev_b32 v5, 6, v0
    v_and_b32 v1, 63, v0
    v_readfirstlane_b32 s36, v5
    s_and_b32 s52, s2, 7
    s_lshr_b32 s53, s2, 3
    s_and_b32 s54, s52, 1
    s_lshl_b32 s54, s54, 2
    s_lshr_b32 s55, s53, 3
    s_or_b32 s34, s54, s55
    s_and_b32 s35, s53, 7
    s_lshr_b32 s54, s52, 2
    s_mul_i32 s54, s54, 0x15000
    s_bfe_u32 s55, s52, 0x10001
    s_mul_i32 s55, s55, 0x180
    s_add_u32 s38, s54, s55
    v_mov_b32 v239, v1
    v_add_u32 v250, 0, v239
    v_mul_u32_u24 v248, 0x2aab, v250
    v_lshrrev_b32 v248, 16, v248
    v_mul_u32_u24 v249, 6, v248
    v_sub_u32 v250, v250, v249
    v_lshrrev_b32 v249, 1, v248
    v_and_b32 v249, 4, v249
    v_xor_b32 v248, v248, v249
    v_mul_u32_u24 v248, 0x480, v248
    v_lshl_add_u32 v251, v250, 4, v248
    v_add_u32 v250, 64, v239
    v_mul_u32_u24 v248, 0x2aab, v250
    v_lshrrev_b32 v248, 16, v248
    v_mul_u32_u24 v249, 6, v248
    v_sub_u32 v250, v250, v249
    v_lshrrev_b32 v249, 1, v248
    v_and_b32 v249, 4, v249
    v_xor_b32 v248, v248, v249
    v_mul_u32_u24 v248, 0x480, v248
    v_lshl_add_u32 v252, v250, 4, v248
    v_add_u32 v250, 0x80, v239
    v_mul_u32_u24 v248, 0x2aab, v250
    v_lshrrev_b32 v248, 16, v248
    v_mul_u32_u24 v249, 6, v248
    v_sub_u32 v250, v250, v249
    v_lshrrev_b32 v249, 1, v248
    v_and_b32 v249, 4, v249
    v_xor_b32 v248, v248, v249
    v_mul_u32_u24 v248, 0x480, v248
    v_lshl_add_u32 v253, v250, 4, v248
    s_mul_i32 s49, s36, 0x60
    s_mul_i32 s50, s36, 0x4800
    s_add_u32 s50, s50, 0x15900
    s_lshl_b32 s41, s36, 10
    s_add_u32 s42, s41, 0x1000
    s_min_u32 s42, s42, 0x1a00
    s_mul_i32 s52, s35, 14
    s_sub_u32 s52, s52, 3
    s_lshr_b32 s53, s41, 4
    v_add_u32 v5, s53, v1
    v_mul_u32_u24 v6, 0xaab, v5
    v_lshrrev_b32 v6, 16, v6
    v_mul_u32_u24 v7, 24, v6
    v_sub_u32 v5, v5, v7
    v_and_b32 v7, 2, v6
    v_xor_b32 v5, v5, v7
    v_add_u32 v6, s52, v6
    v_max_i32 v6, 0, v6
    v_min_i32 v6, 0x6f, v6
    v_mul_u32_u24 v6, 0x300, v6
    v_lshl_add_u32 v246, v5, 4, v6
    s_lshr_b32 s53, s42, 4
    v_add_u32 v5, s53, v1
    v_mul_u32_u24 v6, 0xaab, v5
    v_lshrrev_b32 v6, 16, v6
    v_mul_u32_u24 v7, 24, v6
    v_sub_u32 v5, v5, v7
    v_and_b32 v7, 2, v6
    v_xor_b32 v5, v5, v7
    v_add_u32 v6, s52, v6
    v_max_i32 v6, 0, v6
    v_min_i32 v6, 0x6f, v6
    v_mul_u32_u24 v6, 0x300, v6
    v_lshl_add_u32 v247, v5, 4, v6
    s_mul_i32 s53, s34, 14
    s_mul_i32 s51, s53, 0x2a000
    s_add_u32 s51, s51, s38
    s_sub_u32 s39, s51, 0x7e000
    s_add_u32 s43, s39, 0
    s_add_u32 s53, s38, 0xd2000
    s_cmp_eq_u32 s34, 0
    s_cselect_b32 s43, s53, s43
    s_add_u32 s44, s39, 0x2a000
    s_add_u32 s53, s38, 0xfc000
    s_cmp_eq_u32 s34, 0
    s_cselect_b32 s44, s53, s44
    s_add_u32 s45, s39, 0x54000
    s_add_u32 s53, s38, 0
    s_cmp_eq_u32 s34, 0
    s_cselect_b32 s45, s53, s45
    s_waitcnt lgkmcnt(0)
    s_mov_b32 s8, s26
    s_and_b32 s9, s27, 0xffff
    s_mov_b32 s10, 0x36000
    s_mov_b32 s11, 0x20000
    s_mov_b32 s4, s24
    s_and_b32 s5, s25, 0xffff
    s_mov_b32 s6, 0x1260000
    s_mov_b32 s7, 0x20000
    s_mov_b32 s16, s30
    s_and_b32 s17, s31, 0xffff
    s_mov_b32 s18, 0x548
    s_mov_b32 s19, 0x20000
    s_mov_b32 s12, s28
    s_and_b32 s13, s29, 0xffff
    s_mov_b32 s14, 0x12000
    s_mov_b32 s15, 0x20000
    s_mov_b32 s20, s32
    s_and_b32 s21, s33, 0xffff
    s_mov_b32 s22, 0x1260000
    s_mov_b32 s23, 0x20000
    s_add_u32 m0, s41, 0
    v_lshrrev_b32 v2, 4, v1
    buffer_load_dwordx4 v246, s[4:7], s43 offen lds
    s_add_u32 m0, s42, 0
    v_and_b32 v3, 7, v1
    buffer_load_dwordx4 v247, s[4:7], s43 offen lds
    s_add_u32 m0, s41, 0x1e40
    v_bfe_u32 v4, v1, 3, 1
    buffer_load_dwordx4 v246, s[4:7], s44 offen lds
    s_add_u32 m0, s42, 0x1e40
    s_add_u32 s57, s49, 0x180
    buffer_load_dwordx4 v247, s[4:7], s44 offen lds
    s_add_u32 m0, s50, 0
    s_mul_i32 s55, s36, 0xa9
    buffer_load_dwordx4 v251, s[8:11], s57 offen lds
    s_add_u32 m0, s50, 0x400
    v_add_u32 v5, 0, v1
    buffer_load_dwordx4 v252, s[8:11], s57 offen lds
    s_add_u32 m0, s50, 0x800
    v_min_u32 v5, 0xdb, v5
    buffer_load_dwordx4 v253, s[8:11], s57 offen lds
    s_add_u32 s57, s49, 0x9180
    s_add_u32 m0, s50, 0xc00
    v_mul_u32_u24 v6, 0xccd, v5
    buffer_load_dwordx4 v251, s[8:11], s57 offen lds
    s_add_u32 m0, s50, 0x1000
    v_lshrrev_b32 v6, 16, v6
    buffer_load_dwordx4 v252, s[8:11], s57 offen lds
    s_add_u32 m0, s50, 0x1400
    v_mul_u32_u24 v7, 20, v6
    buffer_load_dwordx4 v253, s[8:11], s57 offen lds
    s_add_u32 s57, s49, 0x12180
    s_add_u32 m0, s50, 0x1800
    v_sub_u32 v5, v5, v7
    buffer_load_dwordx4 v251, s[8:11], s57 offen lds
    s_add_u32 m0, s50, 0x1c00
    v_add_u32 v7, -11, v5
    buffer_load_dwordx4 v252, s[8:11], s57 offen lds
    s_add_u32 m0, s50, 0x2000
    v_max_i32 v7, 0, v7
    v_mul_u32_u24 v8, 11, v7
    v_lshrrev_b32 v8, 5, v8
    v_mul_u32_u24 v9, 3, v8
    v_sub_u32 v7, v7, v9
    v_lshlrev_b32 v7, 2, v7
    v_sub_u32 v8, v7, v8
    v_add_u32 v9, -3, v5
    v_cmp_lt_u32 vcc, 10, v5
    s_mov_b32 s37, 0x3e553b95
    s_mov_b32 s40, 0x140
    v_and_b32 v10, 1, v2
    s_mov_b32 s60, 0x710
    s_mov_b32 s61, 0x2132
    s_mov_b32 s62, 0x4354
    s_mov_b32 s63, 0x6576
    s_mov_b32 s64, 0x21073210
    s_mov_b32 s65, 0x65437654
    s_mov_b32 s66, 0x710
    s_mov_b32 s67, 0x2132
    s_mov_b32 s68, 0x7771077
    s_mov_b32 s69, 0x43215432
    s_mov_b32 s70, 0x77657776
    s_mov_b32 s71, 0x710
    s_mov_b32 s72, 0x6576
    s_mov_b32 s73, 0x21073210
    s_mov_b32 s74, 0x65437654
    s_mov_b32 s75, 0x7771077
    s_mov_b32 s76, 0x77657776
    s_mov_b32 s77, 0x710
    s_mov_b32 s78, 0x6576
    s_mov_b32 s79, 0x77657776
    s_mov_b32 s80, 0x7771077
    s_mov_b32 s81, 0x4354
    s_mov_b32 s82, 0x6576
    s_mov_b32 s83, 0x21073210
    s_mov_b32 s84, 0x65437654
    v_add_u32 v250, 0, v239
    v_mul_u32_u24 v248, 0x2aab, v250
    v_lshrrev_b32 v248, 16, v248
    v_mul_u32_u24 v249, 6, v248
    v_sub_u32 v250, v250, v249
    v_lshrrev_b32 v249, 1, v248
    v_and_b32 v249, 4, v249
    v_xor_b32 v248, v248, v249
    v_mul_u32_u24 v248, 0x180, v248
    buffer_load_dwordx4 v253, s[8:11], s57 offen lds
    s_add_u32 s57, s49, 0x1b180
    s_add_u32 m0, s50, 0x2400
    s_nop 0
    buffer_load_dwordx4 v251, s[8:11], s57 offen lds
    s_add_u32 m0, s50, 0x2800
    s_nop 0
    buffer_load_dwordx4 v252, s[8:11], s57 offen lds
    s_add_u32 m0, s50, 0x2c00
    s_nop 0
    buffer_load_dwordx4 v253, s[8:11], s57 offen lds
    s_add_u32 s57, s49, 0x24180
    s_add_u32 m0, s50, 0x3000
    s_waitcnt vmcnt(12)
    s_barrier
    buffer_load_dwordx4 v251, s[8:11], s57 offen lds
    s_add_u32 m0, s50, 0x3400
    s_nop 0
    buffer_load_dwordx4 v252, s[8:11], s57 offen lds
    s_add_u32 m0, s50, 0x3800
    s_nop 0
    buffer_load_dwordx4 v253, s[8:11], s57 offen lds
    s_add_u32 s57, s49, 0x2d180
    s_add_u32 m0, s50, 0x3c00
    s_nop 0
    buffer_load_dwordx4 v251, s[8:11], s57 offen lds
    s_add_u32 m0, s50, 0x4000
    s_nop 0
    buffer_load_dwordx4 v252, s[8:11], s57 offen lds
    s_add_u32 m0, s50, 0x4400
    s_nop 0
    buffer_load_dwordx4 v253, s[8:11], s57 offen lds
    s_add_u32 m0, s41, 0x3c80
    s_nop 0
    buffer_load_dwordx4 v246, s[4:7], s45 offen lds
    s_add_u32 m0, s42, 0x3c80
    s_add_u32 s56, s39, 0x7e000
    buffer_load_dwordx4 v247, s[4:7], s45 offen lds
    s_add_u32 m0, s41, 0x5ac0
    s_nop 0
    buffer_load_dwordx4 v246, s[4:7], s56 offen lds
    s_add_u32 m0, s42, 0x5ac0
    s_cmp_eq_u32 s34, 0
    s_cselect_b32 s52, 2, -8
    s_cmp_eq_u32 s35, 0
    s_cselect_b32 s53, 3, 0
    s_cselect_b32 s54, -3, -2
    v_add_u32 v8, s53, v8
    v_add_u32 v7, s54, v7
    v_cndmask_b32 v5, v5, v8, vcc
    v_cndmask_b32 v16, v9, v7, vcc
    v_add_u32 v7, 3, v6
    v_add_u32 v8, s52, v6
    v_cmp_lt_u32 vcc, 6, v6
    s_nop 1
    v_cndmask_b32 v7, v7, v8, vcc
    v_mov_b32 v8, 32
    v_cmp_eq_u32 vcc, 7, v6
    v_mul_i32_i24 v7, 13, v7
    v_add3_u32 v5, v5, v7, s55
    buffer_load_dwordx4 v247, s[4:7], s56 offen lds
    v_cndmask_b32 v16, v16, v8, vcc
    v_add_lshl_u32 v20, v5, 0, 1
    v_add_lshl_u32 v21, v5, 1, 1
    v_add_lshl_u32 v22, v5, 2, 1
    v_add_lshl_u32 v23, v5, 3, 1
    v_add_u32 v5, 64, v1
    v_min_u32 v5, 0xdb, v5
    v_mul_u32_u24 v6, 0xccd, v5
    v_lshrrev_b32 v6, 16, v6
    v_mul_u32_u24 v7, 20, v6
    v_sub_u32 v5, v5, v7
    v_add_u32 v7, -11, v5
    v_max_i32 v7, 0, v7
    v_mul_u32_u24 v8, 11, v7
    v_lshrrev_b32 v8, 5, v8
    v_mul_u32_u24 v9, 3, v8
    v_sub_u32 v7, v7, v9
    v_lshlrev_b32 v7, 2, v7
    buffer_load_ushort v144, v20, s[16:19], 0 offen
    v_sub_u32 v8, v7, v8
    v_add_u32 v8, s53, v8
    v_add_u32 v7, s54, v7
    v_add_u32 v9, -3, v5
    v_cmp_lt_u32 vcc, 10, v5
    s_add_u32 s56, s39, 0xa8000
    s_add_u32 m0, s41, 0x7900
    v_cndmask_b32 v5, v5, v8, vcc
    v_cndmask_b32 v17, v9, v7, vcc
    v_add_u32 v7, 3, v6
    v_add_u32 v8, s52, v6
    v_cmp_lt_u32 vcc, 6, v6
    s_nop 1
    v_cndmask_b32 v7, v7, v8, vcc
    v_mov_b32 v8, 32
    v_cmp_eq_u32 vcc, 7, v6
    v_mul_i32_i24 v7, 13, v7
    buffer_load_ushort v145, v21, s[16:19], 0 offen
    v_cndmask_b32 v17, v17, v8, vcc
    v_add3_u32 v5, v5, v7, s55
    v_add_lshl_u32 v24, v5, 0, 1
    v_add_lshl_u32 v25, v5, 1, 1
    v_add_lshl_u32 v26, v5, 2, 1
    v_add_lshl_u32 v27, v5, 3, 1
    v_add_u32 v5, 0x80, v1
    v_min_u32 v5, 0xdb, v5
    v_mul_u32_u24 v6, 0xccd, v5
    v_lshrrev_b32 v6, 16, v6
    v_mul_u32_u24 v7, 20, v6
    v_sub_u32 v5, v5, v7
    v_add_u32 v7, -11, v5
    v_max_i32 v7, 0, v7
    v_mul_u32_u24 v8, 11, v7
    v_lshrrev_b32 v8, 5, v8
    v_mul_u32_u24 v9, 3, v8
    v_sub_u32 v7, v7, v9
    buffer_load_ushort v146, v22, s[16:19], 0 offen
    v_lshlrev_b32 v7, 2, v7
    v_sub_u32 v8, v7, v8
    v_add_u32 v8, s53, v8
    v_add_u32 v7, s54, v7
    v_add_u32 v9, -3, v5
    v_cmp_lt_u32 vcc, 10, v5
    s_nop 1
    v_cndmask_b32 v5, v5, v8, vcc
    v_cndmask_b32 v18, v9, v7, vcc
    v_add_u32 v7, 3, v6
    v_add_u32 v8, s52, v6
    v_cmp_lt_u32 vcc, 6, v6
    s_nop 1
    v_cndmask_b32 v7, v7, v8, vcc
    v_mov_b32 v8, 32
    v_cmp_eq_u32 vcc, 7, v6
    buffer_load_ushort v147, v23, s[16:19], 0 offen
    v_mul_i32_i24 v7, 13, v7
    v_cndmask_b32 v18, v18, v8, vcc
    v_add3_u32 v5, v5, v7, s55
    v_add_lshl_u32 v28, v5, 0, 1
    v_add_lshl_u32 v29, v5, 1, 1
    v_add_lshl_u32 v30, v5, 2, 1
    v_add_lshl_u32 v31, v5, 3, 1
    v_add_u32 v5, 0xc0, v1
    v_min_u32 v5, 0xdb, v5
    v_mul_u32_u24 v6, 0xccd, v5
    v_lshrrev_b32 v6, 16, v6
    v_mul_u32_u24 v7, 20, v6
    v_sub_u32 v5, v5, v7
    v_add_u32 v7, -11, v5
    v_max_i32 v7, 0, v7
    v_mul_u32_u24 v8, 11, v7
    v_lshrrev_b32 v8, 5, v8
    v_mul_u32_u24 v9, 3, v8
    buffer_load_ushort v148, v24, s[16:19], 0 offen
    v_sub_u32 v7, v7, v9
    v_lshlrev_b32 v7, 2, v7
    v_sub_u32 v8, v7, v8
    v_add_u32 v8, s53, v8
    v_add_u32 v7, s54, v7
    v_add_u32 v9, -3, v5
    v_cmp_lt_u32 vcc, 10, v5
    s_nop 1
    v_cndmask_b32 v5, v5, v8, vcc
    v_cndmask_b32 v19, v9, v7, vcc
    v_add_u32 v7, 3, v6
    v_add_u32 v8, s52, v6
    v_cmp_lt_u32 vcc, 6, v6
    s_nop 1
    v_cndmask_b32 v7, v7, v8, vcc
    v_mov_b32 v8, 32
    buffer_load_ushort v149, v25, s[16:19], 0 offen
    v_cmp_eq_u32 vcc, 7, v6
    v_mul_i32_i24 v7, 13, v7
    v_add3_u32 v5, v5, v7, s55
    v_cndmask_b32 v19, v19, v8, vcc
    v_add_lshl_u32 v32, v5, 0, 1
    v_add_lshl_u32 v33, v5, 1, 1
    v_add_lshl_u32 v34, v5, 2, 1
    v_add_lshl_u32 v35, v5, 3, 1
    v_bfe_u32 v5, v1, 2, 2
    v_and_b32 v6, 3, v1
    v_and_b32 v7, 1, v2
    v_lshl_add_u32 v8, v2, 3, v5
    v_xor_b32 v9, 0, v7
    v_lshl_add_u32 v9, v9, 2, v8
    v_mul_u32_u24 v9, 0x60, v9
    v_lshl_add_u32 v9, v6, 3, v9
    v_add_u32 v254, s50, v9
    v_xor_b32 v9, 1, v7
    buffer_load_ushort v150, v26, s[16:19], 0 offen
    v_lshl_add_u32 v9, v9, 2, v8
    v_mul_u32_u24 v9, 0x60, v9
    v_lshl_add_u32 v9, v6, 3, v9
    v_add_u32 v255, s50, v9
    v_lshl_add_u32 v8, v2, 2, v5
    v_lshrrev_b32 v9, 1, v2
    v_lshlrev_b32 v9, 2, v9
    v_xor_b32 v8, v8, v9
    v_mul_u32_u24 v8, 0x60, v8
    v_add_u32 v8, s50, v8
    v_lshl_add_u32 v9, v6, 4, v8
    v_cmp_lt_u32 vcc, 5, v3
    v_add_u32 v5, 0, v3
    v_and_b32 v7, 2, v1
    v_xor_b32 v7, v7, v2
    v_lshlrev_b32 v7, 4, v7
    s_mul_i32 s55, s36, 0xdc0
    s_waitcnt vmcnt(26)
    ds_read_b64_tr_b16 a[0:1], v254
    buffer_load_ushort v151, v27, s[16:19], 0 offen
    ds_read_b64_tr_b16 a[2:3], v255
    ds_read_b64_tr_b16 a[4:5], v254 offset:32
    ds_read_b64_tr_b16 a[6:7], v255 offset:32
    ds_read_b64_tr_b16 a[8:9], v254 offset:64
    ds_read_b64_tr_b16 a[10:11], v255 offset:64
    s_waitcnt vmcnt(24)
    ds_read_b64_tr_b16 a[12:13], v254 offset:3072
    ds_read_b64_tr_b16 a[14:15], v255 offset:3072
    ds_read_b64_tr_b16 a[16:17], v254 offset:3104
    ds_read_b64_tr_b16 a[18:19], v255 offset:3104
    ds_read_b64_tr_b16 a[20:21], v254 offset:3136
    ds_read_b64_tr_b16 a[22:23], v255 offset:3136
    s_waitcnt vmcnt(21)
    ds_read_b64_tr_b16 a[24:25], v254 offset:6144
    ds_read_b64_tr_b16 a[26:27], v255 offset:6144
    ds_read_b64_tr_b16 a[28:29], v254 offset:6176
    ds_read_b64_tr_b16 a[30:31], v255 offset:6176
    ds_read_b64_tr_b16 a[32:33], v254 offset:6208
    ds_read_b64_tr_b16 a[34:35], v255 offset:6208
    s_waitcnt vmcnt(18)
    ds_read_b64_tr_b16 a[36:37], v254 offset:9216
    ds_read_b64_tr_b16 a[38:39], v255 offset:9216
    ds_read_b64_tr_b16 a[40:41], v254 offset:9248
    buffer_load_ushort v152, v28, s[16:19], 0 offen
    ds_read_b64_tr_b16 a[42:43], v255 offset:9248
    ds_read_b64_tr_b16 a[44:45], v254 offset:9280
    ds_read_b64_tr_b16 a[46:47], v255 offset:9280
    s_waitcnt vmcnt(16)
    ds_read_b64_tr_b16 a[48:49], v254 offset:12288
    ds_read_b64_tr_b16 a[50:51], v255 offset:12288
    ds_read_b64_tr_b16 a[52:53], v254 offset:12320
    ds_read_b64_tr_b16 a[54:55], v255 offset:12320
    ds_read_b64_tr_b16 a[56:57], v254 offset:12352
    ds_read_b64_tr_b16 a[58:59], v255 offset:12352
    s_waitcnt vmcnt(13)
    ds_read_b64_tr_b16 a[60:61], v254 offset:15360
    ds_read_b64_tr_b16 a[62:63], v255 offset:15360
    ds_read_b64_tr_b16 a[64:65], v254 offset:15392
    ds_read_b64_tr_b16 a[66:67], v255 offset:15392
    ds_read_b64_tr_b16 a[68:69], v254 offset:15424
    ds_read_b64_tr_b16 a[70:71], v255 offset:15424
    buffer_load_ushort v153, v29, s[16:19], 0 offen
    buffer_load_ushort v154, v30, s[16:19], 0 offen
    buffer_load_ushort v155, v31, s[16:19], 0 offen
    s_waitcnt vmcnt(12)
    s_barrier
    buffer_load_ushort v156, v32, s[16:19], 0 offen
    s_waitcnt vmcnt(12)
    v_lshlrev_b32 v144, 16, v144
    buffer_load_ushort v157, v33, s[16:19], 0 offen
    s_waitcnt vmcnt(12)
    v_lshlrev_b32 v145, 16, v145
    buffer_load_ushort v158, v34, s[16:19], 0 offen
    s_waitcnt vmcnt(12)
    v_lshlrev_b32 v146, 16, v146
    buffer_load_ushort v159, v35, s[16:19], 0 offen
    s_waitcnt vmcnt(12)
    v_lshlrev_b32 v147, 16, v147
    buffer_load_dwordx4 v246, s[4:7], s56 offen lds
    s_add_u32 m0, s42, 0x7900
    s_nop 0
    s_waitcnt vmcnt(12)
    v_lshlrev_b32 v148, 16, v148
    buffer_load_dwordx4 v247, s[4:7], s56 offen lds
    s_add_u32 s56, s39, 0xd2000
    s_add_u32 m0, s41, 0x9740
    s_waitcnt vmcnt(12)
    v_lshlrev_b32 v149, 16, v149
    buffer_load_dwordx4 v246, s[4:7], s56 offen lds
    s_add_u32 m0, s42, 0x9740
    s_nop 0
    s_waitcnt vmcnt(12)
    v_lshlrev_b32 v150, 16, v150
    buffer_load_dwordx4 v247, s[4:7], s56 offen lds
    s_add_u32 s56, s39, 0xfc000
    s_add_u32 m0, s41, 0xb580
    s_waitcnt vmcnt(12)
    v_lshlrev_b32 v151, 16, v151
    buffer_load_dwordx4 v246, s[4:7], s56 offen lds
    s_add_u32 m0, s42, 0xb580
    s_nop 0
    s_waitcnt vmcnt(12)
    v_lshlrev_b32 v152, 16, v152
    buffer_load_dwordx4 v247, s[4:7], s56 offen lds
    s_add_u32 s56, s39, 0x126000
    s_add_u32 m0, s41, 0xd3c0
    s_waitcnt vmcnt(12)
    v_lshlrev_b32 v153, 16, v153
    buffer_load_dwordx4 v246, s[4:7], s56 offen lds
    s_add_u32 m0, s42, 0xd3c0
    s_add_u32 s46, s39, 0x2ca000
    s_add_u32 s53, s38, 0x1236000
    s_cmp_eq_u32 s34, 7
    s_cselect_b32 s46, s53, s46
    s_add_u32 s47, s39, 0x2f4000
    s_add_u32 s53, s38, 0x113a000
    s_cmp_eq_u32 s34, 7
    s_cselect_b32 s47, s53, s47
    s_add_u32 s48, s39, 0x31e000
    s_add_u32 s53, s38, 0x1164000
    s_cmp_eq_u32 s34, 7
    s_cselect_b32 s48, s53, s48
    s_and_b32 s52, s36, 1
    s_lshl_b32 s53, s52, 5
    s_lshl_b32 s54, s52, 6
    s_sub_u32 s54, 64, s54
    v_add_u32 v240, s53, v9
    v_lshl_add_u32 v9, v6, 3, v8
    v_add_u32 v241, s54, v9
    v_mul_u32_u24 v8, 0x2a000, v4
    v_mul_u32_u24 v9, 0x300, v3
    buffer_load_dwordx4 v247, s[4:7], s56 offen lds
    v_add3_u32 v8, v8, v9, s49
    v_lshl_add_u32 v9, v2, 4, v8
    v_add_u32 v242, s53, v9
    v_lshl_add_u32 v9, v2, 3, v8
    v_add_u32 v243, s54, v9
    v_bfrev_b32 v9, 1
    v_cndmask_b32 v244, v242, v9, vcc
    v_cndmask_b32 v245, v243, v9, vcc
    s_mul_i32 s53, s35, 0x2a00
    s_add_u32 s51, s51, s53
    v_mul_u32_u24 v8, 0x1e40, v4
    v_and_b32 v6, 2, v5
    v_xor_b32 v6, v6, v2
    v_mul_u32_u24 v5, 0x180, v5
    v_lshl_add_u32 v5, v6, 4, v5
    v_add_u32 v224, v5, v8
    v_add_u32 v5, 3, v3
    v_and_b32 v6, 2, v5
    v_xor_b32 v6, v6, v2
    v_mul_u32_u24 v5, 0x180, v5
    v_lshl_add_u32 v5, v6, 4, v5
    v_add_u32 v225, v5, v8
    v_xor_b32 v6, 1, v4
    v_mul_u32_u24 v6, 0xd3c0, v6
    v_add_u32 v226, v5, v6
    v_bfe_u32 v5, v1, 2, 2
    v_mul_u32_u24 v5, 0x1e40, v5
    v_and_b32 v6, 3, v1
    v_add_u32 v6, 16, v6
    v_mul_u32_u24 v6, 0x180, v6
    v_add3_u32 v227, v5, v6, v7
    s_lshr_b32 s53, s36, 1
    s_mul_i32 s53, s53, 0xc00
    s_add_u32 s53, s53, 0x12900
    s_lshl_b32 s54, s52, 11
    s_add_u32 s54, s54, s53
    v_lshl_add_u32 v237, v1, 4, s54
    s_lshl_b32 s54, s52, 3
    s_add_u32 s54, s54, s53
    s_add_u32 s54, s54, 0x400
    v_lshl_add_u32 v238, v1, 4, s54
    s_add_u32 s55, s55, 0xf200
    v_mov_b32 v5, v3
    v_add_u32 v6, 0, v10
    v_lshlrev_b32 v7, 2, v6
    v_sub_u32 v7, v7, v5
    v_add_u32 v7, 3, v7
    v_min_u32 v7, 10, v7
    v_mul_u32_u24 v8, 3, v5
    v_add3_u32 v8, v8, v6, 11
    v_mov_b32 v9, 10
    v_cmp_eq_u32 vcc, 3, v6
    s_cmp_eq_u32 s35, 0
    s_cselect_b32 s53, 3, 0
    v_cndmask_b32 v8, v8, v9, vcc
    v_cmp_gt_u32 vcc, s53, v5
    v_mov_b32 v5, v3
    v_add_u32 v6, 2, v10
    v_cndmask_b32 v7, v7, v8, vcc
    v_lshl_add_u32 v228, v7, 4, s55
    v_lshlrev_b32 v7, 2, v6
    v_sub_u32 v7, v7, v5
    v_add_u32 v7, 3, v7
    v_min_u32 v7, 10, v7
    v_mul_u32_u24 v8, 3, v5
    v_add3_u32 v8, v8, v6, 11
    v_mov_b32 v9, 10
    v_cmp_eq_u32 vcc, 3, v6
    s_cmp_eq_u32 s35, 0
    s_cselect_b32 s53, 3, 0
    v_cndmask_b32 v8, v8, v9, vcc
    v_cmp_gt_u32 vcc, s53, v5
    v_min_u32 v5, 5, v3
    v_add_u32 v6, 0, v10
    v_cndmask_b32 v7, v7, v8, vcc
    v_lshl_add_u32 v229, v7, 4, s55
    v_lshlrev_b32 v7, 2, v6
    v_sub_u32 v7, v7, v5
    v_add_u32 v7, 3, v7
    v_min_u32 v7, 10, v7
    v_add_u32 v5, -3, v5
    v_mul_u32_u24 v8, 3, v5
    v_add3_u32 v8, v8, v6, 11
    v_mov_b32 v9, 10
    v_cmp_eq_u32 vcc, 3, v6
    s_cmp_eq_u32 s35, 7
    s_cselect_b32 s53, 3, 0
    v_cndmask_b32 v8, v8, v9, vcc
    v_cmp_gt_u32 vcc, s53, v5
    v_min_u32 v5, 5, v3
    v_mov_b32 v6, 2
    v_cndmask_b32 v7, v7, v8, vcc
    v_lshl_add_u32 v230, v7, 4, s55
    v_lshlrev_b32 v7, 2, v6
    v_sub_u32 v7, v7, v5
    v_add_u32 v7, 3, v7
    v_min_u32 v7, 10, v7
    v_add_u32 v5, -3, v5
    v_mul_u32_u24 v8, 3, v5
    v_add3_u32 v8, v8, v6, 11
    v_mov_b32 v9, 10
    v_cmp_eq_u32 vcc, 3, v6
    s_cmp_eq_u32 s35, 7
    s_cselect_b32 s53, 3, 0
    v_cndmask_b32 v8, v8, v9, vcc
    v_cmp_gt_u32 vcc, s53, v5
    v_lshrrev_b32 v5, 1, v2
    v_lshl_add_u32 v5, v4, 1, v5
    v_cndmask_b32 v7, v7, v8, vcc
    v_lshl_add_u32 v231, v7, 4, s55
    v_lshlrev_b32 v232, 2, v5
    v_lshl_add_u32 v5, v4, 2, v2
    v_lshlrev_b32 v233, 2, v5
    v_mov_b32 v5, 0x3f803f80
    v_accvgpr_write_b32 a216, v5
    v_accvgpr_write_b32 a217, v5
    v_accvgpr_write_b32 a218, v5
    v_accvgpr_write_b32 a219, v5
    s_cmp_eq_u32 s34, 0
    s_cmov_b32 s60, 0x98a9
    s_cmov_b32 s61, 0x2737
    s_cmov_b32 s63, 0x6586
    s_cmov_b32 s64, 0x279837a9
    s_cmov_b32 s65, 0x65438654
    s_cmov_b32 s66, 0x717
    s_cmov_b32 s68, 0x7771777
    s_cmov_b32 s70, 0x77657786
    s_cmp_eq_u32 s34, 7
    s_cmov_b32 s77, 0xa10
    s_cmov_b32 s78, 0x7576
    s_cmov_b32 s79, 0x77757776
    s_cmov_b32 s80, 0xa771077
    s_cmov_b32 s81, 0x7374
    s_cmov_b32 s82, 0x98a9
    s_cmov_b32 s83, 0x210a3210
    s_cmov_b32 s84, 0x9873a974
    s_mov_b32 s53, 0x40ddb3d7
    v_mov_b32 v10, 0xf149f2ca
    v_mul_f32 v144, s53, v144
    v_add_u32 v5, 0, v16
    v_cmp_gt_u32 vcc, 7, v5
    v_mul_f32 v145, s53, v145
    v_add_u32 v5, 1, v16
    v_cndmask_b32 v144, v10, v144, vcc
    v_cmp_gt_u32 vcc, 7, v5
    v_mul_f32 v146, s53, v146
    v_add_u32 v5, 2, v16
    v_cndmask_b32 v145, v10, v145, vcc
    v_cmp_gt_u32 vcc, 7, v5
    v_mul_f32 v147, s53, v147
    v_add_u32 v5, 3, v16
    v_cndmask_b32 v146, v10, v146, vcc
    v_cmp_gt_u32 vcc, 7, v5
    v_add_u32 v5, 0, v1
    v_min_u32 v5, 0xdb, v5
    v_cndmask_b32 v147, v10, v147, vcc
    v_lshl_add_u32 v6, v5, 4, s55
    ds_write_b128 v6, v[144:147]
    v_mul_f32 v148, s53, v148
    v_add_u32 v5, 0, v17
    v_cmp_gt_u32 vcc, 7, v5
    v_mul_f32 v149, s53, v149
    v_add_u32 v5, 1, v17
    v_cndmask_b32 v148, v10, v148, vcc
    v_cmp_gt_u32 vcc, 7, v5
    v_mul_f32 v150, s53, v150
    v_add_u32 v5, 2, v17
    v_cndmask_b32 v149, v10, v149, vcc
    v_cmp_gt_u32 vcc, 7, v5
    v_mul_f32 v151, s53, v151
    v_add_u32 v5, 3, v17
    v_cndmask_b32 v150, v10, v150, vcc
    v_cmp_gt_u32 vcc, 7, v5
    v_add_u32 v5, 64, v1
    v_min_u32 v5, 0xdb, v5
    v_cndmask_b32 v151, v10, v151, vcc
    v_lshl_add_u32 v7, v5, 4, s55
    ds_write_b128 v7, v[148:151]
    v_mul_f32 v152, s53, v152
    v_add_u32 v5, 0, v18
    v_cmp_gt_u32 vcc, 7, v5
    v_mul_f32 v153, s53, v153
    v_add_u32 v5, 1, v18
    v_cndmask_b32 v152, v10, v152, vcc
    v_cmp_gt_u32 vcc, 7, v5
    s_waitcnt vmcnt(13)
    v_lshlrev_b32 v154, 16, v154
    v_mul_f32 v154, s53, v154
    v_cndmask_b32 v153, v10, v153, vcc
    v_add_u32 v5, 2, v18
    v_cmp_gt_u32 vcc, 7, v5
    s_waitcnt vmcnt(12)
    v_lshlrev_b32 v155, 16, v155
    v_mul_f32 v155, s53, v155
    v_cndmask_b32 v154, v10, v154, vcc
    v_add_u32 v5, 3, v18
    v_cmp_gt_u32 vcc, 7, v5
    v_add_u32 v5, 0x80, v1
    v_min_u32 v5, 0xdb, v5
    v_cndmask_b32 v155, v10, v155, vcc
    v_lshl_add_u32 v6, v5, 4, s55
    ds_write_b128 v6, v[152:155]
    s_waitcnt vmcnt(11)
    v_lshlrev_b32 v156, 16, v156
    v_mul_f32 v156, s53, v156
    v_add_u32 v5, 0, v19
    v_cmp_gt_u32 vcc, 7, v5
    s_waitcnt vmcnt(10)
    v_lshlrev_b32 v157, 16, v157
    v_mul_f32 v157, s53, v157
    v_cndmask_b32 v156, v10, v156, vcc
    v_add_u32 v5, 1, v19
    v_cmp_gt_u32 vcc, 7, v5
    s_waitcnt vmcnt(9)
    v_lshlrev_b32 v158, 16, v158
    v_mul_f32 v158, s53, v158
    v_cndmask_b32 v157, v10, v157, vcc
    v_add_u32 v5, 2, v19
    v_cmp_gt_u32 vcc, 7, v5
    s_waitcnt vmcnt(8)
    v_lshlrev_b32 v159, 16, v159
    v_mul_f32 v159, s53, v159
    v_cndmask_b32 v158, v10, v158, vcc
    v_add_u32 v5, 3, v19
    v_cmp_gt_u32 vcc, 7, v5
    v_add_u32 v5, 0xc0, v1
    v_min_u32 v5, 0xdb, v5
    v_cndmask_b32 v159, v10, v159, vcc
    v_lshl_add_u32 v7, v5, 4, s55
    ds_write_b128 v7, v[156:159]
    s_add_u32 s57, s49, 0x300
    s_add_u32 m0, s50, 0
    ds_read_b128 a[220:223], v224
    s_waitcnt lgkmcnt(3)
    buffer_load_dwordx4 v251, s[8:11], s57 offen lds
    s_add_u32 m0, s50, 0x400
    ds_read_b128 a[224:227], v224 offset:64
    buffer_load_dwordx4 v252, s[8:11], s57 offen lds
    s_add_u32 m0, s50, 0x800
    ds_read_b128 a[228:231], v224 offset:128
    buffer_load_dwordx4 v253, s[8:11], s57 offen lds
    s_add_u32 s57, s49, 0x9300
    s_add_u32 m0, s50, 0xc00
    ds_read_b128 a[232:235], v224 offset:192
    buffer_load_dwordx4 v251, s[8:11], s57 offen lds
    s_add_u32 m0, s50, 0x1000
    ds_read_b128 a[236:239], v224 offset:256
    buffer_load_dwordx4 v252, s[8:11], s57 offen lds
    s_add_u32 m0, s50, 0x1400
    ds_read_b128 a[240:243], v224 offset:320
    buffer_load_dwordx4 v253, s[8:11], s57 offen lds
    s_add_u32 s57, s49, 0x12300
    s_add_u32 m0, s50, 0x1800
    ds_read_b128 a[244:247], v224 offset:3072
    buffer_load_dwordx4 v251, s[8:11], s57 offen lds
    s_add_u32 m0, s50, 0x1c00
    ds_read_b128 a[248:251], v224 offset:3136
    buffer_load_dwordx4 v252, s[8:11], s57 offen lds
    s_add_u32 m0, s50, 0x2000
    ds_read_b128 a[252:255], v224 offset:3200
    buffer_load_dwordx4 v253, s[8:11], s57 offen lds
    s_waitcnt lgkmcnt(8)
    v_mfma_f32_16x16x32_bf16 v[200:203], a[0:3], a[220:223], 0
    s_add_u32 s57, s49, 0x1b300
    v_bfe_u32 v234, s60, v232, 4
    v_mad_u32_u24 v235, v234, s40, v228
    v_mfma_f32_16x16x32_bf16 v[204:207], a[4:7], a[220:223], 0
    s_add_u32 m0, s50, 0x2400
    ds_read_b128 v[144:147], v235
    v_mad_u32_u24 v234, v234, s40, v229
    v_mfma_f32_16x16x32_bf16 v[208:211], a[8:11], a[220:223], 0
    s_waitcnt vmcnt(13) lgkmcnt(8)
    s_barrier
    buffer_load_dwordx4 v251, s[8:11], s57 offen lds
    v_mfma_f32_16x16x32_bf16 v[200:203], a[12:15], a[224:227], v[200:203]
    s_add_u32 m0, s50, 0x2800
    ds_read_b128 a[220:223], v224 offset:3264
    ds_read_b128 v[148:151], v234
    v_mfma_f32_16x16x32_bf16 v[204:207], a[16:19], a[224:227], v[204:207]
    v_bfe_u32 v236, s61, v232, 4
    v_mad_u32_u24 v234, v236, s40, v229
    v_mfma_f32_16x16x32_bf16 v[208:211], a[20:23], a[224:227], v[208:211]
    s_waitcnt lgkmcnt(7)
    ds_read_b128 a[224:227], v224 offset:3328
    ds_read_b128 v[152:155], v234
    v_mfma_f32_16x16x32_bf16 v[200:203], a[24:27], a[228:231], v[200:203]
    v_mad_u32_u24 v236, v236, s40, v228
    v_bfe_u32 v235, s62, v232, 4
    v_mfma_f32_16x16x32_bf16 v[204:207], a[28:31], a[228:231], v[204:207]
    ds_read_b128 v[156:159], v236
    v_mad_u32_u24 v236, v235, s40, v228
    v_mfma_f32_16x16x32_bf16 v[208:211], a[32:35], a[228:231], v[208:211]
    ds_read_b128 a[228:231], v224 offset:3392
    ds_read_b128 v[160:163], v236
    v_mfma_f32_16x16x32_bf16 v[200:203], a[36:39], a[232:235], v[200:203]
    v_mad_u32_u24 v235, v235, s40, v229
    v_bfe_u32 v234, s63, v232, 4
    v_mfma_f32_16x16x32_bf16 v[204:207], a[40:43], a[232:235], v[204:207]
    ds_read_b128 v[164:167], v235
    v_mad_u32_u24 v235, v234, s40, v229
    v_mfma_f32_16x16x32_bf16 v[208:211], a[44:47], a[232:235], v[208:211]
    ds_read_b128 a[232:235], v224 offset:15488
    ds_read_b128 v[168:171], v235
    v_mfma_f32_16x16x32_bf16 v[200:203], a[48:51], a[236:239], v[200:203]
    v_mad_u32_u24 v234, v234, s40, v228
    v_bfe_u32 v236, s60, v232, 4
    v_mfma_f32_16x16x32_bf16 v[204:207], a[52:55], a[236:239], v[204:207]
    ds_read_b128 v[172:175], v234
    v_mad_u32_u24 v236, v236, s40, v230
    v_mfma_f32_16x16x32_bf16 v[208:211], a[56:59], a[236:239], v[208:211]
    s_waitcnt lgkmcnt(9)
    ds_read_b128 a[236:239], v224 offset:15552
    v_bfe_u32 v234, s61, v232, 4
    v_mfma_f32_16x16x32_bf16 v[200:203], a[60:63], a[240:243], v[200:203]
    v_mad_u32_u24 v234, v234, s40, v230
    v_bfe_u32 v235, s62, v232, 4
    v_mfma_f32_16x16x32_bf16 v[204:207], a[64:67], a[240:243], v[204:207]
    v_mad_u32_u24 v235, v235, s40, v230
    v_mfma_f32_16x16x32_bf16 v[208:211], a[68:71], a[240:243], v[208:211]
    ds_read_b128 a[240:243], v224 offset:15616
    v_mfma_f32_16x16x32_bf16 v[212:215], a[0:3], a[244:247], 0
    v_mfma_f32_16x16x32_bf16 v[216:219], a[4:7], a[244:247], 0
    v_cvt_pk_bf16_f32 v0, v200, v201
    v_cvt_pk_bf16_f32 v1, v202, v203
    v_mfma_f32_16x16x32_bf16 v[220:223], a[8:11], a[244:247], 0
    v_cvt_pk_bf16_f32 v2, v204, v205
    v_cvt_pk_bf16_f32 v3, v206, v207
    v_mfma_f32_16x16x32_bf16 v[212:215], a[12:15], a[248:251], v[212:215]
    v_cvt_pk_bf16_f32 v4, v208, v209
    v_cvt_pk_bf16_f32 v5, v210, v211
    v_mfma_f32_16x16x32_bf16 v[216:219], a[16:19], a[248:251], v[216:219]
    ds_read_b128 a[244:247], v224 offset:15680
    v_mfma_f32_16x16x32_bf16 v[220:223], a[20:23], a[248:251], v[220:223]
    ds_read_b128 a[248:251], v224 offset:15744
    v_mfma_f32_16x16x32_bf16 v[212:215], a[24:27], a[252:255], v[212:215]
    v_mfma_f32_16x16x32_bf16 v[216:219], a[28:31], a[252:255], v[216:219]
    v_mfma_f32_16x16x32_bf16 v[220:223], a[32:35], a[252:255], v[220:223]
    ds_read_b128 a[252:255], v224 offset:15808
    v_mfma_f32_16x16x32_bf16 v[212:215], a[36:39], a[220:223], v[212:215]
    v_mfma_f32_16x16x32_bf16 v[216:219], a[40:43], a[220:223], v[216:219]
    v_mfma_f32_16x16x32_bf16 v[220:223], a[44:47], a[220:223], v[220:223]
    s_waitcnt lgkmcnt(3)
    ds_read_b128 a[220:223], v224 offset:18560
    v_mfma_f32_16x16x32_bf16 v[212:215], a[48:51], a[224:227], v[212:215]
    v_mfma_f32_16x16x32_bf16 v[216:219], a[52:55], a[224:227], v[216:219]
    v_mfma_f32_16x16x32_bf16 v[220:223], a[56:59], a[224:227], v[220:223]
    ds_read_b128 a[224:227], v224 offset:18624
    v_mfma_f32_16x16x32_bf16 v[212:215], a[60:63], a[228:231], v[212:215]
    v_mfma_f32_16x16x32_bf16 v[216:219], a[64:67], a[228:231], v[216:219]
    v_mfma_f32_16x16x32_bf16 v[220:223], a[68:71], a[228:231], v[220:223]
    ds_read_b128 a[228:231], v224 offset:18688
    v_mfma_f32_16x16x32_bf16 v[200:203], a[0:3], a[232:235], 0
    v_mfma_f32_16x16x32_bf16 v[204:207], a[4:7], a[232:235], 0
    v_mfma_f32_16x16x32_bf16 v[208:211], a[8:11], a[232:235], 0
    ds_read_b128 a[232:235], v224 offset:18752
    v_mfma_f32_16x16x32_bf16 v[200:203], a[12:15], a[236:239], v[200:203]
    v_cvt_pk_bf16_f32 v24, v212, v213
    v_cvt_pk_bf16_f32 v25, v214, v215
    v_mfma_f32_16x16x32_bf16 v[204:207], a[16:19], a[236:239], v[204:207]
    v_cvt_pk_bf16_f32 v26, v216, v217
    v_cvt_pk_bf16_f32 v27, v218, v219
    v_mfma_f32_16x16x32_bf16 v[208:211], a[20:23], a[236:239], v[208:211]
    v_cvt_pk_bf16_f32 v28, v220, v221
    v_cvt_pk_bf16_f32 v29, v222, v223
    v_mfma_f32_16x16x32_bf16 v[200:203], a[24:27], a[240:243], v[200:203]
    ds_read_b128 a[236:239], v224 offset:18816
    v_mfma_f32_16x16x32_bf16 v[204:207], a[28:31], a[240:243], v[204:207]
    v_mfma_f32_16x16x32_bf16 v[208:211], a[32:35], a[240:243], v[208:211]
    s_waitcnt lgkmcnt(3)
    ds_read_b128 a[240:243], v224 offset:18880
    v_mfma_f32_16x16x32_bf16 v[200:203], a[36:39], a[244:247], v[200:203]
    v_mfma_f32_16x16x32_bf16 v[204:207], a[40:43], a[244:247], v[204:207]
    buffer_load_dwordx4 v252, s[8:11], s57 offen lds
    v_mfma_f32_16x16x32_bf16 v[208:211], a[44:47], a[244:247], v[208:211]
    s_add_u32 m0, s50, 0x2c00
    ds_read_b128 a[244:247], v227
    v_mfma_f32_16x16x32_bf16 v[200:203], a[48:51], a[248:251], v[200:203]
    v_mfma_f32_16x16x32_bf16 v[204:207], a[52:55], a[248:251], v[204:207]
    v_mfma_f32_16x16x32_bf16 v[208:211], a[56:59], a[248:251], v[208:211]
    ds_read_b128 a[248:251], v227 offset:64
    v_mfma_f32_16x16x32_bf16 v[200:203], a[60:63], a[252:255], v[200:203]
    v_mfma_f32_16x16x32_bf16 v[204:207], a[64:67], a[252:255], v[204:207]
    v_mfma_f32_16x16x32_bf16 v[208:211], a[68:71], a[252:255], v[208:211]
    buffer_load_dwordx4 v253, s[8:11], s57 offen lds
    v_mfma_f32_16x16x32_bf16 v[212:215], a[0:3], a[220:223], 0
    s_add_u32 s57, s49, 0x24300
    ds_read_b128 a[252:255], v227 offset:128
    s_add_u32 m0, s50, 0x3000
    v_mfma_f32_16x16x32_bf16 v[216:219], a[4:7], a[220:223], 0
    s_waitcnt vmcnt(12)
    s_barrier
    v_cvt_pk_bf16_f32 v6, v200, v201
    v_cvt_pk_bf16_f32 v7, v202, v203
    v_mfma_f32_16x16x32_bf16 v[220:223], a[8:11], a[220:223], 0
    v_cvt_pk_bf16_f32 v8, v204, v205
    v_cvt_pk_bf16_f32 v9, v206, v207
    v_mfma_f32_16x16x32_bf16 v[212:215], a[12:15], a[224:227], v[212:215]
    v_cvt_pk_bf16_f32 v10, v208, v209
    v_cvt_pk_bf16_f32 v11, v210, v211
    v_mfma_f32_16x16x32_bf16 v[216:219], a[16:19], a[224:227], v[216:219]
    ds_read_b128 a[220:223], v227 offset:192
    v_mfma_f32_16x16x32_bf16 v[220:223], a[20:23], a[224:227], v[220:223]
    s_waitcnt lgkmcnt(3)
    ds_read_b128 a[224:227], v227 offset:256
    v_mfma_f32_16x16x32_bf16 v[212:215], a[24:27], a[228:231], v[212:215]
    v_mfma_f32_16x16x32_bf16 v[216:219], a[28:31], a[228:231], v[216:219]
    v_mfma_f32_16x16x32_bf16 v[220:223], a[32:35], a[228:231], v[220:223]
    ds_read_b128 a[228:231], v227 offset:320
    v_mfma_f32_16x16x32_bf16 v[212:215], a[36:39], a[232:235], v[212:215]
    v_mfma_f32_16x16x32_bf16 v[216:219], a[40:43], a[232:235], v[216:219]
    v_mfma_f32_16x16x32_bf16 v[220:223], a[44:47], a[232:235], v[220:223]
    ds_read_b128 a[232:235], v224 offset:30976
    v_mfma_f32_16x16x32_bf16 v[212:215], a[48:51], a[236:239], v[212:215]
    buffer_load_dwordx4 v251, s[8:11], s57 offen lds
    v_mfma_f32_16x16x32_bf16 v[216:219], a[52:55], a[236:239], v[216:219]
    s_add_u32 m0, s50, 0x3400
    v_mfma_f32_16x16x32_bf16 v[220:223], a[56:59], a[236:239], v[220:223]
    ds_read_b128 a[236:239], v224 offset:31040
    v_mfma_f32_16x16x32_bf16 v[212:215], a[60:63], a[240:243], v[212:215]
    v_mfma_f32_16x16x32_bf16 v[216:219], a[64:67], a[240:243], v[216:219]
    v_mfma_f32_16x16x32_bf16 v[220:223], a[68:71], a[240:243], v[220:223]
    buffer_load_dwordx4 v252, s[8:11], s57 offen lds
    v_mfma_f32_16x16x32_bf16 v[200:203], a[0:3], a[244:247], 0
    s_add_u32 m0, s50, 0x3800
    ds_read_b128 a[240:243], v224 offset:31104
    v_mfma_f32_16x16x32_bf16 v[204:207], a[4:7], a[244:247], 0
    v_mfma_f32_16x16x32_bf16 v[208:211], a[8:11], a[244:247], 0
    s_waitcnt lgkmcnt(3)
    v_cvt_pk_bf16_f32 v30, v212, v213
    v_cvt_pk_bf16_f32 v31, v214, v215
    v_mfma_f32_16x16x32_bf16 v[200:203], a[12:15], a[248:251], v[200:203]
    v_cvt_pk_bf16_f32 v32, v216, v217
    v_cvt_pk_bf16_f32 v33, v218, v219
    v_mfma_f32_16x16x32_bf16 v[204:207], a[16:19], a[248:251], v[204:207]
    v_cvt_pk_bf16_f32 v34, v220, v221
    v_cvt_pk_bf16_f32 v35, v222, v223
    v_mfma_f32_16x16x32_bf16 v[208:211], a[20:23], a[248:251], v[208:211]
    buffer_load_dwordx4 v253, s[8:11], s57 offen lds
    v_mfma_f32_16x16x32_bf16 v[200:203], a[24:27], a[252:255], v[200:203]
    s_add_u32 s57, s49, 0x2d300
    ds_read_b128 a[244:247], v224 offset:31168
    ds_read_b128 a[248:251], v224 offset:31232
    v_mfma_f32_16x16x32_bf16 v[204:207], a[28:31], a[252:255], v[204:207]
    s_add_u32 m0, s50, 0x3c00
    s_waitcnt vmcnt(12)
    ds_read_b64_tr_b16 a[72:73], v254
    ds_read_b64_tr_b16 a[74:75], v255
    v_mfma_f32_16x16x32_bf16 v[208:211], a[32:35], a[252:255], v[208:211]
    ds_read_b128 a[252:255], v224 offset:31296
    ds_read_b64_tr_b16 a[76:77], v254 offset:32
    v_mfma_f32_16x16x32_bf16 v[200:203], a[36:39], a[220:223], v[200:203]
    ds_read_b64_tr_b16 a[78:79], v255 offset:32
    ds_read_b64_tr_b16 a[80:81], v254 offset:64
    v_mfma_f32_16x16x32_bf16 v[204:207], a[40:43], a[220:223], v[204:207]
    buffer_load_dwordx4 v251, s[8:11], s57 offen lds
    v_mfma_f32_16x16x32_bf16 v[208:211], a[44:47], a[220:223], v[208:211]
    s_add_u32 m0, s50, 0x4000
    ds_read_b128 a[220:223], v224 offset:34048
    ds_read_b64_tr_b16 a[82:83], v255 offset:64
    v_mfma_f32_16x16x32_bf16 v[200:203], a[48:51], a[224:227], v[200:203]
    v_mfma_f32_16x16x32_bf16 v[204:207], a[52:55], a[224:227], v[204:207]
    v_mfma_f32_16x16x32_bf16 v[208:211], a[56:59], a[224:227], v[208:211]
    ds_read_b128 a[224:227], v224 offset:34112
    v_mfma_f32_16x16x32_bf16 v[200:203], a[60:63], a[228:231], v[200:203]
    v_mfma_f32_16x16x32_bf16 v[204:207], a[64:67], a[228:231], v[204:207]
    s_waitcnt lgkmcnt(11)
    buffer_load_dwordx4 v252, s[8:11], s57 offen lds
    v_mfma_f32_16x16x32_bf16 v[208:211], a[68:71], a[228:231], v[208:211]
    s_add_u32 m0, s50, 0x4400
    ds_read_b128 a[228:231], v224 offset:34176
    v_mfma_f32_16x16x32_bf16 v[212:215], a[0:3], a[232:235], 0
    v_mfma_f32_16x16x32_bf16 v[216:219], a[4:7], a[232:235], 0
    v_mfma_f32_16x16x32_bf16 v[220:223], a[8:11], a[232:235], 0
    v_cvt_pk_bf16_f32 v48, v200, v201
    v_cvt_pk_bf16_f32 v49, v202, v203
    v_mfma_f32_16x16x32_bf16 v[212:215], a[12:15], a[236:239], v[212:215]
    buffer_load_dwordx4 v253, s[8:11], s57 offen lds
    v_mfma_f32_16x16x32_bf16 v[216:219], a[16:19], a[236:239], v[216:219]
    s_add_u32 s57, s49, 0
    v_cvt_pk_bf16_f32 v50, v204, v205
    v_cvt_pk_bf16_f32 v51, v206, v207
    v_mfma_f32_16x16x32_bf16 v[220:223], a[20:23], a[236:239], v[220:223]
    s_add_u32 m0, s50, 0
    v_cvt_pk_bf16_f32 v52, v208, v209
    v_cvt_pk_bf16_f32 v53, v210, v211
    v_mfma_f32_16x16x32_bf16 v[212:215], a[24:27], a[240:243], v[212:215]
    ds_read_b128 a[232:235], v224 offset:34240
    ds_read_b128 a[236:239], v224 offset:34304
    v_mfma_f32_16x16x32_bf16 v[216:219], a[28:31], a[240:243], v[216:219]
    s_waitcnt vmcnt(12)
    ds_read_b64_tr_b16 a[84:85], v254 offset:3072
    ds_read_b64_tr_b16 a[86:87], v255 offset:3072
    v_mfma_f32_16x16x32_bf16 v[220:223], a[32:35], a[240:243], v[220:223]
    s_waitcnt lgkmcnt(5)
    ds_read_b128 a[240:243], v224 offset:34368
    ds_read_b64_tr_b16 a[88:89], v254 offset:3104
    v_mfma_f32_16x16x32_bf16 v[212:215], a[36:39], a[244:247], v[212:215]
    buffer_load_dwordx4 v251, s[8:11], s57 offen lds
    v_mfma_f32_16x16x32_bf16 v[216:219], a[40:43], a[244:247], v[216:219]
    s_add_u32 m0, s50, 0x400
    ds_read_b64_tr_b16 a[90:91], v255 offset:3104
    ds_read_b64_tr_b16 a[92:93], v254 offset:3136
    v_mfma_f32_16x16x32_bf16 v[220:223], a[44:47], a[244:247], v[220:223]
    ds_read_b64_tr_b16 a[94:95], v255 offset:3136
    ds_read_b128 a[244:247], v224 offset:46464
    v_mfma_f32_16x16x32_bf16 v[212:215], a[48:51], a[248:251], v[212:215]
    v_mfma_f32_16x16x32_bf16 v[216:219], a[52:55], a[248:251], v[216:219]
    v_mfma_f32_16x16x32_bf16 v[220:223], a[56:59], a[248:251], v[220:223]
    buffer_load_dwordx4 v252, s[8:11], s57 offen lds
    v_mfma_f32_16x16x32_bf16 v[212:215], a[60:63], a[252:255], v[212:215]
    s_add_u32 m0, s50, 0x800
    ds_read_b128 a[248:251], v224 offset:46528
    v_mfma_f32_16x16x32_bf16 v[216:219], a[64:67], a[252:255], v[216:219]
    v_mfma_f32_16x16x32_bf16 v[220:223], a[68:71], a[252:255], v[220:223]
    ds_read_b128 a[252:255], v224 offset:46592
    v_mfma_f32_16x16x32_bf16 v[200:203], a[0:3], a[220:223], 0
    v_mfma_f32_16x16x32_bf16 v[204:207], a[4:7], a[220:223], 0
    v_mfma_f32_16x16x32_bf16 v[208:211], a[8:11], a[220:223], 0
    v_cvt_pk_bf16_f32 v12, v212, v213
    v_cvt_pk_bf16_f32 v13, v214, v215
    v_mfma_f32_16x16x32_bf16 v[200:203], a[12:15], a[224:227], v[200:203]
    v_cvt_pk_bf16_f32 v14, v216, v217
    v_cvt_pk_bf16_f32 v15, v218, v219
    v_mfma_f32_16x16x32_bf16 v[204:207], a[16:19], a[224:227], v[204:207]
    v_cvt_pk_bf16_f32 v16, v220, v221
    v_cvt_pk_bf16_f32 v17, v222, v223
    v_mfma_f32_16x16x32_bf16 v[208:211], a[20:23], a[224:227], v[208:211]
    s_waitcnt vmcnt(11) lgkmcnt(2)
    buffer_load_dwordx4 v253, s[8:11], s57 offen lds
    v_mfma_f32_16x16x32_bf16 v[200:203], a[24:27], a[228:231], v[200:203]
    s_add_u32 s57, s49, 0x9000
    ds_read_b64_tr_b16 a[96:97], v254 offset:6144
    ds_read_b64_tr_b16 a[98:99], v255 offset:6144
    v_mfma_f32_16x16x32_bf16 v[204:207], a[28:31], a[228:231], v[204:207]
    s_add_u32 m0, s50, 0xc00
    ds_read_b64_tr_b16 a[100:101], v254 offset:6176
    ds_read_b64_tr_b16 a[102:103], v255 offset:6176
    v_mfma_f32_16x16x32_bf16 v[208:211], a[32:35], a[228:231], v[208:211]
    buffer_load_dwordx4 v251, s[8:11], s57 offen lds
    v_mfma_f32_16x16x32_bf16 v[200:203], a[36:39], a[232:235], v[200:203]
    s_add_u32 m0, s50, 0x1000
    ds_read_b64_tr_b16 a[104:105], v254 offset:6208
    ds_read_b64_tr_b16 a[106:107], v255 offset:6208
    v_mfma_f32_16x16x32_bf16 v[204:207], a[40:43], a[232:235], v[204:207]
    ds_read_b128 a[220:223], v224 offset:46656
    ds_read_b128 a[224:227], v224 offset:46720
    v_mfma_f32_16x16x32_bf16 v[208:211], a[44:47], a[232:235], v[208:211]
    ds_read_b128 a[228:231], v224 offset:46784
    ds_read_b128 a[232:235], v224 offset:49536
    v_mfma_f32_16x16x32_bf16 v[200:203], a[48:51], a[236:239], v[200:203]
    v_mfma_f32_16x16x32_bf16 v[204:207], a[52:55], a[236:239], v[204:207]
    buffer_load_dwordx4 v252, s[8:11], s57 offen lds
    v_mfma_f32_16x16x32_bf16 v[208:211], a[56:59], a[236:239], v[208:211]
    s_add_u32 m0, s50, 0x1400
    ds_read_b128 a[236:239], v224 offset:49600
    v_mfma_f32_16x16x32_bf16 v[200:203], a[60:63], a[240:243], v[200:203]
    v_mfma_f32_16x16x32_bf16 v[204:207], a[64:67], a[240:243], v[204:207]
    v_mfma_f32_16x16x32_bf16 v[208:211], a[68:71], a[240:243], v[208:211]
    ds_read_b128 a[240:243], v224 offset:49664
    v_mfma_f32_16x16x32_bf16 v[212:215], a[0:3], a[244:247], 0
    v_mfma_f32_16x16x32_bf16 v[216:219], a[4:7], a[244:247], 0
    v_mfma_f32_16x16x32_bf16 v[220:223], a[8:11], a[244:247], 0
    s_waitcnt lgkmcnt(6)
    buffer_load_dwordx4 v253, s[8:11], s57 offen lds
    v_mfma_f32_16x16x32_bf16 v[212:215], a[12:15], a[248:251], v[212:215]
    s_add_u32 s57, s49, 0x12000
    v_cvt_pk_bf16_f32 v36, v200, v201
    v_cvt_pk_bf16_f32 v37, v202, v203
    v_mfma_f32_16x16x32_bf16 v[216:219], a[16:19], a[248:251], v[216:219]
    s_add_u32 m0, s50, 0x1800
    v_cvt_pk_bf16_f32 v38, v204, v205
    v_cvt_pk_bf16_f32 v39, v206, v207
    v_mfma_f32_16x16x32_bf16 v[220:223], a[20:23], a[248:251], v[220:223]
    v_cvt_pk_bf16_f32 v40, v208, v209
    v_cvt_pk_bf16_f32 v41, v210, v211
    v_mfma_f32_16x16x32_bf16 v[212:215], a[24:27], a[252:255], v[212:215]
    s_waitcnt vmcnt(12)
    ds_read_b64_tr_b16 a[108:109], v254 offset:9216
    ds_read_b64_tr_b16 a[110:111], v255 offset:9216
    v_mfma_f32_16x16x32_bf16 v[216:219], a[28:31], a[252:255], v[216:219]
    ds_read_b64_tr_b16 a[112:113], v254 offset:9248
    ds_read_b64_tr_b16 a[114:115], v255 offset:9248
    v_mfma_f32_16x16x32_bf16 v[220:223], a[32:35], a[252:255], v[220:223]
    s_waitcnt lgkmcnt(5)
    ds_read_b64_tr_b16 a[116:117], v254 offset:9280
    ds_read_b64_tr_b16 a[118:119], v255 offset:9280
    v_mfma_f32_16x16x32_bf16 v[212:215], a[36:39], a[220:223], v[212:215]
    ds_read_b128 a[244:247], v224 offset:49728
    ds_read_b128 a[248:251], v224 offset:49792
    v_mfma_f32_16x16x32_bf16 v[216:219], a[40:43], a[220:223], v[216:219]
    ds_read_b128 a[252:255], v224 offset:49856
    v_mfma_f32_16x16x32_bf16 v[220:223], a[44:47], a[220:223], v[220:223]
    ds_read_b128 a[220:223], v227 offset:30976
    v_mfma_f32_16x16x32_bf16 v[212:215], a[48:51], a[224:227], v[212:215]
    v_mfma_f32_16x16x32_bf16 v[216:219], a[52:55], a[224:227], v[216:219]
    v_mfma_f32_16x16x32_bf16 v[220:223], a[56:59], a[224:227], v[220:223]
    ds_read_b128 a[224:227], v227 offset:31040
    v_mfma_f32_16x16x32_bf16 v[212:215], a[60:63], a[228:231], v[212:215]
    buffer_load_dwordx4 v251, s[8:11], s57 offen lds
    v_mfma_f32_16x16x32_bf16 v[216:219], a[64:67], a[228:231], v[216:219]
    s_add_u32 m0, s50, 0x1c00
    v_mfma_f32_16x16x32_bf16 v[220:223], a[68:71], a[228:231], v[220:223]
    ds_read_b128 a[228:231], v227 offset:31104
    v_mfma_f32_16x16x32_bf16 v[200:203], a[0:3], a[232:235], 0
    v_mfma_f32_16x16x32_bf16 v[204:207], a[4:7], a[232:235], 0
    v_mfma_f32_16x16x32_bf16 v[208:211], a[8:11], a[232:235], 0
    v_cvt_pk_bf16_f32 v18, v212, v213
    v_cvt_pk_bf16_f32 v19, v214, v215
    v_mfma_f32_16x16x32_bf16 v[200:203], a[12:15], a[236:239], v[200:203]
    buffer_load_dwordx4 v252, s[8:11], s57 offen lds
    v_mfma_f32_16x16x32_bf16 v[204:207], a[16:19], a[236:239], v[204:207]
    s_add_u32 m0, s50, 0x2000
    v_cvt_pk_bf16_f32 v20, v216, v217
    v_cvt_pk_bf16_f32 v21, v218, v219
    v_mfma_f32_16x16x32_bf16 v[208:211], a[20:23], a[236:239], v[208:211]
    s_waitcnt lgkmcnt(2)
    v_cvt_pk_bf16_f32 v22, v220, v221
    v_cvt_pk_bf16_f32 v23, v222, v223
    v_mfma_f32_16x16x32_bf16 v[200:203], a[24:27], a[240:243], v[200:203]
    ds_read_b128 a[232:235], v227 offset:31168
    ds_read_b128 a[236:239], v227 offset:31232
    v_mfma_f32_16x16x32_bf16 v[204:207], a[28:31], a[240:243], v[204:207]
    v_mfma_f32_16x16x32_bf16 v[208:211], a[32:35], a[240:243], v[208:211]
    s_waitcnt vmcnt(11)
    buffer_load_dwordx4 v253, s[8:11], s57 offen lds
    v_mfma_f32_16x16x32_bf16 v[200:203], a[36:39], a[244:247], v[200:203]
    s_add_u32 s57, s49, 0x1b000
    ds_read_b64_tr_b16 a[120:121], v254 offset:12288
    ds_read_b64_tr_b16 a[122:123], v255 offset:12288
    v_mfma_f32_16x16x32_bf16 v[204:207], a[40:43], a[244:247], v[204:207]
    s_add_u32 m0, s50, 0x2400
    ds_read_b64_tr_b16 a[124:125], v254 offset:12320
    ds_read_b64_tr_b16 a[126:127], v255 offset:12320
    v_mfma_f32_16x16x32_bf16 v[208:211], a[44:47], a[244:247], v[208:211]
    ds_read_b64_tr_b16 a[128:129], v254 offset:12352
    ds_read_b64_tr_b16 a[130:131], v255 offset:12352
    v_mfma_f32_16x16x32_bf16 v[200:203], a[48:51], a[248:251], v[200:203]
    ds_read_b128 a[240:243], v227 offset:31296
    ds_read_b128 a[244:247], v224
    v_mfma_f32_16x16x32_bf16 v[204:207], a[52:55], a[248:251], v[204:207]
    v_mfma_f32_16x16x32_bf16 v[208:211], a[56:59], a[248:251], v[208:211]
    buffer_load_dwordx4 v251, s[8:11], s57 offen lds
    v_mfma_f32_16x16x32_bf16 v[200:203], a[60:63], a[252:255], v[200:203]
    s_add_u32 m0, s50, 0x2800
    ds_read_b128 a[248:251], v224 offset:64
    v_mfma_f32_16x16x32_bf16 v[204:207], a[64:67], a[252:255], v[204:207]
    v_mfma_f32_16x16x32_bf16 v[208:211], a[68:71], a[252:255], v[208:211]
    ds_read_b128 a[252:255], v224 offset:128
    v_mfma_f32_16x16x32_bf16 v[212:215], a[0:3], a[220:223], 0
    v_mfma_f32_16x16x32_bf16 v[216:219], a[4:7], a[220:223], 0
    s_waitcnt lgkmcnt(10)
    buffer_load_dwordx4 v252, s[8:11], s57 offen lds
    v_mfma_f32_16x16x32_bf16 v[220:223], a[8:11], a[220:223], 0
    s_add_u32 m0, s50, 0x2c00
    v_cvt_pk_bf16_f32 v42, v200, v201
    v_cvt_pk_bf16_f32 v43, v202, v203
    v_mfma_f32_16x16x32_bf16 v[212:215], a[12:15], a[224:227], v[212:215]
    v_cvt_pk_bf16_f32 v44, v204, v205
    v_cvt_pk_bf16_f32 v45, v206, v207
    v_mfma_f32_16x16x32_bf16 v[216:219], a[16:19], a[224:227], v[216:219]
    v_cvt_pk_bf16_f32 v46, v208, v209
    v_cvt_pk_bf16_f32 v47, v210, v211
    v_mfma_f32_16x16x32_bf16 v[220:223], a[20:23], a[224:227], v[220:223]
    ds_read_b128 a[220:223], v224 offset:192
    ds_read_b128 a[224:227], v224 offset:256
    v_mfma_f32_16x16x32_bf16 v[212:215], a[24:27], a[228:231], v[212:215]
    v_mfma_f32_16x16x32_bf16 v[216:219], a[28:31], a[228:231], v[216:219]
    s_waitcnt vmcnt(11)
    buffer_load_dwordx4 v253, s[8:11], s57 offen lds
    v_mfma_f32_16x16x32_bf16 v[220:223], a[32:35], a[228:231], v[220:223]
    s_add_u32 s57, s49, 0x24000
    ds_read_b64_tr_b16 a[132:133], v254 offset:15360
    ds_read_b64_tr_b16 a[134:135], v255 offset:15360
    v_mfma_f32_16x16x32_bf16 v[212:215], a[36:39], a[232:235], v[212:215]
    s_add_u32 m0, s50, 0x3000
    ds_read_b64_tr_b16 a[136:137], v254 offset:15392
    ds_read_b64_tr_b16 a[138:139], v255 offset:15392
    v_mfma_f32_16x16x32_bf16 v[216:219], a[40:43], a[232:235], v[216:219]
    ds_read_b64_tr_b16 a[140:141], v254 offset:15424
    ds_read_b64_tr_b16 a[142:143], v255 offset:15424
    v_mfma_f32_16x16x32_bf16 v[220:223], a[44:47], a[232:235], v[220:223]
    ds_read_b128 a[228:231], v224 offset:320
    ds_read_b128 a[232:235], v224 offset:3072
    v_mfma_f32_16x16x32_bf16 v[212:215], a[48:51], a[236:239], v[212:215]
    s_waitcnt lgkmcnt(10)
    buffer_load_dwordx4 v251, s[8:11], s57 offen lds
    v_mfma_f32_16x16x32_bf16 v[216:219], a[52:55], a[236:239], v[216:219]
    s_add_u32 m0, s50, 0x3400
    v_mfma_f32_16x16x32_bf16 v[220:223], a[56:59], a[236:239], v[220:223]
    ds_read_b128 a[236:239], v224 offset:3136
    v_mfma_f32_16x16x32_bf16 v[212:215], a[60:63], a[240:243], v[212:215]
    v_mfma_f32_16x16x32_bf16 v[216:219], a[64:67], a[240:243], v[216:219]
    v_mfma_f32_16x16x32_bf16 v[220:223], a[68:71], a[240:243], v[220:223]
    ds_read_b128 a[240:243], v224 offset:3200
    v_mfma_f32_16x16x32_bf16 v[200:203], a[244:247], a[72:75], 0
    buffer_load_dwordx4 v252, s[8:11], s57 offen lds
    v_mfma_f32_16x16x32_bf16 v[204:207], a[244:247], a[76:79], 0
    s_add_u32 m0, s50, 0x3800
    v_mfma_f32_16x16x32_bf16 v[208:211], a[244:247], a[80:83], 0
    v_cvt_pk_bf16_f32 v54, v212, v213
    v_cvt_pk_bf16_f32 v55, v214, v215
    v_mfma_f32_16x16x32_bf16 v[200:203], a[248:251], a[84:87], v[200:203]
    v_cvt_pk_bf16_f32 v56, v216, v217
    v_cvt_pk_bf16_f32 v57, v218, v219
    v_mfma_f32_16x16x32_bf16 v[204:207], a[248:251], a[88:91], v[204:207]
    v_cvt_pk_bf16_f32 v58, v220, v221
    v_cvt_pk_bf16_f32 v59, v222, v223
    v_mfma_f32_16x16x32_bf16 v[208:211], a[248:251], a[92:95], v[208:211]
    ds_read_b128 a[244:247], v224 offset:3264
    ds_read_b128 a[248:251], v224 offset:3328
    v_mfma_f32_16x16x32_bf16 v[200:203], a[252:255], a[96:99], v[200:203]
    v_mfma_f32_16x16x32_bf16 v[204:207], a[252:255], a[100:103], v[204:207]
    v_mfma_f32_16x16x32_bf16 v[208:211], a[252:255], a[104:107], v[208:211]
    s_waitcnt vmcnt(11) lgkmcnt(3)
    buffer_load_dwordx4 v253, s[8:11], s57 offen lds
    v_mfma_f32_16x16x32_bf16 v[200:203], a[220:223], a[108:111], v[200:203]
    s_add_u32 s57, s49, 0x2d000
    ds_read_b128 a[252:255], v224 offset:3392
    ds_read_b64_tr_b16 a[144:145], v254
    v_mfma_f32_16x16x32_bf16 v[204:207], a[220:223], a[112:115], v[204:207]
    s_add_u32 m0, s50, 0x3c00
    ds_read_b64_tr_b16 a[146:147], v255
    ds_read_b64_tr_b16 a[148:149], v254 offset:32
    v_mfma_f32_16x16x32_bf16 v[208:211], a[220:223], a[116:119], v[208:211]
    ds_read_b128 a[220:223], v224 offset:15488
    ds_read_b64_tr_b16 a[150:151], v255 offset:32
    v_mfma_f32_16x16x32_bf16 v[200:203], a[224:227], a[120:123], v[200:203]
    ds_read_b64_tr_b16 a[152:153], v254 offset:64
    ds_read_b64_tr_b16 a[154:155], v255 offset:64
    v_mfma_f32_16x16x32_bf16 v[204:207], a[224:227], a[124:127], v[204:207]
    v_mfma_f32_16x16x32_bf16 v[208:211], a[224:227], a[128:131], v[208:211]
    buffer_load_dwordx4 v251, s[8:11], s57 offen lds
    v_mfma_f32_16x16x32_bf16 v[200:203], a[228:231], a[132:135], v[200:203]
    s_add_u32 m0, s50, 0x4000
    ds_read_b128 a[224:227], v224 offset:15552
    v_lshl_add_u32 v251, v250, 4, v248
    v_mfma_f32_16x16x32_bf16 v[204:207], a[228:231], a[136:139], v[204:207]
    v_add_u32 v250, 64, v239
    v_mul_u32_u24 v248, 0x2aab, v250
    v_mfma_f32_16x16x32_bf16 v[208:211], a[228:231], a[140:143], v[208:211]
    ds_read_b128 a[228:231], v224 offset:15616
    v_cvt_pk_bf16_f32 v66, v200, v201
    v_mfma_f32_16x16x32_bf16 v[212:215], a[232:235], a[72:75], 0
    v_cvt_pk_bf16_f32 v67, v202, v203
    v_lshrrev_b32 v248, 16, v248
    v_mfma_f32_16x16x32_bf16 v[216:219], a[232:235], a[76:79], 0
    buffer_load_dwordx4 v252, s[8:11], s57 offen lds
    v_mfma_f32_16x16x32_bf16 v[220:223], a[232:235], a[80:83], 0
    s_add_u32 m0, s50, 0x4400
    v_cvt_pk_bf16_f32 v88, v204, v205
    v_cvt_pk_bf16_f32 v89, v206, v207
    v_mfma_f32_16x16x32_bf16 v[212:215], a[236:239], a[84:87], v[212:215]
    v_cvt_pk_bf16_f32 v110, v208, v209
    v_cvt_pk_bf16_f32 v111, v210, v211
    v_mfma_f32_16x16x32_bf16 v[216:219], a[236:239], a[88:91], v[216:219]
    ds_read_b128 a[232:235], v224 offset:15680
    v_mul_u32_u24 v249, 6, v248
    v_mfma_f32_16x16x32_bf16 v[220:223], a[236:239], a[92:95], v[220:223]
    s_waitcnt lgkmcnt(3)
    ds_read_b128 a[236:239], v224 offset:15744
    v_sub_u32 v250, v250, v249
    v_mfma_f32_16x16x32_bf16 v[212:215], a[240:243], a[96:99], v[212:215]
    v_lshrrev_b32 v249, 1, v248
    v_and_b32 v249, 4, v249
    v_mfma_f32_16x16x32_bf16 v[216:219], a[240:243], a[100:103], v[216:219]
    buffer_load_dwordx4 v253, s[8:11], s57 offen lds
    v_mfma_f32_16x16x32_bf16 v[220:223], a[240:243], a[104:107], v[220:223]
    s_add_u32 s57, s49, 0
    ds_read_b128 a[240:243], v224 offset:15808
    v_xor_b32 v248, v248, v249
    v_mfma_f32_16x16x32_bf16 v[212:215], a[244:247], a[108:111], v[212:215]
    s_add_u32 m0, s50, 0
    s_waitcnt vmcnt(12)
    ds_read_b64_tr_b16 a[156:157], v254 offset:3072
    v_mul_u32_u24 v248, 0x180, v248
    v_mfma_f32_16x16x32_bf16 v[216:219], a[244:247], a[112:115], v[216:219]
    ds_read_b64_tr_b16 a[158:159], v255 offset:3072
    v_lshl_add_u32 v252, v250, 4, v248
    v_mfma_f32_16x16x32_bf16 v[220:223], a[244:247], a[116:119], v[220:223]
    ds_read_b128 a[244:247], v224 offset:18560
    v_add_u32 v250, 0x80, v239
    v_mfma_f32_16x16x32_bf16 v[212:215], a[248:251], a[120:123], v[212:215]
    v_mul_u32_u24 v248, 0x2aab, v250
    v_lshrrev_b32 v248, 16, v248
    v_mfma_f32_16x16x32_bf16 v[216:219], a[248:251], a[124:127], v[216:219]
    v_mul_u32_u24 v249, 6, v248
    v_sub_u32 v250, v250, v249
    v_mfma_f32_16x16x32_bf16 v[220:223], a[248:251], a[128:131], v[220:223]
    ds_read_b128 a[248:251], v224 offset:18624
    v_lshrrev_b32 v249, 1, v248
    v_mfma_f32_16x16x32_bf16 v[212:215], a[252:255], a[132:135], v[212:215]
    v_and_b32 v249, 4, v249
    v_xor_b32 v248, v248, v249
    v_mfma_f32_16x16x32_bf16 v[216:219], a[252:255], a[136:139], v[216:219]
    v_mul_u32_u24 v248, 0x180, v248
    v_lshl_add_u32 v253, v250, 4, v248
    v_mfma_f32_16x16x32_bf16 v[220:223], a[252:255], a[140:143], v[220:223]
    ds_read_b128 a[252:255], v224 offset:18688
    v_lshlrev_b32 v239, 4, v239
    v_mfma_f32_16x16x32_bf16 v[200:203], a[220:223], a[72:75], 0
    v_cvt_pk_bf16_f32 v68, v212, v213
    v_cvt_pk_bf16_f32 v69, v214, v215
    v_mfma_f32_16x16x32_bf16 v[204:207], a[220:223], a[76:79], 0
    v_cvt_pk_bf16_f32 v90, v216, v217
    v_cvt_pk_bf16_f32 v91, v218, v219
    v_mfma_f32_16x16x32_bf16 v[208:211], a[220:223], a[80:83], 0
    s_waitcnt lgkmcnt(4)
    v_cvt_pk_bf16_f32 v112, v220, v221
    v_cvt_pk_bf16_f32 v113, v222, v223
    v_mfma_f32_16x16x32_bf16 v[200:203], a[224:227], a[84:87], v[200:203]
    ds_read_b128 a[220:223], v224 offset:18752
    v_add_u32 v239, 0x12900, v239
    v_mfma_f32_16x16x32_bf16 v[204:207], a[224:227], a[88:91], v[204:207]
    buffer_load_dwordx4 v251, s[12:15], s57 offen lds
    v_mfma_f32_16x16x32_bf16 v[208:211], a[224:227], a[92:95], v[208:211]
    s_add_u32 m0, s50, 0x400
    ds_read_b128 a[224:227], v224 offset:18816
    ds_read_b64_tr_b16 a[160:161], v254 offset:3104
    v_mfma_f32_16x16x32_bf16 v[200:203], a[228:231], a[96:99], v[200:203]
    buffer_load_dwordx4 v252, s[12:15], s57 offen lds
    v_mfma_f32_16x16x32_bf16 v[204:207], a[228:231], a[100:103], v[204:207]
    s_add_u32 m0, s50, 0x800
    ds_read_b64_tr_b16 a[162:163], v255 offset:3104
    ds_read_b64_tr_b16 a[164:165], v254 offset:3136
    v_mfma_f32_16x16x32_bf16 v[208:211], a[228:231], a[104:107], v[208:211]
    ds_read_b128 a[228:231], v224 offset:18880
    ds_read_b64_tr_b16 a[166:167], v255 offset:3136
    v_mfma_f32_16x16x32_bf16 v[200:203], a[232:235], a[108:111], v[200:203]
    v_mfma_f32_16x16x32_bf16 v[204:207], a[232:235], a[112:115], v[204:207]
    v_mfma_f32_16x16x32_bf16 v[208:211], a[232:235], a[116:119], v[208:211]
    ds_read_b128 a[232:235], v227
    v_mfma_f32_16x16x32_bf16 v[200:203], a[236:239], a[120:123], v[200:203]
    s_waitcnt vmcnt(11)
    buffer_load_dwordx4 v253, s[12:15], s57 offen lds
    v_mfma_f32_16x16x32_bf16 v[204:207], a[236:239], a[124:127], v[204:207]
    s_add_u32 s57, s49, 0x3000
    ds_read_b64_tr_b16 a[168:169], v254 offset:6144
    ds_read_b64_tr_b16 a[170:171], v255 offset:6144
    v_mfma_f32_16x16x32_bf16 v[208:211], a[236:239], a[128:131], v[208:211]
    s_add_u32 m0, s50, 0xc00
    ds_read_b128 a[236:239], v227 offset:64
    ds_read_b64_tr_b16 a[172:173], v254 offset:6176
    v_mfma_f32_16x16x32_bf16 v[200:203], a[240:243], a[132:135], v[200:203]
    ds_read_b64_tr_b16 a[174:175], v255 offset:6176
    ds_read_b64_tr_b16 a[176:177], v254 offset:6208
    v_mfma_f32_16x16x32_bf16 v[204:207], a[240:243], a[136:139], v[204:207]
    ds_read_b64_tr_b16 a[178:179], v255 offset:6208
    v_mfma_f32_16x16x32_bf16 v[208:211], a[240:243], a[140:143], v[208:211]
    s_waitcnt lgkmcnt(12)
    ds_read_b128 a[240:243], v227 offset:128
    v_mfma_f32_16x16x32_bf16 v[212:215], a[244:247], a[72:75], 0
    s_waitcnt lgkmcnt(9)
    buffer_load_dwordx4 v251, s[12:15], s57 offen lds
    v_mfma_f32_16x16x32_bf16 v[216:219], a[244:247], a[76:79], 0
    s_add_u32 m0, s50, 0x1000
    v_cvt_pk_bf16_f32 v72, v200, v201
    v_cvt_pk_bf16_f32 v73, v202, v203
    v_mfma_f32_16x16x32_bf16 v[220:223], a[244:247], a[80:83], 0
    v_cvt_pk_bf16_f32 v94, v204, v205
    v_cvt_pk_bf16_f32 v95, v206, v207
    v_mfma_f32_16x16x32_bf16 v[212:215], a[248:251], a[84:87], v[212:215]
    v_cvt_pk_bf16_f32 v116, v208, v209
    v_cvt_pk_bf16_f32 v117, v210, v211
    v_mfma_f32_16x16x32_bf16 v[216:219], a[248:251], a[88:91], v[216:219]
    ds_read_b128 a[244:247], v227 offset:192
    v_mfma_f32_16x16x32_bf16 v[220:223], a[248:251], a[92:95], v[220:223]
    ds_read_b128 a[248:251], v227 offset:256
    v_mfma_f32_16x16x32_bf16 v[212:215], a[252:255], a[96:99], v[212:215]
    buffer_load_dwordx4 v252, s[12:15], s57 offen lds
    v_mfma_f32_16x16x32_bf16 v[216:219], a[252:255], a[100:103], v[216:219]
    s_add_u32 m0, s50, 0x1400
    v_mfma_f32_16x16x32_bf16 v[220:223], a[252:255], a[104:107], v[220:223]
    ds_read_b128 a[252:255], v227 offset:320
    v_mfma_f32_16x16x32_bf16 v[212:215], a[220:223], a[108:111], v[212:215]
    v_mfma_f32_16x16x32_bf16 v[216:219], a[220:223], a[112:115], v[216:219]
    s_waitcnt vmcnt(11)
    buffer_load_dwordx4 v253, s[12:15], s57 offen lds
    v_mfma_f32_16x16x32_bf16 v[220:223], a[220:223], a[116:119], v[220:223]
    s_add_u32 s57, s49, 0x6000
    ds_read_b64_tr_b16 a[180:181], v254 offset:9216
    ds_read_b64_tr_b16 a[182:183], v255 offset:9216
    v_mfma_f32_16x16x32_bf16 v[212:215], a[224:227], a[120:123], v[212:215]
    s_add_u32 m0, s50, 0x1800
    ds_read_b64_tr_b16 a[184:185], v254 offset:9248
    ds_read_b64_tr_b16 a[186:187], v255 offset:9248
    v_mfma_f32_16x16x32_bf16 v[216:219], a[224:227], a[124:127], v[216:219]
    ds_read_b64_tr_b16 a[188:189], v254 offset:9280
    ds_read_b64_tr_b16 a[190:191], v255 offset:9280
    v_mfma_f32_16x16x32_bf16 v[220:223], a[224:227], a[128:131], v[220:223]
    ds_read_b128 a[220:223], v225 offset:23232
    ds_read_b128 a[224:227], v225 offset:23296
    v_mfma_f32_16x16x32_bf16 v[212:215], a[228:231], a[132:135], v[212:215]
    v_mfma_f32_16x16x32_bf16 v[216:219], a[228:231], a[136:139], v[216:219]
    s_waitcnt lgkmcnt(9)
    buffer_load_dwordx4 v251, s[12:15], s57 offen lds
    v_mfma_f32_16x16x32_bf16 v[220:223], a[228:231], a[140:143], v[220:223]
    s_add_u32 m0, s50, 0x1c00
    ds_read_b128 a[228:231], v225 offset:23360
    v_mfma_f32_16x16x32_bf16 v[200:203], a[232:235], a[72:75], 0
    v_mfma_f32_16x16x32_bf16 v[204:207], a[232:235], a[76:79], 0
    v_mfma_f32_16x16x32_bf16 v[208:211], a[232:235], a[80:83], 0
    v_cvt_pk_bf16_f32 v70, v212, v213
    v_cvt_pk_bf16_f32 v71, v214, v215
    v_mfma_f32_16x16x32_bf16 v[200:203], a[236:239], a[84:87], v[200:203]
    v_cvt_pk_bf16_f32 v92, v216, v217
    v_cvt_pk_bf16_f32 v93, v218, v219
    v_mfma_f32_16x16x32_bf16 v[204:207], a[236:239], a[88:91], v[204:207]
    v_cvt_pk_bf16_f32 v114, v220, v221
    v_cvt_pk_bf16_f32 v115, v222, v223
    v_mfma_f32_16x16x32_bf16 v[208:211], a[236:239], a[92:95], v[208:211]
    buffer_load_dwordx4 v252, s[12:15], s57 offen lds
    v_mfma_f32_16x16x32_bf16 v[200:203], a[240:243], a[96:99], v[200:203]
    s_add_u32 m0, s50, 0x2000
    ds_read_b128 a[232:235], v225 offset:23424
    ds_read_b128 a[236:239], v225 offset:23488
    v_mfma_f32_16x16x32_bf16 v[204:207], a[240:243], a[100:103], v[204:207]
    v_mfma_f32_16x16x32_bf16 v[208:211], a[240:243], a[104:107], v[208:211]
    ds_read_b128 a[240:243], v225 offset:23552
    v_mfma_f32_16x16x32_bf16 v[200:203], a[244:247], a[108:111], v[200:203]
    v_mfma_f32_16x16x32_bf16 v[204:207], a[244:247], a[112:115], v[204:207]
    v_mfma_f32_16x16x32_bf16 v[208:211], a[244:247], a[116:119], v[208:211]
    s_waitcnt vmcnt(11)
    buffer_load_dwordx4 v253, s[12:15], s57 offen lds
    v_mfma_f32_16x16x32_bf16 v[200:203], a[248:251], a[120:123], v[200:203]
    s_add_u32 s57, s49, 0x9000
    ds_read_b64_tr_b16 a[192:193], v254 offset:12288
    ds_read_b64_tr_b16 a[194:195], v255 offset:12288
    v_mfma_f32_16x16x32_bf16 v[204:207], a[248:251], a[124:127], v[204:207]
    s_add_u32 m0, s50, 0x2400
    ds_read_b64_tr_b16 a[196:197], v254 offset:12320
    ds_read_b64_tr_b16 a[198:199], v255 offset:12320
    v_mfma_f32_16x16x32_bf16 v[208:211], a[248:251], a[128:131], v[208:211]
    s_waitcnt lgkmcnt(7)
    ds_read_b64_tr_b16 a[200:201], v254 offset:12352
    ds_read_b64_tr_b16 a[202:203], v255 offset:12352
    v_mfma_f32_16x16x32_bf16 v[200:203], a[252:255], a[132:135], v[200:203]
    ds_read_b128 a[244:247], v225 offset:26304
    ds_read_b128 a[248:251], v225 offset:26368
    v_mfma_f32_16x16x32_bf16 v[204:207], a[252:255], a[136:139], v[204:207]
    v_mfma_f32_16x16x32_bf16 v[208:211], a[252:255], a[140:143], v[208:211]
    buffer_load_dwordx4 v251, s[12:15], s57 offen lds
    v_mfma_f32_16x16x32_bf16 v[212:215], a[144:147], a[220:223], 0
    s_add_u32 m0, s50, 0x2800
    ds_read_b128 a[252:255], v225 offset:26432
    v_cvt_pk_bf16_f32 v82, v200, v201
    v_mfma_f32_16x16x32_bf16 v[216:219], a[148:151], a[220:223], 0
    v_cvt_pk_bf16_f32 v83, v202, v203
    v_cvt_pk_bf16_f32 v104, v204, v205
    v_mfma_f32_16x16x32_bf16 v[220:223], a[152:155], a[220:223], 0
    v_cvt_pk_bf16_f32 v105, v206, v207
    v_cvt_pk_bf16_f32 v126, v208, v209
    v_mfma_f32_16x16x32_bf16 v[212:215], a[156:159], a[224:227], v[212:215]
    ds_read_b128 a[220:223], v225 offset:26496
    v_cvt_pk_bf16_f32 v127, v210, v211
    v_mfma_f32_16x16x32_bf16 v[216:219], a[160:163], a[224:227], v[216:219]
    v_mfma_f32_16x16x32_bf16 v[220:223], a[164:167], a[224:227], v[220:223]
    buffer_load_dwordx4 v252, s[12:15], s57 offen lds
    v_mfma_f32_16x16x32_bf16 v[212:215], a[168:171], a[228:231], v[212:215]
    s_add_u32 m0, s50, 0x2c00
    ds_read_b128 a[224:227], v225 offset:26560
    v_mfma_f32_16x16x32_bf16 v[216:219], a[172:175], a[228:231], v[216:219]
    v_mfma_f32_16x16x32_bf16 v[220:223], a[176:179], a[228:231], v[220:223]
    s_waitcnt lgkmcnt(3)
    ds_read_b128 a[228:231], v225 offset:26624
    v_mfma_f32_16x16x32_bf16 v[212:215], a[180:183], a[232:235], v[212:215]
    v_mfma_f32_16x16x32_bf16 v[216:219], a[184:187], a[232:235], v[216:219]
    s_waitcnt vmcnt(11)
    buffer_load_dwordx4 v253, s[12:15], s57 offen lds
    v_mfma_f32_16x16x32_bf16 v[220:223], a[188:191], a[232:235], v[220:223]
    s_add_u32 s57, s49, 0xc000
    ds_read_b64_tr_b16 a[204:205], v254 offset:15360
    ds_read_b64_tr_b16 a[206:207], v255 offset:15360
    v_mfma_f32_16x16x32_bf16 v[212:215], a[192:195], a[236:239], v[212:215]
    s_add_u32 m0, s50, 0x3000
    ds_read_b64_tr_b16 a[208:209], v254 offset:15392
    ds_read_b64_tr_b16 a[210:211], v255 offset:15392
    v_mfma_f32_16x16x32_bf16 v[216:219], a[196:199], a[236:239], v[216:219]
    ds_read_b64_tr_b16 a[212:213], v254 offset:15424
    ds_read_b64_tr_b16 a[214:215], v255 offset:15424
    v_mfma_f32_16x16x32_bf16 v[220:223], a[200:203], a[236:239], v[220:223]
    ds_read_b128 a[232:235], v224 offset:30976
    ds_read_b128 a[236:239], v224 offset:31040
    v_mfma_f32_16x16x32_bf16 v[200:203], a[144:147], a[244:247], 0
    v_mfma_f32_16x16x32_bf16 v[204:207], a[148:151], a[244:247], 0
    v_mfma_f32_16x16x32_bf16 v[208:211], a[152:155], a[244:247], 0
    ds_read_b128 a[244:247], v224 offset:31168
    v_mfma_f32_16x16x32_bf16 v[200:203], a[156:159], a[248:251], v[200:203]
    v_mfma_f32_16x16x32_bf16 v[204:207], a[160:163], a[248:251], v[204:207]
    v_mfma_f32_16x16x32_bf16 v[208:211], a[164:167], a[248:251], v[208:211]
    s_waitcnt lgkmcnt(7)
    ds_read_b128 a[248:251], v224 offset:31232
    v_mfma_f32_16x16x32_bf16 v[212:215], a[204:207], a[240:243], v[212:215]
    s_waitcnt lgkmcnt(6)
    v_mfma_f32_16x16x32_bf16 v[216:219], a[208:211], a[240:243], v[216:219]
    s_waitcnt lgkmcnt(4)
    v_mfma_f32_16x16x32_bf16 v[220:223], a[212:215], a[240:243], v[220:223]
    ds_read_b128 a[240:243], v224 offset:31104
    v_mfma_f32_16x16x32_bf16 v[200:203], a[168:171], a[252:255], v[200:203]
    v_mfma_f32_16x16x32_bf16 v[204:207], a[172:175], a[252:255], v[204:207]
    buffer_load_dwordx4 v251, s[12:15], s57 offen lds
    v_mfma_f32_16x16x32_bf16 v[208:211], a[176:179], a[252:255], v[208:211]
    s_add_u32 m0, s50, 0x3400
    v_cvt_pk_bf16_f32 v132, v212, v213
    v_cvt_pk_bf16_f32 v133, v214, v215
    v_mfma_f32_16x16x32_bf16 v[200:203], a[180:183], a[220:223], v[200:203]
    v_cvt_pk_bf16_f32 v134, v216, v217
    v_cvt_pk_bf16_f32 v135, v218, v219
    v_mfma_f32_16x16x32_bf16 v[204:207], a[184:187], a[220:223], v[204:207]
    v_cvt_pk_bf16_f32 v136, v220, v221
    v_cvt_pk_bf16_f32 v137, v222, v223
    v_mfma_f32_16x16x32_bf16 v[144:147], v[0:3], v[132:135], v[144:147]
    ds_read_b128 a[252:255], v224 offset:31296
    v_mfma_f32_16x16x32_bf16 v[148:151], v[24:27], v[132:135], v[148:151]
    v_mfma_f32_16x16x32_bf16 v[152:155], v[30:33], v[132:135], v[152:155]
    buffer_load_dwordx4 v252, s[12:15], s57 offen lds
    v_mfma_f32_16x16x32_bf16 v[156:159], v[6:9], v[132:135], v[156:159]
    s_add_u32 m0, s50, 0x3800
    v_mfma_f32_16x16x16_bf16 v[144:147], v[4:5], v[136:137], v[144:147]
    v_mfma_f32_16x16x32_bf16 v[160:163], v[12:15], v[132:135], v[160:163]
    v_mfma_f32_16x16x16_bf16 v[148:151], v[28:29], v[136:137], v[148:151]
    v_mfma_f32_16x16x16_bf16 v[152:155], v[34:35], v[136:137], v[152:155]
    buffer_load_dwordx4 v253, s[12:15], s57 offen lds
    v_mfma_f32_16x16x16_bf16 v[156:159], v[10:11], v[136:137], v[156:159]
    s_add_u32 s57, s49, 0xf000
    s_add_u32 m0, s50, 0x3c00
    v_mfma_f32_16x16x16_bf16 v[160:163], v[16:17], v[136:137], v[160:163]
    v_max3_f32 v248, v144, v145, v146
    v_mfma_f32_16x16x32_bf16 v[164:167], v[36:39], v[132:135], v[164:167]
    v_max3_f32 v249, v147, v148, v149
    v_max3_f32 v248, v248, v150, v151
    v_mfma_f32_16x16x32_bf16 v[168:171], v[42:45], v[132:135], v[168:171]
    v_max3_f32 v249, v249, v152, v153
    v_max3_f32 v248, v248, v154, v155
    v_mfma_f32_16x16x32_bf16 v[172:175], v[18:21], v[132:135], v[172:175]
    v_max3_f32 v249, v249, v156, v157
    v_max3_f32 v248, v248, v158, v159
    v_mfma_f32_16x16x16_bf16 v[164:167], v[40:41], v[136:137], v[164:167]
    buffer_load_dwordx4 v251, s[12:15], s57 offen lds
    v_mfma_f32_16x16x16_bf16 v[168:171], v[46:47], v[136:137], v[168:171]
    s_add_u32 m0, s50, 0x4000
    v_max3_f32 v249, v249, v160, v161
    v_max3_f32 v248, v248, v162, v163
    v_mfma_f32_16x16x16_bf16 v[172:175], v[22:23], v[136:137], v[172:175]
    v_mfma_f32_16x16x32_bf16 v[208:211], a[188:191], a[220:223], v[208:211]
    ds_read_b128 a[220:223], v224 offset:34048
    v_max3_f32 v249, v249, v164, v165
    v_mfma_f32_16x16x32_bf16 v[200:203], a[192:195], a[224:227], v[200:203]
    v_max3_f32 v248, v248, v166, v167
    v_max3_f32 v249, v249, v168, v169
    v_mfma_f32_16x16x32_bf16 v[204:207], a[196:199], a[224:227], v[204:207]
    buffer_load_dwordx4 v252, s[12:15], s57 offen lds
    v_mfma_f32_16x16x32_bf16 v[208:211], a[200:203], a[224:227], v[208:211]
    s_add_u32 m0, s50, 0x4400
    ds_read_b128 a[224:227], v224 offset:34112
    v_max3_f32 v248, v248, v170, v171
    v_mfma_f32_16x16x32_bf16 v[200:203], a[204:207], a[228:231], v[200:203]
    s_add_u32 s56, s39, 0x150000
    v_max3_f32 v249, v249, v172, v173
    v_max3_f32 v248, v248, v174, v175
    v_mfma_f32_16x16x32_bf16 v[204:207], a[208:211], a[228:231], v[204:207]
    s_waitcnt lgkmcnt(2)
    v_max_f32 v248, v248, v249
    v_mov_b32 v249, v248
    v_mfma_f32_16x16x32_bf16 v[208:211], a[212:215], a[228:231], v[208:211]
    s_barrier
    v_cvt_pk_bf16_f32 v138, v200, v201
    v_cvt_pk_bf16_f32 v139, v202, v203
    v_mfma_f32_16x16x32_bf16 v[212:215], a[232:235], a[72:75], 0
    ds_read_b128 a[228:231], v224 offset:34176
    v_cvt_pk_bf16_f32 v140, v204, v205
    v_mfma_f32_16x16x32_bf16 v[216:219], a[232:235], a[76:79], 0
    buffer_load_dwordx4 v253, s[12:15], s57 offen lds
    v_mfma_f32_16x16x32_bf16 v[220:223], a[232:235], a[80:83], 0
    s_add_u32 m0, s41, 0
    v_cvt_pk_bf16_f32 v141, v206, v207
    v_cvt_pk_bf16_f32 v142, v208, v209
    v_mfma_f32_16x16x32_bf16 v[212:215], a[236:239], a[84:87], v[212:215]
    ds_read_b128 a[232:235], v224 offset:34240
    v_cvt_pk_bf16_f32 v143, v210, v211
    v_mfma_f32_16x16x32_bf16 v[216:219], a[236:239], a[88:91], v[216:219]
    v_permlane16_swap_b32 v248, v249
    v_mfma_f32_16x16x32_bf16 v[220:223], a[236:239], a[92:95], v[220:223]
    ds_read_b128 a[236:239], v224 offset:34304
    v_max_f32 v248, v248, v249
    v_mfma_f32_16x16x32_bf16 v[212:215], a[240:243], a[96:99], v[212:215]
    buffer_load_dwordx4 v246, s[4:7], s56 offen lds
    v_mfma_f32_16x16x32_bf16 v[216:219], a[240:243], a[100:103], v[216:219]
    s_add_u32 m0, s42, 0
    v_mov_b32 v249, v248
    v_mfma_f32_16x16x32_bf16 v[220:223], a[240:243], a[104:107], v[220:223]
    ds_read_b128 a[240:243], v224 offset:34368
    v_mfma_f32_16x16x32_bf16 v[212:215], a[244:247], a[108:111], v[212:215]
    v_permlane32_swap_b32 v248, v249
    v_mfma_f32_16x16x32_bf16 v[216:219], a[244:247], a[112:115], v[216:219]
    v_max_f32 v248, v248, v249
    v_mul_f32 v250, s37, v248
    v_mfma_f32_16x16x32_bf16 v[220:223], a[244:247], a[116:119], v[220:223]
    ds_read_b128 a[244:247], v224 offset:46464
    v_fma_f32 v144, v144, s37, -v250
    v_mfma_f32_16x16x32_bf16 v[212:215], a[248:251], a[120:123], v[212:215]
    buffer_load_dwordx4 v247, s[4:7], s56 offen lds
    v_mfma_f32_16x16x32_bf16 v[216:219], a[248:251], a[124:127], v[216:219]
    s_add_u32 s56, s39, 0x17a000
    v_fma_f32 v145, v145, s37, -v250
    v_fma_f32 v146, v146, s37, -v250
    v_mfma_f32_16x16x32_bf16 v[220:223], a[248:251], a[128:131], v[220:223]
    s_add_u32 m0, s41, 0x1e40
    ds_read_b128 a[248:251], v224 offset:46528
    v_fma_f32 v147, v147, s37, -v250
    v_mfma_f32_16x16x32_bf16 v[212:215], a[252:255], a[132:135], v[212:215]
    v_exp_f32 v144, v144
    v_mfma_f32_16x16x32_bf16 v[216:219], a[252:255], a[136:139], v[216:219]
    v_exp_f32 v145, v145
    v_mfma_f32_16x16x32_bf16 v[220:223], a[252:255], a[140:143], v[220:223]
    s_waitcnt lgkmcnt(3)
    buffer_load_dwordx4 v246, s[4:7], s56 offen lds
    v_mfma_f32_16x16x32_bf16 v[200:203], a[220:223], a[72:75], 0
    s_add_u32 m0, s42, 0x1e40
    ds_read_b128 a[252:255], v224 offset:46592
    v_cvt_pk_bf16_f32 v74, v212, v213
    v_mfma_f32_16x16x32_bf16 v[204:207], a[220:223], a[76:79], 0
    v_cvt_pk_bf16_f32 v75, v214, v215
    v_cvt_pk_bf16_f32 v96, v216, v217
    v_mfma_f32_16x16x32_bf16 v[208:211], a[220:223], a[80:83], 0
    v_cvt_pk_bf16_f32 v97, v218, v219
    v_cvt_pk_bf16_f32 v118, v220, v221
    v_mfma_f32_16x16x32_bf16 v[200:203], a[224:227], a[84:87], v[200:203]
    ds_read_b128 a[220:223], v224 offset:46656
    v_cvt_pk_bf16_f32 v119, v222, v223
    v_mfma_f32_16x16x32_bf16 v[204:207], a[224:227], a[88:91], v[204:207]
    v_exp_f32 v146, v146
    v_mfma_f32_16x16x32_bf16 v[208:211], a[224:227], a[92:95], v[208:211]
    buffer_load_dwordx4 v247, s[4:7], s56 offen lds
    v_mfma_f32_16x16x32_bf16 v[200:203], a[228:231], a[96:99], v[200:203]
    s_add_u32 s56, s39, 0x1a4000
    ds_read_b128 a[224:227], v224 offset:46720
    v_cvt_pk_bf16_f32 v176, v144, v145
    v_mfma_f32_16x16x32_bf16 v[204:207], a[228:231], a[100:103], v[204:207]
    s_add_u32 m0, s41, 0x3c80
    v_exp_f32 v147, v147
    v_mfma_f32_16x16x32_bf16 v[208:211], a[228:231], a[104:107], v[208:211]
    ds_read_b128 a[228:231], v224 offset:46784
    v_cvt_pk_bf16_f32 v177, v146, v147
    v_mfma_f32_16x16x32_bf16 v[200:203], a[232:235], a[108:111], v[200:203]
    ds_read_b128 v[144:147], v236
    v_bfe_u32 v236, s63, v232, 4
    v_mfma_f32_16x16x32_bf16 v[204:207], a[232:235], a[112:115], v[204:207]
    buffer_load_dwordx4 v246, s[4:7], s56 offen lds
    v_mfma_f32_16x16x32_bf16 v[208:211], a[232:235], a[116:119], v[208:211]
    s_add_u32 m0, s42, 0x3c80
    ds_read_b128 a[232:235], v224 offset:49536
    v_mad_u32_u24 v236, v236, s40, v230
    v_mfma_f32_16x16x32_bf16 v[200:203], a[236:239], a[120:123], v[200:203]
    v_fma_f32 v148, v148, s37, -v250
    v_fma_f32 v149, v149, s37, -v250
    v_mfma_f32_16x16x32_bf16 v[204:207], a[236:239], a[124:127], v[204:207]
    v_fma_f32 v150, v150, s37, -v250
    v_fma_f32 v151, v151, s37, -v250
    v_mfma_f32_16x16x32_bf16 v[208:211], a[236:239], a[128:131], v[208:211]
    s_waitcnt lgkmcnt(4)
    ds_read_b128 a[236:239], v224 offset:49600
    v_fma_f32 v152, v152, s37, -v250
    v_mfma_f32_16x16x32_bf16 v[200:203], a[240:243], a[132:135], v[200:203]
    v_exp_f32 v148, v148
    v_mfma_f32_16x16x32_bf16 v[204:207], a[240:243], a[136:139], v[204:207]
    buffer_load_dwordx4 v247, s[4:7], s56 offen lds
    v_mfma_f32_16x16x32_bf16 v[208:211], a[240:243], a[140:143], v[208:211]
    s_add_u32 s56, s39, 0x1ce000
    ds_read_b128 a[240:243], v224 offset:49664
    v_fma_f32 v153, v153, s37, -v250
    v_mfma_f32_16x16x32_bf16 v[212:215], a[244:247], a[72:75], 0
    s_add_u32 m0, s41, 0x5ac0
    v_cvt_pk_bf16_f32 v76, v200, v201
    v_cvt_pk_bf16_f32 v77, v202, v203
    s_waitcnt lgkmcnt(3)
    v_mfma_f32_16x16x32_bf16 v[144:147], v[24:27], v[138:141], v[144:147]
    v_cvt_pk_bf16_f32 v98, v204, v205
    v_cvt_pk_bf16_f32 v99, v206, v207
    v_mfma_f32_16x16x32_bf16 v[216:219], a[244:247], a[76:79], 0
    v_cvt_pk_bf16_f32 v120, v208, v209
    v_cvt_pk_bf16_f32 v121, v210, v211
    v_mfma_f32_16x16x32_bf16 v[220:223], a[244:247], a[80:83], 0
    ds_read_b128 a[244:247], v224 offset:49728
    v_fma_f32 v154, v154, s37, -v250
    v_mfma_f32_16x16x16_bf16 v[144:147], v[28:29], v[142:143], v[144:147]
    v_exp_f32 v149, v149
    v_mfma_f32_16x16x32_bf16 v[212:215], a[248:251], a[84:87], v[212:215]
    v_exp_f32 v150, v150
    v_mfma_f32_16x16x32_bf16 v[216:219], a[248:251], a[88:91], v[216:219]
    v_exp_f32 v151, v151
    v_mfma_f32_16x16x32_bf16 v[220:223], a[248:251], a[92:95], v[220:223]
    ds_read_b128 a[248:251], v224 offset:49792
    v_cvt_pk_bf16_f32 v178, v148, v149
    v_mfma_f32_16x16x32_bf16 v[212:215], a[252:255], a[96:99], v[212:215]
    v_cvt_pk_bf16_f32 v179, v150, v151
    v_fma_f32 v155, v155, s37, -v250
    v_mfma_f32_16x16x32_bf16 v[216:219], a[252:255], a[100:103], v[216:219]
    ds_read_b128 v[148:151], v234
    v_bfe_u32 v234, s64, v233, 4
    v_mfma_f32_16x16x32_bf16 v[196:199], a[216:219], v[176:179], 0
    v_mad_u32_u24 v234, v234, s40, v231
    v_fma_f32 v156, v156, s37, -v250
    v_mfma_f32_16x16x32_bf16 v[184:187], v[66:69], v[176:179], 0
    v_exp_f32 v152, v152
    v_mfma_f32_16x16x32_bf16 v[188:191], v[88:91], v[176:179], 0
    buffer_load_dwordx4 v246, s[4:7], s56 offen lds
    v_mfma_f32_16x16x32_bf16 v[192:195], v[110:113], v[176:179], 0
    s_add_u32 m0, s42, 0x5ac0
    v_exp_f32 v153, v153
    v_mfma_f32_16x16x32_bf16 v[220:223], a[252:255], a[104:107], v[220:223]
    ds_read_b128 a[252:255], v224 offset:49856
    v_cvt_pk_bf16_f32 v180, v152, v153
    v_mfma_f32_16x16x32_bf16 v[212:215], a[220:223], a[108:111], v[212:215]
    v_exp_f32 v154, v154
    v_mfma_f32_16x16x32_bf16 v[216:219], a[220:223], a[112:115], v[216:219]
    v_exp_f32 v155, v155
    v_mfma_f32_16x16x32_bf16 v[220:223], a[220:223], a[116:119], v[220:223]
    ds_read_b128 a[220:223], v225 offset:38720
    v_cvt_pk_bf16_f32 v181, v154, v155
    v_mfma_f32_16x16x32_bf16 v[212:215], a[224:227], a[120:123], v[212:215]
    s_waitcnt lgkmcnt(2)
    buffer_load_dwordx4 v247, s[4:7], s56 offen lds
    v_mfma_f32_16x16x32_bf16 v[148:151], v[30:33], v[138:141], v[148:151]
    s_add_u32 s56, s39, 0x1f8000
    ds_read_b128 v[152:155], v235
    v_bfe_u32 v235, s65, v233, 4
    v_mfma_f32_16x16x32_bf16 v[216:219], a[224:227], a[124:127], v[216:219]
    s_add_u32 m0, s41, 0x7900
    v_mad_u32_u24 v235, v235, s40, v231
    v_fma_f32 v157, v157, s37, -v250
    v_mfma_f32_16x16x16_bf16 v[148:151], v[34:35], v[142:143], v[148:151]
    v_fma_f32 v158, v158, s37, -v250
    v_fma_f32 v159, v159, s37, -v250
    v_mfma_f32_16x16x32_bf16 v[220:223], a[224:227], a[128:131], v[220:223]
    ds_read_b128 a[224:227], v225 offset:38784
    v_fma_f32 v160, v160, s37, -v250
    v_mfma_f32_16x16x32_bf16 v[212:215], a[228:231], a[132:135], v[212:215]
    v_exp_f32 v156, v156
    v_mfma_f32_16x16x32_bf16 v[216:219], a[228:231], a[136:139], v[216:219]
    v_exp_f32 v157, v157
    v_mfma_f32_16x16x32_bf16 v[220:223], a[228:231], a[140:143], v[220:223]
    ds_read_b128 a[228:231], v225 offset:38848
    v_cvt_pk_bf16_f32 v182, v156, v157
    v_mfma_f32_16x16x32_bf16 v[200:203], a[232:235], a[72:75], 0
    v_exp_f32 v158, v158
    v_mfma_f32_16x16x32_bf16 v[204:207], a[232:235], a[76:79], 0
    v_cvt_pk_bf16_f32 v80, v212, v213
    v_cvt_pk_bf16_f32 v81, v214, v215
    v_mfma_f32_16x16x32_bf16 v[208:211], a[232:235], a[80:83], 0
    s_waitcnt lgkmcnt(2)
    v_cvt_pk_bf16_f32 v102, v216, v217
    v_cvt_pk_bf16_f32 v103, v218, v219
    v_mfma_f32_16x16x32_bf16 v[152:155], v[36:39], v[138:141], v[152:155]
    v_cvt_pk_bf16_f32 v124, v220, v221
    v_cvt_pk_bf16_f32 v125, v222, v223
    v_mfma_f32_16x16x32_bf16 v[200:203], a[236:239], a[84:87], v[200:203]
    ds_read_b128 a[232:235], v225 offset:38912
    v_fma_f32 v161, v161, s37, -v250
    v_mfma_f32_16x16x32_bf16 v[204:207], a[236:239], a[88:91], v[204:207]
    v_exp_f32 v159, v159
    v_mfma_f32_16x16x16_bf16 v[152:155], v[40:41], v[142:143], v[152:155]
    v_cvt_pk_bf16_f32 v183, v158, v159
    v_fma_f32 v162, v162, s37, -v250
    v_mfma_f32_16x16x32_bf16 v[208:211], a[236:239], a[92:95], v[208:211]
    ds_read_b128 a[236:239], v225 offset:38976
    ds_read_b128 v[156:159], v236
    v_mfma_f32_16x16x32_bf16 v[196:199], a[216:219], v[180:183], v[196:199]
    v_bfe_u32 v236, s66, v232, 4
    v_fma_f32 v163, v163, s37, -v250
    v_mfma_f32_16x16x32_bf16 v[184:187], v[70:73], v[180:183], v[184:187]
    v_exp_f32 v160, v160
    v_mfma_f32_16x16x32_bf16 v[188:191], v[92:95], v[180:183], v[188:191]
    v_exp_f32 v161, v161
    v_mfma_f32_16x16x32_bf16 v[192:195], v[114:117], v[180:183], v[192:195]
    v_exp_f32 v162, v162
    v_mfma_f32_16x16x32_bf16 v[200:203], a[240:243], a[96:99], v[200:203]
    v_exp_f32 v163, v163
    v_mfma_f32_16x16x32_bf16 v[204:207], a[240:243], a[100:103], v[204:207]
    v_cvt_pk_bf16_f32 v176, v160, v161
    v_cvt_pk_bf16_f32 v177, v162, v163
    v_mfma_f32_16x16x32_bf16 v[208:211], a[240:243], a[104:107], v[208:211]
    ds_read_b128 a[240:243], v225 offset:39040
    ds_read_b128 v[160:163], v234
    v_mfma_f32_16x16x32_bf16 v[200:203], a[244:247], a[108:111], v[200:203]
    v_mad_u32_u24 v234, v236, s40, v229
    v_mad_u32_u24 v236, v236, s40, v228
    v_mfma_f32_16x16x32_bf16 v[204:207], a[244:247], a[112:115], v[204:207]
    s_waitcnt lgkmcnt(2)
    v_fma_f32 v164, v164, s37, -v250
    v_fma_f32 v165, v165, s37, -v250
    v_mfma_f32_16x16x32_bf16 v[156:159], v[42:45], v[138:141], v[156:159]
    v_fma_f32 v166, v166, s37, -v250
    v_fma_f32 v167, v167, s37, -v250
    v_mfma_f32_16x16x32_bf16 v[208:211], a[244:247], a[116:119], v[208:211]
    ds_read_b128 a[244:247], v227 offset:30976
    v_fma_f32 v168, v168, s37, -v250
    v_mfma_f32_16x16x32_bf16 v[200:203], a[248:251], a[120:123], v[200:203]
    v_exp_f32 v164, v164
    v_mfma_f32_16x16x16_bf16 v[156:159], v[46:47], v[142:143], v[156:159]
    v_exp_f32 v165, v165
    v_mfma_f32_16x16x32_bf16 v[204:207], a[248:251], a[124:127], v[204:207]
    v_exp_f32 v166, v166
    v_mfma_f32_16x16x32_bf16 v[208:211], a[248:251], a[128:131], v[208:211]
    ds_read_b128 a[248:251], v227 offset:31040
    v_cvt_pk_bf16_f32 v178, v164, v165
    v_mfma_f32_16x16x32_bf16 v[200:203], a[252:255], a[132:135], v[200:203]
    s_waitcnt lgkmcnt(2)
    v_exp_f32 v167, v167
    v_mfma_f32_16x16x32_bf16 v[160:163], v[48:51], v[138:141], v[160:163]
    v_cvt_pk_bf16_f32 v179, v166, v167
    v_fma_f32 v169, v169, s37, -v250
    v_mfma_f32_16x16x32_bf16 v[204:207], a[252:255], a[136:139], v[204:207]
    ds_read_b128 v[164:167], v235
    v_bfe_u32 v235, s67, v232, 4
    v_mfma_f32_16x16x32_bf16 v[196:199], a[216:219], v[176:179], v[196:199]
    v_cvt_pk_bf16_f32 v78, v200, v201
    v_cvt_pk_bf16_f32 v79, v202, v203
    v_mfma_f32_16x16x32_bf16 v[184:187], v[74:77], v[176:179], v[184:187]
    v_fma_f32 v170, v170, s37, -v250
    v_fma_f32 v171, v171, s37, -v250
    v_mfma_f32_16x16x32_bf16 v[188:191], v[96:99], v[176:179], v[188:191]
    v_cvt_pk_bf16_f32 v100, v204, v205
    v_cvt_pk_bf16_f32 v101, v206, v207
    v_mfma_f32_16x16x32_bf16 v[192:195], v[118:121], v[176:179], v[192:195]
    v_exp_f32 v168, v168
    v_mfma_f32_16x16x16_bf16 v[160:163], v[52:53], v[142:143], v[160:163]
    v_exp_f32 v169, v169
    v_mfma_f32_16x16x32_bf16 v[208:211], a[252:255], a[140:143], v[208:211]
    ds_read_b128 a[252:255], v227 offset:31104
    v_cvt_pk_bf16_f32 v180, v168, v169
    v_mfma_f32_16x16x32_bf16 v[212:215], a[144:147], a[220:223], 0
    v_exp_f32 v170, v170
    v_mfma_f32_16x16x32_bf16 v[216:219], a[148:151], a[220:223], 0
    v_exp_f32 v171, v171
    v_mfma_f32_16x16x32_bf16 v[220:223], a[152:155], a[220:223], 0
    s_waitcnt lgkmcnt(1)
    ds_read_b128 a[220:223], v227 offset:31168
    v_cvt_pk_bf16_f32 v122, v208, v209
    v_mfma_f32_16x16x32_bf16 v[164:167], v[54:57], v[138:141], v[164:167]
    v_cvt_pk_bf16_f32 v123, v210, v211
    v_cvt_pk_bf16_f32 v181, v170, v171
    v_mfma_f32_16x16x32_bf16 v[212:215], a[156:159], a[224:227], v[212:215]
    ds_read_b128 v[168:171], v234
    v_bfe_u32 v234, s62, v232, 4
    v_mfma_f32_16x16x32_bf16 v[216:219], a[160:163], a[224:227], v[216:219]
    v_fma_f32 v172, v172, s37, -v250
    v_fma_f32 v173, v173, s37, -v250
    v_mfma_f32_16x16x16_bf16 v[164:167], v[58:59], v[142:143], v[164:167]
    v_fma_f32 v174, v174, s37, -v250
    v_fma_f32 v175, v175, s37, -v250
    v_mfma_f32_16x16x32_bf16 v[220:223], a[164:167], a[224:227], v[220:223]
    ds_read_b128 a[224:227], v227 offset:31232
    v_max3_f32 v248, v144, v145, v146
    v_mfma_f32_16x16x32_bf16 v[212:215], a[168:171], a[228:231], v[212:215]
    v_exp_f32 v172, v172
    v_mfma_f32_16x16x32_bf16 v[216:219], a[172:175], a[228:231], v[216:219]
    v_exp_f32 v173, v173
    v_mfma_f32_16x16x32_bf16 v[220:223], a[176:179], a[228:231], v[220:223]
    ds_read_b128 a[228:231], v227 offset:31296
    v_cvt_pk_bf16_f32 v182, v172, v173
    v_mfma_f32_16x16x32_bf16 v[212:215], a[180:183], a[232:235], v[212:215]
    v_exp_f32 v174, v174
    v_mfma_f32_16x16x32_bf16 v[216:219], a[184:187], a[232:235], v[216:219]
    v_exp_f32 v175, v175
    v_mfma_f32_16x16x32_bf16 v[220:223], a[188:191], a[232:235], v[220:223]
    v_cvt_pk_bf16_f32 v183, v174, v175
    v_max3_f32 v249, v147, v148, v149
    v_mfma_f32_16x16x32_bf16 v[212:215], a[192:195], a[236:239], v[212:215]
    ds_read_b128 v[172:175], v236
    v_mad_u32_u24 v236, v235, s40, v228
    v_mfma_f32_16x16x32_bf16 v[196:199], a[216:219], v[180:183], v[196:199]
    v_mad_u32_u24 v235, v235, s40, v229
    v_max3_f32 v248, v248, v150, v151
    v_mfma_f32_16x16x32_bf16 v[184:187], v[78:81], v[180:183], v[184:187]
    v_max3_f32 v249, v249, v152, v153
    v_max3_f32 v248, v248, v154, v155
    v_mfma_f32_16x16x32_bf16 v[188:191], v[100:103], v[180:183], v[188:191]
    v_max3_f32 v249, v249, v156, v157
    v_max3_f32 v248, v248, v158, v159
    v_mfma_f32_16x16x32_bf16 v[192:195], v[122:125], v[180:183], v[192:195]
    v_rcp_f32 v197, v196
    v_mfma_f32_16x16x32_bf16 v[216:219], a[196:199], a[236:239], v[216:219]
    v_mul_f32 v184, v184, v197
    v_mul_f32 v185, v185, v197
    v_mfma_f32_16x16x32_bf16 v[220:223], a[200:203], a[236:239], v[220:223]
    v_cvt_pk_bf16_f32 v184, v184, v185
    v_mul_f32 v186, v186, v197
    v_mfma_f32_16x16x32_bf16 v[212:215], a[204:207], a[240:243], v[212:215]
    v_mul_f32 v187, v187, v197
    v_cvt_pk_bf16_f32 v185, v186, v187
    v_mfma_f32_16x16x32_bf16 v[216:219], a[208:211], a[240:243], v[216:219]
    v_mul_f32 v188, v188, v197
    v_mul_f32 v189, v189, v197
    v_mfma_f32_16x16x32_bf16 v[220:223], a[212:215], a[240:243], v[220:223]
    v_cvt_pk_bf16_f32 v186, v188, v189
    v_mul_f32 v190, v190, v197
    v_mfma_f32_16x16x32_bf16 v[200:203], a[244:247], a[72:75], 0
    v_cvt_pk_bf16_f32 v132, v212, v213
    v_cvt_pk_bf16_f32 v133, v214, v215
    v_mfma_f32_16x16x32_bf16 v[204:207], a[244:247], a[76:79], 0
    v_cvt_pk_bf16_f32 v134, v216, v217
    v_cvt_pk_bf16_f32 v135, v218, v219
    v_mfma_f32_16x16x32_bf16 v[208:211], a[244:247], a[80:83], 0
    s_waitcnt lgkmcnt(0)
    v_cvt_pk_bf16_f32 v136, v220, v221
    v_cvt_pk_bf16_f32 v137, v222, v223
    v_mfma_f32_16x16x32_bf16 v[168:171], v[30:33], v[132:135], v[168:171]
    v_mul_f32 v191, v191, v197
    v_cvt_pk_bf16_f32 v187, v190, v191
    v_mfma_f32_16x16x32_bf16 v[172:175], v[6:9], v[132:135], v[172:175]
    v_mul_f32 v192, v192, v197
    v_mul_f32 v193, v193, v197
    v_mfma_f32_16x16x32_bf16 v[200:203], a[248:251], a[84:87], v[200:203]
    v_cvt_pk_bf16_f32 v188, v192, v193
    v_mul_f32 v194, v194, v197
    v_mfma_f32_16x16x16_bf16 v[168:171], v[34:35], v[136:137], v[168:171]
    v_mul_f32 v195, v195, v197
    v_cvt_pk_bf16_f32 v189, v194, v195
    v_mfma_f32_16x16x16_bf16 v[172:175], v[10:11], v[136:137], v[172:175]
    v_max3_f32 v249, v249, v160, v161
    v_max3_f32 v248, v248, v162, v163
    v_mfma_f32_16x16x32_bf16 v[204:207], a[248:251], a[88:91], v[204:207]
    v_max3_f32 v249, v249, v164, v165
    v_max3_f32 v248, v248, v166, v167
    v_mfma_f32_16x16x32_bf16 v[208:211], a[248:251], a[92:95], v[208:211]
    v_max_f32 v248, v248, v249
    v_mov_b32 v249, v248
    v_mfma_f32_16x16x32_bf16 v[200:203], a[252:255], a[96:99], v[200:203]
    v_mfma_f32_16x16x32_bf16 v[204:207], a[252:255], a[100:103], v[204:207]
    v_permlane16_swap_b32 v248, v249
    v_mfma_f32_16x16x32_bf16 v[208:211], a[252:255], a[104:107], v[208:211]
    v_max_f32 v248, v248, v249
    v_mov_b32 v249, v248
    v_mfma_f32_16x16x32_bf16 v[200:203], a[220:223], a[108:111], v[200:203]
    v_mfma_f32_16x16x32_bf16 v[204:207], a[220:223], a[112:115], v[204:207]
    v_permlane32_swap_b32 v248, v249
    v_mfma_f32_16x16x32_bf16 v[208:211], a[220:223], a[116:119], v[208:211]
    v_max_f32 v248, v248, v249
    v_mul_f32 v250, s37, v248
    v_mfma_f32_16x16x32_bf16 v[200:203], a[224:227], a[120:123], v[200:203]
    v_fma_f32 v144, v144, s37, -v250
    v_fma_f32 v145, v145, s37, -v250
    v_mfma_f32_16x16x32_bf16 v[204:207], a[224:227], a[124:127], v[204:207]
    v_fma_f32 v146, v146, s37, -v250
    v_fma_f32 v147, v147, s37, -v250
    v_mfma_f32_16x16x32_bf16 v[208:211], a[224:227], a[128:131], v[208:211]
    v_exp_f32 v144, v144
    v_mfma_f32_16x16x32_bf16 v[200:203], a[228:231], a[132:135], v[200:203]
    v_exp_f32 v145, v145
    v_mfma_f32_16x16x32_bf16 v[204:207], a[228:231], a[136:139], v[204:207]
    v_exp_f32 v146, v146
    v_mfma_f32_16x16x32_bf16 v[208:211], a[228:231], a[140:143], v[208:211]
    v_exp_f32 v147, v147
    v_cvt_pk_bf16_f32 v176, v144, v145
    v_cvt_pk_bf16_f32 v177, v146, v147
    ds_read_b128 v[144:147], v236
    v_cvt_pk_bf16_f32 v84, v200, v201
    v_cvt_pk_bf16_f32 v85, v202, v203
    v_cvt_pk_bf16_f32 v106, v204, v205
    v_cvt_pk_bf16_f32 v107, v206, v207
    v_cvt_pk_bf16_f32 v128, v208, v209
    v_cvt_pk_bf16_f32 v129, v210, v211
    v_bfe_u32 v236, s63, v232, 4
    v_fma_f32 v148, v148, s37, -v250
    v_fma_f32 v149, v149, s37, -v250
    v_fma_f32 v150, v150, s37, -v250
    v_fma_f32 v151, v151, s37, -v250
    v_exp_f32 v148, v148
    v_exp_f32 v149, v149
    v_exp_f32 v150, v150
    v_exp_f32 v151, v151
    v_cvt_pk_bf16_f32 v178, v148, v149
    v_cvt_pk_bf16_f32 v179, v150, v151
    ds_read_b128 v[148:151], v235
    v_mad_u32_u24 v235, v234, s40, v229
    v_mfma_f32_16x16x32_bf16 v[196:199], a[216:219], v[176:179], 0
    v_mad_u32_u24 v234, v234, s40, v228
    v_fma_f32 v152, v152, s37, -v250
    v_mfma_f32_16x16x32_bf16 v[192:195], v[112:115], v[176:179], 0
    s_waitcnt vmcnt(4)
    v_fma_f32 v153, v153, s37, -v250
    v_fma_f32 v154, v154, s37, -v250
    s_barrier
    ds_write_b128 v237, v[184:187]
    v_mfma_f32_16x16x32_bf16 v[184:187], v[68:71], v[176:179], 0
    ds_write_b64 v238, v[188:189]
    v_mfma_f32_16x16x32_bf16 v[188:191], v[90:93], v[176:179], 0
    s_waitcnt lgkmcnt(3)
    ds_read_b128 a[232:235], v224
    ds_read_b128 a[236:239], v224 offset:64
    v_mfma_f32_16x16x32_bf16 v[144:147], v[12:15], v[132:135], v[144:147]
    ds_read_b128 a[240:243], v224 offset:128
    ds_read_b128 a[244:247], v224 offset:192
    ds_read_b128 a[248:251], v224 offset:256
    ds_read_b128 a[252:255], v224 offset:320
    ds_read_b128 a[220:223], v224 offset:3072
    ds_read_b128 a[224:227], v224 offset:3136
    v_mfma_f32_16x16x16_bf16 v[144:147], v[16:17], v[136:137], v[144:147]
    s_waitcnt lgkmcnt(10)
    ds_read_b128 a[228:231], v224 offset:3200
    v_fma_f32 v155, v155, s37, -v250
    v_mfma_f32_16x16x32_bf16 v[148:151], v[36:39], v[132:135], v[148:151]
    v_exp_f32 v152, v152
    v_exp_f32 v153, v153
    v_exp_f32 v154, v154
    v_exp_f32 v155, v155
    v_cvt_pk_bf16_f32 v180, v152, v153
    v_cvt_pk_bf16_f32 v181, v154, v155
    v_mfma_f32_16x16x16_bf16 v[148:151], v[40:41], v[136:137], v[148:151]
    s_waitcnt lgkmcnt(8)
    ds_read_b128 v[152:155], v235
    v_bfe_u32 v235, s63, v232, 4
    v_mad_u32_u24 v235, v235, s40, v230
    v_fma_f32 v156, v156, s37, -v250
    v_fma_f32 v157, v157, s37, -v250
    v_fma_f32 v158, v158, s37, -v250
    v_fma_f32 v159, v159, s37, -v250
    v_exp_f32 v156, v156
    v_mfma_f32_16x16x32_bf16 v[212:215], a[0:3], a[232:235], 0
    v_exp_f32 v157, v157
    v_mfma_f32_16x16x32_bf16 v[216:219], a[4:7], a[232:235], 0
    v_exp_f32 v158, v158
    v_mfma_f32_16x16x32_bf16 v[220:223], a[8:11], a[232:235], 0
    v_exp_f32 v159, v159
    v_mfma_f32_16x16x32_bf16 v[200:203], a[232:235], a[72:75], 0
    v_cvt_pk_bf16_f32 v182, v156, v157
    v_cvt_pk_bf16_f32 v183, v158, v159
    v_mfma_f32_16x16x32_bf16 v[204:207], a[232:235], a[76:79], 0
    ds_read_b128 v[156:159], v234
    v_mad_u32_u24 v234, v236, s40, v228
    v_mfma_f32_16x16x32_bf16 v[196:199], a[216:219], v[180:183], v[196:199]
    v_mad_u32_u24 v236, v236, s40, v229
    v_fma_f32 v160, v160, s37, -v250
    v_mfma_f32_16x16x32_bf16 v[184:187], v[76:79], v[180:183], v[184:187]
    v_fma_f32 v161, v161, s37, -v250
    v_fma_f32 v162, v162, s37, -v250
    v_mfma_f32_16x16x32_bf16 v[188:191], v[98:101], v[180:183], v[188:191]
    v_fma_f32 v163, v163, s37, -v250
    v_fma_f32 v164, v164, s37, -v250
    v_mfma_f32_16x16x32_bf16 v[192:195], v[120:123], v[180:183], v[192:195]
    s_waitcnt lgkmcnt(1)
    v_exp_f32 v160, v160
    v_mfma_f32_16x16x32_bf16 v[152:155], v[42:45], v[132:135], v[152:155]
    v_exp_f32 v161, v161
    v_mfma_f32_16x16x32_bf16 v[208:211], a[232:235], a[80:83], 0
    ds_read_b128 a[232:235], v224 offset:3264
    v_cvt_pk_bf16_f32 v176, v160, v161
    v_mfma_f32_16x16x32_bf16 v[212:215], a[12:15], a[236:239], v[212:215]
    v_exp_f32 v162, v162
    v_mfma_f32_16x16x16_bf16 v[152:155], v[46:47], v[136:137], v[152:155]
    v_exp_f32 v163, v163
    v_mfma_f32_16x16x32_bf16 v[216:219], a[16:19], a[236:239], v[216:219]
    s_waitcnt lgkmcnt(1)
    v_cvt_pk_bf16_f32 v177, v162, v163
    v_fma_f32 v165, v165, s37, -v250
    v_mfma_f32_16x16x32_bf16 v[156:159], v[18:21], v[132:135], v[156:159]
    ds_read_b128 v[160:163], v234
    v_bfe_u32 v234, s67, v232, 4
    v_mfma_f32_16x16x32_bf16 v[220:223], a[20:23], a[236:239], v[220:223]
    v_mad_u32_u24 v234, v234, s40, v230
    v_fma_f32 v166, v166, s37, -v250
    v_mfma_f32_16x16x32_bf16 v[200:203], a[236:239], a[84:87], v[200:203]
    v_fma_f32 v167, v167, s37, -v250
    v_max3_f32 v248, v168, v169, v170
    v_mfma_f32_16x16x16_bf16 v[156:159], v[22:23], v[136:137], v[156:159]
    v_exp_f32 v164, v164
    v_mfma_f32_16x16x32_bf16 v[204:207], a[236:239], a[88:91], v[204:207]
    v_exp_f32 v165, v165
    v_mfma_f32_16x16x32_bf16 v[208:211], a[236:239], a[92:95], v[208:211]
    ds_read_b128 a[236:239], v224 offset:3328
    v_cvt_pk_bf16_f32 v178, v164, v165
    v_mfma_f32_16x16x32_bf16 v[212:215], a[24:27], a[240:243], v[212:215]
    v_exp_f32 v166, v166
    v_mfma_f32_16x16x32_bf16 v[216:219], a[28:31], a[240:243], v[216:219]
    v_exp_f32 v167, v167
    v_mfma_f32_16x16x32_bf16 v[220:223], a[32:35], a[240:243], v[220:223]
    v_cvt_pk_bf16_f32 v179, v166, v167
    v_max3_f32 v249, v171, v172, v173
    v_mfma_f32_16x16x32_bf16 v[200:203], a[240:243], a[96:99], v[200:203]
    ds_read_b128 v[164:167], v236
    v_bfe_u32 v236, s66, v232, 4
    v_mfma_f32_16x16x32_bf16 v[196:199], a[216:219], v[176:179], v[196:199]
    v_mad_u32_u24 v236, v236, s40, v230
    v_max3_f32 v248, v248, v174, v175
    v_mfma_f32_16x16x32_bf16 v[184:187], v[82:85], v[176:179], v[184:187]
    v_max3_f32 v249, v249, v144, v145
    v_max3_f32 v248, v248, v146, v147
    v_mfma_f32_16x16x32_bf16 v[188:191], v[104:107], v[176:179], v[188:191]
    v_max3_f32 v249, v249, v148, v149
    v_max3_f32 v248, v248, v150, v151
    v_mfma_f32_16x16x32_bf16 v[192:195], v[126:129], v[176:179], v[192:195]
    v_rcp_f32 v197, v196
    v_mfma_f32_16x16x32_bf16 v[204:207], a[240:243], a[100:103], v[204:207]
    v_mul_f32 v184, v184, v197
    v_mul_f32 v185, v185, v197
    v_mfma_f32_16x16x32_bf16 v[208:211], a[240:243], a[104:107], v[208:211]
    ds_read_b128 a[240:243], v224 offset:3392
    v_cvt_pk_bf16_f32 v184, v184, v185
    v_mfma_f32_16x16x32_bf16 v[212:215], a[36:39], a[244:247], v[212:215]
    v_mul_f32 v186, v186, v197
    v_mul_f32 v187, v187, v197
    v_mfma_f32_16x16x32_bf16 v[216:219], a[40:43], a[244:247], v[216:219]
    v_cvt_pk_bf16_f32 v185, v186, v187
    v_mul_f32 v188, v188, v197
    v_mfma_f32_16x16x32_bf16 v[220:223], a[44:47], a[244:247], v[220:223]
    v_mul_f32 v189, v189, v197
    v_cvt_pk_bf16_f32 v186, v188, v189
    v_mfma_f32_16x16x32_bf16 v[200:203], a[244:247], a[108:111], v[200:203]
    v_mul_f32 v190, v190, v197
    v_mul_f32 v191, v191, v197
    v_mfma_f32_16x16x32_bf16 v[204:207], a[244:247], a[112:115], v[204:207]
    v_cvt_pk_bf16_f32 v187, v190, v191
    v_mul_f32 v192, v192, v197
    v_mfma_f32_16x16x32_bf16 v[208:211], a[244:247], a[116:119], v[208:211]
    v_mul_f32 v193, v193, v197
    v_cvt_pk_bf16_f32 v188, v192, v193
    v_mfma_f32_16x16x32_bf16 v[212:215], a[48:51], a[248:251], v[212:215]
    v_mul_f32 v194, v194, v197
    v_mul_f32 v195, v195, v197
    v_mfma_f32_16x16x32_bf16 v[216:219], a[52:55], a[248:251], v[216:219]
    ds_read_b128 a[244:247], v225 offset:41792
    v_cvt_pk_bf16_f32 v189, v194, v195
    v_mfma_f32_16x16x32_bf16 v[220:223], a[56:59], a[248:251], v[220:223]
    ds_write_b128 v237, v[184:187] offset:6144
    v_mfma_f32_16x16x32_bf16 v[200:203], a[248:251], a[120:123], v[200:203]
    ds_write_b64 v238, v[188:189] offset:6144
    v_mfma_f32_16x16x32_bf16 v[204:207], a[248:251], a[124:127], v[204:207]
    v_max3_f32 v249, v249, v152, v153
    v_max3_f32 v248, v248, v154, v155
    v_mfma_f32_16x16x32_bf16 v[208:211], a[248:251], a[128:131], v[208:211]
    ds_read_b128 a[248:251], v225 offset:41856
    v_max3_f32 v249, v249, v156, v157
    v_mfma_f32_16x16x32_bf16 v[212:215], a[60:63], a[252:255], v[212:215]
    v_max3_f32 v248, v248, v158, v159
    v_mfma_f32_16x16x32_bf16 v[216:219], a[64:67], a[252:255], v[216:219]
    v_mfma_f32_16x16x32_bf16 v[220:223], a[68:71], a[252:255], v[220:223]
    v_mfma_f32_16x16x32_bf16 v[200:203], a[252:255], a[132:135], v[200:203]
    v_mfma_f32_16x16x32_bf16 v[204:207], a[252:255], a[136:139], v[204:207]
    v_mfma_f32_16x16x32_bf16 v[208:211], a[252:255], a[140:143], v[208:211]
    ds_read_b128 a[252:255], v225 offset:41920
    s_nop 0
    v_cvt_pk_bf16_f32 v0, v212, v213
    v_cvt_pk_bf16_f32 v1, v214, v215
    v_mfma_f32_16x16x32_bf16 v[212:215], a[0:3], a[220:223], 0
    v_cvt_pk_bf16_f32 v2, v216, v217
    v_cvt_pk_bf16_f32 v3, v218, v219
    v_mfma_f32_16x16x32_bf16 v[216:219], a[4:7], a[220:223], 0
    s_waitcnt lgkmcnt(2)
    v_cvt_pk_bf16_f32 v4, v220, v221
    v_cvt_pk_bf16_f32 v5, v222, v223
    v_mfma_f32_16x16x32_bf16 v[160:163], v[0:3], v[132:135], v[160:163]
    v_cvt_pk_bf16_f32 v66, v200, v201
    v_cvt_pk_bf16_f32 v67, v202, v203
    v_mfma_f32_16x16x32_bf16 v[220:223], a[8:11], a[220:223], 0
    v_cvt_pk_bf16_f32 v88, v204, v205
    v_cvt_pk_bf16_f32 v89, v206, v207
    v_mfma_f32_16x16x32_bf16 v[200:203], a[220:223], a[72:75], 0
    v_cvt_pk_bf16_f32 v110, v208, v209
    v_cvt_pk_bf16_f32 v111, v210, v211
    v_mfma_f32_16x16x16_bf16 v[160:163], v[4:5], v[136:137], v[160:163]
    v_mfma_f32_16x16x32_bf16 v[204:207], a[220:223], a[76:79], 0
    v_mfma_f32_16x16x32_bf16 v[208:211], a[220:223], a[80:83], 0
    ds_read_b128 a[220:223], v225 offset:41984
    v_mfma_f32_16x16x32_bf16 v[212:215], a[12:15], a[224:227], v[212:215]
    v_mfma_f32_16x16x32_bf16 v[216:219], a[16:19], a[224:227], v[216:219]
    v_mfma_f32_16x16x32_bf16 v[220:223], a[20:23], a[224:227], v[220:223]
    v_mfma_f32_16x16x32_bf16 v[200:203], a[224:227], a[84:87], v[200:203]
    v_mfma_f32_16x16x32_bf16 v[204:207], a[224:227], a[88:91], v[204:207]
    v_max3_f32 v249, v249, v160, v161
    v_max3_f32 v248, v248, v162, v163
    v_mfma_f32_16x16x32_bf16 v[208:211], a[224:227], a[92:95], v[208:211]
    ds_read_b128 a[224:227], v225 offset:42048
    v_mfma_f32_16x16x32_bf16 v[212:215], a[24:27], a[228:231], v[212:215]
    v_mfma_f32_16x16x32_bf16 v[216:219], a[28:31], a[228:231], v[216:219]
    v_mfma_f32_16x16x32_bf16 v[220:223], a[32:35], a[228:231], v[220:223]
    v_mfma_f32_16x16x32_bf16 v[200:203], a[228:231], a[96:99], v[200:203]
    v_mfma_f32_16x16x32_bf16 v[204:207], a[228:231], a[100:103], v[204:207]
    v_mfma_f32_16x16x32_bf16 v[208:211], a[228:231], a[104:107], v[208:211]
    ds_read_b128 a[228:231], v225 offset:42112
    v_mfma_f32_16x16x32_bf16 v[212:215], a[36:39], a[232:235], v[212:215]
    v_mfma_f32_16x16x32_bf16 v[216:219], a[40:43], a[232:235], v[216:219]
    v_mfma_f32_16x16x32_bf16 v[220:223], a[44:47], a[232:235], v[220:223]
    v_mfma_f32_16x16x32_bf16 v[200:203], a[232:235], a[108:111], v[200:203]
    v_mfma_f32_16x16x32_bf16 v[204:207], a[232:235], a[112:115], v[204:207]
    v_mfma_f32_16x16x32_bf16 v[208:211], a[232:235], a[116:119], v[208:211]
    ds_read_b128 a[232:235], v226
    v_mfma_f32_16x16x32_bf16 v[212:215], a[48:51], a[236:239], v[212:215]
    v_mfma_f32_16x16x32_bf16 v[216:219], a[52:55], a[236:239], v[216:219]
    v_mfma_f32_16x16x32_bf16 v[220:223], a[56:59], a[236:239], v[220:223]
    v_mfma_f32_16x16x32_bf16 v[200:203], a[236:239], a[120:123], v[200:203]
    v_mfma_f32_16x16x32_bf16 v[204:207], a[236:239], a[124:127], v[204:207]
    v_mfma_f32_16x16x32_bf16 v[208:211], a[236:239], a[128:131], v[208:211]
    ds_read_b128 a[236:239], v226 offset:64
    v_mfma_f32_16x16x32_bf16 v[212:215], a[60:63], a[240:243], v[212:215]
    v_mfma_f32_16x16x32_bf16 v[216:219], a[64:67], a[240:243], v[216:219]
    v_mfma_f32_16x16x32_bf16 v[220:223], a[68:71], a[240:243], v[220:223]
    v_mfma_f32_16x16x32_bf16 v[200:203], a[240:243], a[132:135], v[200:203]
    v_mfma_f32_16x16x32_bf16 v[204:207], a[240:243], a[136:139], v[204:207]
    v_mfma_f32_16x16x32_bf16 v[208:211], a[240:243], a[140:143], v[208:211]
    ds_read_b128 a[240:243], v226 offset:128
    s_nop 1
    v_cvt_pk_bf16_f32 v24, v212, v213
    v_cvt_pk_bf16_f32 v25, v214, v215
    v_mfma_f32_16x16x32_bf16 v[212:215], a[144:147], a[244:247], 0
    v_cvt_pk_bf16_f32 v26, v216, v217
    v_cvt_pk_bf16_f32 v27, v218, v219
    v_mfma_f32_16x16x32_bf16 v[216:219], a[148:151], a[244:247], 0
    v_cvt_pk_bf16_f32 v28, v220, v221
    v_cvt_pk_bf16_f32 v29, v222, v223
    v_mfma_f32_16x16x32_bf16 v[164:167], v[24:27], v[132:135], v[164:167]
    v_cvt_pk_bf16_f32 v68, v200, v201
    v_cvt_pk_bf16_f32 v69, v202, v203
    v_mfma_f32_16x16x32_bf16 v[220:223], a[152:155], a[244:247], 0
    s_waitcnt lgkmcnt(1)
    v_cvt_pk_bf16_f32 v90, v204, v205
    v_cvt_pk_bf16_f32 v91, v206, v207
    v_mfma_f32_16x16x32_bf16 v[212:215], a[156:159], a[248:251], v[212:215]
    v_cvt_pk_bf16_f32 v112, v208, v209
    v_cvt_pk_bf16_f32 v113, v210, v211
    v_mfma_f32_16x16x16_bf16 v[164:167], v[28:29], v[136:137], v[164:167]
    ds_read_b128 a[244:247], v226 offset:192
    v_mfma_f32_16x16x32_bf16 v[216:219], a[160:163], a[248:251], v[216:219]
    v_mfma_f32_16x16x32_bf16 v[220:223], a[164:167], a[248:251], v[220:223]
    ds_read_b128 a[248:251], v226 offset:256
    v_mfma_f32_16x16x32_bf16 v[212:215], a[168:171], a[252:255], v[212:215]
    v_mfma_f32_16x16x32_bf16 v[216:219], a[172:175], a[252:255], v[216:219]
    v_mfma_f32_16x16x32_bf16 v[220:223], a[176:179], a[252:255], v[220:223]
    ds_read_b128 a[252:255], v226 offset:320
    v_max3_f32 v249, v249, v164, v165
    v_mfma_f32_16x16x32_bf16 v[212:215], a[180:183], a[220:223], v[212:215]
    v_max3_f32 v248, v248, v166, v167
    v_max_f32 v248, v248, v249
    v_mfma_f32_16x16x32_bf16 v[216:219], a[184:187], a[220:223], v[216:219]
    v_mov_b32 v249, v248
    v_mfma_f32_16x16x32_bf16 v[220:223], a[188:191], a[220:223], v[220:223]
    v_mfma_f32_16x16x32_bf16 v[212:215], a[192:195], a[224:227], v[212:215]
    v_permlane16_swap_b32 v248, v249
    v_mfma_f32_16x16x32_bf16 v[216:219], a[196:199], a[224:227], v[216:219]
    v_max_f32 v248, v248, v249
    v_mov_b32 v249, v248
    v_mfma_f32_16x16x32_bf16 v[220:223], a[200:203], a[224:227], v[220:223]
    v_mfma_f32_16x16x32_bf16 v[212:215], a[204:207], a[228:231], v[212:215]
    v_permlane32_swap_b32 v248, v249
    v_mfma_f32_16x16x32_bf16 v[216:219], a[208:211], a[228:231], v[216:219]
    s_waitcnt vmcnt(0)
    v_max_f32 v248, v248, v249
    v_mul_f32 v250, s37, v248
    v_mfma_f32_16x16x32_bf16 v[220:223], a[212:215], a[228:231], v[220:223]
    s_barrier
    buffer_load_dwordx4 v246, s[4:7], s56 offen lds
    v_mfma_f32_16x16x32_bf16 v[200:203], a[144:147], a[232:235], 0
    s_add_u32 m0, s42, 0x7900
    v_cvt_pk_bf16_f32 v138, v212, v213
    v_cvt_pk_bf16_f32 v139, v214, v215
    v_mfma_f32_16x16x32_bf16 v[204:207], a[148:151], a[232:235], 0
    v_cvt_pk_bf16_f32 v140, v216, v217
    v_cvt_pk_bf16_f32 v141, v218, v219
    v_mfma_f32_16x16x32_bf16 v[208:211], a[152:155], a[232:235], 0
    v_cvt_pk_bf16_f32 v142, v220, v221
    v_cvt_pk_bf16_f32 v143, v222, v223
    v_mfma_f32_16x16x32_bf16 v[200:203], a[156:159], a[236:239], v[200:203]
    buffer_load_dwordx4 v247, s[4:7], s56 offen lds
    v_mfma_f32_16x16x32_bf16 v[204:207], a[160:163], a[236:239], v[204:207]
    s_add_u32 s56, s39, 0x222000
    ds_read_b128 a[220:223], v227
    ds_read_b128 a[224:227], v227 offset:64
    v_mfma_f32_16x16x32_bf16 v[208:211], a[164:167], a[236:239], v[208:211]
    s_add_u32 m0, s41, 0x9740
    ds_read_b128 a[228:231], v227 offset:128
    ds_read_b128 a[232:235], v227 offset:192
    s_waitcnt lgkmcnt(4)
    v_mfma_f32_16x16x32_bf16 v[200:203], a[168:171], a[240:243], v[200:203]
    buffer_load_dwordx4 v246, s[4:7], s56 offen lds
    v_mfma_f32_16x16x32_bf16 v[204:207], a[172:175], a[240:243], v[204:207]
    s_add_u32 m0, s42, 0x9740
    ds_read_b128 a[236:239], v227 offset:256
    v_fma_f32 v168, v168, s37, -v250
    v_mfma_f32_16x16x32_bf16 v[208:211], a[176:179], a[240:243], v[208:211]
    s_add_u32 s58, s51, 0
    buffer_load_dwordx4 v247, s[4:7], s56 offen lds
    v_mfma_f32_16x16x32_bf16 v[200:203], a[180:183], a[244:247], v[200:203]
    s_add_u32 s59, s51, 0x1800
    ds_read_b128 a[240:243], v227 offset:320
    v_fma_f32 v169, v169, s37, -v250
    v_mfma_f32_16x16x32_bf16 v[204:207], a[184:187], a[244:247], v[204:207]
    s_add_u32 s56, s39, 0x24c000
    v_fma_f32 v170, v170, s37, -v250
    v_fma_f32 v171, v171, s37, -v250
    v_mfma_f32_16x16x32_bf16 v[208:211], a[188:191], a[244:247], v[208:211]
    s_add_u32 m0, s41, 0xb580
    ds_read_b128 a[244:247], v239
    v_fma_f32 v172, v172, s37, -v250
    v_mfma_f32_16x16x32_bf16 v[200:203], a[192:195], a[248:251], v[200:203]
    v_exp_f32 v168, v168
    v_mfma_f32_16x16x32_bf16 v[204:207], a[196:199], a[248:251], v[204:207]
    v_exp_f32 v169, v169
    v_mfma_f32_16x16x32_bf16 v[208:211], a[200:203], a[248:251], v[208:211]
    ds_read_b128 a[248:251], v239 offset:6144
    v_cvt_pk_bf16_f32 v180, v168, v169
    v_mfma_f32_16x16x32_bf16 v[200:203], a[204:207], a[252:255], v[200:203]
    v_exp_f32 v170, v170
    v_mfma_f32_16x16x32_bf16 v[204:207], a[208:211], a[252:255], v[204:207]
    v_exp_f32 v171, v171
    v_mfma_f32_16x16x32_bf16 v[208:211], a[212:215], a[252:255], v[208:211]
    s_waitcnt lgkmcnt(4)
    ds_read_b64_tr_b16 a[252:253], v240
    ds_read_b64_tr_b16 a[254:255], v240 offset:1536
    v_mfma_f32_16x16x32_bf16 v[212:215], a[0:3], a[220:223], 0
    v_cvt_pk_bf16_f32 v181, v170, v171
    v_cvt_pk_bf16_f32 v132, v200, v201
    v_mfma_f32_16x16x32_bf16 v[216:219], a[4:7], a[220:223], 0
    v_cvt_pk_bf16_f32 v133, v202, v203
    v_cvt_pk_bf16_f32 v134, v204, v205
    v_mfma_f32_16x16x32_bf16 v[220:223], a[8:11], a[220:223], 0
    v_cvt_pk_bf16_f32 v135, v206, v207
    v_cvt_pk_bf16_f32 v136, v208, v209
    v_mfma_f32_16x16x32_bf16 v[200:203], a[220:223], a[72:75], 0
    ds_read_b128 v[168:171], v235
    v_cvt_pk_bf16_f32 v137, v210, v211
    v_mfma_f32_16x16x32_bf16 v[204:207], a[220:223], a[76:79], 0
    v_bfe_u32 v235, s62, v232, 4
    v_mad_u32_u24 v235, v235, s40, v230
    v_mfma_f32_16x16x32_bf16 v[208:211], a[220:223], a[80:83], 0
    ds_read_b64_tr_b16 a[220:221], v240 offset:8
    ds_read_b64_tr_b16 a[222:223], v240 offset:1544
    v_mfma_f32_16x16x32_bf16 v[212:215], a[12:15], a[224:227], v[212:215]
    v_fma_f32 v173, v173, s37, -v250
    v_fma_f32 v174, v174, s37, -v250
    v_mfma_f32_16x16x32_bf16 v[216:219], a[16:19], a[224:227], v[216:219]
    v_fma_f32 v175, v175, s37, -v250
    v_fma_f32 v144, v144, s37, -v250
    v_mfma_f32_16x16x32_bf16 v[220:223], a[20:23], a[224:227], v[220:223]
    v_exp_f32 v172, v172
    v_mfma_f32_16x16x32_bf16 v[200:203], a[224:227], a[84:87], v[200:203]
    v_exp_f32 v173, v173
    v_mfma_f32_16x16x32_bf16 v[204:207], a[224:227], a[88:91], v[204:207]
    v_exp_f32 v174, v174
    v_mfma_f32_16x16x32_bf16 v[208:211], a[224:227], a[92:95], v[208:211]
    ds_read_b64_tr_b16 a[224:225], v241
    ds_read_b64_tr_b16 a[226:227], v241 offset:1536
    v_mfma_f32_16x16x32_bf16 v[212:215], a[24:27], a[228:231], v[212:215]
    s_waitcnt lgkmcnt(4)
    v_exp_f32 v175, v175
    v_mfma_f32_16x16x32_bf16 v[168:171], v[24:27], v[138:141], v[168:171]
    v_cvt_pk_bf16_f32 v182, v172, v173
    v_cvt_pk_bf16_f32 v183, v174, v175
    v_mfma_f32_16x16x32_bf16 v[216:219], a[28:31], a[228:231], v[216:219]
    ds_read_b128 v[172:175], v236
    v_bfe_u32 v236, s68, v233, 4
    v_mfma_f32_16x16x32_bf16 v[196:199], a[216:219], v[180:183], 0
    v_mad_u32_u24 v236, v236, s40, v231
    v_fma_f32 v145, v145, s37, -v250
    v_mfma_f32_16x16x32_bf16 v[184:187], v[70:73], v[180:183], 0
    v_fma_f32 v146, v146, s37, -v250
    v_fma_f32 v147, v147, s37, -v250
    v_mfma_f32_16x16x32_bf16 v[188:191], v[92:95], v[180:183], 0
    v_exp_f32 v144, v144
    v_mfma_f32_16x16x32_bf16 v[192:195], v[114:117], v[180:183], 0
    v_exp_f32 v145, v145
    v_mfma_f32_16x16x16_bf16 v[168:171], v[28:29], v[142:143], v[168:171]
    v_exp_f32 v146, v146
    v_mfma_f32_16x16x32_bf16 v[220:223], a[32:35], a[228:231], v[220:223]
    v_exp_f32 v147, v147
    v_mfma_f32_16x16x32_bf16 v[200:203], a[228:231], a[96:99], v[200:203]
    v_cvt_pk_bf16_f32 v176, v144, v145
    v_cvt_pk_bf16_f32 v177, v146, v147
    v_mfma_f32_16x16x32_bf16 v[204:207], a[228:231], a[100:103], v[204:207]
    ds_read_b128 v[144:147], v234
    v_bfe_u32 v234, s69, v233, 4
    v_mfma_f32_16x16x32_bf16 v[208:211], a[228:231], a[104:107], v[208:211]
    s_waitcnt lgkmcnt(1)
    ds_read_b128 a[228:231], v239 offset:1024
    v_mad_u32_u24 v234, v234, s40, v231
    v_mfma_f32_16x16x32_bf16 v[172:175], v[30:33], v[138:141], v[172:175]
    v_fma_f32 v148, v148, s37, -v250
    v_fma_f32 v149, v149, s37, -v250
    v_mfma_f32_16x16x32_bf16 v[212:215], a[36:39], a[232:235], v[212:215]
    v_fma_f32 v150, v150, s37, -v250
    v_fma_f32 v151, v151, s37, -v250
    v_mfma_f32_16x16x32_bf16 v[216:219], a[40:43], a[232:235], v[216:219]
    v_exp_f32 v148, v148
    v_mfma_f32_16x16x16_bf16 v[172:175], v[34:35], v[142:143], v[172:175]
    v_exp_f32 v149, v149
    v_mfma_f32_16x16x32_bf16 v[220:223], a[44:47], a[232:235], v[220:223]
    v_exp_f32 v150, v150
    v_mfma_f32_16x16x32_bf16 v[200:203], a[232:235], a[108:111], v[200:203]
    v_exp_f32 v151, v151
    v_mfma_f32_16x16x32_bf16 v[204:207], a[232:235], a[112:115], v[204:207]
    v_cvt_pk_bf16_f32 v178, v148, v149
    v_cvt_pk_bf16_f32 v179, v150, v151
    v_mfma_f32_16x16x32_bf16 v[208:211], a[232:235], a[116:119], v[208:211]
    ds_read_b128 a[232:235], v239 offset:7168
    ds_read_b128 v[148:151], v235
    v_mfma_f32_16x16x32_bf16 v[196:199], a[216:219], v[176:179], v[196:199]
    v_bfe_u32 v235, s70, v233, 4
    v_mad_u32_u24 v235, v235, s40, v231
    v_mfma_f32_16x16x32_bf16 v[184:187], v[74:77], v[176:179], v[184:187]
    v_fma_f32 v152, v152, s37, -v250
    v_fma_f32 v153, v153, s37, -v250
    v_mfma_f32_16x16x32_bf16 v[188:191], v[96:99], v[176:179], v[188:191]
    v_fma_f32 v154, v154, s37, -v250
    v_fma_f32 v155, v155, s37, -v250
    v_mfma_f32_16x16x32_bf16 v[192:195], v[118:121], v[176:179], v[192:195]
    s_waitcnt lgkmcnt(2)
    v_exp_f32 v152, v152
    v_mfma_f32_16x16x32_bf16 v[144:147], v[36:39], v[138:141], v[144:147]
    v_exp_f32 v153, v153
    v_mfma_f32_16x16x32_bf16 v[212:215], a[48:51], a[236:239], v[212:215]
    v_exp_f32 v154, v154
    v_mfma_f32_16x16x32_bf16 v[216:219], a[52:55], a[236:239], v[216:219]
    v_exp_f32 v155, v155
    v_mfma_f32_16x16x32_bf16 v[220:223], a[56:59], a[236:239], v[220:223]
    v_cvt_pk_bf16_f32 v180, v152, v153
    v_cvt_pk_bf16_f32 v181, v154, v155
    v_mfma_f32_16x16x16_bf16 v[144:147], v[40:41], v[142:143], v[144:147]
    s_waitcnt lgkmcnt(0)
    ds_read_b128 v[152:155], v236
    v_bfe_u32 v236, s71, v232, 4
    v_mfma_f32_16x16x32_bf16 v[148:151], v[42:45], v[138:141], v[148:151]
    v_fma_f32 v156, v156, s37, -v250
    v_fma_f32 v157, v157, s37, -v250
    v_mfma_f32_16x16x32_bf16 v[200:203], a[236:239], a[120:123], v[200:203]
    v_fma_f32 v158, v158, s37, -v250
    v_fma_f32 v159, v159, s37, -v250
    v_mfma_f32_16x16x32_bf16 v[204:207], a[236:239], a[124:127], v[204:207]
    v_exp_f32 v156, v156
    v_mfma_f32_16x16x16_bf16 v[148:151], v[46:47], v[142:143], v[148:151]
    v_exp_f32 v157, v157
    v_mfma_f32_16x16x32_bf16 v[208:211], a[236:239], a[128:131], v[208:211]
    ds_read_b64_tr_b16 a[236:237], v240 offset:3072
    ds_read_b64_tr_b16 a[238:239], v240 offset:7680
    v_mfma_f32_16x16x32_bf16 v[212:215], a[60:63], a[240:243], v[212:215]
    v_exp_f32 v158, v158
    v_mfma_f32_16x16x32_bf16 v[216:219], a[64:67], a[240:243], v[216:219]
    v_exp_f32 v159, v159
    v_mfma_f32_16x16x32_bf16 v[220:223], a[68:71], a[240:243], v[220:223]
    v_cvt_pk_bf16_f32 v182, v156, v157
    v_cvt_pk_bf16_f32 v183, v158, v159
    v_mfma_f32_16x16x32_bf16 v[200:203], a[240:243], a[132:135], v[200:203]
    ds_read_b128 v[156:159], v234
    v_cvt_pk_bf16_f32 v60, v212, v213
    v_mfma_f32_16x16x32_bf16 v[196:199], a[216:219], v[180:183], v[196:199]
    v_cvt_pk_bf16_f32 v61, v214, v215
    v_cvt_pk_bf16_f32 v62, v216, v217
    v_mfma_f32_16x16x32_bf16 v[184:187], v[78:81], v[180:183], v[184:187]
    v_cvt_pk_bf16_f32 v63, v218, v219
    v_cvt_pk_bf16_f32 v64, v220, v221
    v_mfma_f32_16x16x32_bf16 v[188:191], v[100:103], v[180:183], v[188:191]
    v_cvt_pk_bf16_f32 v65, v222, v223
    v_cvt_pk_bf16_f32 v86, v200, v201
    v_mfma_f32_16x16x32_bf16 v[192:195], v[122:125], v[180:183], v[192:195]
    s_waitcnt lgkmcnt(3)
    v_cvt_pk_bf16_f32 v87, v202, v203
    v_mad_u32_u24 v234, v236, s40, v228
    v_mfma_f32_16x16x32_bf16 v[152:155], v[48:51], v[138:141], v[152:155]
    v_mad_u32_u24 v236, v236, s40, v229
    v_fma_f32 v160, v160, s37, -v250
    v_mfma_f32_16x16x32_bf16 v[204:207], a[240:243], a[136:139], v[204:207]
    v_fma_f32 v161, v161, s37, -v250
    v_fma_f32 v162, v162, s37, -v250
    v_mfma_f32_16x16x32_bf16 v[208:211], a[240:243], a[140:143], v[208:211]
    ds_read_b64_tr_b16 a[240:241], v240 offset:3080
    ds_read_b64_tr_b16 a[242:243], v240 offset:7688
    v_mfma_f32_16x16x16_bf16 v[152:155], v[52:53], v[142:143], v[152:155]
    v_fma_f32 v163, v163, s37, -v250
    v_fma_f32 v164, v164, s37, -v250
    v_mfma_f32_16x16x32_bf16 v[212:215], a[252:255], a[244:247], 0
    s_waitcnt lgkmcnt(2)
    v_cvt_pk_bf16_f32 v108, v204, v205
    v_cvt_pk_bf16_f32 v109, v206, v207
    v_mfma_f32_16x16x32_bf16 v[156:159], v[54:57], v[138:141], v[156:159]
    v_cvt_pk_bf16_f32 v130, v208, v209
    v_cvt_pk_bf16_f32 v131, v210, v211
    v_mfma_f32_16x16x32_bf16 v[200:203], a[252:255], a[248:251], 0
    ds_read_b128 a[252:255], v239 offset:8192
    v_fma_f32 v165, v165, s37, -v250
    v_mfma_f32_16x16x32_bf16 v[216:219], a[220:223], a[244:247], 0
    v_exp_f32 v160, v160
    v_mfma_f32_16x16x16_bf16 v[156:159], v[58:59], v[142:143], v[156:159]
    v_exp_f32 v161, v161
    v_mfma_f32_16x16x32_bf16 v[204:207], a[220:223], a[248:251], 0
    ds_read_b64_tr_b16 a[220:221], v240 offset:4608
    ds_read_b64_tr_b16 a[222:223], v240 offset:6144
    v_mfma_f32_16x16x32_bf16 v[220:223], a[224:227], a[244:247], 0
    ds_read_b64_tr_b16 a[244:245], v241 offset:3072
    ds_read_b64_tr_b16 a[246:247], v241 offset:7680
    v_mfma_f32_16x16x32_bf16 v[208:211], a[224:227], a[248:251], 0
    ds_read_b128 a[248:251], v239 offset:2048
    ds_read_b64_tr_b16 a[224:225], v240 offset:4616
    v_mfma_f32_16x16x32_bf16 v[212:215], a[236:239], a[228:231], v[212:215]
    ds_read_b64_tr_b16 a[226:227], v240 offset:6152
    v_cvt_pk_bf16_f32 v176, v160, v161
    v_mfma_f32_16x16x32_bf16 v[200:203], a[236:239], a[232:235], v[200:203]
    s_waitcnt lgkmcnt(8)
    ds_read_b128 a[236:239], v239 offset:9216
    v_fma_f32 v166, v166, s37, -v250
    v_mfma_f32_16x16x32_bf16 v[216:219], a[240:243], a[228:231], v[216:219]
    v_exp_f32 v162, v162
    v_mfma_f32_16x16x32_bf16 v[204:207], a[240:243], a[232:235], v[204:207]
    s_waitcnt lgkmcnt(6)
    ds_read_b64_tr_b16 a[240:241], v240 offset:9216
    ds_read_b64_tr_b16 a[242:243], v240 offset:10752
    v_exp_f32 v163, v163
    v_fma_f32 v167, v167, s37, -v250
    v_cvt_pk_bf16_f32 v177, v162, v163
    ds_read_b128 v[160:163], v235
    v_bfe_u32 v235, s67, v232, 4
    v_exp_f32 v164, v164
    v_exp_f32 v165, v165
    v_mfma_f32_16x16x32_bf16 v[200:203], a[220:223], a[252:255], v[200:203]
    s_waitcnt lgkmcnt(7)
    v_exp_f32 v166, v166
    v_mfma_f32_16x16x32_bf16 v[220:223], a[244:247], a[228:231], v[220:223]
    ds_read_b64_tr_b16 a[228:229], v241 offset:4608
    ds_read_b64_tr_b16 a[230:231], v241 offset:6144
    v_mfma_f32_16x16x32_bf16 v[208:211], a[244:247], a[232:235], v[208:211]
    s_waitcnt lgkmcnt(8)
    ds_read_b128 a[232:235], v239 offset:3072
    ds_read_b64_tr_b16 a[244:245], v240 offset:9224
    v_mfma_f32_16x16x32_bf16 v[212:215], a[220:223], a[248:251], v[212:215]
    s_waitcnt lgkmcnt(8)
    ds_read_b64_tr_b16 a[246:247], v240 offset:10760
    ds_read_b128 a[220:223], v239 offset:10240
    v_mfma_f32_16x16x32_bf16 v[216:219], a[224:227], a[248:251], v[216:219]
    v_exp_f32 v167, v167
    v_mfma_f32_16x16x32_bf16 v[204:207], a[224:227], a[252:255], v[204:207]
    s_waitcnt lgkmcnt(7)
    ds_read_b64_tr_b16 a[224:225], v240 offset:12288
    ds_read_b64_tr_b16 a[226:227], v240 offset:16896
    v_mfma_f32_16x16x32_bf16 v[200:203], a[240:243], a[236:239], v[200:203]
    s_waitcnt lgkmcnt(8)
    v_cvt_pk_bf16_f32 v178, v164, v165
    v_cvt_pk_bf16_f32 v179, v166, v167
    ds_read_b128 v[164:167], v234
    v_mfma_f32_16x16x32_bf16 v[160:163], v[60:63], v[138:141], v[160:163]
    v_bfe_u32 v234, s62, v232, 4
    v_max3_f32 v248, v168, v169, v170
    v_mfma_f32_16x16x32_bf16 v[196:199], a[216:219], v[176:179], v[196:199]
    v_max3_f32 v249, v171, v172, v173
    v_max3_f32 v248, v248, v174, v175
    v_mfma_f32_16x16x32_bf16 v[184:187], v[66:69], v[176:179], v[184:187]
    v_max3_f32 v249, v249, v144, v145
    v_max3_f32 v248, v248, v146, v147
    v_mfma_f32_16x16x32_bf16 v[188:191], v[88:91], v[176:179], v[188:191]
    v_max3_f32 v249, v249, v148, v149
    v_max3_f32 v248, v248, v150, v151
    v_mfma_f32_16x16x32_bf16 v[192:195], v[110:113], v[176:179], v[192:195]
    v_rcp_f32 v197, v196
    v_mfma_f32_16x16x16_bf16 v[160:163], v[64:65], v[142:143], v[160:163]
    s_waitcnt lgkmcnt(5)
    v_mul_f32 v184, v184, v197
    v_mul_f32 v185, v185, v197
    v_mfma_f32_16x16x32_bf16 v[220:223], a[228:231], a[248:251], v[220:223]
    ds_read_b64_tr_b16 a[248:249], v241 offset:9216
    ds_read_b64_tr_b16 a[250:251], v241 offset:10752
    v_mfma_f32_16x16x32_bf16 v[208:211], a[228:231], a[252:255], v[208:211]
    ds_read_b128 a[252:255], v239 offset:4096
    ds_read_b64_tr_b16 a[228:229], v240 offset:12296
    v_mfma_f32_16x16x32_bf16 v[212:215], a[240:243], a[232:235], v[212:215]
    s_waitcnt lgkmcnt(4)
    ds_read_b64_tr_b16 a[230:231], v240 offset:16904
    ds_read_b128 a[240:243], v239 offset:11264
    v_mfma_f32_16x16x32_bf16 v[164:167], v[12:15], v[132:135], v[164:167]
    v_cvt_pk_bf16_f32 v184, v184, v185
    v_mul_f32 v186, v186, v197
    v_mfma_f32_16x16x32_bf16 v[216:219], a[244:247], a[232:235], v[216:219]
    v_mul_f32 v187, v187, v197
    v_cvt_pk_bf16_f32 v185, v186, v187
    v_mfma_f32_16x16x32_bf16 v[204:207], a[244:247], a[236:239], v[204:207]
    ds_read_b64_tr_b16 a[244:245], v240 offset:13824
    ds_read_b64_tr_b16 a[246:247], v240 offset:15360
    v_mfma_f32_16x16x16_bf16 v[164:167], v[16:17], v[136:137], v[164:167]
    v_mul_f32 v188, v188, v197
    v_mul_f32 v189, v189, v197
    v_mfma_f32_16x16x32_bf16 v[200:203], a[224:227], a[220:223], v[200:203]
    s_waitcnt lgkmcnt(6)
    v_cvt_pk_bf16_f32 v186, v188, v189
    v_mul_f32 v190, v190, v197
    v_mul_f32 v191, v191, v197
    v_cvt_pk_bf16_f32 v187, v190, v191
    v_mul_f32 v192, v192, v197
    v_mul_f32 v193, v193, v197
    v_cvt_pk_bf16_f32 v188, v192, v193
    v_mul_f32 v194, v194, v197
    v_mul_f32 v195, v195, v197
    v_mfma_f32_16x16x32_bf16 v[220:223], a[248:251], a[232:235], v[220:223]
    ds_read_b64_tr_b16 a[232:233], v241 offset:12288
    ds_read_b64_tr_b16 a[234:235], v241 offset:16896
    v_mfma_f32_16x16x32_bf16 v[208:211], a[248:251], a[236:239], v[208:211]
    s_waitcnt lgkmcnt(7)
    ds_read_b128 a[236:239], v239 offset:5120
    ds_read_b64_tr_b16 a[248:249], v240 offset:13832
    v_mfma_f32_16x16x32_bf16 v[212:215], a[224:227], a[252:255], v[212:215]
    s_waitcnt lgkmcnt(7)
    ds_read_b64_tr_b16 a[250:251], v240 offset:15368
    v_cvt_pk_bf16_f32 v189, v194, v195
    v_mfma_f32_16x16x32_bf16 v[216:219], a[228:231], a[252:255], v[216:219]
    ds_read_b128 a[224:227], v224 offset:15552
    v_max3_f32 v249, v249, v152, v153
    v_mfma_f32_16x16x32_bf16 v[204:207], a[228:231], a[220:223], v[204:207]
    s_waitcnt lgkmcnt(6)
    ds_read_b128 a[228:231], v224 offset:15616
    v_max3_f32 v248, v248, v154, v155
    v_mfma_f32_16x16x32_bf16 v[200:203], a[244:247], a[240:243], v[200:203]
    s_waitcnt lgkmcnt(5)
    v_max3_f32 v249, v249, v156, v157
    v_max3_f32 v248, v248, v158, v159
    v_max3_f32 v249, v249, v160, v161
    v_max3_f32 v248, v248, v162, v163
    v_max_f32 v248, v248, v249
    v_mov_b32 v249, v248
    s_nop 1
    v_cvt_pk_bf16_f32 v200, v200, v201
    v_cvt_pk_bf16_f32 v201, v202, v203
    v_permlane16_swap_b32 v248, v249
    v_max_f32 v248, v248, v249
    v_mov_b32 v249, v248
    s_nop 1
    v_permlane32_swap_b32 v248, v249
    v_mfma_f32_16x16x32_bf16 v[220:223], a[232:235], a[252:255], v[220:223]
    ds_read_b64_tr_b16 a[252:253], v241 offset:13824
    ds_read_b64_tr_b16 a[254:255], v241 offset:15360
    v_mfma_f32_16x16x32_bf16 v[208:211], a[232:235], a[220:223], v[208:211]
    s_waitcnt lgkmcnt(6)
    ds_read_b128 a[220:223], v224 offset:15488
    ds_read_b128 a[232:235], v224 offset:15680
    v_mfma_f32_16x16x32_bf16 v[212:215], a[244:247], a[236:239], v[212:215]
    s_waitcnt lgkmcnt(6)
    ds_read_b128 a[244:247], v224 offset:18560
    v_max_f32 v248, v248, v249
    v_mfma_f32_16x16x32_bf16 v[216:219], a[248:251], a[236:239], v[216:219]
    v_mul_f32 v250, s37, v248
    v_fma_f32 v168, v168, s37, -v250
    v_mfma_f32_16x16x32_bf16 v[204:207], a[248:251], a[240:243], v[204:207]
    s_waitcnt lgkmcnt(3)
    ds_read_b128 a[248:251], v224 offset:18624
    v_fma_f32 v169, v169, s37, -v250
    v_cvt_pk_bf16_f32 v212, v212, v213
    v_cvt_pk_bf16_f32 v213, v214, v215
    v_fma_f32 v170, v170, s37, -v250
    v_cvt_pk_bf16_f32 v214, v216, v217
    v_cvt_pk_bf16_f32 v215, v218, v219
    buffer_store_dwordx4 v[212:215], v242, s[20:23], s58 offen sc0 sc1
    v_cvt_pk_bf16_f32 v202, v204, v205
    v_cvt_pk_bf16_f32 v203, v206, v207
    buffer_store_dwordx4 v[200:203], v244, s[20:23], s59 offen sc0 sc1
    v_mfma_f32_16x16x32_bf16 v[220:223], a[252:255], a[236:239], v[220:223]
    s_waitcnt lgkmcnt(3)
    ds_read_b128 a[236:239], v224 offset:15744
    v_fma_f32 v171, v171, s37, -v250
    v_mfma_f32_16x16x32_bf16 v[208:211], a[252:255], a[240:243], v[208:211]
    s_barrier
    ds_write_b128 v237, v[184:187]
    v_mfma_f32_16x16x32_bf16 v[212:215], a[0:3], a[220:223], 0
    ds_write_b64 v238, v[188:189]
    v_mfma_f32_16x16x32_bf16 v[216:219], a[4:7], a[220:223], 0
    ds_read_b128 a[240:243], v224 offset:15808
    v_cvt_pk_bf16_f32 v220, v220, v221
    v_mfma_f32_16x16x32_bf16 v[200:203], a[220:223], a[72:75], 0
    v_cvt_pk_bf16_f32 v221, v222, v223
    v_cvt_pk_bf16_f32 v208, v208, v209
    v_mfma_f32_16x16x32_bf16 v[204:207], a[220:223], a[76:79], 0
    buffer_store_dwordx2 v[220:221], v243, s[20:23], s58 offen sc0 sc1
    v_mfma_f32_16x16x32_bf16 v[220:223], a[8:11], a[220:223], 0
    ds_read_b128 a[252:255], v224 offset:18688
    v_cvt_pk_bf16_f32 v209, v210, v211
    v_mfma_f32_16x16x32_bf16 v[212:215], a[12:15], a[224:227], v[212:215]
    buffer_store_dwordx2 v[208:209], v245, s[20:23], s59 offen sc0 sc1
    v_mfma_f32_16x16x32_bf16 v[208:211], a[220:223], a[80:83], 0
    ds_read_b128 a[220:223], v224 offset:18752
    v_fma_f32 v172, v172, s37, -v250
    v_mfma_f32_16x16x32_bf16 v[216:219], a[16:19], a[224:227], v[216:219]
    v_exp_f32 v168, v168
    v_mfma_f32_16x16x32_bf16 v[220:223], a[20:23], a[224:227], v[220:223]
    v_exp_f32 v169, v169
    v_mfma_f32_16x16x32_bf16 v[200:203], a[224:227], a[84:87], v[200:203]
    v_exp_f32 v170, v170
    v_mfma_f32_16x16x32_bf16 v[204:207], a[224:227], a[88:91], v[204:207]
    v_exp_f32 v171, v171
    v_mfma_f32_16x16x32_bf16 v[208:211], a[224:227], a[92:95], v[208:211]
    ds_read_b128 a[224:227], v224 offset:18816
    v_cvt_pk_bf16_f32 v180, v168, v169
    v_mfma_f32_16x16x32_bf16 v[212:215], a[24:27], a[228:231], v[212:215]
    v_cvt_pk_bf16_f32 v181, v170, v171
    v_fma_f32 v173, v173, s37, -v250
    v_mfma_f32_16x16x32_bf16 v[216:219], a[28:31], a[228:231], v[216:219]
    ds_read_b128 v[168:171], v236
    v_mad_u32_u24 v236, v235, s40, v229
    v_mfma_f32_16x16x32_bf16 v[220:223], a[32:35], a[228:231], v[220:223]
    v_mad_u32_u24 v235, v235, s40, v228
    v_fma_f32 v174, v174, s37, -v250
    v_mfma_f32_16x16x32_bf16 v[200:203], a[228:231], a[96:99], v[200:203]
    v_fma_f32 v175, v175, s37, -v250
    v_fma_f32 v144, v144, s37, -v250
    v_mfma_f32_16x16x32_bf16 v[204:207], a[228:231], a[100:103], v[204:207]
    v_exp_f32 v172, v172
    v_mfma_f32_16x16x32_bf16 v[208:211], a[228:231], a[104:107], v[208:211]
    s_waitcnt lgkmcnt(2)
    ds_read_b128 a[228:231], v224 offset:18880
    v_fma_f32 v145, v145, s37, -v250
    v_mfma_f32_16x16x32_bf16 v[212:215], a[36:39], a[232:235], v[212:215]
    v_exp_f32 v173, v173
    v_mfma_f32_16x16x32_bf16 v[216:219], a[40:43], a[232:235], v[216:219]
    v_exp_f32 v174, v174
    v_mfma_f32_16x16x32_bf16 v[220:223], a[44:47], a[232:235], v[220:223]
    v_exp_f32 v175, v175
    v_mfma_f32_16x16x32_bf16 v[200:203], a[232:235], a[108:111], v[200:203]
    v_cvt_pk_bf16_f32 v182, v172, v173
    v_cvt_pk_bf16_f32 v183, v174, v175
    v_mfma_f32_16x16x32_bf16 v[204:207], a[232:235], a[112:115], v[204:207]
    ds_read_b128 v[172:175], v236
    v_bfe_u32 v236, s72, v232, 4
    v_mfma_f32_16x16x32_bf16 v[196:199], a[216:219], v[180:183], 0
    v_fma_f32 v146, v146, s37, -v250
    v_fma_f32 v147, v147, s37, -v250
    v_mfma_f32_16x16x32_bf16 v[184:187], v[68:71], v[180:183], 0
    v_exp_f32 v144, v144
    v_mfma_f32_16x16x32_bf16 v[188:191], v[90:93], v[180:183], 0
    v_exp_f32 v145, v145
    v_mfma_f32_16x16x32_bf16 v[192:195], v[112:115], v[180:183], 0
    s_waitcnt lgkmcnt(2)
    v_exp_f32 v146, v146
    v_mfma_f32_16x16x32_bf16 v[168:171], v[36:39], v[132:135], v[168:171]
    v_exp_f32 v147, v147
    v_mfma_f32_16x16x32_bf16 v[208:211], a[232:235], a[116:119], v[208:211]
    ds_read_b128 a[232:235], v226 offset:3072
    v_cvt_pk_bf16_f32 v176, v144, v145
    v_mfma_f32_16x16x32_bf16 v[212:215], a[48:51], a[236:239], v[212:215]
    v_cvt_pk_bf16_f32 v177, v146, v147
    v_fma_f32 v148, v148, s37, -v250
    v_mfma_f32_16x16x16_bf16 v[168:171], v[40:41], v[136:137], v[168:171]
    ds_read_b128 v[144:147], v235
    v_mad_u32_u24 v235, v234, s40, v228
    v_mfma_f32_16x16x32_bf16 v[216:219], a[52:55], a[236:239], v[216:219]
    s_waitcnt lgkmcnt(2)
    v_mad_u32_u24 v234, v234, s40, v229
    v_fma_f32 v149, v149, s37, -v250
    v_mfma_f32_16x16x32_bf16 v[172:175], v[42:45], v[132:135], v[172:175]
    v_fma_f32 v150, v150, s37, -v250
    v_fma_f32 v151, v151, s37, -v250
    v_mfma_f32_16x16x32_bf16 v[220:223], a[56:59], a[236:239], v[220:223]
    v_exp_f32 v148, v148
    v_mfma_f32_16x16x32_bf16 v[200:203], a[236:239], a[120:123], v[200:203]
    v_exp_f32 v149, v149
    v_mfma_f32_16x16x16_bf16 v[172:175], v[46:47], v[136:137], v[172:175]
    v_exp_f32 v150, v150
    v_mfma_f32_16x16x32_bf16 v[204:207], a[236:239], a[124:127], v[204:207]
    v_exp_f32 v151, v151
    v_mfma_f32_16x16x32_bf16 v[208:211], a[236:239], a[128:131], v[208:211]
    ds_read_b128 a[236:239], v226 offset:3136
    v_cvt_pk_bf16_f32 v178, v148, v149
    v_mfma_f32_16x16x32_bf16 v[212:215], a[60:63], a[240:243], v[212:215]
    v_cvt_pk_bf16_f32 v179, v150, v151
    v_fma_f32 v152, v152, s37, -v250
    v_mfma_f32_16x16x32_bf16 v[216:219], a[64:67], a[240:243], v[216:219]
    ds_read_b128 v[148:151], v235
    v_bfe_u32 v235, s71, v232, 4
    v_mfma_f32_16x16x32_bf16 v[196:199], a[216:219], v[176:179], v[196:199]
    v_mad_u32_u24 v235, v235, s40, v230
    v_fma_f32 v153, v153, s37, -v250
    v_mfma_f32_16x16x32_bf16 v[184:187], v[76:79], v[176:179], v[184:187]
    v_cvt_pk_bf16_f32 v6, v212, v213
    v_cvt_pk_bf16_f32 v7, v214, v215
    v_mfma_f32_16x16x32_bf16 v[188:191], v[98:101], v[176:179], v[188:191]
    v_cvt_pk_bf16_f32 v8, v216, v217
    v_cvt_pk_bf16_f32 v9, v218, v219
    v_mfma_f32_16x16x32_bf16 v[192:195], v[120:123], v[176:179], v[192:195]
    s_waitcnt lgkmcnt(2)
    v_fma_f32 v154, v154, s37, -v250
    v_fma_f32 v155, v155, s37, -v250
    v_mfma_f32_16x16x32_bf16 v[144:147], v[18:21], v[132:135], v[144:147]
    v_exp_f32 v152, v152
    v_mfma_f32_16x16x32_bf16 v[220:223], a[68:71], a[240:243], v[220:223]
    v_exp_f32 v153, v153
    v_mfma_f32_16x16x32_bf16 v[200:203], a[240:243], a[132:135], v[200:203]
    v_exp_f32 v154, v154
    v_mfma_f32_16x16x32_bf16 v[204:207], a[240:243], a[136:139], v[204:207]
    v_exp_f32 v155, v155
    v_mfma_f32_16x16x16_bf16 v[144:147], v[22:23], v[136:137], v[144:147]
    s_waitcnt lgkmcnt(0)
    v_cvt_pk_bf16_f32 v180, v152, v153
    v_cvt_pk_bf16_f32 v181, v154, v155
    v_mfma_f32_16x16x32_bf16 v[148:151], v[0:3], v[132:135], v[148:151]
    v_cvt_pk_bf16_f32 v10, v220, v221
    v_cvt_pk_bf16_f32 v11, v222, v223
    v_mfma_f32_16x16x32_bf16 v[208:211], a[240:243], a[140:143], v[208:211]
    v_cvt_pk_bf16_f32 v72, v200, v201
    v_cvt_pk_bf16_f32 v73, v202, v203
    v_mfma_f32_16x16x32_bf16 v[212:215], a[0:3], a[244:247], 0
    v_cvt_pk_bf16_f32 v94, v204, v205
    v_cvt_pk_bf16_f32 v95, v206, v207
    v_mfma_f32_16x16x16_bf16 v[148:151], v[4:5], v[136:137], v[148:151]
    ds_read_b128 v[152:155], v234
    v_mad_u32_u24 v234, v236, s40, v229
    v_mfma_f32_16x16x32_bf16 v[216:219], a[4:7], a[244:247], 0
    v_cvt_pk_bf16_f32 v116, v208, v209
    v_cvt_pk_bf16_f32 v117, v210, v211
    v_mfma_f32_16x16x32_bf16 v[220:223], a[8:11], a[244:247], 0
    ds_read_b128 a[240:243], v226 offset:3200
    v_mad_u32_u24 v236, v236, s40, v228
    v_mfma_f32_16x16x32_bf16 v[200:203], a[244:247], a[72:75], 0
    v_fma_f32 v156, v156, s37, -v250
    v_fma_f32 v157, v157, s37, -v250
    v_mfma_f32_16x16x32_bf16 v[204:207], a[244:247], a[76:79], 0
    v_fma_f32 v158, v158, s37, -v250
    v_fma_f32 v159, v159, s37, -v250
    v_mfma_f32_16x16x32_bf16 v[208:211], a[244:247], a[80:83], 0
    ds_read_b128 a[244:247], v226 offset:3264
    v_fma_f32 v160, v160, s37, -v250
    v_mfma_f32_16x16x32_bf16 v[212:215], a[12:15], a[248:251], v[212:215]
    v_exp_f32 v156, v156
    v_mfma_f32_16x16x32_bf16 v[216:219], a[16:19], a[248:251], v[216:219]
    v_exp_f32 v157, v157
    v_mfma_f32_16x16x32_bf16 v[220:223], a[20:23], a[248:251], v[220:223]
    v_exp_f32 v158, v158
    v_mfma_f32_16x16x32_bf16 v[200:203], a[248:251], a[84:87], v[200:203]
    s_waitcnt lgkmcnt(2)
    v_exp_f32 v159, v159
    v_mfma_f32_16x16x32_bf16 v[152:155], v[24:27], v[132:135], v[152:155]
    v_cvt_pk_bf16_f32 v182, v156, v157
    v_cvt_pk_bf16_f32 v183, v158, v159
    v_mfma_f32_16x16x32_bf16 v[204:207], a[248:251], a[88:91], v[204:207]
    ds_read_b128 v[156:159], v234
    v_bfe_u32 v234, s62, v232, 4
    v_mfma_f32_16x16x32_bf16 v[196:199], a[216:219], v[180:183], v[196:199]
    v_mad_u32_u24 v234, v234, s40, v230
    v_fma_f32 v161, v161, s37, -v250
    v_mfma_f32_16x16x32_bf16 v[184:187], v[82:85], v[180:183], v[184:187]
    v_fma_f32 v162, v162, s37, -v250
    v_fma_f32 v163, v163, s37, -v250
    v_mfma_f32_16x16x32_bf16 v[188:191], v[104:107], v[180:183], v[188:191]
    v_exp_f32 v160, v160
    v_mfma_f32_16x16x32_bf16 v[192:195], v[126:129], v[180:183], v[192:195]
    v_exp_f32 v161, v161
    v_mfma_f32_16x16x16_bf16 v[152:155], v[28:29], v[136:137], v[152:155]
    v_exp_f32 v162, v162
    v_mfma_f32_16x16x32_bf16 v[208:211], a[248:251], a[92:95], v[208:211]
    ds_read_b128 a[248:251], v226 offset:3328
    v_cvt_pk_bf16_f32 v176, v160, v161
    v_mfma_f32_16x16x32_bf16 v[212:215], a[24:27], a[252:255], v[212:215]
    v_exp_f32 v163, v163
    v_mfma_f32_16x16x32_bf16 v[216:219], a[28:31], a[252:255], v[216:219]
    v_cvt_pk_bf16_f32 v177, v162, v163
    v_max3_f32 v248, v164, v165, v166
    v_mfma_f32_16x16x32_bf16 v[220:223], a[32:35], a[252:255], v[220:223]
    ds_read_b128 v[160:163], v236
    v_bfe_u32 v236, s67, v232, 4
    v_mfma_f32_16x16x16_bf16 v[196:199], a[216:217], v[176:177], v[196:199]
    v_mad_u32_u24 v236, v236, s40, v230
    v_max3_f32 v249, v167, v168, v169
    v_mfma_f32_16x16x16_bf16 v[184:187], v[86:87], v[176:177], v[184:187]
    v_max3_f32 v248, v248, v170, v171
    v_max3_f32 v249, v249, v172, v173
    v_mfma_f32_16x16x16_bf16 v[188:191], v[108:109], v[176:177], v[188:191]
    v_max3_f32 v248, v248, v174, v175
    v_max3_f32 v249, v249, v144, v145
    v_mfma_f32_16x16x16_bf16 v[192:195], v[130:131], v[176:177], v[192:195]
    v_rcp_f32 v197, v196
    v_mfma_f32_16x16x32_bf16 v[200:203], a[252:255], a[96:99], v[200:203]
    v_mul_f32 v184, v184, v197
    v_mul_f32 v185, v185, v197
    v_mfma_f32_16x16x32_bf16 v[204:207], a[252:255], a[100:103], v[204:207]
    v_cvt_pk_bf16_f32 v184, v184, v185
    v_mul_f32 v186, v186, v197
    v_mfma_f32_16x16x32_bf16 v[208:211], a[252:255], a[104:107], v[208:211]
    v_mul_f32 v187, v187, v197
    v_cvt_pk_bf16_f32 v185, v186, v187
    v_mfma_f32_16x16x32_bf16 v[212:215], a[36:39], a[220:223], v[212:215]
    v_mul_f32 v188, v188, v197
    v_mul_f32 v189, v189, v197
    v_mfma_f32_16x16x32_bf16 v[216:219], a[40:43], a[220:223], v[216:219]
    s_waitcnt lgkmcnt(0)
    v_cvt_pk_bf16_f32 v186, v188, v189
    v_mul_f32 v190, v190, v197
    v_mfma_f32_16x16x32_bf16 v[160:163], v[6:9], v[132:135], v[160:163]
    v_mul_f32 v191, v191, v197
    v_cvt_pk_bf16_f32 v187, v190, v191
    v_mfma_f32_16x16x32_bf16 v[220:223], a[44:47], a[220:223], v[220:223]
    v_mul_f32 v192, v192, v197
    v_mul_f32 v193, v193, v197
    v_mfma_f32_16x16x32_bf16 v[200:203], a[220:223], a[108:111], v[200:203]
    v_cvt_pk_bf16_f32 v188, v192, v193
    v_mul_f32 v194, v194, v197
    v_mfma_f32_16x16x16_bf16 v[160:163], v[10:11], v[136:137], v[160:163]
    ds_read_b128 a[252:255], v226 offset:3392
    v_mul_f32 v195, v195, v197
    v_mfma_f32_16x16x32_bf16 v[204:207], a[220:223], a[112:115], v[204:207]
    v_cvt_pk_bf16_f32 v189, v194, v195
    v_max3_f32 v248, v248, v146, v147
    v_mfma_f32_16x16x32_bf16 v[208:211], a[220:223], a[116:119], v[208:211]
    ds_write_b128 v237, v[184:187] offset:6144
    v_mfma_f32_16x16x32_bf16 v[212:215], a[48:51], a[224:227], v[212:215]
    ds_write_b64 v238, v[188:189] offset:6144
    v_mfma_f32_16x16x32_bf16 v[216:219], a[52:55], a[224:227], v[216:219]
    ds_read_b128 a[220:223], v225 offset:7744
    v_max3_f32 v249, v249, v148, v149
    v_mfma_f32_16x16x32_bf16 v[220:223], a[56:59], a[224:227], v[220:223]
    v_max3_f32 v248, v248, v150, v151
    v_max3_f32 v249, v249, v152, v153
    v_mfma_f32_16x16x32_bf16 v[200:203], a[224:227], a[120:123], v[200:203]
    v_max3_f32 v248, v248, v154, v155
    v_mfma_f32_16x16x32_bf16 v[204:207], a[224:227], a[124:127], v[204:207]
    v_mfma_f32_16x16x32_bf16 v[208:211], a[224:227], a[128:131], v[208:211]
    ds_read_b128 a[224:227], v225 offset:7808
    v_mfma_f32_16x16x32_bf16 v[212:215], a[60:63], a[228:231], v[212:215]
    v_mfma_f32_16x16x32_bf16 v[216:219], a[64:67], a[228:231], v[216:219]
    v_mfma_f32_16x16x32_bf16 v[220:223], a[68:71], a[228:231], v[220:223]
    v_mfma_f32_16x16x32_bf16 v[200:203], a[228:231], a[132:135], v[200:203]
    v_mfma_f32_16x16x32_bf16 v[204:207], a[228:231], a[136:139], v[204:207]
    v_mfma_f32_16x16x32_bf16 v[208:211], a[228:231], a[140:143], v[208:211]
    ds_read_b128 a[228:231], v225 offset:7872
    s_nop 1
    v_cvt_pk_bf16_f32 v30, v212, v213
    v_cvt_pk_bf16_f32 v31, v214, v215
    v_mfma_f32_16x16x32_bf16 v[212:215], a[144:147], a[232:235], 0
    v_cvt_pk_bf16_f32 v32, v216, v217
    v_cvt_pk_bf16_f32 v33, v218, v219
    v_mfma_f32_16x16x32_bf16 v[216:219], a[148:151], a[232:235], 0
    v_cvt_pk_bf16_f32 v34, v220, v221
    v_cvt_pk_bf16_f32 v35, v222, v223
    v_mfma_f32_16x16x32_bf16 v[156:159], v[30:33], v[132:135], v[156:159]
    v_cvt_pk_bf16_f32 v70, v200, v201
    v_cvt_pk_bf16_f32 v71, v202, v203
    v_mfma_f32_16x16x32_bf16 v[220:223], a[152:155], a[232:235], 0
    v_cvt_pk_bf16_f32 v92, v204, v205
    v_cvt_pk_bf16_f32 v93, v206, v207
    v_mfma_f32_16x16x32_bf16 v[212:215], a[156:159], a[236:239], v[212:215]
    v_cvt_pk_bf16_f32 v114, v208, v209
    v_cvt_pk_bf16_f32 v115, v210, v211
    v_mfma_f32_16x16x16_bf16 v[156:159], v[34:35], v[136:137], v[156:159]
    ds_read_b128 a[232:235], v225 offset:7936
    v_mfma_f32_16x16x32_bf16 v[216:219], a[160:163], a[236:239], v[216:219]
    v_mfma_f32_16x16x32_bf16 v[220:223], a[164:167], a[236:239], v[220:223]
    ds_read_b128 a[236:239], v225 offset:8000
    v_mfma_f32_16x16x32_bf16 v[212:215], a[168:171], a[240:243], v[212:215]
    v_mfma_f32_16x16x32_bf16 v[216:219], a[172:175], a[240:243], v[216:219]
    v_mfma_f32_16x16x32_bf16 v[220:223], a[176:179], a[240:243], v[220:223]
    ds_read_b128 a[240:243], v225 offset:8064
    v_max3_f32 v249, v249, v156, v157
    v_mfma_f32_16x16x32_bf16 v[212:215], a[180:183], a[244:247], v[212:215]
    v_max3_f32 v248, v248, v158, v159
    v_max3_f32 v249, v249, v160, v161
    v_mfma_f32_16x16x32_bf16 v[216:219], a[184:187], a[244:247], v[216:219]
    v_max3_f32 v248, v248, v162, v163
    v_max_f32 v248, v248, v249
    v_mfma_f32_16x16x32_bf16 v[220:223], a[188:191], a[244:247], v[220:223]
    v_mov_b32 v249, v248
    v_mfma_f32_16x16x32_bf16 v[212:215], a[192:195], a[248:251], v[212:215]
    v_mfma_f32_16x16x32_bf16 v[216:219], a[196:199], a[248:251], v[216:219]
    v_permlane16_swap_b32 v248, v249
    v_mfma_f32_16x16x32_bf16 v[220:223], a[200:203], a[248:251], v[220:223]
    s_waitcnt lgkmcnt(2)
    v_max_f32 v248, v248, v249
    v_mov_b32 v249, v248
    v_mfma_f32_16x16x32_bf16 v[212:215], a[204:207], a[252:255], v[212:215]
    v_mfma_f32_16x16x32_bf16 v[216:219], a[208:211], a[252:255], v[216:219]
    s_waitcnt vmcnt(4)
    v_permlane32_swap_b32 v248, v249
    v_mfma_f32_16x16x32_bf16 v[220:223], a[212:215], a[252:255], v[220:223]
    s_barrier
    buffer_load_dwordx4 v246, s[4:7], s56 offen lds
    v_mfma_f32_16x16x32_bf16 v[200:203], a[144:147], a[220:223], 0
    s_add_u32 m0, s42, 0xb580
    ds_read_b128 a[244:247], v239
    v_cvt_pk_bf16_f32 v138, v212, v213
    v_mfma_f32_16x16x32_bf16 v[204:207], a[148:151], a[220:223], 0
    v_cvt_pk_bf16_f32 v139, v214, v215
    v_cvt_pk_bf16_f32 v140, v216, v217
    v_mfma_f32_16x16x32_bf16 v[208:211], a[152:155], a[220:223], 0
    v_cvt_pk_bf16_f32 v141, v218, v219
    v_cvt_pk_bf16_f32 v142, v220, v221
    v_mfma_f32_16x16x32_bf16 v[200:203], a[156:159], a[224:227], v[200:203]
    ds_read_b128 a[248:251], v239 offset:6144
    v_cvt_pk_bf16_f32 v143, v222, v223
    v_mfma_f32_16x16x32_bf16 v[204:207], a[160:163], a[224:227], v[204:207]
    buffer_load_dwordx4 v247, s[4:7], s56 offen lds
    v_mfma_f32_16x16x32_bf16 v[208:211], a[164:167], a[224:227], v[208:211]
    s_add_u32 s56, s39, 0x276000
    ds_read_b64_tr_b16 a[252:253], v240
    ds_read_b64_tr_b16 a[254:255], v240 offset:1536
    v_mfma_f32_16x16x32_bf16 v[200:203], a[168:171], a[228:231], v[200:203]
    s_add_u32 m0, s41, 0xd3c0
    ds_read_b64_tr_b16 a[220:221], v240 offset:8
    ds_read_b64_tr_b16 a[222:223], v240 offset:1544
    v_mfma_f32_16x16x32_bf16 v[204:207], a[172:175], a[228:231], v[204:207]
    buffer_load_dwordx4 v246, s[4:7], s56 offen lds
    v_mfma_f32_16x16x32_bf16 v[208:211], a[176:179], a[228:231], v[208:211]
    s_add_u32 m0, s42, 0xd3c0
    ds_read_b64_tr_b16 a[224:225], v241
    ds_read_b64_tr_b16 a[226:227], v241 offset:1536
    v_mfma_f32_16x16x32_bf16 v[200:203], a[180:183], a[232:235], v[200:203]
    s_add_u32 s58, s51, 0x54000
    buffer_load_dwordx4 v247, s[4:7], s56 offen lds
    v_mfma_f32_16x16x32_bf16 v[204:207], a[184:187], a[232:235], v[204:207]
    s_add_u32 s59, s51, 0x55800
    ds_read_b128 a[228:231], v239 offset:1024
    v_max_f32 v248, v248, v249
    v_mfma_f32_16x16x32_bf16 v[208:211], a[188:191], a[232:235], v[208:211]
    s_add_u32 s56, s39, 0x2a0000
    ds_read_b128 a[232:235], v239 offset:7168
    v_mul_f32 v250, s37, v248
    s_waitcnt lgkmcnt(9)
    v_mfma_f32_16x16x32_bf16 v[200:203], a[192:195], a[236:239], v[200:203]
    s_add_u32 m0, s41, 0
    v_fma_f32 v164, v164, s37, -v250
    v_fma_f32 v165, v165, s37, -v250
    v_mfma_f32_16x16x32_bf16 v[204:207], a[196:199], a[236:239], v[204:207]
    v_fma_f32 v166, v166, s37, -v250
    v_fma_f32 v167, v167, s37, -v250
    v_mfma_f32_16x16x32_bf16 v[208:211], a[200:203], a[236:239], v[208:211]
    ds_read_b64_tr_b16 a[236:237], v240 offset:3072
    ds_read_b64_tr_b16 a[238:239], v240 offset:7680
    v_mfma_f32_16x16x32_bf16 v[200:203], a[204:207], a[240:243], v[200:203]
    v_exp_f32 v164, v164
    v_mfma_f32_16x16x32_bf16 v[204:207], a[208:211], a[240:243], v[204:207]
    v_exp_f32 v165, v165
    v_mfma_f32_16x16x32_bf16 v[208:211], a[212:215], a[240:243], v[208:211]
    s_waitcnt lgkmcnt(6)
    ds_read_b64_tr_b16 a[240:241], v240 offset:3080
    ds_read_b64_tr_b16 a[242:243], v240 offset:7688
    v_mfma_f32_16x16x32_bf16 v[212:215], a[252:255], a[244:247], 0
    v_exp_f32 v166, v166
    v_mfma_f32_16x16x32_bf16 v[216:219], a[220:223], a[244:247], 0
    v_cvt_pk_bf16_f32 v132, v200, v201
    v_cvt_pk_bf16_f32 v133, v202, v203
    v_mfma_f32_16x16x32_bf16 v[200:203], a[252:255], a[248:251], 0
    v_cvt_pk_bf16_f32 v134, v204, v205
    v_cvt_pk_bf16_f32 v135, v206, v207
    v_mfma_f32_16x16x32_bf16 v[204:207], a[220:223], a[248:251], 0
    s_waitcnt lgkmcnt(5)
    v_cvt_pk_bf16_f32 v136, v208, v209
    v_cvt_pk_bf16_f32 v137, v210, v211
    v_mfma_f32_16x16x32_bf16 v[220:223], a[224:227], a[244:247], 0
    ds_read_b64_tr_b16 a[244:245], v241 offset:3072
    ds_read_b64_tr_b16 a[246:247], v241 offset:7680
    v_mfma_f32_16x16x32_bf16 v[208:211], a[224:227], a[248:251], 0
    s_waitcnt lgkmcnt(4)
    ds_read_b128 a[248:251], v239 offset:2048
    ds_read_b128 a[252:255], v239 offset:8192
    v_mfma_f32_16x16x32_bf16 v[212:215], a[236:239], a[228:231], v[212:215]
    ds_read_b64_tr_b16 a[220:221], v240 offset:4608
    ds_read_b64_tr_b16 a[222:223], v240 offset:6144
    v_mfma_f32_16x16x32_bf16 v[200:203], a[236:239], a[232:235], v[200:203]
    s_waitcnt lgkmcnt(6)
    ds_read_b64_tr_b16 a[224:225], v240 offset:4616
    ds_read_b64_tr_b16 a[226:227], v240 offset:6152
    ds_read_b128 a[236:239], v239 offset:9216
    v_exp_f32 v167, v167
    v_mfma_f32_16x16x32_bf16 v[216:219], a[240:243], a[228:231], v[216:219]
    v_cvt_pk_bf16_f32 v180, v164, v165
    v_cvt_pk_bf16_f32 v181, v166, v167
    v_mfma_f32_16x16x32_bf16 v[204:207], a[240:243], a[232:235], v[204:207]
    s_waitcnt lgkmcnt(7)
    ds_read_b64_tr_b16 a[240:241], v240 offset:9216
    ds_read_b64_tr_b16 a[242:243], v240 offset:10752
    ds_read_b128 v[164:167], v235
    v_bfe_u32 v235, s72, v232, 4
    v_mad_u32_u24 v235, v235, s40, v230
    v_fma_f32 v168, v168, s37, -v250
    v_fma_f32 v169, v169, s37, -v250
    v_fma_f32 v170, v170, s37, -v250
    v_fma_f32 v171, v171, s37, -v250
    v_exp_f32 v168, v168
    v_exp_f32 v169, v169
    v_exp_f32 v170, v170
    v_mfma_f32_16x16x32_bf16 v[220:223], a[244:247], a[228:231], v[220:223]
    ds_read_b64_tr_b16 a[228:229], v241 offset:4608
    ds_read_b64_tr_b16 a[230:231], v241 offset:6144
    v_mfma_f32_16x16x32_bf16 v[208:211], a[244:247], a[232:235], v[208:211]
    s_waitcnt lgkmcnt(8)
    ds_read_b128 a[232:235], v239 offset:3072
    ds_read_b64_tr_b16 a[244:245], v240 offset:9224
    v_mfma_f32_16x16x32_bf16 v[212:215], a[220:223], a[248:251], v[212:215]
    ds_read_b64_tr_b16 a[246:247], v240 offset:10760
    v_cvt_pk_bf16_f32 v182, v168, v169
    v_mfma_f32_16x16x32_bf16 v[200:203], a[220:223], a[252:255], v[200:203]
    s_waitcnt lgkmcnt(9)
    ds_read_b128 a[220:223], v239 offset:10240
    v_fma_f32 v172, v172, s37, -v250
    v_mfma_f32_16x16x32_bf16 v[216:219], a[224:227], a[248:251], v[216:219]
    v_exp_f32 v171, v171
    v_mfma_f32_16x16x32_bf16 v[204:207], a[224:227], a[252:255], v[204:207]
    s_waitcnt lgkmcnt(6)
    ds_read_b64_tr_b16 a[224:225], v240 offset:12288
    ds_read_b64_tr_b16 a[226:227], v240 offset:16896
    v_mfma_f32_16x16x32_bf16 v[164:167], v[36:39], v[138:141], v[164:167]
    v_cvt_pk_bf16_f32 v183, v170, v171
    v_fma_f32 v173, v173, s37, -v250
    v_mfma_f32_16x16x32_bf16 v[200:203], a[240:243], a[236:239], v[200:203]
    ds_read_b128 v[168:171], v236
    v_bfe_u32 v236, s73, v233, 4
    v_mfma_f32_16x16x32_bf16 v[196:199], a[216:219], v[180:183], 0
    v_mad_u32_u24 v236, v236, s40, v231
    v_fma_f32 v174, v174, s37, -v250
    v_mfma_f32_16x16x32_bf16 v[184:187], v[74:77], v[180:183], 0
    v_fma_f32 v175, v175, s37, -v250
    v_fma_f32 v144, v144, s37, -v250
    v_mfma_f32_16x16x32_bf16 v[188:191], v[96:99], v[180:183], 0
    v_exp_f32 v172, v172
    v_mfma_f32_16x16x32_bf16 v[192:195], v[118:121], v[180:183], 0
    v_exp_f32 v173, v173
    v_mfma_f32_16x16x16_bf16 v[164:167], v[40:41], v[142:143], v[164:167]
    s_waitcnt lgkmcnt(5)
    v_exp_f32 v174, v174
    v_mfma_f32_16x16x32_bf16 v[220:223], a[228:231], a[248:251], v[220:223]
    ds_read_b64_tr_b16 a[248:249], v241 offset:9216
    ds_read_b64_tr_b16 a[250:251], v241 offset:10752
    v_mfma_f32_16x16x32_bf16 v[208:211], a[228:231], a[252:255], v[208:211]
    ds_read_b128 a[252:255], v239 offset:4096
    ds_read_b64_tr_b16 a[228:229], v240 offset:12296
    v_mfma_f32_16x16x32_bf16 v[212:215], a[240:243], a[232:235], v[212:215]
    s_waitcnt lgkmcnt(7)
    ds_read_b64_tr_b16 a[230:231], v240 offset:16904
    ds_read_b128 a[240:243], v239 offset:11264
    v_mfma_f32_16x16x32_bf16 v[216:219], a[244:247], a[232:235], v[216:219]
    s_waitcnt lgkmcnt(6)
    v_exp_f32 v175, v175
    v_mfma_f32_16x16x32_bf16 v[168:171], v[42:45], v[138:141], v[168:171]
    v_cvt_pk_bf16_f32 v176, v172, v173
    v_cvt_pk_bf16_f32 v177, v174, v175
    v_mfma_f32_16x16x32_bf16 v[204:207], a[244:247], a[236:239], v[204:207]
    ds_read_b64_tr_b16 a[244:245], v240 offset:13824
    ds_read_b64_tr_b16 a[246:247], v240 offset:15360
    v_mfma_f32_16x16x32_bf16 v[200:203], a[224:227], a[220:223], v[200:203]
    ds_read_b128 v[172:175], v234
    v_bfe_u32 v234, s74, v233, 4
    v_mfma_f32_16x16x16_bf16 v[168:171], v[46:47], v[142:143], v[168:171]
    s_waitcnt lgkmcnt(7)
    v_mad_u32_u24 v234, v234, s40, v231
    v_fma_f32 v145, v145, s37, -v250
    v_fma_f32 v146, v146, s37, -v250
    v_fma_f32 v147, v147, s37, -v250
    v_exp_f32 v144, v144
    v_exp_f32 v145, v145
    v_exp_f32 v146, v146
    v_mfma_f32_16x16x32_bf16 v[220:223], a[248:251], a[232:235], v[220:223]
    ds_read_b64_tr_b16 a[232:233], v241 offset:12288
    ds_read_b64_tr_b16 a[234:235], v241 offset:16896
    v_mfma_f32_16x16x32_bf16 v[208:211], a[248:251], a[236:239], v[208:211]
    s_waitcnt lgkmcnt(8)
    ds_read_b128 a[236:239], v239 offset:5120
    ds_read_b64_tr_b16 a[248:249], v240 offset:13832
    v_mfma_f32_16x16x32_bf16 v[212:215], a[224:227], a[252:255], v[212:215]
    s_waitcnt lgkmcnt(8)
    ds_read_b64_tr_b16 a[250:251], v240 offset:15368
    ds_read_b128 a[224:227], v224 offset:31040
    v_mfma_f32_16x16x32_bf16 v[216:219], a[228:231], a[252:255], v[216:219]
    v_exp_f32 v147, v147
    v_mfma_f32_16x16x32_bf16 v[204:207], a[228:231], a[220:223], v[204:207]
    s_waitcnt lgkmcnt(7)
    ds_read_b128 a[228:231], v224 offset:31104
    v_cvt_pk_bf16_f32 v178, v144, v145
    v_mfma_f32_16x16x32_bf16 v[200:203], a[244:247], a[240:243], v[200:203]
    s_waitcnt lgkmcnt(7)
    v_cvt_pk_bf16_f32 v179, v146, v147
    v_fma_f32 v148, v148, s37, -v250
    v_mfma_f32_16x16x32_bf16 v[172:175], v[24:27], v[138:141], v[172:175]
    ds_read_b128 v[144:147], v235
    v_bfe_u32 v235, s71, v232, 4
    v_mfma_f32_16x16x32_bf16 v[196:199], a[216:219], v[176:179], v[196:199]
    v_fma_f32 v149, v149, s37, -v250
    v_fma_f32 v150, v150, s37, -v250
    v_mfma_f32_16x16x32_bf16 v[184:187], v[78:81], v[176:179], v[184:187]
    v_cvt_pk_bf16_f32 v200, v200, v201
    v_cvt_pk_bf16_f32 v201, v202, v203
    v_mfma_f32_16x16x32_bf16 v[188:191], v[100:103], v[176:179], v[188:191]
    v_fma_f32 v151, v151, s37, -v250
    v_fma_f32 v152, v152, s37, -v250
    v_mfma_f32_16x16x32_bf16 v[192:195], v[122:125], v[176:179], v[192:195]
    v_exp_f32 v148, v148
    v_mfma_f32_16x16x16_bf16 v[172:175], v[28:29], v[142:143], v[172:175]
    s_waitcnt lgkmcnt(6)
    v_exp_f32 v149, v149
    v_mfma_f32_16x16x32_bf16 v[220:223], a[232:235], a[252:255], v[220:223]
    ds_read_b64_tr_b16 a[252:253], v241 offset:13824
    ds_read_b64_tr_b16 a[254:255], v241 offset:15360
    v_mfma_f32_16x16x32_bf16 v[208:211], a[232:235], a[220:223], v[208:211]
    s_waitcnt lgkmcnt(4)
    ds_read_b128 a[220:223], v224 offset:30976
    ds_read_b128 a[232:235], v224 offset:31168
    v_mfma_f32_16x16x32_bf16 v[212:215], a[244:247], a[236:239], v[212:215]
    ds_read_b128 a[244:247], v224 offset:34048
    v_cvt_pk_bf16_f32 v180, v148, v149
    v_mfma_f32_16x16x32_bf16 v[216:219], a[248:251], a[236:239], v[216:219]
    s_waitcnt lgkmcnt(5)
    v_exp_f32 v150, v150
    v_mfma_f32_16x16x32_bf16 v[144:147], v[30:33], v[138:141], v[144:147]
    v_exp_f32 v151, v151
    v_mfma_f32_16x16x32_bf16 v[204:207], a[248:251], a[240:243], v[204:207]
    ds_read_b128 a[248:251], v224 offset:34112
    v_cvt_pk_bf16_f32 v212, v212, v213
    v_cvt_pk_bf16_f32 v213, v214, v215
    v_cvt_pk_bf16_f32 v181, v150, v151
    v_mfma_f32_16x16x16_bf16 v[144:147], v[34:35], v[142:143], v[144:147]
    s_waitcnt lgkmcnt(4)
    v_cvt_pk_bf16_f32 v214, v216, v217
    v_cvt_pk_bf16_f32 v215, v218, v219
    buffer_store_dwordx4 v[212:215], v242, s[20:23], s58 offen sc0 sc1
    v_cvt_pk_bf16_f32 v202, v204, v205
    v_cvt_pk_bf16_f32 v203, v206, v207
    v_mfma_f32_16x16x32_bf16 v[220:223], a[252:255], a[236:239], v[220:223]
    s_waitcnt lgkmcnt(3)
    buffer_store_dwordx4 v[200:203], v244, s[20:23], s59 offen sc0 sc1
    v_mfma_f32_16x16x32_bf16 v[208:211], a[252:255], a[240:243], v[208:211]
    s_barrier
    ds_read_b128 v[148:151], v236
    ds_read_b128 a[236:239], v224 offset:31232
    v_mfma_f32_16x16x32_bf16 v[212:215], a[0:3], a[220:223], 0
    ds_read_b128 a[240:243], v224 offset:31296
    ds_read_b128 a[252:255], v224 offset:34176
    v_mfma_f32_16x16x32_bf16 v[216:219], a[4:7], a[220:223], 0
    v_cvt_pk_bf16_f32 v220, v220, v221
    v_cvt_pk_bf16_f32 v221, v222, v223
    v_mfma_f32_16x16x32_bf16 v[200:203], a[220:223], a[72:75], 0
    buffer_store_dwordx2 v[220:221], v243, s[20:23], s58 offen sc0 sc1
    v_mfma_f32_16x16x32_bf16 v[220:223], a[8:11], a[220:223], 0
    v_cvt_pk_bf16_f32 v208, v208, v209
    v_cvt_pk_bf16_f32 v209, v210, v211
    v_mfma_f32_16x16x32_bf16 v[204:207], a[220:223], a[76:79], 0
    buffer_store_dwordx2 v[208:209], v245, s[20:23], s59 offen sc0 sc1
    v_mfma_f32_16x16x32_bf16 v[208:211], a[220:223], a[80:83], 0
    ds_read_b128 a[220:223], v224 offset:34240
    v_mad_u32_u24 v236, v235, s40, v229
    v_mfma_f32_16x16x32_bf16 v[212:215], a[12:15], a[224:227], v[212:215]
    v_mad_u32_u24 v235, v235, s40, v228
    v_fma_f32 v153, v153, s37, -v250
    v_mfma_f32_16x16x32_bf16 v[216:219], a[16:19], a[224:227], v[216:219]
    s_waitcnt lgkmcnt(4)
    v_fma_f32 v154, v154, s37, -v250
    v_fma_f32 v155, v155, s37, -v250
    v_mfma_f32_16x16x32_bf16 v[148:151], v[54:57], v[138:141], v[148:151]
    v_exp_f32 v152, v152
    v_mfma_f32_16x16x32_bf16 v[220:223], a[20:23], a[224:227], v[220:223]
    v_exp_f32 v153, v153
    v_mfma_f32_16x16x32_bf16 v[200:203], a[224:227], a[84:87], v[200:203]
    v_exp_f32 v154, v154
    v_mfma_f32_16x16x32_bf16 v[204:207], a[224:227], a[88:91], v[204:207]
    v_exp_f32 v155, v155
    v_mfma_f32_16x16x16_bf16 v[148:151], v[58:59], v[142:143], v[148:151]
    v_cvt_pk_bf16_f32 v182, v152, v153
    v_cvt_pk_bf16_f32 v183, v154, v155
    v_mfma_f32_16x16x32_bf16 v[208:211], a[224:227], a[92:95], v[208:211]
    ds_read_b128 v[152:155], v234
    ds_read_b128 a[224:227], v224 offset:34304
    v_mfma_f32_16x16x32_bf16 v[196:199], a[216:219], v[180:183], v[196:199]
    v_bfe_u32 v234, s67, v232, 4
    v_fma_f32 v156, v156, s37, -v250
    v_mfma_f32_16x16x32_bf16 v[184:187], v[66:69], v[180:183], v[184:187]
    v_fma_f32 v157, v157, s37, -v250
    v_fma_f32 v158, v158, s37, -v250
    v_mfma_f32_16x16x32_bf16 v[188:191], v[88:91], v[180:183], v[188:191]
    v_fma_f32 v159, v159, s37, -v250
    v_fma_f32 v160, v160, s37, -v250
    v_mfma_f32_16x16x32_bf16 v[192:195], v[110:113], v[180:183], v[192:195]
    v_exp_f32 v156, v156
    v_mfma_f32_16x16x32_bf16 v[212:215], a[24:27], a[228:231], v[212:215]
    v_exp_f32 v157, v157
    v_mfma_f32_16x16x32_bf16 v[216:219], a[28:31], a[228:231], v[216:219]
    v_exp_f32 v158, v158
    v_mfma_f32_16x16x32_bf16 v[220:223], a[32:35], a[228:231], v[220:223]
    v_exp_f32 v159, v159
    v_mfma_f32_16x16x32_bf16 v[200:203], a[228:231], a[96:99], v[200:203]
    v_cvt_pk_bf16_f32 v176, v156, v157
    v_cvt_pk_bf16_f32 v177, v158, v159
    v_mfma_f32_16x16x32_bf16 v[204:207], a[228:231], a[100:103], v[204:207]
    s_waitcnt lgkmcnt(1)
    ds_read_b128 v[156:159], v236
    v_bfe_u32 v236, s62, v232, 4
    v_mfma_f32_16x16x32_bf16 v[152:155], v[60:63], v[138:141], v[152:155]
    v_fma_f32 v161, v161, s37, -v250
    v_fma_f32 v162, v162, s37, -v250
    v_mfma_f32_16x16x32_bf16 v[208:211], a[228:231], a[104:107], v[208:211]
    ds_read_b128 a[228:231], v224 offset:34368
    v_fma_f32 v163, v163, s37, -v250
    v_mfma_f32_16x16x32_bf16 v[212:215], a[36:39], a[232:235], v[212:215]
    v_exp_f32 v160, v160
    v_mfma_f32_16x16x16_bf16 v[152:155], v[64:65], v[142:143], v[152:155]
    v_exp_f32 v161, v161
    v_mfma_f32_16x16x32_bf16 v[216:219], a[40:43], a[232:235], v[216:219]
    v_exp_f32 v162, v162
    v_mfma_f32_16x16x32_bf16 v[220:223], a[44:47], a[232:235], v[220:223]
    v_exp_f32 v163, v163
    v_mfma_f32_16x16x32_bf16 v[200:203], a[232:235], a[108:111], v[200:203]
    v_cvt_pk_bf16_f32 v178, v160, v161
    v_cvt_pk_bf16_f32 v179, v162, v163
    v_mfma_f32_16x16x32_bf16 v[204:207], a[232:235], a[112:115], v[204:207]
    ds_read_b128 v[160:163], v235
    v_mad_u32_u24 v235, v234, s40, v228
    v_mfma_f32_16x16x32_bf16 v[196:199], a[216:219], v[176:179], v[196:199]
    v_mad_u32_u24 v234, v234, s40, v229
    v_max3_f32 v248, v164, v165, v166
    v_mfma_f32_16x16x32_bf16 v[184:187], v[70:73], v[176:179], v[184:187]
    v_max3_f32 v249, v167, v168, v169
    v_max3_f32 v248, v248, v170, v171
    v_mfma_f32_16x16x32_bf16 v[188:191], v[92:95], v[176:179], v[188:191]
    v_max3_f32 v249, v249, v172, v173
    v_max3_f32 v248, v248, v174, v175
    v_mfma_f32_16x16x32_bf16 v[192:195], v[114:117], v[176:179], v[192:195]
    s_waitcnt lgkmcnt(2)
    v_rcp_f32 v197, v196
    v_mfma_f32_16x16x32_bf16 v[156:159], v[42:45], v[132:135], v[156:159]
    v_mul_f32 v184, v184, v197
    v_mul_f32 v185, v185, v197
    v_mfma_f32_16x16x32_bf16 v[208:211], a[232:235], a[116:119], v[208:211]
    v_cvt_pk_bf16_f32 v184, v184, v185
    v_mul_f32 v186, v186, v197
    v_mfma_f32_16x16x32_bf16 v[212:215], a[48:51], a[236:239], v[212:215]
    v_mul_f32 v187, v187, v197
    v_cvt_pk_bf16_f32 v185, v186, v187
    v_mfma_f32_16x16x16_bf16 v[156:159], v[46:47], v[136:137], v[156:159]
    v_mul_f32 v188, v188, v197
    v_mul_f32 v189, v189, v197
    v_mfma_f32_16x16x32_bf16 v[216:219], a[52:55], a[236:239], v[216:219]
    s_waitcnt lgkmcnt(0)
    v_cvt_pk_bf16_f32 v186, v188, v189
    v_mul_f32 v190, v190, v197
    v_mfma_f32_16x16x32_bf16 v[160:163], v[18:21], v[132:135], v[160:163]
    v_mul_f32 v191, v191, v197
    v_cvt_pk_bf16_f32 v187, v190, v191
    v_mfma_f32_16x16x32_bf16 v[220:223], a[56:59], a[236:239], v[220:223]
    v_mul_f32 v192, v192, v197
    v_mul_f32 v193, v193, v197
    v_mfma_f32_16x16x32_bf16 v[200:203], a[236:239], a[120:123], v[200:203]
    v_cvt_pk_bf16_f32 v188, v192, v193
    v_mul_f32 v194, v194, v197
    v_mfma_f32_16x16x16_bf16 v[160:163], v[22:23], v[136:137], v[160:163]
    ds_read_b128 a[232:235], v225 offset:10816
    v_mul_f32 v195, v195, v197
    v_mfma_f32_16x16x32_bf16 v[204:207], a[236:239], a[124:127], v[204:207]
    v_cvt_pk_bf16_f32 v189, v194, v195
    v_max3_f32 v249, v249, v144, v145
    v_mfma_f32_16x16x32_bf16 v[208:211], a[236:239], a[128:131], v[208:211]
    ds_write_b128 v237, v[184:187]
    v_mfma_f32_16x16x32_bf16 v[212:215], a[60:63], a[240:243], v[212:215]
    ds_write_b64 v238, v[188:189]
    v_mfma_f32_16x16x32_bf16 v[216:219], a[64:67], a[240:243], v[216:219]
    ds_read_b128 a[236:239], v225 offset:10880
    v_max3_f32 v248, v248, v146, v147
    v_mfma_f32_16x16x32_bf16 v[220:223], a[68:71], a[240:243], v[220:223]
    v_max3_f32 v249, v249, v148, v149
    v_max3_f32 v248, v248, v150, v151
    v_mfma_f32_16x16x32_bf16 v[200:203], a[240:243], a[132:135], v[200:203]
    v_cvt_pk_bf16_f32 v12, v212, v213
    v_cvt_pk_bf16_f32 v13, v214, v215
    v_mfma_f32_16x16x32_bf16 v[204:207], a[240:243], a[136:139], v[204:207]
    v_cvt_pk_bf16_f32 v14, v216, v217
    v_cvt_pk_bf16_f32 v15, v218, v219
    v_mfma_f32_16x16x32_bf16 v[208:211], a[240:243], a[140:143], v[208:211]
    v_cvt_pk_bf16_f32 v16, v220, v221
    v_cvt_pk_bf16_f32 v17, v222, v223
    v_mfma_f32_16x16x32_bf16 v[212:215], a[0:3], a[244:247], 0
    v_cvt_pk_bf16_f32 v74, v200, v201
    v_cvt_pk_bf16_f32 v75, v202, v203
    v_mfma_f32_16x16x32_bf16 v[216:219], a[4:7], a[244:247], 0
    v_cvt_pk_bf16_f32 v96, v204, v205
    v_cvt_pk_bf16_f32 v97, v206, v207
    v_mfma_f32_16x16x32_bf16 v[220:223], a[8:11], a[244:247], 0
    v_cvt_pk_bf16_f32 v118, v208, v209
    v_cvt_pk_bf16_f32 v119, v210, v211
    v_mfma_f32_16x16x32_bf16 v[200:203], a[244:247], a[72:75], 0
    ds_read_b128 a[240:243], v225 offset:10944
    v_max3_f32 v249, v249, v152, v153
    v_mfma_f32_16x16x32_bf16 v[204:207], a[244:247], a[76:79], 0
    v_max3_f32 v248, v248, v154, v155
    v_max_f32 v248, v248, v249
    v_mfma_f32_16x16x32_bf16 v[208:211], a[244:247], a[80:83], 0
    ds_read_b128 a[244:247], v225 offset:11008
    v_mov_b32 v249, v248
    v_mfma_f32_16x16x32_bf16 v[212:215], a[12:15], a[248:251], v[212:215]
    v_mfma_f32_16x16x32_bf16 v[216:219], a[16:19], a[248:251], v[216:219]
    v_permlane16_swap_b32 v248, v249
    v_mfma_f32_16x16x32_bf16 v[220:223], a[20:23], a[248:251], v[220:223]
    v_max_f32 v248, v248, v249
    v_mov_b32 v249, v248
    v_mfma_f32_16x16x32_bf16 v[200:203], a[248:251], a[84:87], v[200:203]
    v_mfma_f32_16x16x32_bf16 v[204:207], a[248:251], a[88:91], v[204:207]
    v_permlane32_swap_b32 v248, v249
    v_mfma_f32_16x16x32_bf16 v[208:211], a[248:251], a[92:95], v[208:211]
    ds_read_b128 a[248:251], v225 offset:11072
    v_max_f32 v248, v248, v249
    v_mfma_f32_16x16x32_bf16 v[212:215], a[24:27], a[252:255], v[212:215]
    v_mul_f32 v250, s37, v248
    v_fma_f32 v164, v164, s37, -v250
    v_mfma_f32_16x16x32_bf16 v[216:219], a[28:31], a[252:255], v[216:219]
    v_fma_f32 v165, v165, s37, -v250
    v_fma_f32 v166, v166, s37, -v250
    v_mfma_f32_16x16x32_bf16 v[220:223], a[32:35], a[252:255], v[220:223]
    v_fma_f32 v167, v167, s37, -v250
    v_fma_f32 v168, v168, s37, -v250
    v_mfma_f32_16x16x32_bf16 v[200:203], a[252:255], a[96:99], v[200:203]
    v_exp_f32 v164, v164
    v_mfma_f32_16x16x32_bf16 v[204:207], a[252:255], a[100:103], v[204:207]
    v_exp_f32 v165, v165
    v_mfma_f32_16x16x32_bf16 v[208:211], a[252:255], a[104:107], v[208:211]
    ds_read_b128 a[252:255], v225 offset:11136
    v_cvt_pk_bf16_f32 v180, v164, v165
    v_mfma_f32_16x16x32_bf16 v[212:215], a[36:39], a[220:223], v[212:215]
    v_exp_f32 v166, v166
    v_mfma_f32_16x16x32_bf16 v[216:219], a[40:43], a[220:223], v[216:219]
    v_exp_f32 v167, v167
    v_mfma_f32_16x16x32_bf16 v[220:223], a[44:47], a[220:223], v[220:223]
    v_cvt_pk_bf16_f32 v181, v166, v167
    v_fma_f32 v169, v169, s37, -v250
    v_mfma_f32_16x16x32_bf16 v[200:203], a[220:223], a[108:111], v[200:203]
    ds_read_b128 v[164:167], v235
    v_bfe_u32 v235, s72, v232, 4
    v_mfma_f32_16x16x32_bf16 v[204:207], a[220:223], a[112:115], v[204:207]
    v_fma_f32 v170, v170, s37, -v250
    v_fma_f32 v171, v171, s37, -v250
    v_mfma_f32_16x16x32_bf16 v[208:211], a[220:223], a[116:119], v[208:211]
    ds_read_b128 a[220:223], v225 offset:23232
    v_fma_f32 v172, v172, s37, -v250
    v_mfma_f32_16x16x32_bf16 v[212:215], a[48:51], a[224:227], v[212:215]
    v_exp_f32 v168, v168
    v_mfma_f32_16x16x32_bf16 v[216:219], a[52:55], a[224:227], v[216:219]
    v_exp_f32 v169, v169
    v_mfma_f32_16x16x32_bf16 v[220:223], a[56:59], a[224:227], v[220:223]
    v_exp_f32 v170, v170
    v_mfma_f32_16x16x32_bf16 v[200:203], a[224:227], a[120:123], v[200:203]
    v_exp_f32 v171, v171
    v_mfma_f32_16x16x32_bf16 v[204:207], a[224:227], a[124:127], v[204:207]
    v_cvt_pk_bf16_f32 v182, v168, v169
    v_cvt_pk_bf16_f32 v183, v170, v171
    v_mfma_f32_16x16x32_bf16 v[208:211], a[224:227], a[128:131], v[208:211]
    ds_read_b128 v[168:171], v234
    v_mad_u32_u24 v234, v236, s40, v229
    v_mfma_f32_16x16x32_bf16 v[196:199], a[216:219], v[180:183], 0
    ds_read_b128 a[224:227], v225 offset:23296
    v_mad_u32_u24 v236, v236, s40, v228
    v_mfma_f32_16x16x32_bf16 v[184:187], v[76:79], v[180:183], 0
    v_fma_f32 v173, v173, s37, -v250
    v_fma_f32 v174, v174, s37, -v250
    v_mfma_f32_16x16x32_bf16 v[188:191], v[98:101], v[180:183], 0
    v_fma_f32 v175, v175, s37, -v250
    v_fma_f32 v144, v144, s37, -v250
    v_mfma_f32_16x16x32_bf16 v[192:195], v[120:123], v[180:183], 0
    s_waitcnt lgkmcnt(3)
    v_exp_f32 v172, v172
    v_mfma_f32_16x16x32_bf16 v[164:167], v[0:3], v[132:135], v[164:167]
    v_exp_f32 v173, v173
    v_mfma_f32_16x16x32_bf16 v[212:215], a[60:63], a[228:231], v[212:215]
    v_exp_f32 v174, v174
    v_mfma_f32_16x16x32_bf16 v[216:219], a[64:67], a[228:231], v[216:219]
    v_exp_f32 v175, v175
    v_mfma_f32_16x16x32_bf16 v[220:223], a[68:71], a[228:231], v[220:223]
    v_cvt_pk_bf16_f32 v176, v172, v173
    v_cvt_pk_bf16_f32 v177, v174, v175
    v_mfma_f32_16x16x16_bf16 v[164:167], v[4:5], v[136:137], v[164:167]
    s_waitcnt lgkmcnt(1)
    ds_read_b128 v[172:175], v234
    v_cvt_pk_bf16_f32 v36, v212, v213
    v_mfma_f32_16x16x32_bf16 v[168:171], v[24:27], v[132:135], v[168:171]
    v_cvt_pk_bf16_f32 v37, v214, v215
    v_cvt_pk_bf16_f32 v38, v216, v217
    v_mfma_f32_16x16x32_bf16 v[200:203], a[228:231], a[132:135], v[200:203]
    v_cvt_pk_bf16_f32 v39, v218, v219
    v_cvt_pk_bf16_f32 v40, v220, v221
    v_mfma_f32_16x16x32_bf16 v[204:207], a[228:231], a[136:139], v[204:207]
    v_cvt_pk_bf16_f32 v41, v222, v223
    v_bfe_u32 v234, s72, v232, 4
    v_mfma_f32_16x16x16_bf16 v[168:171], v[28:29], v[136:137], v[168:171]
    v_mad_u32_u24 v234, v234, s40, v230
    v_fma_f32 v145, v145, s37, -v250
    v_mfma_f32_16x16x32_bf16 v[208:211], a[228:231], a[140:143], v[208:211]
    v_cvt_pk_bf16_f32 v76, v200, v201
    v_cvt_pk_bf16_f32 v77, v202, v203
    v_mfma_f32_16x16x32_bf16 v[212:215], a[144:147], a[232:235], 0
    v_cvt_pk_bf16_f32 v98, v204, v205
    v_cvt_pk_bf16_f32 v99, v206, v207
    v_mfma_f32_16x16x32_bf16 v[216:219], a[148:151], a[232:235], 0
    ds_read_b128 a[228:231], v225 offset:23360
    v_fma_f32 v146, v146, s37, -v250
    v_mfma_f32_16x16x32_bf16 v[220:223], a[152:155], a[232:235], 0
    v_cvt_pk_bf16_f32 v120, v208, v209
    v_cvt_pk_bf16_f32 v121, v210, v211
    v_mfma_f32_16x16x32_bf16 v[212:215], a[156:159], a[236:239], v[212:215]
    s_waitcnt lgkmcnt(1)
    ds_read_b128 a[232:235], v225 offset:23424
    v_fma_f32 v147, v147, s37, -v250
    v_mfma_f32_16x16x32_bf16 v[172:175], v[30:33], v[132:135], v[172:175]
    v_exp_f32 v144, v144
    v_mfma_f32_16x16x32_bf16 v[216:219], a[160:163], a[236:239], v[216:219]
    v_exp_f32 v145, v145
    v_mfma_f32_16x16x32_bf16 v[220:223], a[164:167], a[236:239], v[220:223]
    ds_read_b128 a[236:239], v225 offset:23488
    v_cvt_pk_bf16_f32 v178, v144, v145
    v_mfma_f32_16x16x16_bf16 v[172:175], v[34:35], v[136:137], v[172:175]
    v_exp_f32 v146, v146
    v_mfma_f32_16x16x32_bf16 v[212:215], a[168:171], a[240:243], v[212:215]
    v_exp_f32 v147, v147
    v_mfma_f32_16x16x32_bf16 v[216:219], a[172:175], a[240:243], v[216:219]
    v_cvt_pk_bf16_f32 v179, v146, v147
    v_fma_f32 v148, v148, s37, -v250
    v_mfma_f32_16x16x32_bf16 v[220:223], a[176:179], a[240:243], v[220:223]
    ds_read_b128 v[144:147], v236
    v_mad_u32_u24 v236, v235, s40, v228
    v_mfma_f32_16x16x32_bf16 v[196:199], a[216:219], v[176:179], v[196:199]
    ds_read_b128 a[240:243], v225 offset:23552
    v_mad_u32_u24 v235, v235, s40, v229
    v_mfma_f32_16x16x32_bf16 v[184:187], v[68:71], v[176:179], v[184:187]
    v_fma_f32 v149, v149, s37, -v250
    v_fma_f32 v150, v150, s37, -v250
    v_mfma_f32_16x16x32_bf16 v[188:191], v[90:93], v[176:179], v[188:191]
    v_fma_f32 v151, v151, s37, -v250
    v_fma_f32 v152, v152, s37, -v250
    v_mfma_f32_16x16x32_bf16 v[192:195], v[112:115], v[176:179], v[192:195]
    v_exp_f32 v148, v148
    v_mfma_f32_16x16x32_bf16 v[212:215], a[180:183], a[244:247], v[212:215]
    v_exp_f32 v149, v149
    v_mfma_f32_16x16x32_bf16 v[216:219], a[184:187], a[244:247], v[216:219]
    v_exp_f32 v150, v150
    v_mfma_f32_16x16x32_bf16 v[220:223], a[188:191], a[244:247], v[220:223]
    v_exp_f32 v151, v151
    v_mfma_f32_16x16x32_bf16 v[212:215], a[192:195], a[248:251], v[212:215]
    v_cvt_pk_bf16_f32 v180, v148, v149
    v_cvt_pk_bf16_f32 v181, v150, v151
    v_mfma_f32_16x16x32_bf16 v[216:219], a[196:199], a[248:251], v[216:219]
    s_waitcnt lgkmcnt(1)
    ds_read_b128 v[148:151], v236
    v_bfe_u32 v236, s67, v232, 4
    v_mfma_f32_16x16x32_bf16 v[144:147], v[6:9], v[132:135], v[144:147]
    v_mad_u32_u24 v236, v236, s40, v230
    v_fma_f32 v153, v153, s37, -v250
    v_mfma_f32_16x16x32_bf16 v[220:223], a[200:203], a[248:251], v[220:223]
    v_fma_f32 v154, v154, s37, -v250
    v_fma_f32 v155, v155, s37, -v250
    v_mfma_f32_16x16x32_bf16 v[212:215], a[204:207], a[252:255], v[212:215]
    v_exp_f32 v152, v152
    v_mfma_f32_16x16x16_bf16 v[144:147], v[10:11], v[136:137], v[144:147]
    v_exp_f32 v153, v153
    v_mfma_f32_16x16x32_bf16 v[216:219], a[208:211], a[252:255], v[216:219]
    v_exp_f32 v154, v154
    v_mfma_f32_16x16x32_bf16 v[220:223], a[212:215], a[252:255], v[220:223]
    v_exp_f32 v155, v155
    v_mfma_f32_16x16x32_bf16 v[200:203], a[144:147], a[220:223], 0
    v_cvt_pk_bf16_f32 v138, v212, v213
    v_cvt_pk_bf16_f32 v139, v214, v215
    v_mfma_f32_16x16x32_bf16 v[204:207], a[148:151], a[220:223], 0
    v_cvt_pk_bf16_f32 v182, v152, v153
    v_cvt_pk_bf16_f32 v140, v216, v217
    v_mfma_f32_16x16x32_bf16 v[208:211], a[152:155], a[220:223], 0
    s_waitcnt lgkmcnt(0)
    v_cvt_pk_bf16_f32 v141, v218, v219
    v_cvt_pk_bf16_f32 v142, v220, v221
    v_mfma_f32_16x16x32_bf16 v[148:151], v[12:15], v[132:135], v[148:151]
    v_cvt_pk_bf16_f32 v143, v222, v223
    v_cvt_pk_bf16_f32 v183, v154, v155
    v_mfma_f32_16x16x32_bf16 v[200:203], a[156:159], a[224:227], v[200:203]
    ds_read_b128 v[152:155], v235
    v_bfe_u32 v235, s71, v232, 4
    v_mfma_f32_16x16x32_bf16 v[196:199], a[216:219], v[180:183], v[196:199]
    v_mad_u32_u24 v235, v235, s40, v230
    v_max3_f32 v248, v156, v157, v158
    v_mfma_f32_16x16x32_bf16 v[184:187], v[84:87], v[180:183], v[184:187]
    v_max3_f32 v249, v159, v160, v161
    v_max3_f32 v248, v248, v162, v163
    v_mfma_f32_16x16x32_bf16 v[188:191], v[106:109], v[180:183], v[188:191]
    v_max3_f32 v249, v249, v164, v165
    v_max3_f32 v248, v248, v166, v167
    v_mfma_f32_16x16x32_bf16 v[192:195], v[128:131], v[180:183], v[192:195]
    v_rcp_f32 v197, v196
    v_mfma_f32_16x16x16_bf16 v[148:151], v[16:17], v[136:137], v[148:151]
    v_mul_f32 v184, v184, v197
    v_mul_f32 v185, v185, v197
    v_mfma_f32_16x16x32_bf16 v[204:207], a[160:163], a[224:227], v[204:207]
    v_cvt_pk_bf16_f32 v184, v184, v185
    v_mul_f32 v186, v186, v197
    v_mfma_f32_16x16x32_bf16 v[208:211], a[164:167], a[224:227], v[208:211]
    v_mul_f32 v187, v187, v197
    v_cvt_pk_bf16_f32 v185, v186, v187
    v_mfma_f32_16x16x32_bf16 v[200:203], a[168:171], a[228:231], v[200:203]
    v_mul_f32 v188, v188, v197
    v_mul_f32 v189, v189, v197
    v_mfma_f32_16x16x32_bf16 v[204:207], a[172:175], a[228:231], v[204:207]
    s_waitcnt lgkmcnt(0)
    v_cvt_pk_bf16_f32 v186, v188, v189
    v_mul_f32 v190, v190, v197
    v_mfma_f32_16x16x32_bf16 v[152:155], v[36:39], v[132:135], v[152:155]
    v_mul_f32 v191, v191, v197
    v_cvt_pk_bf16_f32 v187, v190, v191
    v_mfma_f32_16x16x32_bf16 v[208:211], a[176:179], a[228:231], v[208:211]
    v_mul_f32 v192, v192, v197
    v_mul_f32 v193, v193, v197
    v_mfma_f32_16x16x32_bf16 v[200:203], a[180:183], a[232:235], v[200:203]
    v_cvt_pk_bf16_f32 v188, v192, v193
    v_mul_f32 v194, v194, v197
    v_mfma_f32_16x16x16_bf16 v[152:155], v[40:41], v[136:137], v[152:155]
    v_mul_f32 v195, v195, v197
    v_cvt_pk_bf16_f32 v189, v194, v195
    v_mfma_f32_16x16x32_bf16 v[204:207], a[184:187], a[232:235], v[204:207]
    ds_write_b128 v237, v[184:187] offset:6144
    v_mfma_f32_16x16x32_bf16 v[208:211], a[188:191], a[232:235], v[208:211]
    ds_write_b64 v238, v[188:189] offset:6144
    v_mfma_f32_16x16x32_bf16 v[200:203], a[192:195], a[236:239], v[200:203]
    v_max3_f32 v249, v249, v168, v169
    v_max3_f32 v248, v248, v170, v171
    v_mfma_f32_16x16x32_bf16 v[204:207], a[196:199], a[236:239], v[204:207]
    v_max3_f32 v249, v249, v172, v173
    v_max3_f32 v248, v248, v174, v175
    v_mfma_f32_16x16x32_bf16 v[208:211], a[200:203], a[236:239], v[208:211]
    v_max3_f32 v249, v249, v144, v145
    v_max3_f32 v248, v248, v146, v147
    v_mfma_f32_16x16x32_bf16 v[200:203], a[204:207], a[240:243], v[200:203]
    v_max3_f32 v249, v249, v148, v149
    v_max3_f32 v248, v248, v150, v151
    v_mfma_f32_16x16x32_bf16 v[204:207], a[208:211], a[240:243], v[204:207]
    v_max3_f32 v249, v249, v152, v153
    v_max3_f32 v248, v248, v154, v155
    v_mfma_f32_16x16x32_bf16 v[208:211], a[212:215], a[240:243], v[208:211]
    s_waitcnt vmcnt(4) lgkmcnt(0)
    ds_read_b64_tr_b16 a[240:241], v240
    ds_read_b64_tr_b16 a[242:243], v240 offset:1536
    v_cvt_pk_bf16_f32 v132, v200, v201
    v_cvt_pk_bf16_f32 v133, v202, v203
    v_max_f32 v248, v248, v249
    v_cvt_pk_bf16_f32 v134, v204, v205
    v_cvt_pk_bf16_f32 v135, v206, v207
    v_mov_b32 v249, v248
    v_cvt_pk_bf16_f32 v136, v208, v209
    v_cvt_pk_bf16_f32 v137, v210, v211
    v_permlane16_swap_b32 v248, v249
    s_barrier
    buffer_load_dwordx4 v246, s[4:7], s56 offen lds
    s_add_u32 m0, s42, 0
    ds_read_b128 a[244:247], v227 offset:30976
    buffer_load_dwordx4 v247, s[4:7], s56 offen lds
    s_add_u32 m0, s41, 0x1e40
    ds_read_b128 a[248:251], v227 offset:31040
    buffer_load_dwordx4 v246, s[4:7], s46 offen lds
    s_add_u32 m0, s42, 0x1e40
    ds_read_b128 a[252:255], v227 offset:31104
    buffer_load_dwordx4 v247, s[4:7], s46 offen lds
    ds_read_b128 a[220:223], v227 offset:31168
    ds_read_b128 a[224:227], v227 offset:31232
    ds_read_b128 a[228:231], v227 offset:31296
    ds_read_b128 a[232:235], v239
    ds_read_b128 a[236:239], v239 offset:6144
    s_add_u32 s58, s51, 0xa8000
    s_add_u32 s59, s51, 0xa9800
    s_add_u32 m0, s41, 0x3c80
    v_max_f32 v248, v248, v249
    v_mov_b32 v249, v248
    s_nop 1
    v_permlane32_swap_b32 v248, v249
    v_max_f32 v248, v248, v249
    v_mul_f32 v250, s37, v248
    v_fma_f32 v156, v156, s37, -v250
    v_fma_f32 v157, v157, s37, -v250
    v_fma_f32 v158, v158, s37, -v250
    v_fma_f32 v159, v159, s37, -v250
    v_exp_f32 v156, v156
    v_exp_f32 v157, v157
    v_exp_f32 v158, v158
    s_waitcnt lgkmcnt(7)
    v_mfma_f32_16x16x32_bf16 v[212:215], a[0:3], a[244:247], 0
    v_exp_f32 v159, v159
    v_mfma_f32_16x16x32_bf16 v[216:219], a[4:7], a[244:247], 0
    v_cvt_pk_bf16_f32 v176, v156, v157
    v_cvt_pk_bf16_f32 v177, v158, v159
    v_mfma_f32_16x16x32_bf16 v[220:223], a[8:11], a[244:247], 0
    ds_read_b128 v[156:159], v234
    v_bfe_u32 v234, s62, v232, 4
    v_mfma_f32_16x16x32_bf16 v[200:203], a[244:247], a[72:75], 0
    v_mad_u32_u24 v234, v234, s40, v230
    v_fma_f32 v160, v160, s37, -v250
    v_mfma_f32_16x16x32_bf16 v[204:207], a[244:247], a[76:79], 0
    v_fma_f32 v161, v161, s37, -v250
    v_fma_f32 v162, v162, s37, -v250
    v_mfma_f32_16x16x32_bf16 v[208:211], a[244:247], a[80:83], 0
    s_waitcnt lgkmcnt(1)
    ds_read_b64_tr_b16 a[244:245], v240 offset:8
    ds_read_b64_tr_b16 a[246:247], v240 offset:1544
    v_mfma_f32_16x16x32_bf16 v[212:215], a[12:15], a[248:251], v[212:215]
    v_fma_f32 v163, v163, s37, -v250
    v_fma_f32 v164, v164, s37, -v250
    v_mfma_f32_16x16x32_bf16 v[216:219], a[16:19], a[248:251], v[216:219]
    v_exp_f32 v160, v160
    v_mfma_f32_16x16x32_bf16 v[220:223], a[20:23], a[248:251], v[220:223]
    v_exp_f32 v161, v161
    v_mfma_f32_16x16x32_bf16 v[200:203], a[248:251], a[84:87], v[200:203]
    v_exp_f32 v162, v162
    v_mfma_f32_16x16x32_bf16 v[204:207], a[248:251], a[88:91], v[204:207]
    v_exp_f32 v163, v163
    v_mfma_f32_16x16x32_bf16 v[208:211], a[248:251], a[92:95], v[208:211]
    s_waitcnt lgkmcnt(2)
    ds_read_b64_tr_b16 a[248:249], v241
    ds_read_b64_tr_b16 a[250:251], v241 offset:1536
    v_mfma_f32_16x16x32_bf16 v[156:159], v[36:39], v[138:141], v[156:159]
    v_cvt_pk_bf16_f32 v178, v160, v161
    v_cvt_pk_bf16_f32 v179, v162, v163
    v_mfma_f32_16x16x32_bf16 v[212:215], a[24:27], a[252:255], v[212:215]
    ds_read_b128 v[160:163], v235
    v_bfe_u32 v235, s75, v233, 4
    v_mfma_f32_16x16x32_bf16 v[196:199], a[216:219], v[176:179], 0
    v_mad_u32_u24 v235, v235, s40, v231
    v_fma_f32 v165, v165, s37, -v250
    v_mfma_f32_16x16x32_bf16 v[184:187], v[78:81], v[176:179], 0
    v_fma_f32 v166, v166, s37, -v250
    v_fma_f32 v167, v167, s37, -v250
    v_mfma_f32_16x16x32_bf16 v[188:191], v[100:103], v[176:179], 0
    v_exp_f32 v164, v164
    v_mfma_f32_16x16x32_bf16 v[192:195], v[122:125], v[176:179], 0
    v_exp_f32 v165, v165
    v_mfma_f32_16x16x16_bf16 v[156:159], v[40:41], v[142:143], v[156:159]
    v_exp_f32 v166, v166
    v_mfma_f32_16x16x32_bf16 v[216:219], a[28:31], a[252:255], v[216:219]
    v_exp_f32 v167, v167
    v_mfma_f32_16x16x32_bf16 v[220:223], a[32:35], a[252:255], v[220:223]
    v_cvt_pk_bf16_f32 v180, v164, v165
    v_cvt_pk_bf16_f32 v181, v166, v167
    v_mfma_f32_16x16x32_bf16 v[200:203], a[252:255], a[96:99], v[200:203]
    ds_read_b128 v[164:167], v236
    v_bfe_u32 v236, s69, v233, 4
    v_mfma_f32_16x16x32_bf16 v[204:207], a[252:255], a[100:103], v[204:207]
    s_waitcnt lgkmcnt(1)
    v_mad_u32_u24 v236, v236, s40, v231
    v_fma_f32 v168, v168, s37, -v250
    v_mfma_f32_16x16x32_bf16 v[160:163], v[42:45], v[138:141], v[160:163]
    v_fma_f32 v169, v169, s37, -v250
    v_fma_f32 v170, v170, s37, -v250
    v_mfma_f32_16x16x32_bf16 v[208:211], a[252:255], a[104:107], v[208:211]
    ds_read_b128 a[252:255], v239 offset:1024
    v_fma_f32 v171, v171, s37, -v250
    v_mfma_f32_16x16x32_bf16 v[212:215], a[36:39], a[220:223], v[212:215]
    v_exp_f32 v168, v168
    v_mfma_f32_16x16x16_bf16 v[160:163], v[46:47], v[142:143], v[160:163]
    v_exp_f32 v169, v169
    v_mfma_f32_16x16x32_bf16 v[216:219], a[40:43], a[220:223], v[216:219]
    v_exp_f32 v170, v170
    v_mfma_f32_16x16x32_bf16 v[220:223], a[44:47], a[220:223], v[220:223]
    v_exp_f32 v171, v171
    v_mfma_f32_16x16x32_bf16 v[200:203], a[220:223], a[108:111], v[200:203]
    v_cvt_pk_bf16_f32 v182, v168, v169
    v_cvt_pk_bf16_f32 v183, v170, v171
    v_mfma_f32_16x16x32_bf16 v[204:207], a[220:223], a[112:115], v[204:207]
    ds_read_b128 v[168:171], v234
    v_bfe_u32 v234, s76, v233, 4
    v_mfma_f32_16x16x32_bf16 v[196:199], a[216:219], v[180:183], v[196:199]
    v_mad_u32_u24 v234, v234, s40, v231
    v_fma_f32 v172, v172, s37, -v250
    v_mfma_f32_16x16x32_bf16 v[184:187], v[66:69], v[180:183], v[184:187]
    v_fma_f32 v173, v173, s37, -v250
    v_fma_f32 v174, v174, s37, -v250
    v_mfma_f32_16x16x32_bf16 v[188:191], v[88:91], v[180:183], v[188:191]
    v_fma_f32 v175, v175, s37, -v250
    v_fma_f32 v144, v144, s37, -v250
    v_mfma_f32_16x16x32_bf16 v[192:195], v[110:113], v[180:183], v[192:195]
    s_waitcnt lgkmcnt(2)
    v_exp_f32 v172, v172
    v_mfma_f32_16x16x32_bf16 v[164:167], v[24:27], v[138:141], v[164:167]
    v_exp_f32 v173, v173
    v_mfma_f32_16x16x32_bf16 v[208:211], a[220:223], a[116:119], v[208:211]
    ds_read_b128 a[220:223], v239 offset:7168
    v_cvt_pk_bf16_f32 v176, v172, v173
    v_mfma_f32_16x16x32_bf16 v[212:215], a[48:51], a[224:227], v[212:215]
    v_exp_f32 v174, v174
    v_mfma_f32_16x16x16_bf16 v[164:167], v[28:29], v[142:143], v[164:167]
    v_exp_f32 v175, v175
    v_mfma_f32_16x16x32_bf16 v[216:219], a[52:55], a[224:227], v[216:219]
    s_waitcnt lgkmcnt(1)
    v_cvt_pk_bf16_f32 v177, v174, v175
    v_fma_f32 v145, v145, s37, -v250
    v_mfma_f32_16x16x32_bf16 v[168:171], v[30:33], v[138:141], v[168:171]
    ds_read_b128 v[172:175], v235
    v_bfe_u32 v235, s71, v232, 4
    v_mfma_f32_16x16x32_bf16 v[220:223], a[56:59], a[224:227], v[220:223]
    v_fma_f32 v146, v146, s37, -v250
    v_fma_f32 v147, v147, s37, -v250
    v_mfma_f32_16x16x32_bf16 v[200:203], a[224:227], a[120:123], v[200:203]
    v_exp_f32 v144, v144
    v_mfma_f32_16x16x16_bf16 v[168:171], v[34:35], v[142:143], v[168:171]
    v_exp_f32 v145, v145
    v_mfma_f32_16x16x32_bf16 v[204:207], a[224:227], a[124:127], v[204:207]
    v_exp_f32 v146, v146
    v_mfma_f32_16x16x32_bf16 v[208:211], a[224:227], a[128:131], v[208:211]
    ds_read_b64_tr_b16 a[224:225], v240 offset:3072
    ds_read_b64_tr_b16 a[226:227], v240 offset:7680
    v_mfma_f32_16x16x32_bf16 v[212:215], a[60:63], a[228:231], v[212:215]
    v_exp_f32 v147, v147
    v_mfma_f32_16x16x32_bf16 v[216:219], a[64:67], a[228:231], v[216:219]
    v_cvt_pk_bf16_f32 v178, v144, v145
    v_cvt_pk_bf16_f32 v179, v146, v147
    v_mfma_f32_16x16x32_bf16 v[220:223], a[68:71], a[228:231], v[220:223]
    ds_read_b128 v[144:147], v236
    v_mad_u32_u24 v236, v235, s40, v228
    v_mfma_f32_16x16x32_bf16 v[196:199], a[216:219], v[176:179], v[196:199]
    v_cvt_pk_bf16_f32 v48, v212, v213
    v_cvt_pk_bf16_f32 v49, v214, v215
    v_mfma_f32_16x16x32_bf16 v[184:187], v[70:73], v[176:179], v[184:187]
    v_cvt_pk_bf16_f32 v50, v216, v217
    v_cvt_pk_bf16_f32 v51, v218, v219
    v_mfma_f32_16x16x32_bf16 v[188:191], v[92:95], v[176:179], v[188:191]
    v_cvt_pk_bf16_f32 v52, v220, v221
    v_cvt_pk_bf16_f32 v53, v222, v223
    v_mfma_f32_16x16x32_bf16 v[192:195], v[114:117], v[176:179], v[192:195]
    s_waitcnt lgkmcnt(3)
    v_mad_u32_u24 v235, v235, s40, v229
    v_fma_f32 v148, v148, s37, -v250
    v_mfma_f32_16x16x32_bf16 v[172:175], v[54:57], v[138:141], v[172:175]
    v_fma_f32 v149, v149, s37, -v250
    v_fma_f32 v150, v150, s37, -v250
    v_mfma_f32_16x16x32_bf16 v[200:203], a[228:231], a[132:135], v[200:203]
    v_fma_f32 v151, v151, s37, -v250
    v_fma_f32 v152, v152, s37, -v250
    v_mfma_f32_16x16x32_bf16 v[204:207], a[228:231], a[136:139], v[204:207]
    v_exp_f32 v148, v148
    v_mfma_f32_16x16x16_bf16 v[172:175], v[58:59], v[142:143], v[172:175]
    v_exp_f32 v149, v149
    v_mfma_f32_16x16x32_bf16 v[208:211], a[228:231], a[140:143], v[208:211]
    s_waitcnt lgkmcnt(0)
    ds_read_b64_tr_b16 a[228:229], v240 offset:3080
    v_cvt_pk_bf16_f32 v82, v200, v201
    v_mfma_f32_16x16x32_bf16 v[144:147], v[60:63], v[138:141], v[144:147]
    ds_read_b64_tr_b16 a[230:231], v240 offset:7688
    v_cvt_pk_bf16_f32 v83, v202, v203
    v_mfma_f32_16x16x32_bf16 v[212:215], a[240:243], a[232:235], 0
    v_cvt_pk_bf16_f32 v104, v204, v205
    v_cvt_pk_bf16_f32 v105, v206, v207
    v_mfma_f32_16x16x32_bf16 v[200:203], a[240:243], a[236:239], 0
    v_cvt_pk_bf16_f32 v126, v208, v209
    v_cvt_pk_bf16_f32 v127, v210, v211
    v_mfma_f32_16x16x16_bf16 v[144:147], v[64:65], v[142:143], v[144:147]
    ds_read_b128 a[240:243], v239 offset:8192
    v_cvt_pk_bf16_f32 v180, v148, v149
    v_mfma_f32_16x16x32_bf16 v[216:219], a[244:247], a[232:235], 0
    v_exp_f32 v150, v150
    v_mfma_f32_16x16x32_bf16 v[204:207], a[244:247], a[236:239], 0
    ds_read_b64_tr_b16 a[244:245], v240 offset:4608
    ds_read_b64_tr_b16 a[246:247], v240 offset:6144
    v_mfma_f32_16x16x32_bf16 v[220:223], a[248:251], a[232:235], 0
    ds_read_b64_tr_b16 a[232:233], v241 offset:3072
    ds_read_b64_tr_b16 a[234:235], v241 offset:7680
    v_mfma_f32_16x16x32_bf16 v[208:211], a[248:251], a[236:239], 0
    ds_read_b128 a[236:239], v239 offset:2048
    ds_read_b64_tr_b16 a[248:249], v240 offset:4616
    v_mfma_f32_16x16x32_bf16 v[212:215], a[224:227], a[252:255], v[212:215]
    ds_read_b64_tr_b16 a[250:251], v240 offset:6152
    v_fma_f32 v153, v153, s37, -v250
    v_mfma_f32_16x16x32_bf16 v[200:203], a[224:227], a[220:223], v[200:203]
    s_waitcnt lgkmcnt(8)
    ds_read_b128 a[224:227], v239 offset:9216
    v_fma_f32 v154, v154, s37, -v250
    v_mfma_f32_16x16x32_bf16 v[216:219], a[228:231], a[252:255], v[216:219]
    v_exp_f32 v151, v151
    v_mfma_f32_16x16x32_bf16 v[204:207], a[228:231], a[220:223], v[204:207]
    s_waitcnt lgkmcnt(6)
    ds_read_b64_tr_b16 a[228:229], v240 offset:9216
    ds_read_b64_tr_b16 a[230:231], v240 offset:10752
    v_cvt_pk_bf16_f32 v181, v150, v151
    ds_read_b128 v[148:151], v234
    v_bfe_u32 v234, s67, v232, 4
    v_fma_f32 v155, v155, s37, -v250
    v_exp_f32 v152, v152
    v_exp_f32 v153, v153
    v_exp_f32 v154, v154
    v_mfma_f32_16x16x32_bf16 v[200:203], a[244:247], a[240:243], v[200:203]
    s_waitcnt lgkmcnt(7)
    v_exp_f32 v155, v155
    v_mfma_f32_16x16x32_bf16 v[220:223], a[232:235], a[252:255], v[220:223]
    ds_read_b64_tr_b16 a[252:253], v241 offset:4608
    ds_read_b64_tr_b16 a[254:255], v241 offset:6144
    v_mfma_f32_16x16x32_bf16 v[208:211], a[232:235], a[220:223], v[208:211]
    s_waitcnt lgkmcnt(8)
    ds_read_b128 a[220:223], v239 offset:3072
    ds_read_b64_tr_b16 a[232:233], v240 offset:9224
    v_mfma_f32_16x16x32_bf16 v[212:215], a[244:247], a[236:239], v[212:215]
    s_waitcnt lgkmcnt(8)
    ds_read_b64_tr_b16 a[234:235], v240 offset:10760
    ds_read_b128 a[244:247], v239 offset:10240
    v_mfma_f32_16x16x32_bf16 v[216:219], a[248:251], a[236:239], v[216:219]
    v_cvt_pk_bf16_f32 v182, v152, v153
    v_cvt_pk_bf16_f32 v183, v154, v155
    v_mfma_f32_16x16x32_bf16 v[204:207], a[248:251], a[240:243], v[204:207]
    ds_read_b64_tr_b16 a[248:249], v240 offset:12288
    ds_read_b64_tr_b16 a[250:251], v240 offset:16896
    v_mfma_f32_16x16x32_bf16 v[196:199], a[216:219], v[180:183], v[196:199]
    ds_read_b128 v[152:155], v236
    v_bfe_u32 v236, s62, v232, 4
    v_mfma_f32_16x16x32_bf16 v[184:187], v[74:77], v[180:183], v[184:187]
    v_max3_f32 v248, v156, v157, v158
    v_max3_f32 v249, v159, v160, v161
    v_mfma_f32_16x16x32_bf16 v[188:191], v[96:99], v[180:183], v[188:191]
    v_max3_f32 v248, v248, v162, v163
    v_max3_f32 v249, v249, v164, v165
    v_mfma_f32_16x16x32_bf16 v[192:195], v[118:121], v[180:183], v[192:195]
    s_waitcnt lgkmcnt(9)
    v_rcp_f32 v197, v196
    v_mfma_f32_16x16x32_bf16 v[148:151], v[48:51], v[138:141], v[148:151]
    s_waitcnt lgkmcnt(7)
    v_mul_f32 v184, v184, v197
    v_mul_f32 v185, v185, v197
    v_mfma_f32_16x16x32_bf16 v[220:223], a[252:255], a[236:239], v[220:223]
    ds_read_b64_tr_b16 a[236:237], v241 offset:9216
    ds_read_b64_tr_b16 a[238:239], v241 offset:10752
    v_mfma_f32_16x16x32_bf16 v[208:211], a[252:255], a[240:243], v[208:211]
    ds_read_b128 a[240:243], v239 offset:4096
    ds_read_b64_tr_b16 a[252:253], v240 offset:12296
    v_mfma_f32_16x16x16_bf16 v[148:151], v[52:53], v[142:143], v[148:151]
    s_waitcnt lgkmcnt(9)
    ds_read_b64_tr_b16 a[254:255], v240 offset:16904
    v_cvt_pk_bf16_f32 v184, v184, v185
    v_mfma_f32_16x16x32_bf16 v[212:215], a[228:231], a[220:223], v[212:215]
    v_mul_f32 v186, v186, v197
    v_mul_f32 v187, v187, v197
    v_mfma_f32_16x16x32_bf16 v[200:203], a[228:231], a[224:227], v[200:203]
    s_waitcnt lgkmcnt(5)
    ds_read_b128 a[228:231], v239 offset:11264
    v_cvt_pk_bf16_f32 v185, v186, v187
    v_mfma_f32_16x16x32_bf16 v[152:155], v[0:3], v[132:135], v[152:155]
    v_mul_f32 v188, v188, v197
    v_mul_f32 v189, v189, v197
    v_mfma_f32_16x16x32_bf16 v[216:219], a[232:235], a[220:223], v[216:219]
    v_cvt_pk_bf16_f32 v186, v188, v189
    v_mul_f32 v190, v190, v197
    v_mfma_f32_16x16x32_bf16 v[204:207], a[232:235], a[224:227], v[204:207]
    ds_read_b64_tr_b16 a[232:233], v240 offset:13824
    ds_read_b64_tr_b16 a[234:235], v240 offset:15360
    v_mfma_f32_16x16x16_bf16 v[152:155], v[4:5], v[136:137], v[152:155]
    v_mul_f32 v191, v191, v197
    v_cvt_pk_bf16_f32 v187, v190, v191
    v_mfma_f32_16x16x32_bf16 v[200:203], a[248:251], a[244:247], v[200:203]
    s_waitcnt lgkmcnt(6)
    v_mul_f32 v192, v192, v197
    v_mul_f32 v193, v193, v197
    v_mfma_f32_16x16x32_bf16 v[220:223], a[236:239], a[220:223], v[220:223]
    ds_read_b64_tr_b16 a[220:221], v241 offset:12288
    ds_read_b64_tr_b16 a[222:223], v241 offset:16896
    v_mfma_f32_16x16x32_bf16 v[208:211], a[236:239], a[224:227], v[208:211]
    s_waitcnt lgkmcnt(7)
    ds_read_b128 a[224:227], v239 offset:5120
    ds_read_b64_tr_b16 a[236:237], v240 offset:13832
    v_mfma_f32_16x16x32_bf16 v[212:215], a[248:251], a[240:243], v[212:215]
    s_waitcnt lgkmcnt(7)
    ds_read_b64_tr_b16 a[238:239], v240 offset:15368
    v_cvt_pk_bf16_f32 v188, v192, v193
    v_mfma_f32_16x16x32_bf16 v[216:219], a[252:255], a[240:243], v[216:219]
    v_mul_f32 v194, v194, v197
    v_mul_f32 v195, v195, v197
    v_mfma_f32_16x16x32_bf16 v[204:207], a[252:255], a[244:247], v[204:207]
    s_waitcnt lgkmcnt(5)
    v_cvt_pk_bf16_f32 v189, v194, v195
    ds_read_b128 a[248:251], v224 offset:46528
    ds_read_b128 a[252:255], v224 offset:46592
    v_max3_f32 v248, v248, v166, v167
    v_max3_f32 v249, v249, v168, v169
    v_max3_f32 v248, v248, v170, v171
    v_max3_f32 v249, v249, v172, v173
    v_mfma_f32_16x16x32_bf16 v[200:203], a[232:235], a[228:231], v[200:203]
    s_waitcnt lgkmcnt(5)
    v_max3_f32 v248, v248, v174, v175
    v_max3_f32 v249, v249, v144, v145
    v_max3_f32 v248, v248, v146, v147
    v_max3_f32 v249, v249, v148, v149
    v_max3_f32 v248, v248, v150, v151
    v_max_f32 v248, v248, v249
    v_mov_b32 v249, v248
    s_nop 0
    v_cvt_pk_bf16_f32 v200, v200, v201
    v_cvt_pk_bf16_f32 v201, v202, v203
    v_mfma_f32_16x16x32_bf16 v[220:223], a[220:223], a[240:243], v[220:223]
    ds_read_b64_tr_b16 a[240:241], v241 offset:13824
    ds_read_b64_tr_b16 a[242:243], v241 offset:15360
    v_mfma_f32_16x16x32_bf16 v[208:211], a[220:223], a[244:247], v[208:211]
    s_waitcnt lgkmcnt(6)
    ds_read_b128 a[244:247], v224 offset:46464
    ds_read_b128 a[220:223], v224 offset:46656
    v_mfma_f32_16x16x32_bf16 v[212:215], a[232:235], a[224:227], v[212:215]
    s_waitcnt lgkmcnt(6)
    ds_read_b128 a[232:235], v224 offset:49536
    v_mfma_f32_16x16x32_bf16 v[216:219], a[236:239], a[224:227], v[216:219]
    v_permlane16_swap_b32 v248, v249
    v_mfma_f32_16x16x32_bf16 v[204:207], a[236:239], a[228:231], v[204:207]
    s_waitcnt lgkmcnt(3)
    ds_read_b128 a[236:239], v224 offset:49600
    v_max_f32 v248, v248, v249
    v_mov_b32 v249, v248
    s_nop 0
    v_cvt_pk_bf16_f32 v212, v212, v213
    v_cvt_pk_bf16_f32 v213, v214, v215
    v_cvt_pk_bf16_f32 v214, v216, v217
    v_cvt_pk_bf16_f32 v215, v218, v219
    buffer_store_dwordx4 v[212:215], v242, s[20:23], s58 offen sc0 sc1
    v_cvt_pk_bf16_f32 v202, v204, v205
    v_cvt_pk_bf16_f32 v203, v206, v207
    buffer_store_dwordx4 v[200:203], v244, s[20:23], s59 offen sc0 sc1
    v_mfma_f32_16x16x32_bf16 v[220:223], a[240:243], a[224:227], v[220:223]
    s_waitcnt lgkmcnt(3)
    ds_read_b128 a[224:227], v224 offset:46720
    v_mfma_f32_16x16x32_bf16 v[208:211], a[240:243], a[228:231], v[208:211]
    s_barrier
    ds_write_b128 v237, v[184:187]
    v_mfma_f32_16x16x32_bf16 v[212:215], a[0:3], a[244:247], 0
    ds_write_b64 v238, v[188:189]
    v_mfma_f32_16x16x32_bf16 v[216:219], a[4:7], a[244:247], 0
    ds_read_b128 a[228:231], v224 offset:46784
    v_cvt_pk_bf16_f32 v220, v220, v221
    v_mfma_f32_16x16x32_bf16 v[200:203], a[244:247], a[72:75], 0
    v_cvt_pk_bf16_f32 v221, v222, v223
    v_cvt_pk_bf16_f32 v208, v208, v209
    v_mfma_f32_16x16x32_bf16 v[204:207], a[244:247], a[76:79], 0
    buffer_store_dwordx2 v[220:221], v243, s[20:23], s58 offen sc0 sc1
    v_mfma_f32_16x16x32_bf16 v[220:223], a[8:11], a[244:247], 0
    ds_read_b128 a[240:243], v224 offset:49664
    v_cvt_pk_bf16_f32 v209, v210, v211
    v_mfma_f32_16x16x32_bf16 v[212:215], a[12:15], a[248:251], v[212:215]
    buffer_store_dwordx2 v[208:209], v245, s[20:23], s59 offen sc0 sc1
    v_mfma_f32_16x16x32_bf16 v[208:211], a[244:247], a[80:83], 0
    ds_read_b128 a[244:247], v224 offset:49728
    v_mfma_f32_16x16x32_bf16 v[216:219], a[16:19], a[248:251], v[216:219]
    v_permlane32_swap_b32 v248, v249
    v_mfma_f32_16x16x32_bf16 v[220:223], a[20:23], a[248:251], v[220:223]
    v_max_f32 v248, v248, v249
    v_mul_f32 v250, s37, v248
    v_mfma_f32_16x16x32_bf16 v[200:203], a[248:251], a[84:87], v[200:203]
    v_fma_f32 v156, v156, s37, -v250
    v_fma_f32 v157, v157, s37, -v250
    v_mfma_f32_16x16x32_bf16 v[204:207], a[248:251], a[88:91], v[204:207]
    v_fma_f32 v158, v158, s37, -v250
    v_fma_f32 v159, v159, s37, -v250
    v_mfma_f32_16x16x32_bf16 v[208:211], a[248:251], a[92:95], v[208:211]
    ds_read_b128 a[248:251], v224 offset:49792
    v_fma_f32 v160, v160, s37, -v250
    v_mfma_f32_16x16x32_bf16 v[212:215], a[24:27], a[252:255], v[212:215]
    v_exp_f32 v156, v156
    v_mfma_f32_16x16x32_bf16 v[216:219], a[28:31], a[252:255], v[216:219]
    v_exp_f32 v157, v157
    v_mfma_f32_16x16x32_bf16 v[220:223], a[32:35], a[252:255], v[220:223]
    v_exp_f32 v158, v158
    v_mfma_f32_16x16x32_bf16 v[200:203], a[252:255], a[96:99], v[200:203]
    v_exp_f32 v159, v159
    v_mfma_f32_16x16x32_bf16 v[204:207], a[252:255], a[100:103], v[204:207]
    v_cvt_pk_bf16_f32 v176, v156, v157
    v_cvt_pk_bf16_f32 v177, v158, v159
    v_mfma_f32_16x16x32_bf16 v[208:211], a[252:255], a[104:107], v[208:211]
    s_waitcnt lgkmcnt(1)
    ds_read_b128 a[252:255], v224 offset:49856
    ds_read_b128 v[156:159], v235
    v_mfma_f32_16x16x32_bf16 v[212:215], a[36:39], a[220:223], v[212:215]
    v_mad_u32_u24 v235, v234, s40, v229
    v_mad_u32_u24 v234, v234, s40, v228
    v_mfma_f32_16x16x32_bf16 v[216:219], a[40:43], a[220:223], v[216:219]
    v_fma_f32 v161, v161, s37, -v250
    v_fma_f32 v162, v162, s37, -v250
    v_mfma_f32_16x16x32_bf16 v[220:223], a[44:47], a[220:223], v[220:223]
    v_fma_f32 v163, v163, s37, -v250
    v_fma_f32 v164, v164, s37, -v250
    v_mfma_f32_16x16x32_bf16 v[200:203], a[220:223], a[108:111], v[200:203]
    v_exp_f32 v160, v160
    v_mfma_f32_16x16x32_bf16 v[204:207], a[220:223], a[112:115], v[204:207]
    v_exp_f32 v161, v161
    v_mfma_f32_16x16x32_bf16 v[208:211], a[220:223], a[116:119], v[208:211]
    ds_read_b128 a[220:223], v225 offset:26304
    v_cvt_pk_bf16_f32 v178, v160, v161
    v_mfma_f32_16x16x32_bf16 v[212:215], a[48:51], a[224:227], v[212:215]
    v_exp_f32 v162, v162
    v_mfma_f32_16x16x32_bf16 v[216:219], a[52:55], a[224:227], v[216:219]
    v_exp_f32 v163, v163
    v_mfma_f32_16x16x32_bf16 v[220:223], a[56:59], a[224:227], v[220:223]
    s_waitcnt lgkmcnt(1)
    v_cvt_pk_bf16_f32 v179, v162, v163
    v_fma_f32 v165, v165, s37, -v250
    v_mfma_f32_16x16x32_bf16 v[156:159], v[24:27], v[132:135], v[156:159]
    ds_read_b128 v[160:163], v235
    v_bfe_u32 v235, s72, v232, 4
    v_mfma_f32_16x16x32_bf16 v[196:199], a[216:219], v[176:179], 0
    v_fma_f32 v166, v166, s37, -v250
    v_fma_f32 v167, v167, s37, -v250
    v_mfma_f32_16x16x32_bf16 v[184:187], v[76:79], v[176:179], 0
    v_exp_f32 v164, v164
    v_mfma_f32_16x16x32_bf16 v[188:191], v[98:101], v[176:179], 0
    v_exp_f32 v165, v165
    v_mfma_f32_16x16x32_bf16 v[192:195], v[120:123], v[176:179], 0
    v_exp_f32 v166, v166
    v_mfma_f32_16x16x16_bf16 v[156:159], v[28:29], v[136:137], v[156:159]
    v_exp_f32 v167, v167
    v_mfma_f32_16x16x32_bf16 v[200:203], a[224:227], a[120:123], v[200:203]
    v_cvt_pk_bf16_f32 v180, v164, v165
    v_cvt_pk_bf16_f32 v181, v166, v167
    v_mfma_f32_16x16x32_bf16 v[204:207], a[224:227], a[124:127], v[204:207]
    ds_read_b128 v[164:167], v234
    v_mad_u32_u24 v234, v236, s40, v228
    v_mfma_f32_16x16x32_bf16 v[208:211], a[224:227], a[128:131], v[208:211]
    ds_read_b128 a[224:227], v225 offset:26368
    v_mad_u32_u24 v236, v236, s40, v229
    v_mfma_f32_16x16x32_bf16 v[212:215], a[60:63], a[228:231], v[212:215]
    s_waitcnt lgkmcnt(2)
    v_fma_f32 v168, v168, s37, -v250
    v_fma_f32 v169, v169, s37, -v250
    v_mfma_f32_16x16x32_bf16 v[160:163], v[30:33], v[132:135], v[160:163]
    v_fma_f32 v170, v170, s37, -v250
    v_fma_f32 v171, v171, s37, -v250
    v_mfma_f32_16x16x32_bf16 v[216:219], a[64:67], a[228:231], v[216:219]
    v_exp_f32 v168, v168
    v_mfma_f32_16x16x32_bf16 v[220:223], a[68:71], a[228:231], v[220:223]
    v_cvt_pk_bf16_f32 v18, v212, v213
    v_cvt_pk_bf16_f32 v19, v214, v215
    v_mfma_f32_16x16x16_bf16 v[160:163], v[34:35], v[136:137], v[160:163]
    v_exp_f32 v169, v169
    v_mfma_f32_16x16x32_bf16 v[200:203], a[228:231], a[132:135], v[200:203]
    v_exp_f32 v170, v170
    v_mfma_f32_16x16x32_bf16 v[204:207], a[228:231], a[136:139], v[204:207]
    v_cvt_pk_bf16_f32 v20, v216, v217
    v_cvt_pk_bf16_f32 v21, v218, v219
    v_mfma_f32_16x16x32_bf16 v[208:211], a[228:231], a[140:143], v[208:211]
    s_waitcnt lgkmcnt(1)
    v_cvt_pk_bf16_f32 v22, v220, v221
    v_cvt_pk_bf16_f32 v23, v222, v223
    v_mfma_f32_16x16x32_bf16 v[164:167], v[6:9], v[132:135], v[164:167]
    v_cvt_pk_bf16_f32 v80, v200, v201
    v_cvt_pk_bf16_f32 v81, v202, v203
    v_mfma_f32_16x16x32_bf16 v[212:215], a[0:3], a[232:235], 0
    v_cvt_pk_bf16_f32 v102, v204, v205
    v_cvt_pk_bf16_f32 v103, v206, v207
    v_mfma_f32_16x16x32_bf16 v[216:219], a[4:7], a[232:235], 0
    v_cvt_pk_bf16_f32 v124, v208, v209
    v_cvt_pk_bf16_f32 v125, v210, v211
    v_mfma_f32_16x16x16_bf16 v[164:167], v[10:11], v[136:137], v[164:167]
    ds_read_b128 a[228:231], v225 offset:26432
    v_cvt_pk_bf16_f32 v182, v168, v169
    v_mfma_f32_16x16x32_bf16 v[220:223], a[8:11], a[232:235], 0
    v_exp_f32 v171, v171
    v_mfma_f32_16x16x32_bf16 v[200:203], a[232:235], a[72:75], 0
    v_cvt_pk_bf16_f32 v183, v170, v171
    v_fma_f32 v172, v172, s37, -v250
    v_mfma_f32_16x16x32_bf16 v[204:207], a[232:235], a[76:79], 0
    ds_read_b128 v[168:171], v234
    v_bfe_u32 v234, s71, v232, 4
    v_mfma_f32_16x16x32_bf16 v[196:199], a[216:219], v[180:183], v[196:199]
    v_mad_u32_u24 v234, v234, s40, v230
    v_fma_f32 v173, v173, s37, -v250
    v_mfma_f32_16x16x32_bf16 v[184:187], v[68:71], v[180:183], v[184:187]
    v_fma_f32 v174, v174, s37, -v250
    v_fma_f32 v175, v175, s37, -v250
    v_mfma_f32_16x16x32_bf16 v[188:191], v[90:93], v[180:183], v[188:191]
    v_exp_f32 v172, v172
    v_mfma_f32_16x16x32_bf16 v[192:195], v[112:115], v[180:183], v[192:195]
    v_exp_f32 v173, v173
    v_mfma_f32_16x16x32_bf16 v[208:211], a[232:235], a[80:83], 0
    ds_read_b128 a[232:235], v225 offset:26496
    v_cvt_pk_bf16_f32 v176, v172, v173
    v_mfma_f32_16x16x32_bf16 v[212:215], a[12:15], a[236:239], v[212:215]
    v_exp_f32 v174, v174
    v_mfma_f32_16x16x32_bf16 v[216:219], a[16:19], a[236:239], v[216:219]
    v_exp_f32 v175, v175
    v_mfma_f32_16x16x32_bf16 v[220:223], a[20:23], a[236:239], v[220:223]
    v_cvt_pk_bf16_f32 v177, v174, v175
    v_fma_f32 v144, v144, s37, -v250
    v_mfma_f32_16x16x32_bf16 v[200:203], a[236:239], a[84:87], v[200:203]
    s_waitcnt lgkmcnt(1)
    ds_read_b128 v[172:175], v236
    v_mad_u32_u24 v236, v235, s40, v229
    v_mfma_f32_16x16x32_bf16 v[168:171], v[12:15], v[132:135], v[168:171]
    v_mad_u32_u24 v235, v235, s40, v228
    v_fma_f32 v145, v145, s37, -v250
    v_mfma_f32_16x16x32_bf16 v[204:207], a[236:239], a[88:91], v[204:207]
    v_fma_f32 v146, v146, s37, -v250
    v_fma_f32 v147, v147, s37, -v250
    v_mfma_f32_16x16x32_bf16 v[208:211], a[236:239], a[92:95], v[208:211]
    ds_read_b128 a[236:239], v225 offset:26560
    v_fma_f32 v148, v148, s37, -v250
    v_mfma_f32_16x16x16_bf16 v[168:171], v[16:17], v[136:137], v[168:171]
    v_exp_f32 v144, v144
    v_mfma_f32_16x16x32_bf16 v[212:215], a[24:27], a[240:243], v[212:215]
    v_exp_f32 v145, v145
    v_mfma_f32_16x16x32_bf16 v[216:219], a[28:31], a[240:243], v[216:219]
    v_exp_f32 v146, v146
    v_mfma_f32_16x16x32_bf16 v[220:223], a[32:35], a[240:243], v[220:223]
    v_exp_f32 v147, v147
    v_mfma_f32_16x16x32_bf16 v[200:203], a[240:243], a[96:99], v[200:203]
    v_cvt_pk_bf16_f32 v178, v144, v145
    v_cvt_pk_bf16_f32 v179, v146, v147
    v_mfma_f32_16x16x32_bf16 v[204:207], a[240:243], a[100:103], v[204:207]
    ds_read_b128 v[144:147], v236
    v_bfe_u32 v236, s62, v232, 4
    v_mfma_f32_16x16x32_bf16 v[196:199], a[216:219], v[176:179], v[196:199]
    v_mad_u32_u24 v236, v236, s40, v230
    v_fma_f32 v149, v149, s37, -v250
    v_mfma_f32_16x16x32_bf16 v[184:187], v[84:87], v[176:179], v[184:187]
    v_fma_f32 v150, v150, s37, -v250
    v_fma_f32 v151, v151, s37, -v250
    v_mfma_f32_16x16x32_bf16 v[188:191], v[106:109], v[176:179], v[188:191]
    v_exp_f32 v148, v148
    v_mfma_f32_16x16x32_bf16 v[192:195], v[128:131], v[176:179], v[192:195]
    s_waitcnt lgkmcnt(2)
    v_exp_f32 v149, v149
    v_mfma_f32_16x16x32_bf16 v[172:175], v[36:39], v[132:135], v[172:175]
    v_exp_f32 v150, v150
    v_mfma_f32_16x16x32_bf16 v[208:211], a[240:243], a[104:107], v[208:211]
    ds_read_b128 a[240:243], v225 offset:26624
    v_cvt_pk_bf16_f32 v180, v148, v149
    v_mfma_f32_16x16x32_bf16 v[212:215], a[36:39], a[244:247], v[212:215]
    v_exp_f32 v151, v151
    v_mfma_f32_16x16x16_bf16 v[172:175], v[40:41], v[136:137], v[172:175]
    v_cvt_pk_bf16_f32 v181, v150, v151
    v_max3_f32 v248, v152, v153, v154
    v_mfma_f32_16x16x32_bf16 v[216:219], a[40:43], a[244:247], v[216:219]
    ds_read_b128 v[148:151], v235
    v_bfe_u32 v235, s67, v232, 4
    v_mfma_f32_16x16x16_bf16 v[196:199], a[216:217], v[180:181], v[196:199]
    v_mad_u32_u24 v235, v235, s40, v230
    v_max3_f32 v249, v155, v156, v157
    v_mfma_f32_16x16x16_bf16 v[184:187], v[82:83], v[180:181], v[184:187]
    v_max3_f32 v248, v248, v158, v159
    v_max3_f32 v249, v249, v160, v161
    v_mfma_f32_16x16x16_bf16 v[188:191], v[104:105], v[180:181], v[188:191]
    v_max3_f32 v248, v248, v162, v163
    v_max3_f32 v249, v249, v164, v165
    v_mfma_f32_16x16x16_bf16 v[192:195], v[126:127], v[180:181], v[192:195]
    v_rcp_f32 v197, v196
    v_mfma_f32_16x16x32_bf16 v[220:223], a[44:47], a[244:247], v[220:223]
    v_mul_f32 v184, v184, v197
    v_mul_f32 v185, v185, v197
    v_mfma_f32_16x16x32_bf16 v[200:203], a[244:247], a[108:111], v[200:203]
    v_cvt_pk_bf16_f32 v184, v184, v185
    v_mul_f32 v186, v186, v197
    v_mfma_f32_16x16x32_bf16 v[204:207], a[244:247], a[112:115], v[204:207]
    v_mul_f32 v187, v187, v197
    v_cvt_pk_bf16_f32 v185, v186, v187
    v_mfma_f32_16x16x32_bf16 v[208:211], a[244:247], a[116:119], v[208:211]
    v_mul_f32 v188, v188, v197
    v_mul_f32 v189, v189, v197
    v_mfma_f32_16x16x32_bf16 v[212:215], a[48:51], a[248:251], v[212:215]
    s_waitcnt lgkmcnt(0)
    v_cvt_pk_bf16_f32 v186, v188, v189
    v_mul_f32 v190, v190, v197
    v_mfma_f32_16x16x32_bf16 v[148:151], v[18:21], v[132:135], v[148:151]
    v_mul_f32 v191, v191, v197
    v_cvt_pk_bf16_f32 v187, v190, v191
    v_mfma_f32_16x16x32_bf16 v[216:219], a[52:55], a[248:251], v[216:219]
    v_mul_f32 v192, v192, v197
    v_mul_f32 v193, v193, v197
    v_mfma_f32_16x16x32_bf16 v[220:223], a[56:59], a[248:251], v[220:223]
    v_cvt_pk_bf16_f32 v188, v192, v193
    v_mul_f32 v194, v194, v197
    v_mfma_f32_16x16x16_bf16 v[148:151], v[22:23], v[136:137], v[148:151]
    ds_read_b128 a[244:247], v225 offset:38720
    v_mul_f32 v195, v195, v197
    v_mfma_f32_16x16x32_bf16 v[200:203], a[248:251], a[120:123], v[200:203]
    v_cvt_pk_bf16_f32 v189, v194, v195
    v_max3_f32 v248, v248, v166, v167
    v_mfma_f32_16x16x32_bf16 v[204:207], a[248:251], a[124:127], v[204:207]
    ds_write_b128 v237, v[184:187] offset:6144
    v_mfma_f32_16x16x32_bf16 v[208:211], a[248:251], a[128:131], v[208:211]
    ds_write_b64 v238, v[188:189] offset:6144
    v_mfma_f32_16x16x32_bf16 v[212:215], a[60:63], a[252:255], v[212:215]
    ds_read_b128 a[248:251], v225 offset:38784
    v_max3_f32 v249, v249, v168, v169
    v_mfma_f32_16x16x32_bf16 v[216:219], a[64:67], a[252:255], v[216:219]
    v_max3_f32 v248, v248, v170, v171
    v_max3_f32 v249, v249, v172, v173
    v_mfma_f32_16x16x32_bf16 v[220:223], a[68:71], a[252:255], v[220:223]
    v_max3_f32 v248, v248, v174, v175
    v_mfma_f32_16x16x32_bf16 v[200:203], a[252:255], a[132:135], v[200:203]
    v_cvt_pk_bf16_f32 v42, v212, v213
    v_cvt_pk_bf16_f32 v43, v214, v215
    v_mfma_f32_16x16x32_bf16 v[204:207], a[252:255], a[136:139], v[204:207]
    v_cvt_pk_bf16_f32 v44, v216, v217
    v_cvt_pk_bf16_f32 v45, v218, v219
    v_mfma_f32_16x16x32_bf16 v[208:211], a[252:255], a[140:143], v[208:211]
    v_cvt_pk_bf16_f32 v46, v220, v221
    v_cvt_pk_bf16_f32 v47, v222, v223
    v_mfma_f32_16x16x32_bf16 v[144:147], v[42:45], v[132:135], v[144:147]
    v_cvt_pk_bf16_f32 v78, v200, v201
    v_cvt_pk_bf16_f32 v79, v202, v203
    v_mfma_f32_16x16x32_bf16 v[212:215], a[144:147], a[220:223], 0
    v_cvt_pk_bf16_f32 v100, v204, v205
    v_cvt_pk_bf16_f32 v101, v206, v207
    v_mfma_f32_16x16x32_bf16 v[216:219], a[148:151], a[220:223], 0
    v_cvt_pk_bf16_f32 v122, v208, v209
    v_cvt_pk_bf16_f32 v123, v210, v211
    v_mfma_f32_16x16x16_bf16 v[144:147], v[46:47], v[136:137], v[144:147]
    ds_read_b128 a[252:255], v225 offset:38848
    v_mfma_f32_16x16x32_bf16 v[220:223], a[152:155], a[220:223], 0
    ds_read_b128 a[220:223], v225 offset:38912
    v_mfma_f32_16x16x32_bf16 v[212:215], a[156:159], a[224:227], v[212:215]
    v_mfma_f32_16x16x32_bf16 v[216:219], a[160:163], a[224:227], v[216:219]
    v_mfma_f32_16x16x32_bf16 v[220:223], a[164:167], a[224:227], v[220:223]
    ds_read_b128 a[224:227], v225 offset:38976
    v_mfma_f32_16x16x32_bf16 v[212:215], a[168:171], a[228:231], v[212:215]
    v_max3_f32 v249, v249, v144, v145
    v_max3_f32 v248, v248, v146, v147
    v_mfma_f32_16x16x32_bf16 v[216:219], a[172:175], a[228:231], v[216:219]
    v_max3_f32 v249, v249, v148, v149
    v_max3_f32 v248, v248, v150, v151
    v_mfma_f32_16x16x32_bf16 v[220:223], a[176:179], a[228:231], v[220:223]
    ds_read_b128 a[228:231], v225 offset:39040
    v_max_f32 v248, v248, v249
    v_mfma_f32_16x16x32_bf16 v[212:215], a[180:183], a[232:235], v[212:215]
    v_mov_b32 v249, v248
    v_mfma_f32_16x16x32_bf16 v[216:219], a[184:187], a[232:235], v[216:219]
    v_mfma_f32_16x16x32_bf16 v[220:223], a[188:191], a[232:235], v[220:223]
    v_permlane16_swap_b32 v248, v249
    v_mfma_f32_16x16x32_bf16 v[212:215], a[192:195], a[236:239], v[212:215]
    v_max_f32 v248, v248, v249
    v_mov_b32 v249, v248
    v_mfma_f32_16x16x32_bf16 v[216:219], a[196:199], a[236:239], v[216:219]
    v_mfma_f32_16x16x32_bf16 v[220:223], a[200:203], a[236:239], v[220:223]
    v_permlane32_swap_b32 v248, v249
    v_mfma_f32_16x16x32_bf16 v[212:215], a[204:207], a[240:243], v[212:215]
    v_max_f32 v248, v248, v249
    v_mul_f32 v250, s37, v248
    v_mfma_f32_16x16x32_bf16 v[216:219], a[208:211], a[240:243], v[216:219]
    s_waitcnt vmcnt(4) lgkmcnt(1)
    v_fma_f32 v152, v152, s37, -v250
    v_fma_f32 v153, v153, s37, -v250
    v_mfma_f32_16x16x32_bf16 v[220:223], a[212:215], a[240:243], v[220:223]
    s_barrier
    buffer_load_dwordx4 v246, s[4:7], s47 offen lds
    v_mfma_f32_16x16x32_bf16 v[200:203], a[144:147], a[244:247], 0
    s_add_u32 m0, s42, 0x3c80
    v_cvt_pk_bf16_f32 v138, v212, v213
    v_cvt_pk_bf16_f32 v139, v214, v215
    v_mfma_f32_16x16x32_bf16 v[204:207], a[148:151], a[244:247], 0
    v_cvt_pk_bf16_f32 v140, v216, v217
    v_cvt_pk_bf16_f32 v141, v218, v219
    v_mfma_f32_16x16x32_bf16 v[208:211], a[152:155], a[244:247], 0
    v_cvt_pk_bf16_f32 v142, v220, v221
    v_cvt_pk_bf16_f32 v143, v222, v223
    v_mfma_f32_16x16x32_bf16 v[200:203], a[156:159], a[248:251], v[200:203]
    buffer_load_dwordx4 v247, s[4:7], s47 offen lds
    v_mfma_f32_16x16x32_bf16 v[204:207], a[160:163], a[248:251], v[204:207]
    s_add_u32 m0, s41, 0x5ac0
    ds_read_b128 a[232:235], v239
    ds_read_b128 a[236:239], v239 offset:6144
    v_mfma_f32_16x16x32_bf16 v[208:211], a[164:167], a[248:251], v[208:211]
    buffer_load_dwordx4 v246, s[4:7], s48 offen lds
    v_mfma_f32_16x16x32_bf16 v[200:203], a[168:171], a[252:255], v[200:203]
    s_add_u32 m0, s42, 0x5ac0
    ds_read_b64_tr_b16 a[240:241], v240
    ds_read_b64_tr_b16 a[242:243], v240 offset:1536
    v_mfma_f32_16x16x32_bf16 v[204:207], a[172:175], a[252:255], v[204:207]
    s_add_u32 s58, s51, 0xfc000
    buffer_load_dwordx4 v247, s[4:7], s48 offen lds
    v_mfma_f32_16x16x32_bf16 v[208:211], a[176:179], a[252:255], v[208:211]
    s_add_u32 s59, s51, 0xfd800
    ds_read_b64_tr_b16 a[244:245], v240 offset:8
    ds_read_b64_tr_b16 a[246:247], v240 offset:1544
    v_mfma_f32_16x16x32_bf16 v[200:203], a[180:183], a[220:223], v[200:203]
    ds_read_b64_tr_b16 a[248:249], v241
    ds_read_b64_tr_b16 a[250:251], v241 offset:1536
    v_mfma_f32_16x16x32_bf16 v[204:207], a[184:187], a[220:223], v[204:207]
    ds_read_b128 a[252:255], v239 offset:1024
    v_fma_f32 v154, v154, s37, -v250
    v_mfma_f32_16x16x32_bf16 v[208:211], a[188:191], a[220:223], v[208:211]
    ds_read_b128 a[220:223], v239 offset:7168
    v_fma_f32 v155, v155, s37, -v250
    v_mfma_f32_16x16x32_bf16 v[200:203], a[192:195], a[224:227], v[200:203]
    v_exp_f32 v152, v152
    v_mfma_f32_16x16x32_bf16 v[204:207], a[196:199], a[224:227], v[204:207]
    v_exp_f32 v153, v153
    v_mfma_f32_16x16x32_bf16 v[208:211], a[200:203], a[224:227], v[208:211]
    s_waitcnt lgkmcnt(10)
    ds_read_b64_tr_b16 a[224:225], v240 offset:3072
    ds_read_b64_tr_b16 a[226:227], v240 offset:7680
    v_mfma_f32_16x16x32_bf16 v[200:203], a[204:207], a[228:231], v[200:203]
    v_exp_f32 v154, v154
    v_mfma_f32_16x16x32_bf16 v[204:207], a[208:211], a[228:231], v[204:207]
    v_exp_f32 v155, v155
    v_mfma_f32_16x16x32_bf16 v[208:211], a[212:215], a[228:231], v[208:211]
    s_waitcnt lgkmcnt(8)
    ds_read_b64_tr_b16 a[228:229], v240 offset:3080
    ds_read_b64_tr_b16 a[230:231], v240 offset:7688
    v_mfma_f32_16x16x32_bf16 v[212:215], a[240:243], a[232:235], 0
    s_waitcnt lgkmcnt(8)
    v_cvt_pk_bf16_f32 v176, v152, v153
    v_cvt_pk_bf16_f32 v132, v200, v201
    v_mfma_f32_16x16x32_bf16 v[216:219], a[244:247], a[232:235], 0
    v_cvt_pk_bf16_f32 v133, v202, v203
    v_cvt_pk_bf16_f32 v134, v204, v205
    v_mfma_f32_16x16x32_bf16 v[200:203], a[240:243], a[236:239], 0
    v_cvt_pk_bf16_f32 v135, v206, v207
    v_cvt_pk_bf16_f32 v136, v208, v209
    v_mfma_f32_16x16x32_bf16 v[204:207], a[244:247], a[236:239], 0
    s_waitcnt lgkmcnt(5)
    ds_read_b128 a[240:243], v239 offset:8192
    v_cvt_pk_bf16_f32 v137, v210, v211
    v_mfma_f32_16x16x32_bf16 v[220:223], a[248:251], a[232:235], 0
    ds_read_b64_tr_b16 a[232:233], v241 offset:3072
    ds_read_b64_tr_b16 a[234:235], v241 offset:7680
    v_mfma_f32_16x16x32_bf16 v[208:211], a[248:251], a[236:239], 0
    s_waitcnt lgkmcnt(5)
    ds_read_b128 a[236:239], v239 offset:2048
    ds_read_b64_tr_b16 a[244:245], v240 offset:4608
    v_mfma_f32_16x16x32_bf16 v[212:215], a[224:227], a[252:255], v[212:215]
    ds_read_b64_tr_b16 a[246:247], v240 offset:6144
    ds_read_b64_tr_b16 a[248:249], v240 offset:4616
    v_mfma_f32_16x16x32_bf16 v[200:203], a[224:227], a[220:223], v[200:203]
    s_waitcnt lgkmcnt(7)
    ds_read_b64_tr_b16 a[250:251], v240 offset:6152
    ds_read_b128 a[224:227], v239 offset:9216
    v_cvt_pk_bf16_f32 v177, v154, v155
    ds_read_b128 v[152:155], v234
    v_mfma_f32_16x16x32_bf16 v[216:219], a[228:231], a[252:255], v[216:219]
    v_bfe_u32 v234, s72, v232, 4
    v_mad_u32_u24 v234, v234, s40, v230
    v_mfma_f32_16x16x32_bf16 v[204:207], a[228:231], a[220:223], v[204:207]
    s_waitcnt lgkmcnt(7)
    ds_read_b64_tr_b16 a[228:229], v240 offset:9216
    ds_read_b64_tr_b16 a[230:231], v240 offset:10752
    v_fma_f32 v156, v156, s37, -v250
    v_fma_f32 v157, v157, s37, -v250
    v_fma_f32 v158, v158, s37, -v250
    v_fma_f32 v159, v159, s37, -v250
    v_exp_f32 v156, v156
    v_exp_f32 v157, v157
    v_exp_f32 v158, v158
    v_exp_f32 v159, v159
    v_mfma_f32_16x16x32_bf16 v[220:223], a[232:235], a[252:255], v[220:223]
    ds_read_b64_tr_b16 a[252:253], v241 offset:4608
    ds_read_b64_tr_b16 a[254:255], v241 offset:6144
    v_mfma_f32_16x16x32_bf16 v[208:211], a[232:235], a[220:223], v[208:211]
    s_waitcnt lgkmcnt(8)
    ds_read_b128 a[220:223], v239 offset:3072
    ds_read_b64_tr_b16 a[232:233], v240 offset:9224
    v_mfma_f32_16x16x32_bf16 v[212:215], a[244:247], a[236:239], v[212:215]
    ds_read_b64_tr_b16 a[234:235], v240 offset:10760
    v_cvt_pk_bf16_f32 v178, v156, v157
    v_mfma_f32_16x16x32_bf16 v[200:203], a[244:247], a[240:243], v[200:203]
    s_waitcnt lgkmcnt(7)
    ds_read_b128 a[244:247], v239 offset:10240
    v_cvt_pk_bf16_f32 v179, v158, v159
    v_mfma_f32_16x16x32_bf16 v[152:155], v[24:27], v[138:141], v[152:155]
    ds_read_b128 v[156:159], v235
    v_bfe_u32 v235, s73, v233, 4
    v_mfma_f32_16x16x32_bf16 v[196:199], a[216:219], v[176:179], 0
    v_mad_u32_u24 v235, v235, s40, v231
    v_fma_f32 v160, v160, s37, -v250
    v_mfma_f32_16x16x32_bf16 v[184:187], v[66:69], v[176:179], 0
    v_fma_f32 v161, v161, s37, -v250
    v_fma_f32 v162, v162, s37, -v250
    v_mfma_f32_16x16x32_bf16 v[188:191], v[88:91], v[176:179], 0
    v_fma_f32 v163, v163, s37, -v250
    v_fma_f32 v164, v164, s37, -v250
    v_mfma_f32_16x16x32_bf16 v[192:195], v[110:113], v[176:179], 0
    v_exp_f32 v160, v160
    v_mfma_f32_16x16x16_bf16 v[152:155], v[28:29], v[142:143], v[152:155]
    v_exp_f32 v161, v161
    v_mfma_f32_16x16x32_bf16 v[216:219], a[248:251], a[236:239], v[216:219]
    v_exp_f32 v162, v162
    v_mfma_f32_16x16x32_bf16 v[204:207], a[248:251], a[240:243], v[204:207]
    s_waitcnt lgkmcnt(5)
    ds_read_b64_tr_b16 a[248:249], v240 offset:12288
    ds_read_b64_tr_b16 a[250:251], v240 offset:16896
    v_mfma_f32_16x16x32_bf16 v[220:223], a[252:255], a[236:239], v[220:223]
    ds_read_b64_tr_b16 a[236:237], v241 offset:9216
    ds_read_b64_tr_b16 a[238:239], v241 offset:10752
    v_mfma_f32_16x16x32_bf16 v[208:211], a[252:255], a[240:243], v[208:211]
    s_waitcnt lgkmcnt(4)
    ds_read_b128 a[240:243], v239 offset:4096
    ds_read_b64_tr_b16 a[252:253], v240 offset:12296
    v_mfma_f32_16x16x32_bf16 v[156:159], v[30:33], v[138:141], v[156:159]
    ds_read_b64_tr_b16 a[254:255], v240 offset:16904
    v_cvt_pk_bf16_f32 v180, v160, v161
    v_mfma_f32_16x16x32_bf16 v[212:215], a[228:231], a[220:223], v[212:215]
    v_exp_f32 v163, v163
    v_mfma_f32_16x16x32_bf16 v[200:203], a[228:231], a[224:227], v[200:203]
    ds_read_b128 a[228:231], v239 offset:11264
    v_cvt_pk_bf16_f32 v181, v162, v163
    v_mfma_f32_16x16x16_bf16 v[156:159], v[34:35], v[142:143], v[156:159]
    ds_read_b128 v[160:163], v236
    v_bfe_u32 v236, s74, v233, 4
    v_mfma_f32_16x16x32_bf16 v[216:219], a[232:235], a[220:223], v[216:219]
    v_mad_u32_u24 v236, v236, s40, v231
    v_fma_f32 v165, v165, s37, -v250
    v_mfma_f32_16x16x32_bf16 v[204:207], a[232:235], a[224:227], v[204:207]
    s_waitcnt lgkmcnt(7)
    ds_read_b64_tr_b16 a[232:233], v240 offset:13824
    ds_read_b64_tr_b16 a[234:235], v240 offset:15360
    v_fma_f32 v166, v166, s37, -v250
    v_fma_f32 v167, v167, s37, -v250
    v_exp_f32 v164, v164
    v_mfma_f32_16x16x32_bf16 v[200:203], a[248:251], a[244:247], v[200:203]
    s_waitcnt lgkmcnt(7)
    v_exp_f32 v165, v165
    v_mfma_f32_16x16x32_bf16 v[220:223], a[236:239], a[220:223], v[220:223]
    ds_read_b64_tr_b16 a[220:221], v241 offset:12288
    ds_read_b64_tr_b16 a[222:223], v241 offset:16896
    v_mfma_f32_16x16x32_bf16 v[208:211], a[236:239], a[224:227], v[208:211]
    s_waitcnt lgkmcnt(8)
    ds_read_b128 a[224:227], v239 offset:5120
    ds_read_b64_tr_b16 a[236:237], v240 offset:13832
    v_mfma_f32_16x16x32_bf16 v[212:215], a[248:251], a[240:243], v[212:215]
    s_waitcnt lgkmcnt(8)
    ds_read_b64_tr_b16 a[238:239], v240 offset:15368
    ds_read_b128 a[248:251], v224 offset:64
    v_mfma_f32_16x16x32_bf16 v[216:219], a[252:255], a[240:243], v[216:219]
    v_exp_f32 v166, v166
    v_mfma_f32_16x16x32_bf16 v[204:207], a[252:255], a[244:247], v[204:207]
    s_waitcnt lgkmcnt(8)
    ds_read_b128 a[252:255], v224 offset:128
    v_cvt_pk_bf16_f32 v182, v164, v165
    v_mfma_f32_16x16x32_bf16 v[160:163], v[36:39], v[138:141], v[160:163]
    s_waitcnt lgkmcnt(7)
    v_exp_f32 v167, v167
    v_fma_f32 v168, v168, s37, -v250
    v_cvt_pk_bf16_f32 v183, v166, v167
    ds_read_b128 v[164:167], v234
    v_mfma_f32_16x16x32_bf16 v[200:203], a[232:235], a[228:231], v[200:203]
    v_bfe_u32 v234, s77, v232, 4
    v_fma_f32 v169, v169, s37, -v250
    v_mfma_f32_16x16x32_bf16 v[196:199], a[216:219], v[180:183], v[196:199]
    v_fma_f32 v170, v170, s37, -v250
    v_fma_f32 v171, v171, s37, -v250
    v_mfma_f32_16x16x32_bf16 v[184:187], v[70:73], v[180:183], v[184:187]
    v_exp_f32 v168, v168
    v_mfma_f32_16x16x32_bf16 v[188:191], v[92:95], v[180:183], v[188:191]
    v_cvt_pk_bf16_f32 v200, v200, v201
    v_cvt_pk_bf16_f32 v201, v202, v203
    v_mfma_f32_16x16x32_bf16 v[192:195], v[114:117], v[180:183], v[192:195]
    v_exp_f32 v169, v169
    v_mfma_f32_16x16x16_bf16 v[160:163], v[40:41], v[142:143], v[160:163]
    s_waitcnt lgkmcnt(4)
    v_exp_f32 v170, v170
    v_mfma_f32_16x16x32_bf16 v[220:223], a[220:223], a[240:243], v[220:223]
    ds_read_b64_tr_b16 a[240:241], v241 offset:13824
    ds_read_b64_tr_b16 a[242:243], v241 offset:15360
    v_mfma_f32_16x16x32_bf16 v[208:211], a[220:223], a[244:247], v[208:211]
    ds_read_b128 a[244:247], v224
    ds_read_b128 a[220:223], v224 offset:192
    v_mfma_f32_16x16x32_bf16 v[212:215], a[232:235], a[224:227], v[212:215]
    s_waitcnt lgkmcnt(4)
    ds_read_b128 a[232:235], v224 offset:3072
    v_cvt_pk_bf16_f32 v176, v168, v169
    v_mfma_f32_16x16x32_bf16 v[164:167], v[42:45], v[138:141], v[164:167]
    v_exp_f32 v171, v171
    v_mfma_f32_16x16x32_bf16 v[216:219], a[236:239], a[224:227], v[216:219]
    v_cvt_pk_bf16_f32 v177, v170, v171
    v_fma_f32 v172, v172, s37, -v250
    v_mfma_f32_16x16x32_bf16 v[204:207], a[236:239], a[228:231], v[204:207]
    ds_read_b128 v[168:171], v235
    v_cvt_pk_bf16_f32 v212, v212, v213
    v_mfma_f32_16x16x16_bf16 v[164:167], v[46:47], v[142:143], v[164:167]
    s_waitcnt lgkmcnt(4)
    v_cvt_pk_bf16_f32 v213, v214, v215
    ds_read_b128 a[236:239], v224 offset:3136
    v_cvt_pk_bf16_f32 v214, v216, v217
    v_cvt_pk_bf16_f32 v215, v218, v219
    buffer_store_dwordx4 v[212:215], v242, s[20:23], s58 offen sc0 sc1
    v_mfma_f32_16x16x32_bf16 v[220:223], a[240:243], a[224:227], v[220:223]
    s_waitcnt lgkmcnt(4)
    v_cvt_pk_bf16_f32 v202, v204, v205
    v_cvt_pk_bf16_f32 v203, v206, v207
    v_mfma_f32_16x16x32_bf16 v[208:211], a[240:243], a[228:231], v[208:211]
    s_barrier
    buffer_store_dwordx4 v[200:203], v244, s[20:23], s59 offen sc0 sc1
    v_mfma_f32_16x16x32_bf16 v[212:215], a[0:3], a[244:247], 0
    ds_read_b128 a[224:227], v224 offset:256
    ds_read_b128 a[228:231], v224 offset:320
    v_mfma_f32_16x16x32_bf16 v[216:219], a[4:7], a[244:247], 0
    s_waitcnt lgkmcnt(3)
    ds_read_b128 a[240:243], v224 offset:3200
    v_cvt_pk_bf16_f32 v220, v220, v221
    v_mfma_f32_16x16x32_bf16 v[168:171], v[60:63], v[138:141], v[168:171]
    v_cvt_pk_bf16_f32 v221, v222, v223
    v_cvt_pk_bf16_f32 v208, v208, v209
    v_mfma_f32_16x16x32_bf16 v[200:203], a[244:247], a[72:75], 0
    buffer_store_dwordx2 v[220:221], v243, s[20:23], s58 offen sc0 sc1
    v_mfma_f32_16x16x32_bf16 v[220:223], a[8:11], a[244:247], 0
    s_add_u32 s58, s51, 0x150000
    v_cvt_pk_bf16_f32 v209, v210, v211
    v_mad_u32_u24 v235, v234, s40, v229
    v_mfma_f32_16x16x16_bf16 v[168:171], v[64:65], v[142:143], v[168:171]
    buffer_store_dwordx2 v[208:209], v245, s[20:23], s59 offen sc0 sc1
    v_mfma_f32_16x16x32_bf16 v[204:207], a[244:247], a[76:79], 0
    s_add_u32 s59, s51, 0x151800
    v_mad_u32_u24 v234, v234, s40, v228
    v_fma_f32 v173, v173, s37, -v250
    v_mfma_f32_16x16x32_bf16 v[208:211], a[244:247], a[80:83], 0
    ds_read_b128 a[244:247], v224 offset:3264
    v_fma_f32 v174, v174, s37, -v250
    v_mfma_f32_16x16x32_bf16 v[212:215], a[12:15], a[248:251], v[212:215]
    v_fma_f32 v175, v175, s37, -v250
    v_fma_f32 v144, v144, s37, -v250
    v_mfma_f32_16x16x32_bf16 v[216:219], a[16:19], a[248:251], v[216:219]
    v_exp_f32 v172, v172
    v_mfma_f32_16x16x32_bf16 v[220:223], a[20:23], a[248:251], v[220:223]
    v_exp_f32 v173, v173
    v_mfma_f32_16x16x32_bf16 v[200:203], a[248:251], a[84:87], v[200:203]
    v_exp_f32 v174, v174
    v_mfma_f32_16x16x32_bf16 v[204:207], a[248:251], a[88:91], v[204:207]
    v_exp_f32 v175, v175
    v_mfma_f32_16x16x32_bf16 v[208:211], a[248:251], a[92:95], v[208:211]
    ds_read_b128 a[248:251], v224 offset:3328
    v_cvt_pk_bf16_f32 v178, v172, v173
    v_mfma_f32_16x16x32_bf16 v[212:215], a[24:27], a[252:255], v[212:215]
    v_cvt_pk_bf16_f32 v179, v174, v175
    v_fma_f32 v145, v145, s37, -v250
    v_mfma_f32_16x16x32_bf16 v[216:219], a[28:31], a[252:255], v[216:219]
    ds_read_b128 v[172:175], v236
    v_bfe_u32 v236, s67, v232, 4
    v_mfma_f32_16x16x32_bf16 v[196:199], a[216:219], v[176:179], v[196:199]
    v_fma_f32 v146, v146, s37, -v250
    v_fma_f32 v147, v147, s37, -v250
    v_mfma_f32_16x16x32_bf16 v[184:187], v[74:77], v[176:179], v[184:187]
    v_exp_f32 v144, v144
    v_mfma_f32_16x16x32_bf16 v[188:191], v[96:99], v[176:179], v[188:191]
    v_exp_f32 v145, v145
    v_mfma_f32_16x16x32_bf16 v[192:195], v[118:121], v[176:179], v[192:195]
    v_exp_f32 v146, v146
    v_mfma_f32_16x16x32_bf16 v[220:223], a[32:35], a[252:255], v[220:223]
    v_exp_f32 v147, v147
    v_mfma_f32_16x16x32_bf16 v[200:203], a[252:255], a[96:99], v[200:203]
    v_cvt_pk_bf16_f32 v180, v144, v145
    v_cvt_pk_bf16_f32 v181, v146, v147
    v_mfma_f32_16x16x32_bf16 v[204:207], a[252:255], a[100:103], v[204:207]
    ds_read_b128 v[144:147], v235
    v_bfe_u32 v235, s62, v232, 4
    v_mfma_f32_16x16x32_bf16 v[208:211], a[252:255], a[104:107], v[208:211]
    ds_read_b128 a[252:255], v224 offset:3392
    v_fma_f32 v148, v148, s37, -v250
    v_mfma_f32_16x16x32_bf16 v[212:215], a[36:39], a[220:223], v[212:215]
    s_waitcnt lgkmcnt(2)
    v_fma_f32 v149, v149, s37, -v250
    v_fma_f32 v150, v150, s37, -v250
    v_mfma_f32_16x16x32_bf16 v[172:175], v[48:51], v[138:141], v[172:175]
    v_fma_f32 v151, v151, s37, -v250
    v_max3_f32 v248, v152, v153, v154
    v_mfma_f32_16x16x32_bf16 v[216:219], a[40:43], a[220:223], v[216:219]
    v_exp_f32 v148, v148
    v_mfma_f32_16x16x32_bf16 v[220:223], a[44:47], a[220:223], v[220:223]
    v_exp_f32 v149, v149
    v_mfma_f32_16x16x16_bf16 v[172:175], v[52:53], v[142:143], v[172:175]
    v_exp_f32 v150, v150
    v_mfma_f32_16x16x32_bf16 v[200:203], a[220:223], a[108:111], v[200:203]
    v_exp_f32 v151, v151
    v_mfma_f32_16x16x32_bf16 v[204:207], a[220:223], a[112:115], v[204:207]
    v_cvt_pk_bf16_f32 v182, v148, v149
    v_cvt_pk_bf16_f32 v183, v150, v151
    v_mfma_f32_16x16x32_bf16 v[208:211], a[220:223], a[116:119], v[208:211]
    ds_read_b128 v[148:151], v234
    v_mad_u32_u24 v234, v236, s40, v228
    v_mfma_f32_16x16x32_bf16 v[196:199], a[216:219], v[180:183], v[196:199]
    ds_read_b128 a[220:223], v225 offset:41792
    v_mad_u32_u24 v236, v236, s40, v229
    v_mfma_f32_16x16x32_bf16 v[184:187], v[78:81], v[180:183], v[184:187]
    v_max3_f32 v249, v155, v156, v157
    v_max3_f32 v248, v248, v158, v159
    v_mfma_f32_16x16x32_bf16 v[188:191], v[100:103], v[180:183], v[188:191]
    v_max3_f32 v249, v249, v160, v161
    v_max3_f32 v248, v248, v162, v163
    v_mfma_f32_16x16x32_bf16 v[192:195], v[122:125], v[180:183], v[192:195]
    s_waitcnt lgkmcnt(2)
    v_rcp_f32 v197, v196
    v_mfma_f32_16x16x32_bf16 v[144:147], v[30:33], v[132:135], v[144:147]
    v_mul_f32 v184, v184, v197
    v_mul_f32 v185, v185, v197
    v_mfma_f32_16x16x32_bf16 v[212:215], a[48:51], a[224:227], v[212:215]
    v_cvt_pk_bf16_f32 v184, v184, v185
    v_mul_f32 v186, v186, v197
    v_mfma_f32_16x16x32_bf16 v[216:219], a[52:55], a[224:227], v[216:219]
    v_mul_f32 v187, v187, v197
    v_cvt_pk_bf16_f32 v185, v186, v187
    v_mfma_f32_16x16x16_bf16 v[144:147], v[34:35], v[136:137], v[144:147]
    v_mul_f32 v188, v188, v197
    v_mul_f32 v189, v189, v197
    v_mfma_f32_16x16x32_bf16 v[220:223], a[56:59], a[224:227], v[220:223]
    s_waitcnt lgkmcnt(1)
    v_cvt_pk_bf16_f32 v186, v188, v189
    v_mul_f32 v190, v190, v197
    v_mfma_f32_16x16x32_bf16 v[148:151], v[6:9], v[132:135], v[148:151]
    v_mul_f32 v191, v191, v197
    v_cvt_pk_bf16_f32 v187, v190, v191
    v_mfma_f32_16x16x32_bf16 v[200:203], a[224:227], a[120:123], v[200:203]
    v_mul_f32 v192, v192, v197
    v_mul_f32 v193, v193, v197
    v_mfma_f32_16x16x32_bf16 v[204:207], a[224:227], a[124:127], v[204:207]
    v_cvt_pk_bf16_f32 v188, v192, v193
    v_mul_f32 v194, v194, v197
    v_mfma_f32_16x16x16_bf16 v[148:151], v[10:11], v[136:137], v[148:151]
    v_mul_f32 v195, v195, v197
    v_cvt_pk_bf16_f32 v189, v194, v195
    v_mfma_f32_16x16x32_bf16 v[208:211], a[224:227], a[128:131], v[208:211]
    ds_write_b128 v237, v[184:187]
    v_mfma_f32_16x16x32_bf16 v[212:215], a[60:63], a[228:231], v[212:215]
    ds_write_b64 v238, v[188:189]
    v_mfma_f32_16x16x32_bf16 v[216:219], a[64:67], a[228:231], v[216:219]
    ds_read_b128 a[224:227], v225 offset:41856
    v_max3_f32 v249, v249, v164, v165
    v_mfma_f32_16x16x32_bf16 v[220:223], a[68:71], a[228:231], v[220:223]
    v_max3_f32 v248, v248, v166, v167
    v_max3_f32 v249, v249, v168, v169
    v_mfma_f32_16x16x32_bf16 v[200:203], a[228:231], a[132:135], v[200:203]
    v_cvt_pk_bf16_f32 v0, v212, v213
    v_cvt_pk_bf16_f32 v1, v214, v215
    v_mfma_f32_16x16x32_bf16 v[204:207], a[228:231], a[136:139], v[204:207]
    v_cvt_pk_bf16_f32 v2, v216, v217
    v_cvt_pk_bf16_f32 v3, v218, v219
    v_mfma_f32_16x16x32_bf16 v[208:211], a[228:231], a[140:143], v[208:211]
    v_cvt_pk_bf16_f32 v4, v220, v221
    v_cvt_pk_bf16_f32 v5, v222, v223
    v_mfma_f32_16x16x32_bf16 v[212:215], a[0:3], a[232:235], 0
    v_cvt_pk_bf16_f32 v66, v200, v201
    v_cvt_pk_bf16_f32 v67, v202, v203
    v_mfma_f32_16x16x32_bf16 v[216:219], a[4:7], a[232:235], 0
    v_cvt_pk_bf16_f32 v88, v204, v205
    v_cvt_pk_bf16_f32 v89, v206, v207
    v_mfma_f32_16x16x32_bf16 v[220:223], a[8:11], a[232:235], 0
    v_cvt_pk_bf16_f32 v110, v208, v209
    v_cvt_pk_bf16_f32 v111, v210, v211
    v_mfma_f32_16x16x32_bf16 v[200:203], a[232:235], a[72:75], 0
    ds_read_b128 a[228:231], v225 offset:41920
    v_max3_f32 v248, v248, v170, v171
    v_mfma_f32_16x16x32_bf16 v[204:207], a[232:235], a[76:79], 0
    v_max3_f32 v249, v249, v172, v173
    v_max3_f32 v248, v248, v174, v175
    v_mfma_f32_16x16x32_bf16 v[208:211], a[232:235], a[80:83], 0
    ds_read_b128 a[232:235], v225 offset:41984
    v_max_f32 v248, v248, v249
    v_mfma_f32_16x16x32_bf16 v[212:215], a[12:15], a[236:239], v[212:215]
    v_mov_b32 v249, v248
    v_mfma_f32_16x16x32_bf16 v[216:219], a[16:19], a[236:239], v[216:219]
    v_mfma_f32_16x16x32_bf16 v[220:223], a[20:23], a[236:239], v[220:223]
    v_permlane16_swap_b32 v248, v249
    v_mfma_f32_16x16x32_bf16 v[200:203], a[236:239], a[84:87], v[200:203]
    v_max_f32 v248, v248, v249
    v_mov_b32 v249, v248
    v_mfma_f32_16x16x32_bf16 v[204:207], a[236:239], a[88:91], v[204:207]
    v_mfma_f32_16x16x32_bf16 v[208:211], a[236:239], a[92:95], v[208:211]
    ds_read_b128 a[236:239], v225 offset:42048
    v_mfma_f32_16x16x32_bf16 v[212:215], a[24:27], a[240:243], v[212:215]
    v_permlane32_swap_b32 v248, v249
    v_mfma_f32_16x16x32_bf16 v[216:219], a[28:31], a[240:243], v[216:219]
    v_max_f32 v248, v248, v249
    v_mul_f32 v250, s37, v248
    v_mfma_f32_16x16x32_bf16 v[220:223], a[32:35], a[240:243], v[220:223]
    v_fma_f32 v152, v152, s37, -v250
    v_fma_f32 v153, v153, s37, -v250
    v_mfma_f32_16x16x32_bf16 v[200:203], a[240:243], a[96:99], v[200:203]
    v_fma_f32 v154, v154, s37, -v250
    v_fma_f32 v155, v155, s37, -v250
    v_mfma_f32_16x16x32_bf16 v[204:207], a[240:243], a[100:103], v[204:207]
    v_exp_f32 v152, v152
    v_mfma_f32_16x16x32_bf16 v[208:211], a[240:243], a[104:107], v[208:211]
    ds_read_b128 a[240:243], v225 offset:42112
    v_fma_f32 v156, v156, s37, -v250
    v_mfma_f32_16x16x32_bf16 v[212:215], a[36:39], a[244:247], v[212:215]
    v_exp_f32 v153, v153
    v_mfma_f32_16x16x32_bf16 v[216:219], a[40:43], a[244:247], v[216:219]
    v_exp_f32 v154, v154
    v_mfma_f32_16x16x32_bf16 v[220:223], a[44:47], a[244:247], v[220:223]
    v_exp_f32 v155, v155
    v_mfma_f32_16x16x32_bf16 v[200:203], a[244:247], a[108:111], v[200:203]
    v_cvt_pk_bf16_f32 v176, v152, v153
    v_cvt_pk_bf16_f32 v177, v154, v155
    v_mfma_f32_16x16x32_bf16 v[204:207], a[244:247], a[112:115], v[204:207]
    ds_read_b128 v[152:155], v234
    v_bfe_u32 v234, s78, v232, 4
    v_mfma_f32_16x16x32_bf16 v[208:211], a[244:247], a[116:119], v[208:211]
    ds_read_b128 a[244:247], v226
    v_fma_f32 v157, v157, s37, -v250
    v_mfma_f32_16x16x32_bf16 v[212:215], a[48:51], a[248:251], v[212:215]
    v_fma_f32 v158, v158, s37, -v250
    v_fma_f32 v159, v159, s37, -v250
    v_mfma_f32_16x16x32_bf16 v[216:219], a[52:55], a[248:251], v[216:219]
    v_exp_f32 v156, v156
    v_mfma_f32_16x16x32_bf16 v[220:223], a[56:59], a[248:251], v[220:223]
    v_exp_f32 v157, v157
    v_mfma_f32_16x16x32_bf16 v[200:203], a[248:251], a[120:123], v[200:203]
    v_exp_f32 v158, v158
    v_mfma_f32_16x16x32_bf16 v[204:207], a[248:251], a[124:127], v[204:207]
    v_exp_f32 v159, v159
    v_mfma_f32_16x16x32_bf16 v[208:211], a[248:251], a[128:131], v[208:211]
    ds_read_b128 a[248:251], v226 offset:64
    v_cvt_pk_bf16_f32 v178, v156, v157
    v_mfma_f32_16x16x32_bf16 v[212:215], a[60:63], a[252:255], v[212:215]
    v_cvt_pk_bf16_f32 v179, v158, v159
    v_fma_f32 v160, v160, s37, -v250
    v_mfma_f32_16x16x32_bf16 v[216:219], a[64:67], a[252:255], v[216:219]
    ds_read_b128 v[156:159], v236
    v_mad_u32_u24 v236, v235, s40, v229
    v_mfma_f32_16x16x32_bf16 v[196:199], a[216:219], v[176:179], 0
    v_mad_u32_u24 v235, v235, s40, v228
    v_fma_f32 v161, v161, s37, -v250
    v_mfma_f32_16x16x32_bf16 v[184:187], v[68:71], v[176:179], 0
    v_cvt_pk_bf16_f32 v24, v212, v213
    v_cvt_pk_bf16_f32 v25, v214, v215
    v_mfma_f32_16x16x32_bf16 v[188:191], v[90:93], v[176:179], 0
    v_cvt_pk_bf16_f32 v26, v216, v217
    v_cvt_pk_bf16_f32 v27, v218, v219
    v_mfma_f32_16x16x32_bf16 v[192:195], v[112:115], v[176:179], 0
    s_waitcnt lgkmcnt(2)
    v_fma_f32 v162, v162, s37, -v250
    v_fma_f32 v163, v163, s37, -v250
    v_mfma_f32_16x16x32_bf16 v[152:155], v[12:15], v[132:135], v[152:155]
    v_exp_f32 v160, v160
    v_mfma_f32_16x16x32_bf16 v[220:223], a[68:71], a[252:255], v[220:223]
    v_exp_f32 v161, v161
    v_mfma_f32_16x16x32_bf16 v[200:203], a[252:255], a[132:135], v[200:203]
    v_exp_f32 v162, v162
    v_mfma_f32_16x16x32_bf16 v[204:207], a[252:255], a[136:139], v[204:207]
    v_exp_f32 v163, v163
    v_mfma_f32_16x16x16_bf16 v[152:155], v[16:17], v[136:137], v[152:155]
    s_waitcnt lgkmcnt(0)
    v_cvt_pk_bf16_f32 v180, v160, v161
    v_cvt_pk_bf16_f32 v181, v162, v163
    v_mfma_f32_16x16x32_bf16 v[156:159], v[36:39], v[132:135], v[156:159]
    v_cvt_pk_bf16_f32 v28, v220, v221
    v_cvt_pk_bf16_f32 v29, v222, v223
    v_mfma_f32_16x16x32_bf16 v[208:211], a[252:255], a[140:143], v[208:211]
    v_cvt_pk_bf16_f32 v68, v200, v201
    v_cvt_pk_bf16_f32 v69, v202, v203
    v_mfma_f32_16x16x32_bf16 v[212:215], a[144:147], a[220:223], 0
    v_cvt_pk_bf16_f32 v90, v204, v205
    v_cvt_pk_bf16_f32 v91, v206, v207
    v_mfma_f32_16x16x16_bf16 v[156:159], v[40:41], v[136:137], v[156:159]
    ds_read_b128 v[160:163], v236
    ds_read_b128 a[252:255], v226 offset:128
    v_mfma_f32_16x16x32_bf16 v[216:219], a[148:151], a[220:223], 0
    v_cvt_pk_bf16_f32 v112, v208, v209
    v_cvt_pk_bf16_f32 v113, v210, v211
    v_mfma_f32_16x16x32_bf16 v[220:223], a[152:155], a[220:223], 0
    ds_read_b128 a[220:223], v226 offset:192
    v_bfe_u32 v236, s78, v232, 4
    v_mfma_f32_16x16x32_bf16 v[212:215], a[156:159], a[224:227], v[212:215]
    v_mad_u32_u24 v236, v236, s40, v230
    v_fma_f32 v164, v164, s37, -v250
    v_mfma_f32_16x16x32_bf16 v[216:219], a[160:163], a[224:227], v[216:219]
    v_fma_f32 v165, v165, s37, -v250
    v_fma_f32 v166, v166, s37, -v250
    v_mfma_f32_16x16x32_bf16 v[220:223], a[164:167], a[224:227], v[220:223]
    ds_read_b128 a[224:227], v226 offset:256
    v_fma_f32 v167, v167, s37, -v250
    v_mfma_f32_16x16x32_bf16 v[212:215], a[168:171], a[228:231], v[212:215]
    v_exp_f32 v164, v164
    v_mfma_f32_16x16x32_bf16 v[216:219], a[172:175], a[228:231], v[216:219]
    v_exp_f32 v165, v165
    v_mfma_f32_16x16x32_bf16 v[220:223], a[176:179], a[228:231], v[220:223]
    ds_read_b128 a[228:231], v226 offset:320
    v_cvt_pk_bf16_f32 v182, v164, v165
    v_mfma_f32_16x16x32_bf16 v[212:215], a[180:183], a[232:235], v[212:215]
    s_waitcnt lgkmcnt(4)
    v_exp_f32 v166, v166
    v_mfma_f32_16x16x32_bf16 v[160:163], v[42:45], v[132:135], v[160:163]
    v_exp_f32 v167, v167
    v_mfma_f32_16x16x32_bf16 v[216:219], a[184:187], a[232:235], v[216:219]
    v_cvt_pk_bf16_f32 v183, v166, v167
    v_fma_f32 v168, v168, s37, -v250
    v_mfma_f32_16x16x32_bf16 v[220:223], a[188:191], a[232:235], v[220:223]
    ds_read_b128 v[164:167], v235
    v_mad_u32_u24 v235, v234, s40, v228
    v_mfma_f32_16x16x32_bf16 v[196:199], a[216:219], v[180:183], v[196:199]
    v_mad_u32_u24 v234, v234, s40, v229
    v_fma_f32 v169, v169, s37, -v250
    v_mfma_f32_16x16x32_bf16 v[184:187], v[76:79], v[180:183], v[184:187]
    v_fma_f32 v170, v170, s37, -v250
    v_fma_f32 v171, v171, s37, -v250
    v_mfma_f32_16x16x32_bf16 v[188:191], v[98:101], v[180:183], v[188:191]
    v_exp_f32 v168, v168
    v_mfma_f32_16x16x32_bf16 v[192:195], v[120:123], v[180:183], v[192:195]
    v_exp_f32 v169, v169
    v_mfma_f32_16x16x16_bf16 v[160:163], v[46:47], v[136:137], v[160:163]
    v_exp_f32 v170, v170
    v_mfma_f32_16x16x32_bf16 v[212:215], a[192:195], a[236:239], v[212:215]
    v_exp_f32 v171, v171
    v_mfma_f32_16x16x32_bf16 v[216:219], a[196:199], a[236:239], v[216:219]
    v_cvt_pk_bf16_f32 v176, v168, v169
    v_cvt_pk_bf16_f32 v177, v170, v171
    v_mfma_f32_16x16x32_bf16 v[220:223], a[200:203], a[236:239], v[220:223]
    ds_read_b128 v[168:171], v235
    v_bfe_u32 v235, s67, v232, 4
    v_mfma_f32_16x16x16_bf16 v[196:199], a[216:217], v[176:177], v[196:199]
    v_mad_u32_u24 v235, v235, s40, v230
    v_fma_f32 v172, v172, s37, -v250
    v_mfma_f32_16x16x16_bf16 v[184:187], v[86:87], v[176:177], v[184:187]
    v_fma_f32 v173, v173, s37, -v250
    v_fma_f32 v174, v174, s37, -v250
    v_mfma_f32_16x16x16_bf16 v[188:191], v[108:109], v[176:177], v[188:191]
    v_fma_f32 v175, v175, s37, -v250
    v_max3_f32 v248, v144, v145, v146
    v_mfma_f32_16x16x16_bf16 v[192:195], v[130:131], v[176:177], v[192:195]
    s_waitcnt lgkmcnt(1)
    v_exp_f32 v172, v172
    v_mfma_f32_16x16x32_bf16 v[164:167], v[18:21], v[132:135], v[164:167]
    v_exp_f32 v173, v173
    v_mfma_f32_16x16x32_bf16 v[212:215], a[204:207], a[240:243], v[212:215]
    v_exp_f32 v174, v174
    v_mfma_f32_16x16x32_bf16 v[216:219], a[208:211], a[240:243], v[216:219]
    v_exp_f32 v175, v175
    v_mfma_f32_16x16x32_bf16 v[220:223], a[212:215], a[240:243], v[220:223]
    v_cvt_pk_bf16_f32 v180, v172, v173
    v_cvt_pk_bf16_f32 v181, v174, v175
    v_mfma_f32_16x16x16_bf16 v[164:167], v[22:23], v[136:137], v[164:167]
    ds_read_b128 v[172:175], v234
    v_cvt_pk_bf16_f32 v138, v212, v213
    v_mfma_f32_16x16x16_bf16 v[196:199], a[216:217], v[180:181], v[196:199]
    v_cvt_pk_bf16_f32 v139, v214, v215
    v_cvt_pk_bf16_f32 v140, v216, v217
    v_mfma_f32_16x16x16_bf16 v[184:187], v[82:83], v[180:181], v[184:187]
    v_cvt_pk_bf16_f32 v141, v218, v219
    v_cvt_pk_bf16_f32 v142, v220, v221
    v_mfma_f32_16x16x16_bf16 v[188:191], v[104:105], v[180:181], v[188:191]
    v_cvt_pk_bf16_f32 v143, v222, v223
    v_bfe_u32 v234, s77, v232, 4
    v_mfma_f32_16x16x16_bf16 v[192:195], v[126:127], v[180:181], v[192:195]
    s_waitcnt lgkmcnt(1)
    v_rcp_f32 v197, v196
    v_mfma_f32_16x16x32_bf16 v[168:171], v[0:3], v[132:135], v[168:171]
    v_mul_f32 v184, v184, v197
    v_mul_f32 v185, v185, v197
    v_mfma_f32_16x16x32_bf16 v[200:203], a[144:147], a[244:247], 0
    v_cvt_pk_bf16_f32 v184, v184, v185
    v_mul_f32 v186, v186, v197
    v_mfma_f32_16x16x32_bf16 v[204:207], a[148:151], a[244:247], 0
    v_mul_f32 v187, v187, v197
    v_cvt_pk_bf16_f32 v185, v186, v187
    v_mfma_f32_16x16x16_bf16 v[168:171], v[4:5], v[136:137], v[168:171]
    v_mul_f32 v188, v188, v197
    v_mul_f32 v189, v189, v197
    v_mfma_f32_16x16x32_bf16 v[208:211], a[152:155], a[244:247], 0
    s_waitcnt lgkmcnt(0)
    v_cvt_pk_bf16_f32 v186, v188, v189
    v_mul_f32 v190, v190, v197
    v_mfma_f32_16x16x32_bf16 v[172:175], v[24:27], v[132:135], v[172:175]
    v_mul_f32 v191, v191, v197
    v_cvt_pk_bf16_f32 v187, v190, v191
    v_mfma_f32_16x16x32_bf16 v[200:203], a[156:159], a[248:251], v[200:203]
    v_mul_f32 v192, v192, v197
    v_mul_f32 v193, v193, v197
    v_mfma_f32_16x16x32_bf16 v[204:207], a[160:163], a[248:251], v[204:207]
    v_cvt_pk_bf16_f32 v188, v192, v193
    v_mul_f32 v194, v194, v197
    v_mfma_f32_16x16x16_bf16 v[172:175], v[28:29], v[136:137], v[172:175]
    v_mul_f32 v195, v195, v197
    v_cvt_pk_bf16_f32 v189, v194, v195
    v_mfma_f32_16x16x32_bf16 v[208:211], a[164:167], a[248:251], v[208:211]
    ds_write_b128 v237, v[184:187] offset:6144
    v_mfma_f32_16x16x32_bf16 v[200:203], a[168:171], a[252:255], v[200:203]
    ds_write_b64 v238, v[188:189] offset:6144
    v_mfma_f32_16x16x32_bf16 v[204:207], a[172:175], a[252:255], v[204:207]
    v_mad_u32_u24 v234, v234, s40, v230
    v_max3_f32 v249, v147, v148, v149
    v_mfma_f32_16x16x32_bf16 v[208:211], a[176:179], a[252:255], v[208:211]
    v_max3_f32 v248, v248, v150, v151
    v_max3_f32 v249, v249, v152, v153
    v_mfma_f32_16x16x32_bf16 v[200:203], a[180:183], a[220:223], v[200:203]
    v_max3_f32 v248, v248, v154, v155
    v_max3_f32 v249, v249, v156, v157
    v_mfma_f32_16x16x32_bf16 v[204:207], a[184:187], a[220:223], v[204:207]
    v_max3_f32 v248, v248, v158, v159
    v_max3_f32 v249, v249, v160, v161
    v_mfma_f32_16x16x32_bf16 v[208:211], a[188:191], a[220:223], v[208:211]
    v_max3_f32 v248, v248, v162, v163
    v_max3_f32 v249, v249, v164, v165
    v_mfma_f32_16x16x32_bf16 v[200:203], a[192:195], a[224:227], v[200:203]
    v_max3_f32 v248, v248, v166, v167
    v_max3_f32 v249, v249, v168, v169
    v_mfma_f32_16x16x32_bf16 v[204:207], a[196:199], a[224:227], v[204:207]
    v_max3_f32 v248, v248, v170, v171
    v_max3_f32 v249, v249, v172, v173
    v_mfma_f32_16x16x32_bf16 v[208:211], a[200:203], a[224:227], v[208:211]
    s_waitcnt vmcnt(4) lgkmcnt(0)
    v_max3_f32 v248, v248, v174, v175
    v_max_f32 v248, v248, v249
    v_mfma_f32_16x16x32_bf16 v[200:203], a[204:207], a[228:231], v[200:203]
    s_barrier
    ds_read_b128 a[232:235], v227
    ds_read_b128 a[236:239], v227 offset:64
    v_mfma_f32_16x16x32_bf16 v[204:207], a[208:211], a[228:231], v[204:207]
    ds_read_b128 a[240:243], v227 offset:128
    ds_read_b128 a[244:247], v227 offset:192
    v_mfma_f32_16x16x32_bf16 v[208:211], a[212:215], a[228:231], v[208:211]
    s_waitcnt lgkmcnt(3)
    ds_read_b128 a[248:251], v227 offset:256
    v_cvt_pk_bf16_f32 v132, v200, v201
    v_cvt_pk_bf16_f32 v133, v202, v203
    ds_read_b128 a[252:255], v227 offset:320
    ds_read_b128 a[220:223], v239
    v_cvt_pk_bf16_f32 v134, v204, v205
    v_cvt_pk_bf16_f32 v135, v206, v207
    ds_read_b128 a[224:227], v239 offset:6144
    v_cvt_pk_bf16_f32 v136, v208, v209
    v_cvt_pk_bf16_f32 v137, v210, v211
    ds_read_b64_tr_b16 a[228:229], v240
    ds_read_b64_tr_b16 a[230:231], v240 offset:1536
    v_mov_b32 v249, v248
    s_nop 1
    v_permlane16_swap_b32 v248, v249
    v_max_f32 v248, v248, v249
    v_mov_b32 v249, v248
    s_nop 1
    v_permlane32_swap_b32 v248, v249
    v_mfma_f32_16x16x32_bf16 v[212:215], a[0:3], a[232:235], 0
    v_max_f32 v248, v248, v249
    v_mul_f32 v250, s37, v248
    v_mfma_f32_16x16x32_bf16 v[216:219], a[4:7], a[232:235], 0
    v_fma_f32 v144, v144, s37, -v250
    v_fma_f32 v145, v145, s37, -v250
    v_mfma_f32_16x16x32_bf16 v[220:223], a[8:11], a[232:235], 0
    v_fma_f32 v146, v146, s37, -v250
    v_fma_f32 v147, v147, s37, -v250
    v_mfma_f32_16x16x32_bf16 v[200:203], a[232:235], a[72:75], 0
    v_exp_f32 v144, v144
    v_mfma_f32_16x16x32_bf16 v[204:207], a[232:235], a[76:79], 0
    v_exp_f32 v145, v145
    v_mfma_f32_16x16x32_bf16 v[208:211], a[232:235], a[80:83], 0
    s_waitcnt lgkmcnt(3)
    ds_read_b64_tr_b16 a[232:233], v240 offset:8
    ds_read_b64_tr_b16 a[234:235], v240 offset:1544
    v_mfma_f32_16x16x32_bf16 v[212:215], a[12:15], a[236:239], v[212:215]
    v_exp_f32 v146, v146
    v_mfma_f32_16x16x32_bf16 v[216:219], a[16:19], a[236:239], v[216:219]
    v_exp_f32 v147, v147
    v_mfma_f32_16x16x32_bf16 v[220:223], a[20:23], a[236:239], v[220:223]
    v_cvt_pk_bf16_f32 v176, v144, v145
    v_cvt_pk_bf16_f32 v177, v146, v147
    v_mfma_f32_16x16x32_bf16 v[200:203], a[236:239], a[84:87], v[200:203]
    ds_read_b128 v[144:147], v236
    v_bfe_u32 v236, s62, v232, 4
    v_mfma_f32_16x16x32_bf16 v[204:207], a[236:239], a[88:91], v[204:207]
    v_mad_u32_u24 v236, v236, s40, v230
    v_fma_f32 v148, v148, s37, -v250
    v_mfma_f32_16x16x32_bf16 v[208:211], a[236:239], a[92:95], v[208:211]
    ds_read_b64_tr_b16 a[236:237], v241
    ds_read_b64_tr_b16 a[238:239], v241 offset:1536
    v_mfma_f32_16x16x32_bf16 v[212:215], a[24:27], a[240:243], v[212:215]
    v_fma_f32 v149, v149, s37, -v250
    v_fma_f32 v150, v150, s37, -v250
    v_mfma_f32_16x16x32_bf16 v[216:219], a[28:31], a[240:243], v[216:219]
    v_fma_f32 v151, v151, s37, -v250
    v_fma_f32 v152, v152, s37, -v250
    v_mfma_f32_16x16x32_bf16 v[220:223], a[32:35], a[240:243], v[220:223]
    v_exp_f32 v148, v148
    v_mfma_f32_16x16x32_bf16 v[200:203], a[240:243], a[96:99], v[200:203]
    v_exp_f32 v149, v149
    v_mfma_f32_16x16x32_bf16 v[204:207], a[240:243], a[100:103], v[204:207]
    v_exp_f32 v150, v150
    v_mfma_f32_16x16x32_bf16 v[208:211], a[240:243], a[104:107], v[208:211]
    ds_read_b128 a[240:243], v239 offset:1024
    v_cvt_pk_bf16_f32 v178, v148, v149
    v_mfma_f32_16x16x32_bf16 v[212:215], a[36:39], a[244:247], v[212:215]
    s_waitcnt lgkmcnt(3)
    v_exp_f32 v151, v151
    v_mfma_f32_16x16x32_bf16 v[144:147], v[24:27], v[138:141], v[144:147]
    v_cvt_pk_bf16_f32 v179, v150, v151
    v_fma_f32 v153, v153, s37, -v250
    v_mfma_f32_16x16x32_bf16 v[216:219], a[40:43], a[244:247], v[216:219]
    ds_read_b128 v[148:151], v234
    v_bfe_u32 v234, s69, v233, 4
    v_mfma_f32_16x16x32_bf16 v[196:199], a[216:219], v[176:179], 0
    v_mad_u32_u24 v234, v234, s40, v231
    v_fma_f32 v154, v154, s37, -v250
    v_mfma_f32_16x16x32_bf16 v[184:187], v[70:73], v[176:179], 0
    v_fma_f32 v155, v155, s37, -v250
    v_fma_f32 v156, v156, s37, -v250
    v_mfma_f32_16x16x32_bf16 v[188:191], v[92:95], v[176:179], 0
    v_exp_f32 v152, v152
    v_mfma_f32_16x16x32_bf16 v[192:195], v[114:117], v[176:179], 0
    v_exp_f32 v153, v153
    v_mfma_f32_16x16x16_bf16 v[144:147], v[28:29], v[142:143], v[144:147]
    v_exp_f32 v154, v154
    v_mfma_f32_16x16x32_bf16 v[220:223], a[44:47], a[244:247], v[220:223]
    v_exp_f32 v155, v155
    v_mfma_f32_16x16x32_bf16 v[200:203], a[244:247], a[108:111], v[200:203]
    v_cvt_pk_bf16_f32 v180, v152, v153
    v_cvt_pk_bf16_f32 v181, v154, v155
    v_mfma_f32_16x16x32_bf16 v[204:207], a[244:247], a[112:115], v[204:207]
    ds_read_b128 v[152:155], v235
    v_bfe_u32 v235, s79, v233, 4
    v_mfma_f32_16x16x32_bf16 v[208:211], a[244:247], a[116:119], v[208:211]
    s_waitcnt lgkmcnt(1)
    ds_read_b128 a[244:247], v239 offset:7168
    v_mad_u32_u24 v235, v235, s40, v231
    v_mfma_f32_16x16x32_bf16 v[148:151], v[30:33], v[138:141], v[148:151]
    v_fma_f32 v157, v157, s37, -v250
    v_fma_f32 v158, v158, s37, -v250
    v_mfma_f32_16x16x32_bf16 v[212:215], a[48:51], a[248:251], v[212:215]
    v_fma_f32 v159, v159, s37, -v250
    v_fma_f32 v160, v160, s37, -v250
    v_mfma_f32_16x16x32_bf16 v[216:219], a[52:55], a[248:251], v[216:219]
    v_exp_f32 v156, v156
    v_mfma_f32_16x16x16_bf16 v[148:151], v[34:35], v[142:143], v[148:151]
    v_exp_f32 v157, v157
    v_mfma_f32_16x16x32_bf16 v[220:223], a[56:59], a[248:251], v[220:223]
    v_exp_f32 v158, v158
    v_mfma_f32_16x16x32_bf16 v[200:203], a[248:251], a[120:123], v[200:203]
    v_exp_f32 v159, v159
    v_mfma_f32_16x16x32_bf16 v[204:207], a[248:251], a[124:127], v[204:207]
    v_cvt_pk_bf16_f32 v182, v156, v157
    v_cvt_pk_bf16_f32 v183, v158, v159
    v_mfma_f32_16x16x32_bf16 v[208:211], a[248:251], a[128:131], v[208:211]
    ds_read_b64_tr_b16 a[248:249], v240 offset:3072
    ds_read_b64_tr_b16 a[250:251], v240 offset:7680
    v_mfma_f32_16x16x32_bf16 v[196:199], a[216:219], v[180:183], v[196:199]
    ds_read_b128 v[156:159], v236
    v_bfe_u32 v236, s80, v233, 4
    v_mfma_f32_16x16x32_bf16 v[184:187], v[74:77], v[180:183], v[184:187]
    v_mad_u32_u24 v236, v236, s40, v231
    v_fma_f32 v161, v161, s37, -v250
    v_mfma_f32_16x16x32_bf16 v[188:191], v[96:99], v[180:183], v[188:191]
    v_fma_f32 v162, v162, s37, -v250
    v_fma_f32 v163, v163, s37, -v250
    v_mfma_f32_16x16x32_bf16 v[192:195], v[118:121], v[180:183], v[192:195]
    s_waitcnt lgkmcnt(3)
    v_exp_f32 v160, v160
    v_mfma_f32_16x16x32_bf16 v[152:155], v[36:39], v[138:141], v[152:155]
    v_exp_f32 v161, v161
    v_mfma_f32_16x16x32_bf16 v[212:215], a[60:63], a[252:255], v[212:215]
    v_exp_f32 v162, v162
    v_mfma_f32_16x16x32_bf16 v[216:219], a[64:67], a[252:255], v[216:219]
    v_exp_f32 v163, v163
    v_mfma_f32_16x16x32_bf16 v[220:223], a[68:71], a[252:255], v[220:223]
    v_cvt_pk_bf16_f32 v176, v160, v161
    v_cvt_pk_bf16_f32 v177, v162, v163
    v_mfma_f32_16x16x16_bf16 v[152:155], v[40:41], v[142:143], v[152:155]
    ds_read_b128 v[160:163], v234
    v_cvt_pk_bf16_f32 v54, v212, v213
    v_mfma_f32_16x16x32_bf16 v[200:203], a[252:255], a[132:135], v[200:203]
    s_waitcnt lgkmcnt(1)
    v_cvt_pk_bf16_f32 v55, v214, v215
    v_cvt_pk_bf16_f32 v56, v216, v217
    v_mfma_f32_16x16x32_bf16 v[156:159], v[42:45], v[138:141], v[156:159]
    v_cvt_pk_bf16_f32 v57, v218, v219
    v_cvt_pk_bf16_f32 v58, v220, v221
    v_mfma_f32_16x16x32_bf16 v[204:207], a[252:255], a[136:139], v[204:207]
    v_cvt_pk_bf16_f32 v59, v222, v223
    v_bfe_u32 v234, s77, v232, 4
    v_mfma_f32_16x16x32_bf16 v[208:211], a[252:255], a[140:143], v[208:211]
    v_cvt_pk_bf16_f32 v84, v200, v201
    v_cvt_pk_bf16_f32 v85, v202, v203
    v_mfma_f32_16x16x16_bf16 v[156:159], v[46:47], v[142:143], v[156:159]
    ds_read_b64_tr_b16 a[252:253], v240 offset:3080
    ds_read_b64_tr_b16 a[254:255], v240 offset:7688
    v_mfma_f32_16x16x32_bf16 v[212:215], a[228:231], a[220:223], 0
    v_cvt_pk_bf16_f32 v106, v204, v205
    v_cvt_pk_bf16_f32 v107, v206, v207
    v_mfma_f32_16x16x32_bf16 v[200:203], a[228:231], a[224:227], 0
    v_cvt_pk_bf16_f32 v128, v208, v209
    v_cvt_pk_bf16_f32 v129, v210, v211
    v_mfma_f32_16x16x32_bf16 v[216:219], a[232:235], a[220:223], 0
    ds_read_b128 a[228:231], v239 offset:8192
    v_fma_f32 v164, v164, s37, -v250
    v_mfma_f32_16x16x32_bf16 v[204:207], a[232:235], a[224:227], 0
    s_waitcnt lgkmcnt(3)
    ds_read_b64_tr_b16 a[232:233], v240 offset:4608
    ds_read_b64_tr_b16 a[234:235], v240 offset:6144
    v_mfma_f32_16x16x32_bf16 v[160:163], v[48:51], v[138:141], v[160:163]
    v_fma_f32 v165, v165, s37, -v250
    v_fma_f32 v166, v166, s37, -v250
    v_mfma_f32_16x16x32_bf16 v[220:223], a[236:239], a[220:223], 0
    ds_read_b64_tr_b16 a[220:221], v241 offset:3072
    ds_read_b64_tr_b16 a[222:223], v241 offset:7680
    v_mfma_f32_16x16x32_bf16 v[208:211], a[236:239], a[224:227], 0
    ds_read_b128 a[224:227], v239 offset:2048
    ds_read_b64_tr_b16 a[236:237], v240 offset:4616
    v_mfma_f32_16x16x16_bf16 v[160:163], v[52:53], v[142:143], v[160:163]
    ds_read_b64_tr_b16 a[238:239], v240 offset:6152
    v_fma_f32 v167, v167, s37, -v250
    v_mfma_f32_16x16x32_bf16 v[212:215], a[248:251], a[240:243], v[212:215]
    v_exp_f32 v164, v164
    v_mfma_f32_16x16x32_bf16 v[200:203], a[248:251], a[244:247], v[200:203]
    s_waitcnt lgkmcnt(8)
    ds_read_b128 a[248:251], v239 offset:9216
    v_fma_f32 v168, v168, s37, -v250
    v_mfma_f32_16x16x32_bf16 v[216:219], a[252:255], a[240:243], v[216:219]
    v_exp_f32 v165, v165
    v_mfma_f32_16x16x32_bf16 v[204:207], a[252:255], a[244:247], v[204:207]
    s_waitcnt lgkmcnt(6)
    ds_read_b64_tr_b16 a[252:253], v240 offset:9216
    ds_read_b64_tr_b16 a[254:255], v240 offset:10752
    v_exp_f32 v166, v166
    v_exp_f32 v167, v167
    v_mfma_f32_16x16x32_bf16 v[200:203], a[232:235], a[228:231], v[200:203]
    s_waitcnt lgkmcnt(6)
    v_cvt_pk_bf16_f32 v178, v164, v165
    v_cvt_pk_bf16_f32 v179, v166, v167
    ds_read_b128 v[164:167], v235
    v_mfma_f32_16x16x32_bf16 v[220:223], a[220:223], a[240:243], v[220:223]
    ds_read_b64_tr_b16 a[240:241], v241 offset:4608
    ds_read_b64_tr_b16 a[242:243], v241 offset:6144
    v_mfma_f32_16x16x32_bf16 v[196:199], a[216:219], v[176:179], v[196:199]
    v_mad_u32_u24 v235, v234, s40, v228
    v_mad_u32_u24 v234, v234, s40, v229
    v_mfma_f32_16x16x32_bf16 v[184:187], v[78:81], v[176:179], v[184:187]
    v_fma_f32 v169, v169, s37, -v250
    v_fma_f32 v170, v170, s37, -v250
    v_mfma_f32_16x16x32_bf16 v[188:191], v[100:103], v[176:179], v[188:191]
    v_fma_f32 v171, v171, s37, -v250
    v_fma_f32 v172, v172, s37, -v250
    v_mfma_f32_16x16x32_bf16 v[192:195], v[122:125], v[176:179], v[192:195]
    v_exp_f32 v168, v168
    v_mfma_f32_16x16x32_bf16 v[208:211], a[220:223], a[244:247], v[208:211]
    s_waitcnt lgkmcnt(5)
    ds_read_b128 a[244:247], v239 offset:3072
    ds_read_b64_tr_b16 a[220:221], v240 offset:9224
    v_mfma_f32_16x16x32_bf16 v[212:215], a[232:235], a[224:227], v[212:215]
    ds_read_b64_tr_b16 a[222:223], v240 offset:10760
    ds_read_b128 a[232:235], v239 offset:10240
    v_mfma_f32_16x16x32_bf16 v[216:219], a[236:239], a[224:227], v[216:219]
    v_exp_f32 v169, v169
    v_mfma_f32_16x16x32_bf16 v[204:207], a[236:239], a[228:231], v[204:207]
    s_waitcnt lgkmcnt(6)
    ds_read_b64_tr_b16 a[236:237], v240 offset:12288
    ds_read_b64_tr_b16 a[238:239], v240 offset:16896
    v_mfma_f32_16x16x32_bf16 v[164:167], v[54:57], v[138:141], v[164:167]
    s_waitcnt lgkmcnt(6)
    v_exp_f32 v170, v170
    v_mfma_f32_16x16x32_bf16 v[220:223], a[240:243], a[224:227], v[220:223]
    ds_read_b64_tr_b16 a[224:225], v241 offset:9216
    ds_read_b64_tr_b16 a[226:227], v241 offset:10752
    v_mfma_f32_16x16x32_bf16 v[208:211], a[240:243], a[228:231], v[208:211]
    ds_read_b128 a[228:231], v239 offset:4096
    ds_read_b64_tr_b16 a[240:241], v240 offset:12296
    v_mfma_f32_16x16x16_bf16 v[164:167], v[58:59], v[142:143], v[164:167]
    ds_read_b64_tr_b16 a[242:243], v240 offset:16904
    v_cvt_pk_bf16_f32 v180, v168, v169
    v_mfma_f32_16x16x32_bf16 v[200:203], a[252:255], a[248:251], v[200:203]
    s_waitcnt lgkmcnt(10)
    v_exp_f32 v171, v171
    v_fma_f32 v173, v173, s37, -v250
    v_cvt_pk_bf16_f32 v181, v170, v171
    v_mfma_f32_16x16x32_bf16 v[212:215], a[252:255], a[244:247], v[212:215]
    s_waitcnt lgkmcnt(8)
    ds_read_b128 a[252:255], v239 offset:11264
    ds_read_b128 v[168:171], v236
    v_mfma_f32_16x16x32_bf16 v[216:219], a[220:223], a[244:247], v[216:219]
    v_bfe_u32 v236, s67, v232, 4
    v_fma_f32 v174, v174, s37, -v250
    v_mfma_f32_16x16x32_bf16 v[204:207], a[220:223], a[248:251], v[204:207]
    s_waitcnt lgkmcnt(7)
    ds_read_b64_tr_b16 a[220:221], v240 offset:13824
    ds_read_b64_tr_b16 a[222:223], v240 offset:15360
    v_fma_f32 v175, v175, s37, -v250
    v_mfma_f32_16x16x32_bf16 v[200:203], a[236:239], a[232:235], v[200:203]
    s_waitcnt lgkmcnt(7)
    v_exp_f32 v172, v172
    v_exp_f32 v173, v173
    v_exp_f32 v174, v174
    v_mfma_f32_16x16x32_bf16 v[220:223], a[224:227], a[244:247], v[220:223]
    ds_read_b64_tr_b16 a[244:245], v241 offset:12288
    ds_read_b64_tr_b16 a[246:247], v241 offset:16896
    v_mfma_f32_16x16x32_bf16 v[208:211], a[224:227], a[248:251], v[208:211]
    s_waitcnt lgkmcnt(8)
    ds_read_b128 a[248:251], v239 offset:5120
    ds_read_b64_tr_b16 a[224:225], v240 offset:13832
    v_mfma_f32_16x16x32_bf16 v[212:215], a[236:239], a[228:231], v[212:215]
    s_waitcnt lgkmcnt(8)
    ds_read_b64_tr_b16 a[226:227], v240 offset:15368
    ds_read_b128 a[236:239], v224 offset:15552
    v_mfma_f32_16x16x32_bf16 v[216:219], a[240:243], a[228:231], v[216:219]
    v_exp_f32 v175, v175
    v_mfma_f32_16x16x32_bf16 v[204:207], a[240:243], a[232:235], v[204:207]
    s_waitcnt lgkmcnt(8)
    ds_read_b128 a[240:243], v224 offset:15616
    v_cvt_pk_bf16_f32 v182, v172, v173
    v_mfma_f32_16x16x32_bf16 v[168:171], v[60:63], v[138:141], v[168:171]
    v_cvt_pk_bf16_f32 v183, v174, v175
    v_max3_f32 v248, v144, v145, v146
    ds_read_b128 v[172:175], v235
    v_mfma_f32_16x16x32_bf16 v[196:199], a[216:219], v[180:183], v[196:199]
    v_bfe_u32 v235, s81, v232, 4
    v_max3_f32 v249, v147, v148, v149
    v_mfma_f32_16x16x32_bf16 v[184:187], v[66:69], v[180:183], v[184:187]
    v_max3_f32 v248, v248, v150, v151
    v_max3_f32 v249, v249, v152, v153
    v_mfma_f32_16x16x32_bf16 v[188:191], v[88:91], v[180:183], v[188:191]
    v_max3_f32 v248, v248, v154, v155
    v_max3_f32 v249, v249, v156, v157
    v_mfma_f32_16x16x32_bf16 v[192:195], v[110:113], v[180:183], v[192:195]
    v_rcp_f32 v197, v196
    v_mfma_f32_16x16x16_bf16 v[168:171], v[64:65], v[142:143], v[168:171]
    s_waitcnt lgkmcnt(6)
    v_mul_f32 v184, v184, v197
    v_mul_f32 v185, v185, v197
    v_mfma_f32_16x16x32_bf16 v[220:223], a[244:247], a[228:231], v[220:223]
    ds_read_b64_tr_b16 a[228:229], v241 offset:13824
    ds_read_b64_tr_b16 a[230:231], v241 offset:15360
    v_mfma_f32_16x16x32_bf16 v[208:211], a[244:247], a[232:235], v[208:211]
    s_waitcnt lgkmcnt(4)
    v_cvt_pk_bf16_f32 v184, v184, v185
    v_mul_f32 v186, v186, v197
    v_mfma_f32_16x16x32_bf16 v[212:215], a[220:223], a[248:251], v[212:215]
    v_mul_f32 v187, v187, v197
    v_cvt_pk_bf16_f32 v185, v186, v187
    v_mfma_f32_16x16x32_bf16 v[200:203], a[220:223], a[252:255], v[200:203]
    s_waitcnt lgkmcnt(2)
    v_mul_f32 v188, v188, v197
    v_mul_f32 v189, v189, v197
    v_mfma_f32_16x16x32_bf16 v[172:175], v[12:15], v[132:135], v[172:175]
    v_cvt_pk_bf16_f32 v186, v188, v189
    v_mul_f32 v190, v190, v197
    v_mfma_f32_16x16x32_bf16 v[216:219], a[224:227], a[248:251], v[216:219]
    v_cvt_pk_bf16_f32 v212, v212, v213
    v_cvt_pk_bf16_f32 v213, v214, v215
    v_mfma_f32_16x16x32_bf16 v[204:207], a[224:227], a[252:255], v[204:207]
    v_cvt_pk_bf16_f32 v200, v200, v201
    v_cvt_pk_bf16_f32 v201, v202, v203
    v_mfma_f32_16x16x16_bf16 v[172:175], v[16:17], v[136:137], v[172:175]
    s_waitcnt lgkmcnt(0)
    v_mul_f32 v191, v191, v197
    v_cvt_pk_bf16_f32 v187, v190, v191
    v_cvt_pk_bf16_f32 v214, v216, v217
    v_cvt_pk_bf16_f32 v215, v218, v219
    buffer_store_dwordx4 v[212:215], v242, s[20:23], s58 offen sc0 sc1
    v_mfma_f32_16x16x32_bf16 v[220:223], a[228:231], a[248:251], v[220:223]
    v_cvt_pk_bf16_f32 v202, v204, v205
    v_cvt_pk_bf16_f32 v203, v206, v207
    v_mfma_f32_16x16x32_bf16 v[208:211], a[228:231], a[252:255], v[208:211]
    s_barrier
    buffer_store_dwordx4 v[200:203], v244, s[20:23], s59 offen sc0 sc1
    v_mul_f32 v192, v192, v197
    v_mul_f32 v193, v193, v197
    v_cvt_pk_bf16_f32 v188, v192, v193
    v_cvt_pk_bf16_f32 v220, v220, v221
    v_cvt_pk_bf16_f32 v221, v222, v223
    buffer_store_dwordx2 v[220:221], v243, s[20:23], s58 offen sc0 sc1
    v_cvt_pk_bf16_f32 v208, v208, v209
    v_cvt_pk_bf16_f32 v209, v210, v211
    buffer_store_dwordx2 v[208:209], v245, s[20:23], s59 offen sc0 sc1
    v_mul_f32 v194, v194, v197
    v_mul_f32 v195, v195, v197
    v_cvt_pk_bf16_f32 v189, v194, v195
    ds_write_b128 v237, v[184:187]
    ds_write_b64 v238, v[188:189]
    ds_read_b128 a[232:235], v224 offset:15488
    ds_read_b128 a[244:247], v224 offset:15680
    ds_read_b128 a[248:251], v224 offset:15744
    ds_read_b128 a[252:255], v224 offset:15808
    ds_read_b128 a[220:223], v224 offset:18560
    ds_read_b128 a[224:227], v224 offset:18624
    ds_read_b128 a[228:231], v224 offset:18688
    s_add_u32 s58, s51, 0x1a4000
    s_add_u32 s59, s51, 0x1a5800
    v_max3_f32 v248, v248, v158, v159
    v_max3_f32 v249, v249, v160, v161
    v_max3_f32 v248, v248, v162, v163
    v_max3_f32 v249, v249, v164, v165
    v_max3_f32 v248, v248, v166, v167
    v_max3_f32 v249, v249, v168, v169
    v_max3_f32 v248, v248, v170, v171
    v_max_f32 v248, v248, v249
    v_mov_b32 v249, v248
    s_nop 1
    v_permlane16_swap_b32 v248, v249
    v_max_f32 v248, v248, v249
    v_mov_b32 v249, v248
    s_nop 1
    v_permlane32_swap_b32 v248, v249
    v_max_f32 v248, v248, v249
    v_mul_f32 v250, s37, v248
    v_fma_f32 v144, v144, s37, -v250
    v_fma_f32 v145, v145, s37, -v250
    v_fma_f32 v146, v146, s37, -v250
    v_fma_f32 v147, v147, s37, -v250
    v_exp_f32 v144, v144
    s_waitcnt lgkmcnt(6)
    v_mfma_f32_16x16x32_bf16 v[212:215], a[0:3], a[232:235], 0
    v_exp_f32 v145, v145
    v_mfma_f32_16x16x32_bf16 v[216:219], a[4:7], a[232:235], 0
    v_exp_f32 v146, v146
    v_mfma_f32_16x16x32_bf16 v[220:223], a[8:11], a[232:235], 0
    v_exp_f32 v147, v147
    v_mfma_f32_16x16x32_bf16 v[200:203], a[232:235], a[72:75], 0
    v_cvt_pk_bf16_f32 v176, v144, v145
    v_cvt_pk_bf16_f32 v177, v146, v147
    v_mfma_f32_16x16x32_bf16 v[204:207], a[232:235], a[76:79], 0
    ds_read_b128 v[144:147], v234
    v_mad_u32_u24 v234, v236, s40, v229
    v_mfma_f32_16x16x32_bf16 v[208:211], a[232:235], a[80:83], 0
    ds_read_b128 a[232:235], v224 offset:18752
    v_mad_u32_u24 v236, v236, s40, v228
    v_mfma_f32_16x16x32_bf16 v[212:215], a[12:15], a[236:239], v[212:215]
    v_fma_f32 v148, v148, s37, -v250
    v_fma_f32 v149, v149, s37, -v250
    v_mfma_f32_16x16x32_bf16 v[216:219], a[16:19], a[236:239], v[216:219]
    v_fma_f32 v150, v150, s37, -v250
    v_fma_f32 v151, v151, s37, -v250
    v_mfma_f32_16x16x32_bf16 v[220:223], a[20:23], a[236:239], v[220:223]
    v_exp_f32 v148, v148
    v_mfma_f32_16x16x32_bf16 v[200:203], a[236:239], a[84:87], v[200:203]
    v_exp_f32 v149, v149
    v_mfma_f32_16x16x32_bf16 v[204:207], a[236:239], a[88:91], v[204:207]
    v_exp_f32 v150, v150
    v_mfma_f32_16x16x32_bf16 v[208:211], a[236:239], a[92:95], v[208:211]
    ds_read_b128 a[236:239], v224 offset:18816
    v_cvt_pk_bf16_f32 v178, v148, v149
    v_mfma_f32_16x16x32_bf16 v[212:215], a[24:27], a[240:243], v[212:215]
    v_exp_f32 v151, v151
    v_mfma_f32_16x16x32_bf16 v[216:219], a[28:31], a[240:243], v[216:219]
    s_waitcnt lgkmcnt(2)
    v_cvt_pk_bf16_f32 v179, v150, v151
    v_fma_f32 v152, v152, s37, -v250
    v_mfma_f32_16x16x32_bf16 v[144:147], v[36:39], v[132:135], v[144:147]
    ds_read_b128 v[148:151], v234
    v_bfe_u32 v234, s82, v232, 4
    v_mfma_f32_16x16x32_bf16 v[196:199], a[216:219], v[176:179], 0
    v_fma_f32 v153, v153, s37, -v250
    v_fma_f32 v154, v154, s37, -v250
    v_mfma_f32_16x16x32_bf16 v[184:187], v[68:71], v[176:179], 0
    v_fma_f32 v155, v155, s37, -v250
    v_fma_f32 v156, v156, s37, -v250
    v_mfma_f32_16x16x32_bf16 v[188:191], v[90:93], v[176:179], 0
    v_exp_f32 v152, v152
    v_mfma_f32_16x16x32_bf16 v[192:195], v[112:115], v[176:179], 0
    v_exp_f32 v153, v153
    v_mfma_f32_16x16x16_bf16 v[144:147], v[40:41], v[136:137], v[144:147]
    v_exp_f32 v154, v154
    v_mfma_f32_16x16x32_bf16 v[220:223], a[32:35], a[240:243], v[220:223]
    v_exp_f32 v155, v155
    v_mfma_f32_16x16x32_bf16 v[200:203], a[240:243], a[96:99], v[200:203]
    v_cvt_pk_bf16_f32 v180, v152, v153
    v_cvt_pk_bf16_f32 v181, v154, v155
    v_mfma_f32_16x16x32_bf16 v[204:207], a[240:243], a[100:103], v[204:207]
    ds_read_b128 v[152:155], v236
    v_mad_u32_u24 v236, v235, s40, v228
    v_mfma_f32_16x16x32_bf16 v[208:211], a[240:243], a[104:107], v[208:211]
    s_waitcnt lgkmcnt(1)
    ds_read_b128 a[240:243], v224 offset:18880
    v_mad_u32_u24 v235, v235, s40, v229
    v_mfma_f32_16x16x32_bf16 v[148:151], v[42:45], v[132:135], v[148:151]
    v_fma_f32 v157, v157, s37, -v250
    v_fma_f32 v158, v158, s37, -v250
    v_mfma_f32_16x16x32_bf16 v[212:215], a[36:39], a[244:247], v[212:215]
    v_fma_f32 v159, v159, s37, -v250
    v_fma_f32 v160, v160, s37, -v250
    v_mfma_f32_16x16x32_bf16 v[216:219], a[40:43], a[244:247], v[216:219]
    v_exp_f32 v156, v156
    v_mfma_f32_16x16x16_bf16 v[148:151], v[46:47], v[136:137], v[148:151]
    v_exp_f32 v157, v157
    v_mfma_f32_16x16x32_bf16 v[220:223], a[44:47], a[244:247], v[220:223]
    v_exp_f32 v158, v158
    v_mfma_f32_16x16x32_bf16 v[200:203], a[244:247], a[108:111], v[200:203]
    v_exp_f32 v159, v159
    v_mfma_f32_16x16x32_bf16 v[204:207], a[244:247], a[112:115], v[204:207]
    v_cvt_pk_bf16_f32 v182, v156, v157
    v_cvt_pk_bf16_f32 v183, v158, v159
    v_mfma_f32_16x16x32_bf16 v[208:211], a[244:247], a[116:119], v[208:211]
    ds_read_b128 v[156:159], v236
    ds_read_b128 a[244:247], v226 offset:3072
    v_mfma_f32_16x16x32_bf16 v[196:199], a[216:219], v[180:183], v[196:199]
    v_bfe_u32 v236, s77, v232, 4
    v_mad_u32_u24 v236, v236, s40, v230
    v_mfma_f32_16x16x32_bf16 v[184:187], v[76:79], v[180:183], v[184:187]
    v_fma_f32 v161, v161, s37, -v250
    v_fma_f32 v162, v162, s37, -v250
    v_mfma_f32_16x16x32_bf16 v[188:191], v[98:101], v[180:183], v[188:191]
    v_fma_f32 v163, v163, s37, -v250
    v_fma_f32 v164, v164, s37, -v250
    v_mfma_f32_16x16x32_bf16 v[192:195], v[120:123], v[180:183], v[192:195]
    s_waitcnt lgkmcnt(2)
    v_exp_f32 v160, v160
    v_mfma_f32_16x16x32_bf16 v[152:155], v[18:21], v[132:135], v[152:155]
    v_exp_f32 v161, v161
    v_mfma_f32_16x16x32_bf16 v[212:215], a[48:51], a[248:251], v[212:215]
    v_exp_f32 v162, v162
    v_mfma_f32_16x16x32_bf16 v[216:219], a[52:55], a[248:251], v[216:219]
    v_exp_f32 v163, v163
    v_mfma_f32_16x16x32_bf16 v[220:223], a[56:59], a[248:251], v[220:223]
    v_cvt_pk_bf16_f32 v176, v160, v161
    v_cvt_pk_bf16_f32 v177, v162, v163
    v_mfma_f32_16x16x16_bf16 v[152:155], v[22:23], v[136:137], v[152:155]
    ds_read_b128 v[160:163], v235
    v_mad_u32_u24 v235, v234, s40, v229
    v_mfma_f32_16x16x16_bf16 v[196:199], a[216:217], v[176:177], v[196:199]
    v_mad_u32_u24 v234, v234, s40, v228
    v_fma_f32 v165, v165, s37, -v250
    v_mfma_f32_16x16x16_bf16 v[184:187], v[82:83], v[176:177], v[184:187]
    v_fma_f32 v166, v166, s37, -v250
    v_fma_f32 v167, v167, s37, -v250
    v_mfma_f32_16x16x16_bf16 v[188:191], v[104:105], v[176:177], v[188:191]
    v_exp_f32 v164, v164
    v_mfma_f32_16x16x16_bf16 v[192:195], v[126:127], v[176:177], v[192:195]
    s_waitcnt lgkmcnt(1)
    v_exp_f32 v165, v165
    v_mfma_f32_16x16x32_bf16 v[156:159], v[0:3], v[132:135], v[156:159]
    v_exp_f32 v166, v166
    v_mfma_f32_16x16x32_bf16 v[200:203], a[248:251], a[120:123], v[200:203]
    v_exp_f32 v167, v167
    v_mfma_f32_16x16x32_bf16 v[204:207], a[248:251], a[124:127], v[204:207]
    v_cvt_pk_bf16_f32 v180, v164, v165
    v_cvt_pk_bf16_f32 v181, v166, v167
    v_mfma_f32_16x16x16_bf16 v[156:159], v[4:5], v[136:137], v[156:159]
    ds_read_b128 v[164:167], v235
    v_bfe_u32 v235, s81, v232, 4
    v_mfma_f32_16x16x32_bf16 v[208:211], a[248:251], a[128:131], v[208:211]
    s_waitcnt lgkmcnt(1)
    ds_read_b128 a[248:251], v226 offset:3136
    v_mad_u32_u24 v235, v235, s40, v230
    v_mfma_f32_16x16x32_bf16 v[160:163], v[24:27], v[132:135], v[160:163]
    v_fma_f32 v168, v168, s37, -v250
    v_fma_f32 v169, v169, s37, -v250
    v_mfma_f32_16x16x32_bf16 v[212:215], a[60:63], a[252:255], v[212:215]
    v_fma_f32 v170, v170, s37, -v250
    v_fma_f32 v171, v171, s37, -v250
    v_mfma_f32_16x16x32_bf16 v[216:219], a[64:67], a[252:255], v[216:219]
    v_exp_f32 v168, v168
    v_mfma_f32_16x16x16_bf16 v[160:163], v[28:29], v[136:137], v[160:163]
    v_exp_f32 v169, v169
    v_mfma_f32_16x16x32_bf16 v[220:223], a[68:71], a[252:255], v[220:223]
    v_exp_f32 v170, v170
    v_mfma_f32_16x16x32_bf16 v[200:203], a[252:255], a[132:135], v[200:203]
    v_cvt_pk_bf16_f32 v6, v212, v213
    v_cvt_pk_bf16_f32 v7, v214, v215
    v_mfma_f32_16x16x32_bf16 v[204:207], a[252:255], a[136:139], v[204:207]
    v_cvt_pk_bf16_f32 v8, v216, v217
    v_cvt_pk_bf16_f32 v9, v218, v219
    v_mfma_f32_16x16x32_bf16 v[208:211], a[252:255], a[140:143], v[208:211]
    v_cvt_pk_bf16_f32 v10, v220, v221
    v_cvt_pk_bf16_f32 v11, v222, v223
    v_mfma_f32_16x16x32_bf16 v[212:215], a[0:3], a[220:223], 0
    v_cvt_pk_bf16_f32 v72, v200, v201
    v_cvt_pk_bf16_f32 v73, v202, v203
    v_mfma_f32_16x16x32_bf16 v[216:219], a[4:7], a[220:223], 0
    v_cvt_pk_bf16_f32 v94, v204, v205
    v_cvt_pk_bf16_f32 v95, v206, v207
    v_mfma_f32_16x16x32_bf16 v[220:223], a[8:11], a[220:223], 0
    v_cvt_pk_bf16_f32 v116, v208, v209
    v_cvt_pk_bf16_f32 v117, v210, v211
    v_mfma_f32_16x16x32_bf16 v[200:203], a[220:223], a[72:75], 0
    ds_read_b128 a[252:255], v226 offset:3200
    v_cvt_pk_bf16_f32 v182, v168, v169
    v_mfma_f32_16x16x32_bf16 v[204:207], a[220:223], a[76:79], 0
    v_exp_f32 v171, v171
    v_mfma_f32_16x16x32_bf16 v[208:211], a[220:223], a[80:83], 0
    ds_read_b128 a[220:223], v226 offset:3264
    v_cvt_pk_bf16_f32 v183, v170, v171
    v_mfma_f32_16x16x32_bf16 v[212:215], a[12:15], a[224:227], v[212:215]
    ds_read_b128 v[168:171], v234
    v_bfe_u32 v234, s67, v232, 4
    v_mfma_f32_16x16x32_bf16 v[196:199], a[216:219], v[180:183], v[196:199]
    v_mad_u32_u24 v234, v234, s40, v230
    v_max3_f32 v248, v172, v173, v174
    v_mfma_f32_16x16x32_bf16 v[184:187], v[84:87], v[180:183], v[184:187]
    v_max3_f32 v249, v175, v144, v145
    v_max3_f32 v248, v248, v146, v147
    v_mfma_f32_16x16x32_bf16 v[188:191], v[106:109], v[180:183], v[188:191]
    v_max3_f32 v249, v249, v148, v149
    v_max3_f32 v248, v248, v150, v151
    v_mfma_f32_16x16x32_bf16 v[192:195], v[128:131], v[180:183], v[192:195]
    v_rcp_f32 v197, v196
    v_mfma_f32_16x16x32_bf16 v[216:219], a[16:19], a[224:227], v[216:219]
    v_mul_f32 v184, v184, v197
    v_mul_f32 v185, v185, v197
    v_mfma_f32_16x16x32_bf16 v[220:223], a[20:23], a[224:227], v[220:223]
    v_cvt_pk_bf16_f32 v184, v184, v185
    v_mul_f32 v186, v186, v197
    v_mfma_f32_16x16x32_bf16 v[200:203], a[224:227], a[84:87], v[200:203]
    v_mul_f32 v187, v187, v197
    v_cvt_pk_bf16_f32 v185, v186, v187
    v_mfma_f32_16x16x32_bf16 v[204:207], a[224:227], a[88:91], v[204:207]
    v_mul_f32 v188, v188, v197
    v_mul_f32 v189, v189, v197
    v_mfma_f32_16x16x32_bf16 v[208:211], a[224:227], a[92:95], v[208:211]
    s_waitcnt lgkmcnt(0)
    v_cvt_pk_bf16_f32 v186, v188, v189
    v_mul_f32 v190, v190, v197
    v_mfma_f32_16x16x32_bf16 v[168:171], v[6:9], v[132:135], v[168:171]
    v_mul_f32 v191, v191, v197
    v_cvt_pk_bf16_f32 v187, v190, v191
    v_mfma_f32_16x16x32_bf16 v[212:215], a[24:27], a[228:231], v[212:215]
    v_mul_f32 v192, v192, v197
    v_mul_f32 v193, v193, v197
    v_mfma_f32_16x16x32_bf16 v[216:219], a[28:31], a[228:231], v[216:219]
    v_cvt_pk_bf16_f32 v188, v192, v193
    v_mul_f32 v194, v194, v197
    v_mfma_f32_16x16x16_bf16 v[168:171], v[10:11], v[136:137], v[168:171]
    ds_read_b128 a[224:227], v226 offset:3328
    v_mul_f32 v195, v195, v197
    v_mfma_f32_16x16x32_bf16 v[220:223], a[32:35], a[228:231], v[220:223]
    v_cvt_pk_bf16_f32 v189, v194, v195
    v_max3_f32 v249, v249, v152, v153
    v_mfma_f32_16x16x32_bf16 v[200:203], a[228:231], a[96:99], v[200:203]
    ds_write_b128 v237, v[184:187] offset:6144
    v_mfma_f32_16x16x32_bf16 v[204:207], a[228:231], a[100:103], v[204:207]
    ds_write_b64 v238, v[188:189] offset:6144
    v_mfma_f32_16x16x32_bf16 v[208:211], a[228:231], a[104:107], v[208:211]
    ds_read_b128 a[228:231], v226 offset:3392
    v_max3_f32 v248, v248, v154, v155
    v_mfma_f32_16x16x32_bf16 v[212:215], a[36:39], a[232:235], v[212:215]
    v_max3_f32 v249, v249, v156, v157
    v_max3_f32 v248, v248, v158, v159
    v_mfma_f32_16x16x32_bf16 v[216:219], a[40:43], a[232:235], v[216:219]
    v_max3_f32 v249, v249, v160, v161
    v_max3_f32 v248, v248, v162, v163
    v_mfma_f32_16x16x32_bf16 v[220:223], a[44:47], a[232:235], v[220:223]
    v_mfma_f32_16x16x32_bf16 v[200:203], a[232:235], a[108:111], v[200:203]
    v_mfma_f32_16x16x32_bf16 v[204:207], a[232:235], a[112:115], v[204:207]
    v_mfma_f32_16x16x32_bf16 v[208:211], a[232:235], a[116:119], v[208:211]
    v_mfma_f32_16x16x32_bf16 v[212:215], a[48:51], a[236:239], v[212:215]
    s_waitcnt lgkmcnt(1)
    v_mfma_f32_16x16x32_bf16 v[216:219], a[52:55], a[236:239], v[216:219]
    s_barrier
    ds_read_b128 a[232:235], v239
    v_mfma_f32_16x16x32_bf16 v[220:223], a[56:59], a[236:239], v[220:223]
    v_mfma_f32_16x16x32_bf16 v[200:203], a[236:239], a[120:123], v[200:203]
    v_mfma_f32_16x16x32_bf16 v[204:207], a[236:239], a[124:127], v[204:207]
    v_mfma_f32_16x16x32_bf16 v[208:211], a[236:239], a[128:131], v[208:211]
    ds_read_b128 a[236:239], v239 offset:6144
    v_mfma_f32_16x16x32_bf16 v[212:215], a[60:63], a[240:243], v[212:215]
    v_mfma_f32_16x16x32_bf16 v[216:219], a[64:67], a[240:243], v[216:219]
    v_mfma_f32_16x16x32_bf16 v[220:223], a[68:71], a[240:243], v[220:223]
    v_mfma_f32_16x16x32_bf16 v[200:203], a[240:243], a[132:135], v[200:203]
    v_mfma_f32_16x16x32_bf16 v[204:207], a[240:243], a[136:139], v[204:207]
    v_mfma_f32_16x16x32_bf16 v[208:211], a[240:243], a[140:143], v[208:211]
    ds_read_b64_tr_b16 a[240:241], v240
    ds_read_b64_tr_b16 a[242:243], v240 offset:1536
    s_nop 0
    v_cvt_pk_bf16_f32 v30, v212, v213
    v_cvt_pk_bf16_f32 v31, v214, v215
    v_mfma_f32_16x16x32_bf16 v[212:215], a[144:147], a[244:247], 0
    v_cvt_pk_bf16_f32 v32, v216, v217
    v_cvt_pk_bf16_f32 v33, v218, v219
    v_mfma_f32_16x16x32_bf16 v[216:219], a[148:151], a[244:247], 0
    v_cvt_pk_bf16_f32 v34, v220, v221
    v_cvt_pk_bf16_f32 v35, v222, v223
    v_mfma_f32_16x16x32_bf16 v[164:167], v[30:33], v[132:135], v[164:167]
    v_cvt_pk_bf16_f32 v70, v200, v201
    v_cvt_pk_bf16_f32 v71, v202, v203
    v_mfma_f32_16x16x32_bf16 v[220:223], a[152:155], a[244:247], 0
    v_cvt_pk_bf16_f32 v92, v204, v205
    v_cvt_pk_bf16_f32 v93, v206, v207
    v_mfma_f32_16x16x32_bf16 v[212:215], a[156:159], a[248:251], v[212:215]
    v_cvt_pk_bf16_f32 v114, v208, v209
    v_cvt_pk_bf16_f32 v115, v210, v211
    v_mfma_f32_16x16x16_bf16 v[164:167], v[34:35], v[136:137], v[164:167]
    ds_read_b64_tr_b16 a[244:245], v240 offset:8
    ds_read_b64_tr_b16 a[246:247], v240 offset:1544
    v_mfma_f32_16x16x32_bf16 v[216:219], a[160:163], a[248:251], v[216:219]
    v_mfma_f32_16x16x32_bf16 v[220:223], a[164:167], a[248:251], v[220:223]
    ds_read_b64_tr_b16 a[248:249], v241
    ds_read_b64_tr_b16 a[250:251], v241 offset:1536
    v_mfma_f32_16x16x32_bf16 v[212:215], a[168:171], a[252:255], v[212:215]
    v_mfma_f32_16x16x32_bf16 v[216:219], a[172:175], a[252:255], v[216:219]
    v_max3_f32 v249, v249, v164, v165
    v_max3_f32 v248, v248, v166, v167
    v_mfma_f32_16x16x32_bf16 v[220:223], a[176:179], a[252:255], v[220:223]
    ds_read_b128 a[252:255], v239 offset:1024
    v_max3_f32 v249, v249, v168, v169
    v_mfma_f32_16x16x32_bf16 v[212:215], a[180:183], a[220:223], v[212:215]
    v_max3_f32 v248, v248, v170, v171
    v_max_f32 v248, v248, v249
    v_mfma_f32_16x16x32_bf16 v[216:219], a[184:187], a[220:223], v[216:219]
    v_mov_b32 v249, v248
    v_mfma_f32_16x16x32_bf16 v[220:223], a[188:191], a[220:223], v[220:223]
    ds_read_b128 a[220:223], v239 offset:7168
    v_mfma_f32_16x16x32_bf16 v[212:215], a[192:195], a[224:227], v[212:215]
    v_permlane16_swap_b32 v248, v249
    v_mfma_f32_16x16x32_bf16 v[216:219], a[196:199], a[224:227], v[216:219]
    v_max_f32 v248, v248, v249
    v_mov_b32 v249, v248
    v_mfma_f32_16x16x32_bf16 v[220:223], a[200:203], a[224:227], v[220:223]
    s_waitcnt lgkmcnt(4)
    ds_read_b64_tr_b16 a[224:225], v240 offset:3072
    ds_read_b64_tr_b16 a[226:227], v240 offset:7680
    v_mfma_f32_16x16x32_bf16 v[212:215], a[204:207], a[228:231], v[212:215]
    v_permlane32_swap_b32 v248, v249
    v_mfma_f32_16x16x32_bf16 v[216:219], a[208:211], a[228:231], v[216:219]
    v_max_f32 v248, v248, v249
    v_mul_f32 v250, s37, v248
    v_mfma_f32_16x16x32_bf16 v[220:223], a[212:215], a[228:231], v[220:223]
    ds_read_b64_tr_b16 a[228:229], v240 offset:3080
    ds_read_b64_tr_b16 a[230:231], v240 offset:7688
    v_mfma_f32_16x16x32_bf16 v[200:203], a[240:243], a[232:235], 0
    v_cvt_pk_bf16_f32 v138, v212, v213
    v_cvt_pk_bf16_f32 v139, v214, v215
    v_mfma_f32_16x16x32_bf16 v[212:215], a[240:243], a[236:239], 0
    v_cvt_pk_bf16_f32 v140, v216, v217
    v_cvt_pk_bf16_f32 v141, v218, v219
    v_mfma_f32_16x16x32_bf16 v[204:207], a[244:247], a[232:235], 0
    v_cvt_pk_bf16_f32 v142, v220, v221
    v_cvt_pk_bf16_f32 v143, v222, v223
    v_mfma_f32_16x16x32_bf16 v[216:219], a[244:247], a[236:239], 0
    s_waitcnt lgkmcnt(5)
    ds_read_b128 a[240:243], v239 offset:8192
    ds_read_b64_tr_b16 a[244:245], v240 offset:4608
    v_mfma_f32_16x16x32_bf16 v[208:211], a[248:251], a[232:235], 0
    ds_read_b64_tr_b16 a[232:233], v241 offset:3072
    ds_read_b64_tr_b16 a[234:235], v241 offset:7680
    v_mfma_f32_16x16x32_bf16 v[220:223], a[248:251], a[236:239], 0
    s_waitcnt lgkmcnt(6)
    ds_read_b128 a[236:239], v239 offset:2048
    ds_read_b64_tr_b16 a[246:247], v240 offset:6144
    v_mfma_f32_16x16x32_bf16 v[200:203], a[224:227], a[252:255], v[200:203]
    ds_read_b64_tr_b16 a[248:249], v240 offset:4616
    ds_read_b64_tr_b16 a[250:251], v240 offset:6152
    v_mfma_f32_16x16x32_bf16 v[212:215], a[224:227], a[220:223], v[212:215]
    s_waitcnt lgkmcnt(8)
    ds_read_b128 a[224:227], v239 offset:9216
    v_fma_f32 v172, v172, s37, -v250
    v_fma_f32 v173, v173, s37, -v250
    v_fma_f32 v174, v174, s37, -v250
    v_fma_f32 v175, v175, s37, -v250
    v_mfma_f32_16x16x32_bf16 v[204:207], a[228:231], a[252:255], v[204:207]
    v_exp_f32 v172, v172
    v_mfma_f32_16x16x32_bf16 v[216:219], a[228:231], a[220:223], v[216:219]
    s_waitcnt lgkmcnt(5)
    ds_read_b64_tr_b16 a[228:229], v240 offset:9216
    ds_read_b64_tr_b16 a[230:231], v240 offset:10752
    v_exp_f32 v173, v173
    v_exp_f32 v174, v174
    v_exp_f32 v175, v175
    v_cvt_pk_bf16_f32 v176, v172, v173
    v_cvt_pk_bf16_f32 v177, v174, v175
    ds_read_b128 v[172:175], v236
    v_bfe_u32 v236, s82, v232, 4
    v_mfma_f32_16x16x32_bf16 v[208:211], a[232:235], a[252:255], v[208:211]
    ds_read_b64_tr_b16 a[252:253], v241 offset:4608
    ds_read_b64_tr_b16 a[254:255], v241 offset:6144
    v_mfma_f32_16x16x32_bf16 v[220:223], a[232:235], a[220:223], v[220:223]
    s_waitcnt lgkmcnt(8)
    ds_read_b128 a[220:223], v239 offset:3072
    ds_read_b64_tr_b16 a[232:233], v240 offset:9224
    v_mfma_f32_16x16x32_bf16 v[200:203], a[244:247], a[236:239], v[200:203]
    ds_read_b64_tr_b16 a[234:235], v240 offset:10760
    v_mad_u32_u24 v236, v236, s40, v230
    v_mfma_f32_16x16x32_bf16 v[212:215], a[244:247], a[240:243], v[212:215]
    s_waitcnt lgkmcnt(9)
    ds_read_b128 a[244:247], v239 offset:10240
    v_fma_f32 v144, v144, s37, -v250
    v_mfma_f32_16x16x32_bf16 v[204:207], a[248:251], a[236:239], v[204:207]
    v_fma_f32 v145, v145, s37, -v250
    v_fma_f32 v146, v146, s37, -v250
    v_mfma_f32_16x16x32_bf16 v[216:219], a[248:251], a[240:243], v[216:219]
    s_waitcnt lgkmcnt(7)
    ds_read_b64_tr_b16 a[248:249], v240 offset:12288
    ds_read_b64_tr_b16 a[250:251], v240 offset:16896
    v_mfma_f32_16x16x32_bf16 v[212:215], a[228:231], a[224:227], v[212:215]
    s_waitcnt lgkmcnt(8)
    v_fma_f32 v147, v147, s37, -v250
    v_exp_f32 v144, v144
    v_exp_f32 v145, v145
    v_exp_f32 v146, v146
    v_exp_f32 v147, v147
    v_mfma_f32_16x16x32_bf16 v[172:175], v[36:39], v[138:141], v[172:175]
    s_waitcnt lgkmcnt(6)
    v_cvt_pk_bf16_f32 v178, v144, v145
    v_cvt_pk_bf16_f32 v179, v146, v147
    v_mfma_f32_16x16x32_bf16 v[208:211], a[252:255], a[236:239], v[208:211]
    ds_read_b64_tr_b16 a[236:237], v241 offset:9216
    ds_read_b64_tr_b16 a[238:239], v241 offset:10752
    v_mfma_f32_16x16x32_bf16 v[196:199], a[216:219], v[176:179], 0
    ds_read_b128 v[144:147], v234
    v_bfe_u32 v234, s83, v233, 4
    v_mfma_f32_16x16x32_bf16 v[184:187], v[74:77], v[176:179], 0
    v_mad_u32_u24 v234, v234, s40, v231
    v_fma_f32 v148, v148, s37, -v250
    v_mfma_f32_16x16x32_bf16 v[188:191], v[96:99], v[176:179], 0
    v_fma_f32 v149, v149, s37, -v250
    v_fma_f32 v150, v150, s37, -v250
    v_mfma_f32_16x16x32_bf16 v[192:195], v[118:121], v[176:179], 0
    v_fma_f32 v151, v151, s37, -v250
    v_fma_f32 v152, v152, s37, -v250
    v_mfma_f32_16x16x16_bf16 v[172:175], v[40:41], v[142:143], v[172:175]
    v_exp_f32 v148, v148
    v_mfma_f32_16x16x32_bf16 v[220:223], a[252:255], a[240:243], v[220:223]
    s_waitcnt lgkmcnt(3)
    ds_read_b128 a[240:243], v239 offset:4096
    ds_read_b64_tr_b16 a[252:253], v240 offset:12296
    v_mfma_f32_16x16x32_bf16 v[200:203], a[228:231], a[220:223], v[200:203]
    ds_read_b64_tr_b16 a[254:255], v240 offset:16904
    ds_read_b128 a[228:231], v239 offset:11264
    v_mfma_f32_16x16x32_bf16 v[204:207], a[232:235], a[220:223], v[204:207]
    v_exp_f32 v149, v149
    v_mfma_f32_16x16x32_bf16 v[216:219], a[232:235], a[224:227], v[216:219]
    s_waitcnt lgkmcnt(5)
    ds_read_b64_tr_b16 a[232:233], v240 offset:13824
    ds_read_b64_tr_b16 a[234:235], v240 offset:15360
    v_mfma_f32_16x16x32_bf16 v[208:211], a[236:239], a[220:223], v[208:211]
    s_waitcnt lgkmcnt(6)
    ds_read_b64_tr_b16 a[220:221], v241 offset:12288
    ds_read_b64_tr_b16 a[222:223], v241 offset:16896
    v_mfma_f32_16x16x32_bf16 v[144:147], v[42:45], v[138:141], v[144:147]
    v_exp_f32 v150, v150
    v_mfma_f32_16x16x32_bf16 v[220:223], a[236:239], a[224:227], v[220:223]
    ds_read_b128 a[224:227], v239 offset:5120
    ds_read_b64_tr_b16 a[236:237], v240 offset:13832
    v_mfma_f32_16x16x32_bf16 v[212:215], a[248:251], a[244:247], v[212:215]
    ds_read_b64_tr_b16 a[238:239], v240 offset:15368
    v_cvt_pk_bf16_f32 v180, v148, v149
    v_mfma_f32_16x16x16_bf16 v[144:147], v[46:47], v[142:143], v[144:147]
    s_waitcnt lgkmcnt(10)
    v_exp_f32 v151, v151
    v_fma_f32 v153, v153, s37, -v250
    v_cvt_pk_bf16_f32 v181, v150, v151
    v_mfma_f32_16x16x32_bf16 v[200:203], a[248:251], a[240:243], v[200:203]
    s_waitcnt lgkmcnt(8)
    ds_read_b128 v[148:151], v235
    v_bfe_u32 v235, s84, v233, 4
    v_mfma_f32_16x16x32_bf16 v[204:207], a[252:255], a[240:243], v[204:207]
    v_mad_u32_u24 v235, v235, s40, v231
    v_fma_f32 v154, v154, s37, -v250
    v_mfma_f32_16x16x32_bf16 v[216:219], a[252:255], a[244:247], v[216:219]
    s_waitcnt lgkmcnt(6)
    ds_read_b64_tr_b16 a[252:253], v240
    ds_read_b64_tr_b16 a[254:255], v240 offset:1536
    v_fma_f32 v155, v155, s37, -v250
    v_mfma_f32_16x16x32_bf16 v[212:215], a[232:235], a[228:231], v[212:215]
    s_waitcnt lgkmcnt(6)
    v_exp_f32 v152, v152
    v_mfma_f32_16x16x32_bf16 v[208:211], a[220:223], a[240:243], v[208:211]
    ds_read_b64_tr_b16 a[240:241], v241 offset:13824
    ds_read_b64_tr_b16 a[242:243], v241 offset:15360
    v_mfma_f32_16x16x32_bf16 v[220:223], a[220:223], a[244:247], v[220:223]
    s_waitcnt lgkmcnt(7)
    ds_read_b64_tr_b16 a[220:221], v240 offset:8
    ds_read_b64_tr_b16 a[222:223], v240 offset:1544
    v_mfma_f32_16x16x32_bf16 v[200:203], a[232:235], a[224:227], v[200:203]
    s_waitcnt lgkmcnt(7)
    v_cvt_pk_bf16_f32 v212, v212, v213
    v_cvt_pk_bf16_f32 v213, v214, v215
    v_mfma_f32_16x16x32_bf16 v[204:207], a[236:239], a[224:227], v[204:207]
    v_exp_f32 v153, v153
    v_mfma_f32_16x16x32_bf16 v[216:219], a[236:239], a[228:231], v[216:219]
    s_waitcnt lgkmcnt(6)
    ds_read_b64_tr_b16 a[236:237], v240 offset:3072
    ds_read_b64_tr_b16 a[238:239], v240 offset:7680
    v_exp_f32 v154, v154
    v_mfma_f32_16x16x32_bf16 v[148:151], v[24:27], v[138:141], v[148:151]
    v_cvt_pk_bf16_f32 v200, v200, v201
    v_cvt_pk_bf16_f32 v201, v202, v203
    v_cvt_pk_bf16_f32 v202, v204, v205
    v_cvt_pk_bf16_f32 v203, v206, v207
    buffer_store_dwordx4 v[200:203], v242, s[20:23], s58 offen sc0 sc1
    v_cvt_pk_bf16_f32 v214, v216, v217
    v_mfma_f32_16x16x16_bf16 v[148:151], v[28:29], v[142:143], v[148:151]
    s_waitcnt lgkmcnt(4)
    v_cvt_pk_bf16_f32 v215, v218, v219
    v_cvt_pk_bf16_f32 v182, v152, v153
    v_mfma_f32_16x16x32_bf16 v[208:211], a[240:243], a[224:227], v[208:211]
    buffer_store_dwordx4 v[212:215], v244, s[20:23], s59 offen sc0 sc1
    v_mfma_f32_16x16x32_bf16 v[220:223], a[240:243], a[228:231], v[220:223]
    s_barrier
    ds_read_b64_tr_b16 a[224:225], v241
    ds_read_b64_tr_b16 a[226:227], v241 offset:1536
    ds_read_b64_tr_b16 a[240:241], v240 offset:3080
    ds_read_b64_tr_b16 a[242:243], v240 offset:7688
    v_exp_f32 v155, v155
    v_cvt_pk_bf16_f32 v208, v208, v209
    v_cvt_pk_bf16_f32 v209, v210, v211
    buffer_store_dwordx2 v[208:209], v243, s[20:23], s58 offen sc0 sc1
    v_cvt_pk_bf16_f32 v220, v220, v221
    v_cvt_pk_bf16_f32 v221, v222, v223
    buffer_store_dwordx2 v[220:221], v245, s[20:23], s59 offen sc0 sc1
    s_add_u32 s58, s51, 0x1f8000
    s_add_u32 s59, s51, 0x1f9800
    v_cvt_pk_bf16_f32 v183, v154, v155
    ds_read_b128 v[152:155], v236
    v_fma_f32 v156, v156, s37, -v250
    v_mfma_f32_16x16x32_bf16 v[196:199], a[216:219], v[180:183], v[196:199]
    v_fma_f32 v157, v157, s37, -v250
    v_fma_f32 v158, v158, s37, -v250
    v_mfma_f32_16x16x32_bf16 v[184:187], v[78:81], v[180:183], v[184:187]
    v_fma_f32 v159, v159, s37, -v250
    v_fma_f32 v160, v160, s37, -v250
    v_mfma_f32_16x16x32_bf16 v[188:191], v[100:103], v[180:183], v[188:191]
    v_exp_f32 v156, v156
    v_mfma_f32_16x16x32_bf16 v[192:195], v[122:125], v[180:183], v[192:195]
    s_waitcnt lgkmcnt(0)
    v_exp_f32 v157, v157
    v_exp_f32 v158, v158
    v_exp_f32 v159, v159
    v_cvt_pk_bf16_f32 v176, v156, v157
    v_cvt_pk_bf16_f32 v177, v158, v159
    ds_read_b128 v[156:159], v234
    v_fma_f32 v161, v161, s37, -v250
    v_fma_f32 v162, v162, s37, -v250
    v_fma_f32 v163, v163, s37, -v250
    v_exp_f32 v160, v160
    v_exp_f32 v161, v161
    v_exp_f32 v162, v162
    v_mfma_f32_16x16x32_bf16 v[152:155], v[30:33], v[138:141], v[152:155]
    v_exp_f32 v163, v163
    v_cvt_pk_bf16_f32 v178, v160, v161
    v_cvt_pk_bf16_f32 v179, v162, v163
    ds_read_b128 v[160:163], v235
    v_fma_f32 v164, v164, s37, -v250
    v_mfma_f32_16x16x32_bf16 v[196:199], a[216:219], v[176:179], v[196:199]
    v_fma_f32 v165, v165, s37, -v250
    v_fma_f32 v166, v166, s37, -v250
    v_mfma_f32_16x16x32_bf16 v[184:187], v[66:69], v[176:179], v[184:187]
    v_fma_f32 v167, v167, s37, -v250
    v_fma_f32 v168, v168, s37, -v250
    v_mfma_f32_16x16x32_bf16 v[188:191], v[88:91], v[176:179], v[188:191]
    v_exp_f32 v164, v164
    v_mfma_f32_16x16x32_bf16 v[192:195], v[110:113], v[176:179], v[192:195]
    v_exp_f32 v165, v165
    v_mfma_f32_16x16x16_bf16 v[152:155], v[34:35], v[142:143], v[152:155]
    s_waitcnt lgkmcnt(1)
    v_exp_f32 v166, v166
    v_mfma_f32_16x16x32_bf16 v[156:159], v[48:51], v[138:141], v[156:159]
    v_exp_f32 v167, v167
    v_cvt_pk_bf16_f32 v180, v164, v165
    v_cvt_pk_bf16_f32 v181, v166, v167
    v_fma_f32 v169, v169, s37, -v250
    v_fma_f32 v170, v170, s37, -v250
    v_fma_f32 v171, v171, s37, -v250
    v_mfma_f32_16x16x16_bf16 v[156:159], v[52:53], v[142:143], v[156:159]
    s_waitcnt lgkmcnt(0)
    v_exp_f32 v168, v168
    v_exp_f32 v169, v169
    v_mfma_f32_16x16x32_bf16 v[160:163], v[54:57], v[138:141], v[160:163]
    v_exp_f32 v170, v170
    v_exp_f32 v171, v171
    v_cvt_pk_bf16_f32 v182, v168, v169
    v_cvt_pk_bf16_f32 v183, v170, v171
    v_max3_f32 v248, v172, v173, v174
    v_max3_f32 v249, v175, v144, v145
    v_mfma_f32_16x16x32_bf16 v[196:199], a[216:219], v[180:183], v[196:199]
    v_max3_f32 v248, v248, v146, v147
    v_max3_f32 v249, v249, v148, v149
    v_mfma_f32_16x16x32_bf16 v[184:187], v[70:73], v[180:183], v[184:187]
    v_max3_f32 v248, v248, v150, v151
    v_max3_f32 v249, v249, v152, v153
    v_mfma_f32_16x16x32_bf16 v[188:191], v[92:95], v[180:183], v[188:191]
    v_max3_f32 v248, v248, v154, v155
    v_max3_f32 v249, v249, v156, v157
    v_mfma_f32_16x16x32_bf16 v[192:195], v[114:117], v[180:183], v[192:195]
    v_rcp_f32 v197, v196
    v_mfma_f32_16x16x16_bf16 v[160:163], v[58:59], v[142:143], v[160:163]
    v_mul_f32 v184, v184, v197
    v_mul_f32 v185, v185, v197
    v_cvt_pk_bf16_f32 v184, v184, v185
    v_mul_f32 v186, v186, v197
    v_mul_f32 v187, v187, v197
    v_cvt_pk_bf16_f32 v185, v186, v187
    v_mul_f32 v188, v188, v197
    v_mul_f32 v189, v189, v197
    v_cvt_pk_bf16_f32 v186, v188, v189
    v_mul_f32 v190, v190, v197
    v_mul_f32 v191, v191, v197
    v_cvt_pk_bf16_f32 v187, v190, v191
    v_mul_f32 v192, v192, v197
    v_mul_f32 v193, v193, v197
    v_cvt_pk_bf16_f32 v188, v192, v193
    v_mul_f32 v194, v194, v197
    v_mul_f32 v195, v195, v197
    v_cvt_pk_bf16_f32 v189, v194, v195
    ds_write_b128 v237, v[184:187]
    ds_write_b64 v238, v[188:189]
    v_max3_f32 v248, v248, v158, v159
    v_max3_f32 v249, v249, v160, v161
    v_max3_f32 v248, v248, v162, v163
    v_max_f32 v248, v248, v249
    v_mov_b32 v249, v248
    s_nop 1
    v_permlane16_swap_b32 v248, v249
    v_max_f32 v248, v248, v249
    v_mov_b32 v249, v248
    s_nop 1
    v_permlane32_swap_b32 v248, v249
    v_max_f32 v248, v248, v249
    v_mul_f32 v250, s37, v248
    v_fma_f32 v172, v172, s37, -v250
    v_fma_f32 v173, v173, s37, -v250
    v_fma_f32 v174, v174, s37, -v250
    v_fma_f32 v175, v175, s37, -v250
    v_exp_f32 v172, v172
    v_exp_f32 v173, v173
    v_exp_f32 v174, v174
    v_exp_f32 v175, v175
    v_cvt_pk_bf16_f32 v176, v172, v173
    v_cvt_pk_bf16_f32 v177, v174, v175
    v_fma_f32 v144, v144, s37, -v250
    v_fma_f32 v145, v145, s37, -v250
    v_fma_f32 v146, v146, s37, -v250
    v_fma_f32 v147, v147, s37, -v250
    v_exp_f32 v144, v144
    v_exp_f32 v145, v145
    v_exp_f32 v146, v146
    v_exp_f32 v147, v147
    v_cvt_pk_bf16_f32 v178, v144, v145
    v_cvt_pk_bf16_f32 v179, v146, v147
    v_fma_f32 v148, v148, s37, -v250
    v_fma_f32 v149, v149, s37, -v250
    v_mfma_f32_16x16x32_bf16 v[196:199], a[216:219], v[176:179], 0
    v_fma_f32 v150, v150, s37, -v250
    v_fma_f32 v151, v151, s37, -v250
    v_mfma_f32_16x16x32_bf16 v[184:187], v[76:79], v[176:179], 0
    v_exp_f32 v148, v148
    v_mfma_f32_16x16x32_bf16 v[188:191], v[98:101], v[176:179], 0
    v_exp_f32 v149, v149
    v_mfma_f32_16x16x32_bf16 v[192:195], v[120:123], v[176:179], 0
    v_exp_f32 v150, v150
    v_exp_f32 v151, v151
    v_cvt_pk_bf16_f32 v180, v148, v149
    v_cvt_pk_bf16_f32 v181, v150, v151
    v_fma_f32 v152, v152, s37, -v250
    v_fma_f32 v153, v153, s37, -v250
    v_fma_f32 v154, v154, s37, -v250
    v_fma_f32 v155, v155, s37, -v250
    v_exp_f32 v152, v152
    v_exp_f32 v153, v153
    v_exp_f32 v154, v154
    v_exp_f32 v155, v155
    v_cvt_pk_bf16_f32 v182, v152, v153
    v_cvt_pk_bf16_f32 v183, v154, v155
    v_fma_f32 v156, v156, s37, -v250
    v_fma_f32 v157, v157, s37, -v250
    v_mfma_f32_16x16x32_bf16 v[196:199], a[216:219], v[180:183], v[196:199]
    v_fma_f32 v158, v158, s37, -v250
    v_fma_f32 v159, v159, s37, -v250
    v_mfma_f32_16x16x32_bf16 v[184:187], v[68:71], v[180:183], v[184:187]
    v_exp_f32 v156, v156
    v_mfma_f32_16x16x32_bf16 v[188:191], v[90:93], v[180:183], v[188:191]
    v_exp_f32 v157, v157
    v_mfma_f32_16x16x32_bf16 v[192:195], v[112:115], v[180:183], v[192:195]
    v_exp_f32 v158, v158
    v_exp_f32 v159, v159
    v_cvt_pk_bf16_f32 v176, v156, v157
    v_cvt_pk_bf16_f32 v177, v158, v159
    v_fma_f32 v160, v160, s37, -v250
    v_fma_f32 v161, v161, s37, -v250
    v_fma_f32 v162, v162, s37, -v250
    v_fma_f32 v163, v163, s37, -v250
    v_exp_f32 v160, v160
    v_exp_f32 v161, v161
    v_exp_f32 v162, v162
    v_exp_f32 v163, v163
    v_cvt_pk_bf16_f32 v178, v160, v161
    v_cvt_pk_bf16_f32 v179, v162, v163
    s_nop 1
    v_mfma_f32_16x16x32_bf16 v[196:199], a[216:219], v[176:179], v[196:199]
    v_mfma_f32_16x16x32_bf16 v[184:187], v[82:85], v[176:179], v[184:187]
    v_mfma_f32_16x16x32_bf16 v[188:191], v[104:107], v[176:179], v[188:191]
    v_mfma_f32_16x16x32_bf16 v[192:195], v[126:129], v[176:179], v[192:195]
    s_nop 4
    v_rcp_f32 v197, v196
    s_nop 0
    v_mul_f32 v184, v184, v197
    v_mul_f32 v185, v185, v197
    v_cvt_pk_bf16_f32 v184, v184, v185
    v_mul_f32 v186, v186, v197
    v_mul_f32 v187, v187, v197
    v_cvt_pk_bf16_f32 v185, v186, v187
    v_mul_f32 v188, v188, v197
    v_mul_f32 v189, v189, v197
    v_cvt_pk_bf16_f32 v186, v188, v189
    v_mul_f32 v190, v190, v197
    v_mul_f32 v191, v191, v197
    v_cvt_pk_bf16_f32 v187, v190, v191
    v_mul_f32 v192, v192, v197
    v_mul_f32 v193, v193, v197
    v_cvt_pk_bf16_f32 v188, v192, v193
    v_mul_f32 v194, v194, v197
    v_mul_f32 v195, v195, v197
    v_cvt_pk_bf16_f32 v189, v194, v195
    ds_write_b128 v237, v[184:187] offset:6144
    ds_write_b64 v238, v[188:189] offset:6144
    s_waitcnt lgkmcnt(0)
    s_barrier
    ds_read_b128 a[244:247], v239
    ds_read_b128 a[248:251], v239 offset:6144
    ds_read_b128 a[228:231], v239 offset:1024
    ds_read_b128 a[232:235], v239 offset:7168
    s_waitcnt lgkmcnt(3)
    v_mfma_f32_16x16x32_bf16 v[200:203], a[252:255], a[244:247], 0
    s_waitcnt lgkmcnt(2)
    v_mfma_f32_16x16x32_bf16 v[212:215], a[252:255], a[248:251], 0
    ds_read_b128 a[252:255], v239 offset:8192
    v_mfma_f32_16x16x32_bf16 v[204:207], a[220:223], a[244:247], 0
    v_mfma_f32_16x16x32_bf16 v[216:219], a[220:223], a[248:251], 0
    ds_read_b64_tr_b16 a[220:221], v240 offset:4608
    ds_read_b64_tr_b16 a[222:223], v240 offset:6144
    v_mfma_f32_16x16x32_bf16 v[208:211], a[224:227], a[244:247], 0
    ds_read_b64_tr_b16 a[244:245], v241 offset:3072
    ds_read_b64_tr_b16 a[246:247], v241 offset:7680
    v_mfma_f32_16x16x32_bf16 v[220:223], a[224:227], a[248:251], 0
    s_waitcnt lgkmcnt(5)
    ds_read_b128 a[248:251], v239 offset:2048
    ds_read_b64_tr_b16 a[224:225], v240 offset:4616
    v_mfma_f32_16x16x32_bf16 v[200:203], a[236:239], a[228:231], v[200:203]
    ds_read_b64_tr_b16 a[226:227], v240 offset:6152
    v_mfma_f32_16x16x32_bf16 v[212:215], a[236:239], a[232:235], v[212:215]
    ds_read_b128 a[236:239], v239 offset:9216
    v_mfma_f32_16x16x32_bf16 v[204:207], a[240:243], a[228:231], v[204:207]
    v_mfma_f32_16x16x32_bf16 v[216:219], a[240:243], a[232:235], v[216:219]
    s_waitcnt lgkmcnt(6)
    ds_read_b64_tr_b16 a[240:241], v240 offset:9216
    ds_read_b64_tr_b16 a[242:243], v240 offset:10752
    v_mfma_f32_16x16x32_bf16 v[212:215], a[220:223], a[252:255], v[212:215]
    s_waitcnt lgkmcnt(6)
    v_mfma_f32_16x16x32_bf16 v[208:211], a[244:247], a[228:231], v[208:211]
    ds_read_b64_tr_b16 a[228:229], v241 offset:4608
    ds_read_b64_tr_b16 a[230:231], v241 offset:6144
    v_mfma_f32_16x16x32_bf16 v[220:223], a[244:247], a[232:235], v[220:223]
    s_waitcnt lgkmcnt(7)
    ds_read_b128 a[232:235], v239 offset:3072
    ds_read_b64_tr_b16 a[244:245], v240 offset:9224
    v_mfma_f32_16x16x32_bf16 v[200:203], a[220:223], a[248:251], v[200:203]
    s_waitcnt lgkmcnt(7)
    ds_read_b64_tr_b16 a[246:247], v240 offset:10760
    ds_read_b128 a[220:223], v239 offset:10240
    v_mfma_f32_16x16x32_bf16 v[204:207], a[224:227], a[248:251], v[204:207]
    v_mfma_f32_16x16x32_bf16 v[216:219], a[224:227], a[252:255], v[216:219]
    s_waitcnt lgkmcnt(6)
    ds_read_b64_tr_b16 a[224:225], v240 offset:12288
    ds_read_b64_tr_b16 a[226:227], v240 offset:16896
    v_mfma_f32_16x16x32_bf16 v[212:215], a[240:243], a[236:239], v[212:215]
    s_waitcnt lgkmcnt(6)
    v_mfma_f32_16x16x32_bf16 v[208:211], a[228:231], a[248:251], v[208:211]
    ds_read_b64_tr_b16 a[248:249], v241 offset:9216
    ds_read_b64_tr_b16 a[250:251], v241 offset:10752
    v_mfma_f32_16x16x32_bf16 v[220:223], a[228:231], a[252:255], v[220:223]
    s_waitcnt lgkmcnt(7)
    ds_read_b128 a[252:255], v239 offset:4096
    ds_read_b64_tr_b16 a[228:229], v240 offset:12296
    v_mfma_f32_16x16x32_bf16 v[200:203], a[240:243], a[232:235], v[200:203]
    s_waitcnt lgkmcnt(7)
    ds_read_b64_tr_b16 a[230:231], v240 offset:16904
    ds_read_b128 a[240:243], v239 offset:11264
    v_mfma_f32_16x16x32_bf16 v[204:207], a[244:247], a[232:235], v[204:207]
    v_mfma_f32_16x16x32_bf16 v[216:219], a[244:247], a[236:239], v[216:219]
    s_waitcnt lgkmcnt(6)
    ds_read_b64_tr_b16 a[244:245], v240 offset:13824
    ds_read_b64_tr_b16 a[246:247], v240 offset:15360
    v_mfma_f32_16x16x32_bf16 v[212:215], a[224:227], a[220:223], v[212:215]
    s_waitcnt lgkmcnt(6)
    v_mfma_f32_16x16x32_bf16 v[208:211], a[248:251], a[232:235], v[208:211]
    ds_read_b64_tr_b16 a[232:233], v241 offset:12288
    ds_read_b64_tr_b16 a[234:235], v241 offset:16896
    v_mfma_f32_16x16x32_bf16 v[220:223], a[248:251], a[236:239], v[220:223]
    s_waitcnt lgkmcnt(7)
    ds_read_b128 a[236:239], v239 offset:5120
    ds_read_b64_tr_b16 a[248:249], v240 offset:13832
    v_mfma_f32_16x16x32_bf16 v[200:203], a[224:227], a[252:255], v[200:203]
    s_waitcnt lgkmcnt(7)
    ds_read_b64_tr_b16 a[250:251], v240 offset:15368
    v_mfma_f32_16x16x32_bf16 v[204:207], a[228:231], a[252:255], v[204:207]
    v_mfma_f32_16x16x32_bf16 v[216:219], a[228:231], a[220:223], v[216:219]
    s_waitcnt lgkmcnt(3)
    v_mfma_f32_16x16x32_bf16 v[212:215], a[244:247], a[240:243], v[212:215]
    s_nop 7
    v_cvt_pk_bf16_f32 v212, v212, v213
    v_cvt_pk_bf16_f32 v213, v214, v215
    v_mfma_f32_16x16x32_bf16 v[208:211], a[232:235], a[252:255], v[208:211]
    ds_read_b64_tr_b16 a[252:253], v241 offset:13824
    ds_read_b64_tr_b16 a[254:255], v241 offset:15360
    v_mfma_f32_16x16x32_bf16 v[220:223], a[232:235], a[220:223], v[220:223]
    s_waitcnt lgkmcnt(4)
    v_mfma_f32_16x16x32_bf16 v[200:203], a[244:247], a[236:239], v[200:203]
    s_waitcnt lgkmcnt(2)
    v_mfma_f32_16x16x32_bf16 v[204:207], a[248:251], a[236:239], v[204:207]
    s_waitcnt lgkmcnt(0)
    v_mfma_f32_16x16x32_bf16 v[216:219], a[248:251], a[240:243], v[216:219]
    s_nop 5
    v_cvt_pk_bf16_f32 v200, v200, v201
    v_cvt_pk_bf16_f32 v201, v202, v203
    v_cvt_pk_bf16_f32 v202, v204, v205
    v_cvt_pk_bf16_f32 v203, v206, v207
    buffer_store_dwordx4 v[200:203], v242, s[20:23], s58 offen sc0 sc1
    v_cvt_pk_bf16_f32 v214, v216, v217
    v_cvt_pk_bf16_f32 v215, v218, v219
    v_mfma_f32_16x16x32_bf16 v[208:211], a[252:255], a[236:239], v[208:211]
    buffer_store_dwordx4 v[212:215], v244, s[20:23], s59 offen sc0 sc1
    v_mfma_f32_16x16x32_bf16 v[220:223], a[252:255], a[240:243], v[220:223]
    s_nop 5
    v_cvt_pk_bf16_f32 v208, v208, v209
    v_cvt_pk_bf16_f32 v209, v210, v211
    buffer_store_dwordx2 v[208:209], v243, s[20:23], s58 offen sc0 sc1
    v_cvt_pk_bf16_f32 v220, v220, v221
    v_cvt_pk_bf16_f32 v221, v222, v223
    buffer_store_dwordx2 v[220:221], v245, s[20:23], s59 offen sc0 sc1
    s_endpgm
.section .rodata,"a"
.p2align 6
.amdhsa_kernel standalone__neighborhood_dinat__vision_kernel
  .amdhsa_next_free_vgpr 512
  .amdhsa_next_free_sgpr 102
  .amdhsa_accum_offset 256
  .amdhsa_group_segment_fixed_size 0
  .amdhsa_kernarg_size 56
  .amdhsa_user_sgpr_count 2
  .amdhsa_user_sgpr_kernarg_segment_ptr 1
  .amdhsa_system_sgpr_workgroup_id_x 1
.end_amdhsa_kernel
```

```asm
; @launch grid=(256,1,1) block=(256,1,1) lds=163344
.amdgcn_target "amdgcn-amd-amdhsa--gfx950"
.text
.globl standalone__neighborhood_dinat__vision_kernel
.p2align 8
.type standalone__neighborhood_dinat__vision_kernel,@function
standalone__neighborhood_dinat__vision_kernel:
    s_cmp_ge_u32 s2, 256
    s_cbranch_scc1 L_exit
L_go:
    s_load_dwordx4 s[24:27], s[0:1], 0
    s_load_dwordx4 s[28:31], s[0:1], 16
    s_load_dwordx2 s[32:33], s[0:1], 32
    s_getpc_b64 s[12:13]
    s_and_b32 s13, s13, 0xffff
    s_mov_b32 s14, L_end-L_go-64
    s_mov_b32 s15, 0x20000
    s_lshl_b32 s52, s2, 10
    v_lshlrev_b32 v189, 5, v0
    s_and_b32 s53, s52, 0xe000
    buffer_load_dword v188, v189, s[12:15], s53 offen
    v_lshrrev_b32 v74, 6, v0
    v_and_b32 v184, 63, v0
    v_readfirstlane_b32 s36, v74
    v_mul_u32_u24 v76, 0x2aab, v184
    v_lshrrev_b32 v76, 16, v76
    v_mul_u32_u24 v74, 6, v76
    v_sub_u32 v77, v184, v74
    v_lshrrev_b32 v74, 1, v76
    v_and_b32 v74, 4, v74
    v_xor_b32 v76, v76, v74
    v_mul_u32_u24 v74, 0x480, v76
    v_lshl_add_u32 v251, v77, 4, v74
    v_add_u32 v79, 64, v184
    v_mul_u32_u24 v78, 0x2aab, v79
    v_lshrrev_b32 v78, 16, v78
    v_mul_u32_u24 v74, 6, v78
    v_sub_u32 v79, v79, v74
    v_lshrrev_b32 v74, 1, v78
    v_and_b32 v74, 4, v74
    v_xor_b32 v78, v78, v74
    v_mul_u32_u24 v74, 0x480, v78
    v_lshl_add_u32 v252, v79, 4, v74
    v_add_u32 v81, 0x80, v184
    v_mul_u32_u24 v80, 0x2aab, v81
    v_lshrrev_b32 v80, 16, v80
    v_mul_u32_u24 v74, 6, v80
    v_sub_u32 v81, v81, v74
    v_lshrrev_b32 v74, 1, v80
    v_and_b32 v74, 4, v74
    v_xor_b32 v80, v80, v74
    v_mul_u32_u24 v74, 0x480, v80
    v_lshl_add_u32 v253, v81, 4, v74
    s_mul_i32 s49, s36, 0x60
    s_mul_i32 s50, s36, 0xc00
    s_add_u32 s50, s50, 0x15e00
    s_mov_b32 s10, 0x36000
    s_mov_b32 s11, 0x20000
    s_and_b32 s53, s52, 0x3e000
    s_add_u32 s57, s49, 0x180
    s_add_u32 m0, s50, 0
    s_and_b32 s54, s2, 1
    s_lshl_b32 s54, s54, 2
    s_lshl_b32 s41, s36, 10
    s_add_u32 s42, s41, 0x1000
    s_min_u32 s42, s42, 0x1a00
    s_mov_b32 s6, 0x1260000
    s_mov_b32 s7, 0x20000
    s_mov_b32 s14, 0x12000
    s_mov_b32 s15, 0x20000
    s_mov_b32 s18, 0x548
    s_mov_b32 s19, 0x20000
    s_mov_b32 s22, 0x1260000
    s_mov_b32 s23, 0x20000
    s_and_b32 s52, s52, 0x1e000
    v_lshlrev_b32 v199, 1, v184
    v_lshrrev_b32 v185, 4, v184
    v_and_b32 v186, 7, v184
    v_bfe_u32 v187, v184, 3, 1
    v_and_b32 v103, 1, v185
    v_mul_u32_u24 v102, 0x1e40, v187
    v_mul_u32_u24 v100, 0x180, v186
    v_mul_u32_u24 v74, 0x180, v76
    v_lshl_add_u32 v192, v77, 4, v74
    v_mul_u32_u24 v74, 0x180, v78
    v_lshl_add_u32 v193, v79, 4, v74
    v_mul_u32_u24 v74, 0x180, v80
    v_lshl_add_u32 v194, v81, 4, v74
    v_cmp_lt_u32 vcc, 5, v186
    v_lshlrev_b32 v239, 4, v184
    v_add_u32 v239, 0x12e00, v239
    s_mov_b32 s37, 0x3e553b95
    s_mov_b32 s40, 0x140
    v_mov_b32 v250, 1.0
    v_lshrrev_b32 v60, 1, v185
    v_lshl_add_u32 v61, v187, 1, v60
    v_lshlrev_b32 v232, 2, v61
    v_lshl_add_u32 v61, v187, 2, v185
    v_lshlrev_b32 v233, 2, v61
    v_sub_u32 v60, v60, v187
    v_mul_i32_i24 v60, 0x140, v60
    v_lshl_add_u32 v61, v103, 2, 3
    v_sub_u32 v62, v61, v186
    v_min_u32 v63, 10, v62
    v_mad_u32_u24 v64, v186, 3, v103
    v_add_u32 v65, 11, v64
    v_add_u32 v62, 8, v62
    s_mov_b32 s60, 0x2222
    s_mov_b32 s61, 0x4444
    s_mov_b32 s62, 0x8808
    s_mov_b32 s63, 0x32104321
    s_mov_b32 s64, 0x76540765
    s_mov_b32 s65, 0x2222
    s_mov_b32 s66, 0x10002100
    s_waitcnt lgkmcnt(0)
    s_mov_b32 s8, s26
    s_and_b32 s9, s27, 0xffff
    buffer_load_dword v188, v189, s[8:11], s53 offen
    buffer_load_dwordx4 v251, s[8:11], s57 offen lds
    s_add_u32 m0, s50, 0x400
    s_lshr_b32 s53, s2, 3
    buffer_load_dwordx4 v252, s[8:11], s57 offen lds
    s_add_u32 m0, s50, 0x800
    s_lshr_b32 s55, s53, 3
    buffer_load_dwordx4 v253, s[8:11], s57 offen lds
    s_add_u32 s57, s49, 0x9180
    s_add_u32 m0, s50, 0x3000
    s_or_b32 s34, s54, s55
    buffer_load_dwordx4 v251, s[8:11], s57 offen lds
    s_add_u32 m0, s50, 0x3400
    s_and_b32 s35, s53, 7
    buffer_load_dwordx4 v252, s[8:11], s57 offen lds
    s_add_u32 m0, s50, 0x3800
    s_bfe_u32 s54, s2, 0x10002
    s_mul_i32 s54, s54, 0x15000
    s_bfe_u32 s55, s2, 0x10001
    s_mul_i32 s55, s55, 0x180
    s_add_u32 s38, s54, s55
    s_mul_i32 s54, s35, 14
    s_sub_u32 s54, s54, 3
    s_movk_i32 s53, 0x6f
    s_lshr_b32 s55, s41, 4
    v_add_u32 v96, s55, v184
    v_mul_u32_u24 v97, 0xaab, v96
    v_lshrrev_b32 v97, 16, v97
    v_mul_u32_u24 v98, 24, v97
    v_sub_u32 v96, v96, v98
    v_and_b32 v98, 2, v97
    v_xor_b32 v96, v96, v98
    v_add_u32 v97, s54, v97
    buffer_load_dwordx4 v253, s[8:11], s57 offen lds
    v_med3_i32 v97, v97, 0, s53
    v_mul_u32_u24 v97, 0x300, v97
    v_lshl_add_u32 v246, v96, 4, v97
    s_lshr_b32 s55, s42, 4
    v_add_u32 v96, s55, v184
    v_mul_u32_u24 v97, 0xaab, v96
    v_lshrrev_b32 v97, 16, v97
    v_mul_u32_u24 v98, 24, v97
    v_sub_u32 v96, v96, v98
    v_and_b32 v98, 2, v97
    v_xor_b32 v96, v96, v98
    v_add_u32 v97, s54, v97
    v_med3_i32 v97, v97, 0, s53
    v_mul_u32_u24 v97, 0x300, v97
    v_lshl_add_u32 v247, v96, 4, v97
    s_mul_i32 s51, s34, 0x24c000
    s_add_u32 s51, s51, s38
    s_sub_u32 s39, s51, 0x7e000
    s_cmp_eq_u32 s34, 0
    s_cselect_b32 s43, 8, 0
    s_cselect_b32 s44, 9, 1
    s_cselect_b32 s45, 3, 2
    s_mul_i32 s43, s43, 0x2a000
    s_add_u32 s43, s43, s39
    s_mul_i32 s44, s44, 0x2a000
    s_add_u32 s44, s44, s39
    s_mul_i32 s45, s45, 0x2a000
    s_add_u32 s45, s45, s39
    s_mov_b32 s4, s24
    s_and_b32 s5, s25, 0xffff
    s_add_u32 m0, s41, 0
    s_mov_b32 s12, s28
    buffer_load_dwordx4 v246, s[4:7], s43 offen lds
    s_add_u32 m0, s42, 0
    s_and_b32 s13, s29, 0xffff
    s_mov_b32 s16, s30
    s_and_b32 s17, s31, 0xffff
    s_mov_b32 s20, s32
    s_and_b32 s21, s33, 0xffff
    buffer_load_dwordx4 v247, s[4:7], s43 offen lds
    s_add_u32 m0, s41, 0x1e40
    s_add_u32 s57, s49, 0x12180
    s_add_u32 s56, s39, 0x7e000
    s_mul_i32 s55, s36, 0x152
    v_bfe_u32 v96, v184, 2, 2
    v_and_b32 v97, 3, v184
    v_lshl_add_u32 v99, v185, 3, v96
    v_lshl_add_u32 v99, v103, 2, v99
    v_lshl_add_u32 v101, v97, 3, s50
    s_movk_i32 s27, 0x60
    v_mad_u32_u24 v254, v99, s27, v101
    v_xor_b32 v99, 4, v99
    v_mad_u32_u24 v255, v99, s27, v101
    v_and_b32 v98, 2, v184
    v_xor_b32 v98, v98, v185
    v_lshlrev_b32 v98, 4, v98
    v_add3_u32 v224, v98, v100, v102
    v_mul_u32_u24 v99, 0x1e40, v96
    v_mul_u32_u24 v227, 0x180, v97
    v_add3_u32 v227, v227, v98, v99
    buffer_load_dwordx4 v246, s[4:7], s44 offen lds
    s_add_u32 m0, s42, 0x1e40
    v_add_u32 v98, 3, v186
    v_and_b32 v98, 2, v98
    v_xor_b32 v98, v98, v185
    v_lshl_add_u32 v98, v98, 4, v100
    v_add_u32 v225, v98, v102
    v_xor_b32 v99, 1, v187
    v_mul_u32_u24 v99, 0xd3c0, v99
    v_add_u32 v226, v98, v99
    v_lshl_add_u32 v99, v185, 2, v96
    v_and_b32 v98, 2, v185
    v_lshlrev_b32 v98, 1, v98
    v_xor_b32 v99, v99, v98
    v_mad_u32_u24 v99, v99, s27, v101
    s_and_b32 s24, s36, 1
    s_lshl_b32 s25, s24, 5
    s_lshl_b32 s26, s24, 6
    s_sub_u32 s26, 64, s26
    buffer_load_dwordx4 v247, s[4:7], s44 offen lds
    s_add_u32 m0, s50, 0x6000
    v_add_u32 v241, s26, v99
    v_lshl_add_u32 v99, v97, 3, v99
    v_add_u32 v240, s25, v99
    v_mul_u32_u24 v99, 0x2a000, v187
    v_lshl_add_u32 v99, v100, 1, v99
    v_lshl_add_u32 v99, v185, 3, v99
    v_add_u32 v243, s26, v99
    v_lshl_add_u32 v99, v185, 3, v99
    v_add_u32 v242, s25, v99
    v_bfrev_b32 v99, 1
    s_mul_i32 s27, s35, 0x2a00
    v_cndmask_b32 v244, v242, v99, vcc
    v_cndmask_b32 v245, v243, v99, vcc
    s_add_u32 s51, s51, s27
    s_add_u32 s51, s51, s49
    s_add_u32 s58, s51, 0
    s_add_u32 s59, s51, 0x1800
    s_lshr_b32 s25, s36, 1
    s_mul_i32 s25, s25, 0xc00
    buffer_load_dwordx4 v251, s[8:11], s57 offen lds
    s_add_u32 m0, s50, 0x6400
    s_lshl_b32 s26, s24, 11
    s_add_u32 s26, s26, s25
    v_add_u32 v237, s26, v239
    s_lshl_b32 s26, s24, 3
    s_add_u32 s26, s26, s25
    s_add_u32 s26, s26, 0x400
    v_add_u32 v238, s26, v239
    s_cmp_eq_u32 s34, 7
    s_cselect_b32 s46, 16, 17
    s_cselect_b32 s47, 10, 18
    s_cselect_b32 s48, 11, 19
    s_mul_i32 s46, s46, 0x2a000
    s_add_u32 s46, s46, s39
    s_mul_i32 s47, s47, 0x2a000
    s_add_u32 s47, s47, s39
    s_mul_i32 s48, s48, 0x2a000
    s_add_u32 s48, s48, s39
    v_mov_b32 v96, 0x3f803f80
    v_accvgpr_write_b32 a216, v96
    buffer_load_dwordx4 v252, s[8:11], s57 offen lds
    s_add_u32 m0, s50, 0x6800
    v_accvgpr_write_b32 a217, v96
    v_accvgpr_write_b32 a218, v96
    v_accvgpr_write_b32 a219, v96
    s_cmp_eq_u32 s35, 0
    s_cselect_b32 s29, 3, 0
    s_cselect_b32 s30, -3, -2
    s_cmp_eq_u32 s35, 7
    s_cselect_b32 s33, 2, 64
    s_mul_i32 s32, s36, 0xf00
    s_add_u32 s32, s32, 0xf200
    s_sub_u32 s31, s32, 0x140
    v_add_u32 v60, s31, v60
    v_cmp_gt_u32 vcc, s29, v186
    s_mov_b32 s67, 0x54326543
    s_mov_b32 s68, 0x760007
    v_cndmask_b32 v63, v63, v65, vcc
    v_lshl_add_u32 v228, v63, 4, v60
    buffer_load_dwordx4 v253, s[8:11], s57 offen lds
    s_add_u32 s57, s49, 0x1b180
    s_add_u32 m0, s50, 0x9000
    v_min_u32 v63, 10, v62
    v_lshl_add_u32 v62, v103, 4, v186
    v_cmp_gt_u32 vcc, s29, v62
    v_add_u32 v65, 13, v64
    v_min_u32 v62, 5, v186
    v_cndmask_b32 v63, v63, v65, vcc
    v_lshl_add_u32 v229, v63, 4, v60
    v_cmp_lt_u32 vcc, s33, v62
    v_sub_u32 v63, v61, v62
    v_min_u32 v63, 10, v63
    v_mad_u32_u24 v64, v62, 3, 2
    v_add_u32 v65, v64, v103
    v_cndmask_b32 v63, v63, v65, vcc
    v_lshl_add_u32 v230, v63, 4, v60
    v_sub_u32 v63, 11, v62
    v_min_u32 v63, 10, v63
    buffer_load_dwordx4 v251, s[8:11], s57 offen lds
    s_add_u32 m0, s50, 0x9400
    v_add_u32 v65, 2, v64
    v_cndmask_b32 v63, v63, v65, vcc
    v_lshl_add_u32 v231, v63, 4, s32
    s_mov_b32 s69, 0x32104321
    s_mov_b32 s70, 0x76540765
    s_mov_b32 s71, 0x10002100
    s_mov_b32 s72, 0x760007
    s_mov_b32 s73, 0x2222
    s_mov_b32 s74, 0x8808
    s_mov_b32 s75, 0x760007
    s_mov_b32 s76, 0x10002100
    s_mov_b32 s77, 0x6666
    s_mov_b32 s78, 0x8808
    s_mov_b32 s79, 0x32104321
    s_mov_b32 s80, 0x76540765
    s_cmp_eq_u32 s34, 0
    s_cmov_b32 s60, 0xbbbb
    s_cmov_b32 s61, 0x4241
    buffer_load_dwordx4 v252, s[8:11], s57 offen lds
    s_add_u32 m0, s50, 0x9800
    v_bfe_u32 v234, s60, v232, 4
    v_mad_u32_u24 v235, v234, s40, v228
    v_mad_u32_u24 v234, v234, s40, v229
    v_bfe_u32 v236, s61, v232, 4
    s_cmp_eq_u32 s34, 0
    s_cmov_b32 s62, 0x8898
    s_cmov_b32 s63, 0x30a940ba
    s_cmp_eq_u32 s34, 0
    s_cmov_b32 s64, 0x76549765
    s_cmov_b32 s65, 0x2221
    s_cmp_eq_u32 s34, 0
    s_cmov_b32 s66, 0x10002000
    s_cmov_b32 s68, 0x760097
    s_cmp_eq_u32 s34, 7
    s_cmov_b32 s73, 0x2d22
    s_cmov_b32 s74, 0x1808
    s_cmp_eq_u32 s34, 7
    s_cmov_b32 s75, 0x60007
    s_cmov_b32 s76, 0x1b002100
    buffer_load_dwordx4 v253, s[8:11], s57 offen lds
    s_add_u32 s57, s49, 0x24180
    s_add_u32 m0, s50, 0xc000
    s_mov_b64 exec, 0
    s_cmp_eq_u32 s36, 0
    s_cbranch_scc1 L_pg1
    s_cmp_eq_u32 s36, 1
    s_cbranch_scc1 L_pg2
    s_cmp_eq_u32 s36, 2
    s_cbranch_scc1 L_pg3
    s_branch L_pg4
    .p2align 12
L_back:
    s_mov_b64 exec, -1
    buffer_load_dwordx4 v251, s[8:11], s57 offen lds
    s_add_u32 m0, s50, 0xc400
    buffer_load_dword v188, v189, s[12:15], s52 offen
    buffer_load_dwordx4 v252, s[8:11], s57 offen lds
    s_add_u32 m0, s50, 0xc800
    buffer_load_ushort v196, v199, s[16:19], s55 offen
    buffer_load_dwordx4 v253, s[8:11], s57 offen lds
    s_add_u32 s57, s49, 0x2d180
    s_add_u32 m0, s50, 0xf000
    buffer_load_ushort v197, v199, s[16:19], s55 offen offset:128
    buffer_load_dwordx4 v251, s[8:11], s57 offen lds
    s_add_u32 m0, s50, 0xf400
    s_waitcnt vmcnt(20)
    ds_read_b64_tr_b16 a[0:1], v254
    ds_read_b64_tr_b16 a[2:3], v255
    ds_read_b64_tr_b16 a[4:5], v254 offset:32
    ds_read_b64_tr_b16 a[6:7], v255 offset:32
    ds_read_b64_tr_b16 a[8:9], v254 offset:64
    ds_read_b64_tr_b16 a[10:11], v255 offset:64
    buffer_load_dwordx4 v252, s[8:11], s57 offen lds
    s_add_u32 m0, s50, 0xf800
    s_waitcnt vmcnt(18)
    ds_read_b64_tr_b16 a[12:13], v254 offset:12288
    ds_read_b64_tr_b16 a[14:15], v255 offset:12288
    ds_read_b64_tr_b16 a[16:17], v254 offset:12320
    ds_read_b64_tr_b16 a[18:19], v255 offset:12320
    ds_read_b64_tr_b16 a[20:21], v254 offset:12352
    ds_read_b64_tr_b16 a[22:23], v255 offset:12352
    s_cmp_eq_u32 s34, 7
    s_cmov_b32 s77, 0x1606
    s_cmov_b32 s78, 0xbbbb
    s_cmp_eq_u32 s34, 7
    s_cmov_b32 s79, 0x321b4321
    s_cmov_b32 s80, 0xa904ba05
    s_waitcnt vmcnt(14)
    s_barrier
    ds_read_b128 a[232:235], v224
    ds_read_b128 a[236:239], v224 offset:64
    ds_read_b128 a[240:243], v224 offset:128
    s_lshl_b32 s31, s36, 10
    s_add_u32 s31, s31, 0x12e40
    v_and_b32 v118, 31, v184
    buffer_load_dwordx4 v253, s[8:11], s57 offen lds
    s_add_u32 m0, s41, 0x3c80
    s_add_u32 s57, s49, 0x300
    ds_read_b128 a[244:247], v224 offset:192
    ds_read_b128 a[248:251], v224 offset:256
    ds_read_b128 a[252:255], v224 offset:320
    v_min_u32 v118, 19, v118
    v_lshrrev_b32 v119, 5, v184
    v_add_u32 v120, -11, v118
    ds_read_b128 a[220:223], v224 offset:3072
    v_max_i32 v120, 0, v120
    ds_read_b128 a[224:227], v224 offset:3136
    v_mul_u32_u24 v121, 11, v120
    ds_read_b128 a[228:231], v224 offset:3200
    buffer_load_dwordx4 v246, s[4:7], s45 offen lds
    s_add_u32 m0, s42, 0x3c80
    v_lshrrev_b32 v121, 5, v121
    v_mul_u32_u24 v122, 3, v121
    s_waitcnt lgkmcnt(8)
    v_mfma_f32_16x16x32_bf16 v[176:179], a[0:3], a[232:235], 0
    s_cmp_eq_u32 s34, 0
    s_cselect_b32 s28, 0x208, 0
    v_sub_u32 v120, v120, v122
    v_mfma_f32_16x16x32_bf16 v[180:183], a[4:7], a[232:235], 0
    v_lshlrev_b32 v120, 2, v120
    v_sub_u32 v121, v120, v121
    v_mfma_f32_16x16x32_bf16 v[200:203], a[8:11], a[232:235], 0
    s_waitcnt lgkmcnt(7)
    ds_read_b128 a[232:235], v224 offset:3264
    v_cmp_lt_u32 vcc, 10, v118
    v_mfma_f32_16x16x32_bf16 v[176:179], a[12:15], a[236:239], v[176:179]
    v_add_u32 v121, s29, v121
    v_add_u32 v120, s30, v120
    v_mfma_f32_16x16x32_bf16 v[180:183], a[16:19], a[236:239], v[180:183]
    s_waitcnt lgkmcnt(3)
    buffer_load_dwordx4 v247, s[4:7], s45 offen lds
    v_mfma_f32_16x16x32_bf16 v[200:203], a[20:23], a[236:239], v[200:203]
    s_add_u32 m0, s41, 0x5ac0
    ds_read_b128 a[236:239], v224 offset:3328
    v_add_u32 v122, -3, v118
    v_mfma_f32_16x16x32_bf16 v[204:207], a[0:3], a[220:223], 0
    v_cndmask_b32 v121, v118, v121, vcc
    v_cndmask_b32 v120, v122, v120, vcc
    v_mfma_f32_16x16x32_bf16 v[208:211], a[4:7], a[220:223], 0
    v_mad_u32_u24 v121, v119, 13, v121
    v_lshl_add_u32 v121, v121, 2, s31
    v_mfma_f32_16x16x32_bf16 v[212:215], a[8:11], a[220:223], 0
    s_waitcnt vmcnt(14) lgkmcnt(3)
    ds_read_b64_tr_b16 a[24:25], v254 offset:24576
    ds_read_b64_tr_b16 a[26:27], v255 offset:24576
    v_mfma_f32_16x16x32_bf16 v[204:207], a[12:15], a[224:227], v[204:207]
    buffer_load_dwordx4 v246, s[4:7], s56 offen lds
    v_mfma_f32_16x16x32_bf16 v[208:211], a[16:19], a[224:227], v[208:211]
    s_add_u32 m0, s42, 0x5ac0
    ds_read_b64_tr_b16 a[28:29], v254 offset:24608
    ds_read_b64_tr_b16 a[30:31], v255 offset:24608
    v_mfma_f32_16x16x32_bf16 v[212:215], a[20:23], a[224:227], v[212:215]
    s_waitcnt lgkmcnt(2)
    ds_read_b64_tr_b16 a[32:33], v254 offset:24640
    ds_read_b64_tr_b16 a[34:35], v255 offset:24640
    v_add_u32 v122, s28, v121
    v_cmp_gt_u32 s[24:25], 7, v120
    v_add_u32 v120, 1, v120
    v_cmp_gt_u32 s[26:27], 7, v120
    v_add_u32 v120, 1, v120
    v_cmp_gt_u32 s[52:53], 7, v120
    v_add_u32 v120, 1, v120
    v_lshl_add_u32 v118, v118, 4, s32
    v_mad_u32_u24 v123, v119, s40, v118
    v_lshlrev_b32 v119, 3, v119
    v_mad_u32_u24 v124, v119, s40, v118
    v_lshl_add_u32 v125, v184, 2, s31
    buffer_load_dwordx4 v247, s[4:7], s56 offen lds
    s_add_u32 s56, s39, 0xa8000
    s_add_u32 m0, s41, 0x7900
    v_mfma_f32_16x16x32_bf16 v[176:179], a[24:27], a[240:243], v[176:179]
    s_mov_b32 s28, 0x3fb8aa3b
    v_mov_b32 v168, 0xf149f2ca
    v_mov_b32 v169, 0xf149f2ca
    v_mfma_f32_16x16x32_bf16 v[204:207], a[24:27], a[228:231], v[204:207]
    s_waitcnt lgkmcnt(2)
    v_mov_b32 v170, 0xf149f2ca
    v_mov_b32 v171, 0xf149f2ca
    v_mfma_f32_16x16x32_bf16 v[180:183], a[28:31], a[240:243], v[180:183]
    s_waitcnt lgkmcnt(0)
    v_mfma_f32_16x16x32_bf16 v[200:203], a[32:35], a[240:243], v[200:203]
    ds_read_b128 a[240:243], v224 offset:3392
    v_mfma_f32_16x16x32_bf16 v[208:211], a[28:31], a[228:231], v[208:211]
    buffer_load_ushort v198, v199, s[16:19], s55 offen offset:256
    v_mfma_f32_16x16x32_bf16 v[212:215], a[32:35], a[228:231], v[212:215]
    s_waitcnt vmcnt(14)
    v_cmp_gt_u32 s[54:55], 7, v120
    ds_read_b64_tr_b16 a[36:37], v254 offset:36864
    ds_read_b64_tr_b16 a[38:39], v255 offset:36864
    ds_read_b64_tr_b16 a[40:41], v254 offset:36896
    ds_read_b64_tr_b16 a[42:43], v255 offset:36896
    ds_read_b64_tr_b16 a[44:45], v254 offset:36928
    ds_read_b64_tr_b16 a[46:47], v255 offset:36928
    buffer_load_dwordx4 v246, s[4:7], s56 offen lds
    s_add_u32 m0, s42, 0x7900
    s_nop 0
    buffer_load_dwordx4 v247, s[4:7], s56 offen lds
    s_waitcnt lgkmcnt(4)
    v_mfma_f32_16x16x32_bf16 v[176:179], a[36:39], a[244:247], v[176:179]
    s_add_u32 s56, s39, 0xd2000
    s_add_u32 m0, s41, 0x9740
    s_waitcnt lgkmcnt(2)
    v_mfma_f32_16x16x32_bf16 v[180:183], a[40:43], a[244:247], v[180:183]
    s_waitcnt lgkmcnt(0)
    v_mfma_f32_16x16x32_bf16 v[200:203], a[44:47], a[244:247], v[200:203]
    v_mfma_f32_16x16x32_bf16 v[204:207], a[36:39], a[232:235], v[204:207]
    v_mfma_f32_16x16x32_bf16 v[208:211], a[40:43], a[232:235], v[208:211]
    v_mfma_f32_16x16x32_bf16 v[212:215], a[44:47], a[232:235], v[212:215]
    s_waitcnt vmcnt(10)
    buffer_load_dwordx4 v246, s[4:7], s56 offen lds
    s_add_u32 m0, s42, 0x9740
    s_nop 0
    buffer_load_dwordx4 v247, s[4:7], s56 offen lds
    s_add_u32 s56, s39, 0xfc000
    s_add_u32 m0, s41, 0xb580
    v_lshlrev_b32 v196, 16, v196
    v_mul_f32 v196, s28, v196
    ds_write_b32 v125, v196
    buffer_load_dwordx4 v246, s[4:7], s56 offen lds
    s_add_u32 m0, s42, 0xb580
    s_nop 0
    ds_read_b64_tr_b16 a[48:49], v254 offset:49152
    ds_read_b64_tr_b16 a[50:51], v255 offset:49152
    ds_read_b64_tr_b16 a[52:53], v254 offset:49184
    ds_read_b64_tr_b16 a[54:55], v255 offset:49184
    ds_read_b64_tr_b16 a[56:57], v254 offset:49216
    ds_read_b64_tr_b16 a[58:59], v255 offset:49216
    v_lshlrev_b32 v197, 16, v197
    v_mul_f32 v197, s28, v197
    ds_write_b32 v125, v197 offset:256
    buffer_load_dwordx4 v247, s[4:7], s56 offen lds
    s_add_u32 s56, s39, 0x126000
    s_add_u32 m0, s41, 0xd3c0
    s_nop 0
    s_waitcnt lgkmcnt(5)
    v_mfma_f32_16x16x32_bf16 v[176:179], a[48:51], a[248:251], v[176:179]
    s_waitcnt lgkmcnt(3)
    v_mfma_f32_16x16x32_bf16 v[180:183], a[52:55], a[248:251], v[180:183]
    s_waitcnt lgkmcnt(1)
    buffer_load_dwordx4 v246, s[4:7], s56 offen lds
    v_mfma_f32_16x16x32_bf16 v[200:203], a[56:59], a[248:251], v[200:203]
    s_add_u32 m0, s42, 0xd3c0
    v_mfma_f32_16x16x32_bf16 v[204:207], a[48:51], a[236:239], v[204:207]
    v_mfma_f32_16x16x32_bf16 v[208:211], a[52:55], a[236:239], v[208:211]
    v_mfma_f32_16x16x32_bf16 v[212:215], a[56:59], a[236:239], v[212:215]
    s_waitcnt vmcnt(12)
    buffer_load_dwordx4 v247, s[4:7], s56 offen lds
    s_add_u32 m0, s50, 0
    s_add_u32 s56, s39, 0x150000
    ds_read_b64_tr_b16 a[60:61], v254 offset:61440
    ds_read_b64_tr_b16 a[62:63], v255 offset:61440
    ds_read_b64_tr_b16 a[64:65], v254 offset:61472
    ds_read_b64_tr_b16 a[66:67], v255 offset:61472
    ds_read_b64_tr_b16 a[68:69], v254 offset:61504
    ds_read_b64_tr_b16 a[70:71], v255 offset:61504
    buffer_load_dwordx4 v251, s[8:11], s57 offen lds
    s_add_u32 m0, s50, 0x400
    s_nop 0
    s_waitcnt lgkmcnt(4)
    v_mfma_f32_16x16x32_bf16 v[176:179], a[60:63], a[252:255], v[176:179]
    s_waitcnt lgkmcnt(0)
    buffer_load_dwordx4 v252, s[8:11], s57 offen lds
    v_mfma_f32_16x16x32_bf16 v[180:183], a[64:67], a[252:255], v[180:183]
    s_add_u32 m0, s50, 0x800
    v_mfma_f32_16x16x32_bf16 v[200:203], a[68:71], a[252:255], v[200:203]
    v_mfma_f32_16x16x32_bf16 v[204:207], a[60:63], a[240:243], v[204:207]
    v_mfma_f32_16x16x32_bf16 v[208:211], a[64:67], a[240:243], v[208:211]
    v_mfma_f32_16x16x32_bf16 v[212:215], a[68:71], a[240:243], v[212:215]
    s_waitcnt vmcnt(10)
    buffer_load_dwordx4 v253, s[8:11], s57 offen lds
    s_add_u32 s57, s49, 0x9300
    s_add_u32 m0, s50, 0x3000
    v_cvt_pk_bf16_f32 v0, v176, v177
    v_cvt_pk_bf16_f32 v1, v178, v179
    v_cvt_pk_bf16_f32 v2, v180, v181
    v_cvt_pk_bf16_f32 v3, v182, v183
    v_cvt_pk_bf16_f32 v4, v200, v201
    v_cvt_pk_bf16_f32 v5, v202, v203
    v_cvt_pk_bf16_f32 v24, v204, v205
    v_cvt_pk_bf16_f32 v25, v206, v207
    v_cvt_pk_bf16_f32 v26, v208, v209
    v_cvt_pk_bf16_f32 v27, v210, v211
    v_cvt_pk_bf16_f32 v28, v212, v213
    v_cvt_pk_bf16_f32 v29, v214, v215
    buffer_load_dwordx4 v251, s[8:11], s57 offen lds
    s_add_u32 m0, s50, 0x3400
    s_nop 0
    s_barrier
    ds_read_b128 a[244:247], v224 offset:15488
    ds_read_b128 a[248:251], v224 offset:15552
    ds_read_b128 a[252:255], v224 offset:15616
    v_lshlrev_b32 v198, 16, v198
    ds_read_b128 a[220:223], v224 offset:15680
    v_mul_f32 v198, s28, v198
    ds_read_b128 a[224:227], v224 offset:15744
    buffer_load_dwordx4 v252, s[8:11], s57 offen lds
    s_add_u32 m0, s50, 0x3800
    ds_read_b128 a[228:231], v224 offset:15808
    ds_read_b128 a[232:235], v224 offset:18560
    ds_read_b128 a[236:239], v224 offset:18624
    ds_read_b128 a[240:243], v224 offset:18688
    ds_write_b32 v125, v198 offset:512
    ds_read2_b32 v[144:145], v121 offset0:39 offset1:40
    s_waitcnt lgkmcnt(10)
    v_mfma_f32_16x16x32_bf16 v[216:219], a[0:3], a[244:247], 0
    buffer_load_dwordx4 v253, s[8:11], s57 offen lds
    v_mfma_f32_16x16x32_bf16 v[220:223], a[4:7], a[244:247], 0
    s_add_u32 s57, s49, 0x12300
    ds_read2_b32 v[146:147], v121 offset0:41 offset1:42
    ds_read2_b32 v[148:149], v121 offset0:65 offset1:66
    v_mfma_f32_16x16x32_bf16 v[176:179], a[8:11], a[244:247], 0
    s_add_u32 m0, s50, 0x6000
    ds_read_b128 a[244:247], v224 offset:18752
    ds_read2_b32 v[150:151], v121 offset0:67 offset1:68
    s_waitcnt lgkmcnt(13)
    v_mfma_f32_16x16x32_bf16 v[216:219], a[12:15], a[248:251], v[216:219]
    ds_read2_b32 v[152:153], v121 offset0:91 offset1:92
    ds_read2_b32 v[154:155], v121 offset0:93 offset1:94
    v_mfma_f32_16x16x32_bf16 v[220:223], a[16:19], a[248:251], v[220:223]
    ds_read2_b32 v[156:157], v121 offset0:117 offset1:118
    ds_read2_b32 v[158:159], v121 offset0:119 offset1:120
    v_mfma_f32_16x16x32_bf16 v[176:179], a[20:23], a[248:251], v[176:179]
    s_waitcnt lgkmcnt(14)
    ds_read_b128 a[248:251], v224 offset:18816
    ds_read2_b32 v[160:161], v122 offset0:0 offset1:1
    v_mfma_f32_16x16x32_bf16 v[216:219], a[24:27], a[252:255], v[216:219]
    buffer_load_dwordx4 v251, s[8:11], s57 offen lds
    v_mfma_f32_16x16x32_bf16 v[220:223], a[28:31], a[252:255], v[220:223]
    s_add_u32 m0, s50, 0x6400
    ds_read2_b32 v[162:163], v122 offset0:2 offset1:3
    ds_read2_b32 v[164:165], v122 offset0:13 offset1:14
    v_mfma_f32_16x16x32_bf16 v[176:179], a[32:35], a[252:255], v[176:179]
    ds_read_b128 a[252:255], v224 offset:18880
    ds_read2_b32 v[166:167], v122 offset0:15 offset1:16
    v_mfma_f32_16x16x32_bf16 v[216:219], a[36:39], a[220:223], v[216:219]
    s_waitcnt lgkmcnt(14)
    v_cndmask_b32 v144, v168, v144, s[24:25]
    v_cndmask_b32 v145, v168, v145, s[26:27]
    v_mfma_f32_16x16x32_bf16 v[220:223], a[40:43], a[220:223], v[220:223]
    s_waitcnt lgkmcnt(13)
    v_cndmask_b32 v146, v168, v146, s[52:53]
    v_cndmask_b32 v147, v168, v147, s[54:55]
    v_mfma_f32_16x16x32_bf16 v[176:179], a[44:47], a[220:223], v[176:179]
    s_waitcnt lgkmcnt(12)
    buffer_load_dwordx4 v252, s[8:11], s57 offen lds
    v_mfma_f32_16x16x32_bf16 v[216:219], a[48:51], a[224:227], v[216:219]
    s_add_u32 m0, s50, 0x6800
    ds_read_b128 a[220:223], v227 offset:6144
    v_cndmask_b32 v148, v168, v148, s[24:25]
    v_mfma_f32_16x16x32_bf16 v[220:223], a[52:55], a[224:227], v[220:223]
    s_waitcnt vmcnt(12)
    ds_write_b128 v123, v[144:147] offset:320
    v_mfma_f32_16x16x32_bf16 v[176:179], a[56:59], a[224:227], v[176:179]
    s_barrier
    ds_read_b128 a[224:227], v227 offset:6208
    v_cndmask_b32 v149, v168, v149, s[26:27]
    v_mfma_f32_16x16x32_bf16 v[216:219], a[60:63], a[228:231], v[216:219]
    s_waitcnt lgkmcnt(8)
    v_cndmask_b32 v150, v168, v150, s[52:53]
    v_cndmask_b32 v151, v168, v151, s[54:55]
    v_mfma_f32_16x16x32_bf16 v[220:223], a[64:67], a[228:231], v[220:223]
    buffer_load_dwordx4 v253, s[8:11], s57 offen lds
    v_mfma_f32_16x16x32_bf16 v[176:179], a[68:71], a[228:231], v[176:179]
    s_add_u32 s57, s49, 0x1b300
    ds_read_b128 a[228:231], v227 offset:6272
    v_cndmask_b32 v152, v168, v152, s[24:25]
    v_mfma_f32_16x16x32_bf16 v[180:183], a[0:3], a[232:235], 0
    s_add_u32 m0, s50, 0x9000
    v_cvt_pk_bf16_f32 v6, v216, v217
    v_cvt_pk_bf16_f32 v7, v218, v219
    v_mfma_f32_16x16x32_bf16 v[200:203], a[4:7], a[232:235], 0
    v_cvt_pk_bf16_f32 v8, v220, v221
    v_cvt_pk_bf16_f32 v9, v222, v223
    v_mfma_f32_16x16x32_bf16 v[204:207], a[8:11], a[232:235], 0
    v_cvt_pk_bf16_f32 v10, v176, v177
    v_cvt_pk_bf16_f32 v11, v178, v179
    v_mfma_f32_16x16x32_bf16 v[180:183], a[12:15], a[236:239], v[180:183]
    buffer_load_dwordx4 v251, s[8:11], s57 offen lds
    v_mfma_f32_16x16x32_bf16 v[200:203], a[16:19], a[236:239], v[200:203]
    s_add_u32 m0, s50, 0x9400
    ds_read_b128 a[232:235], v227 offset:6336
    v_cndmask_b32 v153, v168, v153, s[26:27]
    v_mfma_f32_16x16x32_bf16 v[204:207], a[20:23], a[236:239], v[204:207]
    ds_read_b128 a[236:239], v227 offset:6400
    v_cndmask_b32 v154, v168, v154, s[52:53]
    v_mfma_f32_16x16x32_bf16 v[180:183], a[24:27], a[240:243], v[180:183]
    ds_write_b128 v123, v[148:151] offset:960
    v_mfma_f32_16x16x32_bf16 v[200:203], a[28:31], a[240:243], v[200:203]
    v_cndmask_b32 v155, v168, v155, s[54:55]
    v_cndmask_b32 v156, v168, v156, s[24:25]
    v_mfma_f32_16x16x32_bf16 v[204:207], a[32:35], a[240:243], v[204:207]
    buffer_load_dwordx4 v252, s[8:11], s57 offen lds
    v_mfma_f32_16x16x32_bf16 v[180:183], a[36:39], a[244:247], v[180:183]
    s_add_u32 m0, s50, 0x9800
    ds_read_b128 a[240:243], v227 offset:6464
    v_cndmask_b32 v157, v168, v157, s[26:27]
    v_mfma_f32_16x16x32_bf16 v[200:203], a[40:43], a[244:247], v[200:203]
    ds_write_b128 v123, v[152:155] offset:1600
    v_mfma_f32_16x16x32_bf16 v[204:207], a[44:47], a[244:247], v[204:207]
    ds_read_b128 a[244:247], v224 offset:30976
    v_cndmask_b32 v158, v168, v158, s[52:53]
    v_mfma_f32_16x16x32_bf16 v[180:183], a[48:51], a[248:251], v[180:183]
    s_waitcnt lgkmcnt(5)
    v_cndmask_b32 v159, v168, v159, s[54:55]
    v_cndmask_b32 v160, v168, v160, s[24:25]
    v_mfma_f32_16x16x32_bf16 v[200:203], a[52:55], a[248:251], v[200:203]
    buffer_load_dwordx4 v253, s[8:11], s57 offen lds
    v_mfma_f32_16x16x32_bf16 v[204:207], a[56:59], a[248:251], v[204:207]
    s_add_u32 s57, s49, 0x24300
    ds_read_b128 a[248:251], v224 offset:31040
    v_cndmask_b32 v161, v168, v161, s[26:27]
    v_mfma_f32_16x16x32_bf16 v[180:183], a[60:63], a[252:255], v[180:183]
    s_add_u32 m0, s50, 0xc000
    ds_write_b128 v123, v[156:159] offset:2240
    v_mfma_f32_16x16x32_bf16 v[200:203], a[64:67], a[252:255], v[200:203]
    s_waitcnt vmcnt(12)
    s_barrier
    v_cndmask_b32 v162, v168, v162, s[52:53]
    v_cndmask_b32 v163, v168, v163, s[54:55]
    v_mfma_f32_16x16x32_bf16 v[204:207], a[68:71], a[252:255], v[204:207]
    ds_read_b128 a[252:255], v224 offset:31104
    v_cvt_pk_bf16_f32 v30, v180, v181
    v_mfma_f32_16x16x32_bf16 v[208:211], a[0:3], a[220:223], 0
    buffer_load_dwordx4 v251, s[8:11], s57 offen lds
    v_mfma_f32_16x16x32_bf16 v[212:215], a[4:7], a[220:223], 0
    s_add_u32 m0, s50, 0xc400
    v_cvt_pk_bf16_f32 v31, v182, v183
    v_cvt_pk_bf16_f32 v32, v200, v201
    v_mfma_f32_16x16x32_bf16 v[216:219], a[8:11], a[220:223], 0
    v_cvt_pk_bf16_f32 v33, v202, v203
    v_cvt_pk_bf16_f32 v34, v204, v205
    v_mfma_f32_16x16x32_bf16 v[208:211], a[12:15], a[224:227], v[208:211]
    ds_read_b128 a[220:223], v224 offset:31168
    v_cvt_pk_bf16_f32 v35, v206, v207
    v_mfma_f32_16x16x32_bf16 v[212:215], a[16:19], a[224:227], v[212:215]
    ds_write_b128 v123, v[160:163] offset:2880
    v_mfma_f32_16x16x32_bf16 v[216:219], a[20:23], a[224:227], v[216:219]
    buffer_load_dwordx4 v252, s[8:11], s57 offen lds
    v_mfma_f32_16x16x32_bf16 v[208:211], a[24:27], a[228:231], v[208:211]
    s_add_u32 m0, s50, 0xc800
    ds_read_b128 a[224:227], v224 offset:31232
    v_cndmask_b32 v164, v168, v164, s[24:25]
    v_mfma_f32_16x16x32_bf16 v[212:215], a[28:31], a[228:231], v[212:215]
    s_lshl_b32 s25, s36, 2
    v_cndmask_b32 v165, v168, v165, s[26:27]
    v_cndmask_b32 v166, v168, v166, s[52:53]
    v_mfma_f32_16x16x32_bf16 v[216:219], a[32:35], a[228:231], v[216:219]
    s_add_u32 s25, s25, 0x27e00
    ds_read_b128 a[228:231], v224 offset:31296
    v_mov_b32 v249, s25
    v_mfma_f32_16x16x32_bf16 v[208:211], a[36:39], a[232:235], v[208:211]
    v_cndmask_b32 v167, v168, v167, s[54:55]
    v_mfma_f32_16x16x32_bf16 v[212:215], a[40:43], a[232:235], v[212:215]
    s_waitcnt lgkmcnt(4)
    buffer_load_dwordx4 v253, s[8:11], s57 offen lds
    v_mfma_f32_16x16x32_bf16 v[216:219], a[44:47], a[232:235], v[216:219]
    s_add_u32 s57, s49, 0x2d300
    ds_read_b128 a[232:235], v224 offset:34048
    s_add_u32 m0, s50, 0xf000
    v_mfma_f32_16x16x32_bf16 v[208:211], a[48:51], a[236:239], v[208:211]
    ds_write_b128 v123, v[164:167] offset:3200
    v_mfma_f32_16x16x32_bf16 v[212:215], a[52:55], a[236:239], v[212:215]
    s_waitcnt vmcnt(12)
    ds_read_b64_tr_b16 a[72:73], v254
    ds_read_b64_tr_b16 a[74:75], v255
    v_mfma_f32_16x16x32_bf16 v[216:219], a[56:59], a[236:239], v[216:219]
    ds_read_b128 a[236:239], v224 offset:34112
    ds_read_b64_tr_b16 a[76:77], v254 offset:32
    v_mfma_f32_16x16x32_bf16 v[208:211], a[60:63], a[240:243], v[208:211]
    buffer_load_dwordx4 v251, s[8:11], s57 offen lds
    v_mfma_f32_16x16x32_bf16 v[212:215], a[64:67], a[240:243], v[212:215]
    s_add_u32 m0, s50, 0xf400
    ds_read_b64_tr_b16 a[78:79], v255 offset:32
    ds_read_b64_tr_b16 a[80:81], v254 offset:64
    v_mfma_f32_16x16x32_bf16 v[216:219], a[68:71], a[240:243], v[216:219]
    ds_read_b128 a[240:243], v224 offset:34176
    ds_read_b64_tr_b16 a[82:83], v255 offset:64
    v_mfma_f32_16x16x32_bf16 v[220:223], a[0:3], a[244:247], 0
    v_cvt_pk_bf16_f32 v48, v208, v209
    v_cvt_pk_bf16_f32 v49, v210, v211
    v_mfma_f32_16x16x32_bf16 v[176:179], a[4:7], a[244:247], 0
    v_cvt_pk_bf16_f32 v50, v212, v213
    v_cvt_pk_bf16_f32 v51, v214, v215
    v_mfma_f32_16x16x32_bf16 v[180:183], a[8:11], a[244:247], 0
    buffer_load_dwordx4 v252, s[8:11], s57 offen lds
    v_mfma_f32_16x16x32_bf16 v[220:223], a[12:15], a[248:251], v[220:223]
    s_add_u32 m0, s50, 0xf800
    v_cvt_pk_bf16_f32 v52, v216, v217
    v_cvt_pk_bf16_f32 v53, v218, v219
    v_mfma_f32_16x16x32_bf16 v[176:179], a[16:19], a[248:251], v[176:179]
    ds_read_b128 a[244:247], v224 offset:34240
    v_mfma_f32_16x16x32_bf16 v[180:183], a[20:23], a[248:251], v[180:183]
    ds_read_b128 a[248:251], v224 offset:34304
    v_mfma_f32_16x16x32_bf16 v[220:223], a[24:27], a[252:255], v[220:223]
    ds_write_b128 v124, v[168:171]
    v_mfma_f32_16x16x32_bf16 v[176:179], a[28:31], a[252:255], v[176:179]
    s_waitcnt lgkmcnt(5)
    buffer_load_dwordx4 v253, s[8:11], s57 offen lds
    v_mfma_f32_16x16x32_bf16 v[180:183], a[32:35], a[252:255], v[180:183]
    s_add_u32 s57, s49, 0
    ds_read_b128 a[252:255], v224 offset:34368
    ds_read_b128 v[144:147], v235
    v_mfma_f32_16x16x32_bf16 v[220:223], a[36:39], a[220:223], v[220:223]
    s_add_u32 m0, s50, 0
    ds_read_b128 v[148:151], v234
    v_mad_u32_u24 v234, v236, s40, v229
    v_mfma_f32_16x16x32_bf16 v[176:179], a[40:43], a[220:223], v[176:179]
    v_mad_u32_u24 v236, v236, s40, v228
    v_bfe_u32 v235, s62, v232, 4
    v_mfma_f32_16x16x32_bf16 v[180:183], a[44:47], a[220:223], v[180:183]
    s_waitcnt vmcnt(12)
    ds_read_b64_tr_b16 a[84:85], v254 offset:12288
    v_mfma_f32_16x16x32_bf16 v[220:223], a[48:51], a[224:227], v[220:223]
    s_waitcnt lgkmcnt(7)
    buffer_load_dwordx4 v251, s[8:11], s57 offen lds
    v_mfma_f32_16x16x32_bf16 v[176:179], a[52:55], a[224:227], v[176:179]
    s_add_u32 m0, s50, 0x400
    ds_read_b64_tr_b16 a[86:87], v255 offset:12288
    ds_read_b64_tr_b16 a[88:89], v254 offset:12320
    v_mfma_f32_16x16x32_bf16 v[180:183], a[56:59], a[224:227], v[180:183]
    ds_read_b64_tr_b16 a[90:91], v255 offset:12320
    ds_read_b64_tr_b16 a[92:93], v254 offset:12352
    v_mfma_f32_16x16x32_bf16 v[220:223], a[60:63], a[228:231], v[220:223]
    ds_read_b64_tr_b16 a[94:95], v255 offset:12352
    ds_read_b128 a[220:223], v224 offset:46464
    v_mfma_f32_16x16x32_bf16 v[176:179], a[64:67], a[228:231], v[176:179]
    ds_read_b128 a[224:227], v224 offset:46528
    ds_read_b128 v[152:155], v234
    v_mfma_f32_16x16x32_bf16 v[180:183], a[68:71], a[228:231], v[180:183]
    v_bfe_u32 v234, s60, v232, 4
    v_mad_u32_u24 v234, v234, s40, v230
    v_mfma_f32_16x16x32_bf16 v[200:203], a[0:3], a[232:235], 0
    v_cvt_pk_bf16_f32 v12, v220, v221
    v_cvt_pk_bf16_f32 v13, v222, v223
    v_mfma_f32_16x16x32_bf16 v[204:207], a[4:7], a[232:235], 0
    v_cvt_pk_bf16_f32 v14, v176, v177
    v_cvt_pk_bf16_f32 v15, v178, v179
    v_mfma_f32_16x16x32_bf16 v[208:211], a[8:11], a[232:235], 0
    v_cvt_pk_bf16_f32 v16, v180, v181
    v_cvt_pk_bf16_f32 v17, v182, v183
    v_mfma_f32_16x16x32_bf16 v[200:203], a[12:15], a[236:239], v[200:203]
    buffer_load_dwordx4 v252, s[8:11], s57 offen lds
    v_mfma_f32_16x16x32_bf16 v[204:207], a[16:19], a[236:239], v[204:207]
    s_add_u32 m0, s50, 0x800
    ds_read_b128 a[228:231], v224 offset:46592
    ds_read_b128 a[232:235], v224 offset:46656
    v_mfma_f32_16x16x32_bf16 v[208:211], a[20:23], a[236:239], v[208:211]
    buffer_load_dwordx4 v253, s[8:11], s57 offen lds
    v_mfma_f32_16x16x32_bf16 v[200:203], a[24:27], a[240:243], v[200:203]
    s_add_u32 s57, s49, 0x9000
    ds_read_b128 a[236:239], v224 offset:46720
    ds_read_b128 v[156:159], v236
    v_mfma_f32_16x16x32_bf16 v[204:207], a[28:31], a[240:243], v[204:207]
    s_add_u32 m0, s50, 0x3000
    ds_read_b128 v[160:163], v228 offset:1920
    v_mad_u32_u24 v236, v235, s40, v229
    v_mfma_f32_16x16x32_bf16 v[208:211], a[32:35], a[240:243], v[208:211]
    s_waitcnt lgkmcnt(7)
    v_mad_u32_u24 v235, v235, s40, v228
    v_mfma_f32_16x16x32_bf16 v[200:203], a[36:39], a[244:247], v[200:203]
    s_waitcnt vmcnt(12)
    ds_read_b64_tr_b16 a[96:97], v254 offset:24576
    v_mfma_f32_16x16x32_bf16 v[204:207], a[40:43], a[244:247], v[204:207]
    ds_read_b64_tr_b16 a[98:99], v255 offset:24576
    ds_read_b64_tr_b16 a[100:101], v254 offset:24608
    v_mfma_f32_16x16x32_bf16 v[208:211], a[44:47], a[244:247], v[208:211]
    buffer_load_dwordx4 v251, s[8:11], s57 offen lds
    v_mfma_f32_16x16x32_bf16 v[200:203], a[48:51], a[248:251], v[200:203]
    s_add_u32 m0, s50, 0x3400
    ds_read_b64_tr_b16 a[102:103], v255 offset:24608
    ds_read_b64_tr_b16 a[104:105], v254 offset:24640
    v_mfma_f32_16x16x32_bf16 v[204:207], a[52:55], a[248:251], v[204:207]
    ds_read_b64_tr_b16 a[106:107], v255 offset:24640
    ds_read_b128 a[240:243], v224 offset:46784
    v_mfma_f32_16x16x32_bf16 v[208:211], a[56:59], a[248:251], v[208:211]
    ds_read_b128 a[244:247], v224 offset:49536
    ds_read_b128 a[248:251], v224 offset:49600
    v_mfma_f32_16x16x32_bf16 v[200:203], a[60:63], a[252:255], v[200:203]
    ds_read_b128 v[164:167], v229 offset:1920
    v_mfma_f32_16x16x32_bf16 v[204:207], a[64:67], a[252:255], v[204:207]
    buffer_load_dwordx4 v252, s[8:11], s57 offen lds
    v_mfma_f32_16x16x32_bf16 v[208:211], a[68:71], a[252:255], v[208:211]
    s_add_u32 m0, s50, 0x3800
    ds_read_b128 a[252:255], v224 offset:49664
    v_mfma_f32_16x16x32_bf16 v[212:215], a[0:3], a[220:223], 0
    v_mfma_f32_16x16x32_bf16 v[216:219], a[4:7], a[220:223], 0
    v_cvt_pk_bf16_f32 v36, v200, v201
    v_cvt_pk_bf16_f32 v37, v202, v203
    v_mfma_f32_16x16x32_bf16 v[220:223], a[8:11], a[220:223], 0
    s_waitcnt lgkmcnt(10)
    v_cvt_pk_bf16_f32 v38, v204, v205
    v_cvt_pk_bf16_f32 v39, v206, v207
    v_mfma_f32_16x16x32_bf16 v[212:215], a[12:15], a[224:227], v[212:215]
    v_cvt_pk_bf16_f32 v40, v208, v209
    v_cvt_pk_bf16_f32 v41, v210, v211
    v_mfma_f32_16x16x32_bf16 v[216:219], a[16:19], a[224:227], v[216:219]
    buffer_load_dwordx4 v253, s[8:11], s57 offen lds
    v_mfma_f32_16x16x32_bf16 v[220:223], a[20:23], a[224:227], v[220:223]
    s_add_u32 s57, s49, 0x12000
    ds_read_b128 a[220:223], v224 offset:49728
    ds_read_b128 a[224:227], v224 offset:49792
    v_mfma_f32_16x16x32_bf16 v[212:215], a[24:27], a[228:231], v[212:215]
    s_add_u32 m0, s50, 0x6000
    v_mfma_f32_16x16x32_bf16 v[216:219], a[28:31], a[228:231], v[216:219]
    s_waitcnt vmcnt(12)
    ds_read_b64_tr_b16 a[108:109], v254 offset:36864
    ds_read_b64_tr_b16 a[110:111], v255 offset:36864
    v_mfma_f32_16x16x32_bf16 v[220:223], a[32:35], a[228:231], v[220:223]
    ds_read_b64_tr_b16 a[112:113], v254 offset:36896
L_pg1:
    s_cbranch_execz L_pg5
    ds_read_b64_tr_b16 a[114:115], v255 offset:36896
    v_mfma_f32_16x16x32_bf16 v[212:215], a[36:39], a[232:235], v[212:215]
    s_waitcnt lgkmcnt(8)
    buffer_load_dwordx4 v251, s[8:11], s57 offen lds
    v_mfma_f32_16x16x32_bf16 v[216:219], a[40:43], a[232:235], v[216:219]
    s_add_u32 m0, s50, 0x6400
    ds_read_b64_tr_b16 a[116:117], v254 offset:36928
    ds_read_b64_tr_b16 a[118:119], v255 offset:36928
    v_mfma_f32_16x16x32_bf16 v[220:223], a[44:47], a[232:235], v[220:223]
    ds_read_b128 a[228:231], v224 offset:49856
    ds_read_b128 a[232:235], v227 offset:37120
    v_mfma_f32_16x16x32_bf16 v[212:215], a[48:51], a[236:239], v[212:215]
    v_mfma_f32_16x16x32_bf16 v[216:219], a[52:55], a[236:239], v[216:219]
    v_mfma_f32_16x16x32_bf16 v[220:223], a[56:59], a[236:239], v[220:223]
    ds_read_b128 a[236:239], v227 offset:37184
    v_mfma_f32_16x16x32_bf16 v[212:215], a[60:63], a[240:243], v[212:215]
    buffer_load_dwordx4 v252, s[8:11], s57 offen lds
    v_mfma_f32_16x16x32_bf16 v[216:219], a[64:67], a[240:243], v[216:219]
    s_add_u32 m0, s50, 0x6800
    v_mfma_f32_16x16x32_bf16 v[220:223], a[68:71], a[240:243], v[220:223]
    ds_read_b128 a[240:243], v227 offset:37248
    v_mfma_f32_16x16x32_bf16 v[176:179], a[0:3], a[244:247], 0
    v_mfma_f32_16x16x32_bf16 v[180:183], a[4:7], a[244:247], 0
    v_mfma_f32_16x16x32_bf16 v[200:203], a[8:11], a[244:247], 0
    buffer_load_dwordx4 v253, s[8:11], s57 offen lds
    v_mfma_f32_16x16x32_bf16 v[176:179], a[12:15], a[248:251], v[176:179]
    s_add_u32 s57, s49, 0x1b000
    v_cvt_pk_bf16_f32 v18, v212, v213
    v_cvt_pk_bf16_f32 v19, v214, v215
    v_mfma_f32_16x16x32_bf16 v[180:183], a[16:19], a[248:251], v[180:183]
    s_add_u32 m0, s50, 0x9000
    v_cvt_pk_bf16_f32 v20, v216, v217
    v_cvt_pk_bf16_f32 v21, v218, v219
    v_mfma_f32_16x16x32_bf16 v[200:203], a[20:23], a[248:251], v[200:203]
    s_waitcnt lgkmcnt(2)
    v_cvt_pk_bf16_f32 v22, v220, v221
    v_cvt_pk_bf16_f32 v23, v222, v223
    v_mfma_f32_16x16x32_bf16 v[176:179], a[24:27], a[252:255], v[176:179]
    s_waitcnt vmcnt(12)
    ds_read_b64_tr_b16 a[120:121], v254 offset:49152
    ds_read_b64_tr_b16 a[122:123], v255 offset:49152
    v_mfma_f32_16x16x32_bf16 v[180:183], a[28:31], a[252:255], v[180:183]
    ds_read_b64_tr_b16 a[124:125], v254 offset:49184
    ds_read_b64_tr_b16 a[126:127], v255 offset:49184
    v_mfma_f32_16x16x32_bf16 v[200:203], a[32:35], a[252:255], v[200:203]
    buffer_load_dwordx4 v251, s[8:11], s57 offen lds
    v_mfma_f32_16x16x32_bf16 v[176:179], a[36:39], a[220:223], v[176:179]
    s_add_u32 m0, s50, 0x9400
    ds_read_b64_tr_b16 a[128:129], v254 offset:49216
    ds_read_b64_tr_b16 a[130:131], v255 offset:49216
    v_mfma_f32_16x16x32_bf16 v[180:183], a[40:43], a[220:223], v[180:183]
    ds_read_b128 a[244:247], v227 offset:37312
    ds_read_b128 a[248:251], v227 offset:37376
    v_mfma_f32_16x16x32_bf16 v[200:203], a[44:47], a[220:223], v[200:203]
    ds_read_b128 a[252:255], v227 offset:37440
    ds_read_b128 a[220:223], v224
    v_mfma_f32_16x16x32_bf16 v[176:179], a[48:51], a[224:227], v[176:179]
    v_mfma_f32_16x16x32_bf16 v[180:183], a[52:55], a[224:227], v[180:183]
    buffer_load_dwordx4 v252, s[8:11], s57 offen lds
    v_mfma_f32_16x16x32_bf16 v[200:203], a[56:59], a[224:227], v[200:203]
    s_add_u32 m0, s50, 0x9800
    ds_read_b128 a[224:227], v224 offset:64
    v_mfma_f32_16x16x32_bf16 v[176:179], a[60:63], a[228:231], v[176:179]
    v_mfma_f32_16x16x32_bf16 v[180:183], a[64:67], a[228:231], v[180:183]
    v_mfma_f32_16x16x32_bf16 v[200:203], a[68:71], a[228:231], v[200:203]
    ds_read_b128 a[228:231], v224 offset:128
    v_mfma_f32_16x16x32_bf16 v[204:207], a[0:3], a[232:235], 0
    v_mfma_f32_16x16x32_bf16 v[208:211], a[4:7], a[232:235], 0
    s_waitcnt lgkmcnt(6)
    buffer_load_dwordx4 v253, s[8:11], s57 offen lds
    v_mfma_f32_16x16x32_bf16 v[212:215], a[8:11], a[232:235], 0
    s_add_u32 s57, s49, 0x24000
    v_cvt_pk_bf16_f32 v42, v176, v177
    v_cvt_pk_bf16_f32 v43, v178, v179
    v_mfma_f32_16x16x32_bf16 v[204:207], a[12:15], a[236:239], v[204:207]
    s_add_u32 m0, s50, 0xc000
    v_cvt_pk_bf16_f32 v44, v180, v181
    v_cvt_pk_bf16_f32 v45, v182, v183
    v_mfma_f32_16x16x32_bf16 v[208:211], a[16:19], a[236:239], v[208:211]
    s_waitcnt vmcnt(12)
    ds_read_b64_tr_b16 a[132:133], v254 offset:61440
    ds_read_b64_tr_b16 a[134:135], v255 offset:61440
    v_mfma_f32_16x16x32_bf16 v[212:215], a[20:23], a[236:239], v[212:215]
    ds_read_b64_tr_b16 a[136:137], v254 offset:61472
    ds_read_b64_tr_b16 a[138:139], v255 offset:61472
    v_mfma_f32_16x16x32_bf16 v[204:207], a[24:27], a[240:243], v[204:207]
    buffer_load_dwordx4 v251, s[8:11], s57 offen lds
    v_mfma_f32_16x16x32_bf16 v[208:211], a[28:31], a[240:243], v[208:211]
    s_add_u32 m0, s50, 0xc400
    ds_read_b64_tr_b16 a[140:141], v254 offset:61504
    ds_read_b64_tr_b16 a[142:143], v255 offset:61504
    v_mfma_f32_16x16x32_bf16 v[212:215], a[32:35], a[240:243], v[212:215]
    s_waitcnt lgkmcnt(7)
    v_cvt_pk_bf16_f32 v46, v200, v201
    v_cvt_pk_bf16_f32 v47, v202, v203
    v_mfma_f32_16x16x32_bf16 v[204:207], a[36:39], a[244:247], v[204:207]
    ds_read_b128 a[232:235], v224 offset:192
    ds_read_b128 a[236:239], v224 offset:256
    v_mfma_f32_16x16x32_bf16 v[208:211], a[40:43], a[244:247], v[208:211]
    ds_read_b128 a[240:243], v224 offset:320
    v_mfma_f32_16x16x32_bf16 v[212:215], a[44:47], a[244:247], v[212:215]
    ds_read_b128 a[244:247], v224 offset:3072
    v_mfma_f32_16x16x32_bf16 v[204:207], a[48:51], a[248:251], v[204:207]
    buffer_load_dwordx4 v252, s[8:11], s57 offen lds
    v_mfma_f32_16x16x32_bf16 v[208:211], a[52:55], a[248:251], v[208:211]
    s_add_u32 m0, s50, 0xc800
    v_mfma_f32_16x16x32_bf16 v[212:215], a[56:59], a[248:251], v[212:215]
    ds_read_b128 a[248:251], v224 offset:3136
    v_mfma_f32_16x16x32_bf16 v[204:207], a[60:63], a[252:255], v[204:207]
    v_mfma_f32_16x16x32_bf16 v[208:211], a[64:67], a[252:255], v[208:211]
    v_mfma_f32_16x16x32_bf16 v[212:215], a[68:71], a[252:255], v[212:215]
    buffer_load_dwordx4 v253, s[8:11], s57 offen lds
    v_mfma_f32_16x16x32_bf16 v[216:219], a[220:223], a[72:75], 0
    s_add_u32 s57, s49, 0x2d000
    ds_read_b128 a[252:255], v224 offset:3200
    s_add_u32 m0, s50, 0xf000
    v_mfma_f32_16x16x32_bf16 v[220:223], a[220:223], a[76:79], 0
    v_cvt_pk_bf16_f32 v54, v204, v205
    v_cvt_pk_bf16_f32 v55, v206, v207
    v_mfma_f32_16x16x32_bf16 v[176:179], a[220:223], a[80:83], 0
    v_cvt_pk_bf16_f32 v56, v208, v209
    v_cvt_pk_bf16_f32 v57, v210, v211
    v_mfma_f32_16x16x32_bf16 v[216:219], a[224:227], a[84:87], v[216:219]
    v_cvt_pk_bf16_f32 v58, v212, v213
    v_cvt_pk_bf16_f32 v59, v214, v215
    v_mfma_f32_16x16x32_bf16 v[220:223], a[224:227], a[88:91], v[220:223]
    s_waitcnt vmcnt(12)
    ds_read_b128 a[220:223], v224 offset:3264
    ds_read_b64_tr_b16 a[144:145], v254
    v_mfma_f32_16x16x32_bf16 v[176:179], a[224:227], a[92:95], v[176:179]
    s_waitcnt lgkmcnt(4)
    buffer_load_dwordx4 v251, s[8:11], s57 offen lds
    v_mfma_f32_16x16x32_bf16 v[216:219], a[228:231], a[96:99], v[216:219]
    s_add_u32 m0, s50, 0xf400
    ds_read_b128 a[224:227], v224 offset:3328
    ds_read_b64_tr_b16 a[146:147], v255
    v_mfma_f32_16x16x32_bf16 v[220:223], a[228:231], a[100:103], v[220:223]
    ds_read_b64_tr_b16 a[148:149], v254 offset:32
    ds_read_b64_tr_b16 a[150:151], v255 offset:32
    v_mfma_f32_16x16x32_bf16 v[176:179], a[228:231], a[104:107], v[176:179]
    ds_read_b128 a[228:231], v224 offset:3392
    ds_read_b64_tr_b16 a[152:153], v254 offset:64
    v_mfma_f32_16x16x32_bf16 v[216:219], a[232:235], a[108:111], v[216:219]
    ds_read_b64_tr_b16 a[154:155], v255 offset:64
    v_mfma_f32_16x16x32_bf16 v[220:223], a[232:235], a[112:115], v[220:223]
    buffer_load_dwordx4 v252, s[8:11], s57 offen lds
    v_mfma_f32_16x16x32_bf16 v[176:179], a[232:235], a[116:119], v[176:179]
    s_add_u32 m0, s50, 0xf800
    ds_read_b128 a[232:235], v224 offset:15488
    v_mfma_f32_16x16x32_bf16 v[216:219], a[236:239], a[120:123], v[216:219]
    v_mfma_f32_16x16x32_bf16 v[220:223], a[236:239], a[124:127], v[220:223]
    v_mfma_f32_16x16x32_bf16 v[176:179], a[236:239], a[128:131], v[176:179]
    ds_read_b128 a[236:239], v224 offset:15552
    v_mfma_f32_16x16x32_bf16 v[216:219], a[240:243], a[132:135], v[216:219]
    v_mfma_f32_16x16x32_bf16 v[220:223], a[240:243], a[136:139], v[220:223]
    buffer_load_dwordx4 v253, s[8:11], s57 offen lds
    v_mfma_f32_16x16x32_bf16 v[176:179], a[240:243], a[140:143], v[176:179]
    s_add_u32 s57, s49, 0
    ds_read_b128 a[240:243], v224 offset:15616
    s_add_u32 m0, s50, 0
    v_mfma_f32_16x16x32_bf16 v[180:183], a[244:247], a[72:75], 0
    v_mfma_f32_16x16x32_bf16 v[200:203], a[244:247], a[76:79], 0
    v_cvt_pk_bf16_f32 v66, v216, v217
    v_cvt_pk_bf16_f32 v67, v218, v219
    v_mfma_f32_16x16x32_bf16 v[204:207], a[244:247], a[80:83], 0
    s_waitcnt lgkmcnt(3)
    v_cvt_pk_bf16_f32 v88, v220, v221
    v_cvt_pk_bf16_f32 v89, v222, v223
    v_mfma_f32_16x16x32_bf16 v[180:183], a[248:251], a[84:87], v[180:183]
    v_cvt_pk_bf16_f32 v110, v176, v177
    v_cvt_pk_bf16_f32 v111, v178, v179
    v_mfma_f32_16x16x32_bf16 v[200:203], a[248:251], a[88:91], v[200:203]
    s_waitcnt vmcnt(12)
    ds_read_b128 a[244:247], v224 offset:15680
    ds_read_b64_tr_b16 a[156:157], v254 offset:12288
    v_mfma_f32_16x16x32_bf16 v[204:207], a[248:251], a[92:95], v[204:207]
    ds_read_b128 a[248:251], v224 offset:15744
    ds_read_b64_tr_b16 a[158:159], v255 offset:12288
    v_mfma_f32_16x16x32_bf16 v[180:183], a[252:255], a[96:99], v[180:183]
    buffer_load_dwordx4 v192, s[12:15], s57 offen lds
    v_mfma_f32_16x16x32_bf16 v[200:203], a[252:255], a[100:103], v[200:203]
    s_add_u32 m0, s50, 0x400
    ds_read_b64_tr_b16 a[160:161], v254 offset:12320
    ds_read_b64_tr_b16 a[162:163], v255 offset:12320
    v_mfma_f32_16x16x32_bf16 v[204:207], a[252:255], a[104:107], v[204:207]
    ds_read_b128 a[252:255], v224 offset:15808
    ds_read_b64_tr_b16 a[164:165], v254 offset:12352
    v_mfma_f32_16x16x32_bf16 v[180:183], a[220:223], a[108:111], v[180:183]
    buffer_load_dwordx4 v193, s[12:15], s57 offen lds
    v_mfma_f32_16x16x32_bf16 v[200:203], a[220:223], a[112:115], v[200:203]
    s_add_u32 m0, s50, 0x800
    ds_read_b64_tr_b16 a[166:167], v255 offset:12352
    v_mfma_f32_16x16x32_bf16 v[204:207], a[220:223], a[116:119], v[204:207]
    ds_read_b128 a[220:223], v224 offset:18560
    v_mfma_f32_16x16x32_bf16 v[180:183], a[224:227], a[120:123], v[180:183]
    v_mfma_f32_16x16x32_bf16 v[200:203], a[224:227], a[124:127], v[200:203]
    v_mfma_f32_16x16x32_bf16 v[204:207], a[224:227], a[128:131], v[204:207]
    ds_read_b128 a[224:227], v224 offset:18624
    v_mfma_f32_16x16x32_bf16 v[180:183], a[228:231], a[132:135], v[180:183]
    buffer_load_dwordx4 v194, s[12:15], s57 offen lds
    v_mfma_f32_16x16x32_bf16 v[200:203], a[228:231], a[136:139], v[200:203]
    s_add_u32 s57, s49, 0x3000
    s_add_u32 m0, s50, 0x3000
    v_mfma_f32_16x16x32_bf16 v[204:207], a[228:231], a[140:143], v[204:207]
    s_waitcnt lgkmcnt(5)
    ds_read_b128 a[228:231], v224 offset:18688
    v_mfma_f32_16x16x32_bf16 v[208:211], a[232:235], a[72:75], 0
    s_waitcnt vmcnt(12)
    ds_read_b64_tr_b16 a[168:169], v254 offset:24576
    v_cvt_pk_bf16_f32 v68, v180, v181
    v_mfma_f32_16x16x32_bf16 v[212:215], a[232:235], a[76:79], 0
    v_cvt_pk_bf16_f32 v69, v182, v183
    v_cvt_pk_bf16_f32 v90, v200, v201
    v_mfma_f32_16x16x32_bf16 v[216:219], a[232:235], a[80:83], 0
    v_cvt_pk_bf16_f32 v91, v202, v203
    v_cvt_pk_bf16_f32 v112, v204, v205
    v_mfma_f32_16x16x32_bf16 v[208:211], a[236:239], a[84:87], v[208:211]
    ds_read_b128 a[232:235], v224 offset:18752
    v_cvt_pk_bf16_f32 v113, v206, v207
    v_mfma_f32_16x16x32_bf16 v[212:215], a[236:239], a[88:91], v[212:215]
    s_waitcnt lgkmcnt(4)
    buffer_load_dwordx4 v192, s[12:15], s57 offen lds
    v_mfma_f32_16x16x32_bf16 v[216:219], a[236:239], a[92:95], v[216:219]
    s_add_u32 m0, s50, 0x3400
    ds_read_b128 a[236:239], v224 offset:18816
    ds_read_b64_tr_b16 a[170:171], v255 offset:24576
    v_mfma_f32_16x16x32_bf16 v[208:211], a[240:243], a[96:99], v[208:211]
    ds_read_b64_tr_b16 a[172:173], v254 offset:24608
    ds_read_b64_tr_b16 a[174:175], v255 offset:24608
    v_mfma_f32_16x16x32_bf16 v[212:215], a[240:243], a[100:103], v[212:215]
    buffer_load_dwordx4 v193, s[12:15], s57 offen lds
    v_mfma_f32_16x16x32_bf16 v[216:219], a[240:243], a[104:107], v[216:219]
    s_add_u32 m0, s50, 0x3800
    ds_read_b128 a[240:243], v224 offset:18880
    ds_read_b64_tr_b16 a[176:177], v254 offset:24640
    v_mfma_f32_16x16x32_bf16 v[208:211], a[244:247], a[108:111], v[208:211]
    ds_read_b64_tr_b16 a[178:179], v255 offset:24640
    v_mfma_f32_16x16x32_bf16 v[212:215], a[244:247], a[112:115], v[212:215]
    v_mfma_f32_16x16x32_bf16 v[216:219], a[244:247], a[116:119], v[216:219]
    ds_read_b128 a[244:247], v227 offset:6144
    v_mfma_f32_16x16x32_bf16 v[208:211], a[248:251], a[120:123], v[208:211]
    v_mfma_f32_16x16x32_bf16 v[212:215], a[248:251], a[124:127], v[212:215]
    buffer_load_dwordx4 v194, s[12:15], s57 offen lds
    v_mfma_f32_16x16x32_bf16 v[216:219], a[248:251], a[128:131], v[216:219]
    s_add_u32 s57, s49, 0x6000
    ds_read_b128 a[248:251], v227 offset:6208
    s_add_u32 m0, s50, 0x6000
    v_mfma_f32_16x16x32_bf16 v[208:211], a[252:255], a[132:135], v[208:211]
    v_mfma_f32_16x16x32_bf16 v[212:215], a[252:255], a[136:139], v[212:215]
    s_waitcnt vmcnt(12)
    ds_read_b64_tr_b16 a[180:181], v254 offset:36864
    ds_read_b64_tr_b16 a[182:183], v255 offset:36864
    v_mfma_f32_16x16x32_bf16 v[216:219], a[252:255], a[140:143], v[216:219]
    ds_read_b128 a[252:255], v227 offset:6272
    ds_read_b64_tr_b16 a[184:185], v254 offset:36896
    v_mfma_f32_16x16x32_bf16 v[220:223], a[220:223], a[72:75], 0
    s_waitcnt lgkmcnt(6)
    buffer_load_dwordx4 v192, s[12:15], s57 offen lds
    v_mfma_f32_16x16x32_bf16 v[176:179], a[220:223], a[76:79], 0
    s_add_u32 m0, s50, 0x6400
    v_cvt_pk_bf16_f32 v72, v208, v209
    v_cvt_pk_bf16_f32 v73, v210, v211
    v_mfma_f32_16x16x32_bf16 v[180:183], a[220:223], a[80:83], 0
    v_cvt_pk_bf16_f32 v94, v212, v213
    v_cvt_pk_bf16_f32 v95, v214, v215
    v_mfma_f32_16x16x32_bf16 v[220:223], a[224:227], a[84:87], v[220:223]
    v_cvt_pk_bf16_f32 v116, v216, v217
    v_cvt_pk_bf16_f32 v117, v218, v219
    v_mfma_f32_16x16x32_bf16 v[176:179], a[224:227], a[88:91], v[176:179]
    ds_read_b128 a[220:223], v227 offset:6336
    ds_read_b64_tr_b16 a[186:187], v255 offset:36896
    v_mfma_f32_16x16x32_bf16 v[180:183], a[224:227], a[92:95], v[180:183]
    ds_read_b128 a[224:227], v227 offset:6400
    ds_read_b64_tr_b16 a[188:189], v254 offset:36928
    v_mfma_f32_16x16x32_bf16 v[220:223], a[228:231], a[96:99], v[220:223]
    buffer_load_dwordx4 v193, s[12:15], s57 offen lds
    v_mfma_f32_16x16x32_bf16 v[176:179], a[228:231], a[100:103], v[176:179]
    s_add_u32 m0, s50, 0x6800
    ds_read_b64_tr_b16 a[190:191], v255 offset:36928
    v_mfma_f32_16x16x32_bf16 v[180:183], a[228:231], a[104:107], v[180:183]
    ds_read_b128 a[228:231], v227 offset:6464
    v_mfma_f32_16x16x32_bf16 v[220:223], a[232:235], a[108:111], v[220:223]
    v_mfma_f32_16x16x32_bf16 v[176:179], a[232:235], a[112:115], v[176:179]
    v_mfma_f32_16x16x32_bf16 v[180:183], a[232:235], a[116:119], v[180:183]
    buffer_load_dwordx4 v194, s[12:15], s57 offen lds
    v_mfma_f32_16x16x32_bf16 v[220:223], a[236:239], a[120:123], v[220:223]
    s_add_u32 s57, s49, 0x9000
    ds_read_b128 a[232:235], v225 offset:24384
    s_add_u32 m0, s50, 0x9000
    v_mfma_f32_16x16x32_bf16 v[176:179], a[236:239], a[124:127], v[176:179]
    v_mfma_f32_16x16x32_bf16 v[180:183], a[236:239], a[128:131], v[180:183]
    ds_read_b128 a[236:239], v225 offset:24448
    v_mfma_f32_16x16x32_bf16 v[220:223], a[240:243], a[132:135], v[220:223]
    s_waitcnt vmcnt(12)
    ds_read_b64_tr_b16 a[192:193], v254 offset:49152
    ds_read_b64_tr_b16 a[194:195], v255 offset:49152
    v_mfma_f32_16x16x32_bf16 v[176:179], a[240:243], a[136:139], v[176:179]
    ds_read_b64_tr_b16 a[196:197], v254 offset:49184
    ds_read_b64_tr_b16 a[198:199], v255 offset:49184
    v_mfma_f32_16x16x32_bf16 v[180:183], a[240:243], a[140:143], v[180:183]
    s_waitcnt lgkmcnt(7)
    buffer_load_dwordx4 v192, s[12:15], s57 offen lds
    v_mfma_f32_16x16x32_bf16 v[200:203], a[244:247], a[72:75], 0
    s_add_u32 m0, s50, 0x9400
    v_cvt_pk_bf16_f32 v70, v220, v221
    v_cvt_pk_bf16_f32 v71, v222, v223
    v_mfma_f32_16x16x32_bf16 v[204:207], a[244:247], a[76:79], 0
    v_cvt_pk_bf16_f32 v92, v176, v177
    v_cvt_pk_bf16_f32 v93, v178, v179
    v_mfma_f32_16x16x32_bf16 v[208:211], a[244:247], a[80:83], 0
    v_cvt_pk_bf16_f32 v114, v180, v181
    v_cvt_pk_bf16_f32 v115, v182, v183
    v_mfma_f32_16x16x32_bf16 v[200:203], a[248:251], a[84:87], v[200:203]
    ds_read_b64_tr_b16 a[200:201], v254 offset:49216
    ds_read_b64_tr_b16 a[202:203], v255 offset:49216
    v_mfma_f32_16x16x32_bf16 v[204:207], a[248:251], a[88:91], v[204:207]
    buffer_load_dwordx4 v193, s[12:15], s57 offen lds
    v_mfma_f32_16x16x32_bf16 v[208:211], a[248:251], a[92:95], v[208:211]
    s_add_u32 m0, s50, 0x9800
    ds_read_b128 a[240:243], v225 offset:24512
    ds_read_b128 a[244:247], v225 offset:24576
    v_mfma_f32_16x16x32_bf16 v[200:203], a[252:255], a[96:99], v[200:203]
    ds_read_b128 a[248:251], v225 offset:24640
    v_mfma_f32_16x16x32_bf16 v[204:207], a[252:255], a[100:103], v[204:207]
    v_mfma_f32_16x16x32_bf16 v[208:211], a[252:255], a[104:107], v[208:211]
    ds_read_b128 a[252:255], v225 offset:24704
    v_mfma_f32_16x16x32_bf16 v[200:203], a[220:223], a[108:111], v[200:203]
    v_mfma_f32_16x16x32_bf16 v[204:207], a[220:223], a[112:115], v[204:207]
    buffer_load_dwordx4 v194, s[12:15], s57 offen lds
    v_mfma_f32_16x16x32_bf16 v[208:211], a[220:223], a[116:119], v[208:211]
    s_add_u32 s57, s49, 0xc000
    ds_read_b128 a[220:223], v225 offset:27456
    s_add_u32 m0, s50, 0xc000
    v_mfma_f32_16x16x32_bf16 v[200:203], a[224:227], a[120:123], v[200:203]
    v_mfma_f32_16x16x32_bf16 v[204:207], a[224:227], a[124:127], v[204:207]
    s_waitcnt vmcnt(12)
    ds_read_b64_tr_b16 a[204:205], v254 offset:61440
    ds_read_b64_tr_b16 a[206:207], v255 offset:61440
    v_mfma_f32_16x16x32_bf16 v[208:211], a[224:227], a[128:131], v[208:211]
    s_waitcnt lgkmcnt(7)
    ds_read_b64_tr_b16 a[208:209], v254 offset:61472
    ds_read_b64_tr_b16 a[210:211], v255 offset:61472
    v_mfma_f32_16x16x32_bf16 v[200:203], a[228:231], a[132:135], v[200:203]
    buffer_load_dwordx4 v192, s[12:15], s57 offen lds
    v_mfma_f32_16x16x32_bf16 v[204:207], a[228:231], a[136:139], v[204:207]
    s_add_u32 m0, s50, 0xc400
    ds_read_b64_tr_b16 a[212:213], v254 offset:61504
    ds_read_b64_tr_b16 a[214:215], v255 offset:61504
    v_mfma_f32_16x16x32_bf16 v[208:211], a[228:231], a[140:143], v[208:211]
    ds_read_b128 a[224:227], v225 offset:27520
    ds_read_b128 a[228:231], v225 offset:27584
    v_mfma_f32_16x16x32_bf16 v[212:215], a[144:147], a[232:235], 0
    v_cvt_pk_bf16_f32 v82, v200, v201
    v_cvt_pk_bf16_f32 v83, v202, v203
    v_mfma_f32_16x16x32_bf16 v[216:219], a[148:151], a[232:235], 0
    v_cvt_pk_bf16_f32 v104, v204, v205
    v_cvt_pk_bf16_f32 v105, v206, v207
    v_mfma_f32_16x16x32_bf16 v[220:223], a[152:155], a[232:235], 0
    v_cvt_pk_bf16_f32 v126, v208, v209
    v_cvt_pk_bf16_f32 v127, v210, v211
    v_mfma_f32_16x16x32_bf16 v[212:215], a[156:159], a[236:239], v[212:215]
    buffer_load_dwordx4 v193, s[12:15], s57 offen lds
    v_mfma_f32_16x16x32_bf16 v[216:219], a[160:163], a[236:239], v[216:219]
    s_add_u32 m0, s50, 0xc800
    ds_read_b128 a[232:235], v225 offset:27648
    ds_read_b128 v[252:255], v225 offset:39872
    v_mfma_f32_16x16x32_bf16 v[220:223], a[164:167], a[236:239], v[220:223]
    s_waitcnt lgkmcnt(7)
    ds_read_b128 a[236:239], v225 offset:27712
    v_mfma_f32_16x16x32_bf16 v[212:215], a[168:171], a[240:243], v[212:215]
    v_mfma_f32_16x16x32_bf16 v[216:219], a[172:175], a[240:243], v[216:219]
    v_mfma_f32_16x16x32_bf16 v[220:223], a[176:179], a[240:243], v[220:223]
    buffer_load_dwordx4 v194, s[12:15], s57 offen lds
    v_mfma_f32_16x16x32_bf16 v[212:215], a[180:183], a[244:247], v[212:215]
    s_add_u32 s57, s49, 0xf000
    ds_read_b128 a[240:243], v225 offset:27776
    s_add_u32 m0, s50, 0xf000
    v_mfma_f32_16x16x32_bf16 v[216:219], a[184:187], a[244:247], v[216:219]
    v_mfma_f32_16x16x32_bf16 v[220:223], a[188:191], a[244:247], v[220:223]
    ds_read_b128 a[244:247], v224 offset:30976
    v_mfma_f32_16x16x32_bf16 v[212:215], a[192:195], a[248:251], v[212:215]
    v_mfma_f32_16x16x32_bf16 v[216:219], a[196:199], a[248:251], v[216:219]
    v_mfma_f32_16x16x32_bf16 v[220:223], a[200:203], a[248:251], v[220:223]
    s_waitcnt lgkmcnt(4)
    buffer_load_dwordx4 v192, s[12:15], s57 offen lds
    v_mfma_f32_16x16x32_bf16 v[212:215], a[204:207], a[252:255], v[212:215]
    s_add_u32 m0, s50, 0xf400
    ds_read_b128 a[248:251], v224 offset:31040
    v_mfma_f32_16x16x32_bf16 v[216:219], a[208:211], a[252:255], v[216:219]
    v_mfma_f32_16x16x32_bf16 v[220:223], a[212:215], a[252:255], v[220:223]
    s_waitcnt lgkmcnt(2)
    ds_read_b128 a[252:255], v224 offset:31104
    s_barrier
    v_mfma_f32_16x16x32_bf16 v[176:179], a[144:147], a[220:223], 0
    v_mfma_f32_16x16x32_bf16 v[180:183], a[148:151], a[220:223], 0
    buffer_load_dwordx4 v193, s[12:15], s57 offen lds
    v_mfma_f32_16x16x32_bf16 v[200:203], a[152:155], a[220:223], 0
    s_add_u32 m0, s50, 0xf800
    v_mul_f32 v212, s37, v212
    v_mul_f32 v213, s37, v213
    v_mfma_f32_16x16x32_bf16 v[176:179], a[156:159], a[224:227], v[176:179]
    v_mul_f32 v214, s37, v214
    v_mul_f32 v215, s37, v215
    v_mfma_f32_16x16x32_bf16 v[180:183], a[160:163], a[224:227], v[180:183]
    v_cvt_pk_bf16_f32 v132, v212, v213
    v_cvt_pk_bf16_f32 v133, v214, v215
    v_mfma_f32_16x16x32_bf16 v[200:203], a[164:167], a[224:227], v[200:203]
    v_mul_f32 v216, s37, v216
    v_mul_f32 v217, s37, v217
    v_mfma_f32_16x16x32_bf16 v[176:179], a[168:171], a[228:231], v[176:179]
    v_mul_f32 v218, s37, v218
    v_mul_f32 v219, s37, v219
    v_mfma_f32_16x16x32_bf16 v[180:183], a[172:175], a[228:231], v[180:183]
    buffer_load_dwordx4 v194, s[12:15], s57 offen lds
    v_mfma_f32_16x16x32_bf16 v[200:203], a[176:179], a[228:231], v[200:203]
    s_add_u32 m0, s41, 0
    v_cvt_pk_bf16_f32 v134, v216, v217
    v_cvt_pk_bf16_f32 v135, v218, v219
    v_mfma_f32_16x16x32_bf16 v[176:179], a[180:183], a[232:235], v[176:179]
    v_mul_f32 v220, s37, v220
    v_mul_f32 v221, s37, v221
    v_mfma_f32_16x16x32_bf16 v[144:147], v[0:3], v[132:135], v[144:147]
    v_mul_f32 v222, s37, v222
    v_mul_f32 v223, s37, v223
    v_mfma_f32_16x16x32_bf16 v[148:151], v[24:27], v[132:135], v[148:151]
    v_cvt_pk_bf16_f32 v136, v220, v221
    v_cvt_pk_bf16_f32 v137, v222, v223
    v_mfma_f32_16x16x32_bf16 v[152:155], v[30:33], v[132:135], v[152:155]
    buffer_load_dwordx4 v246, s[4:7], s56 offen lds
    v_mfma_f32_16x16x16_bf16 v[144:147], v[4:5], v[136:137], v[144:147]
    s_add_u32 m0, s42, 0
    ds_read_b128 a[220:223], v224 offset:31168
    ds_read_b128 a[224:227], v224 offset:31232
    v_mfma_f32_16x16x16_bf16 v[148:151], v[28:29], v[136:137], v[148:151]
    ds_read_b128 a[228:231], v224 offset:31296
    v_mfma_f32_16x16x16_bf16 v[152:155], v[34:35], v[136:137], v[152:155]
    v_mfma_f32_16x16x32_bf16 v[156:159], v[6:9], v[132:135], v[156:159]
    v_mfma_f32_16x16x32_bf16 v[160:163], v[12:15], v[132:135], v[160:163]
    v_exp_f32 v144, v144
    v_mfma_f32_16x16x32_bf16 v[164:167], v[36:39], v[132:135], v[164:167]
    buffer_load_dwordx4 v247, s[4:7], s56 offen lds
    v_mfma_f32_16x16x32_bf16 v[180:183], a[184:187], a[232:235], v[180:183]
    s_add_u32 s56, s39, 0x17a000
    v_exp_f32 v145, v145
    v_mfma_f32_16x16x16_bf16 v[156:159], v[10:11], v[136:137], v[156:159]
    s_add_u32 m0, s41, 0x1e40
    v_exp_f32 v146, v146
    v_mfma_f32_16x16x16_bf16 v[160:163], v[16:17], v[136:137], v[160:163]
    v_exp_f32 v147, v147
    v_mfma_f32_16x16x16_bf16 v[164:167], v[40:41], v[136:137], v[164:167]
    v_cvt_pk_bf16_f32 v168, v144, v145
    v_cvt_pk_bf16_f32 v169, v146, v147
    v_mfma_f32_16x16x32_bf16 v[200:203], a[188:191], a[232:235], v[200:203]
    buffer_load_dwordx4 v246, s[4:7], s56 offen lds
    v_mfma_f32_16x16x32_bf16 v[176:179], a[192:195], a[236:239], v[176:179]
    s_add_u32 m0, s42, 0x1e40
    ds_read_b128 a[232:235], v224 offset:34048
    ds_read_b128 v[144:147], v236
    v_mfma_f32_16x16x32_bf16 v[180:183], a[196:199], a[236:239], v[180:183]
    v_bfe_u32 v236, s62, v232, 4
    v_mad_u32_u24 v236, v236, s40, v230
    v_mfma_f32_16x16x32_bf16 v[200:203], a[200:203], a[236:239], v[200:203]
    ds_read_b128 a[236:239], v224 offset:34112
    v_mfma_f32_16x16x32_bf16 v[176:179], a[204:207], a[240:243], v[176:179]
    v_exp_f32 v148, v148
    v_mfma_f32_16x16x32_bf16 v[180:183], a[208:211], a[240:243], v[180:183]
    v_exp_f32 v149, v149
    v_mfma_f32_16x16x32_bf16 v[200:203], a[212:215], a[240:243], v[200:203]
    s_waitcnt lgkmcnt(3)
    buffer_load_dwordx4 v247, s[4:7], s56 offen lds
    v_mfma_f32_16x16x32_bf16 v[204:207], a[244:247], a[72:75], 0
    s_add_u32 s56, s39, 0x1a4000
    ds_read_b128 a[240:243], v224 offset:34176
    v_mul_f32 v176, s37, v176
    v_mfma_f32_16x16x32_bf16 v[208:211], a[244:247], a[76:79], 0
    s_add_u32 m0, s41, 0x3c80
    v_mul_f32 v177, s37, v177
    v_mul_f32 v178, s37, v178
    v_mfma_f32_16x16x32_bf16 v[212:215], a[244:247], a[80:83], 0
    v_mul_f32 v179, s37, v179
    v_cvt_pk_bf16_f32 v138, v176, v177
    v_mfma_f32_16x16x32_bf16 v[204:207], a[248:251], a[84:87], v[204:207]
    v_cvt_pk_bf16_f32 v139, v178, v179
    v_mul_f32 v180, s37, v180
    v_mfma_f32_16x16x32_bf16 v[208:211], a[248:251], a[88:91], v[208:211]
    s_waitcnt lgkmcnt(2)
    v_mul_f32 v181, s37, v181
    v_mul_f32 v182, s37, v182
    v_mfma_f32_16x16x32_bf16 v[144:147], v[42:45], v[132:135], v[144:147]
    v_mul_f32 v183, s37, v183
    v_cvt_pk_bf16_f32 v140, v180, v181
    v_mfma_f32_16x16x32_bf16 v[212:215], a[248:251], a[92:95], v[212:215]
    v_cvt_pk_bf16_f32 v141, v182, v183
    v_mul_f32 v200, s37, v200
    v_mfma_f32_16x16x32_bf16 v[204:207], a[252:255], a[96:99], v[204:207]
    v_mul_f32 v201, s37, v201
    v_mul_f32 v202, s37, v202
    v_mfma_f32_16x16x16_bf16 v[144:147], v[46:47], v[136:137], v[144:147]
    v_mul_f32 v203, s37, v203
    v_cvt_pk_bf16_f32 v142, v200, v201
    v_mfma_f32_16x16x32_bf16 v[208:211], a[252:255], a[100:103], v[208:211]
    ds_read_b128 a[244:247], v224 offset:34240
    v_cvt_pk_bf16_f32 v143, v202, v203
    v_mfma_f32_16x16x32_bf16 v[212:215], a[252:255], a[104:107], v[212:215]
    buffer_load_dwordx4 v246, s[4:7], s56 offen lds
    v_mfma_f32_16x16x32_bf16 v[204:207], a[220:223], a[108:111], v[204:207]
    s_add_u32 m0, s42, 0x3c80
    ds_read_b128 a[248:251], v224 offset:34304
    ds_read_b128 a[252:255], v224 offset:34368
    v_mfma_f32_16x16x32_bf16 v[208:211], a[220:223], a[112:115], v[208:211]
    buffer_load_dwordx4 v247, s[4:7], s56 offen lds
    v_mfma_f32_16x16x32_bf16 v[212:215], a[220:223], a[116:119], v[212:215]
    s_add_u32 s56, s39, 0x1ce000
    ds_read_b128 a[220:223], v224 offset:46464
    v_cvt_pk_bf16_f32 v170, v148, v149
    v_mfma_f32_16x16x32_bf16 v[204:207], a[224:227], a[120:123], v[204:207]
    s_add_u32 m0, s41, 0x5ac0
    v_exp_f32 v150, v150
    v_mfma_f32_16x16x32_bf16 v[208:211], a[224:227], a[124:127], v[208:211]
    buffer_load_dwordx4 v246, s[4:7], s56 offen lds
    v_mfma_f32_16x16x32_bf16 v[212:215], a[224:227], a[128:131], v[212:215]
    s_add_u32 m0, s42, 0x5ac0
    ds_read_b128 a[224:227], v224 offset:46528
    v_mfma_f32_16x16x32_bf16 v[204:207], a[228:231], a[132:135], v[204:207]
    v_exp_f32 v151, v151
    v_mfma_f32_16x16x32_bf16 v[208:211], a[228:231], a[136:139], v[208:211]
    v_cvt_pk_bf16_f32 v171, v150, v151
    v_mfma_f32_16x16x32_bf16 v[212:215], a[228:231], a[140:143], v[212:215]
    ds_read_b128 a[228:231], v224 offset:46592
    ds_read_b128 v[148:151], v235
    v_mfma_f32_16x16x32_bf16 v[196:199], a[216:219], v[168:171], 0
    v_bfe_u32 v235, s61, v232, 4
    v_cvt_pk_bf16_f32 v74, v204, v205
    v_mfma_f32_16x16x32_bf16 v[184:187], v[66:69], v[168:171], 0
    buffer_load_dwordx4 v247, s[4:7], s56 offen lds
    v_mfma_f32_16x16x32_bf16 v[188:191], v[88:91], v[168:171], 0
    s_add_u32 s56, s39, 0x1f8000
    v_cvt_pk_bf16_f32 v75, v206, v207
    v_cvt_pk_bf16_f32 v96, v208, v209
    v_mfma_f32_16x16x32_bf16 v[192:195], v[110:113], v[168:171], 0
    s_add_u32 m0, s41, 0x7900
    v_cvt_pk_bf16_f32 v97, v210, v211
    v_cvt_pk_bf16_f32 v118, v212, v213
    v_mfma_f32_16x16x32_bf16 v[216:219], a[232:235], a[72:75], 0
L_pg2:
    s_cbranch_execz L_pg6
    v_cvt_pk_bf16_f32 v119, v214, v215
    v_mad_u32_u24 v235, v235, s40, v230
    v_mfma_f32_16x16x32_bf16 v[220:223], a[232:235], a[76:79], 0
    v_exp_f32 v152, v152
    v_mfma_f32_16x16x32_bf16 v[176:179], a[232:235], a[80:83], 0
    s_waitcnt lgkmcnt(2)
    ds_read_b128 a[232:235], v224 offset:46656
    v_mfma_f32_16x16x32_bf16 v[216:219], a[236:239], a[84:87], v[216:219]
    v_exp_f32 v153, v153
    v_mfma_f32_16x16x32_bf16 v[220:223], a[236:239], a[88:91], v[220:223]
    v_exp_f32 v154, v154
    v_mfma_f32_16x16x32_bf16 v[176:179], a[236:239], a[92:95], v[176:179]
    s_waitcnt lgkmcnt(1)
    ds_read_b128 a[236:239], v224 offset:46720
    v_cvt_pk_bf16_f32 v172, v152, v153
    v_mfma_f32_16x16x32_bf16 v[148:151], v[18:21], v[132:135], v[148:151]
    v_exp_f32 v155, v155
    v_mfma_f32_16x16x32_bf16 v[216:219], a[240:243], a[96:99], v[216:219]
    v_cvt_pk_bf16_f32 v173, v154, v155
    v_mfma_f32_16x16x32_bf16 v[220:223], a[240:243], a[100:103], v[220:223]
    ds_read_b128 v[152:155], v234
    v_bfe_u32 v234, s63, v233, 4
    v_mfma_f32_16x16x16_bf16 v[148:151], v[22:23], v[136:137], v[148:151]
    v_mad_u32_u24 v234, v234, s40, v231
    v_mfma_f32_16x16x32_bf16 v[176:179], a[240:243], a[104:107], v[176:179]
    ds_read_b128 a[240:243], v224 offset:46784
    v_mfma_f32_16x16x32_bf16 v[216:219], a[244:247], a[108:111], v[216:219]
    v_exp_f32 v156, v156
    v_mfma_f32_16x16x32_bf16 v[220:223], a[244:247], a[112:115], v[220:223]
    v_exp_f32 v157, v157
    v_mfma_f32_16x16x32_bf16 v[176:179], a[244:247], a[116:119], v[176:179]
    ds_read_b128 a[244:247], v224 offset:49536
    v_cvt_pk_bf16_f32 v174, v156, v157
    v_mfma_f32_16x16x32_bf16 v[216:219], a[248:251], a[120:123], v[216:219]
    v_exp_f32 v158, v158
    v_mfma_f32_16x16x32_bf16 v[220:223], a[248:251], a[124:127], v[220:223]
    v_exp_f32 v159, v159
    v_mfma_f32_16x16x32_bf16 v[176:179], a[248:251], a[128:131], v[176:179]
    ds_read_b128 a[248:251], v224 offset:49600
    v_cvt_pk_bf16_f32 v175, v158, v159
    v_mfma_f32_16x16x32_bf16 v[216:219], a[252:255], a[132:135], v[216:219]
    ds_read_b128 v[156:159], v235
    v_bfe_u32 v235, s64, v233, 4
    v_mfma_f32_16x16x32_bf16 v[196:199], a[216:219], v[172:175], v[196:199]
    v_mad_u32_u24 v235, v235, s40, v231
    v_mfma_f32_16x16x32_bf16 v[184:187], v[70:73], v[172:175], v[184:187]
    v_exp_f32 v160, v160
    v_mfma_f32_16x16x32_bf16 v[188:191], v[92:95], v[172:175], v[188:191]
    v_exp_f32 v161, v161
    v_mfma_f32_16x16x32_bf16 v[192:195], v[114:117], v[172:175], v[192:195]
    s_waitcnt lgkmcnt(3)
    v_cvt_pk_bf16_f32 v76, v216, v217
    v_cvt_pk_bf16_f32 v77, v218, v219
    v_mfma_f32_16x16x32_bf16 v[152:155], v[24:27], v[138:141], v[152:155]
    v_exp_f32 v162, v162
    v_mfma_f32_16x16x32_bf16 v[220:223], a[252:255], a[136:139], v[220:223]
    v_exp_f32 v163, v163
    v_mfma_f32_16x16x32_bf16 v[176:179], a[252:255], a[140:143], v[176:179]
    ds_read_b128 a[252:255], v224 offset:49664
    v_cvt_pk_bf16_f32 v168, v160, v161
    v_mfma_f32_16x16x16_bf16 v[152:155], v[28:29], v[142:143], v[152:155]
    v_cvt_pk_bf16_f32 v169, v162, v163
    v_mfma_f32_16x16x32_bf16 v[180:183], a[220:223], a[72:75], 0
    s_waitcnt lgkmcnt(1)
    ds_read_b128 v[160:163], v230 offset:1920
    v_cvt_pk_bf16_f32 v98, v220, v221
    v_mfma_f32_16x16x32_bf16 v[156:159], v[30:33], v[138:141], v[156:159]
    v_cvt_pk_bf16_f32 v99, v222, v223
    v_cvt_pk_bf16_f32 v120, v176, v177
    v_mfma_f32_16x16x32_bf16 v[200:203], a[220:223], a[76:79], 0
    v_cvt_pk_bf16_f32 v121, v178, v179
    v_mfma_f32_16x16x32_bf16 v[204:207], a[220:223], a[80:83], 0
    ds_read_b128 a[220:223], v224 offset:49728
    v_mfma_f32_16x16x16_bf16 v[156:159], v[34:35], v[142:143], v[156:159]
    v_exp_f32 v164, v164
    v_mfma_f32_16x16x32_bf16 v[180:183], a[224:227], a[84:87], v[180:183]
    v_exp_f32 v165, v165
    v_mfma_f32_16x16x32_bf16 v[200:203], a[224:227], a[88:91], v[200:203]
    v_exp_f32 v166, v166
    v_mfma_f32_16x16x32_bf16 v[204:207], a[224:227], a[92:95], v[204:207]
    ds_read_b128 a[224:227], v224 offset:49792
    v_cvt_pk_bf16_f32 v170, v164, v165
    v_mfma_f32_16x16x32_bf16 v[180:183], a[228:231], a[96:99], v[180:183]
    v_exp_f32 v167, v167
    v_mfma_f32_16x16x32_bf16 v[200:203], a[228:231], a[100:103], v[200:203]
    s_waitcnt lgkmcnt(2)
    v_cvt_pk_bf16_f32 v171, v166, v167
    v_mfma_f32_16x16x32_bf16 v[160:163], v[36:39], v[138:141], v[160:163]
    ds_read_b128 v[164:167], v236
    v_bfe_u32 v236, s65, v232, 4
    v_mfma_f32_16x16x32_bf16 v[196:199], a[216:219], v[168:171], v[196:199]
    v_exp_f32 v144, v144
    v_mfma_f32_16x16x32_bf16 v[184:187], v[74:77], v[168:171], v[184:187]
    v_exp_f32 v145, v145
    v_mfma_f32_16x16x32_bf16 v[188:191], v[96:99], v[168:171], v[188:191]
    v_exp_f32 v146, v146
    v_mfma_f32_16x16x32_bf16 v[192:195], v[118:121], v[168:171], v[192:195]
    v_exp_f32 v147, v147
    v_mfma_f32_16x16x16_bf16 v[160:163], v[40:41], v[142:143], v[160:163]
    v_cvt_pk_bf16_f32 v172, v144, v145
    v_cvt_pk_bf16_f32 v173, v146, v147
    v_mfma_f32_16x16x32_bf16 v[204:207], a[228:231], a[104:107], v[204:207]
    ds_read_b128 a[228:231], v224 offset:49856
    ds_read_b128 v[144:147], v234
    v_mfma_f32_16x16x32_bf16 v[180:183], a[232:235], a[108:111], v[180:183]
    v_mad_u32_u24 v234, v236, s40, v229
    v_mad_u32_u24 v236, v236, s40, v228
    v_mfma_f32_16x16x32_bf16 v[200:203], a[232:235], a[112:115], v[200:203]
    s_waitcnt vmcnt(4) lgkmcnt(2)
    v_exp_f32 v148, v148
    v_mfma_f32_16x16x32_bf16 v[204:207], a[232:235], a[116:119], v[204:207]
    s_barrier
    ds_read_b128 a[232:235], v227 offset:37120
    v_mfma_f32_16x16x32_bf16 v[164:167], v[42:45], v[138:141], v[164:167]
    v_exp_f32 v149, v149
    v_mfma_f32_16x16x32_bf16 v[180:183], a[236:239], a[120:123], v[180:183]
    v_exp_f32 v150, v150
    v_mfma_f32_16x16x32_bf16 v[200:203], a[236:239], a[124:127], v[200:203]
    v_exp_f32 v151, v151
    v_mfma_f32_16x16x32_bf16 v[204:207], a[236:239], a[128:131], v[204:207]
    ds_read_b128 a[236:239], v227 offset:37184
    v_cvt_pk_bf16_f32 v174, v148, v149
    v_mfma_f32_16x16x16_bf16 v[164:167], v[46:47], v[142:143], v[164:167]
    v_cvt_pk_bf16_f32 v175, v150, v151
    v_mfma_f32_16x16x32_bf16 v[180:183], a[240:243], a[132:135], v[180:183]
    ds_read_b128 v[148:151], v235
    v_bfe_u32 v235, s62, v232, 4
    v_mfma_f32_16x16x32_bf16 v[196:199], a[216:219], v[172:175], v[196:199]
    s_waitcnt lgkmcnt(3)
    v_exp_f32 v152, v152
    v_mfma_f32_16x16x32_bf16 v[144:147], v[48:51], v[138:141], v[144:147]
    v_exp_f32 v153, v153
    v_mfma_f32_16x16x32_bf16 v[200:203], a[240:243], a[136:139], v[200:203]
    v_exp_f32 v154, v154
    v_mfma_f32_16x16x32_bf16 v[204:207], a[240:243], a[140:143], v[204:207]
    v_cvt_pk_bf16_f32 v80, v180, v181
    v_cvt_pk_bf16_f32 v81, v182, v183
    v_mfma_f32_16x16x16_bf16 v[144:147], v[52:53], v[142:143], v[144:147]
    ds_read_b128 a[240:243], v227 offset:37248
    v_cvt_pk_bf16_f32 v168, v152, v153
    v_mfma_f32_16x16x32_bf16 v[208:211], a[244:247], a[72:75], 0
    v_cvt_pk_bf16_f32 v102, v200, v201
    v_cvt_pk_bf16_f32 v103, v202, v203
    v_mfma_f32_16x16x32_bf16 v[212:215], a[244:247], a[76:79], 0
    v_cvt_pk_bf16_f32 v124, v204, v205
    v_cvt_pk_bf16_f32 v125, v206, v207
    v_mfma_f32_16x16x32_bf16 v[216:219], a[244:247], a[80:83], 0
    ds_read_b128 a[244:247], v227 offset:37312
    v_mfma_f32_16x16x32_bf16 v[208:211], a[248:251], a[84:87], v[208:211]
    s_waitcnt lgkmcnt(2)
    v_rcp_f32 v197, v196
    v_mfma_f32_16x16x32_bf16 v[148:151], v[54:57], v[138:141], v[148:151]
    v_max3_f32 v250, v250, v196, v197
    v_mfma_f32_16x16x32_bf16 v[212:215], a[248:251], a[88:91], v[212:215]
    v_exp_f32 v155, v155
    v_mfma_f32_16x16x32_bf16 v[216:219], a[248:251], a[92:95], v[216:219]
    ds_read_b128 a[248:251], v227 offset:37376
    v_cvt_pk_bf16_f32 v169, v154, v155
    v_mfma_f32_16x16x16_bf16 v[148:151], v[58:59], v[142:143], v[148:151]
    ds_read_b128 v[152:155], v234
    v_bfe_u32 v234, s62, v232, 4
    v_mfma_f32_16x16x32_bf16 v[208:211], a[252:255], a[96:99], v[208:211]
    v_mad_u32_u24 v234, v234, s40, v230
    v_mfma_f32_16x16x32_bf16 v[212:215], a[252:255], a[100:103], v[212:215]
    v_exp_f32 v156, v156
    v_mfma_f32_16x16x32_bf16 v[216:219], a[252:255], a[104:107], v[216:219]
    ds_read_b128 a[252:255], v227 offset:37440
    v_mfma_f32_16x16x32_bf16 v[208:211], a[220:223], a[108:111], v[208:211]
    v_exp_f32 v157, v157
    v_mfma_f32_16x16x32_bf16 v[212:215], a[220:223], a[112:115], v[212:215]
    v_exp_f32 v158, v158
    v_mfma_f32_16x16x32_bf16 v[216:219], a[220:223], a[116:119], v[216:219]
    ds_read_b64_tr_b16 a[220:221], v240
    ds_read_b64_tr_b16 a[222:223], v240 offset:1536
    v_mfma_f32_16x16x32_bf16 v[208:211], a[224:227], a[120:123], v[208:211]
    v_exp_f32 v159, v159
    v_mfma_f32_16x16x32_bf16 v[212:215], a[224:227], a[124:127], v[212:215]
    v_cvt_pk_bf16_f32 v170, v156, v157
    v_cvt_pk_bf16_f32 v171, v158, v159
    v_mfma_f32_16x16x32_bf16 v[216:219], a[224:227], a[128:131], v[216:219]
    ds_read_b64_tr_b16 a[224:225], v240 offset:8
    ds_read_b64_tr_b16 a[226:227], v240 offset:1544
    v_mfma_f32_16x16x32_bf16 v[208:211], a[228:231], a[132:135], v[208:211]
    ds_read_b128 v[156:159], v236
    v_mad_u32_u24 v236, v235, s40, v228
    v_mfma_f32_16x16x32_bf16 v[212:215], a[228:231], a[136:139], v[212:215]
    v_mad_u32_u24 v235, v235, s40, v229
    v_mfma_f32_16x16x32_bf16 v[216:219], a[228:231], a[140:143], v[216:219]
    ds_read_b64_tr_b16 a[228:229], v241
    ds_read_b64_tr_b16 a[230:231], v241 offset:1536
    v_mfma_f32_16x16x32_bf16 v[220:223], a[232:235], a[72:75], 0
    v_cvt_pk_bf16_f32 v78, v208, v209
    v_cvt_pk_bf16_f32 v79, v210, v211
    v_mfma_f32_16x16x32_bf16 v[176:179], a[232:235], a[76:79], 0
    v_cvt_pk_bf16_f32 v100, v212, v213
    v_cvt_pk_bf16_f32 v101, v214, v215
    v_mfma_f32_16x16x32_bf16 v[184:187], v[78:81], v[172:175], v[184:187]
    v_cvt_pk_bf16_f32 v122, v216, v217
    v_cvt_pk_bf16_f32 v123, v218, v219
    v_mfma_f32_16x16x32_bf16 v[188:191], v[100:103], v[172:175], v[188:191]
    v_exp_f32 v160, v160
    v_mfma_f32_16x16x32_bf16 v[192:195], v[122:125], v[172:175], v[192:195]
    v_exp_f32 v161, v161
    v_mfma_f32_16x16x32_bf16 v[180:183], a[232:235], a[80:83], 0
    ds_read_b128 a[232:235], v225 offset:39936
    v_mul_f32 v184, v184, v197
    v_mfma_f32_16x16x32_bf16 v[220:223], a[236:239], a[84:87], v[220:223]
    v_mul_f32 v185, v185, v197
    v_cvt_pk_bf16_f32 v184, v184, v185
    v_mfma_f32_16x16x32_bf16 v[176:179], a[236:239], a[88:91], v[176:179]
    v_mul_f32 v186, v186, v197
    v_mul_f32 v187, v187, v197
    v_mfma_f32_16x16x32_bf16 v[180:183], a[236:239], a[92:95], v[180:183]
    s_waitcnt lgkmcnt(4)
    v_cvt_pk_bf16_f32 v185, v186, v187
    v_mul_f32 v188, v188, v197
    v_mfma_f32_16x16x32_bf16 v[220:223], a[240:243], a[96:99], v[220:223]
    v_mul_f32 v189, v189, v197
    v_cvt_pk_bf16_f32 v186, v188, v189
    v_mfma_f32_16x16x32_bf16 v[176:179], a[240:243], a[100:103], v[176:179]
    v_mul_f32 v190, v190, v197
    v_mul_f32 v191, v191, v197
    v_mfma_f32_16x16x32_bf16 v[180:183], a[240:243], a[104:107], v[180:183]
    v_cvt_pk_bf16_f32 v187, v190, v191
    v_mul_f32 v192, v192, v197
    v_mfma_f32_16x16x32_bf16 v[220:223], a[244:247], a[108:111], v[220:223]
    v_mul_f32 v193, v193, v197
    v_cvt_pk_bf16_f32 v188, v192, v193
    v_mfma_f32_16x16x32_bf16 v[176:179], a[244:247], a[112:115], v[176:179]
    v_mul_f32 v194, v194, v197
    v_mul_f32 v195, v195, v197
    v_mfma_f32_16x16x32_bf16 v[196:199], a[216:219], v[168:171], 0
    ds_read_b128 a[236:239], v225 offset:40000
    v_cvt_pk_bf16_f32 v189, v194, v195
    v_mfma_f32_16x16x32_bf16 v[192:195], v[112:115], v[168:171], 0
    ds_write_b128 v237, v[184:187]
    v_mfma_f32_16x16x32_bf16 v[184:187], v[68:71], v[168:171], 0
    ds_write_b64 v238, v[188:189]
    v_mfma_f32_16x16x32_bf16 v[188:191], v[90:93], v[168:171], 0
    ds_read_b128 a[240:243], v225 offset:40064
    v_cvt_pk_bf16_f32 v172, v160, v161
    v_mfma_f32_16x16x32_bf16 v[180:183], a[244:247], a[116:119], v[180:183]
    ds_read_b128 a[244:247], v225 offset:40128
    v_mfma_f32_16x16x32_bf16 v[220:223], a[248:251], a[120:123], v[220:223]
    v_exp_f32 v162, v162
    v_mfma_f32_16x16x32_bf16 v[176:179], a[248:251], a[124:127], v[176:179]
    v_exp_f32 v163, v163
    v_mfma_f32_16x16x32_bf16 v[180:183], a[248:251], a[128:131], v[180:183]
    ds_read_b128 a[248:251], v225 offset:40192
    v_cvt_pk_bf16_f32 v173, v162, v163
    v_mfma_f32_16x16x32_bf16 v[220:223], a[252:255], a[132:135], v[220:223]
    ds_read_b128 v[160:163], v228 offset:1280
    v_mfma_f32_16x16x32_bf16 v[176:179], a[252:255], a[136:139], v[176:179]
    v_exp_f32 v164, v164
    v_mfma_f32_16x16x32_bf16 v[180:183], a[252:255], a[140:143], v[180:183]
    ds_read_b128 a[252:255], v224
    v_mfma_f32_16x16x32_bf16 v[200:203], a[144:147], v[252:255], 0
    v_exp_f32 v165, v165
    v_mfma_f32_16x16x32_bf16 v[204:207], a[148:151], v[252:255], 0
    v_cvt_pk_bf16_f32 v84, v220, v221
    v_cvt_pk_bf16_f32 v85, v222, v223
    v_mfma_f32_16x16x32_bf16 v[208:211], a[152:155], v[252:255], 0
    s_waitcnt lgkmcnt(4)
    v_cvt_pk_bf16_f32 v106, v176, v177
    v_cvt_pk_bf16_f32 v107, v178, v179
    v_mfma_f32_16x16x32_bf16 v[200:203], a[156:159], a[232:235], v[200:203]
    v_cvt_pk_bf16_f32 v128, v180, v181
    v_cvt_pk_bf16_f32 v129, v182, v183
    v_mfma_f32_16x16x32_bf16 v[204:207], a[160:163], a[232:235], v[204:207]
    ds_read_b128 v[252:255], v224 offset:64
    v_cvt_pk_bf16_f32 v174, v164, v165
    v_mfma_f32_16x16x32_bf16 v[208:211], a[164:167], a[232:235], v[208:211]
    ds_read_b128 a[232:235], v224 offset:128
    v_mfma_f32_16x16x32_bf16 v[200:203], a[168:171], a[236:239], v[200:203]
    v_exp_f32 v166, v166
    v_mfma_f32_16x16x32_bf16 v[204:207], a[172:175], a[236:239], v[204:207]
    v_exp_f32 v167, v167
    v_mfma_f32_16x16x32_bf16 v[208:211], a[176:179], a[236:239], v[208:211]
    ds_read_b128 a[236:239], v224 offset:192
    v_cvt_pk_bf16_f32 v175, v166, v167
    v_mfma_f32_16x16x32_bf16 v[200:203], a[180:183], a[240:243], v[200:203]
    ds_read_b128 v[164:167], v229 offset:1280
    v_mfma_f32_16x16x32_bf16 v[196:199], a[216:219], v[172:175], v[196:199]
    v_exp_f32 v144, v144
    v_mfma_f32_16x16x32_bf16 v[184:187], v[76:79], v[172:175], v[184:187]
    v_exp_f32 v145, v145
    v_mfma_f32_16x16x32_bf16 v[188:191], v[98:101], v[172:175], v[188:191]
    v_exp_f32 v146, v146
    v_mfma_f32_16x16x32_bf16 v[192:195], v[120:123], v[172:175], v[192:195]
    v_exp_f32 v147, v147
    v_mfma_f32_16x16x32_bf16 v[204:207], a[184:187], a[240:243], v[204:207]
    v_cvt_pk_bf16_f32 v168, v144, v145
    v_cvt_pk_bf16_f32 v169, v146, v147
    v_mfma_f32_16x16x32_bf16 v[208:211], a[188:191], a[240:243], v[208:211]
    s_waitcnt lgkmcnt(2)
    ds_read_b128 a[240:243], v224 offset:256
    ds_read_b128 v[144:147], v229 offset:1920
    v_mfma_f32_16x16x32_bf16 v[200:203], a[192:195], a[244:247], v[200:203]
    v_exp_f32 v148, v148
    v_mfma_f32_16x16x32_bf16 v[204:207], a[196:199], a[244:247], v[204:207]
    v_exp_f32 v149, v149
    v_mfma_f32_16x16x32_bf16 v[208:211], a[200:203], a[244:247], v[208:211]
    ds_read_b128 a[244:247], v224 offset:320
    v_cvt_pk_bf16_f32 v170, v148, v149
    v_mfma_f32_16x16x32_bf16 v[200:203], a[204:207], a[248:251], v[200:203]
    v_exp_f32 v150, v150
    v_mfma_f32_16x16x32_bf16 v[204:207], a[208:211], a[248:251], v[204:207]
    v_exp_f32 v151, v151
    v_mfma_f32_16x16x32_bf16 v[208:211], a[212:215], a[248:251], v[208:211]
    ds_read_b128 a[248:251], v224 offset:3072
    v_cvt_pk_bf16_f32 v171, v150, v151
    v_mfma_f32_16x16x32_bf16 v[212:215], a[0:3], a[252:255], 0
    ds_read_b128 v[148:151], v228 offset:1920
    v_mul_f32 v200, s37, v200
    v_mfma_f32_16x16x32_bf16 v[196:199], a[216:219], v[168:171], v[196:199]
    v_mul_f32 v201, s37, v201
    v_mul_f32 v202, s37, v202
    v_mfma_f32_16x16x32_bf16 v[184:187], v[82:85], v[168:171], v[184:187]
    v_mul_f32 v203, s37, v203
    v_cvt_pk_bf16_f32 v132, v200, v201
    v_mfma_f32_16x16x32_bf16 v[188:191], v[104:107], v[168:171], v[188:191]
    v_cvt_pk_bf16_f32 v133, v202, v203
    v_mul_f32 v204, s37, v204
    v_mfma_f32_16x16x32_bf16 v[192:195], v[126:129], v[168:171], v[192:195]
    v_mul_f32 v205, s37, v205
    v_mul_f32 v206, s37, v206
    v_mfma_f32_16x16x32_bf16 v[216:219], a[4:7], a[252:255], 0
    v_mul_f32 v207, s37, v207
    v_cvt_pk_bf16_f32 v134, v204, v205
    v_mfma_f32_16x16x32_bf16 v[220:223], a[8:11], a[252:255], 0
    v_cvt_pk_bf16_f32 v135, v206, v207
    v_mul_f32 v208, s37, v208
    v_mfma_f32_16x16x32_bf16 v[176:179], a[252:255], a[72:75], 0
    v_mul_f32 v209, s37, v209
    v_mul_f32 v210, s37, v210
    v_mfma_f32_16x16x32_bf16 v[152:155], v[30:33], v[132:135], v[152:155]
    v_mul_f32 v211, s37, v211
    v_cvt_pk_bf16_f32 v136, v208, v209
    v_mfma_f32_16x16x32_bf16 v[156:159], v[6:9], v[132:135], v[156:159]
    v_cvt_pk_bf16_f32 v137, v210, v211
    v_mfma_f32_16x16x32_bf16 v[160:163], v[12:15], v[132:135], v[160:163]
    v_rcp_f32 v197, v196
    v_mfma_f32_16x16x16_bf16 v[152:155], v[34:35], v[136:137], v[152:155]
    v_mul_f32 v184, v184, v197
    v_mul_f32 v185, v185, v197
    v_mfma_f32_16x16x16_bf16 v[156:159], v[10:11], v[136:137], v[156:159]
    v_cvt_pk_bf16_f32 v184, v184, v185
    v_mul_f32 v186, v186, v197
    v_mfma_f32_16x16x16_bf16 v[160:163], v[16:17], v[136:137], v[160:163]
    s_waitcnt lgkmcnt(0)
    v_mul_f32 v187, v187, v197
    v_cvt_pk_bf16_f32 v185, v186, v187
    v_mfma_f32_16x16x32_bf16 v[164:167], v[36:39], v[132:135], v[164:167]
    v_mul_f32 v188, v188, v197
    v_mul_f32 v189, v189, v197
    v_mfma_f32_16x16x32_bf16 v[144:147], v[42:45], v[132:135], v[144:147]
    v_cvt_pk_bf16_f32 v186, v188, v189
    v_mul_f32 v190, v190, v197
    v_mfma_f32_16x16x32_bf16 v[148:151], v[18:21], v[132:135], v[148:151]
    v_mul_f32 v191, v191, v197
    v_cvt_pk_bf16_f32 v187, v190, v191
    v_mfma_f32_16x16x16_bf16 v[164:167], v[40:41], v[136:137], v[164:167]
    v_mul_f32 v192, v192, v197
    v_mul_f32 v193, v193, v197
    v_mfma_f32_16x16x16_bf16 v[144:147], v[46:47], v[136:137], v[144:147]
    v_cvt_pk_bf16_f32 v188, v192, v193
    v_mul_f32 v194, v194, v197
    v_mfma_f32_16x16x16_bf16 v[148:151], v[22:23], v[136:137], v[148:151]
    v_mul_f32 v195, v195, v197
    v_cvt_pk_bf16_f32 v189, v194, v195
    v_mfma_f32_16x16x32_bf16 v[180:183], a[252:255], a[76:79], 0
    v_max3_f32 v250, v250, v196, v197
    v_mfma_f32_16x16x32_bf16 v[200:203], a[252:255], a[80:83], 0
    ds_read_b128 a[252:255], v224 offset:3136
    v_mfma_f32_16x16x32_bf16 v[212:215], a[12:15], v[252:255], v[212:215]
    ds_write_b128 v237, v[184:187] offset:6144
    v_mfma_f32_16x16x32_bf16 v[216:219], a[16:19], v[252:255], v[216:219]
    ds_write_b64 v238, v[188:189] offset:6144
    v_mfma_f32_16x16x32_bf16 v[220:223], a[20:23], v[252:255], v[220:223]
    v_exp_f32 v152, v152
    v_mfma_f32_16x16x32_bf16 v[176:179], v[252:255], a[84:87], v[176:179]
    v_exp_f32 v153, v153
    v_mfma_f32_16x16x32_bf16 v[180:183], v[252:255], a[88:91], v[180:183]
    v_exp_f32 v154, v154
    v_mfma_f32_16x16x32_bf16 v[200:203], v[252:255], a[92:95], v[200:203]
    ds_read_b128 v[252:255], v224 offset:3200
    v_cvt_pk_bf16_f32 v172, v152, v153
    v_mfma_f32_16x16x32_bf16 v[212:215], a[24:27], a[232:235], v[212:215]
    v_exp_f32 v155, v155
    v_mfma_f32_16x16x32_bf16 v[216:219], a[28:31], a[232:235], v[216:219]
    v_cvt_pk_bf16_f32 v173, v154, v155
    v_mfma_f32_16x16x32_bf16 v[220:223], a[32:35], a[232:235], v[220:223]
    ds_read_b128 v[152:155], v236
    v_bfe_u32 v236, s66, v233, 4
    v_mfma_f32_16x16x32_bf16 v[176:179], a[232:235], a[96:99], v[176:179]
    v_mad_u32_u24 v236, v236, s40, v231
    v_mfma_f32_16x16x32_bf16 v[180:183], a[232:235], a[100:103], v[180:183]
    v_exp_f32 v156, v156
    v_mfma_f32_16x16x32_bf16 v[200:203], a[232:235], a[104:107], v[200:203]
    ds_read_b128 a[232:235], v224 offset:3264
    v_mfma_f32_16x16x32_bf16 v[212:215], a[36:39], a[236:239], v[212:215]
    v_exp_f32 v157, v157
    v_mfma_f32_16x16x32_bf16 v[216:219], a[40:43], a[236:239], v[216:219]
    v_exp_f32 v158, v158
    v_mfma_f32_16x16x32_bf16 v[220:223], a[44:47], a[236:239], v[220:223]
    v_exp_f32 v159, v159
    v_mfma_f32_16x16x32_bf16 v[176:179], a[236:239], a[108:111], v[176:179]
    v_cvt_pk_bf16_f32 v174, v156, v157
    v_cvt_pk_bf16_f32 v175, v158, v159
    v_mfma_f32_16x16x32_bf16 v[180:183], a[236:239], a[112:115], v[180:183]
    ds_read_b128 v[156:159], v235
    v_bfe_u32 v235, s65, v232, 4
    v_mfma_f32_16x16x32_bf16 v[196:199], a[216:219], v[172:175], 0
    v_mad_u32_u24 v235, v235, s40, v230
    v_mfma_f32_16x16x32_bf16 v[184:187], v[70:73], v[172:175], 0
    v_exp_f32 v160, v160
    v_mfma_f32_16x16x32_bf16 v[188:191], v[92:95], v[172:175], 0
    v_exp_f32 v161, v161
    v_mfma_f32_16x16x32_bf16 v[192:195], v[114:117], v[172:175], 0
    v_exp_f32 v162, v162
    v_mfma_f32_16x16x32_bf16 v[200:203], a[236:239], a[116:119], v[200:203]
    ds_read_b128 a[236:239], v224 offset:3328
    v_cvt_pk_bf16_f32 v168, v160, v161
    v_mfma_f32_16x16x32_bf16 v[212:215], a[48:51], a[240:243], v[212:215]
    v_exp_f32 v163, v163
    v_mfma_f32_16x16x32_bf16 v[216:219], a[52:55], a[240:243], v[216:219]
    v_cvt_pk_bf16_f32 v169, v162, v163
    v_mfma_f32_16x16x32_bf16 v[220:223], a[56:59], a[240:243], v[220:223]
    ds_read_b128 v[160:163], v234
    v_bfe_u32 v234, s67, v233, 4
    v_mfma_f32_16x16x32_bf16 v[176:179], a[240:243], a[120:123], v[176:179]
    v_mad_u32_u24 v234, v234, s40, v231
    v_mfma_f32_16x16x32_bf16 v[180:183], a[240:243], a[124:127], v[180:183]
    v_exp_f32 v164, v164
    v_mfma_f32_16x16x32_bf16 v[200:203], a[240:243], a[128:131], v[200:203]
    ds_read_b128 a[240:243], v224 offset:3392
    v_mfma_f32_16x16x32_bf16 v[212:215], a[60:63], a[244:247], v[212:215]
    v_exp_f32 v165, v165
    v_mfma_f32_16x16x32_bf16 v[216:219], a[64:67], a[244:247], v[216:219]
    v_exp_f32 v166, v166
    v_mfma_f32_16x16x32_bf16 v[220:223], a[68:71], a[244:247], v[220:223]
    v_exp_f32 v167, v167
    v_mfma_f32_16x16x32_bf16 v[176:179], a[244:247], a[132:135], v[176:179]
    v_cvt_pk_bf16_f32 v170, v164, v165
    v_cvt_pk_bf16_f32 v171, v166, v167
    v_mfma_f32_16x16x32_bf16 v[180:183], a[244:247], a[136:139], v[180:183]
    v_cvt_pk_bf16_f32 v0, v212, v213
    v_cvt_pk_bf16_f32 v1, v214, v215
    v_mfma_f32_16x16x32_bf16 v[196:199], a[216:219], v[168:171], v[196:199]
    v_cvt_pk_bf16_f32 v2, v216, v217
    v_cvt_pk_bf16_f32 v3, v218, v219
    v_mfma_f32_16x16x32_bf16 v[184:187], v[74:77], v[168:171], v[184:187]
    v_cvt_pk_bf16_f32 v4, v220, v221
    v_cvt_pk_bf16_f32 v5, v222, v223
    v_mfma_f32_16x16x32_bf16 v[188:191], v[96:99], v[168:171], v[188:191]
    v_cvt_pk_bf16_f32 v66, v176, v177
    v_cvt_pk_bf16_f32 v67, v178, v179
    v_mfma_f32_16x16x32_bf16 v[192:195], v[118:121], v[168:171], v[192:195]
    s_waitcnt lgkmcnt(1)
    v_cvt_pk_bf16_f32 v88, v180, v181
    v_cvt_pk_bf16_f32 v89, v182, v183
    v_mfma_f32_16x16x32_bf16 v[152:155], v[0:3], v[132:135], v[152:155]
    ds_read_b128 v[164:167], v235
    v_bfe_u32 v235, s68, v233, 4
    v_mfma_f32_16x16x32_bf16 v[200:203], a[244:247], a[140:143], v[200:203]
    ds_read_b128 a[244:247], v225 offset:42944
    v_mad_u32_u24 v235, v235, s40, v231
    v_mfma_f32_16x16x32_bf16 v[204:207], a[0:3], a[248:251], 0
    v_exp_f32 v144, v144
    v_mfma_f32_16x16x16_bf16 v[152:155], v[4:5], v[136:137], v[152:155]
    v_exp_f32 v145, v145
    v_mfma_f32_16x16x32_bf16 v[208:211], a[4:7], a[248:251], 0
    v_exp_f32 v146, v146
    v_mfma_f32_16x16x32_bf16 v[212:215], a[8:11], a[248:251], 0
    v_cvt_pk_bf16_f32 v110, v200, v201
    v_cvt_pk_bf16_f32 v111, v202, v203
    v_mfma_f32_16x16x32_bf16 v[216:219], a[248:251], a[72:75], 0
    v_exp_f32 v147, v147
    v_mfma_f32_16x16x32_bf16 v[220:223], a[248:251], a[76:79], 0
    v_cvt_pk_bf16_f32 v172, v144, v145
    v_cvt_pk_bf16_f32 v173, v146, v147
    v_mfma_f32_16x16x32_bf16 v[176:179], a[248:251], a[80:83], 0
    ds_read_b128 a[248:251], v225 offset:43008
    ds_read_b128 v[144:147], v230 offset:1280
    v_mfma_f32_16x16x32_bf16 v[204:207], a[12:15], a[252:255], v[204:207]
    v_exp_f32 v148, v148
    v_mfma_f32_16x16x32_bf16 v[208:211], a[16:19], a[252:255], v[208:211]
    v_exp_f32 v149, v149
    v_mfma_f32_16x16x32_bf16 v[212:215], a[20:23], a[252:255], v[212:215]
    v_exp_f32 v150, v150
    v_mfma_f32_16x16x32_bf16 v[216:219], a[252:255], a[84:87], v[216:219]
    v_exp_f32 v151, v151
    v_mfma_f32_16x16x32_bf16 v[220:223], a[252:255], a[88:91], v[220:223]
    v_cvt_pk_bf16_f32 v174, v148, v149
    v_cvt_pk_bf16_f32 v175, v150, v151
    v_mfma_f32_16x16x32_bf16 v[176:179], a[252:255], a[92:95], v[176:179]
    ds_read_b128 a[252:255], v225 offset:43072
    ds_read_b128 v[148:151], v230 offset:1920
    v_mfma_f32_16x16x32_bf16 v[196:199], a[216:219], v[172:175], v[196:199]
    v_exp_f32 v152, v152
    v_mfma_f32_16x16x32_bf16 v[184:187], v[78:81], v[172:175], v[184:187]
    v_exp_f32 v153, v153
    v_mfma_f32_16x16x32_bf16 v[188:191], v[100:103], v[172:175], v[188:191]
    v_exp_f32 v154, v154
    v_mfma_f32_16x16x32_bf16 v[192:195], v[122:125], v[172:175], v[192:195]
    v_exp_f32 v155, v155
    v_mfma_f32_16x16x32_bf16 v[204:207], a[24:27], v[252:255], v[204:207]
    v_cvt_pk_bf16_f32 v168, v152, v153
    v_cvt_pk_bf16_f32 v169, v154, v155
    v_mfma_f32_16x16x32_bf16 v[208:211], a[28:31], v[252:255], v[208:211]
    ds_read_b128 v[152:155], v236
    v_bfe_u32 v236, s69, v233, 4
    v_mfma_f32_16x16x32_bf16 v[212:215], a[32:35], v[252:255], v[212:215]
    v_mad_u32_u24 v236, v236, s40, v231
    v_mfma_f32_16x16x32_bf16 v[216:219], v[252:255], a[96:99], v[216:219]
    v_mfma_f32_16x16x32_bf16 v[220:223], v[252:255], a[100:103], v[220:223]
    v_mfma_f32_16x16x32_bf16 v[176:179], v[252:255], a[104:107], v[176:179]
    ds_read_b128 v[252:255], v225 offset:43136
    v_mfma_f32_16x16x32_bf16 v[204:207], a[36:39], a[232:235], v[204:207]
    v_mfma_f32_16x16x32_bf16 v[208:211], a[40:43], a[232:235], v[208:211]
    v_mfma_f32_16x16x32_bf16 v[212:215], a[44:47], a[232:235], v[212:215]
    v_mfma_f32_16x16x32_bf16 v[216:219], a[232:235], a[108:111], v[216:219]
    v_mfma_f32_16x16x32_bf16 v[220:223], a[232:235], a[112:115], v[220:223]
    v_mfma_f32_16x16x32_bf16 v[176:179], a[232:235], a[116:119], v[176:179]
    ds_read_b128 a[232:235], v225 offset:43200
    v_mfma_f32_16x16x32_bf16 v[204:207], a[48:51], a[236:239], v[204:207]
    v_mfma_f32_16x16x32_bf16 v[208:211], a[52:55], a[236:239], v[208:211]
    v_mfma_f32_16x16x32_bf16 v[212:215], a[56:59], a[236:239], v[212:215]
    v_mfma_f32_16x16x32_bf16 v[216:219], a[236:239], a[120:123], v[216:219]
    v_mfma_f32_16x16x32_bf16 v[220:223], a[236:239], a[124:127], v[220:223]
    v_mfma_f32_16x16x32_bf16 v[176:179], a[236:239], a[128:131], v[176:179]
    s_waitcnt lgkmcnt(1)
    ds_read_b128 a[236:239], v225 offset:43264
    v_mfma_f32_16x16x32_bf16 v[204:207], a[60:63], a[240:243], v[204:207]
    v_mfma_f32_16x16x32_bf16 v[208:211], a[64:67], a[240:243], v[208:211]
    v_mfma_f32_16x16x32_bf16 v[212:215], a[68:71], a[240:243], v[212:215]
    v_mfma_f32_16x16x32_bf16 v[216:219], a[240:243], a[132:135], v[216:219]
    v_mfma_f32_16x16x32_bf16 v[220:223], a[240:243], a[136:139], v[220:223]
    v_mfma_f32_16x16x32_bf16 v[176:179], a[240:243], a[140:143], v[176:179]
    v_mfma_f32_16x16x32_bf16 v[180:183], a[144:147], a[244:247], 0
    s_waitcnt vmcnt(0) lgkmcnt(0)
    v_mfma_f32_16x16x32_bf16 v[200:203], a[148:151], a[244:247], 0
    s_barrier
    v_cvt_pk_bf16_f32 v24, v204, v205
    v_mfma_f32_16x16x32_bf16 v[180:183], a[156:159], a[248:251], v[180:183]
    v_cvt_pk_bf16_f32 v25, v206, v207
    v_cvt_pk_bf16_f32 v26, v208, v209
    v_mfma_f32_16x16x32_bf16 v[204:207], a[152:155], a[244:247], 0
    v_cvt_pk_bf16_f32 v27, v210, v211
    v_cvt_pk_bf16_f32 v28, v212, v213
    v_mfma_f32_16x16x32_bf16 v[200:203], a[160:163], a[248:251], v[200:203]
    v_cvt_pk_bf16_f32 v29, v214, v215
    v_cvt_pk_bf16_f32 v68, v216, v217
    v_mfma_f32_16x16x32_bf16 v[156:159], v[24:27], v[132:135], v[156:159]
    v_cvt_pk_bf16_f32 v69, v218, v219
    v_cvt_pk_bf16_f32 v90, v220, v221
    v_mfma_f32_16x16x32_bf16 v[204:207], a[164:167], a[248:251], v[204:207]
    v_cvt_pk_bf16_f32 v91, v222, v223
    v_cvt_pk_bf16_f32 v112, v176, v177
    v_mfma_f32_16x16x32_bf16 v[180:183], a[168:171], a[252:255], v[180:183]
    ds_read_b128 a[240:243], v227 offset:6144
    v_cvt_pk_bf16_f32 v113, v178, v179
    v_mfma_f32_16x16x16_bf16 v[156:159], v[28:29], v[136:137], v[156:159]
    buffer_load_dwordx4 v246, s[4:7], s56 offen lds
    v_mfma_f32_16x16x32_bf16 v[200:203], a[172:175], a[252:255], v[200:203]
    s_add_u32 m0, s42, 0x7900
    ds_read_b128 a[244:247], v227 offset:6208
    ds_read_b128 a[248:251], v227 offset:6272
    v_mfma_f32_16x16x32_bf16 v[204:207], a[176:179], a[252:255], v[204:207]
    buffer_load_dwordx4 v247, s[4:7], s56 offen lds
    v_mfma_f32_16x16x32_bf16 v[180:183], a[180:183], v[252:255], v[180:183]
    s_add_u32 s56, s39, 0x222000
    ds_read_b128 a[252:255], v227 offset:6336
    s_add_u32 m0, s41, 0x9740
    v_mfma_f32_16x16x32_bf16 v[200:203], a[184:187], v[252:255], v[200:203]
L_pg3:
    s_cbranch_execz L_pg7
    buffer_load_dwordx4 v246, s[4:7], s56 offen lds
    v_mfma_f32_16x16x32_bf16 v[204:207], a[188:191], v[252:255], v[204:207]
    s_add_u32 m0, s42, 0x9740
    ds_read_b128 v[252:255], v227 offset:6400
    v_mfma_f32_16x16x32_bf16 v[180:183], a[192:195], a[232:235], v[180:183]
    buffer_load_dwordx4 v247, s[4:7], s56 offen lds
    v_mfma_f32_16x16x32_bf16 v[200:203], a[196:199], a[232:235], v[200:203]
    s_add_u32 s56, s39, 0x24c000
    v_exp_f32 v156, v156
    v_mfma_f32_16x16x32_bf16 v[204:207], a[200:203], a[232:235], v[204:207]
    s_add_u32 m0, s41, 0xb580
    ds_read_b128 a[232:235], v227 offset:6464
    v_mfma_f32_16x16x32_bf16 v[180:183], a[204:207], a[236:239], v[180:183]
    v_exp_f32 v157, v157
    v_mfma_f32_16x16x32_bf16 v[200:203], a[208:211], a[236:239], v[200:203]
    v_exp_f32 v158, v158
    v_mfma_f32_16x16x32_bf16 v[204:207], a[212:215], a[236:239], v[204:207]
    s_waitcnt lgkmcnt(4)
    ds_read_b128 a[236:239], v239
    v_cvt_pk_bf16_f32 v170, v156, v157
    v_mfma_f32_16x16x32_bf16 v[208:211], a[0:3], a[240:243], 0
    v_exp_f32 v159, v159
    v_mfma_f32_16x16x32_bf16 v[212:215], a[4:7], a[240:243], 0
    v_mul_f32 v180, s37, v180
    v_mul_f32 v181, s37, v181
    v_mfma_f32_16x16x32_bf16 v[216:219], a[8:11], a[240:243], 0
    v_mul_f32 v182, s37, v182
    v_mul_f32 v183, s37, v183
    v_mfma_f32_16x16x32_bf16 v[220:223], a[240:243], a[72:75], 0
    v_cvt_pk_bf16_f32 v138, v180, v181
    v_cvt_pk_bf16_f32 v139, v182, v183
    v_mfma_f32_16x16x32_bf16 v[176:179], a[240:243], a[76:79], 0
    v_mul_f32 v200, s37, v200
    v_mul_f32 v201, s37, v201
    v_mfma_f32_16x16x32_bf16 v[180:183], a[240:243], a[80:83], 0
    v_mul_f32 v202, s37, v202
    v_mul_f32 v203, s37, v203
    v_mfma_f32_16x16x32_bf16 v[208:211], a[12:15], a[244:247], v[208:211]
    v_cvt_pk_bf16_f32 v140, v200, v201
    v_cvt_pk_bf16_f32 v141, v202, v203
    v_mfma_f32_16x16x32_bf16 v[212:215], a[16:19], a[244:247], v[212:215]
    v_mul_f32 v204, s37, v204
    v_mul_f32 v205, s37, v205
    v_mfma_f32_16x16x32_bf16 v[160:163], v[24:27], v[138:141], v[160:163]
    v_mul_f32 v206, s37, v206
    v_mul_f32 v207, s37, v207
    v_mfma_f32_16x16x32_bf16 v[164:167], v[30:33], v[138:141], v[164:167]
    v_cvt_pk_bf16_f32 v142, v204, v205
    v_cvt_pk_bf16_f32 v143, v206, v207
    v_mfma_f32_16x16x32_bf16 v[144:147], v[36:39], v[138:141], v[144:147]
    ds_read_b128 a[240:243], v239 offset:6144
    v_cvt_pk_bf16_f32 v171, v158, v159
    v_mfma_f32_16x16x16_bf16 v[160:163], v[28:29], v[142:143], v[160:163]
    ds_read_b128 v[156:159], v234
    v_bfe_u32 v234, s70, v233, 4
    v_mfma_f32_16x16x32_bf16 v[196:199], a[216:219], v[168:171], v[196:199]
    v_mad_u32_u24 v234, v234, s40, v231
    v_mfma_f32_16x16x32_bf16 v[184:187], v[66:69], v[168:171], v[184:187]
    v_mfma_f32_16x16x32_bf16 v[188:191], v[88:91], v[168:171], v[188:191]
    v_mfma_f32_16x16x32_bf16 v[192:195], v[110:113], v[168:171], v[192:195]
    v_mfma_f32_16x16x16_bf16 v[164:167], v[34:35], v[142:143], v[164:167]
    v_exp_f32 v160, v160
    v_mfma_f32_16x16x16_bf16 v[144:147], v[40:41], v[142:143], v[144:147]
    v_exp_f32 v161, v161
    v_mfma_f32_16x16x32_bf16 v[148:151], v[42:45], v[138:141], v[148:151]
    v_rcp_f32 v197, v196
    v_mfma_f32_16x16x32_bf16 v[152:155], v[48:51], v[138:141], v[152:155]
    v_mul_f32 v184, v184, v197
    v_mul_f32 v185, v185, v197
    v_mfma_f32_16x16x32_bf16 v[216:219], a[20:23], a[244:247], v[216:219]
    v_cvt_pk_bf16_f32 v184, v184, v185
    v_mul_f32 v186, v186, v197
    v_mfma_f32_16x16x16_bf16 v[148:151], v[46:47], v[142:143], v[148:151]
    v_mul_f32 v187, v187, v197
    v_cvt_pk_bf16_f32 v185, v186, v187
    v_mfma_f32_16x16x16_bf16 v[152:155], v[52:53], v[142:143], v[152:155]
    s_waitcnt lgkmcnt(0)
    v_mul_f32 v188, v188, v197
    v_mul_f32 v189, v189, v197
    v_mfma_f32_16x16x32_bf16 v[156:159], v[54:57], v[138:141], v[156:159]
    v_cvt_pk_bf16_f32 v186, v188, v189
    v_mul_f32 v190, v190, v197
    v_mfma_f32_16x16x32_bf16 v[220:223], a[244:247], a[84:87], v[220:223]
    v_mul_f32 v191, v191, v197
    v_cvt_pk_bf16_f32 v187, v190, v191
    v_mfma_f32_16x16x32_bf16 v[176:179], a[244:247], a[88:91], v[176:179]
    v_mul_f32 v192, v192, v197
    v_mul_f32 v193, v193, v197
    v_mfma_f32_16x16x16_bf16 v[156:159], v[58:59], v[142:143], v[156:159]
    v_cvt_pk_bf16_f32 v188, v192, v193
    v_mul_f32 v194, v194, v197
    v_mfma_f32_16x16x32_bf16 v[180:183], a[244:247], a[92:95], v[180:183]
    ds_read_b128 a[244:247], v239 offset:1024
    v_mul_f32 v195, v195, v197
    v_mfma_f32_16x16x32_bf16 v[208:211], a[24:27], a[248:251], v[208:211]
    v_cvt_pk_bf16_f32 v189, v194, v195
    v_max3_f32 v250, v250, v196, v197
    v_mfma_f32_16x16x32_bf16 v[212:215], a[28:31], a[248:251], v[212:215]
    ds_write_b128 v237, v[184:187] offset:12288
    v_mfma_f32_16x16x32_bf16 v[216:219], a[32:35], a[248:251], v[216:219]
    ds_write_b64 v238, v[188:189] offset:12288
    v_mfma_f32_16x16x32_bf16 v[220:223], a[248:251], a[96:99], v[220:223]
    v_exp_f32 v162, v162
    v_mfma_f32_16x16x32_bf16 v[176:179], a[248:251], a[100:103], v[176:179]
    v_exp_f32 v163, v163
    v_mfma_f32_16x16x32_bf16 v[180:183], a[248:251], a[104:107], v[180:183]
    ds_read_b128 a[248:251], v239 offset:7168
    v_cvt_pk_bf16_f32 v172, v160, v161
    v_mfma_f32_16x16x32_bf16 v[208:211], a[36:39], a[252:255], v[208:211]
    v_cvt_pk_bf16_f32 v173, v162, v163
    v_mfma_f32_16x16x32_bf16 v[212:215], a[40:43], a[252:255], v[212:215]
    ds_read_b128 v[160:163], v235
    v_bfe_u32 v235, s71, v233, 4
    v_mfma_f32_16x16x32_bf16 v[216:219], a[44:47], a[252:255], v[216:219]
    v_mad_u32_u24 v235, v235, s40, v231
    v_mfma_f32_16x16x32_bf16 v[220:223], a[252:255], a[108:111], v[220:223]
    v_exp_f32 v164, v164
    v_mfma_f32_16x16x32_bf16 v[176:179], a[252:255], a[112:115], v[176:179]
    v_exp_f32 v165, v165
    v_mfma_f32_16x16x32_bf16 v[180:183], a[252:255], a[116:119], v[180:183]
    ds_read_b64_tr_b16 a[252:253], v240 offset:12288
    ds_read_b64_tr_b16 a[254:255], v240 offset:26112
    v_mfma_f32_16x16x32_bf16 v[208:211], a[48:51], v[252:255], v[208:211]
    v_exp_f32 v166, v166
    v_mfma_f32_16x16x32_bf16 v[212:215], a[52:55], v[252:255], v[212:215]
    v_exp_f32 v167, v167
    v_mfma_f32_16x16x32_bf16 v[216:219], a[56:59], v[252:255], v[216:219]
    v_cvt_pk_bf16_f32 v174, v164, v165
    v_cvt_pk_bf16_f32 v175, v166, v167
    v_mfma_f32_16x16x32_bf16 v[220:223], v[252:255], a[120:123], v[220:223]
    ds_read_b128 v[164:167], v228 offset:640
    v_mfma_f32_16x16x32_bf16 v[196:199], a[216:219], v[172:175], 0
    v_exp_f32 v144, v144
    v_mfma_f32_16x16x32_bf16 v[184:187], v[68:71], v[172:175], 0
    v_exp_f32 v145, v145
    v_mfma_f32_16x16x32_bf16 v[188:191], v[90:93], v[172:175], 0
    v_exp_f32 v146, v146
    v_mfma_f32_16x16x32_bf16 v[192:195], v[112:115], v[172:175], 0
    v_exp_f32 v147, v147
    v_mfma_f32_16x16x32_bf16 v[176:179], v[252:255], a[124:127], v[176:179]
    v_cvt_pk_bf16_f32 v168, v144, v145
    v_cvt_pk_bf16_f32 v169, v146, v147
    v_mfma_f32_16x16x32_bf16 v[180:183], v[252:255], a[128:131], v[180:183]
    ds_read_b64_tr_b16 v[252:253], v240 offset:12296
    ds_read_b64_tr_b16 v[254:255], v240 offset:26120
    v_mfma_f32_16x16x32_bf16 v[208:211], a[60:63], a[232:235], v[208:211]
    ds_read_b128 v[144:147], v229 offset:640
    v_mfma_f32_16x16x32_bf16 v[212:215], a[64:67], a[232:235], v[212:215]
    v_exp_f32 v148, v148
    v_mfma_f32_16x16x32_bf16 v[216:219], a[68:71], a[232:235], v[216:219]
    v_exp_f32 v149, v149
    v_mfma_f32_16x16x32_bf16 v[220:223], a[232:235], a[132:135], v[220:223]
    v_exp_f32 v150, v150
    v_mfma_f32_16x16x32_bf16 v[176:179], a[232:235], a[136:139], v[176:179]
    v_cvt_pk_bf16_f32 v60, v208, v209
    v_cvt_pk_bf16_f32 v61, v210, v211
    v_mfma_f32_16x16x32_bf16 v[180:183], a[232:235], a[140:143], v[180:183]
    v_cvt_pk_bf16_f32 v62, v212, v213
    v_cvt_pk_bf16_f32 v63, v214, v215
    v_mfma_f32_16x16x32_bf16 v[200:203], a[220:223], a[236:239], 0
    s_waitcnt lgkmcnt(3)
    v_cvt_pk_bf16_f32 v64, v216, v217
    v_cvt_pk_bf16_f32 v65, v218, v219
    v_mfma_f32_16x16x32_bf16 v[160:163], v[60:63], v[138:141], v[160:163]
    v_cvt_pk_bf16_f32 v86, v220, v221
    v_cvt_pk_bf16_f32 v87, v222, v223
    v_mfma_f32_16x16x32_bf16 v[212:215], a[220:223], a[240:243], 0
    v_cvt_pk_bf16_f32 v108, v176, v177
    v_cvt_pk_bf16_f32 v109, v178, v179
    v_mfma_f32_16x16x32_bf16 v[204:207], a[224:227], a[236:239], 0
    v_cvt_pk_bf16_f32 v130, v180, v181
    v_cvt_pk_bf16_f32 v131, v182, v183
    v_mfma_f32_16x16x16_bf16 v[160:163], v[64:65], v[142:143], v[160:163]
    ds_read_b64_tr_b16 a[232:233], v241 offset:12288
    ds_read_b64_tr_b16 a[234:235], v241 offset:26112
    v_mfma_f32_16x16x32_bf16 v[216:219], a[224:227], a[240:243], 0
    v_exp_f32 v151, v151
    v_mfma_f32_16x16x32_bf16 v[208:211], a[228:231], a[236:239], 0
    ds_read_b128 a[236:239], v239 offset:2048
    v_cvt_pk_bf16_f32 v170, v148, v149
    v_mfma_f32_16x16x32_bf16 v[220:223], a[228:231], a[240:243], 0
    ds_read_b128 a[240:243], v239 offset:8192
    v_cvt_pk_bf16_f32 v171, v150, v151
    v_mfma_f32_16x16x32_bf16 v[200:203], a[252:255], a[244:247], v[200:203]
    ds_read_b128 v[148:151], v229 offset:1280
    v_mfma_f32_16x16x32_bf16 v[196:199], a[216:219], v[168:171], v[196:199]
    v_exp_f32 v152, v152
    v_mfma_f32_16x16x32_bf16 v[184:187], v[76:79], v[168:171], v[184:187]
    v_exp_f32 v153, v153
    v_mfma_f32_16x16x32_bf16 v[188:191], v[98:101], v[168:171], v[188:191]
    v_exp_f32 v154, v154
    v_mfma_f32_16x16x32_bf16 v[192:195], v[120:123], v[168:171], v[192:195]
    v_exp_f32 v155, v155
    v_mfma_f32_16x16x32_bf16 v[212:215], a[252:255], a[248:251], v[212:215]
    s_waitcnt lgkmcnt(4)
    ds_read_b64_tr_b16 a[252:253], v241 offset:13824
    ds_read_b64_tr_b16 a[254:255], v241 offset:24576
    v_mfma_f32_16x16x32_bf16 v[204:207], v[252:255], a[244:247], v[204:207]
    v_cvt_pk_bf16_f32 v172, v152, v153
    v_cvt_pk_bf16_f32 v173, v154, v155
    v_mfma_f32_16x16x32_bf16 v[216:219], v[252:255], a[248:251], v[216:219]
    s_waitcnt lgkmcnt(5)
    ds_read_b128 v[252:255], v239 offset:3072
    ds_read_b128 v[152:155], v228 offset:1280
    v_mfma_f32_16x16x32_bf16 v[208:211], a[232:235], a[244:247], v[208:211]
    ds_read_b64_tr_b16 a[244:245], v240 offset:13824
    v_mfma_f32_16x16x32_bf16 v[220:223], a[232:235], a[248:251], v[220:223]
    s_waitcnt lgkmcnt(3)
    ds_read_b64_tr_b16 a[246:247], v240 offset:24576
    v_exp_f32 v156, v156
    v_exp_f32 v157, v157
    ds_read_b64_tr_b16 a[248:249], v240 offset:13832
    ds_read_b64_tr_b16 a[250:251], v240 offset:24584
    v_exp_f32 v158, v158
    v_exp_f32 v159, v159
    ds_read_b128 a[232:235], v239 offset:9216
    v_mfma_f32_16x16x32_bf16 v[208:211], a[252:255], a[236:239], v[208:211]
    v_cvt_pk_bf16_f32 v174, v156, v157
    v_cvt_pk_bf16_f32 v175, v158, v159
    v_mfma_f32_16x16x32_bf16 v[220:223], a[252:255], a[240:243], v[220:223]
    ds_read_b128 a[252:255], v239 offset:10240
    ds_read_b128 v[156:159], v228 offset:1920
    v_mfma_f32_16x16x32_bf16 v[196:199], a[216:219], v[172:175], v[196:199]
    v_exp_f32 v160, v160
    v_mfma_f32_16x16x32_bf16 v[184:187], v[82:85], v[172:175], v[184:187]
    v_exp_f32 v161, v161
    v_mfma_f32_16x16x32_bf16 v[188:191], v[104:107], v[172:175], v[188:191]
    v_exp_f32 v162, v162
    v_mfma_f32_16x16x32_bf16 v[192:195], v[126:129], v[172:175], v[192:195]
    s_waitcnt lgkmcnt(5)
    v_exp_f32 v163, v163
    v_mfma_f32_16x16x32_bf16 v[200:203], a[244:247], a[236:239], v[200:203]
    v_cvt_pk_bf16_f32 v168, v160, v161
    v_cvt_pk_bf16_f32 v169, v162, v163
    v_mfma_f32_16x16x32_bf16 v[212:215], a[244:247], a[240:243], v[212:215]
    ds_read_b64_tr_b16 a[244:245], v241 offset:36864
    ds_read_b64_tr_b16 a[246:247], v241 offset:38400
    v_mfma_f32_16x16x16_bf16 v[196:199], a[216:217], v[168:169], v[196:199]
    ds_read_b128 v[160:163], v229 offset:1920
    v_mfma_f32_16x16x16_bf16 v[184:187], v[86:87], v[168:169], v[184:187]
    v_mfma_f32_16x16x16_bf16 v[188:191], v[108:109], v[168:169], v[188:191]
    v_mfma_f32_16x16x16_bf16 v[192:195], v[130:131], v[168:169], v[192:195]
    s_waitcnt lgkmcnt(4)
    v_mfma_f32_16x16x32_bf16 v[204:207], a[248:251], a[236:239], v[204:207]
    ds_read_b64_tr_b16 a[236:237], v240 offset:36864
    ds_read_b64_tr_b16 a[238:239], v240 offset:38400
    v_mfma_f32_16x16x32_bf16 v[216:219], a[248:251], a[240:243], v[216:219]
    s_waitcnt lgkmcnt(3)
    ds_read_b64_tr_b16 a[240:241], v240 offset:36872
    ds_read_b64_tr_b16 a[242:243], v240 offset:38408
    v_rcp_f32 v197, v196
    ds_read_b128 a[248:251], v239 offset:4096
    v_mul_f32 v184, v184, v197
    v_mfma_f32_16x16x32_bf16 v[208:211], a[244:247], v[252:255], v[208:211]
    v_mul_f32 v185, v185, v197
    v_cvt_pk_bf16_f32 v184, v184, v185
    v_mfma_f32_16x16x32_bf16 v[220:223], a[244:247], a[232:235], v[220:223]
    s_waitcnt lgkmcnt(3)
    ds_read_b128 a[244:247], v239 offset:11264
    v_mul_f32 v186, v186, v197
    v_mul_f32 v187, v187, v197
    v_cvt_pk_bf16_f32 v185, v186, v187
    v_mul_f32 v188, v188, v197
    v_mul_f32 v189, v189, v197
    v_cvt_pk_bf16_f32 v186, v188, v189
    v_mul_f32 v190, v190, v197
    v_mul_f32 v191, v191, v197
    v_cvt_pk_bf16_f32 v187, v190, v191
    v_mul_f32 v192, v192, v197
    v_mul_f32 v193, v193, v197
    v_cvt_pk_bf16_f32 v188, v192, v193
    v_mul_f32 v194, v194, v197
    v_mul_f32 v195, v195, v197
    v_cvt_pk_bf16_f32 v189, v194, v195
    v_max3_f32 v250, v250, v196, v197
    ds_write_b128 v237, v[184:187] offset:18432
    v_mfma_f32_16x16x32_bf16 v[200:203], a[236:239], v[252:255], v[200:203]
    ds_write_b64 v238, v[188:189] offset:18432
    v_mfma_f32_16x16x32_bf16 v[212:215], a[236:239], a[232:235], v[212:215]
    s_waitcnt lgkmcnt(4)
    ds_read_b64_tr_b16 a[236:237], v241 offset:49152
    ds_read_b64_tr_b16 a[238:239], v241 offset:62976
    v_mfma_f32_16x16x32_bf16 v[204:207], a[240:243], v[252:255], v[204:207]
    ds_read_b64_tr_b16 v[252:253], v240 offset:49152
    ds_read_b64_tr_b16 v[254:255], v240 offset:62976
    v_mfma_f32_16x16x32_bf16 v[216:219], a[240:243], a[232:235], v[216:219]
    s_waitcnt lgkmcnt(2)
    ds_read_b64_tr_b16 a[232:233], v240 offset:49160
    ds_read_b64_tr_b16 a[234:235], v240 offset:62984
    ds_read_b128 a[240:243], v239 offset:5120
    v_mfma_f32_16x16x32_bf16 v[208:211], a[236:239], a[248:251], v[208:211]
    v_mfma_f32_16x16x32_bf16 v[220:223], a[236:239], a[252:255], v[220:223]
    s_waitcnt lgkmcnt(3)
    ds_read_b128 a[236:239], v226 offset:1216
    v_mfma_f32_16x16x32_bf16 v[200:203], v[252:255], a[248:251], v[200:203]
    v_mfma_f32_16x16x32_bf16 v[212:215], v[252:255], a[252:255], v[212:215]
    s_waitcnt lgkmcnt(2)
    ds_read_b64_tr_b16 v[252:253], v241 offset:50688
    ds_read_b64_tr_b16 v[254:255], v241 offset:61440
    v_mfma_f32_16x16x32_bf16 v[204:207], a[232:235], a[248:251], v[204:207]
    ds_read_b64_tr_b16 a[248:249], v240 offset:50688
    ds_read_b64_tr_b16 a[250:251], v240 offset:61440
    v_mfma_f32_16x16x32_bf16 v[216:219], a[232:235], a[252:255], v[216:219]
    s_waitcnt lgkmcnt(2)
    ds_read_b64_tr_b16 a[252:253], v240 offset:50696
    ds_read_b64_tr_b16 a[254:255], v240 offset:61448
    ds_read_b128 a[232:235], v226 offset:1152
    v_mfma_f32_16x16x32_bf16 v[208:211], v[252:255], a[240:243], v[208:211]
    v_mfma_f32_16x16x32_bf16 v[220:223], v[252:255], a[244:247], v[220:223]
    s_waitcnt lgkmcnt(3)
    ds_read_b128 v[252:255], v224 offset:15488
    v_mfma_f32_16x16x32_bf16 v[200:203], a[248:251], a[240:243], v[200:203]
    v_mfma_f32_16x16x32_bf16 v[212:215], a[248:251], a[244:247], v[212:215]
    s_waitcnt lgkmcnt(2)
    ds_read_b128 a[248:251], v226 offset:1408
    v_mfma_f32_16x16x32_bf16 v[204:207], a[252:255], a[240:243], v[204:207]
    ds_read_b128 a[240:243], v226 offset:1280
    v_mfma_f32_16x16x32_bf16 v[216:219], a[252:255], a[244:247], v[216:219]
    s_waitcnt lgkmcnt(3)
    ds_read_b128 a[244:247], v226 offset:1344
    v_cvt_pk_bf16_f32 v208, v208, v209
    v_mfma_f32_16x16x32_bf16 v[176:179], a[144:147], a[232:235], 0
    v_cvt_pk_bf16_f32 v200, v200, v201
    v_cvt_pk_bf16_f32 v201, v202, v203
    v_mfma_f32_16x16x32_bf16 v[180:183], a[148:151], a[232:235], 0
    v_cvt_pk_bf16_f32 v202, v204, v205
    v_cvt_pk_bf16_f32 v203, v206, v207
    v_mfma_f32_16x16x32_bf16 v[176:179], a[156:159], a[236:239], v[176:179]
    buffer_store_dwordx4 v[200:203], v242, s[20:23], s58 offen sc0 sc1
    v_mfma_f32_16x16x32_bf16 v[180:183], a[160:163], a[236:239], v[180:183]
    v_cvt_pk_bf16_f32 v209, v210, v211
    v_cvt_pk_bf16_f32 v212, v212, v213
    v_mfma_f32_16x16x32_bf16 v[200:203], a[152:155], a[232:235], 0
    s_waitcnt lgkmcnt(1)
    buffer_store_dwordx2 v[208:209], v243, s[20:23], s58 offen sc0 sc1
    v_mfma_f32_16x16x32_bf16 v[200:203], a[164:167], a[236:239], v[200:203]
    s_add_u32 s58, s51, 0x54000
    v_cvt_pk_bf16_f32 v213, v214, v215
    v_cvt_pk_bf16_f32 v214, v216, v217
    v_mfma_f32_16x16x32_bf16 v[176:179], a[168:171], a[240:243], v[176:179]
    v_cvt_pk_bf16_f32 v215, v218, v219
    v_cvt_pk_bf16_f32 v220, v220, v221
    v_mfma_f32_16x16x32_bf16 v[180:183], a[172:175], a[240:243], v[180:183]
    buffer_store_dwordx4 v[212:215], v244, s[20:23], s59 offen sc0 sc1
    v_mfma_f32_16x16x32_bf16 v[200:203], a[176:179], a[240:243], v[200:203]
    s_waitcnt lgkmcnt(0)
    ds_read_b128 a[252:255], v226 offset:1472
    v_cvt_pk_bf16_f32 v221, v222, v223
    v_mfma_f32_16x16x32_bf16 v[176:179], a[180:183], a[244:247], v[176:179]
    buffer_store_dwordx2 v[220:221], v245, s[20:23], s59 offen sc0 sc1
    v_mfma_f32_16x16x32_bf16 v[180:183], a[184:187], a[244:247], v[180:183]
    s_add_u32 s59, s51, 0x55800
    ds_read_b128 a[232:235], v224 offset:15552
    ds_read_b128 a[236:239], v224 offset:15616
    v_mfma_f32_16x16x32_bf16 v[200:203], a[188:191], a[244:247], v[200:203]
    ds_read_b128 a[240:243], v224 offset:15680
    ds_read_b128 a[244:247], v224 offset:15744
    v_mfma_f32_16x16x32_bf16 v[176:179], a[192:195], a[248:251], v[176:179]
    v_mfma_f32_16x16x32_bf16 v[180:183], a[196:199], a[248:251], v[180:183]
    v_mfma_f32_16x16x32_bf16 v[200:203], a[200:203], a[248:251], v[200:203]
    ds_read_b128 a[248:251], v224 offset:15808
    v_mfma_f32_16x16x32_bf16 v[204:207], a[0:3], v[252:255], 0
    v_mfma_f32_16x16x32_bf16 v[208:211], a[4:7], v[252:255], 0
    s_waitcnt lgkmcnt(5)
    v_mfma_f32_16x16x32_bf16 v[176:179], a[204:207], a[252:255], v[176:179]
    v_mfma_f32_16x16x32_bf16 v[180:183], a[208:211], a[252:255], v[180:183]
    v_mfma_f32_16x16x32_bf16 v[200:203], a[212:215], a[252:255], v[200:203]
    ds_read_b128 a[252:255], v224 offset:18560
    v_mfma_f32_16x16x32_bf16 v[212:215], a[8:11], v[252:255], 0
    v_mfma_f32_16x16x32_bf16 v[216:219], v[252:255], a[72:75], 0
    v_mfma_f32_16x16x32_bf16 v[220:223], v[252:255], a[76:79], 0
    s_waitcnt lgkmcnt(3)
    v_mfma_f32_16x16x32_bf16 v[204:207], a[12:15], a[232:235], v[204:207]
    v_mfma_f32_16x16x32_bf16 v[208:211], a[16:19], a[232:235], v[208:211]
    v_mul_f32 v176, s37, v176
    v_mul_f32 v177, s37, v177
    v_mfma_f32_16x16x32_bf16 v[212:215], a[20:23], a[232:235], v[212:215]
    v_mul_f32 v178, s37, v178
    v_mul_f32 v179, s37, v179
    v_mfma_f32_16x16x32_bf16 v[216:219], a[232:235], a[84:87], v[216:219]
    v_cvt_pk_bf16_f32 v132, v176, v177
    v_cvt_pk_bf16_f32 v133, v178, v179
    v_mfma_f32_16x16x32_bf16 v[176:179], v[252:255], a[80:83], 0
    v_mul_f32 v180, s37, v180
    v_mul_f32 v181, s37, v181
    v_mfma_f32_16x16x32_bf16 v[220:223], a[232:235], a[88:91], v[220:223]
    v_mul_f32 v182, s37, v182
    v_mul_f32 v183, s37, v183
    v_mfma_f32_16x16x32_bf16 v[176:179], a[232:235], a[92:95], v[176:179]
    v_cvt_pk_bf16_f32 v134, v180, v181
    v_cvt_pk_bf16_f32 v135, v182, v183
    v_mfma_f32_16x16x32_bf16 v[204:207], a[24:27], a[236:239], v[204:207]
    v_mul_f32 v200, s37, v200
    v_mul_f32 v201, s37, v201
    v_mfma_f32_16x16x32_bf16 v[164:167], v[12:15], v[132:135], v[164:167]
    v_mul_f32 v202, s37, v202
    v_mul_f32 v203, s37, v203
    v_mfma_f32_16x16x32_bf16 v[144:147], v[36:39], v[132:135], v[144:147]
    v_cvt_pk_bf16_f32 v136, v200, v201
    v_cvt_pk_bf16_f32 v137, v202, v203
    v_mfma_f32_16x16x32_bf16 v[148:151], v[42:45], v[132:135], v[148:151]
    ds_read_b128 v[252:255], v224 offset:18624
    ds_read_b128 a[232:235], v224 offset:18688
    v_mfma_f32_16x16x16_bf16 v[164:167], v[16:17], v[136:137], v[164:167]
    v_mfma_f32_16x16x16_bf16 v[144:147], v[40:41], v[136:137], v[144:147]
    v_mfma_f32_16x16x32_bf16 v[152:155], v[18:21], v[132:135], v[152:155]
    v_mfma_f32_16x16x32_bf16 v[156:159], v[0:3], v[132:135], v[156:159]
    v_mfma_f32_16x16x16_bf16 v[148:151], v[46:47], v[136:137], v[148:151]
    v_mfma_f32_16x16x32_bf16 v[160:163], v[24:27], v[132:135], v[160:163]
    v_mfma_f32_16x16x32_bf16 v[208:211], a[28:31], a[236:239], v[208:211]
    v_mfma_f32_16x16x32_bf16 v[212:215], a[32:35], a[236:239], v[212:215]
    v_mfma_f32_16x16x32_bf16 v[216:219], a[236:239], a[96:99], v[216:219]
    v_exp_f32 v164, v164
    v_mfma_f32_16x16x16_bf16 v[152:155], v[22:23], v[136:137], v[152:155]
    v_exp_f32 v165, v165
    v_mfma_f32_16x16x16_bf16 v[156:159], v[4:5], v[136:137], v[156:159]
    v_exp_f32 v166, v166
    v_mfma_f32_16x16x16_bf16 v[160:163], v[28:29], v[136:137], v[160:163]
    v_exp_f32 v167, v167
    v_mfma_f32_16x16x32_bf16 v[220:223], a[236:239], a[100:103], v[220:223]
    v_cvt_pk_bf16_f32 v172, v164, v165
    v_cvt_pk_bf16_f32 v173, v166, v167
    v_mfma_f32_16x16x32_bf16 v[176:179], a[236:239], a[104:107], v[176:179]
    ds_read_b128 a[236:239], v224 offset:18752
    ds_read_b128 v[164:167], v229 offset:2560
    v_mfma_f32_16x16x32_bf16 v[204:207], a[36:39], a[240:243], v[204:207]
    v_exp_f32 v144, v144
    v_mfma_f32_16x16x32_bf16 v[208:211], a[40:43], a[240:243], v[208:211]
    v_exp_f32 v145, v145
    v_mfma_f32_16x16x32_bf16 v[212:215], a[44:47], a[240:243], v[212:215]
    v_exp_f32 v146, v146
    v_mfma_f32_16x16x32_bf16 v[216:219], a[240:243], a[108:111], v[216:219]
    v_exp_f32 v147, v147
    v_mfma_f32_16x16x32_bf16 v[220:223], a[240:243], a[112:115], v[220:223]
    v_cvt_pk_bf16_f32 v174, v144, v145
    v_cvt_pk_bf16_f32 v175, v146, v147
    v_mfma_f32_16x16x32_bf16 v[176:179], a[240:243], a[116:119], v[176:179]
    ds_read_b128 a[240:243], v224 offset:18816
    ds_read_b128 v[144:147], v228 offset:2560
    v_mfma_f32_16x16x32_bf16 v[196:199], a[216:219], v[172:175], 0
    v_exp_f32 v148, v148
    v_mfma_f32_16x16x32_bf16 v[184:187], v[74:77], v[172:175], 0
    v_exp_f32 v149, v149
    v_mfma_f32_16x16x32_bf16 v[188:191], v[96:99], v[172:175], 0
    v_exp_f32 v150, v150
    v_mfma_f32_16x16x32_bf16 v[192:195], v[118:121], v[172:175], 0
    s_waitcnt lgkmcnt(3)
    v_exp_f32 v151, v151
    v_mfma_f32_16x16x32_bf16 v[204:207], a[48:51], a[244:247], v[204:207]
    v_cvt_pk_bf16_f32 v168, v148, v149
    v_cvt_pk_bf16_f32 v169, v150, v151
    v_mfma_f32_16x16x32_bf16 v[208:211], a[52:55], a[244:247], v[208:211]
    ds_read_b128 v[148:151], v230 offset:640
    v_mfma_f32_16x16x32_bf16 v[212:215], a[56:59], a[244:247], v[212:215]
    v_exp_f32 v152, v152
    v_mfma_f32_16x16x32_bf16 v[216:219], a[244:247], a[120:123], v[216:219]
    v_exp_f32 v153, v153
    v_mfma_f32_16x16x32_bf16 v[220:223], a[244:247], a[124:127], v[220:223]
    v_exp_f32 v154, v154
    v_mfma_f32_16x16x32_bf16 v[176:179], a[244:247], a[128:131], v[176:179]
    ds_read_b128 a[244:247], v224 offset:18880
    v_cvt_pk_bf16_f32 v170, v152, v153
    v_mfma_f32_16x16x32_bf16 v[204:207], a[60:63], a[248:251], v[204:207]
    v_exp_f32 v155, v155
    v_mfma_f32_16x16x32_bf16 v[208:211], a[64:67], a[248:251], v[208:211]
    v_cvt_pk_bf16_f32 v171, v154, v155
    v_mfma_f32_16x16x32_bf16 v[212:215], a[68:71], a[248:251], v[212:215]
    ds_read_b128 v[152:155], v230 offset:1280
    v_mfma_f32_16x16x32_bf16 v[196:199], a[216:219], v[168:171], v[196:199]
    v_exp_f32 v156, v156
    v_mfma_f32_16x16x32_bf16 v[184:187], v[78:81], v[168:171], v[184:187]
    v_cvt_pk_bf16_f32 v6, v204, v205
    v_cvt_pk_bf16_f32 v7, v206, v207
    v_mfma_f32_16x16x32_bf16 v[188:191], v[100:103], v[168:171], v[188:191]
    v_cvt_pk_bf16_f32 v8, v208, v209
    v_cvt_pk_bf16_f32 v9, v210, v211
    v_mfma_f32_16x16x32_bf16 v[192:195], v[122:125], v[168:171], v[192:195]
    s_waitcnt lgkmcnt(2)
    v_cvt_pk_bf16_f32 v10, v212, v213
    v_cvt_pk_bf16_f32 v11, v214, v215
    v_mfma_f32_16x16x32_bf16 v[144:147], v[6:9], v[132:135], v[144:147]
    v_exp_f32 v157, v157
    v_mfma_f32_16x16x32_bf16 v[216:219], a[248:251], a[132:135], v[216:219]
    v_exp_f32 v158, v158
    v_mfma_f32_16x16x32_bf16 v[220:223], a[248:251], a[136:139], v[220:223]
    v_exp_f32 v159, v159
    v_mfma_f32_16x16x32_bf16 v[176:179], a[248:251], a[140:143], v[176:179]
    ds_read_b128 a[248:251], v226 offset:4224
    v_cvt_pk_bf16_f32 v172, v156, v157
    v_mfma_f32_16x16x16_bf16 v[144:147], v[10:11], v[136:137], v[144:147]
    v_cvt_pk_bf16_f32 v173, v158, v159
    v_cvt_pk_bf16_f32 v72, v216, v217
    v_mfma_f32_16x16x32_bf16 v[180:183], a[0:3], a[252:255], 0
    v_cvt_pk_bf16_f32 v73, v218, v219
    v_cvt_pk_bf16_f32 v94, v220, v221
    v_mfma_f32_16x16x32_bf16 v[200:203], a[4:7], a[252:255], 0
    v_cvt_pk_bf16_f32 v95, v222, v223
    v_cvt_pk_bf16_f32 v116, v176, v177
    v_mfma_f32_16x16x32_bf16 v[204:207], a[8:11], a[252:255], 0
    ds_read_b128 v[156:159], v230 offset:1920
    v_cvt_pk_bf16_f32 v117, v178, v179
    v_mfma_f32_16x16x32_bf16 v[208:211], a[252:255], a[72:75], 0
    v_exp_f32 v160, v160
    v_mfma_f32_16x16x32_bf16 v[212:215], a[252:255], a[76:79], 0
    v_exp_f32 v161, v161
    v_mfma_f32_16x16x32_bf16 v[216:219], a[252:255], a[80:83], 0
    ds_read_b128 a[252:255], v226 offset:4288
    v_cvt_pk_bf16_f32 v174, v160, v161
    v_mfma_f32_16x16x32_bf16 v[180:183], a[12:15], v[252:255], v[180:183]
    v_exp_f32 v162, v162
    v_mfma_f32_16x16x32_bf16 v[200:203], a[16:19], v[252:255], v[200:203]
    v_exp_f32 v163, v163
    v_mfma_f32_16x16x32_bf16 v[204:207], a[20:23], v[252:255], v[204:207]
    v_cvt_pk_bf16_f32 v175, v162, v163
    v_mfma_f32_16x16x32_bf16 v[208:211], v[252:255], a[84:87], v[208:211]
    ds_read_b128 v[160:163], v230 offset:2560
    v_mfma_f32_16x16x32_bf16 v[196:199], a[216:219], v[172:175], v[196:199]
    v_exp_f32 v144, v144
    v_mfma_f32_16x16x32_bf16 v[184:187], v[66:69], v[172:175], v[184:187]
    v_exp_f32 v145, v145
    v_mfma_f32_16x16x32_bf16 v[188:191], v[88:91], v[172:175], v[188:191]
    v_exp_f32 v146, v146
    v_mfma_f32_16x16x32_bf16 v[192:195], v[110:113], v[172:175], v[192:195]
    v_exp_f32 v147, v147
    v_mfma_f32_16x16x32_bf16 v[212:215], v[252:255], a[88:91], v[212:215]
    v_cvt_pk_bf16_f32 v170, v144, v145
    v_cvt_pk_bf16_f32 v171, v146, v147
    v_mfma_f32_16x16x32_bf16 v[216:219], v[252:255], a[92:95], v[216:219]
    ds_read_b128 v[252:255], v226 offset:4352
    ds_read_b128 v[144:147], v234
    v_mfma_f32_16x16x32_bf16 v[180:183], a[24:27], a[232:235], v[180:183]
    v_bfe_u32 v234, s72, v233, 4
    v_mad_u32_u24 v234, v234, s40, v231
    v_mfma_f32_16x16x32_bf16 v[200:203], a[28:31], a[232:235], v[200:203]
    v_mfma_f32_16x16x32_bf16 v[204:207], a[32:35], a[232:235], v[204:207]
    v_mfma_f32_16x16x32_bf16 v[208:211], a[232:235], a[96:99], v[208:211]
    v_mfma_f32_16x16x32_bf16 v[212:215], a[232:235], a[100:103], v[212:215]
    v_mfma_f32_16x16x32_bf16 v[216:219], a[232:235], a[104:107], v[216:219]
    ds_read_b128 a[232:235], v226 offset:4416
    v_mfma_f32_16x16x32_bf16 v[180:183], a[36:39], a[236:239], v[180:183]
    v_mfma_f32_16x16x32_bf16 v[200:203], a[40:43], a[236:239], v[200:203]
    v_mfma_f32_16x16x32_bf16 v[204:207], a[44:47], a[236:239], v[204:207]
    v_mfma_f32_16x16x32_bf16 v[208:211], a[236:239], a[108:111], v[208:211]
    v_mfma_f32_16x16x32_bf16 v[212:215], a[236:239], a[112:115], v[212:215]
    v_mfma_f32_16x16x32_bf16 v[216:219], a[236:239], a[116:119], v[216:219]
    ds_read_b128 a[236:239], v226 offset:4480
    v_mfma_f32_16x16x32_bf16 v[180:183], a[48:51], a[240:243], v[180:183]
    v_mfma_f32_16x16x32_bf16 v[200:203], a[52:55], a[240:243], v[200:203]
    v_mfma_f32_16x16x32_bf16 v[204:207], a[56:59], a[240:243], v[204:207]
    v_mfma_f32_16x16x32_bf16 v[208:211], a[240:243], a[120:123], v[208:211]
    v_mfma_f32_16x16x32_bf16 v[212:215], a[240:243], a[124:127], v[212:215]
    v_mfma_f32_16x16x32_bf16 v[216:219], a[240:243], a[128:131], v[216:219]
    s_waitcnt lgkmcnt(1)
    ds_read_b128 a[240:243], v226 offset:4544
    v_mfma_f32_16x16x32_bf16 v[180:183], a[60:63], a[244:247], v[180:183]
    v_mfma_f32_16x16x32_bf16 v[200:203], a[64:67], a[244:247], v[200:203]
    v_mfma_f32_16x16x32_bf16 v[204:207], a[68:71], a[244:247], v[204:207]
    v_mfma_f32_16x16x32_bf16 v[208:211], a[244:247], a[132:135], v[208:211]
    v_mfma_f32_16x16x32_bf16 v[212:215], a[244:247], a[136:139], v[212:215]
    v_mfma_f32_16x16x32_bf16 v[216:219], a[244:247], a[140:143], v[216:219]
    v_mfma_f32_16x16x32_bf16 v[220:223], a[144:147], a[248:251], 0
    s_waitcnt vmcnt(4) lgkmcnt(0)
    v_mfma_f32_16x16x32_bf16 v[176:179], a[148:151], a[248:251], 0
    s_barrier
    v_cvt_pk_bf16_f32 v30, v180, v181
    v_mfma_f32_16x16x32_bf16 v[220:223], a[156:159], a[252:255], v[220:223]
    v_cvt_pk_bf16_f32 v31, v182, v183
    v_cvt_pk_bf16_f32 v32, v200, v201
    v_mfma_f32_16x16x32_bf16 v[180:183], a[152:155], a[248:251], 0
    v_cvt_pk_bf16_f32 v33, v202, v203
    v_cvt_pk_bf16_f32 v34, v204, v205
    v_mfma_f32_16x16x32_bf16 v[176:179], a[160:163], a[252:255], v[176:179]
    v_cvt_pk_bf16_f32 v35, v206, v207
    v_cvt_pk_bf16_f32 v70, v208, v209
    v_mfma_f32_16x16x32_bf16 v[164:167], v[30:33], v[132:135], v[164:167]
    v_cvt_pk_bf16_f32 v71, v210, v211
    v_cvt_pk_bf16_f32 v92, v212, v213
    v_mfma_f32_16x16x32_bf16 v[180:183], a[164:167], a[252:255], v[180:183]
    v_cvt_pk_bf16_f32 v93, v214, v215
    v_cvt_pk_bf16_f32 v114, v216, v217
    v_mfma_f32_16x16x32_bf16 v[220:223], a[168:171], v[252:255], v[220:223]
L_pg4:
    s_cbranch_execz L_pg8
    ds_read_b128 a[244:247], v239 offset:12288
    v_cvt_pk_bf16_f32 v115, v218, v219
    v_mfma_f32_16x16x16_bf16 v[164:167], v[34:35], v[136:137], v[164:167]
    buffer_load_dwordx4 v246, s[4:7], s56 offen lds
    v_mfma_f32_16x16x32_bf16 v[176:179], a[172:175], v[252:255], v[176:179]
    s_add_u32 m0, s42, 0xb580
    ds_read_b128 a[248:251], v239 offset:18432
    ds_read_b128 a[252:255], v239 offset:13312
    v_mfma_f32_16x16x32_bf16 v[180:183], a[176:179], v[252:255], v[180:183]
    buffer_load_dwordx4 v247, s[4:7], s56 offen lds
    v_mfma_f32_16x16x32_bf16 v[220:223], a[180:183], a[232:235], v[220:223]
    s_add_u32 s56, s39, 0x276000
    ds_read_b128 v[252:255], v239 offset:19456
    s_add_u32 m0, s41, 0xd3c0
    v_mfma_f32_16x16x32_bf16 v[176:179], a[184:187], a[232:235], v[176:179]
    buffer_load_dwordx4 v246, s[4:7], s56 offen lds
    v_mfma_f32_16x16x32_bf16 v[180:183], a[188:191], a[232:235], v[180:183]
    s_add_u32 m0, s42, 0xd3c0
    ds_read_b64_tr_b16 a[232:233], v240 offset:12288
    ds_read_b64_tr_b16 a[234:235], v240 offset:26112
    v_mfma_f32_16x16x32_bf16 v[220:223], a[192:195], a[236:239], v[220:223]
    buffer_load_dwordx4 v247, s[4:7], s56 offen lds
    v_mfma_f32_16x16x32_bf16 v[176:179], a[196:199], a[236:239], v[176:179]
    s_add_u32 s56, s39, 0x2a0000
    v_exp_f32 v164, v164
    v_mfma_f32_16x16x32_bf16 v[180:183], a[200:203], a[236:239], v[180:183]
    s_add_u32 m0, s41, 0
    ds_read_b64_tr_b16 a[236:237], v240 offset:12296
    ds_read_b64_tr_b16 a[238:239], v240 offset:26120
    v_mfma_f32_16x16x32_bf16 v[220:223], a[204:207], a[240:243], v[220:223]
    v_exp_f32 v165, v165
    v_mfma_f32_16x16x32_bf16 v[176:179], a[208:211], a[240:243], v[176:179]
    v_exp_f32 v166, v166
    v_mfma_f32_16x16x32_bf16 v[180:183], a[212:215], a[240:243], v[180:183]
    s_waitcnt lgkmcnt(6)
    ds_read_b64_tr_b16 a[240:241], v241 offset:12288
    ds_read_b64_tr_b16 a[242:243], v241 offset:26112
    v_mfma_f32_16x16x32_bf16 v[200:203], a[220:223], a[244:247], 0
    v_exp_f32 v167, v167
    v_mfma_f32_16x16x32_bf16 v[212:215], a[220:223], a[248:251], 0
    v_mul_f32 v220, s37, v220
    v_mul_f32 v221, s37, v221
    v_mfma_f32_16x16x32_bf16 v[204:207], a[224:227], a[244:247], 0
    v_mul_f32 v222, s37, v222
    v_mul_f32 v223, s37, v223
    v_mfma_f32_16x16x32_bf16 v[216:219], a[224:227], a[248:251], 0
    v_cvt_pk_bf16_f32 v138, v220, v221
    v_cvt_pk_bf16_f32 v139, v222, v223
    v_mfma_f32_16x16x32_bf16 v[208:211], a[228:231], a[244:247], 0
    v_mul_f32 v176, s37, v176
    v_mul_f32 v177, s37, v177
    v_mfma_f32_16x16x32_bf16 v[220:223], a[228:231], a[248:251], 0
    s_waitcnt lgkmcnt(4)
    v_mul_f32 v178, s37, v178
    v_mul_f32 v179, s37, v179
    v_mfma_f32_16x16x32_bf16 v[200:203], a[232:235], a[252:255], v[200:203]
    v_cvt_pk_bf16_f32 v140, v176, v177
    v_cvt_pk_bf16_f32 v141, v178, v179
    v_mfma_f32_16x16x32_bf16 v[212:215], a[232:235], v[252:255], v[212:215]
    v_mul_f32 v180, s37, v180
    v_mul_f32 v181, s37, v181
    v_mfma_f32_16x16x32_bf16 v[148:151], v[36:39], v[138:141], v[148:151]
    v_mul_f32 v182, s37, v182
    v_mul_f32 v183, s37, v183
    v_mfma_f32_16x16x32_bf16 v[152:155], v[42:45], v[138:141], v[152:155]
    v_cvt_pk_bf16_f32 v142, v180, v181
    v_cvt_pk_bf16_f32 v143, v182, v183
    v_mfma_f32_16x16x32_bf16 v[156:159], v[24:27], v[138:141], v[156:159]
    ds_read_b128 a[244:247], v239 offset:14336
    ds_read_b128 a[248:251], v239 offset:20480
    v_mfma_f32_16x16x16_bf16 v[148:151], v[40:41], v[142:143], v[148:151]
    ds_read_b64_tr_b16 a[232:233], v241 offset:13824
    ds_read_b64_tr_b16 a[234:235], v241 offset:24576
    v_mfma_f32_16x16x16_bf16 v[152:155], v[46:47], v[142:143], v[152:155]
    v_cvt_pk_bf16_f32 v168, v164, v165
    v_cvt_pk_bf16_f32 v169, v166, v167
    v_mfma_f32_16x16x16_bf16 v[156:159], v[28:29], v[142:143], v[156:159]
    ds_read_b128 v[164:167], v236
    v_bfe_u32 v236, s67, v233, 4
    v_mfma_f32_16x16x32_bf16 v[196:199], a[216:219], v[168:171], v[196:199]
    v_mad_u32_u24 v236, v236, s40, v231
    v_mfma_f32_16x16x32_bf16 v[184:187], v[70:73], v[168:171], v[184:187]
    v_exp_f32 v148, v148
    v_mfma_f32_16x16x32_bf16 v[188:191], v[92:95], v[168:171], v[188:191]
    v_exp_f32 v149, v149
    v_mfma_f32_16x16x32_bf16 v[192:195], v[114:117], v[168:171], v[192:195]
    v_exp_f32 v150, v150
    v_mfma_f32_16x16x32_bf16 v[160:163], v[30:33], v[138:141], v[160:163]
    v_rcp_f32 v197, v196
    v_mfma_f32_16x16x32_bf16 v[144:147], v[60:63], v[138:141], v[144:147]
    s_waitcnt lgkmcnt(5)
    v_mul_f32 v184, v184, v197
    v_mul_f32 v185, v185, v197
    v_mfma_f32_16x16x32_bf16 v[204:207], a[236:239], a[252:255], v[204:207]
    v_cvt_pk_bf16_f32 v184, v184, v185
    v_mul_f32 v186, v186, v197
    v_mfma_f32_16x16x16_bf16 v[160:163], v[34:35], v[142:143], v[160:163]
    v_mul_f32 v187, v187, v197
    v_cvt_pk_bf16_f32 v185, v186, v187
    v_mfma_f32_16x16x16_bf16 v[144:147], v[64:65], v[142:143], v[144:147]
    s_waitcnt lgkmcnt(0)
    v_mul_f32 v188, v188, v197
    v_mul_f32 v189, v189, v197
    v_mfma_f32_16x16x32_bf16 v[164:167], v[54:57], v[138:141], v[164:167]
    v_cvt_pk_bf16_f32 v186, v188, v189
    v_mul_f32 v190, v190, v197
    v_mfma_f32_16x16x32_bf16 v[216:219], a[236:239], v[252:255], v[216:219]
    ds_read_b128 a[236:239], v239 offset:15360
    v_mul_f32 v191, v191, v197
    v_mfma_f32_16x16x32_bf16 v[208:211], a[240:243], a[252:255], v[208:211]
    ds_read_b64_tr_b16 a[252:253], v240 offset:13824
    ds_read_b64_tr_b16 a[254:255], v240 offset:24576
    v_mfma_f32_16x16x16_bf16 v[164:167], v[58:59], v[142:143], v[164:167]
    v_cvt_pk_bf16_f32 v187, v190, v191
    v_mul_f32 v192, v192, v197
    v_mfma_f32_16x16x32_bf16 v[220:223], a[240:243], v[252:255], v[220:223]
    ds_read_b64_tr_b16 v[252:253], v240 offset:13832
    ds_read_b64_tr_b16 v[254:255], v240 offset:24584
    v_mfma_f32_16x16x32_bf16 v[208:211], a[232:235], a[244:247], v[208:211]
    ds_read_b128 a[240:243], v239 offset:21504
    v_mul_f32 v193, v193, v197
    v_mfma_f32_16x16x32_bf16 v[220:223], a[232:235], a[248:251], v[220:223]
    s_waitcnt lgkmcnt(3)
    ds_read_b128 a[232:235], v239 offset:22528
    v_cvt_pk_bf16_f32 v188, v192, v193
    v_mul_f32 v194, v194, v197
    v_mul_f32 v195, v195, v197
    v_cvt_pk_bf16_f32 v189, v194, v195
    v_max3_f32 v250, v250, v196, v197
    ds_write_b128 v237, v[184:187]
    ds_write_b64 v238, v[188:189]
    v_exp_f32 v151, v151
    v_cvt_pk_bf16_f32 v172, v148, v149
    v_cvt_pk_bf16_f32 v173, v150, v151
    v_mfma_f32_16x16x32_bf16 v[200:203], a[252:255], a[244:247], v[200:203]
    ds_read_b128 v[148:151], v229 offset:640
    v_mfma_f32_16x16x32_bf16 v[212:215], a[252:255], a[248:251], v[212:215]
    s_waitcnt lgkmcnt(5)
    ds_read_b64_tr_b16 a[252:253], v241 offset:36864
    ds_read_b64_tr_b16 a[254:255], v241 offset:38400
    v_mfma_f32_16x16x32_bf16 v[204:207], v[252:255], a[244:247], v[204:207]
    ds_read_b64_tr_b16 a[244:245], v240 offset:36864
    ds_read_b64_tr_b16 a[246:247], v240 offset:38400
    v_mfma_f32_16x16x32_bf16 v[216:219], v[252:255], a[248:251], v[216:219]
    ds_read_b64_tr_b16 a[248:249], v240 offset:36872
    v_exp_f32 v152, v152
    v_exp_f32 v153, v153
    ds_read_b64_tr_b16 a[250:251], v240 offset:38408
    ds_read_b128 v[252:255], v239 offset:16384
    v_exp_f32 v154, v154
    v_exp_f32 v155, v155
    v_cvt_pk_bf16_f32 v174, v152, v153
    v_cvt_pk_bf16_f32 v175, v154, v155
    ds_read_b128 v[152:155], v228 offset:640
    v_exp_f32 v156, v156
    v_mfma_f32_16x16x32_bf16 v[196:199], a[216:219], v[172:175], 0
    v_exp_f32 v157, v157
    v_mfma_f32_16x16x32_bf16 v[184:187], v[76:79], v[172:175], 0
    v_exp_f32 v158, v158
    v_mfma_f32_16x16x32_bf16 v[188:191], v[98:101], v[172:175], 0
    v_exp_f32 v159, v159
    v_mfma_f32_16x16x32_bf16 v[192:195], v[120:123], v[172:175], 0
    s_waitcnt lgkmcnt(4)
    v_cvt_pk_bf16_f32 v168, v156, v157
    v_cvt_pk_bf16_f32 v169, v158, v159
    v_mfma_f32_16x16x32_bf16 v[200:203], a[244:247], a[236:239], v[200:203]
    ds_read_b128 v[156:159], v228 offset:1280
    v_mfma_f32_16x16x32_bf16 v[212:215], a[244:247], a[240:243], v[212:215]
    s_waitcnt lgkmcnt(3)
    ds_read_b64_tr_b16 a[244:245], v241 offset:49152
    ds_read_b64_tr_b16 a[246:247], v241 offset:62976
    v_mfma_f32_16x16x32_bf16 v[204:207], a[248:251], a[236:239], v[204:207]
    v_exp_f32 v160, v160
    v_mfma_f32_16x16x32_bf16 v[216:219], a[248:251], a[240:243], v[216:219]
    ds_read_b128 a[248:251], v239 offset:17408
    v_mfma_f32_16x16x32_bf16 v[208:211], a[252:255], a[236:239], v[208:211]
    ds_read_b64_tr_b16 a[236:237], v240 offset:49152
    ds_read_b64_tr_b16 a[238:239], v240 offset:62976
    v_mfma_f32_16x16x32_bf16 v[220:223], a[252:255], a[240:243], v[220:223]
    ds_read_b64_tr_b16 a[240:241], v240 offset:49160
    ds_read_b64_tr_b16 a[242:243], v240 offset:62984
    v_exp_f32 v161, v161
    ds_read_b128 a[252:255], v239 offset:23552
    v_exp_f32 v162, v162
    v_exp_f32 v163, v163
    v_cvt_pk_bf16_f32 v170, v160, v161
    v_cvt_pk_bf16_f32 v171, v162, v163
    ds_read_b128 v[160:163], v229 offset:1280
    v_exp_f32 v164, v164
    v_mfma_f32_16x16x32_bf16 v[196:199], a[216:219], v[168:171], v[196:199]
    v_exp_f32 v165, v165
    v_mfma_f32_16x16x32_bf16 v[184:187], v[68:71], v[168:171], v[184:187]
    v_exp_f32 v166, v166
    v_mfma_f32_16x16x32_bf16 v[188:191], v[90:93], v[168:171], v[188:191]
    v_exp_f32 v167, v167
    v_mfma_f32_16x16x32_bf16 v[192:195], v[112:115], v[168:171], v[192:195]
    s_waitcnt lgkmcnt(4)
    v_cvt_pk_bf16_f32 v172, v164, v165
    v_cvt_pk_bf16_f32 v173, v166, v167
    v_mfma_f32_16x16x32_bf16 v[200:203], a[236:239], v[252:255], v[200:203]
    ds_read_b128 v[164:167], v229 offset:1920
    v_mfma_f32_16x16x32_bf16 v[212:215], a[236:239], a[232:235], v[212:215]
    s_waitcnt lgkmcnt(3)
    ds_read_b64_tr_b16 a[236:237], v241 offset:50688
    ds_read_b64_tr_b16 a[238:239], v241 offset:61440
    v_mfma_f32_16x16x32_bf16 v[204:207], a[240:243], v[252:255], v[204:207]
    v_exp_f32 v144, v144
    v_mfma_f32_16x16x32_bf16 v[216:219], a[240:243], a[232:235], v[216:219]
    ds_read_b128 a[240:243], v225 offset:8896
    v_mfma_f32_16x16x32_bf16 v[208:211], a[244:247], v[252:255], v[208:211]
    ds_read_b64_tr_b16 v[252:253], v240 offset:50688
    ds_read_b64_tr_b16 v[254:255], v240 offset:61440
    v_mfma_f32_16x16x32_bf16 v[220:223], a[244:247], a[232:235], v[220:223]
    ds_read_b64_tr_b16 a[232:233], v240 offset:50696
    ds_read_b64_tr_b16 a[234:235], v240 offset:61448
    v_exp_f32 v145, v145
    ds_read_b128 a[244:247], v225 offset:8960
    v_exp_f32 v146, v146
    v_exp_f32 v147, v147
    v_cvt_pk_bf16_f32 v174, v144, v145
    v_cvt_pk_bf16_f32 v175, v146, v147
    ds_read_b128 v[144:147], v228 offset:1920
    s_nop 0
    v_mfma_f32_16x16x32_bf16 v[196:199], a[216:219], v[172:175], v[196:199]
    v_mfma_f32_16x16x32_bf16 v[184:187], v[84:87], v[172:175], v[184:187]
    v_mfma_f32_16x16x32_bf16 v[188:191], v[106:109], v[172:175], v[188:191]
    v_mfma_f32_16x16x32_bf16 v[192:195], v[128:131], v[172:175], v[192:195]
    s_waitcnt lgkmcnt(4)
    v_mfma_f32_16x16x32_bf16 v[200:203], v[252:255], a[248:251], v[200:203]
    v_mfma_f32_16x16x32_bf16 v[212:215], v[252:255], a[252:255], v[212:215]
    s_waitcnt lgkmcnt(2)
    ds_read_b128 v[252:255], v225 offset:9152
    v_mfma_f32_16x16x32_bf16 v[204:207], a[232:235], a[248:251], v[204:207]
    v_mfma_f32_16x16x32_bf16 v[216:219], a[232:235], a[252:255], v[216:219]
    ds_read_b128 a[232:235], v225 offset:9216
    v_mfma_f32_16x16x32_bf16 v[208:211], a[236:239], a[248:251], v[208:211]
    ds_read_b128 a[248:251], v225 offset:9024
    v_mfma_f32_16x16x32_bf16 v[220:223], a[236:239], a[252:255], v[220:223]
    ds_read_b128 a[252:255], v225 offset:9088
    v_cvt_pk_bf16_f32 v200, v200, v201
    v_mfma_f32_16x16x32_bf16 v[176:179], a[144:147], a[240:243], 0
    v_cvt_pk_bf16_f32 v201, v202, v203
    v_cvt_pk_bf16_f32 v202, v204, v205
    v_mfma_f32_16x16x32_bf16 v[180:183], a[148:151], a[240:243], 0
    s_waitcnt lgkmcnt(4)
    v_cvt_pk_bf16_f32 v203, v206, v207
    v_cvt_pk_bf16_f32 v208, v208, v209
    v_mfma_f32_16x16x32_bf16 v[176:179], a[156:159], a[244:247], v[176:179]
    buffer_store_dwordx4 v[200:203], v242, s[20:23], s58 offen sc0 sc1
    v_mfma_f32_16x16x32_bf16 v[180:183], a[160:163], a[244:247], v[180:183]
    v_cvt_pk_bf16_f32 v209, v210, v211
    v_cvt_pk_bf16_f32 v212, v212, v213
    v_mfma_f32_16x16x32_bf16 v[200:203], a[152:155], a[240:243], 0
    s_waitcnt lgkmcnt(1)
    buffer_store_dwordx2 v[208:209], v243, s[20:23], s58 offen sc0 sc1
    v_mfma_f32_16x16x32_bf16 v[200:203], a[164:167], a[244:247], v[200:203]
    s_add_u32 s58, s51, 0xa8000
    v_cvt_pk_bf16_f32 v213, v214, v215
    v_cvt_pk_bf16_f32 v214, v216, v217
    v_mfma_f32_16x16x32_bf16 v[176:179], a[168:171], a[248:251], v[176:179]
    v_cvt_pk_bf16_f32 v215, v218, v219
    v_cvt_pk_bf16_f32 v220, v220, v221
    v_mfma_f32_16x16x32_bf16 v[180:183], a[172:175], a[248:251], v[180:183]
    buffer_store_dwordx4 v[212:215], v244, s[20:23], s59 offen sc0 sc1
    v_mfma_f32_16x16x32_bf16 v[200:203], a[176:179], a[248:251], v[200:203]
    s_waitcnt lgkmcnt(0)
    ds_read_b128 a[236:239], v224 offset:30976
    v_cvt_pk_bf16_f32 v221, v222, v223
    v_mfma_f32_16x16x32_bf16 v[176:179], a[180:183], a[252:255], v[176:179]
    buffer_store_dwordx2 v[220:221], v245, s[20:23], s59 offen sc0 sc1
    v_mfma_f32_16x16x32_bf16 v[180:183], a[184:187], a[252:255], v[180:183]
    s_add_u32 s59, s51, 0xa9800
    ds_read_b128 a[240:243], v224 offset:31040
    ds_read_b128 a[244:247], v224 offset:31104
    v_mfma_f32_16x16x32_bf16 v[200:203], a[188:191], a[252:255], v[200:203]
    ds_read_b128 a[248:251], v224 offset:31168
    ds_read_b128 a[252:255], v224 offset:31232
    v_mfma_f32_16x16x32_bf16 v[176:179], a[192:195], v[252:255], v[176:179]
    v_rcp_f32 v197, v196
    v_mfma_f32_16x16x32_bf16 v[180:183], a[196:199], v[252:255], v[180:183]
    v_mul_f32 v184, v184, v197
    v_mul_f32 v185, v185, v197
    v_mfma_f32_16x16x32_bf16 v[200:203], a[200:203], v[252:255], v[200:203]
    ds_read_b128 v[252:255], v224 offset:31296
    v_cvt_pk_bf16_f32 v184, v184, v185
    v_mfma_f32_16x16x32_bf16 v[176:179], a[204:207], a[232:235], v[176:179]
    v_mul_f32 v186, v186, v197
    v_mul_f32 v187, v187, v197
    v_mfma_f32_16x16x32_bf16 v[180:183], a[208:211], a[232:235], v[180:183]
    v_cvt_pk_bf16_f32 v185, v186, v187
    v_mul_f32 v188, v188, v197
    v_mfma_f32_16x16x32_bf16 v[200:203], a[212:215], a[232:235], v[200:203]
    s_waitcnt lgkmcnt(5)
    ds_read_b128 a[232:235], v224 offset:34048
    v_mul_f32 v189, v189, v197
    v_mfma_f32_16x16x32_bf16 v[204:207], a[0:3], a[236:239], 0
    v_mul_f32 v176, s37, v176
    v_mul_f32 v177, s37, v177
    v_mfma_f32_16x16x32_bf16 v[208:211], a[4:7], a[236:239], 0
    v_mul_f32 v178, s37, v178
    v_mul_f32 v179, s37, v179
    v_mfma_f32_16x16x32_bf16 v[212:215], a[8:11], a[236:239], 0
    v_cvt_pk_bf16_f32 v132, v176, v177
    v_cvt_pk_bf16_f32 v133, v178, v179
    v_mfma_f32_16x16x32_bf16 v[216:219], a[236:239], a[72:75], 0
    v_mul_f32 v180, s37, v180
    v_mul_f32 v181, s37, v181
    v_mfma_f32_16x16x32_bf16 v[220:223], a[236:239], a[76:79], 0
    v_mul_f32 v182, s37, v182
    v_mul_f32 v183, s37, v183
    v_mfma_f32_16x16x32_bf16 v[176:179], a[236:239], a[80:83], 0
    s_waitcnt lgkmcnt(2)
    v_cvt_pk_bf16_f32 v134, v180, v181
    v_cvt_pk_bf16_f32 v135, v182, v183
    v_mfma_f32_16x16x32_bf16 v[204:207], a[12:15], a[240:243], v[204:207]
    v_mul_f32 v200, s37, v200
    v_mul_f32 v201, s37, v201
    v_mfma_f32_16x16x32_bf16 v[148:151], v[42:45], v[132:135], v[148:151]
    v_mul_f32 v202, s37, v202
    v_mul_f32 v203, s37, v203
    v_mfma_f32_16x16x32_bf16 v[152:155], v[18:21], v[132:135], v[152:155]
    v_cvt_pk_bf16_f32 v136, v200, v201
    v_cvt_pk_bf16_f32 v137, v202, v203
    v_mfma_f32_16x16x32_bf16 v[156:159], v[0:3], v[132:135], v[156:159]
    ds_read_b128 a[236:239], v224 offset:34112
    v_cvt_pk_bf16_f32 v186, v188, v189
    v_mfma_f32_16x16x16_bf16 v[148:151], v[46:47], v[136:137], v[148:151]
    v_mul_f32 v190, v190, v197
    v_mul_f32 v191, v191, v197
    v_mfma_f32_16x16x16_bf16 v[152:155], v[22:23], v[136:137], v[152:155]
    v_cvt_pk_bf16_f32 v187, v190, v191
    v_mul_f32 v192, v192, v197
    v_mfma_f32_16x16x16_bf16 v[156:159], v[4:5], v[136:137], v[156:159]
    v_mul_f32 v193, v193, v197
    v_cvt_pk_bf16_f32 v188, v192, v193
    v_mfma_f32_16x16x32_bf16 v[160:163], v[24:27], v[132:135], v[160:163]
    v_mul_f32 v194, v194, v197
    v_mul_f32 v195, v195, v197
    v_mfma_f32_16x16x32_bf16 v[164:167], v[30:33], v[132:135], v[164:167]
    v_cvt_pk_bf16_f32 v189, v194, v195
    v_max3_f32 v250, v250, v196, v197
    v_mfma_f32_16x16x32_bf16 v[144:147], v[6:9], v[132:135], v[144:147]
    ds_write_b128 v237, v[184:187] offset:6144
    v_mfma_f32_16x16x16_bf16 v[160:163], v[28:29], v[136:137], v[160:163]
    ds_write_b64 v238, v[188:189] offset:6144
    v_mfma_f32_16x16x16_bf16 v[164:167], v[34:35], v[136:137], v[164:167]
    v_exp_f32 v148, v148
    v_mfma_f32_16x16x32_bf16 v[208:211], a[16:19], a[240:243], v[208:211]
    v_exp_f32 v149, v149
    v_mfma_f32_16x16x16_bf16 v[144:147], v[10:11], v[136:137], v[144:147]
    v_exp_f32 v150, v150
    v_mfma_f32_16x16x32_bf16 v[212:215], a[20:23], a[240:243], v[212:215]
    v_exp_f32 v151, v151
    v_mfma_f32_16x16x32_bf16 v[216:219], a[240:243], a[84:87], v[216:219]
    v_cvt_pk_bf16_f32 v168, v148, v149
    v_cvt_pk_bf16_f32 v169, v150, v151
    v_mfma_f32_16x16x32_bf16 v[220:223], a[240:243], a[88:91], v[220:223]
    ds_read_b128 v[148:151], v228 offset:2560
    v_mfma_f32_16x16x32_bf16 v[176:179], a[240:243], a[92:95], v[176:179]
    ds_read_b128 a[240:243], v224 offset:34176
    v_mfma_f32_16x16x32_bf16 v[204:207], a[24:27], a[244:247], v[204:207]
    v_exp_f32 v152, v152
    v_mfma_f32_16x16x32_bf16 v[208:211], a[28:31], a[244:247], v[208:211]
    v_exp_f32 v153, v153
    v_mfma_f32_16x16x32_bf16 v[212:215], a[32:35], a[244:247], v[212:215]
    v_exp_f32 v154, v154
    v_mfma_f32_16x16x32_bf16 v[216:219], a[244:247], a[96:99], v[216:219]
    v_exp_f32 v155, v155
    v_mfma_f32_16x16x32_bf16 v[220:223], a[244:247], a[100:103], v[220:223]
    v_cvt_pk_bf16_f32 v170, v152, v153
    v_cvt_pk_bf16_f32 v171, v154, v155
    v_mfma_f32_16x16x32_bf16 v[176:179], a[244:247], a[104:107], v[176:179]
    ds_read_b128 a[244:247], v224 offset:34240
    ds_read_b128 v[152:155], v229 offset:2560
    v_mfma_f32_16x16x32_bf16 v[196:199], a[216:219], v[168:171], 0
    v_exp_f32 v156, v156
    v_mfma_f32_16x16x32_bf16 v[184:187], v[78:81], v[168:171], 0
    v_exp_f32 v157, v157
    v_mfma_f32_16x16x32_bf16 v[188:191], v[100:103], v[168:171], 0
    v_exp_f32 v158, v158
    v_mfma_f32_16x16x32_bf16 v[192:195], v[122:125], v[168:171], 0
    v_exp_f32 v159, v159
    v_mfma_f32_16x16x32_bf16 v[204:207], a[36:39], a[248:251], v[204:207]
    v_cvt_pk_bf16_f32 v172, v156, v157
    v_cvt_pk_bf16_f32 v173, v158, v159
    v_mfma_f32_16x16x32_bf16 v[208:211], a[40:43], a[248:251], v[208:211]
    ds_read_b128 v[156:159], v230 offset:2560
    v_mfma_f32_16x16x32_bf16 v[212:215], a[44:47], a[248:251], v[212:215]
    v_exp_f32 v160, v160
    v_mfma_f32_16x16x32_bf16 v[216:219], a[248:251], a[108:111], v[216:219]
    v_exp_f32 v161, v161
    v_mfma_f32_16x16x32_bf16 v[220:223], a[248:251], a[112:115], v[220:223]
    v_exp_f32 v162, v162
    v_mfma_f32_16x16x32_bf16 v[176:179], a[248:251], a[116:119], v[176:179]
    ds_read_b128 a[248:251], v224 offset:34304
    v_cvt_pk_bf16_f32 v174, v160, v161
    v_mfma_f32_16x16x32_bf16 v[204:207], a[48:51], a[252:255], v[204:207]
    v_exp_f32 v163, v163
    v_mfma_f32_16x16x32_bf16 v[208:211], a[52:55], a[252:255], v[208:211]
    v_cvt_pk_bf16_f32 v175, v162, v163
    v_mfma_f32_16x16x32_bf16 v[212:215], a[56:59], a[252:255], v[212:215]
    ds_read_b128 v[160:163], v230 offset:640
    v_mfma_f32_16x16x32_bf16 v[196:199], a[216:219], v[172:175], v[196:199]
    v_exp_f32 v164, v164
    v_mfma_f32_16x16x32_bf16 v[184:187], v[66:69], v[172:175], v[184:187]
    v_exp_f32 v165, v165
    v_mfma_f32_16x16x32_bf16 v[188:191], v[88:91], v[172:175], v[188:191]
    v_exp_f32 v166, v166
    v_mfma_f32_16x16x32_bf16 v[192:195], v[110:113], v[172:175], v[192:195]
    v_exp_f32 v167, v167
    v_mfma_f32_16x16x32_bf16 v[216:219], a[252:255], a[120:123], v[216:219]
    v_cvt_pk_bf16_f32 v168, v164, v165
    v_cvt_pk_bf16_f32 v169, v166, v167
    v_mfma_f32_16x16x32_bf16 v[220:223], a[252:255], a[124:127], v[220:223]
    ds_read_b128 v[164:167], v230 offset:1280
    v_mfma_f32_16x16x32_bf16 v[176:179], a[252:255], a[128:131], v[176:179]
    s_waitcnt lgkmcnt(2)
    ds_read_b128 a[252:255], v224 offset:34368
    v_mfma_f32_16x16x32_bf16 v[204:207], a[60:63], v[252:255], v[204:207]
    v_exp_f32 v144, v144
    v_mfma_f32_16x16x32_bf16 v[208:211], a[64:67], v[252:255], v[208:211]
    v_exp_f32 v145, v145
    v_mfma_f32_16x16x32_bf16 v[212:215], a[68:71], v[252:255], v[212:215]
    v_exp_f32 v146, v146
    v_mfma_f32_16x16x32_bf16 v[216:219], v[252:255], a[132:135], v[216:219]
    v_exp_f32 v147, v147
    v_mfma_f32_16x16x32_bf16 v[220:223], v[252:255], a[136:139], v[220:223]
    v_cvt_pk_bf16_f32 v12, v204, v205
    v_cvt_pk_bf16_f32 v13, v206, v207
    v_mfma_f32_16x16x32_bf16 v[176:179], v[252:255], a[140:143], v[176:179]
    v_cvt_pk_bf16_f32 v14, v208, v209
    v_cvt_pk_bf16_f32 v15, v210, v211
    v_mfma_f32_16x16x32_bf16 v[180:183], a[0:3], a[232:235], 0
    v_cvt_pk_bf16_f32 v16, v212, v213
    v_cvt_pk_bf16_f32 v17, v214, v215
    v_mfma_f32_16x16x32_bf16 v[148:151], v[12:15], v[132:135], v[148:151]
    v_cvt_pk_bf16_f32 v74, v216, v217
    v_cvt_pk_bf16_f32 v75, v218, v219
    v_mfma_f32_16x16x32_bf16 v[200:203], a[4:7], a[232:235], 0
    v_cvt_pk_bf16_f32 v96, v220, v221
    v_cvt_pk_bf16_f32 v97, v222, v223
    v_mfma_f32_16x16x32_bf16 v[204:207], a[8:11], a[232:235], 0
    v_cvt_pk_bf16_f32 v118, v176, v177
    v_cvt_pk_bf16_f32 v119, v178, v179
    v_mfma_f32_16x16x16_bf16 v[148:151], v[16:17], v[136:137], v[148:151]
    ds_read_b128 v[252:255], v225 offset:11968
    v_cvt_pk_bf16_f32 v170, v144, v145
    v_mfma_f32_16x16x32_bf16 v[208:211], a[232:235], a[72:75], 0
    v_cvt_pk_bf16_f32 v171, v146, v147
    v_mfma_f32_16x16x32_bf16 v[212:215], a[232:235], a[76:79], 0
    ds_read_b128 v[144:147], v230 offset:1920
    v_mfma_f32_16x16x32_bf16 v[196:199], a[216:219], v[168:171], v[196:199]
    v_mfma_f32_16x16x32_bf16 v[184:187], v[70:73], v[168:171], v[184:187]
    v_exp_f32 v148, v148
    v_mfma_f32_16x16x32_bf16 v[188:191], v[92:95], v[168:171], v[188:191]
    v_exp_f32 v149, v149
    v_mfma_f32_16x16x32_bf16 v[192:195], v[114:117], v[168:171], v[192:195]
    v_exp_f32 v150, v150
    v_mfma_f32_16x16x32_bf16 v[216:219], a[232:235], a[80:83], 0
    ds_read_b128 a[232:235], v225 offset:12032
    v_cvt_pk_bf16_f32 v172, v148, v149
    v_mfma_f32_16x16x32_bf16 v[180:183], a[12:15], a[236:239], v[180:183]
    v_exp_f32 v151, v151
    v_mfma_f32_16x16x32_bf16 v[200:203], a[16:19], a[236:239], v[200:203]
    v_cvt_pk_bf16_f32 v173, v150, v151
    v_mfma_f32_16x16x32_bf16 v[204:207], a[20:23], a[236:239], v[204:207]
    ds_read_b128 v[148:151], v235
    v_bfe_u32 v235, s69, v233, 4
    v_mfma_f32_16x16x32_bf16 v[208:211], a[236:239], a[84:87], v[208:211]
    v_mad_u32_u24 v235, v235, s40, v231
    v_mfma_f32_16x16x32_bf16 v[212:215], a[236:239], a[88:91], v[212:215]
    v_mfma_f32_16x16x32_bf16 v[216:219], a[236:239], a[92:95], v[216:219]
    ds_read_b128 a[236:239], v225 offset:12096
    v_mfma_f32_16x16x32_bf16 v[180:183], a[24:27], a[240:243], v[180:183]
    v_mfma_f32_16x16x32_bf16 v[200:203], a[28:31], a[240:243], v[200:203]
    v_mfma_f32_16x16x32_bf16 v[204:207], a[32:35], a[240:243], v[204:207]
    v_mfma_f32_16x16x32_bf16 v[208:211], a[240:243], a[96:99], v[208:211]
    v_mfma_f32_16x16x32_bf16 v[212:215], a[240:243], a[100:103], v[212:215]
    v_mfma_f32_16x16x32_bf16 v[216:219], a[240:243], a[104:107], v[216:219]
    ds_read_b128 a[240:243], v225 offset:12160
    v_mfma_f32_16x16x32_bf16 v[180:183], a[36:39], a[244:247], v[180:183]
    v_mfma_f32_16x16x32_bf16 v[200:203], a[40:43], a[244:247], v[200:203]
    v_mfma_f32_16x16x32_bf16 v[204:207], a[44:47], a[244:247], v[204:207]
    v_mfma_f32_16x16x32_bf16 v[208:211], a[244:247], a[108:111], v[208:211]
    v_mfma_f32_16x16x32_bf16 v[212:215], a[244:247], a[112:115], v[212:215]
    v_mfma_f32_16x16x32_bf16 v[216:219], a[244:247], a[116:119], v[216:219]
    ds_read_b128 a[244:247], v225 offset:12224
    v_mfma_f32_16x16x32_bf16 v[180:183], a[48:51], a[248:251], v[180:183]
    v_mfma_f32_16x16x32_bf16 v[200:203], a[52:55], a[248:251], v[200:203]
    v_mfma_f32_16x16x32_bf16 v[204:207], a[56:59], a[248:251], v[204:207]
    v_mfma_f32_16x16x32_bf16 v[208:211], a[248:251], a[120:123], v[208:211]
    v_mfma_f32_16x16x32_bf16 v[212:215], a[248:251], a[124:127], v[212:215]
    v_mfma_f32_16x16x32_bf16 v[216:219], a[248:251], a[128:131], v[216:219]
    s_waitcnt lgkmcnt(1)
    ds_read_b128 a[248:251], v225 offset:12288
    v_mfma_f32_16x16x32_bf16 v[180:183], a[60:63], a[252:255], v[180:183]
    v_mfma_f32_16x16x32_bf16 v[200:203], a[64:67], a[252:255], v[200:203]
    v_mfma_f32_16x16x32_bf16 v[204:207], a[68:71], a[252:255], v[204:207]
    v_mfma_f32_16x16x32_bf16 v[208:211], a[252:255], a[132:135], v[208:211]
    v_mfma_f32_16x16x32_bf16 v[212:215], a[252:255], a[136:139], v[212:215]
    v_mfma_f32_16x16x32_bf16 v[216:219], a[252:255], a[140:143], v[216:219]
    v_mfma_f32_16x16x32_bf16 v[220:223], a[144:147], v[252:255], 0
    s_waitcnt vmcnt(4) lgkmcnt(0)
    v_mfma_f32_16x16x32_bf16 v[176:179], a[148:151], v[252:255], 0
    s_barrier
    v_cvt_pk_bf16_f32 v36, v180, v181
    v_mfma_f32_16x16x32_bf16 v[220:223], a[156:159], a[232:235], v[220:223]
    v_cvt_pk_bf16_f32 v37, v182, v183
    v_cvt_pk_bf16_f32 v38, v200, v201
    v_mfma_f32_16x16x32_bf16 v[180:183], a[152:155], v[252:255], 0
    v_cvt_pk_bf16_f32 v39, v202, v203
    v_cvt_pk_bf16_f32 v40, v204, v205
    v_mfma_f32_16x16x32_bf16 v[176:179], a[160:163], a[232:235], v[176:179]
    v_cvt_pk_bf16_f32 v41, v206, v207
    v_cvt_pk_bf16_f32 v76, v208, v209
    v_mfma_f32_16x16x32_bf16 v[152:155], v[36:39], v[132:135], v[152:155]
    v_cvt_pk_bf16_f32 v77, v210, v211
    v_cvt_pk_bf16_f32 v98, v212, v213
    v_mfma_f32_16x16x32_bf16 v[180:183], a[164:167], a[232:235], v[180:183]
    v_cvt_pk_bf16_f32 v99, v214, v215
    v_cvt_pk_bf16_f32 v120, v216, v217
    v_mfma_f32_16x16x32_bf16 v[220:223], a[168:171], a[236:239], v[220:223]
    ds_read_b128 a[252:255], v227 offset:37120
    v_cvt_pk_bf16_f32 v121, v218, v219
    v_mfma_f32_16x16x16_bf16 v[152:155], v[40:41], v[136:137], v[152:155]
    buffer_load_dwordx4 v246, s[4:7], s56 offen lds
    v_mfma_f32_16x16x32_bf16 v[176:179], a[172:175], a[236:239], v[176:179]
    s_add_u32 m0, s42, 0
    ds_read_b128 v[252:255], v227 offset:37184
    ds_read_b128 a[232:235], v227 offset:37248
    v_mfma_f32_16x16x32_bf16 v[180:183], a[176:179], a[236:239], v[180:183]
    buffer_load_dwordx4 v247, s[4:7], s56 offen lds
    v_mfma_f32_16x16x32_bf16 v[220:223], a[180:183], a[240:243], v[220:223]
    s_add_u32 m0, s41, 0x1e40
    ds_read_b128 a[236:239], v227 offset:37312
    v_mfma_f32_16x16x32_bf16 v[176:179], a[184:187], a[240:243], v[176:179]
    buffer_load_dwordx4 v246, s[4:7], s46 offen lds
    v_mfma_f32_16x16x32_bf16 v[180:183], a[188:191], a[240:243], v[180:183]
    s_add_u32 m0, s42, 0x1e40
    ds_read_b128 a[240:243], v227 offset:37376
    v_mfma_f32_16x16x32_bf16 v[220:223], a[192:195], a[244:247], v[220:223]
    buffer_load_dwordx4 v247, s[4:7], s46 offen lds
    v_mfma_f32_16x16x32_bf16 v[176:179], a[196:199], a[244:247], v[176:179]
    s_add_u32 m0, s41, 0x3c80
    v_exp_f32 v152, v152
    v_mfma_f32_16x16x32_bf16 v[180:183], a[200:203], a[244:247], v[180:183]
    ds_read_b128 a[244:247], v227 offset:37440
    v_mfma_f32_16x16x32_bf16 v[220:223], a[204:207], a[248:251], v[220:223]
    v_exp_f32 v153, v153
    v_mfma_f32_16x16x32_bf16 v[176:179], a[208:211], a[248:251], v[176:179]
    v_exp_f32 v154, v154
    v_mfma_f32_16x16x32_bf16 v[180:183], a[212:215], a[248:251], v[180:183]
    s_waitcnt lgkmcnt(4)
    ds_read_b128 a[248:251], v239
    v_cvt_pk_bf16_f32 v174, v152, v153
    v_mfma_f32_16x16x32_bf16 v[200:203], a[0:3], a[252:255], 0
    v_exp_f32 v155, v155
    v_mfma_f32_16x16x32_bf16 v[204:207], a[4:7], a[252:255], 0
    v_mul_f32 v220, s37, v220
    v_mul_f32 v221, s37, v221
    v_mfma_f32_16x16x32_bf16 v[208:211], a[8:11], a[252:255], 0
    v_mul_f32 v222, s37, v222
    v_mul_f32 v223, s37, v223
    v_mfma_f32_16x16x32_bf16 v[212:215], a[252:255], a[72:75], 0
    v_cvt_pk_bf16_f32 v138, v220, v221
    v_cvt_pk_bf16_f32 v139, v222, v223
    v_mfma_f32_16x16x32_bf16 v[216:219], a[252:255], a[76:79], 0
    v_mul_f32 v176, s37, v176
    v_mul_f32 v177, s37, v177
    v_mfma_f32_16x16x32_bf16 v[220:223], a[252:255], a[80:83], 0
    v_mul_f32 v178, s37, v178
    v_mul_f32 v179, s37, v179
    v_mfma_f32_16x16x32_bf16 v[200:203], a[12:15], v[252:255], v[200:203]
    v_cvt_pk_bf16_f32 v140, v176, v177
    v_cvt_pk_bf16_f32 v141, v178, v179
    v_mfma_f32_16x16x32_bf16 v[204:207], a[16:19], v[252:255], v[204:207]
    v_mul_f32 v180, s37, v180
    v_mul_f32 v181, s37, v181
    v_mfma_f32_16x16x32_bf16 v[156:159], v[36:39], v[138:141], v[156:159]
    v_mul_f32 v182, s37, v182
    v_mul_f32 v183, s37, v183
    v_mfma_f32_16x16x32_bf16 v[160:163], v[42:45], v[138:141], v[160:163]
    v_cvt_pk_bf16_f32 v142, v180, v181
    v_cvt_pk_bf16_f32 v143, v182, v183
    v_mfma_f32_16x16x32_bf16 v[164:167], v[24:27], v[138:141], v[164:167]
L_pg5:
    s_cbranch_execz L_back
    ds_read_b128 a[252:255], v239 offset:6144
    v_cvt_pk_bf16_f32 v175, v154, v155
    v_mfma_f32_16x16x16_bf16 v[156:159], v[40:41], v[142:143], v[156:159]
    ds_read_b128 v[152:155], v236
    v_bfe_u32 v236, s70, v233, 4
    v_mfma_f32_16x16x32_bf16 v[196:199], a[216:219], v[172:175], v[196:199]
    v_mad_u32_u24 v236, v236, s40, v231
    v_mfma_f32_16x16x32_bf16 v[184:187], v[74:77], v[172:175], v[184:187]
    v_mfma_f32_16x16x32_bf16 v[188:191], v[96:99], v[172:175], v[188:191]
    v_mfma_f32_16x16x32_bf16 v[192:195], v[118:121], v[172:175], v[192:195]
    v_mfma_f32_16x16x16_bf16 v[160:163], v[46:47], v[142:143], v[160:163]
    v_exp_f32 v156, v156
    v_mfma_f32_16x16x16_bf16 v[164:167], v[28:29], v[142:143], v[164:167]
    v_exp_f32 v157, v157
    v_mfma_f32_16x16x32_bf16 v[144:147], v[30:33], v[138:141], v[144:147]
    v_rcp_f32 v197, v196
    v_mfma_f32_16x16x32_bf16 v[148:151], v[54:57], v[138:141], v[148:151]
    v_mul_f32 v184, v184, v197
    v_mul_f32 v185, v185, v197
    v_mfma_f32_16x16x32_bf16 v[208:211], a[20:23], v[252:255], v[208:211]
    v_cvt_pk_bf16_f32 v184, v184, v185
    v_mul_f32 v186, v186, v197
    v_mfma_f32_16x16x16_bf16 v[144:147], v[34:35], v[142:143], v[144:147]
    v_mul_f32 v187, v187, v197
    v_cvt_pk_bf16_f32 v185, v186, v187
    v_mfma_f32_16x16x16_bf16 v[148:151], v[58:59], v[142:143], v[148:151]
    s_waitcnt lgkmcnt(0)
    v_mul_f32 v188, v188, v197
    v_mul_f32 v189, v189, v197
    v_mfma_f32_16x16x32_bf16 v[152:155], v[60:63], v[138:141], v[152:155]
    v_cvt_pk_bf16_f32 v186, v188, v189
    v_mul_f32 v190, v190, v197
    v_mfma_f32_16x16x32_bf16 v[212:215], v[252:255], a[84:87], v[212:215]
    v_mul_f32 v191, v191, v197
    v_cvt_pk_bf16_f32 v187, v190, v191
    v_mfma_f32_16x16x32_bf16 v[216:219], v[252:255], a[88:91], v[216:219]
    v_mul_f32 v192, v192, v197
    v_mul_f32 v193, v193, v197
    v_mfma_f32_16x16x16_bf16 v[152:155], v[64:65], v[142:143], v[152:155]
    v_cvt_pk_bf16_f32 v188, v192, v193
    v_mul_f32 v194, v194, v197
    v_mfma_f32_16x16x32_bf16 v[220:223], v[252:255], a[92:95], v[220:223]
    ds_read_b128 v[252:255], v239 offset:1024
    v_mul_f32 v195, v195, v197
    v_mfma_f32_16x16x32_bf16 v[200:203], a[24:27], a[232:235], v[200:203]
    v_cvt_pk_bf16_f32 v189, v194, v195
    v_max3_f32 v250, v250, v196, v197
    v_mfma_f32_16x16x32_bf16 v[204:207], a[28:31], a[232:235], v[204:207]
    ds_write_b128 v237, v[184:187] offset:12288
    v_mfma_f32_16x16x32_bf16 v[208:211], a[32:35], a[232:235], v[208:211]
    ds_write_b64 v238, v[188:189] offset:12288
    v_mfma_f32_16x16x32_bf16 v[212:215], a[232:235], a[96:99], v[212:215]
    v_exp_f32 v158, v158
    v_mfma_f32_16x16x32_bf16 v[216:219], a[232:235], a[100:103], v[216:219]
    v_exp_f32 v159, v159
    v_mfma_f32_16x16x32_bf16 v[220:223], a[232:235], a[104:107], v[220:223]
    ds_read_b128 a[232:235], v239 offset:7168
    v_cvt_pk_bf16_f32 v168, v156, v157
    v_mfma_f32_16x16x32_bf16 v[200:203], a[36:39], a[236:239], v[200:203]
    v_cvt_pk_bf16_f32 v169, v158, v159
    v_mfma_f32_16x16x32_bf16 v[204:207], a[40:43], a[236:239], v[204:207]
    ds_read_b128 v[156:159], v234
    v_bfe_u32 v234, s73, v232, 4
    v_mfma_f32_16x16x32_bf16 v[208:211], a[44:47], a[236:239], v[208:211]
    v_exp_f32 v160, v160
    v_mfma_f32_16x16x32_bf16 v[212:215], a[236:239], a[108:111], v[212:215]
    v_exp_f32 v161, v161
    v_mfma_f32_16x16x32_bf16 v[216:219], a[236:239], a[112:115], v[216:219]
    v_exp_f32 v162, v162
    v_mfma_f32_16x16x32_bf16 v[220:223], a[236:239], a[116:119], v[220:223]
    ds_read_b64_tr_b16 a[236:237], v240 offset:12288
    ds_read_b64_tr_b16 a[238:239], v240 offset:26112
    v_mfma_f32_16x16x32_bf16 v[200:203], a[48:51], a[240:243], v[200:203]
    v_exp_f32 v163, v163
    v_mfma_f32_16x16x32_bf16 v[204:207], a[52:55], a[240:243], v[204:207]
    v_cvt_pk_bf16_f32 v170, v160, v161
    v_cvt_pk_bf16_f32 v171, v162, v163
    v_mfma_f32_16x16x32_bf16 v[208:211], a[56:59], a[240:243], v[208:211]
    ds_read_b128 v[160:163], v228 offset:640
    v_mfma_f32_16x16x32_bf16 v[196:199], a[216:219], v[168:171], 0
    v_exp_f32 v164, v164
    v_mfma_f32_16x16x32_bf16 v[184:187], v[76:79], v[168:171], 0
    v_exp_f32 v165, v165
    v_mfma_f32_16x16x32_bf16 v[188:191], v[98:101], v[168:171], 0
    v_exp_f32 v166, v166
    v_mfma_f32_16x16x32_bf16 v[192:195], v[120:123], v[168:171], 0
    v_exp_f32 v167, v167
    v_mfma_f32_16x16x32_bf16 v[212:215], a[240:243], a[120:123], v[212:215]
    v_cvt_pk_bf16_f32 v172, v164, v165
    v_cvt_pk_bf16_f32 v173, v166, v167
    v_mfma_f32_16x16x32_bf16 v[216:219], a[240:243], a[124:127], v[216:219]
    ds_read_b128 v[164:167], v229 offset:640
    v_mfma_f32_16x16x32_bf16 v[220:223], a[240:243], a[128:131], v[220:223]
    ds_read_b64_tr_b16 a[240:241], v240 offset:12296
    ds_read_b64_tr_b16 a[242:243], v240 offset:26120
    v_mfma_f32_16x16x32_bf16 v[200:203], a[60:63], a[244:247], v[200:203]
    v_exp_f32 v144, v144
    v_mfma_f32_16x16x32_bf16 v[204:207], a[64:67], a[244:247], v[204:207]
    v_exp_f32 v145, v145
    v_mfma_f32_16x16x32_bf16 v[208:211], a[68:71], a[244:247], v[208:211]
    v_exp_f32 v146, v146
    v_mfma_f32_16x16x32_bf16 v[212:215], a[244:247], a[132:135], v[212:215]
    v_exp_f32 v147, v147
    v_mfma_f32_16x16x32_bf16 v[216:219], a[244:247], a[136:139], v[216:219]
    v_cvt_pk_bf16_f32 v48, v200, v201
    v_cvt_pk_bf16_f32 v49, v202, v203
    v_mfma_f32_16x16x32_bf16 v[220:223], a[244:247], a[140:143], v[220:223]
    v_cvt_pk_bf16_f32 v50, v204, v205
    v_cvt_pk_bf16_f32 v51, v206, v207
    v_mfma_f32_16x16x32_bf16 v[176:179], a[220:223], a[248:251], 0
    s_waitcnt lgkmcnt(3)
    v_cvt_pk_bf16_f32 v52, v208, v209
    v_cvt_pk_bf16_f32 v53, v210, v211
    v_mfma_f32_16x16x32_bf16 v[156:159], v[48:51], v[138:141], v[156:159]
    v_cvt_pk_bf16_f32 v82, v212, v213
    v_cvt_pk_bf16_f32 v83, v214, v215
    v_mfma_f32_16x16x32_bf16 v[204:207], a[220:223], a[252:255], 0
    v_cvt_pk_bf16_f32 v104, v216, v217
    v_cvt_pk_bf16_f32 v105, v218, v219
    v_mfma_f32_16x16x32_bf16 v[180:183], a[224:227], a[248:251], 0
    v_cvt_pk_bf16_f32 v126, v220, v221
    v_cvt_pk_bf16_f32 v127, v222, v223
    v_mfma_f32_16x16x16_bf16 v[156:159], v[52:53], v[142:143], v[156:159]
    ds_read_b64_tr_b16 a[244:245], v241 offset:12288
    ds_read_b64_tr_b16 a[246:247], v241 offset:26112
    v_mfma_f32_16x16x32_bf16 v[208:211], a[224:227], a[252:255], 0
    v_cvt_pk_bf16_f32 v174, v144, v145
    v_cvt_pk_bf16_f32 v175, v146, v147
    v_mfma_f32_16x16x32_bf16 v[200:203], a[228:231], a[248:251], 0
    ds_read_b128 a[248:251], v239 offset:2048
    ds_read_b128 v[144:147], v229 offset:1280
    v_mfma_f32_16x16x32_bf16 v[196:199], a[216:219], v[172:175], v[196:199]
    v_exp_f32 v148, v148
    v_mfma_f32_16x16x32_bf16 v[184:187], v[68:71], v[172:175], v[184:187]
    v_exp_f32 v149, v149
    v_mfma_f32_16x16x32_bf16 v[188:191], v[90:93], v[172:175], v[188:191]
    v_exp_f32 v150, v150
    v_mfma_f32_16x16x32_bf16 v[192:195], v[112:115], v[172:175], v[192:195]
    v_exp_f32 v151, v151
    v_mfma_f32_16x16x32_bf16 v[212:215], a[228:231], a[252:255], 0
    ds_read_b128 a[252:255], v239 offset:8192
    v_cvt_pk_bf16_f32 v168, v148, v149
    v_mfma_f32_16x16x32_bf16 v[176:179], a[236:239], v[252:255], v[176:179]
    v_cvt_pk_bf16_f32 v169, v150, v151
    v_mfma_f32_16x16x32_bf16 v[204:207], a[236:239], a[232:235], v[204:207]
    s_waitcnt lgkmcnt(4)
    ds_read_b64_tr_b16 a[236:237], v241 offset:13824
    ds_read_b64_tr_b16 a[238:239], v241 offset:24576
    v_mfma_f32_16x16x32_bf16 v[180:183], a[240:243], v[252:255], v[180:183]
    ds_read_b128 v[148:151], v228 offset:1280
    v_mfma_f32_16x16x32_bf16 v[208:211], a[240:243], a[232:235], v[208:211]
    s_waitcnt lgkmcnt(6)
    ds_read_b128 a[240:243], v239 offset:3072
    v_mfma_f32_16x16x32_bf16 v[200:203], a[244:247], v[252:255], v[200:203]
    ds_read_b64_tr_b16 v[252:253], v240 offset:13824
    ds_read_b64_tr_b16 v[254:255], v240 offset:24576
    v_mfma_f32_16x16x32_bf16 v[212:215], a[244:247], a[232:235], v[212:215]
    s_waitcnt lgkmcnt(4)
    ds_read_b64_tr_b16 a[232:233], v240 offset:13832
    v_exp_f32 v152, v152
    v_exp_f32 v153, v153
    ds_read_b64_tr_b16 a[234:235], v240 offset:24584
    ds_read_b128 a[244:247], v239 offset:9216
    v_exp_f32 v154, v154
    v_exp_f32 v155, v155
    v_cvt_pk_bf16_f32 v170, v152, v153
    v_cvt_pk_bf16_f32 v171, v154, v155
    ds_read_b128 v[152:155], v228 offset:1920
    v_mfma_f32_16x16x32_bf16 v[200:203], a[236:239], a[248:251], v[200:203]
    v_exp_f32 v156, v156
    v_mfma_f32_16x16x32_bf16 v[196:199], a[216:219], v[168:171], v[196:199]
    v_exp_f32 v157, v157
    v_mfma_f32_16x16x32_bf16 v[184:187], v[84:87], v[168:171], v[184:187]
    v_exp_f32 v158, v158
    v_mfma_f32_16x16x32_bf16 v[188:191], v[106:109], v[168:171], v[188:191]
    v_exp_f32 v159, v159
    v_mfma_f32_16x16x32_bf16 v[192:195], v[128:131], v[168:171], v[192:195]
    s_waitcnt lgkmcnt(4)
    v_cvt_pk_bf16_f32 v172, v156, v157
    v_cvt_pk_bf16_f32 v173, v158, v159
    v_mfma_f32_16x16x32_bf16 v[176:179], v[252:255], a[248:251], v[176:179]
    ds_read_b128 v[156:159], v229 offset:1920
    v_mfma_f32_16x16x16_bf16 v[196:199], a[216:217], v[172:173], v[196:199]
    v_mfma_f32_16x16x16_bf16 v[184:187], v[82:83], v[172:173], v[184:187]
    v_mfma_f32_16x16x16_bf16 v[188:191], v[104:105], v[172:173], v[188:191]
    v_mfma_f32_16x16x16_bf16 v[192:195], v[126:127], v[172:173], v[192:195]
    v_mfma_f32_16x16x32_bf16 v[204:207], v[252:255], a[252:255], v[204:207]
    s_waitcnt lgkmcnt(2)
    ds_read_b64_tr_b16 v[252:253], v241 offset:36864
    ds_read_b64_tr_b16 v[254:255], v241 offset:38400
    v_mfma_f32_16x16x32_bf16 v[180:183], a[232:235], a[248:251], v[180:183]
    ds_read_b64_tr_b16 a[248:249], v240 offset:36864
    ds_read_b64_tr_b16 a[250:251], v240 offset:38400
    v_mfma_f32_16x16x32_bf16 v[208:211], a[232:235], a[252:255], v[208:211]
    ds_read_b128 a[232:235], v239 offset:4096
    v_mfma_f32_16x16x32_bf16 v[212:215], a[236:239], a[252:255], v[212:215]
    s_waitcnt lgkmcnt(3)
    ds_read_b64_tr_b16 a[252:253], v240 offset:36872
    ds_read_b64_tr_b16 a[254:255], v240 offset:38408
    v_rcp_f32 v197, v196
    ds_read_b128 a[236:239], v239 offset:10240
    v_mul_f32 v184, v184, v197
    v_mul_f32 v185, v185, v197
    v_cvt_pk_bf16_f32 v184, v184, v185
    v_mul_f32 v186, v186, v197
    v_mul_f32 v187, v187, v197
    v_cvt_pk_bf16_f32 v185, v186, v187
    v_mul_f32 v188, v188, v197
    v_mul_f32 v189, v189, v197
    v_cvt_pk_bf16_f32 v186, v188, v189
    v_mul_f32 v190, v190, v197
    v_mul_f32 v191, v191, v197
    v_cvt_pk_bf16_f32 v187, v190, v191
    v_mul_f32 v192, v192, v197
    v_mfma_f32_16x16x32_bf16 v[200:203], v[252:255], a[240:243], v[200:203]
    v_mul_f32 v193, v193, v197
    v_cvt_pk_bf16_f32 v188, v192, v193
    v_mfma_f32_16x16x32_bf16 v[212:215], v[252:255], a[244:247], v[212:215]
    s_waitcnt lgkmcnt(4)
    ds_read_b128 v[252:255], v239 offset:11264
    v_mul_f32 v194, v194, v197
    v_mfma_f32_16x16x32_bf16 v[176:179], a[248:251], a[240:243], v[176:179]
    v_mul_f32 v195, v195, v197
    v_cvt_pk_bf16_f32 v189, v194, v195
    v_mfma_f32_16x16x32_bf16 v[204:207], a[248:251], a[244:247], v[204:207]
    s_waitcnt lgkmcnt(2)
    ds_read_b64_tr_b16 a[248:249], v241 offset:49152
    ds_read_b64_tr_b16 a[250:251], v241 offset:62976
    v_max3_f32 v250, v250, v196, v197
    ds_write_b128 v237, v[184:187] offset:18432
    v_mfma_f32_16x16x32_bf16 v[180:183], a[252:255], a[240:243], v[180:183]
    ds_read_b64_tr_b16 a[240:241], v240 offset:49152
    ds_read_b64_tr_b16 a[242:243], v240 offset:62976
    v_mfma_f32_16x16x32_bf16 v[208:211], a[252:255], a[244:247], v[208:211]
    s_waitcnt lgkmcnt(3)
    ds_read_b64_tr_b16 a[244:245], v240 offset:49160
    ds_read_b64_tr_b16 a[246:247], v240 offset:62984
    ds_read_b128 a[252:255], v239 offset:5120
    ds_write_b64 v238, v[188:189] offset:18432
    v_mfma_f32_16x16x32_bf16 v[200:203], a[248:251], a[232:235], v[200:203]
    v_mfma_f32_16x16x32_bf16 v[212:215], a[248:251], a[236:239], v[212:215]
    s_waitcnt lgkmcnt(4)
    ds_read_b128 a[248:251], v225 offset:24448
    v_mfma_f32_16x16x32_bf16 v[176:179], a[240:243], a[232:235], v[176:179]
    v_mfma_f32_16x16x32_bf16 v[204:207], a[240:243], a[236:239], v[204:207]
    s_waitcnt lgkmcnt(3)
    ds_read_b64_tr_b16 a[240:241], v241 offset:50688
    ds_read_b64_tr_b16 a[242:243], v241 offset:61440
    v_mfma_f32_16x16x32_bf16 v[180:183], a[244:247], a[232:235], v[180:183]
    ds_read_b64_tr_b16 a[232:233], v240 offset:50688
    ds_read_b64_tr_b16 a[234:235], v240 offset:61440
    v_mfma_f32_16x16x32_bf16 v[208:211], a[244:247], a[236:239], v[208:211]
    s_waitcnt lgkmcnt(2)
    ds_read_b64_tr_b16 a[236:237], v240 offset:50696
    ds_read_b64_tr_b16 a[238:239], v240 offset:61448
    ds_read_b128 a[244:247], v225 offset:24384
    v_mfma_f32_16x16x32_bf16 v[200:203], a[240:243], a[252:255], v[200:203]
    v_mfma_f32_16x16x32_bf16 v[212:215], a[240:243], v[252:255], v[212:215]
    s_waitcnt lgkmcnt(3)
    ds_read_b128 a[240:243], v224 offset:46464
    v_mfma_f32_16x16x32_bf16 v[176:179], a[232:235], a[252:255], v[176:179]
    v_mfma_f32_16x16x32_bf16 v[204:207], a[232:235], v[252:255], v[204:207]
    s_waitcnt lgkmcnt(2)
    ds_read_b128 a[232:235], v225 offset:24640
    v_mfma_f32_16x16x32_bf16 v[180:183], a[236:239], a[252:255], v[180:183]
    ds_read_b128 a[252:255], v225 offset:24512
    v_mfma_f32_16x16x32_bf16 v[208:211], a[236:239], v[252:255], v[208:211]
    s_waitcnt lgkmcnt(3)
    ds_read_b128 v[252:255], v225 offset:24576
    v_cvt_pk_bf16_f32 v200, v200, v201
    v_mfma_f32_16x16x32_bf16 v[216:219], a[144:147], a[244:247], 0
    v_cvt_pk_bf16_f32 v176, v176, v177
    v_cvt_pk_bf16_f32 v177, v178, v179
    v_mfma_f32_16x16x32_bf16 v[220:223], a[148:151], a[244:247], 0
    v_cvt_pk_bf16_f32 v178, v180, v181
    v_cvt_pk_bf16_f32 v179, v182, v183
    v_mfma_f32_16x16x32_bf16 v[216:219], a[156:159], a[248:251], v[216:219]
    buffer_store_dwordx4 v[176:179], v242, s[20:23], s58 offen sc0 sc1
    v_mfma_f32_16x16x32_bf16 v[220:223], a[160:163], a[248:251], v[220:223]
    v_cvt_pk_bf16_f32 v201, v202, v203
    v_cvt_pk_bf16_f32 v204, v204, v205
    v_mfma_f32_16x16x32_bf16 v[176:179], a[152:155], a[244:247], 0
    s_waitcnt lgkmcnt(1)
    buffer_store_dwordx2 v[200:201], v243, s[20:23], s58 offen sc0 sc1
    v_mfma_f32_16x16x32_bf16 v[176:179], a[164:167], a[248:251], v[176:179]
    s_add_u32 s58, s51, 0xfc000
    v_cvt_pk_bf16_f32 v205, v206, v207
    v_cvt_pk_bf16_f32 v206, v208, v209
    v_mfma_f32_16x16x32_bf16 v[216:219], a[168:171], a[252:255], v[216:219]
    v_cvt_pk_bf16_f32 v207, v210, v211
    v_cvt_pk_bf16_f32 v212, v212, v213
    v_mfma_f32_16x16x32_bf16 v[220:223], a[172:175], a[252:255], v[220:223]
    buffer_store_dwordx4 v[204:207], v244, s[20:23], s59 offen sc0 sc1
    v_mfma_f32_16x16x32_bf16 v[176:179], a[176:179], a[252:255], v[176:179]
    s_waitcnt lgkmcnt(0)
    ds_read_b128 a[236:239], v225 offset:24704
    v_cvt_pk_bf16_f32 v213, v214, v215
    v_mfma_f32_16x16x32_bf16 v[216:219], a[180:183], v[252:255], v[216:219]
    buffer_store_dwordx2 v[212:213], v245, s[20:23], s59 offen sc0 sc1
    v_mfma_f32_16x16x32_bf16 v[220:223], a[184:187], v[252:255], v[220:223]
    s_add_u32 s59, s51, 0xfd800
    ds_read_b128 a[244:247], v224 offset:46528
    ds_read_b128 a[248:251], v224 offset:46592
    v_mfma_f32_16x16x32_bf16 v[176:179], a[188:191], v[252:255], v[176:179]
    ds_read_b128 a[252:255], v224 offset:46656
    ds_read_b128 v[252:255], v224 offset:46720
    v_mfma_f32_16x16x32_bf16 v[216:219], a[192:195], a[232:235], v[216:219]
    v_mfma_f32_16x16x32_bf16 v[220:223], a[196:199], a[232:235], v[220:223]
    v_mfma_f32_16x16x32_bf16 v[176:179], a[200:203], a[232:235], v[176:179]
    ds_read_b128 a[232:235], v224 offset:46784
    v_mfma_f32_16x16x32_bf16 v[180:183], a[0:3], a[240:243], 0
    v_mfma_f32_16x16x32_bf16 v[200:203], a[4:7], a[240:243], 0
    s_waitcnt lgkmcnt(5)
    v_mfma_f32_16x16x32_bf16 v[216:219], a[204:207], a[236:239], v[216:219]
    v_mfma_f32_16x16x32_bf16 v[220:223], a[208:211], a[236:239], v[220:223]
    v_mfma_f32_16x16x32_bf16 v[176:179], a[212:215], a[236:239], v[176:179]
    ds_read_b128 a[236:239], v224 offset:49536
    v_mfma_f32_16x16x32_bf16 v[204:207], a[8:11], a[240:243], 0
    v_mfma_f32_16x16x32_bf16 v[208:211], a[240:243], a[72:75], 0
    v_mfma_f32_16x16x32_bf16 v[212:215], a[240:243], a[76:79], 0
    s_waitcnt lgkmcnt(3)
    v_mfma_f32_16x16x32_bf16 v[180:183], a[12:15], a[244:247], v[180:183]
    v_mfma_f32_16x16x32_bf16 v[200:203], a[16:19], a[244:247], v[200:203]
    v_mul_f32 v216, s37, v216
    v_mul_f32 v217, s37, v217
    v_mfma_f32_16x16x32_bf16 v[204:207], a[20:23], a[244:247], v[204:207]
    v_mul_f32 v218, s37, v218
    v_mul_f32 v219, s37, v219
    v_mfma_f32_16x16x32_bf16 v[208:211], a[244:247], a[84:87], v[208:211]
    v_cvt_pk_bf16_f32 v132, v216, v217
    v_cvt_pk_bf16_f32 v133, v218, v219
    v_mfma_f32_16x16x32_bf16 v[216:219], a[240:243], a[80:83], 0
    v_mul_f32 v220, s37, v220
    v_mul_f32 v221, s37, v221
    v_mfma_f32_16x16x32_bf16 v[212:215], a[244:247], a[88:91], v[212:215]
    v_mul_f32 v222, s37, v222
    v_mul_f32 v223, s37, v223
    v_mfma_f32_16x16x32_bf16 v[216:219], a[244:247], a[92:95], v[216:219]
    v_cvt_pk_bf16_f32 v134, v220, v221
    v_cvt_pk_bf16_f32 v135, v222, v223
    v_mfma_f32_16x16x32_bf16 v[180:183], a[24:27], a[248:251], v[180:183]
    v_mul_f32 v176, s37, v176
    v_mul_f32 v177, s37, v177
    v_mfma_f32_16x16x32_bf16 v[160:163], v[0:3], v[132:135], v[160:163]
    v_mul_f32 v178, s37, v178
    v_mul_f32 v179, s37, v179
    v_mfma_f32_16x16x32_bf16 v[164:167], v[24:27], v[132:135], v[164:167]
    v_cvt_pk_bf16_f32 v136, v176, v177
    v_cvt_pk_bf16_f32 v137, v178, v179
    v_mfma_f32_16x16x32_bf16 v[144:147], v[30:33], v[132:135], v[144:147]
    ds_read_b128 a[240:243], v224 offset:49600
    ds_read_b128 a[244:247], v224 offset:49664
    v_mfma_f32_16x16x16_bf16 v[160:163], v[4:5], v[136:137], v[160:163]
    v_mfma_f32_16x16x16_bf16 v[164:167], v[28:29], v[136:137], v[164:167]
    v_mfma_f32_16x16x32_bf16 v[148:151], v[6:9], v[132:135], v[148:151]
    v_mfma_f32_16x16x32_bf16 v[152:155], v[12:15], v[132:135], v[152:155]
    v_mfma_f32_16x16x16_bf16 v[144:147], v[34:35], v[136:137], v[144:147]
    v_mfma_f32_16x16x32_bf16 v[156:159], v[36:39], v[132:135], v[156:159]
    v_mfma_f32_16x16x32_bf16 v[200:203], a[28:31], a[248:251], v[200:203]
    v_mfma_f32_16x16x32_bf16 v[204:207], a[32:35], a[248:251], v[204:207]
    v_mfma_f32_16x16x32_bf16 v[208:211], a[248:251], a[96:99], v[208:211]
    v_exp_f32 v160, v160
    v_mfma_f32_16x16x16_bf16 v[148:151], v[10:11], v[136:137], v[148:151]
    v_exp_f32 v161, v161
    v_mfma_f32_16x16x16_bf16 v[152:155], v[16:17], v[136:137], v[152:155]
    v_exp_f32 v162, v162
    v_mfma_f32_16x16x16_bf16 v[156:159], v[40:41], v[136:137], v[156:159]
    v_exp_f32 v163, v163
    v_mfma_f32_16x16x32_bf16 v[212:215], a[248:251], a[100:103], v[212:215]
    v_cvt_pk_bf16_f32 v168, v160, v161
    v_cvt_pk_bf16_f32 v169, v162, v163
    v_mfma_f32_16x16x32_bf16 v[216:219], a[248:251], a[104:107], v[216:219]
    ds_read_b128 a[248:251], v224 offset:49728
    ds_read_b128 v[160:163], v229 offset:2560
    v_mfma_f32_16x16x32_bf16 v[180:183], a[36:39], a[252:255], v[180:183]
    v_exp_f32 v164, v164
    v_mfma_f32_16x16x32_bf16 v[200:203], a[40:43], a[252:255], v[200:203]
    v_exp_f32 v165, v165
    v_mfma_f32_16x16x32_bf16 v[204:207], a[44:47], a[252:255], v[204:207]
    v_exp_f32 v166, v166
    v_mfma_f32_16x16x32_bf16 v[208:211], a[252:255], a[108:111], v[208:211]
    v_exp_f32 v167, v167
    v_mfma_f32_16x16x32_bf16 v[212:215], a[252:255], a[112:115], v[212:215]
    v_cvt_pk_bf16_f32 v170, v164, v165
    v_cvt_pk_bf16_f32 v171, v166, v167
    v_mfma_f32_16x16x32_bf16 v[216:219], a[252:255], a[116:119], v[216:219]
    ds_read_b128 a[252:255], v224 offset:49792
    ds_read_b128 v[164:167], v228 offset:2560
    v_mfma_f32_16x16x32_bf16 v[196:199], a[216:219], v[168:171], 0
    v_exp_f32 v144, v144
    v_mfma_f32_16x16x32_bf16 v[184:187], v[66:69], v[168:171], 0
    v_exp_f32 v145, v145
    v_mfma_f32_16x16x32_bf16 v[188:191], v[88:91], v[168:171], 0
    v_exp_f32 v146, v146
    v_mfma_f32_16x16x32_bf16 v[192:195], v[110:113], v[168:171], 0
    s_waitcnt lgkmcnt(3)
    v_exp_f32 v147, v147
    v_mfma_f32_16x16x32_bf16 v[180:183], a[48:51], v[252:255], v[180:183]
    v_cvt_pk_bf16_f32 v172, v144, v145
    v_cvt_pk_bf16_f32 v173, v146, v147
    v_mfma_f32_16x16x32_bf16 v[200:203], a[52:55], v[252:255], v[200:203]
    ds_read_b128 v[144:147], v230 offset:640
    v_mfma_f32_16x16x32_bf16 v[204:207], a[56:59], v[252:255], v[204:207]
    v_exp_f32 v148, v148
    v_mfma_f32_16x16x32_bf16 v[208:211], v[252:255], a[120:123], v[208:211]
    v_exp_f32 v149, v149
    v_mfma_f32_16x16x32_bf16 v[212:215], v[252:255], a[124:127], v[212:215]
    v_exp_f32 v150, v150
    v_mfma_f32_16x16x32_bf16 v[216:219], v[252:255], a[128:131], v[216:219]
    ds_read_b128 v[252:255], v224 offset:49856
    v_cvt_pk_bf16_f32 v174, v148, v149
    v_mfma_f32_16x16x32_bf16 v[180:183], a[60:63], a[232:235], v[180:183]
    v_exp_f32 v151, v151
    v_mfma_f32_16x16x32_bf16 v[200:203], a[64:67], a[232:235], v[200:203]
    v_cvt_pk_bf16_f32 v175, v150, v151
    v_mfma_f32_16x16x32_bf16 v[204:207], a[68:71], a[232:235], v[204:207]
    ds_read_b128 v[148:151], v230 offset:1280
    v_mfma_f32_16x16x32_bf16 v[196:199], a[216:219], v[172:175], v[196:199]
    v_exp_f32 v152, v152
    v_mfma_f32_16x16x32_bf16 v[184:187], v[70:73], v[172:175], v[184:187]
    v_cvt_pk_bf16_f32 v18, v180, v181
    v_cvt_pk_bf16_f32 v19, v182, v183
    v_mfma_f32_16x16x32_bf16 v[188:191], v[92:95], v[172:175], v[188:191]
    v_cvt_pk_bf16_f32 v20, v200, v201
    v_cvt_pk_bf16_f32 v21, v202, v203
    v_mfma_f32_16x16x32_bf16 v[192:195], v[114:117], v[172:175], v[192:195]
    s_waitcnt lgkmcnt(2)
    v_cvt_pk_bf16_f32 v22, v204, v205
    v_cvt_pk_bf16_f32 v23, v206, v207
    v_mfma_f32_16x16x32_bf16 v[164:167], v[18:21], v[132:135], v[164:167]
    v_exp_f32 v153, v153
    v_mfma_f32_16x16x32_bf16 v[208:211], a[232:235], a[132:135], v[208:211]
    v_exp_f32 v154, v154
    v_mfma_f32_16x16x32_bf16 v[212:215], a[232:235], a[136:139], v[212:215]
    v_exp_f32 v155, v155
    v_mfma_f32_16x16x32_bf16 v[216:219], a[232:235], a[140:143], v[216:219]
    ds_read_b128 a[232:235], v225 offset:27456
    v_cvt_pk_bf16_f32 v168, v152, v153
    v_mfma_f32_16x16x16_bf16 v[164:167], v[22:23], v[136:137], v[164:167]
    v_cvt_pk_bf16_f32 v169, v154, v155
    v_cvt_pk_bf16_f32 v80, v208, v209
    v_mfma_f32_16x16x32_bf16 v[220:223], a[0:3], a[236:239], 0
    v_cvt_pk_bf16_f32 v81, v210, v211
    v_cvt_pk_bf16_f32 v102, v212, v213
    v_mfma_f32_16x16x32_bf16 v[176:179], a[4:7], a[236:239], 0
    v_cvt_pk_bf16_f32 v103, v214, v215
    v_cvt_pk_bf16_f32 v124, v216, v217
    v_mfma_f32_16x16x32_bf16 v[180:183], a[8:11], a[236:239], 0
    ds_read_b128 v[152:155], v230 offset:1920
    v_cvt_pk_bf16_f32 v125, v218, v219
    v_mfma_f32_16x16x32_bf16 v[200:203], a[236:239], a[72:75], 0
    v_exp_f32 v156, v156
    v_mfma_f32_16x16x32_bf16 v[204:207], a[236:239], a[76:79], 0
    v_exp_f32 v157, v157
    v_mfma_f32_16x16x32_bf16 v[208:211], a[236:239], a[80:83], 0
    ds_read_b128 a[236:239], v225 offset:27520
    v_cvt_pk_bf16_f32 v170, v156, v157
    v_mfma_f32_16x16x32_bf16 v[220:223], a[12:15], a[240:243], v[220:223]
    v_exp_f32 v158, v158
    v_mfma_f32_16x16x32_bf16 v[176:179], a[16:19], a[240:243], v[176:179]
    v_exp_f32 v159, v159
    v_mfma_f32_16x16x32_bf16 v[180:183], a[20:23], a[240:243], v[180:183]
    v_cvt_pk_bf16_f32 v171, v158, v159
    v_mfma_f32_16x16x32_bf16 v[200:203], a[240:243], a[84:87], v[200:203]
    ds_read_b128 v[156:159], v230 offset:2560
    v_mfma_f32_16x16x32_bf16 v[196:199], a[216:219], v[168:171], v[196:199]
    v_exp_f32 v164, v164
    v_mfma_f32_16x16x32_bf16 v[184:187], v[74:77], v[168:171], v[184:187]
    v_exp_f32 v165, v165
    v_mfma_f32_16x16x32_bf16 v[188:191], v[96:99], v[168:171], v[188:191]
    v_exp_f32 v166, v166
    v_mfma_f32_16x16x32_bf16 v[192:195], v[118:121], v[168:171], v[192:195]
    v_exp_f32 v167, v167
    v_mfma_f32_16x16x32_bf16 v[204:207], a[240:243], a[88:91], v[204:207]
    v_cvt_pk_bf16_f32 v174, v164, v165
    v_cvt_pk_bf16_f32 v175, v166, v167
    v_mfma_f32_16x16x32_bf16 v[208:211], a[240:243], a[92:95], v[208:211]
    ds_read_b128 a[240:243], v225 offset:27584
    ds_read_b128 v[164:167], v236
    v_mfma_f32_16x16x32_bf16 v[220:223], a[24:27], a[244:247], v[220:223]
    v_bfe_u32 v236, s74, v232, 4
    v_mfma_f32_16x16x32_bf16 v[176:179], a[28:31], a[244:247], v[176:179]
    v_mfma_f32_16x16x32_bf16 v[180:183], a[32:35], a[244:247], v[180:183]
    v_mfma_f32_16x16x32_bf16 v[200:203], a[244:247], a[96:99], v[200:203]
    v_mfma_f32_16x16x32_bf16 v[204:207], a[244:247], a[100:103], v[204:207]
    v_mfma_f32_16x16x32_bf16 v[208:211], a[244:247], a[104:107], v[208:211]
    ds_read_b128 a[244:247], v225 offset:27648
    v_mfma_f32_16x16x32_bf16 v[220:223], a[36:39], a[248:251], v[220:223]
    v_mfma_f32_16x16x32_bf16 v[176:179], a[40:43], a[248:251], v[176:179]
    v_mfma_f32_16x16x32_bf16 v[180:183], a[44:47], a[248:251], v[180:183]
    v_mfma_f32_16x16x32_bf16 v[200:203], a[248:251], a[108:111], v[200:203]
    v_mfma_f32_16x16x32_bf16 v[204:207], a[248:251], a[112:115], v[204:207]
    v_mfma_f32_16x16x32_bf16 v[208:211], a[248:251], a[116:119], v[208:211]
    ds_read_b128 a[248:251], v225 offset:27712
    v_mfma_f32_16x16x32_bf16 v[220:223], a[48:51], a[252:255], v[220:223]
    v_mfma_f32_16x16x32_bf16 v[176:179], a[52:55], a[252:255], v[176:179]
    v_mfma_f32_16x16x32_bf16 v[180:183], a[56:59], a[252:255], v[180:183]
    v_mfma_f32_16x16x32_bf16 v[200:203], a[252:255], a[120:123], v[200:203]
    v_mfma_f32_16x16x32_bf16 v[204:207], a[252:255], a[124:127], v[204:207]
    v_mfma_f32_16x16x32_bf16 v[208:211], a[252:255], a[128:131], v[208:211]
    s_waitcnt lgkmcnt(1)
    ds_read_b128 a[252:255], v225 offset:27776
    v_mfma_f32_16x16x32_bf16 v[220:223], a[60:63], v[252:255], v[220:223]
    v_mfma_f32_16x16x32_bf16 v[176:179], a[64:67], v[252:255], v[176:179]
    v_mfma_f32_16x16x32_bf16 v[180:183], a[68:71], v[252:255], v[180:183]
    v_mfma_f32_16x16x32_bf16 v[200:203], v[252:255], a[132:135], v[200:203]
    v_mfma_f32_16x16x32_bf16 v[204:207], v[252:255], a[136:139], v[204:207]
    v_mfma_f32_16x16x32_bf16 v[208:211], v[252:255], a[140:143], v[208:211]
    v_mfma_f32_16x16x32_bf16 v[212:215], a[144:147], a[232:235], 0
    s_waitcnt vmcnt(4) lgkmcnt(0)
    v_mfma_f32_16x16x32_bf16 v[216:219], a[148:151], a[232:235], 0
    s_barrier
    v_cvt_pk_bf16_f32 v42, v220, v221
    v_mfma_f32_16x16x32_bf16 v[212:215], a[156:159], a[236:239], v[212:215]
    v_cvt_pk_bf16_f32 v43, v222, v223
    v_cvt_pk_bf16_f32 v44, v176, v177
    v_mfma_f32_16x16x32_bf16 v[220:223], a[152:155], a[232:235], 0
    v_cvt_pk_bf16_f32 v45, v178, v179
    v_cvt_pk_bf16_f32 v46, v180, v181
    v_mfma_f32_16x16x32_bf16 v[216:219], a[160:163], a[236:239], v[216:219]
    v_cvt_pk_bf16_f32 v47, v182, v183
    v_cvt_pk_bf16_f32 v78, v200, v201
    v_mfma_f32_16x16x32_bf16 v[160:163], v[42:45], v[132:135], v[160:163]
    v_cvt_pk_bf16_f32 v79, v202, v203
    v_cvt_pk_bf16_f32 v100, v204, v205
    v_mfma_f32_16x16x32_bf16 v[220:223], a[164:167], a[236:239], v[220:223]
    v_cvt_pk_bf16_f32 v101, v206, v207
    v_cvt_pk_bf16_f32 v122, v208, v209
    v_mfma_f32_16x16x32_bf16 v[212:215], a[168:171], a[240:243], v[212:215]
    ds_read_b128 v[252:255], v239 offset:12288
    v_cvt_pk_bf16_f32 v123, v210, v211
    v_mfma_f32_16x16x16_bf16 v[160:163], v[46:47], v[136:137], v[160:163]
    buffer_load_dwordx4 v246, s[4:7], s47 offen lds
    v_mfma_f32_16x16x32_bf16 v[216:219], a[172:175], a[240:243], v[216:219]
    s_add_u32 m0, s42, 0x3c80
    ds_read_b128 a[232:235], v239 offset:18432
    ds_read_b128 a[236:239], v239 offset:13312
    v_mfma_f32_16x16x32_bf16 v[220:223], a[176:179], a[240:243], v[220:223]
    buffer_load_dwordx4 v247, s[4:7], s47 offen lds
    v_mfma_f32_16x16x32_bf16 v[212:215], a[180:183], a[244:247], v[212:215]
    s_add_u32 m0, s41, 0x5ac0
    ds_read_b128 a[240:243], v239 offset:19456
    v_mfma_f32_16x16x32_bf16 v[216:219], a[184:187], a[244:247], v[216:219]
    buffer_load_dwordx4 v246, s[4:7], s48 offen lds
    v_mfma_f32_16x16x32_bf16 v[220:223], a[188:191], a[244:247], v[220:223]
    s_add_u32 m0, s42, 0x5ac0
    ds_read_b64_tr_b16 a[244:245], v240 offset:12288
    ds_read_b64_tr_b16 a[246:247], v240 offset:26112
    v_mfma_f32_16x16x32_bf16 v[212:215], a[192:195], a[248:251], v[212:215]
    buffer_load_dwordx4 v247, s[4:7], s48 offen lds
    v_mfma_f32_16x16x32_bf16 v[216:219], a[196:199], a[248:251], v[216:219]
    v_exp_f32 v160, v160
    v_mfma_f32_16x16x32_bf16 v[220:223], a[200:203], a[248:251], v[220:223]
    ds_read_b64_tr_b16 a[248:249], v240 offset:12296
    ds_read_b64_tr_b16 a[250:251], v240 offset:26120
    v_mfma_f32_16x16x32_bf16 v[212:215], a[204:207], a[252:255], v[212:215]
    v_exp_f32 v161, v161
    v_mfma_f32_16x16x32_bf16 v[216:219], a[208:211], a[252:255], v[216:219]
    v_exp_f32 v162, v162
    v_mfma_f32_16x16x32_bf16 v[220:223], a[212:215], a[252:255], v[220:223]
    s_waitcnt lgkmcnt(6)
    ds_read_b64_tr_b16 a[252:253], v241 offset:12288
    ds_read_b64_tr_b16 a[254:255], v241 offset:26112
    v_mfma_f32_16x16x32_bf16 v[176:179], a[220:223], v[252:255], 0
    v_exp_f32 v163, v163
    v_mfma_f32_16x16x32_bf16 v[204:207], a[220:223], a[232:235], 0
    v_mul_f32 v212, s37, v212
    v_mul_f32 v213, s37, v213
    v_mfma_f32_16x16x32_bf16 v[180:183], a[224:227], v[252:255], 0
    v_mul_f32 v214, s37, v214
    v_mul_f32 v215, s37, v215
    v_mfma_f32_16x16x32_bf16 v[208:211], a[224:227], a[232:235], 0
    v_cvt_pk_bf16_f32 v138, v212, v213
    v_cvt_pk_bf16_f32 v139, v214, v215
    v_mfma_f32_16x16x32_bf16 v[200:203], a[228:231], v[252:255], 0
L_pg6:
    s_cbranch_execz L_back
    v_mul_f32 v216, s37, v216
    v_mul_f32 v217, s37, v217
    v_mfma_f32_16x16x32_bf16 v[212:215], a[228:231], a[232:235], 0
    s_waitcnt lgkmcnt(4)
    v_mul_f32 v218, s37, v218
    v_mul_f32 v219, s37, v219
    v_mfma_f32_16x16x32_bf16 v[176:179], a[244:247], a[236:239], v[176:179]
    v_cvt_pk_bf16_f32 v140, v216, v217
    v_cvt_pk_bf16_f32 v141, v218, v219
    v_mfma_f32_16x16x32_bf16 v[204:207], a[244:247], a[240:243], v[204:207]
    v_mul_f32 v220, s37, v220
    v_mul_f32 v221, s37, v221
    v_mfma_f32_16x16x32_bf16 v[144:147], v[24:27], v[138:141], v[144:147]
    v_mul_f32 v222, s37, v222
    v_mul_f32 v223, s37, v223
    v_mfma_f32_16x16x32_bf16 v[148:151], v[30:33], v[138:141], v[148:151]
    v_cvt_pk_bf16_f32 v142, v220, v221
    v_cvt_pk_bf16_f32 v143, v222, v223
    v_mfma_f32_16x16x32_bf16 v[152:155], v[36:39], v[138:141], v[152:155]
    ds_read_b128 v[252:255], v239 offset:14336
    ds_read_b128 a[232:235], v239 offset:20480
    v_mfma_f32_16x16x16_bf16 v[144:147], v[28:29], v[142:143], v[144:147]
    ds_read_b64_tr_b16 a[244:245], v241 offset:13824
    ds_read_b64_tr_b16 a[246:247], v241 offset:24576
    v_mfma_f32_16x16x16_bf16 v[148:151], v[34:35], v[142:143], v[148:151]
    v_cvt_pk_bf16_f32 v172, v160, v161
    v_cvt_pk_bf16_f32 v173, v162, v163
    v_mfma_f32_16x16x16_bf16 v[152:155], v[40:41], v[142:143], v[152:155]
    ds_read_b128 v[160:163], v235
    v_mad_u32_u24 v235, v234, s40, v229
    v_mfma_f32_16x16x32_bf16 v[196:199], a[216:219], v[172:175], v[196:199]
    v_mad_u32_u24 v234, v234, s40, v228
    v_mfma_f32_16x16x32_bf16 v[184:187], v[78:81], v[172:175], v[184:187]
    v_exp_f32 v144, v144
    v_mfma_f32_16x16x32_bf16 v[188:191], v[100:103], v[172:175], v[188:191]
    v_exp_f32 v145, v145
    v_mfma_f32_16x16x32_bf16 v[192:195], v[122:125], v[172:175], v[192:195]
    v_exp_f32 v146, v146
    v_mfma_f32_16x16x32_bf16 v[156:159], v[42:45], v[138:141], v[156:159]
    v_rcp_f32 v197, v196
    v_mfma_f32_16x16x32_bf16 v[164:167], v[48:51], v[138:141], v[164:167]
    s_waitcnt lgkmcnt(5)
    v_mul_f32 v184, v184, v197
    v_mul_f32 v185, v185, v197
    v_mfma_f32_16x16x32_bf16 v[180:183], a[248:251], a[236:239], v[180:183]
    v_cvt_pk_bf16_f32 v184, v184, v185
    v_mul_f32 v186, v186, v197
    v_mfma_f32_16x16x16_bf16 v[156:159], v[46:47], v[142:143], v[156:159]
    v_mul_f32 v187, v187, v197
    v_cvt_pk_bf16_f32 v185, v186, v187
    v_mfma_f32_16x16x16_bf16 v[164:167], v[52:53], v[142:143], v[164:167]
    s_waitcnt lgkmcnt(0)
    v_mul_f32 v188, v188, v197
    v_mul_f32 v189, v189, v197
    v_mfma_f32_16x16x32_bf16 v[160:163], v[60:63], v[138:141], v[160:163]
    v_cvt_pk_bf16_f32 v186, v188, v189
    v_mul_f32 v190, v190, v197
    v_mfma_f32_16x16x32_bf16 v[208:211], a[248:251], a[240:243], v[208:211]
    ds_read_b128 a[248:251], v239 offset:15360
    v_mul_f32 v191, v191, v197
    v_mfma_f32_16x16x32_bf16 v[200:203], a[252:255], a[236:239], v[200:203]
    ds_read_b64_tr_b16 a[236:237], v240 offset:13824
    ds_read_b64_tr_b16 a[238:239], v240 offset:24576
    v_mfma_f32_16x16x16_bf16 v[160:163], v[64:65], v[142:143], v[160:163]
    v_cvt_pk_bf16_f32 v187, v190, v191
    v_mul_f32 v192, v192, v197
    v_mfma_f32_16x16x32_bf16 v[212:215], a[252:255], a[240:243], v[212:215]
    ds_read_b64_tr_b16 a[240:241], v240 offset:13832
    ds_read_b64_tr_b16 a[242:243], v240 offset:24584
    v_mfma_f32_16x16x32_bf16 v[200:203], a[244:247], v[252:255], v[200:203]
    ds_read_b128 a[252:255], v239 offset:21504
    v_mul_f32 v193, v193, v197
    v_mfma_f32_16x16x32_bf16 v[212:215], a[244:247], a[232:235], v[212:215]
    s_waitcnt lgkmcnt(3)
    ds_read_b128 a[244:247], v239 offset:22528
    v_cvt_pk_bf16_f32 v188, v192, v193
    v_mul_f32 v194, v194, v197
    v_mul_f32 v195, v195, v197
    v_cvt_pk_bf16_f32 v189, v194, v195
    v_max3_f32 v250, v250, v196, v197
    ds_write_b128 v237, v[184:187]
    ds_write_b64 v238, v[188:189]
    v_exp_f32 v147, v147
    v_cvt_pk_bf16_f32 v168, v144, v145
    v_cvt_pk_bf16_f32 v169, v146, v147
    v_mfma_f32_16x16x32_bf16 v[176:179], a[236:239], v[252:255], v[176:179]
    ds_read_b128 v[144:147], v235
    v_bfe_u32 v235, s74, v232, 4
    v_mfma_f32_16x16x32_bf16 v[204:207], a[236:239], a[232:235], v[204:207]
    s_waitcnt lgkmcnt(5)
    ds_read_b64_tr_b16 a[236:237], v241 offset:36864
    ds_read_b64_tr_b16 a[238:239], v241 offset:38400
    v_mfma_f32_16x16x32_bf16 v[180:183], a[240:243], v[252:255], v[180:183]
    ds_read_b64_tr_b16 v[252:253], v240 offset:36864
    ds_read_b64_tr_b16 v[254:255], v240 offset:38400
    v_mfma_f32_16x16x32_bf16 v[208:211], a[240:243], a[232:235], v[208:211]
    ds_read_b64_tr_b16 a[232:233], v240 offset:36872
    v_mad_u32_u24 v235, v235, s40, v230
    v_exp_f32 v148, v148
    ds_read_b64_tr_b16 a[234:235], v240 offset:38408
    v_exp_f32 v149, v149
    ds_read_b128 a[240:243], v239 offset:16384
    v_exp_f32 v150, v150
    v_exp_f32 v151, v151
    v_cvt_pk_bf16_f32 v170, v148, v149
    v_cvt_pk_bf16_f32 v171, v150, v151
    ds_read_b128 v[148:151], v234
    v_mad_u32_u24 v234, v236, s40, v228
    v_mfma_f32_16x16x32_bf16 v[196:199], a[216:219], v[168:171], 0
    v_mad_u32_u24 v236, v236, s40, v229
    v_mfma_f32_16x16x32_bf16 v[184:187], v[68:71], v[168:171], 0
    v_exp_f32 v152, v152
    v_mfma_f32_16x16x32_bf16 v[188:191], v[90:93], v[168:171], 0
    v_exp_f32 v153, v153
    v_mfma_f32_16x16x32_bf16 v[192:195], v[112:115], v[168:171], 0
    s_waitcnt lgkmcnt(4)
    v_exp_f32 v154, v154
    v_mfma_f32_16x16x32_bf16 v[176:179], v[252:255], a[248:251], v[176:179]
    v_exp_f32 v155, v155
    v_mfma_f32_16x16x32_bf16 v[204:207], v[252:255], a[252:255], v[204:207]
    s_waitcnt lgkmcnt(2)
    ds_read_b64_tr_b16 v[252:253], v241 offset:49152
    ds_read_b64_tr_b16 v[254:255], v241 offset:62976
    v_mfma_f32_16x16x32_bf16 v[180:183], a[232:235], a[248:251], v[180:183]
    v_cvt_pk_bf16_f32 v172, v152, v153
    v_cvt_pk_bf16_f32 v173, v154, v155
    v_mfma_f32_16x16x32_bf16 v[208:211], a[232:235], a[252:255], v[208:211]
    ds_read_b128 a[232:235], v239 offset:17408
    ds_read_b128 v[152:155], v228 offset:1280
    v_mfma_f32_16x16x32_bf16 v[200:203], a[236:239], a[248:251], v[200:203]
    ds_read_b64_tr_b16 a[248:249], v240 offset:49152
    v_mfma_f32_16x16x32_bf16 v[212:215], a[236:239], a[252:255], v[212:215]
    s_waitcnt lgkmcnt(3)
    ds_read_b64_tr_b16 a[250:251], v240 offset:62976
    v_exp_f32 v156, v156
    v_exp_f32 v157, v157
    ds_read_b64_tr_b16 a[252:253], v240 offset:49160
    ds_read_b64_tr_b16 a[254:255], v240 offset:62984
    v_exp_f32 v158, v158
    v_exp_f32 v159, v159
    ds_read_b128 a[236:239], v239 offset:23552
    v_mfma_f32_16x16x32_bf16 v[200:203], v[252:255], a[240:243], v[200:203]
    v_cvt_pk_bf16_f32 v174, v156, v157
    v_cvt_pk_bf16_f32 v175, v158, v159
    v_mfma_f32_16x16x32_bf16 v[212:215], v[252:255], a[244:247], v[212:215]
    ds_read_b128 v[252:255], v225 offset:39936
    ds_read_b128 v[156:159], v229 offset:1280
    v_mfma_f32_16x16x32_bf16 v[196:199], a[216:219], v[172:175], v[196:199]
    v_exp_f32 v160, v160
    v_mfma_f32_16x16x32_bf16 v[184:187], v[76:79], v[172:175], v[184:187]
    v_exp_f32 v161, v161
    v_mfma_f32_16x16x32_bf16 v[188:191], v[98:101], v[172:175], v[188:191]
    v_exp_f32 v162, v162
    v_mfma_f32_16x16x32_bf16 v[192:195], v[120:123], v[172:175], v[192:195]
    s_waitcnt lgkmcnt(5)
    v_exp_f32 v163, v163
    v_mfma_f32_16x16x32_bf16 v[176:179], a[248:251], a[240:243], v[176:179]
    v_cvt_pk_bf16_f32 v168, v160, v161
    v_cvt_pk_bf16_f32 v169, v162, v163
    v_mfma_f32_16x16x32_bf16 v[204:207], a[248:251], a[244:247], v[204:207]
    ds_read_b64_tr_b16 a[248:249], v241 offset:50688
    ds_read_b64_tr_b16 a[250:251], v241 offset:61440
    v_mfma_f32_16x16x16_bf16 v[196:199], a[216:217], v[168:169], v[196:199]
    ds_read_b128 v[160:163], v229 offset:1920
    v_mfma_f32_16x16x16_bf16 v[184:187], v[86:87], v[168:169], v[184:187]
    v_exp_f32 v164, v164
    v_mfma_f32_16x16x16_bf16 v[188:191], v[108:109], v[168:169], v[188:191]
    v_exp_f32 v165, v165
    v_mfma_f32_16x16x16_bf16 v[192:195], v[130:131], v[168:169], v[192:195]
    s_waitcnt lgkmcnt(4)
    v_exp_f32 v166, v166
    v_mfma_f32_16x16x32_bf16 v[180:183], a[252:255], a[240:243], v[180:183]
    ds_read_b64_tr_b16 a[240:241], v240 offset:50688
    ds_read_b64_tr_b16 a[242:243], v240 offset:61440
    v_mfma_f32_16x16x32_bf16 v[208:211], a[252:255], a[244:247], v[208:211]
    s_waitcnt lgkmcnt(3)
    ds_read_b64_tr_b16 a[244:245], v240 offset:50696
    ds_read_b64_tr_b16 a[246:247], v240 offset:61448
    v_exp_f32 v167, v167
    ds_read_b128 a[252:255], v225 offset:39872
    v_cvt_pk_bf16_f32 v172, v164, v165
    v_mfma_f32_16x16x32_bf16 v[200:203], a[248:251], a[232:235], v[200:203]
    v_cvt_pk_bf16_f32 v173, v166, v167
    v_mfma_f32_16x16x32_bf16 v[212:215], a[248:251], a[236:239], v[212:215]
    ds_read_b128 a[248:251], v224
    ds_read_b128 v[164:167], v228 offset:1920
    v_mfma_f32_16x16x16_bf16 v[196:199], a[216:217], v[172:173], v[196:199]
    v_mfma_f32_16x16x16_bf16 v[184:187], v[82:83], v[172:173], v[184:187]
    v_mfma_f32_16x16x16_bf16 v[188:191], v[104:105], v[172:173], v[188:191]
    v_mfma_f32_16x16x16_bf16 v[192:195], v[126:127], v[172:173], v[192:195]
    s_waitcnt lgkmcnt(5)
    v_cvt_pk_bf16_f32 v200, v200, v201
    v_cvt_pk_bf16_f32 v201, v202, v203
    v_mfma_f32_16x16x32_bf16 v[176:179], a[240:243], a[232:235], v[176:179]
    buffer_store_dwordx2 v[200:201], v243, s[20:23], s58 offen sc0 sc1
    v_mfma_f32_16x16x32_bf16 v[204:207], a[240:243], a[236:239], v[204:207]
    s_waitcnt lgkmcnt(3)
    ds_read_b128 a[240:243], v225 offset:40128
    v_cvt_pk_bf16_f32 v212, v212, v213
    v_mfma_f32_16x16x32_bf16 v[180:183], a[244:247], a[232:235], v[180:183]
    ds_read_b128 a[232:235], v225 offset:40000
    v_cvt_pk_bf16_f32 v213, v214, v215
    v_mfma_f32_16x16x32_bf16 v[208:211], a[244:247], a[236:239], v[208:211]
    s_waitcnt lgkmcnt(4)
    ds_read_b128 a[236:239], v225 offset:40064
    v_cvt_pk_bf16_f32 v176, v176, v177
    v_mfma_f32_16x16x32_bf16 v[216:219], a[144:147], a[252:255], 0
    v_cvt_pk_bf16_f32 v177, v178, v179
    v_cvt_pk_bf16_f32 v204, v204, v205
    v_mfma_f32_16x16x32_bf16 v[220:223], a[148:151], a[252:255], 0
    v_cvt_pk_bf16_f32 v178, v180, v181
    v_cvt_pk_bf16_f32 v179, v182, v183
    v_mfma_f32_16x16x32_bf16 v[216:219], a[156:159], v[252:255], v[216:219]
    buffer_store_dwordx4 v[176:179], v242, s[20:23], s58 offen sc0 sc1
    v_mfma_f32_16x16x32_bf16 v[220:223], a[160:163], v[252:255], v[220:223]
    s_add_u32 s58, s51, 0x150000
    ds_read_b128 a[244:247], v225 offset:40192
    v_cvt_pk_bf16_f32 v205, v206, v207
    v_mfma_f32_16x16x32_bf16 v[176:179], a[152:155], a[252:255], 0
    v_cvt_pk_bf16_f32 v206, v208, v209
    v_cvt_pk_bf16_f32 v207, v210, v211
    v_mfma_f32_16x16x32_bf16 v[176:179], a[164:167], v[252:255], v[176:179]
    s_waitcnt lgkmcnt(2)
    buffer_store_dwordx4 v[204:207], v244, s[20:23], s59 offen sc0 sc1
    v_mfma_f32_16x16x32_bf16 v[216:219], a[168:171], a[232:235], v[216:219]
    buffer_store_dwordx2 v[212:213], v245, s[20:23], s59 offen sc0 sc1
    v_mfma_f32_16x16x32_bf16 v[220:223], a[172:175], a[232:235], v[220:223]
    s_add_u32 s59, s51, 0x151800
    ds_read_b128 a[252:255], v224 offset:64
    ds_read_b128 v[252:255], v224 offset:128
    v_mfma_f32_16x16x32_bf16 v[176:179], a[176:179], a[232:235], v[176:179]
    s_waitcnt lgkmcnt(3)
    ds_read_b128 a[232:235], v224 offset:192
    v_mfma_f32_16x16x32_bf16 v[216:219], a[180:183], a[236:239], v[216:219]
    v_rcp_f32 v197, v196
    v_mfma_f32_16x16x32_bf16 v[220:223], a[184:187], a[236:239], v[220:223]
    v_mul_f32 v184, v184, v197
    v_mul_f32 v185, v185, v197
    v_mfma_f32_16x16x32_bf16 v[176:179], a[188:191], a[236:239], v[176:179]
    ds_read_b128 a[236:239], v224 offset:256
    v_cvt_pk_bf16_f32 v184, v184, v185
    v_mfma_f32_16x16x32_bf16 v[216:219], a[192:195], a[240:243], v[216:219]
    v_mul_f32 v186, v186, v197
    v_mul_f32 v187, v187, v197
    v_mfma_f32_16x16x32_bf16 v[220:223], a[196:199], a[240:243], v[220:223]
    v_cvt_pk_bf16_f32 v185, v186, v187
    v_mul_f32 v188, v188, v197
    v_mfma_f32_16x16x32_bf16 v[176:179], a[200:203], a[240:243], v[176:179]
    s_waitcnt lgkmcnt(4)
    ds_read_b128 a[240:243], v224 offset:320
    v_mul_f32 v189, v189, v197
    v_mfma_f32_16x16x32_bf16 v[216:219], a[204:207], a[244:247], v[216:219]
    v_cvt_pk_bf16_f32 v186, v188, v189
    v_mul_f32 v190, v190, v197
    v_mfma_f32_16x16x32_bf16 v[220:223], a[208:211], a[244:247], v[220:223]
    v_mul_f32 v191, v191, v197
    v_cvt_pk_bf16_f32 v187, v190, v191
    v_mfma_f32_16x16x32_bf16 v[176:179], a[212:215], a[244:247], v[176:179]
    ds_read_b128 a[244:247], v224 offset:3072
    v_mul_f32 v192, v192, v197
    v_mfma_f32_16x16x32_bf16 v[180:183], a[0:3], a[248:251], 0
    v_mul_f32 v216, s37, v216
    v_mul_f32 v217, s37, v217
    v_mfma_f32_16x16x32_bf16 v[200:203], a[4:7], a[248:251], 0
    v_mul_f32 v218, s37, v218
    v_mul_f32 v219, s37, v219
    v_mfma_f32_16x16x32_bf16 v[204:207], a[8:11], a[248:251], 0
    v_cvt_pk_bf16_f32 v132, v216, v217
    v_cvt_pk_bf16_f32 v133, v218, v219
    v_mfma_f32_16x16x32_bf16 v[208:211], a[248:251], a[72:75], 0
    v_mul_f32 v220, s37, v220
    v_mul_f32 v221, s37, v221
    v_mfma_f32_16x16x32_bf16 v[212:215], a[248:251], a[76:79], 0
    v_mul_f32 v222, s37, v222
    v_mul_f32 v223, s37, v223
    v_mfma_f32_16x16x32_bf16 v[216:219], a[248:251], a[80:83], 0
    s_waitcnt lgkmcnt(2)
    v_cvt_pk_bf16_f32 v134, v220, v221
    v_cvt_pk_bf16_f32 v135, v222, v223
    v_mfma_f32_16x16x32_bf16 v[180:183], a[12:15], a[252:255], v[180:183]
    v_mul_f32 v176, s37, v176
    v_mul_f32 v177, s37, v177
    v_mfma_f32_16x16x32_bf16 v[144:147], v[30:33], v[132:135], v[144:147]
    v_mul_f32 v178, s37, v178
    v_mul_f32 v179, s37, v179
    v_mfma_f32_16x16x32_bf16 v[148:151], v[6:9], v[132:135], v[148:151]
    v_cvt_pk_bf16_f32 v136, v176, v177
    v_cvt_pk_bf16_f32 v137, v178, v179
    v_mfma_f32_16x16x32_bf16 v[152:155], v[12:15], v[132:135], v[152:155]
    ds_read_b128 a[248:251], v224 offset:3136
    v_mul_f32 v193, v193, v197
    v_mfma_f32_16x16x16_bf16 v[144:147], v[34:35], v[136:137], v[144:147]
    v_cvt_pk_bf16_f32 v188, v192, v193
    v_mul_f32 v194, v194, v197
    v_mfma_f32_16x16x16_bf16 v[148:151], v[10:11], v[136:137], v[148:151]
    v_mul_f32 v195, v195, v197
    v_cvt_pk_bf16_f32 v189, v194, v195
    v_mfma_f32_16x16x16_bf16 v[152:155], v[16:17], v[136:137], v[152:155]
    v_max3_f32 v250, v250, v196, v197
    v_mfma_f32_16x16x32_bf16 v[156:159], v[36:39], v[132:135], v[156:159]
    ds_write_b128 v237, v[184:187] offset:6144
    v_mfma_f32_16x16x32_bf16 v[160:163], v[42:45], v[132:135], v[160:163]
    ds_write_b64 v238, v[188:189] offset:6144
    v_mfma_f32_16x16x32_bf16 v[164:167], v[18:21], v[132:135], v[164:167]
    v_exp_f32 v144, v144
    v_mfma_f32_16x16x32_bf16 v[200:203], a[16:19], a[252:255], v[200:203]
    v_exp_f32 v145, v145
    v_mfma_f32_16x16x16_bf16 v[156:159], v[40:41], v[136:137], v[156:159]
    v_exp_f32 v146, v146
    v_mfma_f32_16x16x16_bf16 v[160:163], v[46:47], v[136:137], v[160:163]
    v_exp_f32 v147, v147
    v_mfma_f32_16x16x16_bf16 v[164:167], v[22:23], v[136:137], v[164:167]
    v_cvt_pk_bf16_f32 v168, v144, v145
    v_cvt_pk_bf16_f32 v169, v146, v147
    v_mfma_f32_16x16x32_bf16 v[204:207], a[20:23], a[252:255], v[204:207]
    ds_read_b128 v[144:147], v234
    v_bfe_u32 v234, s67, v233, 4
    v_mfma_f32_16x16x32_bf16 v[208:211], a[252:255], a[84:87], v[208:211]
    v_mad_u32_u24 v234, v234, s40, v231
    v_mfma_f32_16x16x32_bf16 v[212:215], a[252:255], a[88:91], v[212:215]
    s_waitcnt vmcnt(4) lgkmcnt(1)
    v_exp_f32 v148, v148
    v_mfma_f32_16x16x32_bf16 v[216:219], a[252:255], a[92:95], v[216:219]
    s_barrier
    ds_read_b128 a[252:255], v224 offset:3200
    v_mfma_f32_16x16x32_bf16 v[180:183], a[24:27], v[252:255], v[180:183]
    v_exp_f32 v149, v149
    v_mfma_f32_16x16x32_bf16 v[200:203], a[28:31], v[252:255], v[200:203]
    v_exp_f32 v150, v150
    v_mfma_f32_16x16x32_bf16 v[204:207], a[32:35], v[252:255], v[204:207]
    v_exp_f32 v151, v151
    v_mfma_f32_16x16x32_bf16 v[208:211], v[252:255], a[96:99], v[208:211]
    v_cvt_pk_bf16_f32 v170, v148, v149
    v_cvt_pk_bf16_f32 v171, v150, v151
    v_mfma_f32_16x16x32_bf16 v[212:215], v[252:255], a[100:103], v[212:215]
    ds_read_b128 v[148:151], v236
    v_bfe_u32 v236, s73, v232, 4
    v_mfma_f32_16x16x32_bf16 v[196:199], a[216:219], v[168:171], 0
    v_mad_u32_u24 v236, v236, s40, v230
    v_mfma_f32_16x16x32_bf16 v[184:187], v[70:73], v[168:171], 0
    v_exp_f32 v152, v152
    v_mfma_f32_16x16x32_bf16 v[188:191], v[92:95], v[168:171], 0
    v_exp_f32 v153, v153
    v_mfma_f32_16x16x32_bf16 v[192:195], v[114:117], v[168:171], 0
    v_exp_f32 v154, v154
    v_mfma_f32_16x16x32_bf16 v[216:219], v[252:255], a[104:107], v[216:219]
    ds_read_b128 v[252:255], v224 offset:3264
    v_cvt_pk_bf16_f32 v172, v152, v153
    v_mfma_f32_16x16x32_bf16 v[180:183], a[36:39], a[232:235], v[180:183]
    v_exp_f32 v155, v155
    v_mfma_f32_16x16x32_bf16 v[200:203], a[40:43], a[232:235], v[200:203]
    v_cvt_pk_bf16_f32 v173, v154, v155
    v_mfma_f32_16x16x32_bf16 v[204:207], a[44:47], a[232:235], v[204:207]
    ds_read_b128 v[152:155], v235
    v_bfe_u32 v235, s75, v233, 4
    v_mfma_f32_16x16x32_bf16 v[208:211], a[232:235], a[108:111], v[208:211]
    v_mad_u32_u24 v235, v235, s40, v231
    v_mfma_f32_16x16x32_bf16 v[212:215], a[232:235], a[112:115], v[212:215]
    v_exp_f32 v156, v156
    v_mfma_f32_16x16x32_bf16 v[216:219], a[232:235], a[116:119], v[216:219]
    ds_read_b128 a[232:235], v224 offset:3328
    v_mfma_f32_16x16x32_bf16 v[180:183], a[48:51], a[236:239], v[180:183]
    v_exp_f32 v157, v157
    v_mfma_f32_16x16x32_bf16 v[200:203], a[52:55], a[236:239], v[200:203]
    v_exp_f32 v158, v158
    v_mfma_f32_16x16x32_bf16 v[204:207], a[56:59], a[236:239], v[204:207]
    v_exp_f32 v159, v159
    v_mfma_f32_16x16x32_bf16 v[208:211], a[236:239], a[120:123], v[208:211]
    v_cvt_pk_bf16_f32 v174, v156, v157
    v_cvt_pk_bf16_f32 v175, v158, v159
    v_mfma_f32_16x16x32_bf16 v[212:215], a[236:239], a[124:127], v[212:215]
    ds_read_b128 v[156:159], v236
    v_bfe_u32 v236, s76, v233, 4
    v_mfma_f32_16x16x32_bf16 v[196:199], a[216:219], v[172:175], v[196:199]
    v_mad_u32_u24 v236, v236, s40, v231
    v_mfma_f32_16x16x32_bf16 v[184:187], v[74:77], v[172:175], v[184:187]
    v_exp_f32 v160, v160
    v_mfma_f32_16x16x32_bf16 v[188:191], v[96:99], v[172:175], v[188:191]
    v_exp_f32 v161, v161
    v_mfma_f32_16x16x32_bf16 v[192:195], v[118:121], v[172:175], v[192:195]
    v_exp_f32 v162, v162
    v_mfma_f32_16x16x32_bf16 v[216:219], a[236:239], a[128:131], v[216:219]
    ds_read_b128 a[236:239], v224 offset:3392
    v_cvt_pk_bf16_f32 v168, v160, v161
    v_mfma_f32_16x16x32_bf16 v[180:183], a[60:63], a[240:243], v[180:183]
    v_exp_f32 v163, v163
    v_mfma_f32_16x16x32_bf16 v[200:203], a[64:67], a[240:243], v[200:203]
    v_cvt_pk_bf16_f32 v169, v162, v163
    v_mfma_f32_16x16x32_bf16 v[204:207], a[68:71], a[240:243], v[204:207]
    ds_read_b128 v[160:163], v230 offset:1280
    v_mfma_f32_16x16x32_bf16 v[208:211], a[240:243], a[132:135], v[208:211]
    v_exp_f32 v164, v164
    v_mfma_f32_16x16x32_bf16 v[212:215], a[240:243], a[136:139], v[212:215]
    v_cvt_pk_bf16_f32 v0, v180, v181
    v_cvt_pk_bf16_f32 v1, v182, v183
    v_mfma_f32_16x16x32_bf16 v[216:219], a[240:243], a[140:143], v[216:219]
    v_cvt_pk_bf16_f32 v2, v200, v201
    v_cvt_pk_bf16_f32 v3, v202, v203
    v_mfma_f32_16x16x32_bf16 v[220:223], a[0:3], a[244:247], 0
    s_waitcnt lgkmcnt(2)
    v_cvt_pk_bf16_f32 v4, v204, v205
    v_cvt_pk_bf16_f32 v5, v206, v207
    v_mfma_f32_16x16x32_bf16 v[144:147], v[0:3], v[132:135], v[144:147]
    v_cvt_pk_bf16_f32 v66, v208, v209
    v_cvt_pk_bf16_f32 v67, v210, v211
    v_mfma_f32_16x16x32_bf16 v[176:179], a[4:7], a[244:247], 0
    v_cvt_pk_bf16_f32 v88, v212, v213
    v_cvt_pk_bf16_f32 v89, v214, v215
    v_mfma_f32_16x16x32_bf16 v[180:183], a[8:11], a[244:247], 0
    v_cvt_pk_bf16_f32 v110, v216, v217
    v_cvt_pk_bf16_f32 v111, v218, v219
    v_mfma_f32_16x16x16_bf16 v[144:147], v[4:5], v[136:137], v[144:147]
    ds_read_b128 a[240:243], v225 offset:42944
    v_mfma_f32_16x16x32_bf16 v[200:203], a[244:247], a[72:75], 0
    v_exp_f32 v165, v165
    v_mfma_f32_16x16x32_bf16 v[204:207], a[244:247], a[76:79], 0
    v_exp_f32 v166, v166
    v_mfma_f32_16x16x32_bf16 v[208:211], a[244:247], a[80:83], 0
    ds_read_b128 a[244:247], v225 offset:43008
    v_cvt_pk_bf16_f32 v170, v164, v165
    v_mfma_f32_16x16x32_bf16 v[220:223], a[12:15], a[248:251], v[220:223]
    v_exp_f32 v167, v167
    v_mfma_f32_16x16x32_bf16 v[176:179], a[16:19], a[248:251], v[176:179]
    v_cvt_pk_bf16_f32 v171, v166, v167
    v_mfma_f32_16x16x32_bf16 v[180:183], a[20:23], a[248:251], v[180:183]
    ds_read_b128 v[164:167], v230 offset:1920
    v_mfma_f32_16x16x32_bf16 v[196:199], a[216:219], v[168:171], v[196:199]
    v_exp_f32 v144, v144
    v_mfma_f32_16x16x32_bf16 v[184:187], v[78:81], v[168:171], v[184:187]
    v_exp_f32 v145, v145
    v_mfma_f32_16x16x32_bf16 v[188:191], v[100:103], v[168:171], v[188:191]
    v_exp_f32 v146, v146
    v_mfma_f32_16x16x32_bf16 v[192:195], v[122:125], v[168:171], v[192:195]
    v_exp_f32 v147, v147
    v_mfma_f32_16x16x32_bf16 v[200:203], a[248:251], a[84:87], v[200:203]
    v_cvt_pk_bf16_f32 v172, v144, v145
    v_cvt_pk_bf16_f32 v173, v146, v147
    v_mfma_f32_16x16x32_bf16 v[204:207], a[248:251], a[88:91], v[204:207]
    ds_read_b128 v[144:147], v234
    v_bfe_u32 v234, s73, v232, 4
    v_mfma_f32_16x16x32_bf16 v[208:211], a[248:251], a[92:95], v[208:211]
    ds_read_b128 a[248:251], v225 offset:43072
    v_mfma_f32_16x16x32_bf16 v[220:223], a[24:27], a[252:255], v[220:223]
    v_mfma_f32_16x16x32_bf16 v[176:179], a[28:31], a[252:255], v[176:179]
    v_mfma_f32_16x16x32_bf16 v[180:183], a[32:35], a[252:255], v[180:183]
    v_mfma_f32_16x16x32_bf16 v[200:203], a[252:255], a[96:99], v[200:203]
    v_mfma_f32_16x16x32_bf16 v[204:207], a[252:255], a[100:103], v[204:207]
    v_mfma_f32_16x16x32_bf16 v[208:211], a[252:255], a[104:107], v[208:211]
    ds_read_b128 a[252:255], v225 offset:43136
    v_mfma_f32_16x16x32_bf16 v[220:223], a[36:39], v[252:255], v[220:223]
    v_mfma_f32_16x16x32_bf16 v[176:179], a[40:43], v[252:255], v[176:179]
    v_mfma_f32_16x16x32_bf16 v[180:183], a[44:47], v[252:255], v[180:183]
    v_mfma_f32_16x16x32_bf16 v[200:203], v[252:255], a[108:111], v[200:203]
    v_mfma_f32_16x16x32_bf16 v[204:207], v[252:255], a[112:115], v[204:207]
    v_mfma_f32_16x16x32_bf16 v[208:211], v[252:255], a[116:119], v[208:211]
    ds_read_b128 v[252:255], v225 offset:43200
    v_mfma_f32_16x16x32_bf16 v[220:223], a[48:51], a[232:235], v[220:223]
    v_mfma_f32_16x16x32_bf16 v[176:179], a[52:55], a[232:235], v[176:179]
    v_mfma_f32_16x16x32_bf16 v[180:183], a[56:59], a[232:235], v[180:183]
    v_mfma_f32_16x16x32_bf16 v[200:203], a[232:235], a[120:123], v[200:203]
    v_mfma_f32_16x16x32_bf16 v[204:207], a[232:235], a[124:127], v[204:207]
    v_mfma_f32_16x16x32_bf16 v[208:211], a[232:235], a[128:131], v[208:211]
    s_waitcnt lgkmcnt(1)
    ds_read_b128 a[232:235], v225 offset:43264
    v_mfma_f32_16x16x32_bf16 v[220:223], a[60:63], a[236:239], v[220:223]
    v_mfma_f32_16x16x32_bf16 v[176:179], a[64:67], a[236:239], v[176:179]
    v_mfma_f32_16x16x32_bf16 v[180:183], a[68:71], a[236:239], v[180:183]
    v_mfma_f32_16x16x32_bf16 v[200:203], a[236:239], a[132:135], v[200:203]
    v_mfma_f32_16x16x32_bf16 v[204:207], a[236:239], a[136:139], v[204:207]
    v_mfma_f32_16x16x32_bf16 v[208:211], a[236:239], a[140:143], v[208:211]
    ds_read_b128 a[236:239], v227 offset:6144
    v_mfma_f32_16x16x32_bf16 v[212:215], a[144:147], a[240:243], 0
    v_mfma_f32_16x16x32_bf16 v[216:219], a[148:151], a[240:243], 0
    v_cvt_pk_bf16_f32 v24, v220, v221
    v_cvt_pk_bf16_f32 v25, v222, v223
    v_mfma_f32_16x16x32_bf16 v[220:223], a[152:155], a[240:243], 0
    v_cvt_pk_bf16_f32 v26, v176, v177
    v_cvt_pk_bf16_f32 v27, v178, v179
    v_mfma_f32_16x16x32_bf16 v[212:215], a[156:159], a[244:247], v[212:215]
    v_cvt_pk_bf16_f32 v28, v180, v181
    v_cvt_pk_bf16_f32 v29, v182, v183
    v_mfma_f32_16x16x32_bf16 v[148:151], v[24:27], v[132:135], v[148:151]
    v_cvt_pk_bf16_f32 v68, v200, v201
    v_cvt_pk_bf16_f32 v69, v202, v203
    v_mfma_f32_16x16x32_bf16 v[216:219], a[160:163], a[244:247], v[216:219]
    v_cvt_pk_bf16_f32 v90, v204, v205
    v_cvt_pk_bf16_f32 v91, v206, v207
    v_mfma_f32_16x16x32_bf16 v[220:223], a[164:167], a[244:247], v[220:223]
    v_cvt_pk_bf16_f32 v112, v208, v209
    v_cvt_pk_bf16_f32 v113, v210, v211
    v_mfma_f32_16x16x16_bf16 v[148:151], v[28:29], v[136:137], v[148:151]
    ds_read_b128 a[240:243], v227 offset:6208
    ds_read_b128 a[244:247], v227 offset:6272
    v_mfma_f32_16x16x32_bf16 v[212:215], a[168:171], a[248:251], v[212:215]
    v_mfma_f32_16x16x32_bf16 v[216:219], a[172:175], a[248:251], v[216:219]
    v_mfma_f32_16x16x32_bf16 v[220:223], a[176:179], a[248:251], v[220:223]
    ds_read_b128 a[248:251], v227 offset:6336
    v_mfma_f32_16x16x32_bf16 v[212:215], a[180:183], a[252:255], v[212:215]
    v_mfma_f32_16x16x32_bf16 v[216:219], a[184:187], a[252:255], v[216:219]
    v_exp_f32 v148, v148
    v_mfma_f32_16x16x32_bf16 v[220:223], a[188:191], a[252:255], v[220:223]
    s_waitcnt lgkmcnt(3)
    ds_read_b128 a[252:255], v227 offset:6400
    v_mfma_f32_16x16x32_bf16 v[212:215], a[192:195], v[252:255], v[212:215]
    v_exp_f32 v149, v149
    v_mfma_f32_16x16x32_bf16 v[216:219], a[196:199], v[252:255], v[216:219]
    v_exp_f32 v150, v150
    v_mfma_f32_16x16x32_bf16 v[220:223], a[200:203], v[252:255], v[220:223]
    ds_read_b128 v[252:255], v227 offset:6464
    v_cvt_pk_bf16_f32 v174, v148, v149
    v_mfma_f32_16x16x32_bf16 v[212:215], a[204:207], a[232:235], v[212:215]
    v_exp_f32 v151, v151
    v_mfma_f32_16x16x32_bf16 v[216:219], a[208:211], a[232:235], v[216:219]
    v_cvt_pk_bf16_f32 v175, v150, v151
    v_mfma_f32_16x16x32_bf16 v[220:223], a[212:215], a[232:235], v[220:223]
    ds_read_b128 a[232:235], v239
    ds_read_b128 v[148:151], v235
    v_mfma_f32_16x16x32_bf16 v[196:199], a[216:219], v[172:175], v[196:199]
    v_mad_u32_u24 v235, v234, s40, v228
    v_mul_f32 v212, s37, v212
    v_mfma_f32_16x16x32_bf16 v[184:187], v[66:69], v[172:175], v[184:187]
    v_mul_f32 v213, s37, v213
    v_mul_f32 v214, s37, v214
    v_mfma_f32_16x16x32_bf16 v[188:191], v[88:91], v[172:175], v[188:191]
    v_mul_f32 v215, s37, v215
    v_cvt_pk_bf16_f32 v138, v212, v213
    v_mfma_f32_16x16x32_bf16 v[192:195], v[110:113], v[172:175], v[192:195]
    v_cvt_pk_bf16_f32 v139, v214, v215
    v_mul_f32 v216, s37, v216
    v_mfma_f32_16x16x32_bf16 v[176:179], a[0:3], a[236:239], 0
    v_mul_f32 v217, s37, v217
    v_mul_f32 v218, s37, v218
    v_mfma_f32_16x16x32_bf16 v[180:183], a[4:7], a[236:239], 0
    v_mul_f32 v219, s37, v219
    v_cvt_pk_bf16_f32 v140, v216, v217
    v_mfma_f32_16x16x32_bf16 v[200:203], a[8:11], a[236:239], 0
    v_cvt_pk_bf16_f32 v141, v218, v219
    v_mul_f32 v220, s37, v220
    v_mfma_f32_16x16x32_bf16 v[204:207], a[236:239], a[72:75], 0
    v_mul_f32 v221, s37, v221
    v_mul_f32 v222, s37, v222
    v_mfma_f32_16x16x32_bf16 v[152:155], v[24:27], v[138:141], v[152:155]
    v_mul_f32 v223, s37, v223
    v_cvt_pk_bf16_f32 v142, v220, v221
    v_mfma_f32_16x16x32_bf16 v[156:159], v[30:33], v[138:141], v[156:159]
    v_cvt_pk_bf16_f32 v143, v222, v223
    v_mad_u32_u24 v234, v234, s40, v229
    v_mfma_f32_16x16x32_bf16 v[160:163], v[36:39], v[138:141], v[160:163]
    v_rcp_f32 v197, v196
    v_mfma_f32_16x16x16_bf16 v[152:155], v[28:29], v[142:143], v[152:155]
    v_mul_f32 v184, v184, v197
    v_mul_f32 v185, v185, v197
    v_mfma_f32_16x16x16_bf16 v[156:159], v[34:35], v[142:143], v[156:159]
    v_cvt_pk_bf16_f32 v184, v184, v185
    v_mul_f32 v186, v186, v197
    v_mfma_f32_16x16x16_bf16 v[160:163], v[40:41], v[142:143], v[160:163]
    v_mul_f32 v187, v187, v197
    v_cvt_pk_bf16_f32 v185, v186, v187
    v_mfma_f32_16x16x32_bf16 v[164:167], v[42:45], v[138:141], v[164:167]
    v_mul_f32 v188, v188, v197
    v_mul_f32 v189, v189, v197
    v_mfma_f32_16x16x32_bf16 v[144:147], v[48:51], v[138:141], v[144:147]
    v_cvt_pk_bf16_f32 v186, v188, v189
    v_mul_f32 v190, v190, v197
    v_mfma_f32_16x16x32_bf16 v[208:211], a[236:239], a[76:79], 0
    v_mul_f32 v191, v191, v197
    v_cvt_pk_bf16_f32 v187, v190, v191
    v_mfma_f32_16x16x16_bf16 v[164:167], v[46:47], v[142:143], v[164:167]
    v_mul_f32 v192, v192, v197
    v_mul_f32 v193, v193, v197
    v_mfma_f32_16x16x16_bf16 v[144:147], v[52:53], v[142:143], v[144:147]
    v_cvt_pk_bf16_f32 v188, v192, v193
    v_mul_f32 v194, v194, v197
    v_mfma_f32_16x16x32_bf16 v[212:215], a[236:239], a[80:83], 0
    s_waitcnt lgkmcnt(0)
    ds_read_b128 a[236:239], v239 offset:6144
    v_mul_f32 v195, v195, v197
    v_mfma_f32_16x16x32_bf16 v[176:179], a[12:15], a[240:243], v[176:179]
    v_cvt_pk_bf16_f32 v189, v194, v195
    v_max3_f32 v250, v250, v196, v197
    v_mfma_f32_16x16x32_bf16 v[180:183], a[16:19], a[240:243], v[180:183]
    ds_write_b128 v237, v[184:187] offset:12288
    v_mfma_f32_16x16x32_bf16 v[200:203], a[20:23], a[240:243], v[200:203]
    ds_write_b64 v238, v[188:189] offset:12288
    v_mfma_f32_16x16x32_bf16 v[204:207], a[240:243], a[84:87], v[204:207]
    v_exp_f32 v152, v152
    v_mfma_f32_16x16x32_bf16 v[208:211], a[240:243], a[88:91], v[208:211]
L_pg7:
    s_cbranch_execz L_back
    v_exp_f32 v153, v153
    v_mfma_f32_16x16x32_bf16 v[212:215], a[240:243], a[92:95], v[212:215]
    ds_read_b128 a[240:243], v239 offset:1024
    v_cvt_pk_bf16_f32 v168, v152, v153
    v_mfma_f32_16x16x32_bf16 v[176:179], a[24:27], a[244:247], v[176:179]
    v_exp_f32 v154, v154
    v_mfma_f32_16x16x32_bf16 v[180:183], a[28:31], a[244:247], v[180:183]
    v_exp_f32 v155, v155
    v_mfma_f32_16x16x32_bf16 v[200:203], a[32:35], a[244:247], v[200:203]
    v_cvt_pk_bf16_f32 v169, v154, v155
    v_mfma_f32_16x16x32_bf16 v[204:207], a[244:247], a[96:99], v[204:207]
    ds_read_b128 v[152:155], v236
    v_bfe_u32 v236, s77, v232, 4
    v_mfma_f32_16x16x32_bf16 v[208:211], a[244:247], a[100:103], v[208:211]
    v_exp_f32 v156, v156
    v_mfma_f32_16x16x32_bf16 v[212:215], a[244:247], a[104:107], v[212:215]
    ds_read_b128 a[244:247], v239 offset:7168
    v_mfma_f32_16x16x32_bf16 v[176:179], a[36:39], a[248:251], v[176:179]
    v_exp_f32 v157, v157
    v_mfma_f32_16x16x32_bf16 v[180:183], a[40:43], a[248:251], v[180:183]
    v_exp_f32 v158, v158
    v_mfma_f32_16x16x32_bf16 v[200:203], a[44:47], a[248:251], v[200:203]
    v_exp_f32 v159, v159
    v_mfma_f32_16x16x32_bf16 v[204:207], a[248:251], a[108:111], v[204:207]
    v_cvt_pk_bf16_f32 v170, v156, v157
    v_cvt_pk_bf16_f32 v171, v158, v159
    v_mfma_f32_16x16x32_bf16 v[208:211], a[248:251], a[112:115], v[208:211]
    ds_read_b128 v[156:159], v235
    v_bfe_u32 v235, s78, v232, 4
    v_mfma_f32_16x16x32_bf16 v[196:199], a[216:219], v[168:171], 0
    v_exp_f32 v160, v160
    v_mfma_f32_16x16x32_bf16 v[184:187], v[68:71], v[168:171], 0
    v_exp_f32 v161, v161
    v_mfma_f32_16x16x32_bf16 v[188:191], v[90:93], v[168:171], 0
    v_exp_f32 v162, v162
    v_mfma_f32_16x16x32_bf16 v[192:195], v[112:115], v[168:171], 0
    s_waitcnt lgkmcnt(2)
    v_exp_f32 v163, v163
    v_mfma_f32_16x16x32_bf16 v[152:155], v[60:63], v[138:141], v[152:155]
    v_cvt_pk_bf16_f32 v172, v160, v161
    v_cvt_pk_bf16_f32 v173, v162, v163
    v_mfma_f32_16x16x32_bf16 v[212:215], a[248:251], a[116:119], v[212:215]
    ds_read_b64_tr_b16 a[248:249], v240 offset:12288
    ds_read_b64_tr_b16 a[250:251], v240 offset:26112
    v_mfma_f32_16x16x32_bf16 v[176:179], a[48:51], a[252:255], v[176:179]
    ds_read_b128 v[160:163], v234
    v_mad_u32_u24 v234, v236, s40, v228
    v_mfma_f32_16x16x16_bf16 v[152:155], v[64:65], v[142:143], v[152:155]
    v_mad_u32_u24 v236, v236, s40, v229
    v_mfma_f32_16x16x32_bf16 v[180:183], a[52:55], a[252:255], v[180:183]
    v_exp_f32 v164, v164
    v_mfma_f32_16x16x32_bf16 v[200:203], a[56:59], a[252:255], v[200:203]
    v_exp_f32 v165, v165
    v_mfma_f32_16x16x32_bf16 v[204:207], a[252:255], a[120:123], v[204:207]
    v_exp_f32 v166, v166
    v_mfma_f32_16x16x32_bf16 v[208:211], a[252:255], a[124:127], v[208:211]
    v_exp_f32 v167, v167
    v_mfma_f32_16x16x32_bf16 v[212:215], a[252:255], a[128:131], v[212:215]
    ds_read_b64_tr_b16 a[252:253], v240 offset:12296
    ds_read_b64_tr_b16 a[254:255], v240 offset:26120
    v_mfma_f32_16x16x32_bf16 v[176:179], a[60:63], v[252:255], v[176:179]
    v_cvt_pk_bf16_f32 v174, v164, v165
    v_cvt_pk_bf16_f32 v175, v166, v167
    v_mfma_f32_16x16x32_bf16 v[180:183], a[64:67], v[252:255], v[180:183]
    ds_read_b128 v[164:167], v229 offset:1280
    v_mfma_f32_16x16x32_bf16 v[196:199], a[216:219], v[172:175], v[196:199]
    v_exp_f32 v144, v144
    v_mfma_f32_16x16x32_bf16 v[184:187], v[76:79], v[172:175], v[184:187]
    v_exp_f32 v145, v145
    v_mfma_f32_16x16x32_bf16 v[188:191], v[98:101], v[172:175], v[188:191]
    v_cvt_pk_bf16_f32 v54, v176, v177
    v_cvt_pk_bf16_f32 v55, v178, v179
    v_mfma_f32_16x16x32_bf16 v[192:195], v[120:123], v[172:175], v[192:195]
    v_cvt_pk_bf16_f32 v56, v180, v181
    v_cvt_pk_bf16_f32 v57, v182, v183
    v_mfma_f32_16x16x32_bf16 v[200:203], a[68:71], v[252:255], v[200:203]
    v_exp_f32 v146, v146
    v_mfma_f32_16x16x32_bf16 v[148:151], v[54:57], v[138:141], v[148:151]
    v_exp_f32 v147, v147
    v_mfma_f32_16x16x32_bf16 v[204:207], v[252:255], a[132:135], v[204:207]
    v_cvt_pk_bf16_f32 v168, v144, v145
    v_cvt_pk_bf16_f32 v169, v146, v147
    v_mfma_f32_16x16x32_bf16 v[208:211], v[252:255], a[136:139], v[208:211]
    ds_read_b128 v[144:147], v228 offset:1280
    v_cvt_pk_bf16_f32 v58, v200, v201
    v_mfma_f32_16x16x16_bf16 v[196:199], a[216:217], v[168:169], v[196:199]
    v_cvt_pk_bf16_f32 v59, v202, v203
    v_mfma_f32_16x16x16_bf16 v[184:187], v[82:83], v[168:169], v[184:187]
    v_cvt_pk_bf16_f32 v84, v204, v205
    v_cvt_pk_bf16_f32 v85, v206, v207
    v_mfma_f32_16x16x16_bf16 v[188:191], v[104:105], v[168:169], v[188:191]
    v_cvt_pk_bf16_f32 v106, v208, v209
    v_cvt_pk_bf16_f32 v107, v210, v211
    v_mfma_f32_16x16x16_bf16 v[192:195], v[126:127], v[168:169], v[192:195]
    v_exp_f32 v152, v152
    v_mfma_f32_16x16x16_bf16 v[148:151], v[58:59], v[142:143], v[148:151]
    v_exp_f32 v153, v153
    v_mfma_f32_16x16x32_bf16 v[212:215], v[252:255], a[140:143], v[212:215]
    ds_read_b64_tr_b16 v[252:253], v241 offset:12288
    ds_read_b64_tr_b16 v[254:255], v241 offset:26112
    v_mfma_f32_16x16x32_bf16 v[216:219], a[220:223], a[232:235], 0
    v_exp_f32 v154, v154
    v_mfma_f32_16x16x32_bf16 v[180:183], a[220:223], a[236:239], 0
    v_exp_f32 v155, v155
    v_mfma_f32_16x16x32_bf16 v[220:223], a[224:227], a[232:235], 0
    v_exp_f32 v148, v148
    v_mfma_f32_16x16x32_bf16 v[200:203], a[224:227], a[236:239], 0
    v_cvt_pk_bf16_f32 v128, v212, v213
    v_cvt_pk_bf16_f32 v129, v214, v215
    v_mfma_f32_16x16x32_bf16 v[176:179], a[228:231], a[232:235], 0
    ds_read_b128 a[232:235], v239 offset:2048
    v_cvt_pk_bf16_f32 v174, v152, v153
    v_mfma_f32_16x16x32_bf16 v[204:207], a[228:231], a[236:239], 0
    s_waitcnt lgkmcnt(3)
    ds_read_b128 a[236:239], v239 offset:8192
    v_cvt_pk_bf16_f32 v175, v154, v155
    v_mfma_f32_16x16x32_bf16 v[216:219], a[248:251], a[240:243], v[216:219]
    ds_read_b128 v[152:155], v236
    v_mad_u32_u24 v236, v235, s40, v229
    v_mfma_f32_16x16x32_bf16 v[180:183], a[248:251], a[244:247], v[180:183]
    ds_read_b64_tr_b16 a[248:249], v241 offset:13824
    ds_read_b64_tr_b16 a[250:251], v241 offset:24576
    v_mfma_f32_16x16x32_bf16 v[220:223], a[252:255], a[240:243], v[220:223]
    v_mad_u32_u24 v235, v235, s40, v228
    v_mfma_f32_16x16x32_bf16 v[200:203], a[252:255], a[244:247], v[200:203]
    s_waitcnt lgkmcnt(5)
    ds_read_b128 a[252:255], v239 offset:3072
    v_mfma_f32_16x16x32_bf16 v[176:179], v[252:255], a[240:243], v[176:179]
    ds_read_b64_tr_b16 a[240:241], v240 offset:13824
    ds_read_b64_tr_b16 a[242:243], v240 offset:24576
    v_mfma_f32_16x16x32_bf16 v[204:207], v[252:255], a[244:247], v[204:207]
    ds_read_b64_tr_b16 a[244:245], v240 offset:13832
    ds_read_b64_tr_b16 a[246:247], v240 offset:24584
    v_exp_f32 v149, v149
    ds_read_b128 v[252:255], v239 offset:9216
    v_exp_f32 v150, v150
    v_exp_f32 v151, v151
    v_cvt_pk_bf16_f32 v172, v148, v149
    v_cvt_pk_bf16_f32 v173, v150, v151
    ds_read_b128 v[148:151], v234
    v_bfe_u32 v234, s73, v232, 4
    v_mfma_f32_16x16x32_bf16 v[196:199], a[216:219], v[172:175], v[196:199]
    v_mad_u32_u24 v234, v234, s40, v230
    v_mfma_f32_16x16x32_bf16 v[184:187], v[84:87], v[172:175], v[184:187]
    v_mfma_f32_16x16x32_bf16 v[188:191], v[106:109], v[172:175], v[188:191]
    v_mfma_f32_16x16x32_bf16 v[192:195], v[128:131], v[172:175], v[192:195]
    s_waitcnt lgkmcnt(4)
    v_mfma_f32_16x16x32_bf16 v[216:219], a[240:243], a[232:235], v[216:219]
    v_mfma_f32_16x16x32_bf16 v[180:183], a[240:243], a[236:239], v[180:183]
    s_waitcnt lgkmcnt(2)
    ds_read_b64_tr_b16 a[240:241], v241 offset:36864
    ds_read_b64_tr_b16 a[242:243], v241 offset:38400
    v_mfma_f32_16x16x32_bf16 v[220:223], a[244:247], a[232:235], v[220:223]
    v_rcp_f32 v197, v196
    v_mfma_f32_16x16x32_bf16 v[200:203], a[244:247], a[236:239], v[200:203]
    ds_read_b128 a[244:247], v239 offset:4096
    v_mul_f32 v184, v184, v197
    v_mfma_f32_16x16x32_bf16 v[176:179], a[248:251], a[232:235], v[176:179]
    ds_read_b64_tr_b16 a[232:233], v240 offset:36864
    ds_read_b64_tr_b16 a[234:235], v240 offset:38400
    v_mfma_f32_16x16x32_bf16 v[204:207], a[248:251], a[236:239], v[204:207]
    s_waitcnt lgkmcnt(3)
    ds_read_b64_tr_b16 a[236:237], v240 offset:36872
    ds_read_b64_tr_b16 a[238:239], v240 offset:38408
    v_mul_f32 v185, v185, v197
    v_cvt_pk_bf16_f32 v184, v184, v185
    ds_read_b128 a[248:251], v239 offset:10240
    v_mul_f32 v186, v186, v197
    v_mul_f32 v187, v187, v197
    v_cvt_pk_bf16_f32 v185, v186, v187
    v_mul_f32 v188, v188, v197
    v_mul_f32 v189, v189, v197
    v_cvt_pk_bf16_f32 v186, v188, v189
    v_mul_f32 v190, v190, v197
    v_mul_f32 v191, v191, v197
    v_cvt_pk_bf16_f32 v187, v190, v191
    v_mfma_f32_16x16x32_bf16 v[176:179], a[240:243], a[252:255], v[176:179]
    v_mul_f32 v192, v192, v197
    v_mul_f32 v193, v193, v197
    v_mfma_f32_16x16x32_bf16 v[204:207], a[240:243], v[252:255], v[204:207]
    s_waitcnt lgkmcnt(3)
    ds_read_b128 a[240:243], v239 offset:11264
    v_cvt_pk_bf16_f32 v188, v192, v193
    v_mul_f32 v194, v194, v197
    v_mul_f32 v195, v195, v197
    v_cvt_pk_bf16_f32 v189, v194, v195
    v_max3_f32 v250, v250, v196, v197
    ds_write_b128 v237, v[184:187] offset:18432
    v_mfma_f32_16x16x32_bf16 v[216:219], a[232:235], a[252:255], v[216:219]
    ds_write_b64 v238, v[188:189] offset:18432
    v_mfma_f32_16x16x32_bf16 v[180:183], a[232:235], v[252:255], v[180:183]
    s_waitcnt lgkmcnt(4)
    ds_read_b64_tr_b16 a[232:233], v241 offset:49152
    ds_read_b64_tr_b16 a[234:235], v241 offset:62976
    v_mfma_f32_16x16x32_bf16 v[220:223], a[236:239], a[252:255], v[220:223]
    ds_read_b64_tr_b16 a[252:253], v240 offset:49152
    ds_read_b64_tr_b16 a[254:255], v240 offset:62976
    v_mfma_f32_16x16x32_bf16 v[200:203], a[236:239], v[252:255], v[200:203]
    s_waitcnt lgkmcnt(2)
    ds_read_b64_tr_b16 v[252:253], v240 offset:49160
    ds_read_b64_tr_b16 v[254:255], v240 offset:62984
    ds_read_b128 a[236:239], v239 offset:5120
    v_mfma_f32_16x16x32_bf16 v[176:179], a[232:235], a[244:247], v[176:179]
    v_mfma_f32_16x16x32_bf16 v[204:207], a[232:235], a[248:251], v[204:207]
    s_waitcnt lgkmcnt(3)
    ds_read_b128 a[232:235], v226 offset:1216
    v_mfma_f32_16x16x32_bf16 v[216:219], a[252:255], a[244:247], v[216:219]
    v_mfma_f32_16x16x32_bf16 v[180:183], a[252:255], a[248:251], v[180:183]
    s_waitcnt lgkmcnt(2)
    ds_read_b64_tr_b16 a[252:253], v241 offset:50688
    ds_read_b64_tr_b16 a[254:255], v241 offset:61440
    v_mfma_f32_16x16x32_bf16 v[220:223], v[252:255], a[244:247], v[220:223]
    s_waitcnt lgkmcnt(0)
    ds_read_b64_tr_b16 a[244:245], v240 offset:50688
    ds_read_b64_tr_b16 a[246:247], v240 offset:61440
    v_mfma_f32_16x16x32_bf16 v[200:203], v[252:255], a[248:251], v[200:203]
    s_barrier
    ds_read_b64_tr_b16 a[248:249], v240 offset:50696
    ds_read_b64_tr_b16 a[250:251], v240 offset:61448
    ds_read_b128 v[252:255], v226 offset:1152
    v_mfma_f32_16x16x32_bf16 v[176:179], a[252:255], a[236:239], v[176:179]
    v_mfma_f32_16x16x32_bf16 v[204:207], a[252:255], a[240:243], v[204:207]
    s_waitcnt lgkmcnt(3)
    ds_read_b128 a[252:255], v224 offset:15488
    v_mfma_f32_16x16x32_bf16 v[216:219], a[244:247], a[236:239], v[216:219]
    v_mfma_f32_16x16x32_bf16 v[180:183], a[244:247], a[240:243], v[180:183]
    s_waitcnt lgkmcnt(2)
    ds_read_b128 a[244:247], v226 offset:1408
    v_mfma_f32_16x16x32_bf16 v[220:223], a[248:251], a[236:239], v[220:223]
    ds_read_b128 a[236:239], v226 offset:1280
    v_mfma_f32_16x16x32_bf16 v[200:203], a[248:251], a[240:243], v[200:203]
    s_waitcnt lgkmcnt(3)
    ds_read_b128 a[240:243], v226 offset:1344
    v_cvt_pk_bf16_f32 v176, v176, v177
    v_mfma_f32_16x16x32_bf16 v[208:211], a[144:147], v[252:255], 0
    v_cvt_pk_bf16_f32 v216, v216, v217
    v_cvt_pk_bf16_f32 v217, v218, v219
    v_mfma_f32_16x16x32_bf16 v[212:215], a[148:151], v[252:255], 0
    v_cvt_pk_bf16_f32 v218, v220, v221
    v_cvt_pk_bf16_f32 v219, v222, v223
    v_mfma_f32_16x16x32_bf16 v[208:211], a[156:159], a[232:235], v[208:211]
    buffer_store_dwordx4 v[216:219], v242, s[20:23], s58 offen sc0 sc1
    v_mfma_f32_16x16x32_bf16 v[212:215], a[160:163], a[232:235], v[212:215]
    v_cvt_pk_bf16_f32 v177, v178, v179
    v_cvt_pk_bf16_f32 v180, v180, v181
    v_mfma_f32_16x16x32_bf16 v[216:219], a[152:155], v[252:255], 0
    s_waitcnt lgkmcnt(1)
    buffer_store_dwordx2 v[176:177], v243, s[20:23], s58 offen sc0 sc1
    v_mfma_f32_16x16x32_bf16 v[216:219], a[164:167], a[232:235], v[216:219]
    s_add_u32 s58, s51, 0x1a4000
    v_cvt_pk_bf16_f32 v181, v182, v183
    v_cvt_pk_bf16_f32 v182, v200, v201
    v_mfma_f32_16x16x32_bf16 v[208:211], a[168:171], a[236:239], v[208:211]
    v_cvt_pk_bf16_f32 v183, v202, v203
    v_cvt_pk_bf16_f32 v204, v204, v205
    v_mfma_f32_16x16x32_bf16 v[212:215], a[172:175], a[236:239], v[212:215]
    buffer_store_dwordx4 v[180:183], v244, s[20:23], s59 offen sc0 sc1
    v_mfma_f32_16x16x32_bf16 v[216:219], a[176:179], a[236:239], v[216:219]
    s_waitcnt lgkmcnt(0)
    ds_read_b128 a[248:251], v226 offset:1472
    v_cvt_pk_bf16_f32 v205, v206, v207
    v_mfma_f32_16x16x32_bf16 v[208:211], a[180:183], a[240:243], v[208:211]
    buffer_store_dwordx2 v[204:205], v245, s[20:23], s59 offen sc0 sc1
    v_mfma_f32_16x16x32_bf16 v[212:215], a[184:187], a[240:243], v[212:215]
    s_add_u32 s59, s51, 0x1a5800
    ds_read_b128 v[252:255], v224 offset:15552
    ds_read_b128 a[232:235], v224 offset:15616
    v_mfma_f32_16x16x32_bf16 v[216:219], a[188:191], a[240:243], v[216:219]
    ds_read_b128 a[236:239], v224 offset:15680
    ds_read_b128 a[240:243], v224 offset:15744
    v_mfma_f32_16x16x32_bf16 v[208:211], a[192:195], a[244:247], v[208:211]
    v_mfma_f32_16x16x32_bf16 v[212:215], a[196:199], a[244:247], v[212:215]
    v_mfma_f32_16x16x32_bf16 v[216:219], a[200:203], a[244:247], v[216:219]
    ds_read_b128 a[244:247], v224 offset:15808
    v_mfma_f32_16x16x32_bf16 v[220:223], a[0:3], a[252:255], 0
    v_mfma_f32_16x16x32_bf16 v[176:179], a[4:7], a[252:255], 0
    s_waitcnt lgkmcnt(5)
    v_mfma_f32_16x16x32_bf16 v[208:211], a[204:207], a[248:251], v[208:211]
    v_mfma_f32_16x16x32_bf16 v[212:215], a[208:211], a[248:251], v[212:215]
    v_mfma_f32_16x16x32_bf16 v[216:219], a[212:215], a[248:251], v[216:219]
    ds_read_b128 a[248:251], v224 offset:18560
    v_mfma_f32_16x16x32_bf16 v[180:183], a[8:11], a[252:255], 0
    v_mfma_f32_16x16x32_bf16 v[200:203], a[252:255], a[72:75], 0
    v_mfma_f32_16x16x32_bf16 v[204:207], a[252:255], a[76:79], 0
    s_waitcnt lgkmcnt(3)
    v_mfma_f32_16x16x32_bf16 v[220:223], a[12:15], v[252:255], v[220:223]
    v_mfma_f32_16x16x32_bf16 v[176:179], a[16:19], v[252:255], v[176:179]
    v_mul_f32 v208, s37, v208
    v_mul_f32 v209, s37, v209
    v_mfma_f32_16x16x32_bf16 v[180:183], a[20:23], v[252:255], v[180:183]
    v_mul_f32 v210, s37, v210
    v_mul_f32 v211, s37, v211
    v_mfma_f32_16x16x32_bf16 v[200:203], v[252:255], a[84:87], v[200:203]
    v_cvt_pk_bf16_f32 v132, v208, v209
    v_cvt_pk_bf16_f32 v133, v210, v211
    v_mfma_f32_16x16x32_bf16 v[208:211], a[252:255], a[80:83], 0
    v_mul_f32 v212, s37, v212
    v_mul_f32 v213, s37, v213
    v_mfma_f32_16x16x32_bf16 v[204:207], v[252:255], a[88:91], v[204:207]
    v_mul_f32 v214, s37, v214
    v_mul_f32 v215, s37, v215
    v_mfma_f32_16x16x32_bf16 v[208:211], v[252:255], a[92:95], v[208:211]
    v_cvt_pk_bf16_f32 v134, v212, v213
    v_cvt_pk_bf16_f32 v135, v214, v215
    v_mfma_f32_16x16x32_bf16 v[220:223], a[24:27], a[232:235], v[220:223]
    v_mul_f32 v216, s37, v216
    v_mul_f32 v217, s37, v217
    v_mfma_f32_16x16x32_bf16 v[156:159], v[12:15], v[132:135], v[156:159]
    v_mul_f32 v218, s37, v218
    v_mul_f32 v219, s37, v219
    v_mfma_f32_16x16x32_bf16 v[160:163], v[36:39], v[132:135], v[160:163]
    v_cvt_pk_bf16_f32 v136, v216, v217
    v_cvt_pk_bf16_f32 v137, v218, v219
    v_mfma_f32_16x16x32_bf16 v[164:167], v[42:45], v[132:135], v[164:167]
    ds_read_b128 a[252:255], v224 offset:18624
    ds_read_b128 v[252:255], v224 offset:18688
    v_mfma_f32_16x16x16_bf16 v[156:159], v[16:17], v[136:137], v[156:159]
    v_mfma_f32_16x16x16_bf16 v[160:163], v[40:41], v[136:137], v[160:163]
    v_mfma_f32_16x16x32_bf16 v[144:147], v[18:21], v[132:135], v[144:147]
    v_mfma_f32_16x16x32_bf16 v[148:151], v[0:3], v[132:135], v[148:151]
    v_mfma_f32_16x16x16_bf16 v[164:167], v[46:47], v[136:137], v[164:167]
    v_mfma_f32_16x16x32_bf16 v[152:155], v[24:27], v[132:135], v[152:155]
    v_mfma_f32_16x16x32_bf16 v[176:179], a[28:31], a[232:235], v[176:179]
    v_mfma_f32_16x16x32_bf16 v[180:183], a[32:35], a[232:235], v[180:183]
    v_mfma_f32_16x16x32_bf16 v[200:203], a[232:235], a[96:99], v[200:203]
    v_exp_f32 v156, v156
    v_mfma_f32_16x16x16_bf16 v[144:147], v[22:23], v[136:137], v[144:147]
    v_exp_f32 v157, v157
    v_mfma_f32_16x16x16_bf16 v[148:151], v[4:5], v[136:137], v[148:151]
    v_exp_f32 v158, v158
    v_mfma_f32_16x16x16_bf16 v[152:155], v[28:29], v[136:137], v[152:155]
    v_exp_f32 v159, v159
    v_mfma_f32_16x16x32_bf16 v[204:207], a[232:235], a[100:103], v[204:207]
    v_cvt_pk_bf16_f32 v168, v156, v157
    v_cvt_pk_bf16_f32 v169, v158, v159
    v_mfma_f32_16x16x32_bf16 v[208:211], a[232:235], a[104:107], v[208:211]
    ds_read_b128 a[232:235], v224 offset:18752
    ds_read_b128 v[156:159], v236
    v_mfma_f32_16x16x32_bf16 v[220:223], a[36:39], a[236:239], v[220:223]
    v_bfe_u32 v236, s78, v232, 4
    v_mad_u32_u24 v236, v236, s40, v230
    v_mfma_f32_16x16x32_bf16 v[176:179], a[40:43], a[236:239], v[176:179]
    v_exp_f32 v160, v160
    v_mfma_f32_16x16x32_bf16 v[180:183], a[44:47], a[236:239], v[180:183]
    v_exp_f32 v161, v161
    v_mfma_f32_16x16x32_bf16 v[200:203], a[236:239], a[108:111], v[200:203]
    v_exp_f32 v162, v162
    v_mfma_f32_16x16x32_bf16 v[204:207], a[236:239], a[112:115], v[204:207]
    v_exp_f32 v163, v163
    v_mfma_f32_16x16x32_bf16 v[208:211], a[236:239], a[116:119], v[208:211]
    s_waitcnt lgkmcnt(2)
    ds_read_b128 a[236:239], v224 offset:18816
    v_cvt_pk_bf16_f32 v170, v160, v161
    v_mfma_f32_16x16x32_bf16 v[220:223], a[48:51], a[240:243], v[220:223]
    v_cvt_pk_bf16_f32 v171, v162, v163
    v_mfma_f32_16x16x32_bf16 v[176:179], a[52:55], a[240:243], v[176:179]
    ds_read_b128 v[160:163], v235
    v_bfe_u32 v235, s77, v232, 4
    v_mfma_f32_16x16x32_bf16 v[196:199], a[216:219], v[168:171], 0
    v_mad_u32_u24 v235, v235, s40, v230
    v_mfma_f32_16x16x32_bf16 v[184:187], v[74:77], v[168:171], 0
    v_exp_f32 v164, v164
    v_mfma_f32_16x16x32_bf16 v[188:191], v[96:99], v[168:171], 0
    v_exp_f32 v165, v165
    v_mfma_f32_16x16x32_bf16 v[192:195], v[118:121], v[168:171], 0
    v_exp_f32 v166, v166
    v_mfma_f32_16x16x32_bf16 v[180:183], a[56:59], a[240:243], v[180:183]
    v_exp_f32 v167, v167
    v_mfma_f32_16x16x32_bf16 v[200:203], a[240:243], a[120:123], v[200:203]
    v_cvt_pk_bf16_f32 v172, v164, v165
    v_cvt_pk_bf16_f32 v173, v166, v167
    v_mfma_f32_16x16x32_bf16 v[204:207], a[240:243], a[124:127], v[204:207]
    ds_read_b128 v[164:167], v234
    v_bfe_u32 v234, s79, v233, 4
    v_mfma_f32_16x16x32_bf16 v[208:211], a[240:243], a[128:131], v[208:211]
    ds_read_b128 a[240:243], v224 offset:18880
    v_mad_u32_u24 v234, v234, s40, v231
    v_mfma_f32_16x16x32_bf16 v[220:223], a[60:63], a[244:247], v[220:223]
    v_exp_f32 v144, v144
    v_mfma_f32_16x16x32_bf16 v[176:179], a[64:67], a[244:247], v[176:179]
    v_exp_f32 v145, v145
    v_mfma_f32_16x16x32_bf16 v[180:183], a[68:71], a[244:247], v[180:183]
    v_exp_f32 v146, v146
    v_mfma_f32_16x16x32_bf16 v[200:203], a[244:247], a[132:135], v[200:203]
    v_exp_f32 v147, v147
    v_mfma_f32_16x16x32_bf16 v[204:207], a[244:247], a[136:139], v[204:207]
    v_cvt_pk_bf16_f32 v6, v220, v221
    v_cvt_pk_bf16_f32 v7, v222, v223
    v_mfma_f32_16x16x32_bf16 v[208:211], a[244:247], a[140:143], v[208:211]
    v_cvt_pk_bf16_f32 v8, v176, v177
    v_cvt_pk_bf16_f32 v9, v178, v179
    v_mfma_f32_16x16x32_bf16 v[212:215], a[0:3], a[248:251], 0
    s_waitcnt lgkmcnt(2)
    v_cvt_pk_bf16_f32 v10, v180, v181
    v_cvt_pk_bf16_f32 v11, v182, v183
    v_mfma_f32_16x16x32_bf16 v[160:163], v[6:9], v[132:135], v[160:163]
    v_cvt_pk_bf16_f32 v72, v200, v201
    v_cvt_pk_bf16_f32 v73, v202, v203
    v_mfma_f32_16x16x32_bf16 v[216:219], a[4:7], a[248:251], 0
    v_cvt_pk_bf16_f32 v94, v204, v205
    v_cvt_pk_bf16_f32 v95, v206, v207
    v_mfma_f32_16x16x32_bf16 v[220:223], a[8:11], a[248:251], 0
    v_cvt_pk_bf16_f32 v116, v208, v209
    v_cvt_pk_bf16_f32 v117, v210, v211
    v_mfma_f32_16x16x16_bf16 v[160:163], v[10:11], v[136:137], v[160:163]
    ds_read_b128 a[244:247], v226 offset:4224
    v_cvt_pk_bf16_f32 v174, v144, v145
    v_mfma_f32_16x16x32_bf16 v[176:179], a[248:251], a[72:75], 0
    v_cvt_pk_bf16_f32 v175, v146, v147
    v_mfma_f32_16x16x32_bf16 v[180:183], a[248:251], a[76:79], 0
    ds_read_b128 v[144:147], v230 offset:1280
    v_mfma_f32_16x16x32_bf16 v[196:199], a[216:219], v[172:175], v[196:199]
    v_exp_f32 v148, v148
    v_mfma_f32_16x16x32_bf16 v[184:187], v[78:81], v[172:175], v[184:187]
    v_exp_f32 v149, v149
    v_mfma_f32_16x16x32_bf16 v[188:191], v[100:103], v[172:175], v[188:191]
    v_exp_f32 v150, v150
    v_mfma_f32_16x16x32_bf16 v[192:195], v[122:125], v[172:175], v[192:195]
    v_exp_f32 v151, v151
    v_mfma_f32_16x16x32_bf16 v[200:203], a[248:251], a[80:83], 0
    ds_read_b128 a[248:251], v226 offset:4288
    v_cvt_pk_bf16_f32 v168, v148, v149
    v_mfma_f32_16x16x32_bf16 v[212:215], a[12:15], a[252:255], v[212:215]
    ds_read_b64_tr_b16 a[12:13], v240 offset:12288
    ds_read_b64_tr_b16 a[14:15], v240 offset:26112
    v_mfma_f32_16x16x32_bf16 v[216:219], a[16:19], a[252:255], v[216:219]
    ds_read_b64_tr_b16 a[16:17], v240 offset:12296
    ds_read_b64_tr_b16 a[18:19], v240 offset:26120
    v_mfma_f32_16x16x32_bf16 v[220:223], a[20:23], a[252:255], v[220:223]
    ds_read_b64_tr_b16 a[20:21], v241 offset:12288
    v_cvt_pk_bf16_f32 v169, v150, v151
    v_mfma_f32_16x16x32_bf16 v[176:179], a[252:255], a[84:87], v[176:179]
    ds_read_b64_tr_b16 a[22:23], v241 offset:26112
    ds_read_b128 v[148:151], v235
    v_mfma_f32_16x16x32_bf16 v[180:183], a[252:255], a[88:91], v[180:183]
    v_bfe_u32 v235, s80, v233, 4
    v_mad_u32_u24 v235, v235, s40, v231
    v_mfma_f32_16x16x32_bf16 v[200:203], a[252:255], a[92:95], v[200:203]
    ds_read_b128 a[252:255], v226 offset:4352
    v_mfma_f32_16x16x32_bf16 v[212:215], a[24:27], v[252:255], v[212:215]
    ds_read_b64_tr_b16 a[24:25], v240 offset:13824
    v_mfma_f32_16x16x32_bf16 v[216:219], a[28:31], v[252:255], v[216:219]
    ds_read_b64_tr_b16 a[26:27], v240 offset:24576
    v_mfma_f32_16x16x32_bf16 v[220:223], a[32:35], v[252:255], v[220:223]
    ds_read_b64_tr_b16 a[28:29], v240 offset:13832
    v_mfma_f32_16x16x32_bf16 v[176:179], v[252:255], a[96:99], v[176:179]
    ds_read_b64_tr_b16 a[30:31], v240 offset:24584
    v_mfma_f32_16x16x32_bf16 v[180:183], v[252:255], a[100:103], v[180:183]
    ds_read_b64_tr_b16 a[32:33], v241 offset:13824
    v_mfma_f32_16x16x32_bf16 v[200:203], v[252:255], a[104:107], v[200:203]
    ds_read_b64_tr_b16 a[34:35], v241 offset:24576
    ds_read_b128 v[252:255], v226 offset:4416
    v_mfma_f32_16x16x32_bf16 v[212:215], a[36:39], a[232:235], v[212:215]
    ds_read_b64_tr_b16 a[36:37], v240 offset:36864
    v_mfma_f32_16x16x32_bf16 v[216:219], a[40:43], a[232:235], v[216:219]
    ds_read_b64_tr_b16 a[38:39], v240 offset:38400
    v_mfma_f32_16x16x32_bf16 v[220:223], a[44:47], a[232:235], v[220:223]
    ds_read_b64_tr_b16 a[40:41], v240 offset:36872
    v_mfma_f32_16x16x32_bf16 v[176:179], a[232:235], a[108:111], v[176:179]
    ds_read_b64_tr_b16 a[42:43], v240 offset:38408
    v_mfma_f32_16x16x32_bf16 v[180:183], a[232:235], a[112:115], v[180:183]
    ds_read_b64_tr_b16 a[44:45], v241 offset:36864
    v_mfma_f32_16x16x32_bf16 v[200:203], a[232:235], a[116:119], v[200:203]
    ds_read_b64_tr_b16 a[46:47], v241 offset:38400
    ds_read_b128 a[232:235], v226 offset:4480
    v_mfma_f32_16x16x32_bf16 v[212:215], a[48:51], a[236:239], v[212:215]
    ds_read_b64_tr_b16 a[48:49], v240 offset:49152
    v_mfma_f32_16x16x32_bf16 v[216:219], a[52:55], a[236:239], v[216:219]
    ds_read_b64_tr_b16 a[50:51], v240 offset:62976
    v_mfma_f32_16x16x32_bf16 v[220:223], a[56:59], a[236:239], v[220:223]
    ds_read_b64_tr_b16 a[52:53], v240 offset:49160
    v_mfma_f32_16x16x32_bf16 v[176:179], a[236:239], a[120:123], v[176:179]
    ds_read_b64_tr_b16 a[54:55], v240 offset:62984
    v_mfma_f32_16x16x32_bf16 v[180:183], a[236:239], a[124:127], v[180:183]
    ds_read_b64_tr_b16 a[56:57], v241 offset:49152
    v_mfma_f32_16x16x32_bf16 v[200:203], a[236:239], a[128:131], v[200:203]
    s_waitcnt lgkmcnt(12)
    ds_read_b64_tr_b16 a[58:59], v241 offset:62976
    ds_read_b128 a[236:239], v226 offset:4544
    v_mfma_f32_16x16x32_bf16 v[212:215], a[60:63], a[240:243], v[212:215]
    ds_read_b64_tr_b16 a[60:61], v240 offset:50688
    v_mfma_f32_16x16x32_bf16 v[216:219], a[64:67], a[240:243], v[216:219]
    ds_read_b64_tr_b16 a[62:63], v240 offset:61440
    v_mfma_f32_16x16x32_bf16 v[220:223], a[68:71], a[240:243], v[220:223]
    ds_read_b64_tr_b16 a[64:65], v240 offset:50696
    v_mfma_f32_16x16x32_bf16 v[176:179], a[240:243], a[132:135], v[176:179]
    ds_read_b64_tr_b16 a[66:67], v240 offset:61448
    v_mfma_f32_16x16x32_bf16 v[180:183], a[240:243], a[136:139], v[180:183]
    v_cvt_pk_bf16_f32 v30, v212, v213
    v_cvt_pk_bf16_f32 v31, v214, v215
    v_mfma_f32_16x16x32_bf16 v[200:203], a[240:243], a[140:143], v[200:203]
    v_cvt_pk_bf16_f32 v32, v216, v217
    v_cvt_pk_bf16_f32 v33, v218, v219
    v_mfma_f32_16x16x32_bf16 v[204:207], a[144:147], a[244:247], 0
    v_cvt_pk_bf16_f32 v34, v220, v221
    v_cvt_pk_bf16_f32 v35, v222, v223
    v_mfma_f32_16x16x32_bf16 v[156:159], v[30:33], v[132:135], v[156:159]
    v_cvt_pk_bf16_f32 v70, v176, v177
    v_cvt_pk_bf16_f32 v71, v178, v179
    v_mfma_f32_16x16x32_bf16 v[208:211], a[148:151], a[244:247], 0
    v_cvt_pk_bf16_f32 v92, v180, v181
    v_cvt_pk_bf16_f32 v93, v182, v183
    v_mfma_f32_16x16x32_bf16 v[212:215], a[152:155], a[244:247], 0
    v_cvt_pk_bf16_f32 v114, v200, v201
    v_cvt_pk_bf16_f32 v115, v202, v203
    v_mfma_f32_16x16x16_bf16 v[156:159], v[34:35], v[136:137], v[156:159]
    ds_read_b64_tr_b16 a[68:69], v241 offset:50688
    ds_read_b64_tr_b16 a[70:71], v241 offset:61440
    v_mfma_f32_16x16x32_bf16 v[204:207], a[156:159], a[248:251], v[204:207]
    ds_read_b128 a[240:243], v239 offset:12288
    ds_read_b128 a[244:247], v239 offset:18432
    v_mfma_f32_16x16x32_bf16 v[208:211], a[160:163], a[248:251], v[208:211]
    v_exp_f32 v152, v152
    v_mfma_f32_16x16x32_bf16 v[212:215], a[164:167], a[248:251], v[212:215]
    ds_read_b128 a[248:251], v239 offset:13312
    v_mfma_f32_16x16x32_bf16 v[204:207], a[168:171], a[252:255], v[204:207]
    v_exp_f32 v153, v153
    v_mfma_f32_16x16x32_bf16 v[208:211], a[172:175], a[252:255], v[208:211]
    v_exp_f32 v154, v154
    v_mfma_f32_16x16x32_bf16 v[212:215], a[176:179], a[252:255], v[212:215]
    ds_read_b128 a[252:255], v239 offset:19456
    v_cvt_pk_bf16_f32 v170, v152, v153
    v_mfma_f32_16x16x32_bf16 v[204:207], a[180:183], v[252:255], v[204:207]
    v_exp_f32 v155, v155
    v_mfma_f32_16x16x32_bf16 v[208:211], a[184:187], v[252:255], v[208:211]
    v_cvt_pk_bf16_f32 v171, v154, v155
    v_mfma_f32_16x16x32_bf16 v[212:215], a[188:191], v[252:255], v[212:215]
    ds_read_b128 v[252:255], v239 offset:14336
    ds_read_b128 v[152:155], v236
    v_mfma_f32_16x16x32_bf16 v[196:199], a[216:219], v[168:171], v[196:199]
    v_exp_f32 v156, v156
    v_mfma_f32_16x16x32_bf16 v[184:187], v[66:69], v[168:171], v[184:187]
    v_exp_f32 v157, v157
    v_mfma_f32_16x16x32_bf16 v[188:191], v[88:91], v[168:171], v[188:191]
    v_exp_f32 v158, v158
    v_mfma_f32_16x16x32_bf16 v[192:195], v[110:113], v[168:171], v[192:195]
    s_waitcnt lgkmcnt(3)
    v_exp_f32 v159, v159
    v_mfma_f32_16x16x32_bf16 v[204:207], a[192:195], a[232:235], v[204:207]
    v_cvt_pk_bf16_f32 v172, v156, v157
    v_cvt_pk_bf16_f32 v173, v158, v159
    v_mfma_f32_16x16x32_bf16 v[208:211], a[196:199], a[232:235], v[208:211]
    ds_read_b128 v[156:159], v234
    v_mfma_f32_16x16x32_bf16 v[212:215], a[200:203], a[232:235], v[212:215]
    ds_read_b128 a[232:235], v239 offset:20480
    v_mfma_f32_16x16x32_bf16 v[204:207], a[204:207], a[236:239], v[204:207]
    v_exp_f32 v160, v160
    v_mfma_f32_16x16x32_bf16 v[208:211], a[208:211], a[236:239], v[208:211]
    v_exp_f32 v161, v161
    v_mfma_f32_16x16x32_bf16 v[212:215], a[212:215], a[236:239], v[212:215]
    ds_read_b128 a[236:239], v239 offset:15360
    v_cvt_pk_bf16_f32 v174, v160, v161
    v_mfma_f32_16x16x32_bf16 v[216:219], a[220:223], a[240:243], 0
    v_exp_f32 v162, v162
    v_mfma_f32_16x16x32_bf16 v[180:183], a[220:223], a[244:247], 0
    v_mul_f32 v204, s37, v204
    v_mul_f32 v205, s37, v205
    v_mfma_f32_16x16x32_bf16 v[220:223], a[224:227], a[240:243], 0
    v_mul_f32 v206, s37, v206
    v_mul_f32 v207, s37, v207
    v_mfma_f32_16x16x32_bf16 v[200:203], a[224:227], a[244:247], 0
    v_cvt_pk_bf16_f32 v138, v204, v205
    v_cvt_pk_bf16_f32 v139, v206, v207
    v_mfma_f32_16x16x32_bf16 v[176:179], a[228:231], a[240:243], 0
    v_mul_f32 v208, s37, v208
    v_mul_f32 v209, s37, v209
    v_mfma_f32_16x16x32_bf16 v[204:207], a[228:231], a[244:247], 0
    v_mul_f32 v210, s37, v210
    v_mul_f32 v211, s37, v211
    v_mfma_f32_16x16x32_bf16 v[216:219], a[12:15], a[248:251], v[216:219]
    s_waitcnt lgkmcnt(2)
    v_cvt_pk_bf16_f32 v140, v208, v209
    v_cvt_pk_bf16_f32 v141, v210, v211
    v_mfma_f32_16x16x32_bf16 v[180:183], a[12:15], a[252:255], v[180:183]
L_pg8:
    s_cbranch_execz L_back
    v_mul_f32 v212, s37, v212
    v_mul_f32 v213, s37, v213
    v_mfma_f32_16x16x32_bf16 v[164:167], v[36:39], v[138:141], v[164:167]
    v_mul_f32 v214, s37, v214
    v_mul_f32 v215, s37, v215
    v_mfma_f32_16x16x32_bf16 v[144:147], v[42:45], v[138:141], v[144:147]
    v_cvt_pk_bf16_f32 v142, v212, v213
    v_cvt_pk_bf16_f32 v143, v214, v215
    v_mfma_f32_16x16x32_bf16 v[148:151], v[24:27], v[138:141], v[148:151]
    ds_read_b128 a[240:243], v239 offset:21504
    ds_read_b128 a[244:247], v239 offset:16384
    v_mfma_f32_16x16x16_bf16 v[164:167], v[40:41], v[142:143], v[164:167]
    v_exp_f32 v163, v163
    v_mfma_f32_16x16x16_bf16 v[144:147], v[46:47], v[142:143], v[144:147]
    v_cvt_pk_bf16_f32 v175, v162, v163
    v_mfma_f32_16x16x16_bf16 v[148:151], v[28:29], v[142:143], v[148:151]
    ds_read_b128 v[160:163], v235
    v_mfma_f32_16x16x32_bf16 v[196:199], a[216:219], v[172:175], v[196:199]
    v_mfma_f32_16x16x32_bf16 v[184:187], v[70:73], v[172:175], v[184:187]
    v_mfma_f32_16x16x32_bf16 v[188:191], v[92:95], v[172:175], v[188:191]
    v_exp_f32 v164, v164
    v_mfma_f32_16x16x32_bf16 v[192:195], v[114:117], v[172:175], v[192:195]
    v_exp_f32 v165, v165
    v_mfma_f32_16x16x32_bf16 v[152:155], v[30:33], v[138:141], v[152:155]
    v_exp_f32 v166, v166
    v_mfma_f32_16x16x32_bf16 v[156:159], v[48:51], v[138:141], v[156:159]
    v_rcp_f32 v197, v196
    v_mfma_f32_16x16x32_bf16 v[220:223], a[16:19], a[248:251], v[220:223]
    v_mul_f32 v184, v184, v197
    v_mul_f32 v185, v185, v197
    v_mfma_f32_16x16x16_bf16 v[152:155], v[34:35], v[142:143], v[152:155]
    v_cvt_pk_bf16_f32 v184, v184, v185
    v_mul_f32 v186, v186, v197
    v_mfma_f32_16x16x16_bf16 v[156:159], v[52:53], v[142:143], v[156:159]
    s_waitcnt lgkmcnt(0)
    v_mul_f32 v187, v187, v197
    v_cvt_pk_bf16_f32 v185, v186, v187
    v_mfma_f32_16x16x32_bf16 v[160:163], v[54:57], v[138:141], v[160:163]
    v_mul_f32 v188, v188, v197
    v_mul_f32 v189, v189, v197
    v_mfma_f32_16x16x32_bf16 v[200:203], a[16:19], a[252:255], v[200:203]
    v_cvt_pk_bf16_f32 v186, v188, v189
    v_mul_f32 v190, v190, v197
    v_mfma_f32_16x16x32_bf16 v[176:179], a[20:23], a[248:251], v[176:179]
    ds_read_b128 a[248:251], v239 offset:22528
    v_mul_f32 v191, v191, v197
    v_mfma_f32_16x16x16_bf16 v[160:163], v[58:59], v[142:143], v[160:163]
    v_cvt_pk_bf16_f32 v187, v190, v191
    v_mul_f32 v192, v192, v197
    v_mfma_f32_16x16x32_bf16 v[204:207], a[20:23], a[252:255], v[204:207]
    ds_read_b128 a[252:255], v239 offset:17408
    v_mul_f32 v193, v193, v197
    v_mfma_f32_16x16x32_bf16 v[216:219], a[24:27], v[252:255], v[216:219]
    v_cvt_pk_bf16_f32 v188, v192, v193
    v_mul_f32 v194, v194, v197
    v_mfma_f32_16x16x32_bf16 v[180:183], a[24:27], a[232:235], v[180:183]
    v_mul_f32 v195, v195, v197
    v_cvt_pk_bf16_f32 v189, v194, v195
    v_mfma_f32_16x16x32_bf16 v[220:223], a[28:31], v[252:255], v[220:223]
    v_max3_f32 v250, v250, v196, v197
    v_cvt_pk_bf16_f32 v168, v164, v165
    v_mfma_f32_16x16x32_bf16 v[200:203], a[28:31], a[232:235], v[200:203]
    ds_write_b128 v237, v[184:187]
    v_mfma_f32_16x16x32_bf16 v[176:179], a[32:35], v[252:255], v[176:179]
    ds_read_b128 v[252:255], v239 offset:23552
    v_mfma_f32_16x16x32_bf16 v[204:207], a[32:35], a[232:235], v[204:207]
    ds_write_b64 v238, v[188:189]
    v_mfma_f32_16x16x32_bf16 v[216:219], a[36:39], a[236:239], v[216:219]
    v_exp_f32 v167, v167
    v_mfma_f32_16x16x32_bf16 v[180:183], a[36:39], a[240:243], v[180:183]
    v_cvt_pk_bf16_f32 v169, v166, v167
    v_mfma_f32_16x16x32_bf16 v[220:223], a[40:43], a[236:239], v[220:223]
    v_exp_f32 v144, v144
    v_mfma_f32_16x16x32_bf16 v[200:203], a[40:43], a[240:243], v[200:203]
    v_exp_f32 v145, v145
    v_mfma_f32_16x16x32_bf16 v[176:179], a[44:47], a[236:239], v[176:179]
    v_exp_f32 v146, v146
    v_mfma_f32_16x16x32_bf16 v[204:207], a[44:47], a[240:243], v[204:207]
    v_exp_f32 v147, v147
    v_mfma_f32_16x16x32_bf16 v[216:219], a[48:51], a[244:247], v[216:219]
    s_waitcnt lgkmcnt(3)
    v_cvt_pk_bf16_f32 v170, v144, v145
    v_cvt_pk_bf16_f32 v171, v146, v147
    v_mfma_f32_16x16x32_bf16 v[180:183], a[48:51], a[248:251], v[180:183]
    s_waitcnt lgkmcnt(0)
    v_exp_f32 v148, v148
    v_mfma_f32_16x16x32_bf16 v[196:199], a[216:219], v[168:171], 0
    s_barrier
    ds_read_b128 a[232:235], v239
    ds_read_b128 a[236:239], v239 offset:1024
    v_mfma_f32_16x16x32_bf16 v[184:187], v[76:79], v[168:171], 0
    ds_read_b128 a[240:243], v239 offset:2048
    v_mfma_f32_16x16x32_bf16 v[188:191], v[98:101], v[168:171], 0
    v_exp_f32 v149, v149
    v_mfma_f32_16x16x32_bf16 v[192:195], v[120:123], v[168:171], 0
    v_exp_f32 v150, v150
    v_mfma_f32_16x16x32_bf16 v[220:223], a[52:55], a[244:247], v[220:223]
    v_exp_f32 v151, v151
    v_mfma_f32_16x16x32_bf16 v[200:203], a[52:55], a[248:251], v[200:203]
    v_cvt_pk_bf16_f32 v172, v148, v149
    v_cvt_pk_bf16_f32 v173, v150, v151
    v_mfma_f32_16x16x32_bf16 v[176:179], a[56:59], a[244:247], v[176:179]
    ds_read_b128 a[244:247], v239 offset:3072
    v_mfma_f32_16x16x32_bf16 v[204:207], a[56:59], a[248:251], v[204:207]
    ds_read_b128 a[248:251], v239 offset:4096
    v_mfma_f32_16x16x32_bf16 v[216:219], a[60:63], a[252:255], v[216:219]
    v_exp_f32 v152, v152
    v_mfma_f32_16x16x32_bf16 v[180:183], a[60:63], v[252:255], v[180:183]
    v_exp_f32 v153, v153
    v_mfma_f32_16x16x32_bf16 v[220:223], a[64:67], a[252:255], v[220:223]
    v_exp_f32 v154, v154
    v_mfma_f32_16x16x32_bf16 v[200:203], a[64:67], v[252:255], v[200:203]
    v_exp_f32 v155, v155
    v_mfma_f32_16x16x32_bf16 v[176:179], a[68:71], a[252:255], v[176:179]
    ds_read_b128 a[252:255], v239 offset:5120
    v_cvt_pk_bf16_f32 v216, v216, v217
    v_mfma_f32_16x16x32_bf16 v[204:207], a[68:71], v[252:255], v[204:207]
    s_waitcnt lgkmcnt(3)
    v_cvt_pk_bf16_f32 v217, v218, v219
    v_cvt_pk_bf16_f32 v218, v220, v221
    v_mfma_f32_16x16x32_bf16 v[208:211], a[220:223], a[232:235], 0
    v_cvt_pk_bf16_f32 v219, v222, v223
    v_cvt_pk_bf16_f32 v180, v180, v181
    v_mfma_f32_16x16x32_bf16 v[212:215], a[224:227], a[232:235], 0
    buffer_store_dwordx4 v[216:219], v242, s[20:23], s58 offen sc0 sc1
    v_mfma_f32_16x16x32_bf16 v[208:211], a[12:15], a[236:239], v[208:211]
    v_cvt_pk_bf16_f32 v176, v176, v177
    v_cvt_pk_bf16_f32 v177, v178, v179
    v_mfma_f32_16x16x32_bf16 v[216:219], a[228:231], a[232:235], 0
    buffer_store_dwordx2 v[176:177], v243, s[20:23], s58 offen sc0 sc1
    v_mfma_f32_16x16x32_bf16 v[212:215], a[16:19], a[236:239], v[212:215]
    s_add_u32 s58, s51, 0x1f8000
    v_cvt_pk_bf16_f32 v181, v182, v183
    v_cvt_pk_bf16_f32 v182, v200, v201
    v_mfma_f32_16x16x32_bf16 v[216:219], a[20:23], a[236:239], v[216:219]
    v_cvt_pk_bf16_f32 v183, v202, v203
    v_cvt_pk_bf16_f32 v204, v204, v205
    v_mfma_f32_16x16x32_bf16 v[208:211], a[24:27], a[240:243], v[208:211]
    buffer_store_dwordx4 v[180:183], v244, s[20:23], s59 offen sc0 sc1
    v_mfma_f32_16x16x32_bf16 v[212:215], a[28:31], a[240:243], v[212:215]
    v_cvt_pk_bf16_f32 v205, v206, v207
    v_cvt_pk_bf16_f32 v174, v152, v153
    v_mfma_f32_16x16x32_bf16 v[216:219], a[32:35], a[240:243], v[216:219]
    s_waitcnt lgkmcnt(0)
    buffer_store_dwordx2 v[204:205], v245, s[20:23], s59 offen sc0 sc1
    v_mfma_f32_16x16x32_bf16 v[208:211], a[36:39], a[244:247], v[208:211]
    s_add_u32 s59, s51, 0x1f9800
    v_cvt_pk_bf16_f32 v175, v154, v155
    v_mfma_f32_16x16x32_bf16 v[212:215], a[40:43], a[244:247], v[212:215]
    v_exp_f32 v156, v156
    v_mfma_f32_16x16x32_bf16 v[196:199], a[216:219], v[172:175], v[196:199]
    v_exp_f32 v157, v157
    v_mfma_f32_16x16x32_bf16 v[184:187], v[68:71], v[172:175], v[184:187]
    v_exp_f32 v158, v158
    v_mfma_f32_16x16x32_bf16 v[188:191], v[90:93], v[172:175], v[188:191]
    v_exp_f32 v159, v159
    v_mfma_f32_16x16x32_bf16 v[192:195], v[112:115], v[172:175], v[192:195]
    v_cvt_pk_bf16_f32 v168, v156, v157
    v_cvt_pk_bf16_f32 v169, v158, v159
    v_mfma_f32_16x16x32_bf16 v[216:219], a[44:47], a[244:247], v[216:219]
    v_exp_f32 v160, v160
    v_mfma_f32_16x16x32_bf16 v[208:211], a[48:51], a[248:251], v[208:211]
    v_exp_f32 v161, v161
    v_mfma_f32_16x16x32_bf16 v[212:215], a[52:55], a[248:251], v[212:215]
    v_exp_f32 v162, v162
    v_mfma_f32_16x16x32_bf16 v[216:219], a[56:59], a[248:251], v[216:219]
    v_exp_f32 v163, v163
    v_mfma_f32_16x16x32_bf16 v[208:211], a[60:63], a[252:255], v[208:211]
    v_cvt_pk_bf16_f32 v170, v160, v161
    v_cvt_pk_bf16_f32 v171, v162, v163
    v_mfma_f32_16x16x32_bf16 v[212:215], a[64:67], a[252:255], v[212:215]
    v_mfma_f32_16x16x32_bf16 v[216:219], a[68:71], a[252:255], v[216:219]
    v_mfma_f32_16x16x32_bf16 v[196:199], a[216:219], v[168:171], v[196:199]
    v_mfma_f32_16x16x32_bf16 v[184:187], v[82:85], v[168:171], v[184:187]
    v_mfma_f32_16x16x32_bf16 v[188:191], v[104:107], v[168:171], v[188:191]
    v_mfma_f32_16x16x32_bf16 v[192:195], v[126:129], v[168:171], v[192:195]
    v_cvt_pk_bf16_f32 v208, v208, v209
    v_cvt_pk_bf16_f32 v209, v210, v211
    s_nop 0
    v_cvt_pk_bf16_f32 v210, v212, v213
    v_cvt_pk_bf16_f32 v211, v214, v215
    buffer_store_dwordx4 v[208:211], v242, s[20:23], s58 offen sc0 sc1
    v_cvt_pk_bf16_f32 v216, v216, v217
    v_cvt_pk_bf16_f32 v217, v218, v219
    buffer_store_dwordx2 v[216:217], v243, s[20:23], s58 offen sc0 sc1
    v_rcp_f32 v197, v196
    s_nop 0
    v_mul_f32 v184, v184, v197
    v_mul_f32 v185, v185, v197
    v_cvt_pk_bf16_f32 v184, v184, v185
    v_mul_f32 v186, v186, v197
    v_mul_f32 v187, v187, v197
    v_cvt_pk_bf16_f32 v185, v186, v187
    v_mul_f32 v188, v188, v197
    v_mul_f32 v189, v189, v197
    v_cvt_pk_bf16_f32 v186, v188, v189
    v_mul_f32 v190, v190, v197
    v_mul_f32 v191, v191, v197
    v_cvt_pk_bf16_f32 v187, v190, v191
    v_mul_f32 v192, v192, v197
    v_mul_f32 v193, v193, v197
    v_cvt_pk_bf16_f32 v188, v192, v193
    v_mul_f32 v194, v194, v197
    v_mul_f32 v195, v195, v197
    v_cvt_pk_bf16_f32 v189, v194, v195
    v_max3_f32 v250, v250, v196, v197
    ds_write_b128 v237, v[184:187] offset:6144
    ds_write_b64 v238, v[188:189] offset:6144
    v_cmp_lt_f32 vcc, 0x53800000, v250
    s_nop 1
    s_or_b32 s24, vcc_lo, vcc_hi
    v_mov_b32 v248, s24
    ds_write_b32 v249, v248
    v_mov_b32 v249, 0x27e00
    s_waitcnt lgkmcnt(0)
    s_barrier
    ds_read_b128 v[252:255], v239 offset:6144
    ds_read_b128 a[232:235], v239 offset:7168
    ds_read_b128 a[236:239], v239 offset:8192
    ds_read_b128 a[240:243], v239 offset:9216
    ds_read_b128 a[244:247], v239 offset:10240
    ds_read_b128 a[248:251], v239 offset:11264
    ds_read_b128 v[0:3], v249
    s_waitcnt lgkmcnt(6)
    v_mfma_f32_16x16x32_bf16 v[220:223], a[220:223], v[252:255], 0
    v_mfma_f32_16x16x32_bf16 v[176:179], a[224:227], v[252:255], 0
    v_mfma_f32_16x16x32_bf16 v[180:183], a[228:231], v[252:255], 0
    s_waitcnt lgkmcnt(5)
    v_mfma_f32_16x16x32_bf16 v[220:223], a[12:15], a[232:235], v[220:223]
    v_mfma_f32_16x16x32_bf16 v[176:179], a[16:19], a[232:235], v[176:179]
    v_mfma_f32_16x16x32_bf16 v[180:183], a[20:23], a[232:235], v[180:183]
    s_waitcnt lgkmcnt(2)
    v_mfma_f32_16x16x32_bf16 v[220:223], a[24:27], a[236:239], v[220:223]
    s_waitcnt lgkmcnt(0)
    v_or3_b32 v0, v0, v1, v2
    v_or_b32 v0, v0, v3
    v_mfma_f32_16x16x32_bf16 v[176:179], a[28:31], a[236:239], v[176:179]
    v_readfirstlane_b32 s24, v0
    v_mfma_f32_16x16x32_bf16 v[180:183], a[32:35], a[236:239], v[180:183]
    v_mfma_f32_16x16x32_bf16 v[220:223], a[36:39], a[240:243], v[220:223]
    v_mfma_f32_16x16x32_bf16 v[176:179], a[40:43], a[240:243], v[176:179]
    v_mfma_f32_16x16x32_bf16 v[180:183], a[44:47], a[240:243], v[180:183]
    v_mfma_f32_16x16x32_bf16 v[220:223], a[48:51], a[244:247], v[220:223]
    v_mfma_f32_16x16x32_bf16 v[176:179], a[52:55], a[244:247], v[176:179]
    v_mfma_f32_16x16x32_bf16 v[180:183], a[56:59], a[244:247], v[180:183]
    v_mfma_f32_16x16x32_bf16 v[220:223], a[60:63], a[248:251], v[220:223]
    v_mfma_f32_16x16x32_bf16 v[176:179], a[64:67], a[248:251], v[176:179]
    v_mfma_f32_16x16x32_bf16 v[180:183], a[68:71], a[248:251], v[180:183]
    s_nop 5
    v_cvt_pk_bf16_f32 v220, v220, v221
    v_cvt_pk_bf16_f32 v221, v222, v223
    v_cvt_pk_bf16_f32 v222, v176, v177
    v_cvt_pk_bf16_f32 v223, v178, v179
    buffer_store_dwordx4 v[220:223], v244, s[20:23], s59 offen sc0 sc1
    v_cvt_pk_bf16_f32 v180, v180, v181
    v_cvt_pk_bf16_f32 v181, v182, v183
    buffer_store_dwordx2 v[180:181], v245, s[20:23], s59 offen sc0 sc1
    s_nop 1
    s_cmp_lg_u32 s24, 0
    s_cbranch_scc1 L_safe
L_exit:
    s_endpgm
L_end:
L_safe:
    s_waitcnt vmcnt(0) lgkmcnt(0)
    s_barrier
    v_mbcnt_lo_u32_b32 v0, -1, 0
    v_mbcnt_hi_u32_b32 v0, -1, v0
    s_lshl_b32 s24, s36, 6
    v_add_u32 v0, s24, v0
    s_load_dwordx4 s[24:27], s[0:1], 0
    s_load_dwordx4 s[28:31], s[0:1], 16
    s_load_dwordx2 s[32:33], s[0:1], 32
    v_lshrrev_b32 v74, 6, v0
    v_and_b32 v184, 63, v0
    v_readfirstlane_b32 s36, v74
    v_mul_u32_u24 v76, 0x2aab, v184
    v_lshrrev_b32 v76, 16, v76
    v_mul_u32_u24 v74, 6, v76
    v_sub_u32 v77, v184, v74
    v_lshrrev_b32 v74, 1, v76
    v_and_b32 v74, 4, v74
    v_xor_b32 v76, v76, v74
    v_mul_u32_u24 v74, 0x480, v76
    v_lshl_add_u32 v251, v77, 4, v74
    v_add_u32 v79, 64, v184
    v_mul_u32_u24 v78, 0x2aab, v79
    v_lshrrev_b32 v78, 16, v78
    v_mul_u32_u24 v74, 6, v78
    v_sub_u32 v79, v79, v74
    v_lshrrev_b32 v74, 1, v78
    v_and_b32 v74, 4, v74
    v_xor_b32 v78, v78, v74
    v_mul_u32_u24 v74, 0x480, v78
    v_lshl_add_u32 v252, v79, 4, v74
    v_add_u32 v81, 0x80, v184
    v_mul_u32_u24 v80, 0x2aab, v81
    v_lshrrev_b32 v80, 16, v80
    v_mul_u32_u24 v74, 6, v80
    v_sub_u32 v81, v81, v74
    v_lshrrev_b32 v74, 1, v80
    v_and_b32 v74, 4, v74
    v_xor_b32 v80, v80, v74
    v_mul_u32_u24 v74, 0x480, v80
    v_lshl_add_u32 v253, v81, 4, v74
    s_mul_i32 s49, s36, 0x60
    s_mul_i32 s50, s36, 0xc00
    s_add_u32 s50, s50, 0x15e00
    s_mov_b32 s10, 0x36000
    s_mov_b32 s11, 0x20000
    s_add_u32 s57, s49, 0x180
    s_add_u32 m0, s50, 0
    s_lshr_b32 s53, s2, 3
    s_and_b32 s54, s2, 1
    s_lshl_b32 s54, s54, 2
    s_lshr_b32 s55, s53, 3
    s_or_b32 s34, s54, s55
    s_and_b32 s35, s53, 7
    s_bfe_u32 s54, s2, 0x10002
    s_mul_i32 s54, s54, 0x15000
    s_bfe_u32 s55, s2, 0x10001
    s_mul_i32 s55, s55, 0x180
    s_add_u32 s38, s54, s55
    s_lshl_b32 s41, s36, 10
    s_add_u32 s42, s41, 0x1000
    s_min_u32 s42, s42, 0x1a00
    s_mul_i32 s54, s35, 14
    s_sub_u32 s54, s54, 3
    s_movk_i32 s53, 0x6f
    s_lshr_b32 s55, s41, 4
    v_add_u32 v96, s55, v184
    v_mul_u32_u24 v97, 0xaab, v96
    v_lshrrev_b32 v97, 16, v97
    v_mul_u32_u24 v98, 24, v97
    v_sub_u32 v96, v96, v98
    v_and_b32 v98, 2, v97
    v_xor_b32 v96, v96, v98
    v_add_u32 v97, s54, v97
    v_med3_i32 v97, v97, 0, s53
    v_mul_u32_u24 v97, 0x300, v97
    v_lshl_add_u32 v246, v96, 4, v97
    s_lshr_b32 s55, s42, 4
    v_add_u32 v96, s55, v184
    v_mul_u32_u24 v97, 0xaab, v96
    v_lshrrev_b32 v97, 16, v97
    v_mul_u32_u24 v98, 24, v97
    v_sub_u32 v96, v96, v98
    v_and_b32 v98, 2, v97
    v_xor_b32 v96, v96, v98
    v_add_u32 v97, s54, v97
    v_med3_i32 v97, v97, 0, s53
    v_mul_u32_u24 v97, 0x300, v97
    v_lshl_add_u32 v247, v96, 4, v97
    s_mul_i32 s51, s34, 0x24c000
    s_add_u32 s51, s51, s38
    s_sub_u32 s39, s51, 0x7e000
    s_cmp_eq_u32 s34, 0
    s_cselect_b32 s43, 8, 0
    s_cselect_b32 s44, 9, 1
    s_cselect_b32 s45, 3, 2
    s_mul_i32 s43, s43, 0x2a000
    s_add_u32 s43, s43, s39
    s_mul_i32 s44, s44, 0x2a000
    s_add_u32 s44, s44, s39
    s_mul_i32 s45, s45, 0x2a000
    s_add_u32 s45, s45, s39
    s_mov_b32 s6, 0x1260000
    s_mov_b32 s7, 0x20000
    s_mov_b32 s14, 0x12000
    s_mov_b32 s15, 0x20000
    s_mov_b32 s18, 0x548
    s_mov_b32 s19, 0x20000
    s_mov_b32 s22, 0x1260000
    s_mov_b32 s23, 0x20000
    s_add_u32 s56, s39, 0x7e000
    s_waitcnt lgkmcnt(0)
    s_mov_b32 s8, s26
    s_and_b32 s9, s27, 0xffff
    buffer_load_dwordx4 v251, s[8:11], s57 offen lds
    s_add_u32 m0, s50, 0x400
    s_mov_b32 s4, s24
    buffer_load_dwordx4 v252, s[8:11], s57 offen lds
    s_add_u32 m0, s50, 0x800
    s_and_b32 s5, s25, 0xffff
    buffer_load_dwordx4 v253, s[8:11], s57 offen lds
    s_add_u32 s57, s49, 0x9180
    s_add_u32 m0, s50, 0x3000
    s_mov_b32 s12, s28
    buffer_load_dwordx4 v251, s[8:11], s57 offen lds
    s_add_u32 m0, s50, 0x3400
    s_and_b32 s13, s29, 0xffff
    buffer_load_dwordx4 v252, s[8:11], s57 offen lds
    s_add_u32 m0, s50, 0x3800
    s_mov_b32 s16, s30
    s_and_b32 s17, s31, 0xffff
    s_mov_b32 s20, s32
    s_and_b32 s21, s33, 0xffff
    s_mul_i32 s55, s36, 0x152
    v_lshlrev_b32 v199, 1, v184
    v_lshrrev_b32 v185, 4, v184
    v_and_b32 v186, 7, v184
    v_bfe_u32 v187, v184, 3, 1
    v_bfe_u32 v96, v184, 2, 2
    v_and_b32 v97, 3, v184
    v_and_b32 v103, 1, v185
    v_lshl_add_u32 v99, v185, 3, v96
    v_lshl_add_u32 v99, v103, 2, v99
    v_lshl_add_u32 v101, v97, 3, s50
    buffer_load_dwordx4 v253, s[8:11], s57 offen lds
    s_add_u32 m0, s41, 0
    s_add_u32 s57, s49, 0x12180
    s_movk_i32 s27, 0x60
    v_mad_u32_u24 v254, v99, s27, v101
    v_xor_b32 v99, 4, v99
    v_mad_u32_u24 v255, v99, s27, v101
    v_mul_u32_u24 v102, 0x1e40, v187
    v_and_b32 v98, 2, v184
    v_xor_b32 v98, v98, v185
    v_lshlrev_b32 v98, 4, v98
    v_mul_u32_u24 v100, 0x180, v186
    v_add3_u32 v224, v98, v100, v102
    v_mul_u32_u24 v99, 0x1e40, v96
    v_mul_u32_u24 v227, 0x180, v97
    v_add3_u32 v227, v227, v98, v99
    v_mul_u32_u24 v74, 0x180, v76
    v_lshl_add_u32 v192, v77, 4, v74
    v_mul_u32_u24 v74, 0x180, v78
    buffer_load_dwordx4 v246, s[4:7], s43 offen lds
    s_add_u32 m0, s42, 0
    v_lshl_add_u32 v193, v79, 4, v74
    v_mul_u32_u24 v74, 0x180, v80
    v_lshl_add_u32 v194, v81, 4, v74
    v_add_u32 v98, 3, v186
    v_and_b32 v98, 2, v98
    v_xor_b32 v98, v98, v185
    v_lshl_add_u32 v98, v98, 4, v100
    v_add_u32 v225, v98, v102
    v_xor_b32 v99, 1, v187
    v_mul_u32_u24 v99, 0xd3c0, v99
    v_add_u32 v226, v98, v99
    v_lshl_add_u32 v99, v185, 2, v96
    v_and_b32 v98, 2, v185
    v_lshlrev_b32 v98, 1, v98
    v_xor_b32 v99, v99, v98
    v_mad_u32_u24 v99, v99, s27, v101
    s_and_b32 s24, s36, 1
    buffer_load_dwordx4 v247, s[4:7], s43 offen lds
    s_add_u32 m0, s41, 0x1e40
    s_lshl_b32 s25, s24, 5
    s_lshl_b32 s26, s24, 6
    s_sub_u32 s26, 64, s26
    v_add_u32 v241, s26, v99
    v_lshl_add_u32 v99, v97, 3, v99
    v_add_u32 v240, s25, v99
    v_mul_u32_u24 v99, 0x2a000, v187
    v_lshl_add_u32 v99, v100, 1, v99
    v_lshl_add_u32 v99, v185, 3, v99
    v_add_u32 v243, s26, v99
    v_lshl_add_u32 v99, v185, 3, v99
    v_add_u32 v242, s25, v99
    v_cmp_lt_u32 vcc, 5, v186
    v_bfrev_b32 v99, 1
    s_mul_i32 s27, s35, 0x2a00
    v_cndmask_b32 v244, v242, v99, vcc
    v_cndmask_b32 v245, v243, v99, vcc
    s_add_u32 s51, s51, s27
    s_add_u32 s51, s51, s49
    buffer_load_dwordx4 v246, s[4:7], s44 offen lds
    s_add_u32 m0, s42, 0x1e40
    s_add_u32 s58, s51, 0
    s_add_u32 s59, s51, 0x1800
    v_lshlrev_b32 v239, 4, v184
    v_add_u32 v239, 0x12e00, v239
    s_lshr_b32 s25, s36, 1
    s_mul_i32 s25, s25, 0xc00
    s_lshl_b32 s26, s24, 11
    s_add_u32 s26, s26, s25
    v_add_u32 v237, s26, v239
    s_lshl_b32 s26, s24, 3
    s_add_u32 s26, s26, s25
    s_add_u32 s26, s26, 0x400
    v_add_u32 v238, s26, v239
    s_mov_b32 s37, 0x3e553b95
    s_mov_b32 s40, 0x140
    s_cmp_eq_u32 s34, 7
    s_cselect_b32 s46, 16, 17
    s_cselect_b32 s47, 10, 18
    s_cselect_b32 s48, 11, 19
    buffer_load_dwordx4 v247, s[4:7], s44 offen lds
    s_add_u32 m0, s50, 0x6000
    s_mul_i32 s46, s46, 0x2a000
    s_add_u32 s46, s46, s39
    s_mul_i32 s47, s47, 0x2a000
    s_add_u32 s47, s47, s39
    s_mul_i32 s48, s48, 0x2a000
    s_add_u32 s48, s48, s39
    v_mov_b32 v96, 0x3f803f80
    v_accvgpr_write_b32 a216, v96
    v_accvgpr_write_b32 a217, v96
    v_accvgpr_write_b32 a218, v96
    v_accvgpr_write_b32 a219, v96
    s_cmp_eq_u32 s35, 0
    s_cselect_b32 s29, 3, 0
    s_cselect_b32 s30, -3, -2
    s_cmp_eq_u32 s35, 7
    s_cselect_b32 s33, 2, 64
    s_mul_i32 s32, s36, 0xf00
    s_add_u32 s32, s32, 0xf200
    v_lshrrev_b32 v60, 1, v185
    buffer_load_dwordx4 v251, s[8:11], s57 offen lds
    s_add_u32 m0, s50, 0x6400
    v_lshl_add_u32 v61, v187, 1, v60
    v_lshlrev_b32 v232, 2, v61
    v_lshl_add_u32 v61, v187, 2, v185
    v_lshlrev_b32 v233, 2, v61
    v_sub_u32 v60, v60, v187
    v_mul_i32_i24 v60, 0x140, v60
    s_sub_u32 s31, s32, 0x140
    v_add_u32 v60, s31, v60
    v_lshl_add_u32 v61, v103, 2, 3
    v_cmp_gt_u32 vcc, s29, v186
    v_sub_u32 v62, v61, v186
    v_min_u32 v63, 10, v62
    v_mad_u32_u24 v64, v186, 3, v103
    v_add_u32 v65, 11, v64
    v_cndmask_b32 v63, v63, v65, vcc
    v_lshl_add_u32 v228, v63, 4, v60
    v_add_u32 v62, 8, v62
    buffer_load_dwordx4 v252, s[8:11], s57 offen lds
    s_add_u32 m0, s50, 0x6800
    v_min_u32 v63, 10, v62
    v_lshl_add_u32 v62, v103, 4, v186
    v_cmp_gt_u32 vcc, s29, v62
    v_add_u32 v65, 13, v64
    v_min_u32 v62, 5, v186
    v_cndmask_b32 v63, v63, v65, vcc
    v_lshl_add_u32 v229, v63, 4, v60
    v_cmp_lt_u32 vcc, s33, v62
    v_sub_u32 v63, v61, v62
    v_min_u32 v63, 10, v63
    v_mad_u32_u24 v64, v62, 3, 2
    v_add_u32 v65, v64, v103
    v_cndmask_b32 v63, v63, v65, vcc
    v_lshl_add_u32 v230, v63, 4, v60
    v_sub_u32 v63, 11, v62
    v_min_u32 v63, 10, v63
    v_add_u32 v65, 2, v64
    buffer_load_dwordx4 v253, s[8:11], s57 offen lds
    s_add_u32 s57, s49, 0x1b180
    s_add_u32 m0, s50, 0x9000
    v_cndmask_b32 v63, v63, v65, vcc
    v_lshl_add_u32 v231, v63, 4, s32
    s_mov_b32 s60, 0x2222
    s_mov_b32 s61, 0x4444
    s_mov_b32 s62, 0x8808
    s_mov_b32 s63, 0x32104321
    s_mov_b32 s64, 0x76540765
    s_mov_b32 s65, 0x2222
    s_mov_b32 s66, 0x10002100
    s_mov_b32 s67, 0x54326543
    s_mov_b32 s68, 0x760007
    s_mov_b32 s69, 0x32104321
    s_mov_b32 s70, 0x76540765
    s_mov_b32 s71, 0x10002100
    s_mov_b32 s72, 0x760007
    s_mov_b32 s73, 0x2222
    buffer_load_dwordx4 v251, s[8:11], s57 offen lds
    s_add_u32 m0, s50, 0x9400
    s_mov_b32 s74, 0x8808
    s_mov_b32 s75, 0x760007
    s_mov_b32 s76, 0x10002100
    s_mov_b32 s77, 0x6666
    s_mov_b32 s78, 0x8808
    s_mov_b32 s79, 0x32104321
    s_mov_b32 s80, 0x76540765
    s_cmp_eq_u32 s34, 0
    s_cmov_b32 s60, 0xbbbb
    s_cmov_b32 s61, 0x4241
    v_bfe_u32 v234, s60, v232, 4
    v_mad_u32_u24 v235, v234, s40, v228
    v_mad_u32_u24 v234, v234, s40, v229
    v_bfe_u32 v236, s61, v232, 4
    s_cmp_eq_u32 s34, 0
    s_cmov_b32 s62, 0x8898
    s_cmov_b32 s63, 0x30a940ba
    s_cmp_eq_u32 s34, 0
    s_cmov_b32 s64, 0x76549765
    s_cmov_b32 s65, 0x2221
    buffer_load_dwordx4 v252, s[8:11], s57 offen lds
    s_add_u32 m0, s50, 0x9800
    s_cmp_eq_u32 s34, 0
    s_cmov_b32 s66, 0x10002000
    s_cmov_b32 s68, 0x760097
    s_cmp_eq_u32 s34, 7
    s_cmov_b32 s73, 0x2d22
    s_cmov_b32 s74, 0x1808
    s_cmp_eq_u32 s34, 7
    s_cmov_b32 s75, 0x60007
    s_cmov_b32 s76, 0x1b002100
    s_cmp_eq_u32 s34, 7
    s_cmov_b32 s77, 0x1606
    s_cmov_b32 s78, 0xbbbb
    s_waitcnt vmcnt(12)
    ds_read_b64_tr_b16 a[0:1], v254
    ds_read_b64_tr_b16 a[2:3], v255
    ds_read_b64_tr_b16 a[4:5], v254 offset:32
    ds_read_b64_tr_b16 a[6:7], v255 offset:32
    ds_read_b64_tr_b16 a[8:9], v254 offset:64
    ds_read_b64_tr_b16 a[10:11], v255 offset:64
    buffer_load_dwordx4 v253, s[8:11], s57 offen lds
    s_add_u32 s57, s49, 0x24180
    s_add_u32 m0, s50, 0xc000
    s_cmp_eq_u32 s34, 7
    s_cmov_b32 s79, 0x321b4321
    s_cmov_b32 s80, 0xa904ba05
    s_lshl_b32 s31, s36, 10
    s_add_u32 s31, s31, 0x12e40
    v_and_b32 v118, 31, v184
    v_min_u32 v118, 19, v118
    v_lshrrev_b32 v119, 5, v184
    v_add_u32 v120, -11, v118
    v_max_i32 v120, 0, v120
    v_mul_u32_u24 v121, 11, v120
    v_lshrrev_b32 v121, 5, v121
    v_mul_u32_u24 v122, 3, v121
    v_sub_u32 v120, v120, v122
    v_lshlrev_b32 v120, 2, v120
    v_sub_u32 v121, v120, v121
    v_cmp_lt_u32 vcc, 10, v118
    v_add_u32 v121, s29, v121
    buffer_load_dwordx4 v251, s[8:11], s57 offen lds
    s_add_u32 m0, s50, 0xc400
    v_add_u32 v120, s30, v120
    v_add_u32 v122, -3, v118
    v_cndmask_b32 v121, v118, v121, vcc
    v_cndmask_b32 v120, v122, v120, vcc
    v_mad_u32_u24 v121, v119, 13, v121
    v_lshl_add_u32 v121, v121, 2, s31
    s_cmp_eq_u32 s34, 0
    s_cselect_b32 s28, 0x208, 0
    v_add_u32 v122, s28, v121
    v_cmp_gt_u32 s[24:25], 7, v120
    v_add_u32 v120, 1, v120
    v_cmp_gt_u32 s[26:27], 7, v120
    v_add_u32 v120, 1, v120
    v_cmp_gt_u32 s[52:53], 7, v120
    v_add_u32 v120, 1, v120
    v_lshl_add_u32 v118, v118, 4, s32
    v_mad_u32_u24 v123, v119, s40, v118
    buffer_load_dwordx4 v252, s[8:11], s57 offen lds
    s_add_u32 m0, s50, 0xc800
    v_lshlrev_b32 v119, 3, v119
    v_mad_u32_u24 v124, v119, s40, v118
    v_lshl_add_u32 v125, v184, 2, s31
    s_mov_b32 s28, 0x40ddb3d7
    v_mov_b32 v168, 0xf149f2ca
    v_mov_b32 v169, 0xf149f2ca
    v_mov_b32 v170, 0xf149f2ca
    v_mov_b32 v171, 0xf149f2ca
    s_waitcnt vmcnt(12)
    ds_read_b64_tr_b16 a[12:13], v254 offset:12288
    ds_read_b64_tr_b16 a[14:15], v255 offset:12288
    ds_read_b64_tr_b16 a[16:17], v254 offset:12320
    ds_read_b64_tr_b16 a[18:19], v255 offset:12320
    ds_read_b64_tr_b16 a[20:21], v254 offset:12352
    ds_read_b64_tr_b16 a[22:23], v255 offset:12352
    buffer_load_dwordx4 v253, s[8:11], s57 offen lds
    s_add_u32 s57, s49, 0x2d180
    s_add_u32 m0, s50, 0xf000
    s_nop 0
    buffer_load_dwordx4 v251, s[8:11], s57 offen lds
    s_add_u32 m0, s50, 0xf400
    s_nop 0
    buffer_load_dwordx4 v252, s[8:11], s57 offen lds
    s_add_u32 m0, s50, 0xf800
    s_nop 0
    buffer_load_dwordx4 v253, s[8:11], s57 offen lds
    s_add_u32 m0, s41, 0x3c80
    s_add_u32 s57, s49, 0x300
    s_waitcnt vmcnt(12)
    s_barrier
    ds_read_b128 a[232:235], v224
    ds_read_b128 a[236:239], v224 offset:64
    ds_read_b128 a[240:243], v224 offset:128
    ds_read_b128 a[244:247], v224 offset:192
    buffer_load_dwordx4 v246, s[4:7], s45 offen lds
    s_add_u32 m0, s42, 0x3c80
    ds_read_b128 a[248:251], v224 offset:256
    ds_read_b128 a[252:255], v224 offset:320
    ds_read_b128 a[220:223], v224 offset:3072
    ds_read_b128 a[224:227], v224 offset:3136
    ds_read_b128 a[228:231], v224 offset:3200
    buffer_load_dwordx4 v247, s[4:7], s45 offen lds
    s_add_u32 m0, s41, 0x5ac0
    s_nop 0
    s_waitcnt lgkmcnt(8)
    v_mfma_f32_16x16x32_bf16 v[200:203], a[0:3], a[232:235], 0
    v_mfma_f32_16x16x32_bf16 v[204:207], a[4:7], a[232:235], 0
    v_mfma_f32_16x16x32_bf16 v[208:211], a[8:11], a[232:235], 0
    s_waitcnt lgkmcnt(7)
    ds_read_b128 a[232:235], v224 offset:3264
    v_mfma_f32_16x16x32_bf16 v[200:203], a[12:15], a[236:239], v[200:203]
    v_mfma_f32_16x16x32_bf16 v[204:207], a[16:19], a[236:239], v[204:207]
    s_waitcnt lgkmcnt(3)
    buffer_load_dwordx4 v246, s[4:7], s56 offen lds
    v_mfma_f32_16x16x32_bf16 v[208:211], a[20:23], a[236:239], v[208:211]
    s_add_u32 m0, s42, 0x5ac0
    ds_read_b128 a[236:239], v224 offset:3328
    v_mfma_f32_16x16x32_bf16 v[212:215], a[0:3], a[220:223], 0
    v_mfma_f32_16x16x32_bf16 v[216:219], a[4:7], a[220:223], 0
    v_mfma_f32_16x16x32_bf16 v[220:223], a[8:11], a[220:223], 0
    s_waitcnt vmcnt(12) lgkmcnt(3)
    ds_read_b64_tr_b16 a[24:25], v254 offset:24576
    ds_read_b64_tr_b16 a[26:27], v255 offset:24576
    v_mfma_f32_16x16x32_bf16 v[212:215], a[12:15], a[224:227], v[212:215]
    ds_read_b64_tr_b16 a[28:29], v254 offset:24608
    ds_read_b64_tr_b16 a[30:31], v255 offset:24608
    v_mfma_f32_16x16x32_bf16 v[216:219], a[16:19], a[224:227], v[216:219]
    s_waitcnt lgkmcnt(2)
    buffer_load_dwordx4 v247, s[4:7], s56 offen lds
    v_mfma_f32_16x16x32_bf16 v[220:223], a[20:23], a[224:227], v[220:223]
    s_add_u32 s56, s39, 0xa8000
    s_add_u32 m0, s41, 0x7900
    ds_read_b64_tr_b16 a[32:33], v254 offset:24640
    ds_read_b64_tr_b16 a[34:35], v255 offset:24640
    buffer_load_ushort v196, v199, s[16:19], s55 offen
    v_mfma_f32_16x16x32_bf16 v[200:203], a[24:27], a[240:243], v[200:203]
    s_waitcnt lgkmcnt(2)
    buffer_load_ushort v197, v199, s[16:19], s55 offen offset:128
    v_mfma_f32_16x16x32_bf16 v[204:207], a[28:31], a[240:243], v[204:207]
    buffer_load_ushort v198, v199, s[16:19], s55 offen offset:256
    v_mfma_f32_16x16x32_bf16 v[212:215], a[24:27], a[228:231], v[212:215]
    v_cmp_gt_u32 s[54:55], 7, v120
    v_mfma_f32_16x16x32_bf16 v[216:219], a[28:31], a[228:231], v[216:219]
    s_waitcnt lgkmcnt(0)
    v_mfma_f32_16x16x32_bf16 v[208:211], a[32:35], a[240:243], v[208:211]
    ds_read_b128 a[240:243], v224 offset:3392
    v_mfma_f32_16x16x32_bf16 v[220:223], a[32:35], a[228:231], v[220:223]
    s_waitcnt vmcnt(13)
    buffer_load_dwordx4 v246, s[4:7], s56 offen lds
    s_add_u32 m0, s42, 0x7900
    s_nop 0
    ds_read_b64_tr_b16 a[36:37], v254 offset:36864
    ds_read_b64_tr_b16 a[38:39], v255 offset:36864
    ds_read_b64_tr_b16 a[40:41], v254 offset:36896
    ds_read_b64_tr_b16 a[42:43], v255 offset:36896
    ds_read_b64_tr_b16 a[44:45], v254 offset:36928
    ds_read_b64_tr_b16 a[46:47], v255 offset:36928
    buffer_load_dwordx4 v247, s[4:7], s56 offen lds
    s_add_u32 s56, s39, 0xd2000
    s_add_u32 m0, s41, 0x9740
    s_nop 0
    s_waitcnt lgkmcnt(4)
    v_mfma_f32_16x16x32_bf16 v[200:203], a[36:39], a[244:247], v[200:203]
    s_waitcnt lgkmcnt(2)
    v_mfma_f32_16x16x32_bf16 v[204:207], a[40:43], a[244:247], v[204:207]
    s_waitcnt lgkmcnt(0)
    v_mfma_f32_16x16x32_bf16 v[208:211], a[44:47], a[244:247], v[208:211]
    buffer_load_dwordx4 v246, s[4:7], s56 offen lds
    v_mfma_f32_16x16x32_bf16 v[212:215], a[36:39], a[232:235], v[212:215]
    s_add_u32 m0, s42, 0x9740
    v_mfma_f32_16x16x32_bf16 v[216:219], a[40:43], a[232:235], v[216:219]
    v_mfma_f32_16x16x32_bf16 v[220:223], a[44:47], a[232:235], v[220:223]
    s_waitcnt vmcnt(13)
    buffer_load_dwordx4 v247, s[4:7], s56 offen lds
    s_add_u32 s56, s39, 0xfc000
    s_add_u32 m0, s41, 0xb580
    ds_read_b64_tr_b16 a[48:49], v254 offset:49152
    ds_read_b64_tr_b16 a[50:51], v255 offset:49152
    ds_read_b64_tr_b16 a[52:53], v254 offset:49184
    ds_read_b64_tr_b16 a[54:55], v255 offset:49184
    ds_read_b64_tr_b16 a[56:57], v254 offset:49216
    ds_read_b64_tr_b16 a[58:59], v255 offset:49216
    buffer_load_dwordx4 v246, s[4:7], s56 offen lds
    s_add_u32 m0, s42, 0xb580
    s_nop 0
    s_waitcnt lgkmcnt(4)
    v_mfma_f32_16x16x32_bf16 v[200:203], a[48:51], a[248:251], v[200:203]
    s_waitcnt lgkmcnt(2)
    v_mfma_f32_16x16x32_bf16 v[204:207], a[52:55], a[248:251], v[204:207]
    s_waitcnt lgkmcnt(0)
    v_mfma_f32_16x16x32_bf16 v[208:211], a[56:59], a[248:251], v[208:211]
    buffer_load_dwordx4 v247, s[4:7], s56 offen lds
    v_mfma_f32_16x16x32_bf16 v[212:215], a[48:51], a[236:239], v[212:215]
    s_add_u32 s56, s39, 0x126000
    s_add_u32 m0, s41, 0xd3c0
    v_mfma_f32_16x16x32_bf16 v[216:219], a[52:55], a[236:239], v[216:219]
    v_mfma_f32_16x16x32_bf16 v[220:223], a[56:59], a[236:239], v[220:223]
    s_waitcnt vmcnt(13)
    buffer_load_dwordx4 v246, s[4:7], s56 offen lds
    s_add_u32 m0, s42, 0xd3c0
    s_nop 0
    ds_read_b64_tr_b16 a[60:61], v254 offset:61440
    ds_read_b64_tr_b16 a[62:63], v255 offset:61440
    ds_read_b64_tr_b16 a[64:65], v254 offset:61472
    ds_read_b64_tr_b16 a[66:67], v255 offset:61472
    ds_read_b64_tr_b16 a[68:69], v254 offset:61504
    ds_read_b64_tr_b16 a[70:71], v255 offset:61504
    buffer_load_dwordx4 v247, s[4:7], s56 offen lds
    s_add_u32 m0, s50, 0
    s_add_u32 s56, s39, 0x150000
    s_waitcnt lgkmcnt(4)
    v_mfma_f32_16x16x32_bf16 v[200:203], a[60:63], a[252:255], v[200:203]
    s_waitcnt lgkmcnt(2)
    v_mfma_f32_16x16x32_bf16 v[204:207], a[64:67], a[252:255], v[204:207]
    s_waitcnt lgkmcnt(0)
    v_mfma_f32_16x16x32_bf16 v[208:211], a[68:71], a[252:255], v[208:211]
    buffer_load_dwordx4 v251, s[8:11], s57 offen lds
    v_mfma_f32_16x16x32_bf16 v[212:215], a[60:63], a[240:243], v[212:215]
    s_add_u32 m0, s50, 0x400
    v_mfma_f32_16x16x32_bf16 v[216:219], a[64:67], a[240:243], v[216:219]
    s_waitcnt vmcnt(9)
    v_mfma_f32_16x16x32_bf16 v[220:223], a[68:71], a[240:243], v[220:223]
    s_nop 0
    v_cvt_pk_bf16_f32 v0, v200, v201
    v_cvt_pk_bf16_f32 v1, v202, v203
    v_cvt_pk_bf16_f32 v2, v204, v205
    v_cvt_pk_bf16_f32 v3, v206, v207
    v_cvt_pk_bf16_f32 v4, v208, v209
    buffer_load_dwordx4 v252, s[8:11], s57 offen lds
    s_add_u32 m0, s50, 0x800
    v_cvt_pk_bf16_f32 v5, v210, v211
    v_cvt_pk_bf16_f32 v24, v212, v213
    v_cvt_pk_bf16_f32 v25, v214, v215
    v_cvt_pk_bf16_f32 v26, v216, v217
    v_cvt_pk_bf16_f32 v27, v218, v219
    v_cvt_pk_bf16_f32 v28, v220, v221
    v_cvt_pk_bf16_f32 v29, v222, v223
    buffer_load_dwordx4 v253, s[8:11], s57 offen lds
    s_add_u32 s57, s49, 0x9300
    s_add_u32 m0, s50, 0x3000
    s_barrier
    buffer_load_dwordx4 v251, s[8:11], s57 offen lds
    s_add_u32 m0, s50, 0x3400
    ds_read_b128 a[244:247], v224 offset:15488
    ds_read_b128 a[248:251], v224 offset:15552
    ds_read_b128 a[252:255], v224 offset:15616
    v_lshlrev_b32 v196, 16, v196
    ds_read_b128 a[220:223], v224 offset:15680
    v_mul_f32 v196, s28, v196
    ds_read_b128 a[224:227], v224 offset:15744
    v_lshlrev_b32 v197, 16, v197
    ds_read_b128 a[228:231], v224 offset:15808
    buffer_load_dwordx4 v252, s[8:11], s57 offen lds
    s_add_u32 m0, s50, 0x3800
    ds_read_b128 a[232:235], v224 offset:18560
    v_mul_f32 v197, s28, v197
    ds_read_b128 a[236:239], v224 offset:18624
    v_lshlrev_b32 v198, 16, v198
    ds_read_b128 a[240:243], v224 offset:18688
    v_mul_f32 v198, s28, v198
    ds_write_b32 v125, v196
    s_waitcnt lgkmcnt(9)
    v_mfma_f32_16x16x32_bf16 v[200:203], a[0:3], a[244:247], 0
    ds_write_b32 v125, v197 offset:256
    v_mfma_f32_16x16x32_bf16 v[204:207], a[4:7], a[244:247], 0
    s_waitcnt lgkmcnt(9)
    buffer_load_dwordx4 v253, s[8:11], s57 offen lds
    v_mfma_f32_16x16x32_bf16 v[208:211], a[8:11], a[244:247], 0
    s_add_u32 s57, s49, 0x12300
    ds_read_b128 a[244:247], v224 offset:18752
    s_add_u32 m0, s50, 0x6000
    v_mfma_f32_16x16x32_bf16 v[200:203], a[12:15], a[248:251], v[200:203]
    ds_write_b32 v125, v198 offset:512
    v_mfma_f32_16x16x32_bf16 v[204:207], a[16:19], a[248:251], v[204:207]
    ds_read2_b32 v[144:145], v121 offset0:39 offset1:40
    ds_read2_b32 v[146:147], v121 offset0:41 offset1:42
    v_mfma_f32_16x16x32_bf16 v[208:211], a[20:23], a[248:251], v[208:211]
    s_waitcnt lgkmcnt(10)
    ds_read_b128 a[248:251], v224 offset:18816
    ds_read2_b32 v[148:149], v121 offset0:65 offset1:66
    v_mfma_f32_16x16x32_bf16 v[200:203], a[24:27], a[252:255], v[200:203]
    ds_read2_b32 v[150:151], v121 offset0:67 offset1:68
    ds_read2_b32 v[152:153], v121 offset0:91 offset1:92
    v_mfma_f32_16x16x32_bf16 v[204:207], a[28:31], a[252:255], v[204:207]
    buffer_load_dwordx4 v251, s[8:11], s57 offen lds
    v_mfma_f32_16x16x32_bf16 v[208:211], a[32:35], a[252:255], v[208:211]
    s_add_u32 m0, s50, 0x6400
    ds_read_b128 a[252:255], v224 offset:18880
    ds_read2_b32 v[154:155], v121 offset0:93 offset1:94
    v_mfma_f32_16x16x32_bf16 v[200:203], a[36:39], a[220:223], v[200:203]
    ds_read2_b32 v[156:157], v121 offset0:117 offset1:118
    ds_read2_b32 v[158:159], v121 offset0:119 offset1:120
    v_mfma_f32_16x16x32_bf16 v[204:207], a[40:43], a[220:223], v[204:207]
    ds_read2_b32 v[160:161], v122 offset0:0 offset1:1
    ds_read2_b32 v[162:163], v122 offset0:2 offset1:3
    v_mfma_f32_16x16x32_bf16 v[208:211], a[44:47], a[220:223], v[208:211]
    ds_read_b128 a[220:223], v227 offset:6144
    ds_read2_b32 v[164:165], v122 offset0:13 offset1:14
    v_mfma_f32_16x16x32_bf16 v[200:203], a[48:51], a[224:227], v[200:203]
    s_waitcnt lgkmcnt(13)
    buffer_load_dwordx4 v252, s[8:11], s57 offen lds
    v_mfma_f32_16x16x32_bf16 v[204:207], a[52:55], a[224:227], v[204:207]
    s_add_u32 m0, s50, 0x6800
    ds_read2_b32 v[166:167], v122 offset0:15 offset1:16
    v_cndmask_b32 v144, v168, v144, s[24:25]
    v_mfma_f32_16x16x32_bf16 v[208:211], a[56:59], a[224:227], v[208:211]
    ds_read_b128 a[224:227], v227 offset:6208
    v_cndmask_b32 v145, v168, v145, s[26:27]
    v_mfma_f32_16x16x32_bf16 v[200:203], a[60:63], a[228:231], v[200:203]
    s_waitcnt vmcnt(12) lgkmcnt(12)
    v_cndmask_b32 v146, v168, v146, s[52:53]
    v_cndmask_b32 v147, v168, v147, s[54:55]
    v_mfma_f32_16x16x32_bf16 v[204:207], a[64:67], a[228:231], v[204:207]
    s_barrier
    ds_write_b128 v123, v[144:147] offset:320
    v_mfma_f32_16x16x32_bf16 v[208:211], a[68:71], a[228:231], v[208:211]
    buffer_load_dwordx4 v253, s[8:11], s57 offen lds
    v_mfma_f32_16x16x32_bf16 v[212:215], a[0:3], a[232:235], 0
    s_add_u32 s57, s49, 0x1b300
    v_cvt_pk_bf16_f32 v6, v200, v201
    v_cvt_pk_bf16_f32 v7, v202, v203
    v_mfma_f32_16x16x32_bf16 v[216:219], a[4:7], a[232:235], 0
    s_add_u32 m0, s50, 0x9000
    v_cvt_pk_bf16_f32 v8, v204, v205
    v_cvt_pk_bf16_f32 v9, v206, v207
    v_mfma_f32_16x16x32_bf16 v[220:223], a[8:11], a[232:235], 0
    v_cvt_pk_bf16_f32 v10, v208, v209
    v_cvt_pk_bf16_f32 v11, v210, v211
    v_mfma_f32_16x16x32_bf16 v[212:215], a[12:15], a[236:239], v[212:215]
    ds_read_b128 a[228:231], v227 offset:6272
    ds_read_b128 a[232:235], v227 offset:6336
    v_mfma_f32_16x16x32_bf16 v[216:219], a[16:19], a[236:239], v[216:219]
    buffer_load_dwordx4 v251, s[8:11], s57 offen lds
    v_mfma_f32_16x16x32_bf16 v[220:223], a[20:23], a[236:239], v[220:223]
    s_add_u32 m0, s50, 0x9400
    ds_read_b128 a[236:239], v227 offset:6400
    v_cndmask_b32 v148, v168, v148, s[24:25]
    v_mfma_f32_16x16x32_bf16 v[212:215], a[24:27], a[240:243], v[212:215]
    s_waitcnt lgkmcnt(4)
    v_cndmask_b32 v149, v168, v149, s[26:27]
    v_cndmask_b32 v150, v168, v150, s[52:53]
    v_mfma_f32_16x16x32_bf16 v[216:219], a[28:31], a[240:243], v[216:219]
    v_cndmask_b32 v151, v168, v151, s[54:55]
    v_cndmask_b32 v152, v168, v152, s[24:25]
    v_mfma_f32_16x16x32_bf16 v[220:223], a[32:35], a[240:243], v[220:223]
    ds_read_b128 a[240:243], v227 offset:6464
    v_cndmask_b32 v153, v168, v153, s[26:27]
    v_mfma_f32_16x16x32_bf16 v[212:215], a[36:39], a[244:247], v[212:215]
    ds_write_b128 v123, v[148:151] offset:960
    v_mfma_f32_16x16x32_bf16 v[216:219], a[40:43], a[244:247], v[216:219]
    buffer_load_dwordx4 v252, s[8:11], s57 offen lds
    v_mfma_f32_16x16x32_bf16 v[220:223], a[44:47], a[244:247], v[220:223]
    s_add_u32 m0, s50, 0x9800
    ds_read_b128 a[244:247], v224 offset:30976
    v_cndmask_b32 v154, v168, v154, s[52:53]
    v_mfma_f32_16x16x32_bf16 v[212:215], a[48:51], a[248:251], v[212:215]
    v_cndmask_b32 v155, v168, v155, s[54:55]
    v_cndmask_b32 v156, v168, v156, s[24:25]
    v_mfma_f32_16x16x32_bf16 v[216:219], a[52:55], a[248:251], v[216:219]
    ds_write_b128 v123, v[152:155] offset:1600
    v_mfma_f32_16x16x32_bf16 v[220:223], a[56:59], a[248:251], v[220:223]
    buffer_load_dwordx4 v253, s[8:11], s57 offen lds
    v_mfma_f32_16x16x32_bf16 v[212:215], a[60:63], a[252:255], v[212:215]
    s_add_u32 s57, s49, 0x24300
    ds_read_b128 a[248:251], v224 offset:31040
    v_cndmask_b32 v157, v168, v157, s[26:27]
    v_mfma_f32_16x16x32_bf16 v[216:219], a[64:67], a[252:255], v[216:219]
    s_add_u32 m0, s50, 0xc000
    v_cndmask_b32 v158, v168, v158, s[52:53]
    v_cndmask_b32 v159, v168, v159, s[54:55]
    v_mfma_f32_16x16x32_bf16 v[220:223], a[68:71], a[252:255], v[220:223]
    s_waitcnt vmcnt(12)
    v_cvt_pk_bf16_f32 v30, v212, v213
    v_cvt_pk_bf16_f32 v31, v214, v215
    v_mfma_f32_16x16x32_bf16 v[200:203], a[0:3], a[220:223], 0
    s_barrier
    v_cvt_pk_bf16_f32 v32, v216, v217
    v_cvt_pk_bf16_f32 v33, v218, v219
    v_mfma_f32_16x16x32_bf16 v[204:207], a[4:7], a[220:223], 0
    buffer_load_dwordx4 v251, s[8:11], s57 offen lds
    v_mfma_f32_16x16x32_bf16 v[208:211], a[8:11], a[220:223], 0
    s_add_u32 m0, s50, 0xc400
    v_cvt_pk_bf16_f32 v34, v220, v221
    v_cvt_pk_bf16_f32 v35, v222, v223
    v_mfma_f32_16x16x32_bf16 v[200:203], a[12:15], a[224:227], v[200:203]
    ds_read_b128 a[252:255], v224 offset:31104
    ds_read_b128 a[220:223], v224 offset:31168
    v_mfma_f32_16x16x32_bf16 v[204:207], a[16:19], a[224:227], v[204:207]
    ds_write_b128 v123, v[156:159] offset:2240
    v_mfma_f32_16x16x32_bf16 v[208:211], a[20:23], a[224:227], v[208:211]
    s_waitcnt lgkmcnt(4)
    ds_read_b128 a[224:227], v224 offset:31232
    v_cndmask_b32 v160, v168, v160, s[24:25]
    v_mfma_f32_16x16x32_bf16 v[200:203], a[24:27], a[228:231], v[200:203]
    buffer_load_dwordx4 v252, s[8:11], s57 offen lds
    v_mfma_f32_16x16x32_bf16 v[204:207], a[28:31], a[228:231], v[204:207]
    s_add_u32 m0, s50, 0xc800
    v_cndmask_b32 v161, v168, v161, s[26:27]
    v_cndmask_b32 v162, v168, v162, s[52:53]
    v_mfma_f32_16x16x32_bf16 v[208:211], a[32:35], a[228:231], v[208:211]
    ds_read_b128 a[228:231], v224 offset:31296
    v_cndmask_b32 v163, v168, v163, s[54:55]
    v_mfma_f32_16x16x32_bf16 v[200:203], a[36:39], a[232:235], v[200:203]
    ds_write_b128 v123, v[160:163] offset:2880
    v_mfma_f32_16x16x32_bf16 v[204:207], a[40:43], a[232:235], v[204:207]
    v_cndmask_b32 v164, v168, v164, s[24:25]
    v_cndmask_b32 v165, v168, v165, s[26:27]
    v_mfma_f32_16x16x32_bf16 v[208:211], a[44:47], a[232:235], v[208:211]
    buffer_load_dwordx4 v253, s[8:11], s57 offen lds
    v_mfma_f32_16x16x32_bf16 v[200:203], a[48:51], a[236:239], v[200:203]
    s_add_u32 s57, s49, 0x2d300
    ds_read_b128 a[232:235], v224 offset:34048
    v_cndmask_b32 v166, v168, v166, s[52:53]
    v_mfma_f32_16x16x32_bf16 v[204:207], a[52:55], a[236:239], v[204:207]
    s_add_u32 m0, s50, 0xf000
    v_cndmask_b32 v167, v168, v167, s[54:55]
    v_mfma_f32_16x16x32_bf16 v[208:211], a[56:59], a[236:239], v[208:211]
    s_waitcnt vmcnt(12)
    ds_read_b128 a[236:239], v224 offset:34112
    ds_read_b64_tr_b16 a[72:73], v254
    v_mfma_f32_16x16x32_bf16 v[200:203], a[60:63], a[240:243], v[200:203]
    ds_read_b64_tr_b16 a[74:75], v255
    ds_read_b64_tr_b16 a[76:77], v254 offset:32
    v_mfma_f32_16x16x32_bf16 v[204:207], a[64:67], a[240:243], v[204:207]
    buffer_load_dwordx4 v251, s[8:11], s57 offen lds
    v_mfma_f32_16x16x32_bf16 v[208:211], a[68:71], a[240:243], v[208:211]
    s_add_u32 m0, s50, 0xf400
    ds_read_b128 a[240:243], v224 offset:34176
    ds_read_b64_tr_b16 a[78:79], v255 offset:32
    v_mfma_f32_16x16x32_bf16 v[212:215], a[0:3], a[244:247], 0
    v_cvt_pk_bf16_f32 v48, v200, v201
    v_cvt_pk_bf16_f32 v49, v202, v203
    v_mfma_f32_16x16x32_bf16 v[216:219], a[4:7], a[244:247], 0
    v_cvt_pk_bf16_f32 v50, v204, v205
    v_cvt_pk_bf16_f32 v51, v206, v207
    v_mfma_f32_16x16x32_bf16 v[220:223], a[8:11], a[244:247], 0
    s_waitcnt lgkmcnt(7)
    v_cvt_pk_bf16_f32 v52, v208, v209
    v_cvt_pk_bf16_f32 v53, v210, v211
    v_mfma_f32_16x16x32_bf16 v[212:215], a[12:15], a[248:251], v[212:215]
    ds_read_b128 a[244:247], v224 offset:34240
    ds_read_b64_tr_b16 a[80:81], v254 offset:64
    v_mfma_f32_16x16x32_bf16 v[216:219], a[16:19], a[248:251], v[216:219]
    buffer_load_dwordx4 v252, s[8:11], s57 offen lds
    v_mfma_f32_16x16x32_bf16 v[220:223], a[20:23], a[248:251], v[220:223]
    s_add_u32 m0, s50, 0xf800
    ds_read_b128 a[248:251], v224 offset:34304
    ds_read_b64_tr_b16 a[82:83], v255 offset:64
    v_mfma_f32_16x16x32_bf16 v[212:215], a[24:27], a[252:255], v[212:215]
    ds_write_b128 v123, v[164:167] offset:3200
    v_mfma_f32_16x16x32_bf16 v[216:219], a[28:31], a[252:255], v[216:219]
    ds_write_b128 v124, v[168:171]
    v_mfma_f32_16x16x32_bf16 v[220:223], a[32:35], a[252:255], v[220:223]
    buffer_load_dwordx4 v253, s[8:11], s57 offen lds
    v_mfma_f32_16x16x32_bf16 v[212:215], a[36:39], a[220:223], v[212:215]
    s_add_u32 s57, s49, 0
    ds_read_b128 a[252:255], v224 offset:34368
    ds_read_b128 v[144:147], v235
    v_mfma_f32_16x16x32_bf16 v[216:219], a[40:43], a[220:223], v[216:219]
    s_add_u32 m0, s50, 0
    ds_read_b128 v[148:151], v234
    v_mad_u32_u24 v234, v236, s40, v229
    v_mfma_f32_16x16x32_bf16 v[220:223], a[44:47], a[220:223], v[220:223]
    v_mad_u32_u24 v236, v236, s40, v228
    v_bfe_u32 v235, s62, v232, 4
    v_mfma_f32_16x16x32_bf16 v[212:215], a[48:51], a[224:227], v[212:215]
    s_waitcnt vmcnt(12)
    ds_read_b64_tr_b16 a[84:85], v254 offset:12288
    v_mfma_f32_16x16x32_bf16 v[216:219], a[52:55], a[224:227], v[216:219]
    s_waitcnt lgkmcnt(6)
    buffer_load_dwordx4 v251, s[8:11], s57 offen lds
    v_mfma_f32_16x16x32_bf16 v[220:223], a[56:59], a[224:227], v[220:223]
    s_add_u32 m0, s50, 0x400
    ds_read_b64_tr_b16 a[86:87], v255 offset:12288
    ds_read_b64_tr_b16 a[88:89], v254 offset:12320
    v_mfma_f32_16x16x32_bf16 v[212:215], a[60:63], a[228:231], v[212:215]
    ds_read_b64_tr_b16 a[90:91], v255 offset:12320
    ds_read_b64_tr_b16 a[92:93], v254 offset:12352
    v_mfma_f32_16x16x32_bf16 v[216:219], a[64:67], a[228:231], v[216:219]
    ds_read_b64_tr_b16 a[94:95], v255 offset:12352
    ds_read_b128 a[220:223], v224 offset:46464
    v_mfma_f32_16x16x32_bf16 v[220:223], a[68:71], a[228:231], v[220:223]
    ds_read_b128 a[224:227], v224 offset:46528
    ds_read_b128 a[228:231], v224 offset:46592
    v_mfma_f32_16x16x32_bf16 v[200:203], a[0:3], a[232:235], 0
    v_cvt_pk_bf16_f32 v12, v212, v213
    v_cvt_pk_bf16_f32 v13, v214, v215
    v_mfma_f32_16x16x32_bf16 v[204:207], a[4:7], a[232:235], 0
    v_cvt_pk_bf16_f32 v14, v216, v217
    v_cvt_pk_bf16_f32 v15, v218, v219
    v_mfma_f32_16x16x32_bf16 v[208:211], a[8:11], a[232:235], 0
    v_cvt_pk_bf16_f32 v16, v220, v221
    v_cvt_pk_bf16_f32 v17, v222, v223
    v_mfma_f32_16x16x32_bf16 v[200:203], a[12:15], a[236:239], v[200:203]
    buffer_load_dwordx4 v252, s[8:11], s57 offen lds
    v_mfma_f32_16x16x32_bf16 v[204:207], a[16:19], a[236:239], v[204:207]
    s_add_u32 m0, s50, 0x800
    ds_read_b128 a[232:235], v224 offset:46656
    ds_read_b128 v[152:155], v234
    v_mfma_f32_16x16x32_bf16 v[208:211], a[20:23], a[236:239], v[208:211]
    ds_read_b128 a[236:239], v224 offset:46720
    v_bfe_u32 v234, s60, v232, 4
    v_mfma_f32_16x16x32_bf16 v[200:203], a[24:27], a[240:243], v[200:203]
    buffer_load_dwordx4 v253, s[8:11], s57 offen lds
    v_mfma_f32_16x16x32_bf16 v[204:207], a[28:31], a[240:243], v[204:207]
    s_add_u32 s57, s49, 0x9000
    ds_read_b128 v[156:159], v236
    v_mad_u32_u24 v236, v235, s40, v229
    v_mfma_f32_16x16x32_bf16 v[208:211], a[32:35], a[240:243], v[208:211]
    s_add_u32 m0, s50, 0x3000
    ds_read_b128 a[240:243], v224 offset:46784
    v_mad_u32_u24 v235, v235, s40, v228
    v_mfma_f32_16x16x32_bf16 v[200:203], a[36:39], a[244:247], v[200:203]
    ds_read_b128 v[160:163], v228 offset:1920
    v_mad_u32_u24 v234, v234, s40, v230
    v_mfma_f32_16x16x32_bf16 v[204:207], a[40:43], a[244:247], v[204:207]
    v_mfma_f32_16x16x32_bf16 v[208:211], a[44:47], a[244:247], v[208:211]
    s_waitcnt vmcnt(12)
    ds_read_b64_tr_b16 a[96:97], v254 offset:24576
    v_mfma_f32_16x16x32_bf16 v[200:203], a[48:51], a[248:251], v[200:203]
    s_waitcnt lgkmcnt(7)
    buffer_load_dwordx4 v251, s[8:11], s57 offen lds
    v_mfma_f32_16x16x32_bf16 v[204:207], a[52:55], a[248:251], v[204:207]
    s_add_u32 m0, s50, 0x3400
    ds_read_b64_tr_b16 a[98:99], v255 offset:24576
    ds_read_b64_tr_b16 a[100:101], v254 offset:24608
    v_mfma_f32_16x16x32_bf16 v[208:211], a[56:59], a[248:251], v[208:211]
    ds_read_b64_tr_b16 a[102:103], v255 offset:24608
    ds_read_b64_tr_b16 a[104:105], v254 offset:24640
    v_mfma_f32_16x16x32_bf16 v[200:203], a[60:63], a[252:255], v[200:203]
    ds_read_b64_tr_b16 a[106:107], v255 offset:24640
    ds_read_b128 a[244:247], v224 offset:49536
    v_mfma_f32_16x16x32_bf16 v[204:207], a[64:67], a[252:255], v[204:207]
    ds_read_b128 a[248:251], v224 offset:49600
    ds_read_b128 v[164:167], v229 offset:1920
    v_mfma_f32_16x16x32_bf16 v[208:211], a[68:71], a[252:255], v[208:211]
    buffer_load_dwordx4 v252, s[8:11], s57 offen lds
    v_mfma_f32_16x16x32_bf16 v[212:215], a[0:3], a[220:223], 0
    s_add_u32 m0, s50, 0x3800
    v_cvt_pk_bf16_f32 v36, v200, v201
    v_cvt_pk_bf16_f32 v37, v202, v203
    v_mfma_f32_16x16x32_bf16 v[216:219], a[4:7], a[220:223], 0
    v_cvt_pk_bf16_f32 v38, v204, v205
    v_cvt_pk_bf16_f32 v39, v206, v207
    v_mfma_f32_16x16x32_bf16 v[220:223], a[8:11], a[220:223], 0
    v_cvt_pk_bf16_f32 v40, v208, v209
    v_cvt_pk_bf16_f32 v41, v210, v211
    v_mfma_f32_16x16x32_bf16 v[212:215], a[12:15], a[224:227], v[212:215]
    ds_read_b128 a[252:255], v224 offset:49664
    ds_read_b128 a[220:223], v224 offset:49728
    v_mfma_f32_16x16x32_bf16 v[216:219], a[16:19], a[224:227], v[216:219]
    ds_read_b128 v[168:171], v236
    v_bfe_u32 v236, s62, v232, 4
    v_mfma_f32_16x16x32_bf16 v[220:223], a[20:23], a[224:227], v[220:223]
    buffer_load_dwordx4 v253, s[8:11], s57 offen lds
    v_mfma_f32_16x16x32_bf16 v[212:215], a[24:27], a[228:231], v[212:215]
    s_add_u32 s57, s49, 0x12000
    ds_read_b128 a[224:227], v224 offset:49792
    ds_read_b128 v[172:175], v235
    v_mfma_f32_16x16x32_bf16 v[216:219], a[28:31], a[228:231], v[216:219]
    s_add_u32 m0, s50, 0x6000
    v_bfe_u32 v235, s61, v232, 4
    v_mad_u32_u24 v235, v235, s40, v230
    v_mfma_f32_16x16x32_bf16 v[220:223], a[32:35], a[228:231], v[220:223]
    s_waitcnt lgkmcnt(7)
    ds_read_b128 a[228:231], v224 offset:49856
    v_mad_u32_u24 v236, v236, s40, v230
    v_mfma_f32_16x16x32_bf16 v[212:215], a[36:39], a[232:235], v[212:215]
    s_waitcnt vmcnt(12)
    ds_read_b64_tr_b16 a[108:109], v254 offset:36864
    v_mfma_f32_16x16x32_bf16 v[216:219], a[40:43], a[232:235], v[216:219]
    buffer_load_dwordx4 v251, s[8:11], s57 offen lds
    v_mfma_f32_16x16x32_bf16 v[220:223], a[44:47], a[232:235], v[220:223]
    s_add_u32 m0, s50, 0x6400
    ds_read_b64_tr_b16 a[110:111], v255 offset:36864
    ds_read_b64_tr_b16 a[112:113], v254 offset:36896
    v_mfma_f32_16x16x32_bf16 v[212:215], a[48:51], a[236:239], v[212:215]
    ds_read_b64_tr_b16 a[114:115], v255 offset:36896
    ds_read_b64_tr_b16 a[116:117], v254 offset:36928
    v_mfma_f32_16x16x32_bf16 v[216:219], a[52:55], a[236:239], v[216:219]
    ds_read_b64_tr_b16 a[118:119], v255 offset:36928
    ds_read_b128 a[232:235], v227 offset:37120
    v_mfma_f32_16x16x32_bf16 v[220:223], a[56:59], a[236:239], v[220:223]
    ds_read_b128 a[236:239], v227 offset:37184
    v_mfma_f32_16x16x32_bf16 v[212:215], a[60:63], a[240:243], v[212:215]
    v_mfma_f32_16x16x32_bf16 v[216:219], a[64:67], a[240:243], v[216:219]
    buffer_load_dwordx4 v252, s[8:11], s57 offen lds
    v_mfma_f32_16x16x32_bf16 v[220:223], a[68:71], a[240:243], v[220:223]
    s_add_u32 m0, s50, 0x6800
    ds_read_b128 a[240:243], v227 offset:37248
    v_mfma_f32_16x16x32_bf16 v[200:203], a[0:3], a[244:247], 0
    v_mfma_f32_16x16x32_bf16 v[204:207], a[4:7], a[244:247], 0
    v_mfma_f32_16x16x32_bf16 v[208:211], a[8:11], a[244:247], 0
    s_waitcnt lgkmcnt(8)
    v_cvt_pk_bf16_f32 v18, v212, v213
    v_cvt_pk_bf16_f32 v19, v214, v215
    v_mfma_f32_16x16x32_bf16 v[200:203], a[12:15], a[248:251], v[200:203]
    buffer_load_dwordx4 v253, s[8:11], s57 offen lds
    v_mfma_f32_16x16x32_bf16 v[204:207], a[16:19], a[248:251], v[204:207]
    s_add_u32 s57, s49, 0x1b000
    v_cvt_pk_bf16_f32 v20, v216, v217
    v_cvt_pk_bf16_f32 v21, v218, v219
    v_mfma_f32_16x16x32_bf16 v[208:211], a[20:23], a[248:251], v[208:211]
    s_add_u32 m0, s50, 0x9000
    v_cvt_pk_bf16_f32 v22, v220, v221
    v_cvt_pk_bf16_f32 v23, v222, v223
    v_mfma_f32_16x16x32_bf16 v[200:203], a[24:27], a[252:255], v[200:203]
    ds_read_b128 a[244:247], v227 offset:37312
    ds_read_b128 a[248:251], v227 offset:37376
    v_mfma_f32_16x16x32_bf16 v[204:207], a[28:31], a[252:255], v[204:207]
    s_waitcnt vmcnt(12)
    ds_read_b64_tr_b16 a[120:121], v254 offset:49152
    ds_read_b64_tr_b16 a[122:123], v255 offset:49152
    v_mfma_f32_16x16x32_bf16 v[208:211], a[32:35], a[252:255], v[208:211]
    ds_read_b64_tr_b16 a[124:125], v254 offset:49184
    ds_read_b64_tr_b16 a[126:127], v255 offset:49184
    v_mfma_f32_16x16x32_bf16 v[200:203], a[36:39], a[220:223], v[200:203]
    s_waitcnt lgkmcnt(6)
    buffer_load_dwordx4 v251, s[8:11], s57 offen lds
    v_mfma_f32_16x16x32_bf16 v[204:207], a[40:43], a[220:223], v[204:207]
    s_add_u32 m0, s50, 0x9400
    ds_read_b64_tr_b16 a[128:129], v254 offset:49216
    ds_read_b64_tr_b16 a[130:131], v255 offset:49216
    v_mfma_f32_16x16x32_bf16 v[208:211], a[44:47], a[220:223], v[208:211]
    ds_read_b128 a[252:255], v227 offset:37440
    ds_read_b128 a[220:223], v224
    v_mfma_f32_16x16x32_bf16 v[200:203], a[48:51], a[224:227], v[200:203]
    v_mfma_f32_16x16x32_bf16 v[204:207], a[52:55], a[224:227], v[204:207]
    v_mfma_f32_16x16x32_bf16 v[208:211], a[56:59], a[224:227], v[208:211]
    buffer_load_dwordx4 v252, s[8:11], s57 offen lds
    v_mfma_f32_16x16x32_bf16 v[200:203], a[60:63], a[228:231], v[200:203]
    s_add_u32 m0, s50, 0x9800
    ds_read_b128 a[224:227], v224 offset:64
    v_mfma_f32_16x16x32_bf16 v[204:207], a[64:67], a[228:231], v[204:207]
    v_mfma_f32_16x16x32_bf16 v[208:211], a[68:71], a[228:231], v[208:211]
    ds_read_b128 a[228:231], v224 offset:128
    v_mfma_f32_16x16x32_bf16 v[212:215], a[0:3], a[232:235], 0
    v_mfma_f32_16x16x32_bf16 v[216:219], a[4:7], a[232:235], 0
    v_mfma_f32_16x16x32_bf16 v[220:223], a[8:11], a[232:235], 0
    buffer_load_dwordx4 v253, s[8:11], s57 offen lds
    v_mfma_f32_16x16x32_bf16 v[212:215], a[12:15], a[236:239], v[212:215]
    s_add_u32 s57, s49, 0x24000
    v_cvt_pk_bf16_f32 v42, v200, v201
    v_cvt_pk_bf16_f32 v43, v202, v203
    v_mfma_f32_16x16x32_bf16 v[216:219], a[16:19], a[236:239], v[216:219]
    s_add_u32 m0, s50, 0xc000
    v_cvt_pk_bf16_f32 v44, v204, v205
    v_cvt_pk_bf16_f32 v45, v206, v207
    v_mfma_f32_16x16x32_bf16 v[220:223], a[20:23], a[236:239], v[220:223]
    v_cvt_pk_bf16_f32 v46, v208, v209
    v_cvt_pk_bf16_f32 v47, v210, v211
    v_mfma_f32_16x16x32_bf16 v[212:215], a[24:27], a[240:243], v[212:215]
    s_waitcnt vmcnt(12)
    ds_read_b64_tr_b16 a[132:133], v254 offset:61440
    ds_read_b64_tr_b16 a[134:135], v255 offset:61440
    v_mfma_f32_16x16x32_bf16 v[216:219], a[28:31], a[240:243], v[216:219]
    s_waitcnt lgkmcnt(3)
    buffer_load_dwordx4 v251, s[8:11], s57 offen lds
    v_mfma_f32_16x16x32_bf16 v[220:223], a[32:35], a[240:243], v[220:223]
    s_add_u32 m0, s50, 0xc400
    ds_read_b64_tr_b16 a[136:137], v254 offset:61472
    ds_read_b64_tr_b16 a[138:139], v255 offset:61472
    v_mfma_f32_16x16x32_bf16 v[212:215], a[36:39], a[244:247], v[212:215]
    ds_read_b64_tr_b16 a[140:141], v254 offset:61504
    ds_read_b64_tr_b16 a[142:143], v255 offset:61504
    v_mfma_f32_16x16x32_bf16 v[216:219], a[40:43], a[244:247], v[216:219]
    ds_read_b128 a[232:235], v224 offset:192
    ds_read_b128 a[236:239], v224 offset:256
    v_mfma_f32_16x16x32_bf16 v[220:223], a[44:47], a[244:247], v[220:223]
    ds_read_b128 a[240:243], v224 offset:320
    ds_read_b128 a[244:247], v224 offset:3072
    v_mfma_f32_16x16x32_bf16 v[212:215], a[48:51], a[248:251], v[212:215]
    v_mfma_f32_16x16x32_bf16 v[216:219], a[52:55], a[248:251], v[216:219]
    buffer_load_dwordx4 v252, s[8:11], s57 offen lds
    v_mfma_f32_16x16x32_bf16 v[220:223], a[56:59], a[248:251], v[220:223]
    s_add_u32 m0, s50, 0xc800
    ds_read_b128 a[248:251], v224 offset:3136
    v_mfma_f32_16x16x32_bf16 v[212:215], a[60:63], a[252:255], v[212:215]
    v_mfma_f32_16x16x32_bf16 v[216:219], a[64:67], a[252:255], v[216:219]
    v_mfma_f32_16x16x32_bf16 v[220:223], a[68:71], a[252:255], v[220:223]
    ds_read_b128 a[252:255], v224 offset:3200
    v_mfma_f32_16x16x32_bf16 v[200:203], a[220:223], a[72:75], 0
    buffer_load_dwordx4 v253, s[8:11], s57 offen lds
    v_mfma_f32_16x16x32_bf16 v[204:207], a[220:223], a[76:79], 0
    s_add_u32 s57, s49, 0x2d000
    s_add_u32 m0, s50, 0xf000
    v_cvt_pk_bf16_f32 v54, v212, v213
    v_mfma_f32_16x16x32_bf16 v[208:211], a[220:223], a[80:83], 0
    v_cvt_pk_bf16_f32 v55, v214, v215
    v_cvt_pk_bf16_f32 v56, v216, v217
    v_mfma_f32_16x16x32_bf16 v[200:203], a[224:227], a[84:87], v[200:203]
    v_cvt_pk_bf16_f32 v57, v218, v219
    v_cvt_pk_bf16_f32 v58, v220, v221
    v_mfma_f32_16x16x32_bf16 v[204:207], a[224:227], a[88:91], v[204:207]
    ds_read_b128 a[220:223], v224 offset:3264
    v_cvt_pk_bf16_f32 v59, v222, v223
    v_mfma_f32_16x16x32_bf16 v[208:211], a[224:227], a[92:95], v[208:211]
    s_waitcnt vmcnt(12) lgkmcnt(3)
    ds_read_b128 a[224:227], v224 offset:3328
    ds_read_b64_tr_b16 a[144:145], v254
    v_mfma_f32_16x16x32_bf16 v[200:203], a[228:231], a[96:99], v[200:203]
    buffer_load_dwordx4 v251, s[8:11], s57 offen lds
    v_mfma_f32_16x16x32_bf16 v[204:207], a[228:231], a[100:103], v[204:207]
    s_add_u32 m0, s50, 0xf400
    ds_read_b64_tr_b16 a[146:147], v255
    ds_read_b64_tr_b16 a[148:149], v254 offset:32
    v_mfma_f32_16x16x32_bf16 v[208:211], a[228:231], a[104:107], v[208:211]
    ds_read_b128 a[228:231], v224 offset:3392
    ds_read_b64_tr_b16 a[150:151], v255 offset:32
    v_mfma_f32_16x16x32_bf16 v[200:203], a[232:235], a[108:111], v[200:203]
    ds_read_b64_tr_b16 a[152:153], v254 offset:64
    ds_read_b64_tr_b16 a[154:155], v255 offset:64
    v_mfma_f32_16x16x32_bf16 v[204:207], a[232:235], a[112:115], v[204:207]
    v_mfma_f32_16x16x32_bf16 v[208:211], a[232:235], a[116:119], v[208:211]
    buffer_load_dwordx4 v252, s[8:11], s57 offen lds
    v_mfma_f32_16x16x32_bf16 v[200:203], a[236:239], a[120:123], v[200:203]
    s_add_u32 m0, s50, 0xf800
    ds_read_b128 a[232:235], v224 offset:15488
    v_mfma_f32_16x16x32_bf16 v[204:207], a[236:239], a[124:127], v[204:207]
    v_mfma_f32_16x16x32_bf16 v[208:211], a[236:239], a[128:131], v[208:211]
    ds_read_b128 a[236:239], v224 offset:15552
    v_mfma_f32_16x16x32_bf16 v[200:203], a[240:243], a[132:135], v[200:203]
    v_mfma_f32_16x16x32_bf16 v[204:207], a[240:243], a[136:139], v[204:207]
    v_mfma_f32_16x16x32_bf16 v[208:211], a[240:243], a[140:143], v[208:211]
    buffer_load_dwordx4 v253, s[8:11], s57 offen lds
    v_mfma_f32_16x16x32_bf16 v[212:215], a[244:247], a[72:75], 0
    s_add_u32 s57, s49, 0
    ds_read_b128 a[240:243], v224 offset:15616
    s_add_u32 m0, s50, 0
    v_mfma_f32_16x16x32_bf16 v[216:219], a[244:247], a[76:79], 0
    v_cvt_pk_bf16_f32 v66, v200, v201
    v_cvt_pk_bf16_f32 v67, v202, v203
    v_mfma_f32_16x16x32_bf16 v[220:223], a[244:247], a[80:83], 0
    s_waitcnt lgkmcnt(3)
    v_cvt_pk_bf16_f32 v88, v204, v205
    v_cvt_pk_bf16_f32 v89, v206, v207
    v_mfma_f32_16x16x32_bf16 v[212:215], a[248:251], a[84:87], v[212:215]
    v_cvt_pk_bf16_f32 v110, v208, v209
    v_cvt_pk_bf16_f32 v111, v210, v211
    v_mfma_f32_16x16x32_bf16 v[216:219], a[248:251], a[88:91], v[216:219]
    s_waitcnt vmcnt(12)
    ds_read_b128 a[244:247], v224 offset:15680
    ds_read_b64_tr_b16 a[156:157], v254 offset:12288
    v_mfma_f32_16x16x32_bf16 v[220:223], a[248:251], a[92:95], v[220:223]
    ds_read_b128 a[248:251], v224 offset:15744
    ds_read_b64_tr_b16 a[158:159], v255 offset:12288
    v_mfma_f32_16x16x32_bf16 v[212:215], a[252:255], a[96:99], v[212:215]
    buffer_load_dwordx4 v192, s[12:15], s57 offen lds
    v_mfma_f32_16x16x32_bf16 v[216:219], a[252:255], a[100:103], v[216:219]
    s_add_u32 m0, s50, 0x400
    ds_read_b64_tr_b16 a[160:161], v254 offset:12320
    ds_read_b64_tr_b16 a[162:163], v255 offset:12320
    v_mfma_f32_16x16x32_bf16 v[220:223], a[252:255], a[104:107], v[220:223]
    ds_read_b128 a[252:255], v224 offset:15808
    ds_read_b64_tr_b16 a[164:165], v254 offset:12352
    v_mfma_f32_16x16x32_bf16 v[212:215], a[220:223], a[108:111], v[212:215]
    ds_read_b64_tr_b16 a[166:167], v255 offset:12352
    v_mfma_f32_16x16x32_bf16 v[216:219], a[220:223], a[112:115], v[216:219]
    buffer_load_dwordx4 v193, s[12:15], s57 offen lds
    v_mfma_f32_16x16x32_bf16 v[220:223], a[220:223], a[116:119], v[220:223]
    s_add_u32 m0, s50, 0x800
    ds_read_b128 a[220:223], v224 offset:18560
    v_mfma_f32_16x16x32_bf16 v[212:215], a[224:227], a[120:123], v[212:215]
    v_mfma_f32_16x16x32_bf16 v[216:219], a[224:227], a[124:127], v[216:219]
    v_mfma_f32_16x16x32_bf16 v[220:223], a[224:227], a[128:131], v[220:223]
    ds_read_b128 a[224:227], v224 offset:18624
    v_mfma_f32_16x16x32_bf16 v[212:215], a[228:231], a[132:135], v[212:215]
    buffer_load_dwordx4 v194, s[12:15], s57 offen lds
    v_mfma_f32_16x16x32_bf16 v[216:219], a[228:231], a[136:139], v[216:219]
    s_add_u32 s57, s49, 0x3000
    s_add_u32 m0, s50, 0x3000
    v_mfma_f32_16x16x32_bf16 v[220:223], a[228:231], a[140:143], v[220:223]
    s_waitcnt lgkmcnt(5)
    ds_read_b128 a[228:231], v224 offset:18688
    v_mfma_f32_16x16x32_bf16 v[200:203], a[232:235], a[72:75], 0
    v_mfma_f32_16x16x32_bf16 v[204:207], a[232:235], a[76:79], 0
    v_cvt_pk_bf16_f32 v68, v212, v213
    v_cvt_pk_bf16_f32 v69, v214, v215
    v_mfma_f32_16x16x32_bf16 v[208:211], a[232:235], a[80:83], 0
    v_cvt_pk_bf16_f32 v90, v216, v217
    v_cvt_pk_bf16_f32 v91, v218, v219
    v_mfma_f32_16x16x32_bf16 v[200:203], a[236:239], a[84:87], v[200:203]
    v_cvt_pk_bf16_f32 v112, v220, v221
    v_cvt_pk_bf16_f32 v113, v222, v223
    v_mfma_f32_16x16x32_bf16 v[204:207], a[236:239], a[88:91], v[204:207]
    s_waitcnt vmcnt(12)
    ds_read_b128 a[232:235], v224 offset:18752
    ds_read_b64_tr_b16 a[168:169], v254 offset:24576
    v_mfma_f32_16x16x32_bf16 v[208:211], a[236:239], a[92:95], v[208:211]
    ds_read_b128 a[236:239], v224 offset:18816
    ds_read_b64_tr_b16 a[170:171], v255 offset:24576
    v_mfma_f32_16x16x32_bf16 v[200:203], a[240:243], a[96:99], v[200:203]
    s_waitcnt lgkmcnt(5)
    buffer_load_dwordx4 v192, s[12:15], s57 offen lds
    v_mfma_f32_16x16x32_bf16 v[204:207], a[240:243], a[100:103], v[204:207]
    s_add_u32 m0, s50, 0x3400
    ds_read_b64_tr_b16 a[172:173], v254 offset:24608
    ds_read_b64_tr_b16 a[174:175], v255 offset:24608
    v_mfma_f32_16x16x32_bf16 v[208:211], a[240:243], a[104:107], v[208:211]
    ds_read_b128 a[240:243], v224 offset:18880
    ds_read_b64_tr_b16 a[176:177], v254 offset:24640
    v_mfma_f32_16x16x32_bf16 v[200:203], a[244:247], a[108:111], v[200:203]
    buffer_load_dwordx4 v193, s[12:15], s57 offen lds
    v_mfma_f32_16x16x32_bf16 v[204:207], a[244:247], a[112:115], v[204:207]
    s_add_u32 m0, s50, 0x3800
    ds_read_b64_tr_b16 a[178:179], v255 offset:24640
    v_mfma_f32_16x16x32_bf16 v[208:211], a[244:247], a[116:119], v[208:211]
    ds_read_b128 a[244:247], v227 offset:6144
    v_mfma_f32_16x16x32_bf16 v[200:203], a[248:251], a[120:123], v[200:203]
    v_mfma_f32_16x16x32_bf16 v[204:207], a[248:251], a[124:127], v[204:207]
    v_mfma_f32_16x16x32_bf16 v[208:211], a[248:251], a[128:131], v[208:211]
    ds_read_b128 a[248:251], v227 offset:6208
    v_mfma_f32_16x16x32_bf16 v[200:203], a[252:255], a[132:135], v[200:203]
    buffer_load_dwordx4 v194, s[12:15], s57 offen lds
    v_mfma_f32_16x16x32_bf16 v[204:207], a[252:255], a[136:139], v[204:207]
    s_add_u32 s57, s49, 0x6000
    s_add_u32 m0, s50, 0x6000
    v_mfma_f32_16x16x32_bf16 v[208:211], a[252:255], a[140:143], v[208:211]
    s_waitcnt vmcnt(12)
    ds_read_b128 a[252:255], v227 offset:6272
    ds_read_b64_tr_b16 a[180:181], v254 offset:36864
    v_mfma_f32_16x16x32_bf16 v[212:215], a[220:223], a[72:75], 0
    v_cvt_pk_bf16_f32 v72, v200, v201
    v_cvt_pk_bf16_f32 v73, v202, v203
    v_mfma_f32_16x16x32_bf16 v[216:219], a[220:223], a[76:79], 0
    v_cvt_pk_bf16_f32 v94, v204, v205
    v_cvt_pk_bf16_f32 v95, v206, v207
    v_mfma_f32_16x16x32_bf16 v[220:223], a[220:223], a[80:83], 0
    v_cvt_pk_bf16_f32 v116, v208, v209
    v_cvt_pk_bf16_f32 v117, v210, v211
    v_mfma_f32_16x16x32_bf16 v[212:215], a[224:227], a[84:87], v[212:215]
    ds_read_b128 a[220:223], v227 offset:6336
    ds_read_b64_tr_b16 a[182:183], v255 offset:36864
    v_mfma_f32_16x16x32_bf16 v[216:219], a[224:227], a[88:91], v[216:219]
    s_waitcnt lgkmcnt(5)
    buffer_load_dwordx4 v192, s[12:15], s57 offen lds
    v_mfma_f32_16x16x32_bf16 v[220:223], a[224:227], a[92:95], v[220:223]
    s_add_u32 m0, s50, 0x6400
    ds_read_b128 a[224:227], v227 offset:6400
    ds_read_b64_tr_b16 a[184:185], v254 offset:36896
    v_mfma_f32_16x16x32_bf16 v[212:215], a[228:231], a[96:99], v[212:215]
    ds_read_b64_tr_b16 a[186:187], v255 offset:36896
    ds_read_b64_tr_b16 a[188:189], v254 offset:36928
    v_mfma_f32_16x16x32_bf16 v[216:219], a[228:231], a[100:103], v[216:219]
    buffer_load_dwordx4 v193, s[12:15], s57 offen lds
    v_mfma_f32_16x16x32_bf16 v[220:223], a[228:231], a[104:107], v[220:223]
    s_add_u32 m0, s50, 0x6800
    ds_read_b128 a[228:231], v227 offset:6464
    ds_read_b64_tr_b16 a[190:191], v255 offset:36928
    v_mfma_f32_16x16x32_bf16 v[212:215], a[232:235], a[108:111], v[212:215]
    v_mfma_f32_16x16x32_bf16 v[216:219], a[232:235], a[112:115], v[216:219]
    v_mfma_f32_16x16x32_bf16 v[220:223], a[232:235], a[116:119], v[220:223]
    ds_read_b128 a[232:235], v225 offset:24384
    v_mfma_f32_16x16x32_bf16 v[212:215], a[236:239], a[120:123], v[212:215]
    buffer_load_dwordx4 v194, s[12:15], s57 offen lds
    v_mfma_f32_16x16x32_bf16 v[216:219], a[236:239], a[124:127], v[216:219]
    s_add_u32 s57, s49, 0x9000
    s_add_u32 m0, s50, 0x9000
    v_mfma_f32_16x16x32_bf16 v[220:223], a[236:239], a[128:131], v[220:223]
    ds_read_b128 a[236:239], v225 offset:24448
    v_mfma_f32_16x16x32_bf16 v[212:215], a[240:243], a[132:135], v[212:215]
    v_mfma_f32_16x16x32_bf16 v[216:219], a[240:243], a[136:139], v[216:219]
    s_waitcnt vmcnt(12)
    ds_read_b64_tr_b16 a[192:193], v254 offset:49152
    ds_read_b64_tr_b16 a[194:195], v255 offset:49152
    v_mfma_f32_16x16x32_bf16 v[220:223], a[240:243], a[140:143], v[220:223]
    ds_read_b64_tr_b16 a[196:197], v254 offset:49184
    ds_read_b64_tr_b16 a[198:199], v255 offset:49184
    v_mfma_f32_16x16x32_bf16 v[200:203], a[244:247], a[72:75], 0
    s_waitcnt lgkmcnt(6)
    buffer_load_dwordx4 v192, s[12:15], s57 offen lds
    v_mfma_f32_16x16x32_bf16 v[204:207], a[244:247], a[76:79], 0
    s_add_u32 m0, s50, 0x9400
    v_cvt_pk_bf16_f32 v70, v212, v213
    v_cvt_pk_bf16_f32 v71, v214, v215
    v_mfma_f32_16x16x32_bf16 v[208:211], a[244:247], a[80:83], 0
    v_cvt_pk_bf16_f32 v92, v216, v217
    v_cvt_pk_bf16_f32 v93, v218, v219
    v_mfma_f32_16x16x32_bf16 v[200:203], a[248:251], a[84:87], v[200:203]
    v_cvt_pk_bf16_f32 v114, v220, v221
    v_cvt_pk_bf16_f32 v115, v222, v223
    v_mfma_f32_16x16x32_bf16 v[204:207], a[248:251], a[88:91], v[204:207]
    ds_read_b64_tr_b16 a[200:201], v254 offset:49216
    ds_read_b64_tr_b16 a[202:203], v255 offset:49216
    v_mfma_f32_16x16x32_bf16 v[208:211], a[248:251], a[92:95], v[208:211]
    buffer_load_dwordx4 v193, s[12:15], s57 offen lds
    v_mfma_f32_16x16x32_bf16 v[200:203], a[252:255], a[96:99], v[200:203]
    s_add_u32 m0, s50, 0x9800
    ds_read_b128 a[240:243], v225 offset:24512
    ds_read_b128 a[244:247], v225 offset:24576
    v_mfma_f32_16x16x32_bf16 v[204:207], a[252:255], a[100:103], v[204:207]
    ds_read_b128 a[248:251], v225 offset:24640
    v_mfma_f32_16x16x32_bf16 v[208:211], a[252:255], a[104:107], v[208:211]
    ds_read_b128 a[252:255], v225 offset:24704
    v_mfma_f32_16x16x32_bf16 v[200:203], a[220:223], a[108:111], v[200:203]
    v_mfma_f32_16x16x32_bf16 v[204:207], a[220:223], a[112:115], v[204:207]
    v_mfma_f32_16x16x32_bf16 v[208:211], a[220:223], a[116:119], v[208:211]
    buffer_load_dwordx4 v194, s[12:15], s57 offen lds
    v_mfma_f32_16x16x32_bf16 v[200:203], a[224:227], a[120:123], v[200:203]
    s_add_u32 s57, s49, 0xc000
    ds_read_b128 a[220:223], v225 offset:27456
    s_add_u32 m0, s50, 0xc000
    v_mfma_f32_16x16x32_bf16 v[204:207], a[224:227], a[124:127], v[204:207]
    v_mfma_f32_16x16x32_bf16 v[208:211], a[224:227], a[128:131], v[208:211]
    s_waitcnt vmcnt(12)
    ds_read_b128 a[224:227], v225 offset:27520
    ds_read_b64_tr_b16 a[204:205], v254 offset:61440
    v_mfma_f32_16x16x32_bf16 v[200:203], a[228:231], a[132:135], v[200:203]
    ds_read_b64_tr_b16 a[206:207], v255 offset:61440
    ds_read_b64_tr_b16 a[208:209], v254 offset:61472
    v_mfma_f32_16x16x32_bf16 v[204:207], a[228:231], a[136:139], v[204:207]
    s_waitcnt lgkmcnt(8)
    buffer_load_dwordx4 v192, s[12:15], s57 offen lds
    v_mfma_f32_16x16x32_bf16 v[208:211], a[228:231], a[140:143], v[208:211]
    s_add_u32 m0, s50, 0xc400
    ds_read_b64_tr_b16 a[210:211], v255 offset:61472
    ds_read_b64_tr_b16 a[212:213], v254 offset:61504
    v_mfma_f32_16x16x32_bf16 v[212:215], a[144:147], a[232:235], 0
    v_cvt_pk_bf16_f32 v82, v200, v201
    v_cvt_pk_bf16_f32 v83, v202, v203
    v_mfma_f32_16x16x32_bf16 v[216:219], a[148:151], a[232:235], 0
    v_cvt_pk_bf16_f32 v104, v204, v205
    v_cvt_pk_bf16_f32 v105, v206, v207
    v_mfma_f32_16x16x32_bf16 v[220:223], a[152:155], a[232:235], 0
    v_cvt_pk_bf16_f32 v126, v208, v209
    v_cvt_pk_bf16_f32 v127, v210, v211
    v_mfma_f32_16x16x32_bf16 v[212:215], a[156:159], a[236:239], v[212:215]
    ds_read_b64_tr_b16 a[214:215], v255 offset:61504
    ds_read_b128 a[228:231], v225 offset:27584
    v_mfma_f32_16x16x32_bf16 v[216:219], a[160:163], a[236:239], v[216:219]
    buffer_load_dwordx4 v193, s[12:15], s57 offen lds
    v_mfma_f32_16x16x32_bf16 v[220:223], a[164:167], a[236:239], v[220:223]
    s_add_u32 m0, s50, 0xc800
    ds_read_b128 a[232:235], v225 offset:27648
    ds_read_b128 a[236:239], v225 offset:27712
    v_mfma_f32_16x16x32_bf16 v[212:215], a[168:171], a[240:243], v[212:215]
    ds_read_b128 v[252:255], v227 offset:37120
    v_mfma_f32_16x16x32_bf16 v[216:219], a[172:175], a[240:243], v[216:219]
    v_mfma_f32_16x16x32_bf16 v[220:223], a[176:179], a[240:243], v[220:223]
    s_waitcnt lgkmcnt(6)
    ds_read_b128 a[240:243], v225 offset:27776
    v_mfma_f32_16x16x32_bf16 v[212:215], a[180:183], a[244:247], v[212:215]
    buffer_load_dwordx4 v194, s[12:15], s57 offen lds
    v_mfma_f32_16x16x32_bf16 v[216:219], a[184:187], a[244:247], v[216:219]
    s_add_u32 s57, s49, 0xf000
    s_add_u32 m0, s50, 0xf000
    v_mfma_f32_16x16x32_bf16 v[220:223], a[188:191], a[244:247], v[220:223]
    ds_read_b128 a[244:247], v224 offset:30976
    v_mfma_f32_16x16x32_bf16 v[212:215], a[192:195], a[248:251], v[212:215]
    v_mfma_f32_16x16x32_bf16 v[216:219], a[196:199], a[248:251], v[216:219]
    v_mfma_f32_16x16x32_bf16 v[220:223], a[200:203], a[248:251], v[220:223]
    ds_read_b128 a[248:251], v224 offset:31040
    v_mfma_f32_16x16x32_bf16 v[212:215], a[204:207], a[252:255], v[212:215]
    s_waitcnt lgkmcnt(2)
    buffer_load_dwordx4 v192, s[12:15], s57 offen lds
    v_mfma_f32_16x16x32_bf16 v[216:219], a[208:211], a[252:255], v[216:219]
    s_add_u32 m0, s50, 0xf400
    s_barrier
    v_mfma_f32_16x16x32_bf16 v[220:223], a[212:215], a[252:255], v[220:223]
    ds_read_b128 a[252:255], v224 offset:31104
    v_mfma_f32_16x16x32_bf16 v[200:203], a[144:147], a[220:223], 0
    v_mfma_f32_16x16x32_bf16 v[204:207], a[148:151], a[220:223], 0
    v_cvt_pk_bf16_f32 v132, v212, v213
    v_cvt_pk_bf16_f32 v133, v214, v215
    v_mfma_f32_16x16x32_bf16 v[208:211], a[152:155], a[220:223], 0
    buffer_load_dwordx4 v193, s[12:15], s57 offen lds
    v_mfma_f32_16x16x32_bf16 v[200:203], a[156:159], a[224:227], v[200:203]
    s_add_u32 m0, s50, 0xf800
    v_cvt_pk_bf16_f32 v134, v216, v217
    v_cvt_pk_bf16_f32 v135, v218, v219
    v_mfma_f32_16x16x32_bf16 v[204:207], a[160:163], a[224:227], v[204:207]
    v_cvt_pk_bf16_f32 v136, v220, v221
    v_cvt_pk_bf16_f32 v137, v222, v223
    v_mfma_f32_16x16x32_bf16 v[144:147], v[0:3], v[132:135], v[144:147]
    ds_read_b128 a[220:223], v224 offset:31168
    v_mfma_f32_16x16x32_bf16 v[148:151], v[24:27], v[132:135], v[148:151]
    v_mfma_f32_16x16x32_bf16 v[152:155], v[30:33], v[132:135], v[152:155]
    v_mfma_f32_16x16x32_bf16 v[156:159], v[6:9], v[132:135], v[156:159]
    buffer_load_dwordx4 v194, s[12:15], s57 offen lds
    v_mfma_f32_16x16x32_bf16 v[160:163], v[12:15], v[132:135], v[160:163]
    s_add_u32 m0, s41, 0
    v_mfma_f32_16x16x16_bf16 v[144:147], v[4:5], v[136:137], v[144:147]
    v_mfma_f32_16x16x16_bf16 v[148:151], v[28:29], v[136:137], v[148:151]
    v_mfma_f32_16x16x16_bf16 v[152:155], v[34:35], v[136:137], v[152:155]
    v_mfma_f32_16x16x16_bf16 v[156:159], v[10:11], v[136:137], v[156:159]
    buffer_load_dwordx4 v246, s[4:7], s56 offen lds
    v_mfma_f32_16x16x16_bf16 v[160:163], v[16:17], v[136:137], v[160:163]
    s_add_u32 m0, s42, 0
    v_mfma_f32_16x16x32_bf16 v[164:167], v[36:39], v[132:135], v[164:167]
    v_mfma_f32_16x16x32_bf16 v[168:171], v[42:45], v[132:135], v[168:171]
    v_max3_f32 v248, v144, v145, v146
    v_max3_f32 v249, v147, v148, v149
    v_mfma_f32_16x16x32_bf16 v[172:175], v[18:21], v[132:135], v[172:175]
    v_max3_f32 v248, v248, v150, v151
    v_max3_f32 v249, v249, v152, v153
    v_mfma_f32_16x16x16_bf16 v[164:167], v[40:41], v[136:137], v[164:167]
    v_max3_f32 v248, v248, v154, v155
    v_max3_f32 v249, v249, v156, v157
    v_mfma_f32_16x16x16_bf16 v[168:171], v[46:47], v[136:137], v[168:171]
    buffer_load_dwordx4 v247, s[4:7], s56 offen lds
    v_mfma_f32_16x16x16_bf16 v[172:175], v[22:23], v[136:137], v[172:175]
    s_add_u32 s56, s39, 0x17a000
    v_max3_f32 v248, v248, v158, v159
    v_max3_f32 v249, v249, v160, v161
    v_mfma_f32_16x16x32_bf16 v[208:211], a[164:167], a[224:227], v[208:211]
    s_add_u32 m0, s41, 0x1e40
    ds_read_b128 a[224:227], v224 offset:31232
    v_max3_f32 v248, v248, v162, v163
    v_mfma_f32_16x16x32_bf16 v[200:203], a[168:171], a[228:231], v[200:203]
    v_max3_f32 v249, v249, v164, v165
    v_max3_f32 v248, v248, v166, v167
    v_mfma_f32_16x16x32_bf16 v[204:207], a[172:175], a[228:231], v[204:207]
    v_max3_f32 v249, v249, v168, v169
    v_max3_f32 v248, v248, v170, v171
    v_mfma_f32_16x16x32_bf16 v[208:211], a[176:179], a[228:231], v[208:211]
    buffer_load_dwordx4 v246, s[4:7], s56 offen lds
    v_mfma_f32_16x16x32_bf16 v[200:203], a[180:183], a[232:235], v[200:203]
    s_add_u32 m0, s42, 0x1e40
    ds_read_b128 a[228:231], v224 offset:31296
    v_max3_f32 v249, v249, v172, v173
    v_mfma_f32_16x16x32_bf16 v[204:207], a[184:187], a[232:235], v[204:207]
    v_max3_f32 v248, v248, v174, v175
    v_max_f32 v248, v248, v249
    v_mfma_f32_16x16x32_bf16 v[208:211], a[188:191], a[232:235], v[208:211]
    ds_read_b128 a[232:235], v224 offset:34048
    v_mov_b32 v249, v248
    v_mfma_f32_16x16x32_bf16 v[200:203], a[192:195], a[236:239], v[200:203]
    v_mfma_f32_16x16x32_bf16 v[204:207], a[196:199], a[236:239], v[204:207]
    v_permlane16_swap_b32 v248, v249
    v_mfma_f32_16x16x32_bf16 v[208:211], a[200:203], a[236:239], v[208:211]
    buffer_load_dwordx4 v247, s[4:7], s56 offen lds
    v_mfma_f32_16x16x32_bf16 v[200:203], a[204:207], a[240:243], v[200:203]
    s_add_u32 s56, s39, 0x1a4000
    ds_read_b128 a[236:239], v224 offset:34112
    v_max_f32 v248, v248, v249
    v_mfma_f32_16x16x32_bf16 v[204:207], a[208:211], a[240:243], v[204:207]
    s_add_u32 m0, s41, 0x3c80
    v_mov_b32 v249, v248
    v_mfma_f32_16x16x32_bf16 v[208:211], a[212:215], a[240:243], v[208:211]
    s_waitcnt lgkmcnt(3)
    ds_read_b128 a[240:243], v224 offset:34176
    v_cvt_pk_bf16_f32 v138, v200, v201
    v_mfma_f32_16x16x32_bf16 v[212:215], a[244:247], a[72:75], 0
    v_cvt_pk_bf16_f32 v139, v202, v203
    v_mfma_f32_16x16x32_bf16 v[216:219], a[244:247], a[76:79], 0
    v_cvt_pk_bf16_f32 v140, v204, v205
    v_cvt_pk_bf16_f32 v141, v206, v207
    v_mfma_f32_16x16x32_bf16 v[220:223], a[244:247], a[80:83], 0
    v_cvt_pk_bf16_f32 v142, v208, v209
    v_cvt_pk_bf16_f32 v143, v210, v211
    v_mfma_f32_16x16x32_bf16 v[212:215], a[248:251], a[84:87], v[212:215]
    buffer_load_dwordx4 v246, s[4:7], s56 offen lds
    v_mfma_f32_16x16x32_bf16 v[216:219], a[248:251], a[88:91], v[216:219]
    s_add_u32 m0, s42, 0x3c80
    ds_read_b128 a[244:247], v224 offset:34240
    v_mfma_f32_16x16x32_bf16 v[220:223], a[248:251], a[92:95], v[220:223]
    ds_read_b128 a[248:251], v224 offset:34304
    v_mfma_f32_16x16x32_bf16 v[212:215], a[252:255], a[96:99], v[212:215]
    v_permlane32_swap_b32 v248, v249
    v_mfma_f32_16x16x32_bf16 v[216:219], a[252:255], a[100:103], v[216:219]
    buffer_load_dwordx4 v247, s[4:7], s56 offen lds
    v_mfma_f32_16x16x32_bf16 v[220:223], a[252:255], a[104:107], v[220:223]
    s_add_u32 s56, s39, 0x1ce000
    ds_read_b128 a[252:255], v224 offset:34368
    v_max_f32 v248, v248, v249
    v_mfma_f32_16x16x32_bf16 v[212:215], a[220:223], a[108:111], v[212:215]
    s_add_u32 m0, s41, 0x5ac0
    v_mul_f32 v250, s37, v248
    v_fma_f32 v144, v144, s37, -v250
    v_mfma_f32_16x16x32_bf16 v[216:219], a[220:223], a[112:115], v[216:219]
    v_fma_f32 v145, v145, s37, -v250
    v_fma_f32 v146, v146, s37, -v250
    v_mfma_f32_16x16x32_bf16 v[220:223], a[220:223], a[116:119], v[220:223]
    ds_read_b128 a[220:223], v224 offset:46464
    v_fma_f32 v147, v147, s37, -v250
    v_mfma_f32_16x16x32_bf16 v[212:215], a[224:227], a[120:123], v[212:215]
    buffer_load_dwordx4 v246, s[4:7], s56 offen lds
    v_mfma_f32_16x16x32_bf16 v[216:219], a[224:227], a[124:127], v[216:219]
    s_add_u32 m0, s42, 0x5ac0
    v_exp_f32 v144, v144
    v_mfma_f32_16x16x32_bf16 v[220:223], a[224:227], a[128:131], v[220:223]
    s_waitcnt lgkmcnt(3)
    ds_read_b128 a[224:227], v224 offset:46528
    v_fma_f32 v148, v148, s37, -v250
    v_mfma_f32_16x16x32_bf16 v[212:215], a[228:231], a[132:135], v[212:215]
    v_exp_f32 v145, v145
    v_mfma_f32_16x16x32_bf16 v[216:219], a[228:231], a[136:139], v[216:219]
    v_exp_f32 v146, v146
    v_mfma_f32_16x16x32_bf16 v[220:223], a[228:231], a[140:143], v[220:223]
    ds_read_b128 a[228:231], v224 offset:46592
    v_cvt_pk_bf16_f32 v176, v144, v145
    v_mfma_f32_16x16x32_bf16 v[200:203], a[232:235], a[72:75], 0
    buffer_load_dwordx4 v247, s[4:7], s56 offen lds
    v_mfma_f32_16x16x32_bf16 v[204:207], a[232:235], a[76:79], 0
    s_add_u32 s56, s39, 0x1f8000
    v_cvt_pk_bf16_f32 v74, v212, v213
    v_cvt_pk_bf16_f32 v75, v214, v215
    v_mfma_f32_16x16x32_bf16 v[208:211], a[232:235], a[80:83], 0
    s_add_u32 m0, s41, 0x7900
    v_cvt_pk_bf16_f32 v96, v216, v217
    v_cvt_pk_bf16_f32 v97, v218, v219
    v_mfma_f32_16x16x32_bf16 v[200:203], a[236:239], a[84:87], v[200:203]
    v_cvt_pk_bf16_f32 v118, v220, v221
    v_cvt_pk_bf16_f32 v119, v222, v223
    v_mfma_f32_16x16x32_bf16 v[204:207], a[236:239], a[88:91], v[204:207]
    ds_read_b128 a[232:235], v224 offset:46656
    v_fma_f32 v149, v149, s37, -v250
    v_mfma_f32_16x16x32_bf16 v[208:211], a[236:239], a[92:95], v[208:211]
    ds_read_b128 a[236:239], v224 offset:46720
    v_fma_f32 v150, v150, s37, -v250
    v_mfma_f32_16x16x32_bf16 v[200:203], a[240:243], a[96:99], v[200:203]
    v_exp_f32 v147, v147
    v_mfma_f32_16x16x32_bf16 v[204:207], a[240:243], a[100:103], v[204:207]
    v_cvt_pk_bf16_f32 v177, v146, v147
    v_fma_f32 v151, v151, s37, -v250
    v_mfma_f32_16x16x32_bf16 v[208:211], a[240:243], a[104:107], v[208:211]
    ds_read_b128 a[240:243], v224 offset:46784
    ds_read_b128 v[144:147], v234
    v_mfma_f32_16x16x32_bf16 v[200:203], a[244:247], a[108:111], v[200:203]
    v_bfe_u32 v234, s63, v233, 4
    v_mad_u32_u24 v234, v234, s40, v231
    v_mfma_f32_16x16x32_bf16 v[204:207], a[244:247], a[112:115], v[204:207]
    v_exp_f32 v148, v148
    v_mfma_f32_16x16x32_bf16 v[208:211], a[244:247], a[116:119], v[208:211]
    s_waitcnt lgkmcnt(4)
    ds_read_b128 a[244:247], v224 offset:49536
    v_fma_f32 v152, v152, s37, -v250
    v_mfma_f32_16x16x32_bf16 v[200:203], a[248:251], a[120:123], v[200:203]
    v_exp_f32 v149, v149
    v_mfma_f32_16x16x32_bf16 v[204:207], a[248:251], a[124:127], v[204:207]
    v_exp_f32 v150, v150
    v_mfma_f32_16x16x32_bf16 v[208:211], a[248:251], a[128:131], v[208:211]
    ds_read_b128 a[248:251], v224 offset:49600
    v_cvt_pk_bf16_f32 v178, v148, v149
    v_mfma_f32_16x16x32_bf16 v[200:203], a[252:255], a[132:135], v[200:203]
    v_exp_f32 v151, v151
    v_mfma_f32_16x16x32_bf16 v[204:207], a[252:255], a[136:139], v[204:207]
    v_cvt_pk_bf16_f32 v179, v150, v151
    v_fma_f32 v153, v153, s37, -v250
    v_mfma_f32_16x16x32_bf16 v[208:211], a[252:255], a[140:143], v[208:211]
    ds_read_b128 a[252:255], v224 offset:49664
    ds_read_b128 v[148:151], v235
    v_mfma_f32_16x16x32_bf16 v[196:199], a[216:219], v[176:179], 0
    v_cvt_pk_bf16_f32 v76, v200, v201
    v_cvt_pk_bf16_f32 v77, v202, v203
    v_mfma_f32_16x16x32_bf16 v[184:187], v[66:69], v[176:179], 0
    v_cvt_pk_bf16_f32 v98, v204, v205
    v_cvt_pk_bf16_f32 v99, v206, v207
    v_mfma_f32_16x16x32_bf16 v[188:191], v[88:91], v[176:179], 0
    v_cvt_pk_bf16_f32 v120, v208, v209
    v_cvt_pk_bf16_f32 v121, v210, v211
    v_mfma_f32_16x16x32_bf16 v[192:195], v[110:113], v[176:179], 0
    s_waitcnt lgkmcnt(3)
    v_bfe_u32 v235, s64, v233, 4
    v_mad_u32_u24 v235, v235, s40, v231
    v_mfma_f32_16x16x32_bf16 v[144:147], v[24:27], v[138:141], v[144:147]
    v_fma_f32 v154, v154, s37, -v250
    v_fma_f32 v155, v155, s37, -v250
    v_mfma_f32_16x16x32_bf16 v[212:215], a[220:223], a[72:75], 0
    v_exp_f32 v152, v152
    v_mfma_f32_16x16x32_bf16 v[216:219], a[220:223], a[76:79], 0
    v_exp_f32 v153, v153
    v_mfma_f32_16x16x16_bf16 v[144:147], v[28:29], v[142:143], v[144:147]
    v_exp_f32 v154, v154
    v_mfma_f32_16x16x32_bf16 v[220:223], a[220:223], a[80:83], 0
    ds_read_b128 a[220:223], v224 offset:49728
    v_cvt_pk_bf16_f32 v180, v152, v153
    v_mfma_f32_16x16x32_bf16 v[212:215], a[224:227], a[84:87], v[212:215]
    s_waitcnt lgkmcnt(1)
    v_exp_f32 v155, v155
    v_mfma_f32_16x16x32_bf16 v[148:151], v[30:33], v[138:141], v[148:151]
    v_cvt_pk_bf16_f32 v181, v154, v155
    v_fma_f32 v156, v156, s37, -v250
    v_mfma_f32_16x16x32_bf16 v[216:219], a[224:227], a[88:91], v[216:219]
    ds_read_b128 v[152:155], v230 offset:1920
    v_fma_f32 v157, v157, s37, -v250
    v_mfma_f32_16x16x32_bf16 v[220:223], a[224:227], a[92:95], v[220:223]
    ds_read_b128 a[224:227], v224 offset:49792
    v_fma_f32 v158, v158, s37, -v250
    v_mfma_f32_16x16x16_bf16 v[148:151], v[34:35], v[142:143], v[148:151]
    v_fma_f32 v159, v159, s37, -v250
    v_fma_f32 v160, v160, s37, -v250
    v_mfma_f32_16x16x32_bf16 v[212:215], a[228:231], a[96:99], v[212:215]
    v_exp_f32 v156, v156
    v_mfma_f32_16x16x32_bf16 v[216:219], a[228:231], a[100:103], v[216:219]
    v_exp_f32 v157, v157
    v_mfma_f32_16x16x32_bf16 v[220:223], a[228:231], a[104:107], v[220:223]
    ds_read_b128 a[228:231], v224 offset:49856
    v_cvt_pk_bf16_f32 v182, v156, v157
    v_mfma_f32_16x16x32_bf16 v[212:215], a[232:235], a[108:111], v[212:215]
    v_exp_f32 v158, v158
    v_mfma_f32_16x16x32_bf16 v[216:219], a[232:235], a[112:115], v[216:219]
    v_exp_f32 v159, v159
    v_mfma_f32_16x16x32_bf16 v[220:223], a[232:235], a[116:119], v[220:223]
    ds_read_b128 a[232:235], v225 offset:39872
    v_cvt_pk_bf16_f32 v183, v158, v159
    v_mfma_f32_16x16x32_bf16 v[212:215], a[236:239], a[120:123], v[212:215]
    ds_read_b128 v[156:159], v236
    v_bfe_u32 v236, s65, v232, 4
    v_mfma_f32_16x16x32_bf16 v[196:199], a[216:219], v[180:183], v[196:199]
    v_fma_f32 v161, v161, s37, -v250
    v_fma_f32 v162, v162, s37, -v250
    v_mfma_f32_16x16x32_bf16 v[184:187], v[70:73], v[180:183], v[184:187]
    v_fma_f32 v163, v163, s37, -v250
    v_fma_f32 v164, v164, s37, -v250
    v_mfma_f32_16x16x32_bf16 v[188:191], v[92:95], v[180:183], v[188:191]
    v_exp_f32 v160, v160
    v_mfma_f32_16x16x32_bf16 v[192:195], v[114:117], v[180:183], v[192:195]
    s_waitcnt lgkmcnt(3)
    v_exp_f32 v161, v161
    v_mfma_f32_16x16x32_bf16 v[152:155], v[36:39], v[138:141], v[152:155]
    v_exp_f32 v162, v162
    v_mfma_f32_16x16x32_bf16 v[216:219], a[236:239], a[124:127], v[216:219]
    v_exp_f32 v163, v163
    v_mfma_f32_16x16x32_bf16 v[220:223], a[236:239], a[128:131], v[220:223]
    ds_read_b128 a[236:239], v225 offset:39936
    v_cvt_pk_bf16_f32 v176, v160, v161
    v_mfma_f32_16x16x16_bf16 v[152:155], v[40:41], v[142:143], v[152:155]
    v_cvt_pk_bf16_f32 v177, v162, v163
    v_fma_f32 v165, v165, s37, -v250
    v_mfma_f32_16x16x32_bf16 v[212:215], a[240:243], a[132:135], v[212:215]
    s_waitcnt vmcnt(4) lgkmcnt(1)
    ds_read_b128 v[160:163], v234
    v_mad_u32_u24 v234, v236, s40, v229
    v_mfma_f32_16x16x32_bf16 v[156:159], v[42:45], v[138:141], v[156:159]
    s_barrier
    v_mad_u32_u24 v236, v236, s40, v228
    v_fma_f32 v166, v166, s37, -v250
    v_mfma_f32_16x16x32_bf16 v[216:219], a[240:243], a[136:139], v[216:219]
    v_fma_f32 v167, v167, s37, -v250
    v_cvt_pk_bf16_f32 v80, v212, v213
    v_mfma_f32_16x16x16_bf16 v[156:159], v[46:47], v[142:143], v[156:159]
    v_cvt_pk_bf16_f32 v81, v214, v215
    v_fma_f32 v168, v168, s37, -v250
    v_mfma_f32_16x16x32_bf16 v[220:223], a[240:243], a[140:143], v[220:223]
    ds_read_b128 a[240:243], v225 offset:40000
    v_fma_f32 v169, v169, s37, -v250
    v_mfma_f32_16x16x32_bf16 v[200:203], a[244:247], a[72:75], 0
    v_cvt_pk_bf16_f32 v102, v216, v217
    v_cvt_pk_bf16_f32 v103, v218, v219
    v_mfma_f32_16x16x32_bf16 v[204:207], a[244:247], a[76:79], 0
    v_exp_f32 v164, v164
    v_mfma_f32_16x16x32_bf16 v[208:211], a[244:247], a[80:83], 0
    v_cvt_pk_bf16_f32 v124, v220, v221
    v_cvt_pk_bf16_f32 v125, v222, v223
    v_mfma_f32_16x16x32_bf16 v[200:203], a[248:251], a[84:87], v[200:203]
    ds_read_b128 a[244:247], v225 offset:40064
    v_fma_f32 v170, v170, s37, -v250
    v_mfma_f32_16x16x32_bf16 v[204:207], a[248:251], a[88:91], v[204:207]
    s_waitcnt lgkmcnt(2)
    v_exp_f32 v165, v165
    v_mfma_f32_16x16x32_bf16 v[160:163], v[48:51], v[138:141], v[160:163]
    v_exp_f32 v166, v166
    v_mfma_f32_16x16x32_bf16 v[208:211], a[248:251], a[92:95], v[208:211]
    ds_read_b128 a[248:251], v225 offset:40128
    v_cvt_pk_bf16_f32 v178, v164, v165
    v_mfma_f32_16x16x32_bf16 v[200:203], a[252:255], a[96:99], v[200:203]
    v_exp_f32 v167, v167
    v_mfma_f32_16x16x16_bf16 v[160:163], v[52:53], v[142:143], v[160:163]
    v_cvt_pk_bf16_f32 v179, v166, v167
    v_fma_f32 v171, v171, s37, -v250
    v_mfma_f32_16x16x32_bf16 v[204:207], a[252:255], a[100:103], v[204:207]
    ds_read_b128 v[164:167], v235
    v_bfe_u32 v235, s62, v232, 4
    v_mfma_f32_16x16x32_bf16 v[196:199], a[216:219], v[176:179], v[196:199]
    v_exp_f32 v168, v168
    v_mfma_f32_16x16x32_bf16 v[184:187], v[74:77], v[176:179], v[184:187]
    v_exp_f32 v169, v169
    v_mfma_f32_16x16x32_bf16 v[188:191], v[96:99], v[176:179], v[188:191]
    v_exp_f32 v170, v170
    v_mfma_f32_16x16x32_bf16 v[192:195], v[118:121], v[176:179], v[192:195]
    v_exp_f32 v171, v171
    v_mfma_f32_16x16x32_bf16 v[208:211], a[252:255], a[104:107], v[208:211]
    ds_read_b128 a[252:255], v225 offset:40192
    v_cvt_pk_bf16_f32 v180, v168, v169
    v_mfma_f32_16x16x32_bf16 v[200:203], a[220:223], a[108:111], v[200:203]
    v_cvt_pk_bf16_f32 v181, v170, v171
    v_fma_f32 v172, v172, s37, -v250
    v_mfma_f32_16x16x32_bf16 v[204:207], a[220:223], a[112:115], v[204:207]
    ds_read_b128 v[168:171], v234
    v_bfe_u32 v234, s62, v232, 4
    v_mfma_f32_16x16x32_bf16 v[208:211], a[220:223], a[116:119], v[208:211]
    ds_read_b64_tr_b16 a[220:221], v240
    ds_read_b64_tr_b16 a[222:223], v240 offset:1536
    v_mfma_f32_16x16x32_bf16 v[200:203], a[224:227], a[120:123], v[200:203]
    s_waitcnt lgkmcnt(4)
    v_mad_u32_u24 v234, v234, s40, v230
    v_fma_f32 v173, v173, s37, -v250
    v_mfma_f32_16x16x32_bf16 v[164:167], v[54:57], v[138:141], v[164:167]
    v_fma_f32 v174, v174, s37, -v250
    v_fma_f32 v175, v175, s37, -v250
    v_mfma_f32_16x16x32_bf16 v[204:207], a[224:227], a[124:127], v[204:207]
    v_exp_f32 v172, v172
    v_mfma_f32_16x16x32_bf16 v[208:211], a[224:227], a[128:131], v[208:211]
    ds_read_b64_tr_b16 a[224:225], v240 offset:8
    ds_read_b64_tr_b16 a[226:227], v240 offset:1544
    v_mfma_f32_16x16x16_bf16 v[164:167], v[58:59], v[142:143], v[164:167]
    v_exp_f32 v173, v173
    v_mfma_f32_16x16x32_bf16 v[200:203], a[228:231], a[132:135], v[200:203]
    v_exp_f32 v174, v174
    v_mfma_f32_16x16x32_bf16 v[204:207], a[228:231], a[136:139], v[204:207]
    v_exp_f32 v175, v175
    v_mfma_f32_16x16x32_bf16 v[208:211], a[228:231], a[140:143], v[208:211]
    ds_read_b64_tr_b16 a[228:229], v241
    ds_read_b64_tr_b16 a[230:231], v241 offset:1536
    v_mfma_f32_16x16x32_bf16 v[212:215], a[144:147], a[232:235], 0
    v_cvt_pk_bf16_f32 v182, v172, v173
    v_cvt_pk_bf16_f32 v78, v200, v201
    v_mfma_f32_16x16x32_bf16 v[216:219], a[148:151], a[232:235], 0
    v_cvt_pk_bf16_f32 v79, v202, v203
    v_cvt_pk_bf16_f32 v100, v204, v205
    v_mfma_f32_16x16x32_bf16 v[220:223], a[152:155], a[232:235], 0
    v_cvt_pk_bf16_f32 v101, v206, v207
    v_cvt_pk_bf16_f32 v122, v208, v209
    v_mfma_f32_16x16x32_bf16 v[212:215], a[156:159], a[236:239], v[212:215]
    ds_read_b128 a[232:235], v227 offset:37184
    v_cvt_pk_bf16_f32 v123, v210, v211
    v_mfma_f32_16x16x32_bf16 v[216:219], a[160:163], a[236:239], v[216:219]
    v_cvt_pk_bf16_f32 v183, v174, v175
    v_max3_f32 v248, v144, v145, v146
    v_mfma_f32_16x16x32_bf16 v[220:223], a[164:167], a[236:239], v[220:223]
    ds_read_b128 a[236:239], v227 offset:37248
    ds_read_b128 v[172:175], v236
    v_mfma_f32_16x16x32_bf16 v[196:199], a[216:219], v[180:183], v[196:199]
    v_mad_u32_u24 v236, v235, s40, v228
    v_mad_u32_u24 v235, v235, s40, v229
    v_mfma_f32_16x16x32_bf16 v[184:187], v[78:81], v[180:183], v[184:187]
    v_max3_f32 v249, v147, v148, v149
    v_max3_f32 v248, v248, v150, v151
    v_mfma_f32_16x16x32_bf16 v[188:191], v[100:103], v[180:183], v[188:191]
    v_max3_f32 v249, v249, v152, v153
    v_max3_f32 v248, v248, v154, v155
    v_mfma_f32_16x16x32_bf16 v[192:195], v[122:125], v[180:183], v[192:195]
    v_rcp_f32 v197, v196
    v_mfma_f32_16x16x32_bf16 v[212:215], a[168:171], a[240:243], v[212:215]
    v_mul_f32 v184, v184, v197
    v_mul_f32 v185, v185, v197
    v_mfma_f32_16x16x32_bf16 v[216:219], a[172:175], a[240:243], v[216:219]
    v_cvt_pk_bf16_f32 v184, v184, v185
    v_mul_f32 v186, v186, v197
    v_mfma_f32_16x16x32_bf16 v[220:223], a[176:179], a[240:243], v[220:223]
    ds_read_b128 a[240:243], v227 offset:37312
    v_mul_f32 v187, v187, v197
    v_mfma_f32_16x16x32_bf16 v[212:215], a[180:183], a[244:247], v[212:215]
    v_cvt_pk_bf16_f32 v185, v186, v187
    v_mul_f32 v188, v188, v197
    v_mfma_f32_16x16x32_bf16 v[216:219], a[184:187], a[244:247], v[216:219]
    v_mul_f32 v189, v189, v197
    v_cvt_pk_bf16_f32 v186, v188, v189
    v_mfma_f32_16x16x32_bf16 v[220:223], a[188:191], a[244:247], v[220:223]
    ds_read_b128 a[244:247], v227 offset:37376
    v_mul_f32 v190, v190, v197
    v_mfma_f32_16x16x32_bf16 v[212:215], a[192:195], a[248:251], v[212:215]
    v_mul_f32 v191, v191, v197
    v_cvt_pk_bf16_f32 v187, v190, v191
    v_mfma_f32_16x16x32_bf16 v[216:219], a[196:199], a[248:251], v[216:219]
    v_mul_f32 v192, v192, v197
    v_mul_f32 v193, v193, v197
    v_mfma_f32_16x16x32_bf16 v[220:223], a[200:203], a[248:251], v[220:223]
    s_waitcnt lgkmcnt(2)
    ds_read_b128 a[248:251], v227 offset:37440
    v_cvt_pk_bf16_f32 v188, v192, v193
    v_mfma_f32_16x16x32_bf16 v[212:215], a[204:207], a[252:255], v[212:215]
    v_mul_f32 v194, v194, v197
    v_mul_f32 v195, v195, v197
    v_mfma_f32_16x16x32_bf16 v[216:219], a[208:211], a[252:255], v[216:219]
    v_cvt_pk_bf16_f32 v189, v194, v195
    v_max3_f32 v249, v249, v156, v157
    v_mfma_f32_16x16x32_bf16 v[220:223], a[212:215], a[252:255], v[220:223]
    ds_write_b128 v237, v[184:187]
    v_mfma_f32_16x16x32_bf16 v[200:203], v[252:255], a[72:75], 0
    v_cvt_pk_bf16_f32 v132, v212, v213
    v_cvt_pk_bf16_f32 v133, v214, v215
    v_mfma_f32_16x16x32_bf16 v[204:207], v[252:255], a[76:79], 0
    v_cvt_pk_bf16_f32 v134, v216, v217
    v_cvt_pk_bf16_f32 v135, v218, v219
    v_mfma_f32_16x16x32_bf16 v[208:211], v[252:255], a[80:83], 0
    v_cvt_pk_bf16_f32 v136, v220, v221
    v_cvt_pk_bf16_f32 v137, v222, v223
    v_mfma_f32_16x16x32_bf16 v[168:171], v[30:33], v[132:135], v[168:171]
    ds_write_b64 v238, v[188:189]
    v_mfma_f32_16x16x32_bf16 v[172:175], v[6:9], v[132:135], v[172:175]
    ds_read_b128 a[252:255], v224
    ds_read_b128 v[252:255], v224 offset:64
    v_mfma_f32_16x16x32_bf16 v[200:203], a[232:235], a[84:87], v[200:203]
    v_max3_f32 v248, v248, v158, v159
    v_max3_f32 v249, v249, v160, v161
    v_mfma_f32_16x16x16_bf16 v[168:171], v[34:35], v[136:137], v[168:171]
    v_max3_f32 v248, v248, v162, v163
    v_max3_f32 v249, v249, v164, v165
    v_mfma_f32_16x16x16_bf16 v[172:175], v[10:11], v[136:137], v[172:175]
    v_max3_f32 v248, v248, v166, v167
    v_max_f32 v248, v248, v249
    v_mfma_f32_16x16x32_bf16 v[204:207], a[232:235], a[88:91], v[204:207]
    v_mov_b32 v249, v248
    v_mfma_f32_16x16x32_bf16 v[208:211], a[232:235], a[92:95], v[208:211]
    ds_read_b128 a[232:235], v224 offset:128
    v_mfma_f32_16x16x32_bf16 v[200:203], a[236:239], a[96:99], v[200:203]
    v_permlane16_swap_b32 v248, v249
    v_mfma_f32_16x16x32_bf16 v[204:207], a[236:239], a[100:103], v[204:207]
    v_max_f32 v248, v248, v249
    v_mov_b32 v249, v248
    v_mfma_f32_16x16x32_bf16 v[208:211], a[236:239], a[104:107], v[208:211]
    s_waitcnt lgkmcnt(4)
    ds_read_b128 a[236:239], v224 offset:192
    v_mfma_f32_16x16x32_bf16 v[200:203], a[240:243], a[108:111], v[200:203]
    v_permlane32_swap_b32 v248, v249
    v_mfma_f32_16x16x32_bf16 v[204:207], a[240:243], a[112:115], v[204:207]
    v_max_f32 v248, v248, v249
    v_mul_f32 v250, s37, v248
    v_mfma_f32_16x16x32_bf16 v[208:211], a[240:243], a[116:119], v[208:211]
    ds_read_b128 a[240:243], v224 offset:256
    v_fma_f32 v144, v144, s37, -v250
    v_mfma_f32_16x16x32_bf16 v[200:203], a[244:247], a[120:123], v[200:203]
    v_fma_f32 v145, v145, s37, -v250
    v_fma_f32 v146, v146, s37, -v250
    v_mfma_f32_16x16x32_bf16 v[204:207], a[244:247], a[124:127], v[204:207]
    v_fma_f32 v147, v147, s37, -v250
    v_fma_f32 v148, v148, s37, -v250
    v_mfma_f32_16x16x32_bf16 v[208:211], a[244:247], a[128:131], v[208:211]
    ds_read_b128 a[244:247], v224 offset:320
    v_fma_f32 v149, v149, s37, -v250
    v_mfma_f32_16x16x32_bf16 v[200:203], a[248:251], a[132:135], v[200:203]
    v_exp_f32 v144, v144
    v_mfma_f32_16x16x32_bf16 v[204:207], a[248:251], a[136:139], v[204:207]
    v_exp_f32 v145, v145
    v_mfma_f32_16x16x32_bf16 v[208:211], a[248:251], a[140:143], v[208:211]
    s_waitcnt lgkmcnt(3)
    ds_read_b128 a[248:251], v224 offset:3072
    v_cvt_pk_bf16_f32 v176, v144, v145
    v_mfma_f32_16x16x32_bf16 v[212:215], a[0:3], a[252:255], 0
    v_exp_f32 v146, v146
    v_mfma_f32_16x16x32_bf16 v[216:219], a[4:7], a[252:255], 0
    v_cvt_pk_bf16_f32 v84, v200, v201
    v_cvt_pk_bf16_f32 v85, v202, v203
    v_mfma_f32_16x16x32_bf16 v[220:223], a[8:11], a[252:255], 0
    v_cvt_pk_bf16_f32 v106, v204, v205
    v_cvt_pk_bf16_f32 v107, v206, v207
    v_mfma_f32_16x16x32_bf16 v[200:203], a[252:255], a[72:75], 0
    v_cvt_pk_bf16_f32 v128, v208, v209
    v_cvt_pk_bf16_f32 v129, v210, v211
    v_mfma_f32_16x16x32_bf16 v[204:207], a[252:255], a[76:79], 0
    v_exp_f32 v147, v147
    v_mfma_f32_16x16x32_bf16 v[208:211], a[252:255], a[80:83], 0
    ds_read_b128 a[252:255], v224 offset:3136
    v_cvt_pk_bf16_f32 v177, v146, v147
    v_mfma_f32_16x16x32_bf16 v[212:215], a[12:15], v[252:255], v[212:215]
    ds_read_b128 v[144:147], v228 offset:1280
    v_fma_f32 v150, v150, s37, -v250
    v_mfma_f32_16x16x32_bf16 v[216:219], a[16:19], v[252:255], v[216:219]
    v_fma_f32 v151, v151, s37, -v250
    v_fma_f32 v152, v152, s37, -v250
    v_mfma_f32_16x16x32_bf16 v[220:223], a[20:23], v[252:255], v[220:223]
    v_exp_f32 v148, v148
    v_mfma_f32_16x16x32_bf16 v[200:203], v[252:255], a[84:87], v[200:203]
    v_exp_f32 v149, v149
    v_mfma_f32_16x16x32_bf16 v[204:207], v[252:255], a[88:91], v[204:207]
    v_exp_f32 v150, v150
    v_mfma_f32_16x16x32_bf16 v[208:211], v[252:255], a[92:95], v[208:211]
    ds_read_b128 v[252:255], v224 offset:3200
    v_cvt_pk_bf16_f32 v178, v148, v149
    v_mfma_f32_16x16x32_bf16 v[212:215], a[24:27], a[232:235], v[212:215]
    v_exp_f32 v151, v151
    v_mfma_f32_16x16x32_bf16 v[216:219], a[28:31], a[232:235], v[216:219]
    v_cvt_pk_bf16_f32 v179, v150, v151
    v_fma_f32 v153, v153, s37, -v250
    v_mfma_f32_16x16x32_bf16 v[220:223], a[32:35], a[232:235], v[220:223]
    ds_read_b128 v[148:151], v229 offset:1280
    v_fma_f32 v154, v154, s37, -v250
    v_mfma_f32_16x16x32_bf16 v[196:199], a[216:219], v[176:179], 0
    v_fma_f32 v155, v155, s37, -v250
    v_fma_f32 v156, v156, s37, -v250
    v_mfma_f32_16x16x32_bf16 v[184:187], v[68:71], v[176:179], 0
    v_exp_f32 v152, v152
    v_mfma_f32_16x16x32_bf16 v[188:191], v[90:93], v[176:179], 0
    v_exp_f32 v153, v153
    v_mfma_f32_16x16x32_bf16 v[192:195], v[112:115], v[176:179], 0
    s_waitcnt lgkmcnt(2)
    v_exp_f32 v154, v154
    v_mfma_f32_16x16x32_bf16 v[144:147], v[12:15], v[132:135], v[144:147]
    v_exp_f32 v155, v155
    v_mfma_f32_16x16x32_bf16 v[200:203], a[232:235], a[96:99], v[200:203]
    v_cvt_pk_bf16_f32 v180, v152, v153
    v_cvt_pk_bf16_f32 v181, v154, v155
    v_mfma_f32_16x16x32_bf16 v[204:207], a[232:235], a[100:103], v[204:207]
    ds_read_b128 v[152:155], v229 offset:1920
    v_fma_f32 v157, v157, s37, -v250
    v_mfma_f32_16x16x16_bf16 v[144:147], v[16:17], v[136:137], v[144:147]
    v_fma_f32 v158, v158, s37, -v250
    v_fma_f32 v159, v159, s37, -v250
    v_mfma_f32_16x16x32_bf16 v[208:211], a[232:235], a[104:107], v[208:211]
    s_waitcnt lgkmcnt(1)
    ds_read_b128 a[232:235], v224 offset:3264
    v_fma_f32 v160, v160, s37, -v250
    v_mfma_f32_16x16x32_bf16 v[148:151], v[36:39], v[132:135], v[148:151]
    v_exp_f32 v156, v156
    v_mfma_f32_16x16x32_bf16 v[212:215], a[36:39], a[236:239], v[212:215]
    v_exp_f32 v157, v157
    v_mfma_f32_16x16x32_bf16 v[216:219], a[40:43], a[236:239], v[216:219]
    v_exp_f32 v158, v158
    v_mfma_f32_16x16x32_bf16 v[220:223], a[44:47], a[236:239], v[220:223]
    v_exp_f32 v159, v159
    v_mfma_f32_16x16x16_bf16 v[148:151], v[40:41], v[136:137], v[148:151]
    v_cvt_pk_bf16_f32 v182, v156, v157
    v_cvt_pk_bf16_f32 v183, v158, v159
    v_mfma_f32_16x16x32_bf16 v[200:203], a[236:239], a[108:111], v[200:203]
    ds_read_b128 v[156:159], v228 offset:1920
    v_fma_f32 v161, v161, s37, -v250
    v_mfma_f32_16x16x32_bf16 v[196:199], a[216:219], v[180:183], v[196:199]
    v_fma_f32 v162, v162, s37, -v250
    v_fma_f32 v163, v163, s37, -v250
    v_mfma_f32_16x16x32_bf16 v[184:187], v[76:79], v[180:183], v[184:187]
    v_exp_f32 v160, v160
    v_mfma_f32_16x16x32_bf16 v[188:191], v[98:101], v[180:183], v[188:191]
    v_exp_f32 v161, v161
    v_mfma_f32_16x16x32_bf16 v[192:195], v[120:123], v[180:183], v[192:195]
    s_waitcnt lgkmcnt(1)
    v_exp_f32 v162, v162
    v_mfma_f32_16x16x32_bf16 v[152:155], v[42:45], v[132:135], v[152:155]
    v_exp_f32 v163, v163
    v_mfma_f32_16x16x32_bf16 v[204:207], a[236:239], a[112:115], v[204:207]
    v_cvt_pk_bf16_f32 v176, v160, v161
    v_cvt_pk_bf16_f32 v177, v162, v163
    v_mfma_f32_16x16x32_bf16 v[208:211], a[236:239], a[116:119], v[208:211]
    ds_read_b128 a[236:239], v224 offset:3328
    ds_read_b128 v[160:163], v236
    v_mfma_f32_16x16x16_bf16 v[152:155], v[46:47], v[136:137], v[152:155]
    v_bfe_u32 v236, s66, v233, 4
    v_mad_u32_u24 v236, v236, s40, v231
    v_mfma_f32_16x16x32_bf16 v[212:215], a[48:51], a[240:243], v[212:215]
    s_waitcnt lgkmcnt(2)
    v_fma_f32 v164, v164, s37, -v250
    v_fma_f32 v165, v165, s37, -v250
    v_mfma_f32_16x16x32_bf16 v[156:159], v[18:21], v[132:135], v[156:159]
    v_fma_f32 v166, v166, s37, -v250
    v_fma_f32 v167, v167, s37, -v250
    v_mfma_f32_16x16x32_bf16 v[216:219], a[52:55], a[240:243], v[216:219]
    v_exp_f32 v164, v164
    v_mfma_f32_16x16x32_bf16 v[220:223], a[56:59], a[240:243], v[220:223]
    v_exp_f32 v165, v165
    v_mfma_f32_16x16x16_bf16 v[156:159], v[22:23], v[136:137], v[156:159]
    v_exp_f32 v166, v166
    v_mfma_f32_16x16x32_bf16 v[200:203], a[240:243], a[120:123], v[200:203]
    v_exp_f32 v167, v167
    v_mfma_f32_16x16x32_bf16 v[204:207], a[240:243], a[124:127], v[204:207]
    v_cvt_pk_bf16_f32 v178, v164, v165
    v_cvt_pk_bf16_f32 v179, v166, v167
    v_mfma_f32_16x16x32_bf16 v[208:211], a[240:243], a[128:131], v[208:211]
    ds_read_b128 a[240:243], v224 offset:3392
    ds_read_b128 v[164:167], v235
    v_mfma_f32_16x16x32_bf16 v[196:199], a[216:219], v[176:179], v[196:199]
    v_bfe_u32 v235, s65, v232, 4
    v_mad_u32_u24 v235, v235, s40, v230
    v_mfma_f32_16x16x32_bf16 v[184:187], v[82:85], v[176:179], v[184:187]
    v_max3_f32 v248, v168, v169, v170
    v_max3_f32 v249, v171, v172, v173
    v_mfma_f32_16x16x32_bf16 v[188:191], v[104:107], v[176:179], v[188:191]
    v_max3_f32 v248, v248, v174, v175
    v_max3_f32 v249, v249, v144, v145
    v_mfma_f32_16x16x32_bf16 v[192:195], v[126:129], v[176:179], v[192:195]
    v_rcp_f32 v197, v196
    v_mfma_f32_16x16x32_bf16 v[212:215], a[60:63], a[244:247], v[212:215]
    v_mul_f32 v184, v184, v197
    v_mul_f32 v185, v185, v197
    v_mfma_f32_16x16x32_bf16 v[216:219], a[64:67], a[244:247], v[216:219]
    v_cvt_pk_bf16_f32 v184, v184, v185
    v_mul_f32 v186, v186, v197
    v_mfma_f32_16x16x32_bf16 v[220:223], a[68:71], a[244:247], v[220:223]
    v_mul_f32 v187, v187, v197
    v_cvt_pk_bf16_f32 v185, v186, v187
    v_mfma_f32_16x16x32_bf16 v[200:203], a[244:247], a[132:135], v[200:203]
    v_cvt_pk_bf16_f32 v0, v212, v213
    v_cvt_pk_bf16_f32 v1, v214, v215
    v_mfma_f32_16x16x32_bf16 v[204:207], a[244:247], a[136:139], v[204:207]
    v_cvt_pk_bf16_f32 v2, v216, v217
    v_cvt_pk_bf16_f32 v3, v218, v219
    v_mfma_f32_16x16x32_bf16 v[208:211], a[244:247], a[140:143], v[208:211]
    s_waitcnt lgkmcnt(1)
    v_cvt_pk_bf16_f32 v4, v220, v221
    v_cvt_pk_bf16_f32 v5, v222, v223
    v_mfma_f32_16x16x32_bf16 v[160:163], v[0:3], v[132:135], v[160:163]
    v_cvt_pk_bf16_f32 v66, v200, v201
    v_cvt_pk_bf16_f32 v67, v202, v203
    v_mfma_f32_16x16x32_bf16 v[212:215], a[0:3], a[248:251], 0
    v_cvt_pk_bf16_f32 v88, v204, v205
    v_cvt_pk_bf16_f32 v89, v206, v207
    v_mfma_f32_16x16x32_bf16 v[216:219], a[4:7], a[248:251], 0
    v_cvt_pk_bf16_f32 v110, v208, v209
    v_cvt_pk_bf16_f32 v111, v210, v211
    v_mfma_f32_16x16x16_bf16 v[160:163], v[4:5], v[136:137], v[160:163]
    v_mul_f32 v188, v188, v197
    v_mul_f32 v189, v189, v197
    v_mfma_f32_16x16x32_bf16 v[220:223], a[8:11], a[248:251], 0
    v_cvt_pk_bf16_f32 v186, v188, v189
    v_mul_f32 v190, v190, v197
    v_mfma_f32_16x16x32_bf16 v[200:203], a[248:251], a[72:75], 0
    v_mul_f32 v191, v191, v197
    v_cvt_pk_bf16_f32 v187, v190, v191
    v_mfma_f32_16x16x32_bf16 v[204:207], a[248:251], a[76:79], 0
    v_mul_f32 v192, v192, v197
    v_mul_f32 v193, v193, v197
    v_mfma_f32_16x16x32_bf16 v[208:211], a[248:251], a[80:83], 0
    v_cvt_pk_bf16_f32 v188, v192, v193
    v_mul_f32 v194, v194, v197
    v_mfma_f32_16x16x32_bf16 v[212:215], a[12:15], a[252:255], v[212:215]
    ds_read_b128 a[244:247], v225 offset:42944
    v_mul_f32 v195, v195, v197
    v_mfma_f32_16x16x32_bf16 v[216:219], a[16:19], a[252:255], v[216:219]
    ds_read_b128 a[248:251], v225 offset:43008
    v_cvt_pk_bf16_f32 v189, v194, v195
    v_mfma_f32_16x16x32_bf16 v[220:223], a[20:23], a[252:255], v[220:223]
    ds_write_b128 v237, v[184:187] offset:6144
    v_mfma_f32_16x16x32_bf16 v[200:203], a[252:255], a[84:87], v[200:203]
    ds_write_b64 v238, v[188:189] offset:6144
    v_mfma_f32_16x16x32_bf16 v[204:207], a[252:255], a[88:91], v[204:207]
    v_max3_f32 v248, v248, v146, v147
    v_max3_f32 v249, v249, v148, v149
    v_mfma_f32_16x16x32_bf16 v[208:211], a[252:255], a[92:95], v[208:211]
    ds_read_b128 a[252:255], v225 offset:43072
    v_max3_f32 v248, v248, v150, v151
    v_mfma_f32_16x16x32_bf16 v[212:215], a[24:27], v[252:255], v[212:215]
    v_max3_f32 v249, v249, v152, v153
    v_max3_f32 v248, v248, v154, v155
    v_mfma_f32_16x16x32_bf16 v[216:219], a[28:31], v[252:255], v[216:219]
    v_max3_f32 v249, v249, v156, v157
    v_max3_f32 v248, v248, v158, v159
    v_mfma_f32_16x16x32_bf16 v[220:223], a[32:35], v[252:255], v[220:223]
    v_max3_f32 v249, v249, v160, v161
    v_max3_f32 v248, v248, v162, v163
    v_mfma_f32_16x16x32_bf16 v[200:203], v[252:255], a[96:99], v[200:203]
    v_mfma_f32_16x16x32_bf16 v[204:207], v[252:255], a[100:103], v[204:207]
    v_mfma_f32_16x16x32_bf16 v[208:211], v[252:255], a[104:107], v[208:211]
    ds_read_b128 v[252:255], v225 offset:43136
    v_mfma_f32_16x16x32_bf16 v[212:215], a[36:39], a[232:235], v[212:215]
    v_mfma_f32_16x16x32_bf16 v[216:219], a[40:43], a[232:235], v[216:219]
    v_mfma_f32_16x16x32_bf16 v[220:223], a[44:47], a[232:235], v[220:223]
    v_mfma_f32_16x16x32_bf16 v[200:203], a[232:235], a[108:111], v[200:203]
    v_mfma_f32_16x16x32_bf16 v[204:207], a[232:235], a[112:115], v[204:207]
    v_mfma_f32_16x16x32_bf16 v[208:211], a[232:235], a[116:119], v[208:211]
    ds_read_b128 a[232:235], v225 offset:43200
    v_mfma_f32_16x16x32_bf16 v[212:215], a[48:51], a[236:239], v[212:215]
    v_mfma_f32_16x16x32_bf16 v[216:219], a[52:55], a[236:239], v[216:219]
    v_mfma_f32_16x16x32_bf16 v[220:223], a[56:59], a[236:239], v[220:223]
    v_mfma_f32_16x16x32_bf16 v[200:203], a[236:239], a[120:123], v[200:203]
    v_mfma_f32_16x16x32_bf16 v[204:207], a[236:239], a[124:127], v[204:207]
    v_mfma_f32_16x16x32_bf16 v[208:211], a[236:239], a[128:131], v[208:211]
    ds_read_b128 a[236:239], v225 offset:43264
    v_mfma_f32_16x16x32_bf16 v[212:215], a[60:63], a[240:243], v[212:215]
    v_mfma_f32_16x16x32_bf16 v[216:219], a[64:67], a[240:243], v[216:219]
    v_mfma_f32_16x16x32_bf16 v[220:223], a[68:71], a[240:243], v[220:223]
    v_mfma_f32_16x16x32_bf16 v[200:203], a[240:243], a[132:135], v[200:203]
    v_mfma_f32_16x16x32_bf16 v[204:207], a[240:243], a[136:139], v[204:207]
    v_mfma_f32_16x16x32_bf16 v[208:211], a[240:243], a[140:143], v[208:211]
    s_waitcnt lgkmcnt(1)
    ds_read_b128 a[240:243], v226 offset:1152
    s_nop 1
    v_cvt_pk_bf16_f32 v24, v212, v213
    v_cvt_pk_bf16_f32 v25, v214, v215
    v_mfma_f32_16x16x32_bf16 v[212:215], a[144:147], a[244:247], 0
    s_waitcnt vmcnt(0) lgkmcnt(1)
    v_cvt_pk_bf16_f32 v26, v216, v217
    v_cvt_pk_bf16_f32 v27, v218, v219
    v_mfma_f32_16x16x32_bf16 v[216:219], a[148:151], a[244:247], 0
    s_barrier
    v_cvt_pk_bf16_f32 v28, v220, v221
    v_cvt_pk_bf16_f32 v29, v222, v223
    v_mfma_f32_16x16x32_bf16 v[164:167], v[24:27], v[132:135], v[164:167]
    v_cvt_pk_bf16_f32 v68, v200, v201
    v_cvt_pk_bf16_f32 v69, v202, v203
    v_mfma_f32_16x16x32_bf16 v[220:223], a[152:155], a[244:247], 0
    v_cvt_pk_bf16_f32 v90, v204, v205
    v_cvt_pk_bf16_f32 v91, v206, v207
    v_mfma_f32_16x16x32_bf16 v[212:215], a[156:159], a[248:251], v[212:215]
    v_cvt_pk_bf16_f32 v112, v208, v209
    v_cvt_pk_bf16_f32 v113, v210, v211
    v_mfma_f32_16x16x16_bf16 v[164:167], v[28:29], v[136:137], v[164:167]
    ds_read_b128 a[244:247], v226 offset:1216
    v_mfma_f32_16x16x32_bf16 v[216:219], a[160:163], a[248:251], v[216:219]
    buffer_load_dwordx4 v246, s[4:7], s56 offen lds
    v_mfma_f32_16x16x32_bf16 v[220:223], a[164:167], a[248:251], v[220:223]
    s_add_u32 m0, s42, 0x7900
    ds_read_b128 a[248:251], v226 offset:1280
    v_mfma_f32_16x16x32_bf16 v[212:215], a[168:171], a[252:255], v[212:215]
    buffer_load_dwordx4 v247, s[4:7], s56 offen lds
    v_mfma_f32_16x16x32_bf16 v[216:219], a[172:175], a[252:255], v[216:219]
    s_add_u32 s56, s39, 0x222000
    v_max3_f32 v249, v249, v164, v165
    v_max3_f32 v248, v248, v166, v167
    v_mfma_f32_16x16x32_bf16 v[220:223], a[176:179], a[252:255], v[220:223]
    s_add_u32 m0, s41, 0x9740
    ds_read_b128 a[252:255], v226 offset:1344
    v_max_f32 v248, v248, v249
    v_mfma_f32_16x16x32_bf16 v[212:215], a[180:183], v[252:255], v[212:215]
    buffer_load_dwordx4 v246, s[4:7], s56 offen lds
    v_mfma_f32_16x16x32_bf16 v[216:219], a[184:187], v[252:255], v[216:219]
    s_add_u32 m0, s42, 0x9740
    v_mov_b32 v249, v248
    v_mfma_f32_16x16x32_bf16 v[220:223], a[188:191], v[252:255], v[220:223]
    ds_read_b128 v[252:255], v226 offset:1408
    v_mfma_f32_16x16x32_bf16 v[212:215], a[192:195], a[232:235], v[212:215]
    buffer_load_dwordx4 v247, s[4:7], s56 offen lds
    v_mfma_f32_16x16x32_bf16 v[216:219], a[196:199], a[232:235], v[216:219]
    s_add_u32 s56, s39, 0x24c000
    v_permlane16_swap_b32 v248, v249
    v_mfma_f32_16x16x32_bf16 v[220:223], a[200:203], a[232:235], v[220:223]
    s_add_u32 m0, s41, 0xb580
    ds_read_b128 a[232:235], v226 offset:1472
    v_max_f32 v248, v248, v249
    v_mfma_f32_16x16x32_bf16 v[212:215], a[204:207], a[236:239], v[212:215]
    v_mov_b32 v249, v248
    v_mfma_f32_16x16x32_bf16 v[216:219], a[208:211], a[236:239], v[216:219]
    v_mfma_f32_16x16x32_bf16 v[220:223], a[212:215], a[236:239], v[220:223]
    s_waitcnt lgkmcnt(3)
    ds_read_b128 a[236:239], v227 offset:6144
    v_mfma_f32_16x16x32_bf16 v[200:203], a[144:147], a[240:243], 0
    v_permlane32_swap_b32 v248, v249
    v_mfma_f32_16x16x32_bf16 v[204:207], a[148:151], a[240:243], 0
    v_max_f32 v248, v248, v249
    v_cvt_pk_bf16_f32 v138, v212, v213
    v_mfma_f32_16x16x32_bf16 v[208:211], a[152:155], a[240:243], 0
    v_cvt_pk_bf16_f32 v139, v214, v215
    v_cvt_pk_bf16_f32 v140, v216, v217
    v_mfma_f32_16x16x32_bf16 v[200:203], a[156:159], a[244:247], v[200:203]
    v_cvt_pk_bf16_f32 v141, v218, v219
    v_cvt_pk_bf16_f32 v142, v220, v221
    v_mfma_f32_16x16x32_bf16 v[204:207], a[160:163], a[244:247], v[204:207]
    ds_read_b128 a[240:243], v227 offset:6208
    v_cvt_pk_bf16_f32 v143, v222, v223
    v_mfma_f32_16x16x32_bf16 v[208:211], a[164:167], a[244:247], v[208:211]
    ds_read_b128 a[244:247], v227 offset:6272
    v_mul_f32 v250, s37, v248
    v_mfma_f32_16x16x32_bf16 v[200:203], a[168:171], a[248:251], v[200:203]
    v_fma_f32 v168, v168, s37, -v250
    v_fma_f32 v169, v169, s37, -v250
    v_mfma_f32_16x16x32_bf16 v[204:207], a[172:175], a[248:251], v[204:207]
    v_fma_f32 v170, v170, s37, -v250
    v_fma_f32 v171, v171, s37, -v250
    v_mfma_f32_16x16x32_bf16 v[208:211], a[176:179], a[248:251], v[208:211]
    s_waitcnt lgkmcnt(3)
    ds_read_b128 a[248:251], v227 offset:6336
    v_fma_f32 v172, v172, s37, -v250
    v_mfma_f32_16x16x32_bf16 v[200:203], a[180:183], a[252:255], v[200:203]
    v_exp_f32 v168, v168
    v_mfma_f32_16x16x32_bf16 v[204:207], a[184:187], a[252:255], v[204:207]
    v_exp_f32 v169, v169
    v_mfma_f32_16x16x32_bf16 v[208:211], a[188:191], a[252:255], v[208:211]
    ds_read_b128 a[252:255], v227 offset:6400
    v_cvt_pk_bf16_f32 v180, v168, v169
    v_mfma_f32_16x16x32_bf16 v[200:203], a[192:195], v[252:255], v[200:203]
    v_exp_f32 v170, v170
    v_mfma_f32_16x16x32_bf16 v[204:207], a[196:199], v[252:255], v[204:207]
    v_exp_f32 v171, v171
    v_mfma_f32_16x16x32_bf16 v[208:211], a[200:203], v[252:255], v[208:211]
    ds_read_b128 v[252:255], v227 offset:6464
    v_cvt_pk_bf16_f32 v181, v170, v171
    v_mfma_f32_16x16x32_bf16 v[200:203], a[204:207], a[232:235], v[200:203]
    ds_read_b128 v[168:171], v234
    v_bfe_u32 v234, s67, v233, 4
    v_mfma_f32_16x16x32_bf16 v[204:207], a[208:211], a[232:235], v[204:207]
    v_mad_u32_u24 v234, v234, s40, v231
    v_fma_f32 v173, v173, s37, -v250
    v_mfma_f32_16x16x32_bf16 v[208:211], a[212:215], a[232:235], v[208:211]
    s_waitcnt lgkmcnt(4)
    ds_read_b128 a[232:235], v239
    v_fma_f32 v174, v174, s37, -v250
    v_mfma_f32_16x16x32_bf16 v[212:215], a[0:3], a[236:239], 0
    v_cvt_pk_bf16_f32 v132, v200, v201
    v_cvt_pk_bf16_f32 v133, v202, v203
    v_mfma_f32_16x16x32_bf16 v[216:219], a[4:7], a[236:239], 0
    v_cvt_pk_bf16_f32 v134, v204, v205
    v_cvt_pk_bf16_f32 v135, v206, v207
    v_mfma_f32_16x16x32_bf16 v[220:223], a[8:11], a[236:239], 0
    v_cvt_pk_bf16_f32 v136, v208, v209
    v_cvt_pk_bf16_f32 v137, v210, v211
    v_mfma_f32_16x16x32_bf16 v[200:203], a[236:239], a[72:75], 0
    v_fma_f32 v175, v175, s37, -v250
    v_fma_f32 v144, v144, s37, -v250
    v_mfma_f32_16x16x32_bf16 v[204:207], a[236:239], a[76:79], 0
    v_exp_f32 v172, v172
    v_mfma_f32_16x16x32_bf16 v[208:211], a[236:239], a[80:83], 0
    ds_read_b128 a[236:239], v239 offset:6144
    v_fma_f32 v145, v145, s37, -v250
    v_mfma_f32_16x16x32_bf16 v[212:215], a[12:15], a[240:243], v[212:215]
    s_waitcnt lgkmcnt(2)
    v_exp_f32 v173, v173
    v_mfma_f32_16x16x32_bf16 v[168:171], v[24:27], v[138:141], v[168:171]
    v_exp_f32 v174, v174
    v_mfma_f32_16x16x32_bf16 v[216:219], a[16:19], a[240:243], v[216:219]
    v_exp_f32 v175, v175
    v_mfma_f32_16x16x32_bf16 v[220:223], a[20:23], a[240:243], v[220:223]
    v_cvt_pk_bf16_f32 v182, v172, v173
    v_cvt_pk_bf16_f32 v183, v174, v175
    v_mfma_f32_16x16x16_bf16 v[168:171], v[28:29], v[142:143], v[168:171]
    ds_read_b128 v[172:175], v235
    v_bfe_u32 v235, s68, v233, 4
    v_mfma_f32_16x16x32_bf16 v[196:199], a[216:219], v[180:183], 0
    v_mad_u32_u24 v235, v235, s40, v231
    v_fma_f32 v146, v146, s37, -v250
    v_mfma_f32_16x16x32_bf16 v[184:187], v[70:73], v[180:183], 0
    v_fma_f32 v147, v147, s37, -v250
    v_fma_f32 v148, v148, s37, -v250
    v_mfma_f32_16x16x32_bf16 v[188:191], v[92:95], v[180:183], 0
    v_exp_f32 v144, v144
    v_mfma_f32_16x16x32_bf16 v[192:195], v[114:117], v[180:183], 0
    v_exp_f32 v145, v145
    v_mfma_f32_16x16x32_bf16 v[200:203], a[240:243], a[84:87], v[200:203]
    v_exp_f32 v146, v146
    v_mfma_f32_16x16x32_bf16 v[204:207], a[240:243], a[88:91], v[204:207]
    v_exp_f32 v147, v147
    v_mfma_f32_16x16x32_bf16 v[208:211], a[240:243], a[92:95], v[208:211]
    ds_read_b128 a[240:243], v239 offset:1024
    v_cvt_pk_bf16_f32 v176, v144, v145
    v_mfma_f32_16x16x32_bf16 v[212:215], a[24:27], a[244:247], v[212:215]
    v_cvt_pk_bf16_f32 v177, v146, v147
    v_fma_f32 v149, v149, s37, -v250
    v_mfma_f32_16x16x32_bf16 v[216:219], a[28:31], a[244:247], v[216:219]
    s_waitcnt lgkmcnt(1)
    ds_read_b128 v[144:147], v230 offset:1280
    v_fma_f32 v150, v150, s37, -v250
    v_mfma_f32_16x16x32_bf16 v[172:175], v[30:33], v[138:141], v[172:175]
    v_fma_f32 v151, v151, s37, -v250
    v_fma_f32 v152, v152, s37, -v250
    v_mfma_f32_16x16x32_bf16 v[220:223], a[32:35], a[244:247], v[220:223]
    v_exp_f32 v148, v148
    v_mfma_f32_16x16x32_bf16 v[200:203], a[244:247], a[96:99], v[200:203]
    v_exp_f32 v149, v149
    v_mfma_f32_16x16x16_bf16 v[172:175], v[34:35], v[142:143], v[172:175]
    v_exp_f32 v150, v150
    v_mfma_f32_16x16x32_bf16 v[204:207], a[244:247], a[100:103], v[204:207]
    v_exp_f32 v151, v151
    v_mfma_f32_16x16x32_bf16 v[208:211], a[244:247], a[104:107], v[208:211]
    ds_read_b128 a[244:247], v239 offset:7168
    v_cvt_pk_bf16_f32 v178, v148, v149
    v_mfma_f32_16x16x32_bf16 v[212:215], a[36:39], a[248:251], v[212:215]
    v_cvt_pk_bf16_f32 v179, v150, v151
    v_fma_f32 v153, v153, s37, -v250
    v_mfma_f32_16x16x32_bf16 v[216:219], a[40:43], a[248:251], v[216:219]
    ds_read_b128 v[148:151], v230 offset:1920
    v_fma_f32 v154, v154, s37, -v250
    v_mfma_f32_16x16x32_bf16 v[196:199], a[216:219], v[176:179], v[196:199]
    v_fma_f32 v155, v155, s37, -v250
    v_fma_f32 v156, v156, s37, -v250
    v_mfma_f32_16x16x32_bf16 v[184:187], v[74:77], v[176:179], v[184:187]
    v_exp_f32 v152, v152
    v_mfma_f32_16x16x32_bf16 v[188:191], v[96:99], v[176:179], v[188:191]
    v_exp_f32 v153, v153
    v_mfma_f32_16x16x32_bf16 v[192:195], v[118:121], v[176:179], v[192:195]
    s_waitcnt lgkmcnt(2)
    v_exp_f32 v154, v154
    v_mfma_f32_16x16x32_bf16 v[144:147], v[36:39], v[138:141], v[144:147]
    v_exp_f32 v155, v155
    v_mfma_f32_16x16x32_bf16 v[220:223], a[44:47], a[248:251], v[220:223]
    v_cvt_pk_bf16_f32 v180, v152, v153
    v_cvt_pk_bf16_f32 v181, v154, v155
    v_mfma_f32_16x16x32_bf16 v[200:203], a[248:251], a[108:111], v[200:203]
    ds_read_b128 v[152:155], v236
    v_bfe_u32 v236, s69, v233, 4
    v_mfma_f32_16x16x16_bf16 v[144:147], v[40:41], v[142:143], v[144:147]
    v_mad_u32_u24 v236, v236, s40, v231
    v_fma_f32 v157, v157, s37, -v250
    v_mfma_f32_16x16x32_bf16 v[204:207], a[248:251], a[112:115], v[204:207]
    s_waitcnt lgkmcnt(1)
    v_fma_f32 v158, v158, s37, -v250
    v_fma_f32 v159, v159, s37, -v250
    v_mfma_f32_16x16x32_bf16 v[148:151], v[42:45], v[138:141], v[148:151]
    v_exp_f32 v156, v156
    v_mfma_f32_16x16x32_bf16 v[208:211], a[248:251], a[116:119], v[208:211]
    ds_read_b64_tr_b16 a[248:249], v240 offset:12288
    ds_read_b64_tr_b16 a[250:251], v240 offset:26112
    v_mfma_f32_16x16x32_bf16 v[212:215], a[48:51], a[252:255], v[212:215]
    v_exp_f32 v157, v157
    v_mfma_f32_16x16x16_bf16 v[148:151], v[46:47], v[142:143], v[148:151]
    v_exp_f32 v158, v158
    v_mfma_f32_16x16x32_bf16 v[216:219], a[52:55], a[252:255], v[216:219]
    v_exp_f32 v159, v159
    v_mfma_f32_16x16x32_bf16 v[220:223], a[56:59], a[252:255], v[220:223]
    v_cvt_pk_bf16_f32 v182, v156, v157
    v_cvt_pk_bf16_f32 v183, v158, v159
    v_mfma_f32_16x16x32_bf16 v[200:203], a[252:255], a[120:123], v[200:203]
    ds_read_b128 v[156:159], v234
    v_bfe_u32 v234, s70, v233, 4
    v_mfma_f32_16x16x32_bf16 v[196:199], a[216:219], v[180:183], v[196:199]
    v_mad_u32_u24 v234, v234, s40, v231
    v_fma_f32 v160, v160, s37, -v250
    v_mfma_f32_16x16x32_bf16 v[184:187], v[78:81], v[180:183], v[184:187]
    v_fma_f32 v161, v161, s37, -v250
    v_fma_f32 v162, v162, s37, -v250
    v_mfma_f32_16x16x32_bf16 v[188:191], v[100:103], v[180:183], v[188:191]
    v_fma_f32 v163, v163, s37, -v250
    v_fma_f32 v164, v164, s37, -v250
    v_mfma_f32_16x16x32_bf16 v[192:195], v[122:125], v[180:183], v[192:195]
    s_waitcnt lgkmcnt(3)
    v_exp_f32 v160, v160
    v_mfma_f32_16x16x32_bf16 v[152:155], v[48:51], v[138:141], v[152:155]
    v_exp_f32 v161, v161
    v_mfma_f32_16x16x32_bf16 v[204:207], a[252:255], a[124:127], v[204:207]
    v_exp_f32 v162, v162
    v_mfma_f32_16x16x32_bf16 v[208:211], a[252:255], a[128:131], v[208:211]
    ds_read_b64_tr_b16 a[252:253], v240 offset:12296
    ds_read_b64_tr_b16 a[254:255], v240 offset:26120
    v_mfma_f32_16x16x16_bf16 v[152:155], v[52:53], v[142:143], v[152:155]
    v_exp_f32 v163, v163
    v_mfma_f32_16x16x32_bf16 v[212:215], a[60:63], v[252:255], v[212:215]
    s_waitcnt lgkmcnt(2)
    v_cvt_pk_bf16_f32 v176, v160, v161
    v_cvt_pk_bf16_f32 v177, v162, v163
    v_mfma_f32_16x16x32_bf16 v[156:159], v[54:57], v[138:141], v[156:159]
    ds_read_b128 v[160:163], v235
    v_bfe_u32 v235, s71, v233, 4
    v_mfma_f32_16x16x32_bf16 v[216:219], a[64:67], v[252:255], v[216:219]
    v_mad_u32_u24 v235, v235, s40, v231
    v_fma_f32 v165, v165, s37, -v250
    v_mfma_f32_16x16x32_bf16 v[220:223], a[68:71], v[252:255], v[220:223]
    v_cvt_pk_bf16_f32 v60, v212, v213
    v_cvt_pk_bf16_f32 v61, v214, v215
    v_mfma_f32_16x16x16_bf16 v[156:159], v[58:59], v[142:143], v[156:159]
    v_fma_f32 v166, v166, s37, -v250
    v_fma_f32 v167, v167, s37, -v250
    v_mfma_f32_16x16x32_bf16 v[200:203], v[252:255], a[132:135], v[200:203]
    v_cvt_pk_bf16_f32 v62, v216, v217
    v_cvt_pk_bf16_f32 v63, v218, v219
    v_mfma_f32_16x16x32_bf16 v[204:207], v[252:255], a[136:139], v[204:207]
    v_cvt_pk_bf16_f32 v64, v220, v221
    v_cvt_pk_bf16_f32 v65, v222, v223
    v_mfma_f32_16x16x32_bf16 v[208:211], v[252:255], a[140:143], v[208:211]
    ds_read_b64_tr_b16 v[252:253], v241 offset:12288
    ds_read_b64_tr_b16 v[254:255], v241 offset:26112
    v_mfma_f32_16x16x32_bf16 v[212:215], a[220:223], a[232:235], 0
    v_cvt_pk_bf16_f32 v86, v200, v201
    v_cvt_pk_bf16_f32 v87, v202, v203
    v_mfma_f32_16x16x32_bf16 v[200:203], a[220:223], a[236:239], 0
    v_cvt_pk_bf16_f32 v108, v204, v205
    v_cvt_pk_bf16_f32 v109, v206, v207
    v_mfma_f32_16x16x32_bf16 v[216:219], a[224:227], a[232:235], 0
    s_waitcnt lgkmcnt(2)
    v_cvt_pk_bf16_f32 v130, v208, v209
    v_cvt_pk_bf16_f32 v131, v210, v211
    v_mfma_f32_16x16x32_bf16 v[160:163], v[60:63], v[138:141], v[160:163]
    v_exp_f32 v164, v164
    v_mfma_f32_16x16x32_bf16 v[204:207], a[224:227], a[236:239], 0
    v_exp_f32 v165, v165
    v_mfma_f32_16x16x32_bf16 v[220:223], a[228:231], a[232:235], 0
    ds_read_b128 a[232:235], v239 offset:2048
    v_cvt_pk_bf16_f32 v178, v164, v165
    v_mfma_f32_16x16x16_bf16 v[160:163], v[64:65], v[142:143], v[160:163]
    v_exp_f32 v166, v166
    v_mfma_f32_16x16x32_bf16 v[208:211], a[228:231], a[236:239], 0
    ds_read_b128 a[236:239], v239 offset:8192
    v_max3_f32 v248, v168, v169, v170
    v_mfma_f32_16x16x32_bf16 v[212:215], a[248:251], a[240:243], v[212:215]
    v_exp_f32 v167, v167
    v_mfma_f32_16x16x32_bf16 v[200:203], a[248:251], a[244:247], v[200:203]
    ds_read_b64_tr_b16 a[248:249], v241 offset:13824
    ds_read_b64_tr_b16 a[250:251], v241 offset:24576
    v_mfma_f32_16x16x32_bf16 v[216:219], a[252:255], a[240:243], v[216:219]
    v_cvt_pk_bf16_f32 v179, v166, v167
    v_max3_f32 v249, v171, v172, v173
    v_mfma_f32_16x16x32_bf16 v[204:207], a[252:255], a[244:247], v[204:207]
    ds_read_b128 a[252:255], v239 offset:3072
    ds_read_b128 v[164:167], v228 offset:640
    v_mfma_f32_16x16x32_bf16 v[196:199], a[216:219], v[176:179], v[196:199]
    v_max3_f32 v248, v248, v174, v175
    v_max3_f32 v249, v249, v144, v145
    v_mfma_f32_16x16x32_bf16 v[184:187], v[66:69], v[176:179], v[184:187]
    v_max3_f32 v248, v248, v146, v147
    v_max3_f32 v249, v249, v148, v149
    v_mfma_f32_16x16x32_bf16 v[188:191], v[88:91], v[176:179], v[188:191]
    v_max3_f32 v248, v248, v150, v151
    v_max3_f32 v249, v249, v152, v153
    v_mfma_f32_16x16x32_bf16 v[192:195], v[110:113], v[176:179], v[192:195]
    s_waitcnt lgkmcnt(5)
    v_rcp_f32 v197, v196
    v_mfma_f32_16x16x32_bf16 v[220:223], v[252:255], a[240:243], v[220:223]
    ds_read_b64_tr_b16 a[240:241], v240 offset:13824
    ds_read_b64_tr_b16 a[242:243], v240 offset:24576
    v_mfma_f32_16x16x32_bf16 v[208:211], v[252:255], a[244:247], v[208:211]
    s_waitcnt lgkmcnt(4)
    ds_read_b64_tr_b16 a[244:245], v240 offset:13832
    ds_read_b64_tr_b16 a[246:247], v240 offset:24584
    v_mfma_f32_16x16x32_bf16 v[220:223], a[248:251], a[232:235], v[220:223]
    ds_read_b128 v[252:255], v239 offset:9216
    v_mul_f32 v184, v184, v197
    v_mfma_f32_16x16x32_bf16 v[208:211], a[248:251], a[236:239], v[208:211]
    s_waitcnt lgkmcnt(5)
    ds_read_b128 a[248:251], v239 offset:10240
    v_mul_f32 v185, v185, v197
    v_cvt_pk_bf16_f32 v184, v184, v185
    v_mul_f32 v186, v186, v197
    v_mul_f32 v187, v187, v197
    v_cvt_pk_bf16_f32 v185, v186, v187
    v_mul_f32 v188, v188, v197
    v_mul_f32 v189, v189, v197
    v_mfma_f32_16x16x32_bf16 v[164:167], v[12:15], v[132:135], v[164:167]
    v_cvt_pk_bf16_f32 v186, v188, v189
    v_mul_f32 v190, v190, v197
    v_mul_f32 v191, v191, v197
    v_cvt_pk_bf16_f32 v187, v190, v191
    v_mul_f32 v192, v192, v197
    v_mul_f32 v193, v193, v197
    v_mfma_f32_16x16x16_bf16 v[164:167], v[16:17], v[136:137], v[164:167]
    s_waitcnt lgkmcnt(4)
    v_cvt_pk_bf16_f32 v188, v192, v193
    v_mul_f32 v194, v194, v197
    v_mul_f32 v195, v195, v197
    v_cvt_pk_bf16_f32 v189, v194, v195
    ds_write_b128 v237, v[184:187] offset:12288
    v_mfma_f32_16x16x32_bf16 v[212:215], a[240:243], a[232:235], v[212:215]
    ds_write_b64 v238, v[188:189] offset:12288
    v_mfma_f32_16x16x32_bf16 v[200:203], a[240:243], a[236:239], v[200:203]
    s_waitcnt lgkmcnt(4)
    ds_read_b64_tr_b16 a[240:241], v241 offset:36864
    ds_read_b64_tr_b16 a[242:243], v241 offset:38400
    v_mfma_f32_16x16x32_bf16 v[216:219], a[244:247], a[232:235], v[216:219]
    ds_read_b64_tr_b16 a[232:233], v240 offset:36864
    ds_read_b64_tr_b16 a[234:235], v240 offset:38400
    v_mfma_f32_16x16x32_bf16 v[204:207], a[244:247], a[236:239], v[204:207]
    s_waitcnt lgkmcnt(2)
    ds_read_b64_tr_b16 a[236:237], v240 offset:36872
    ds_read_b64_tr_b16 a[238:239], v240 offset:38408
    v_max3_f32 v248, v248, v154, v155
    v_max3_f32 v249, v249, v156, v157
    ds_read_b128 a[244:247], v239 offset:4096
    v_max3_f32 v248, v248, v158, v159
    v_max3_f32 v249, v249, v160, v161
    v_max3_f32 v248, v248, v162, v163
    v_max_f32 v248, v248, v249
    v_mov_b32 v249, v248
    s_nop 1
    v_permlane16_swap_b32 v248, v249
    v_max_f32 v248, v248, v249
    v_mov_b32 v249, v248
    s_nop 1
    v_permlane32_swap_b32 v248, v249
    v_max_f32 v248, v248, v249
    v_mul_f32 v250, s37, v248
    v_mfma_f32_16x16x32_bf16 v[220:223], a[240:243], a[252:255], v[220:223]
    v_fma_f32 v168, v168, s37, -v250
    v_fma_f32 v169, v169, s37, -v250
    v_mfma_f32_16x16x32_bf16 v[208:211], a[240:243], v[252:255], v[208:211]
    s_waitcnt lgkmcnt(3)
    ds_read_b128 a[240:243], v239 offset:11264
    v_fma_f32 v170, v170, s37, -v250
    v_mfma_f32_16x16x32_bf16 v[212:215], a[232:235], a[252:255], v[212:215]
    v_fma_f32 v171, v171, s37, -v250
    v_fma_f32 v172, v172, s37, -v250
    v_mfma_f32_16x16x32_bf16 v[200:203], a[232:235], v[252:255], v[200:203]
    s_waitcnt lgkmcnt(2)
    ds_read_b64_tr_b16 a[232:233], v241 offset:49152
    ds_read_b64_tr_b16 a[234:235], v241 offset:62976
    v_mfma_f32_16x16x32_bf16 v[216:219], a[236:239], a[252:255], v[216:219]
    ds_read_b64_tr_b16 a[252:253], v240 offset:49152
    ds_read_b64_tr_b16 a[254:255], v240 offset:62976
    v_mfma_f32_16x16x32_bf16 v[204:207], a[236:239], v[252:255], v[204:207]
    s_waitcnt lgkmcnt(2)
    ds_read_b64_tr_b16 v[252:253], v240 offset:49160
    ds_read_b64_tr_b16 v[254:255], v240 offset:62984
    v_exp_f32 v168, v168
    ds_read_b128 a[236:239], v239 offset:5120
    v_exp_f32 v169, v169
    v_exp_f32 v170, v170
    v_exp_f32 v171, v171
    v_cvt_pk_bf16_f32 v180, v168, v169
    v_cvt_pk_bf16_f32 v181, v170, v171
    ds_read_b128 v[168:171], v229 offset:640
    v_fma_f32 v173, v173, s37, -v250
    v_fma_f32 v174, v174, s37, -v250
    v_fma_f32 v175, v175, s37, -v250
    v_exp_f32 v172, v172
    v_exp_f32 v173, v173
    v_mfma_f32_16x16x32_bf16 v[220:223], a[232:235], a[244:247], v[220:223]
    v_exp_f32 v174, v174
    v_mfma_f32_16x16x32_bf16 v[208:211], a[232:235], a[248:251], v[208:211]
    s_waitcnt lgkmcnt(4)
    ds_read_b128 a[232:235], v224 offset:15552
    v_cvt_pk_bf16_f32 v182, v172, v173
    v_mfma_f32_16x16x32_bf16 v[212:215], a[252:255], a[244:247], v[212:215]
    v_exp_f32 v175, v175
    v_mfma_f32_16x16x32_bf16 v[200:203], a[252:255], a[248:251], v[200:203]
    s_waitcnt lgkmcnt(3)
    ds_read_b64_tr_b16 a[252:253], v241 offset:50688
    ds_read_b64_tr_b16 a[254:255], v241 offset:61440
    v_mfma_f32_16x16x32_bf16 v[216:219], v[252:255], a[244:247], v[216:219]
    ds_read_b64_tr_b16 a[244:245], v240 offset:50688
    ds_read_b64_tr_b16 a[246:247], v240 offset:61440
    v_mfma_f32_16x16x32_bf16 v[204:207], v[252:255], a[248:251], v[204:207]
    ds_read_b64_tr_b16 a[248:249], v240 offset:50696
    ds_read_b64_tr_b16 a[250:251], v240 offset:61448
    v_cvt_pk_bf16_f32 v183, v174, v175
    v_fma_f32 v144, v144, s37, -v250
    ds_read_b128 v[252:255], v224 offset:15488
    v_mfma_f32_16x16x32_bf16 v[196:199], a[216:219], v[180:183], 0
    ds_read_b128 v[172:175], v229 offset:1280
    v_fma_f32 v145, v145, s37, -v250
    v_mfma_f32_16x16x32_bf16 v[184:187], v[68:71], v[180:183], 0
    v_fma_f32 v146, v146, s37, -v250
    v_fma_f32 v147, v147, s37, -v250
    v_mfma_f32_16x16x32_bf16 v[188:191], v[90:93], v[180:183], 0
    v_exp_f32 v144, v144
    v_mfma_f32_16x16x32_bf16 v[192:195], v[112:115], v[180:183], 0
    s_waitcnt lgkmcnt(9)
    v_exp_f32 v145, v145
    v_mfma_f32_16x16x32_bf16 v[168:171], v[36:39], v[132:135], v[168:171]
    s_waitcnt lgkmcnt(6)
    v_exp_f32 v146, v146
    v_mfma_f32_16x16x32_bf16 v[220:223], a[252:255], a[236:239], v[220:223]
    v_exp_f32 v147, v147
    v_mfma_f32_16x16x32_bf16 v[208:211], a[252:255], a[240:243], v[208:211]
    ds_read_b128 a[252:255], v224 offset:18560
    v_cvt_pk_bf16_f32 v176, v144, v145
    v_mfma_f32_16x16x16_bf16 v[168:171], v[40:41], v[136:137], v[168:171]
    s_waitcnt lgkmcnt(5)
    v_cvt_pk_bf16_f32 v177, v146, v147
    v_fma_f32 v148, v148, s37, -v250
    v_mfma_f32_16x16x32_bf16 v[212:215], a[244:247], a[236:239], v[212:215]
    ds_read_b128 v[144:147], v228 offset:1280
    v_cvt_pk_bf16_f32 v220, v220, v221
    v_mfma_f32_16x16x32_bf16 v[200:203], a[244:247], a[240:243], v[200:203]
    s_waitcnt lgkmcnt(4)
    v_cvt_pk_bf16_f32 v221, v222, v223
    v_cvt_pk_bf16_f32 v208, v208, v209
    v_mfma_f32_16x16x32_bf16 v[216:219], a[248:251], a[236:239], v[216:219]
    s_waitcnt lgkmcnt(2)
    buffer_store_dwordx2 v[220:221], v243, s[20:23], s58 offen sc0 sc1
    v_mfma_f32_16x16x32_bf16 v[172:175], v[42:45], v[132:135], v[172:175]
    v_cvt_pk_bf16_f32 v212, v212, v213
    v_cvt_pk_bf16_f32 v213, v214, v215
    v_mfma_f32_16x16x32_bf16 v[204:207], a[248:251], a[240:243], v[204:207]
    v_cvt_pk_bf16_f32 v200, v200, v201
    v_cvt_pk_bf16_f32 v201, v202, v203
    v_mfma_f32_16x16x32_bf16 v[220:223], a[8:11], v[252:255], 0
    v_cvt_pk_bf16_f32 v214, v216, v217
    v_cvt_pk_bf16_f32 v215, v218, v219
    v_mfma_f32_16x16x16_bf16 v[172:175], v[46:47], v[136:137], v[172:175]
    buffer_store_dwordx4 v[212:215], v242, s[20:23], s58 offen sc0 sc1
    v_mfma_f32_16x16x32_bf16 v[216:219], a[4:7], v[252:255], 0
    s_add_u32 s58, s51, 0x54000
    v_cvt_pk_bf16_f32 v202, v204, v205
    v_cvt_pk_bf16_f32 v203, v206, v207
    v_mfma_f32_16x16x32_bf16 v[212:215], a[0:3], v[252:255], 0
    s_waitcnt lgkmcnt(0)
    buffer_store_dwordx4 v[200:203], v244, s[20:23], s59 offen sc0 sc1
    v_mfma_f32_16x16x32_bf16 v[144:147], v[18:21], v[132:135], v[144:147]
    ds_read_b128 a[236:239], v224 offset:15616
    v_cvt_pk_bf16_f32 v209, v210, v211
    v_mfma_f32_16x16x32_bf16 v[200:203], v[252:255], a[72:75], 0
    buffer_store_dwordx2 v[208:209], v245, s[20:23], s59 offen sc0 sc1
    v_mfma_f32_16x16x32_bf16 v[204:207], v[252:255], a[76:79], 0
    s_add_u32 s59, s51, 0x55800
    ds_read_b128 a[240:243], v224 offset:15680
    ds_read_b128 a[244:247], v224 offset:15744
    v_mfma_f32_16x16x16_bf16 v[144:147], v[22:23], v[136:137], v[144:147]
    ds_read_b128 a[248:251], v224 offset:15808
    v_fma_f32 v149, v149, s37, -v250
    v_mfma_f32_16x16x32_bf16 v[208:211], v[252:255], a[80:83], 0
    ds_read_b128 v[252:255], v224 offset:18624
    v_fma_f32 v150, v150, s37, -v250
    v_mfma_f32_16x16x32_bf16 v[212:215], a[12:15], a[232:235], v[212:215]
    v_fma_f32 v151, v151, s37, -v250
    v_fma_f32 v152, v152, s37, -v250
    v_mfma_f32_16x16x32_bf16 v[216:219], a[16:19], a[232:235], v[216:219]
    v_exp_f32 v148, v148
    v_mfma_f32_16x16x32_bf16 v[220:223], a[20:23], a[232:235], v[220:223]
    v_exp_f32 v149, v149
    v_mfma_f32_16x16x32_bf16 v[200:203], a[232:235], a[84:87], v[200:203]
    v_exp_f32 v150, v150
    v_mfma_f32_16x16x32_bf16 v[204:207], a[232:235], a[88:91], v[204:207]
    v_exp_f32 v151, v151
    v_mfma_f32_16x16x32_bf16 v[208:211], a[232:235], a[92:95], v[208:211]
    s_waitcnt lgkmcnt(4)
    ds_read_b128 a[232:235], v224 offset:18688
    v_cvt_pk_bf16_f32 v178, v148, v149
    v_mfma_f32_16x16x32_bf16 v[212:215], a[24:27], a[236:239], v[212:215]
    v_cvt_pk_bf16_f32 v179, v150, v151
    v_fma_f32 v153, v153, s37, -v250
    v_mfma_f32_16x16x32_bf16 v[216:219], a[28:31], a[236:239], v[216:219]
    ds_read_b128 v[148:151], v228 offset:1920
    v_fma_f32 v154, v154, s37, -v250
    v_mfma_f32_16x16x32_bf16 v[196:199], a[216:219], v[176:179], v[196:199]
    v_fma_f32 v155, v155, s37, -v250
    v_fma_f32 v156, v156, s37, -v250
    v_mfma_f32_16x16x32_bf16 v[184:187], v[76:79], v[176:179], v[184:187]
    v_exp_f32 v152, v152
    v_mfma_f32_16x16x32_bf16 v[188:191], v[98:101], v[176:179], v[188:191]
    v_exp_f32 v153, v153
    v_mfma_f32_16x16x32_bf16 v[192:195], v[120:123], v[176:179], v[192:195]
    v_exp_f32 v154, v154
    v_mfma_f32_16x16x32_bf16 v[220:223], a[32:35], a[236:239], v[220:223]
    v_exp_f32 v155, v155
    v_mfma_f32_16x16x32_bf16 v[200:203], a[236:239], a[96:99], v[200:203]
    v_cvt_pk_bf16_f32 v180, v152, v153
    v_cvt_pk_bf16_f32 v181, v154, v155
    v_mfma_f32_16x16x32_bf16 v[204:207], a[236:239], a[100:103], v[204:207]
    ds_read_b128 v[152:155], v229 offset:1920
    v_fma_f32 v157, v157, s37, -v250
    v_mfma_f32_16x16x32_bf16 v[208:211], a[236:239], a[104:107], v[208:211]
    s_waitcnt lgkmcnt(2)
    ds_read_b128 a[236:239], v224 offset:18752
    v_fma_f32 v158, v158, s37, -v250
    v_mfma_f32_16x16x32_bf16 v[212:215], a[36:39], a[240:243], v[212:215]
    s_waitcnt lgkmcnt(2)
    v_fma_f32 v159, v159, s37, -v250
    v_fma_f32 v160, v160, s37, -v250
    v_mfma_f32_16x16x32_bf16 v[148:151], v[0:3], v[132:135], v[148:151]
    v_exp_f32 v156, v156
    v_mfma_f32_16x16x32_bf16 v[216:219], a[40:43], a[240:243], v[216:219]
    v_exp_f32 v157, v157
    v_mfma_f32_16x16x32_bf16 v[220:223], a[44:47], a[240:243], v[220:223]
    v_exp_f32 v158, v158
    v_mfma_f32_16x16x32_bf16 v[200:203], a[240:243], a[108:111], v[200:203]
    v_exp_f32 v159, v159
    v_mfma_f32_16x16x16_bf16 v[148:151], v[4:5], v[136:137], v[148:151]
    v_cvt_pk_bf16_f32 v182, v156, v157
    v_cvt_pk_bf16_f32 v183, v158, v159
    v_mfma_f32_16x16x32_bf16 v[204:207], a[240:243], a[112:115], v[204:207]
    ds_read_b128 v[156:159], v229 offset:2560
    v_fma_f32 v161, v161, s37, -v250
    v_mfma_f32_16x16x32_bf16 v[196:199], a[216:219], v[180:183], v[196:199]
    v_fma_f32 v162, v162, s37, -v250
    v_fma_f32 v163, v163, s37, -v250
    v_mfma_f32_16x16x32_bf16 v[184:187], v[82:85], v[180:183], v[184:187]
    v_exp_f32 v160, v160
    v_mfma_f32_16x16x32_bf16 v[188:191], v[104:107], v[180:183], v[188:191]
    v_exp_f32 v161, v161
    v_mfma_f32_16x16x32_bf16 v[192:195], v[126:129], v[180:183], v[192:195]
    s_waitcnt lgkmcnt(1)
    v_exp_f32 v162, v162
    v_mfma_f32_16x16x32_bf16 v[152:155], v[24:27], v[132:135], v[152:155]
    v_exp_f32 v163, v163
    v_mfma_f32_16x16x32_bf16 v[208:211], a[240:243], a[116:119], v[208:211]
    ds_read_b128 a[240:243], v224 offset:18816
    v_cvt_pk_bf16_f32 v176, v160, v161
    v_mfma_f32_16x16x32_bf16 v[212:215], a[48:51], a[244:247], v[212:215]
    v_cvt_pk_bf16_f32 v177, v162, v163
    v_max3_f32 v248, v164, v165, v166
    v_mfma_f32_16x16x16_bf16 v[152:155], v[28:29], v[136:137], v[152:155]
    ds_read_b128 v[160:163], v228 offset:2560
    v_max3_f32 v249, v167, v168, v169
    v_mfma_f32_16x16x16_bf16 v[196:199], a[216:217], v[176:177], v[196:199]
    v_max3_f32 v248, v248, v170, v171
    v_max3_f32 v249, v249, v172, v173
    v_mfma_f32_16x16x16_bf16 v[184:187], v[86:87], v[176:177], v[184:187]
    v_max3_f32 v248, v248, v174, v175
    v_max3_f32 v249, v249, v144, v145
    v_mfma_f32_16x16x16_bf16 v[188:191], v[108:109], v[176:177], v[188:191]
    v_max3_f32 v248, v248, v146, v147
    v_max3_f32 v249, v249, v148, v149
    v_mfma_f32_16x16x16_bf16 v[192:195], v[130:131], v[176:177], v[192:195]
    v_rcp_f32 v197, v196
    v_mfma_f32_16x16x32_bf16 v[216:219], a[52:55], a[244:247], v[216:219]
    v_mul_f32 v184, v184, v197
    v_mul_f32 v185, v185, v197
    v_mfma_f32_16x16x32_bf16 v[220:223], a[56:59], a[244:247], v[220:223]
    v_cvt_pk_bf16_f32 v184, v184, v185
    v_mul_f32 v186, v186, v197
    v_mfma_f32_16x16x32_bf16 v[200:203], a[244:247], a[120:123], v[200:203]
    v_mul_f32 v187, v187, v197
    v_cvt_pk_bf16_f32 v185, v186, v187
    v_mfma_f32_16x16x32_bf16 v[204:207], a[244:247], a[124:127], v[204:207]
    v_mul_f32 v188, v188, v197
    v_mul_f32 v189, v189, v197
    v_mfma_f32_16x16x32_bf16 v[208:211], a[244:247], a[128:131], v[208:211]
    ds_read_b128 a[244:247], v224 offset:18880
    v_cvt_pk_bf16_f32 v186, v188, v189
    v_mfma_f32_16x16x32_bf16 v[212:215], a[60:63], a[248:251], v[212:215]
    v_mul_f32 v190, v190, v197
    v_mul_f32 v191, v191, v197
    v_mfma_f32_16x16x32_bf16 v[216:219], a[64:67], a[248:251], v[216:219]
    v_cvt_pk_bf16_f32 v187, v190, v191
    v_mul_f32 v192, v192, v197
    v_mfma_f32_16x16x32_bf16 v[220:223], a[68:71], a[248:251], v[220:223]
    v_mul_f32 v193, v193, v197
    v_cvt_pk_bf16_f32 v188, v192, v193
    v_mfma_f32_16x16x32_bf16 v[200:203], a[248:251], a[132:135], v[200:203]
    v_cvt_pk_bf16_f32 v6, v212, v213
    v_cvt_pk_bf16_f32 v7, v214, v215
    v_mfma_f32_16x16x32_bf16 v[204:207], a[248:251], a[136:139], v[204:207]
    v_cvt_pk_bf16_f32 v8, v216, v217
    v_cvt_pk_bf16_f32 v9, v218, v219
    v_mfma_f32_16x16x32_bf16 v[208:211], a[248:251], a[140:143], v[208:211]
    s_waitcnt lgkmcnt(1)
    v_cvt_pk_bf16_f32 v10, v220, v221
    v_cvt_pk_bf16_f32 v11, v222, v223
    v_mfma_f32_16x16x32_bf16 v[160:163], v[6:9], v[132:135], v[160:163]
    v_cvt_pk_bf16_f32 v72, v200, v201
    v_cvt_pk_bf16_f32 v73, v202, v203
    v_mfma_f32_16x16x32_bf16 v[212:215], a[0:3], a[252:255], 0
    v_cvt_pk_bf16_f32 v94, v204, v205
    v_cvt_pk_bf16_f32 v95, v206, v207
    v_mfma_f32_16x16x32_bf16 v[216:219], a[4:7], a[252:255], 0
    v_cvt_pk_bf16_f32 v116, v208, v209
    v_cvt_pk_bf16_f32 v117, v210, v211
    v_mfma_f32_16x16x16_bf16 v[160:163], v[10:11], v[136:137], v[160:163]
    v_mul_f32 v194, v194, v197
    v_mul_f32 v195, v195, v197
    v_mfma_f32_16x16x32_bf16 v[220:223], a[8:11], a[252:255], 0
    ds_read_b128 a[248:251], v226 offset:4224
    v_cvt_pk_bf16_f32 v189, v194, v195
    v_mfma_f32_16x16x32_bf16 v[200:203], a[252:255], a[72:75], 0
    ds_write_b128 v237, v[184:187] offset:18432
    v_mfma_f32_16x16x32_bf16 v[204:207], a[252:255], a[76:79], 0
    ds_write_b64 v238, v[188:189] offset:18432
    v_mfma_f32_16x16x32_bf16 v[208:211], a[252:255], a[80:83], 0
    ds_read_b128 a[252:255], v226 offset:4288
    v_max3_f32 v248, v248, v150, v151
    v_mfma_f32_16x16x32_bf16 v[212:215], a[12:15], v[252:255], v[212:215]
    v_max3_f32 v249, v249, v152, v153
    v_max3_f32 v248, v248, v154, v155
    v_mfma_f32_16x16x32_bf16 v[216:219], a[16:19], v[252:255], v[216:219]
    v_mfma_f32_16x16x32_bf16 v[220:223], a[20:23], v[252:255], v[220:223]
    v_mfma_f32_16x16x32_bf16 v[200:203], v[252:255], a[84:87], v[200:203]
    v_mfma_f32_16x16x32_bf16 v[204:207], v[252:255], a[88:91], v[204:207]
    v_mfma_f32_16x16x32_bf16 v[208:211], v[252:255], a[92:95], v[208:211]
    ds_read_b128 v[252:255], v226 offset:4352
    v_mfma_f32_16x16x32_bf16 v[212:215], a[24:27], a[232:235], v[212:215]
    v_mfma_f32_16x16x32_bf16 v[216:219], a[28:31], a[232:235], v[216:219]
    v_mfma_f32_16x16x32_bf16 v[220:223], a[32:35], a[232:235], v[220:223]
    v_mfma_f32_16x16x32_bf16 v[200:203], a[232:235], a[96:99], v[200:203]
    v_mfma_f32_16x16x32_bf16 v[204:207], a[232:235], a[100:103], v[204:207]
    v_mfma_f32_16x16x32_bf16 v[208:211], a[232:235], a[104:107], v[208:211]
    ds_read_b128 a[232:235], v226 offset:4416
    v_mfma_f32_16x16x32_bf16 v[212:215], a[36:39], a[236:239], v[212:215]
    v_mfma_f32_16x16x32_bf16 v[216:219], a[40:43], a[236:239], v[216:219]
    v_mfma_f32_16x16x32_bf16 v[220:223], a[44:47], a[236:239], v[220:223]
    v_mfma_f32_16x16x32_bf16 v[200:203], a[236:239], a[108:111], v[200:203]
    v_mfma_f32_16x16x32_bf16 v[204:207], a[236:239], a[112:115], v[204:207]
    v_mfma_f32_16x16x32_bf16 v[208:211], a[236:239], a[116:119], v[208:211]
    ds_read_b128 a[236:239], v226 offset:4480
    v_mfma_f32_16x16x32_bf16 v[212:215], a[48:51], a[240:243], v[212:215]
    v_mfma_f32_16x16x32_bf16 v[216:219], a[52:55], a[240:243], v[216:219]
    v_mfma_f32_16x16x32_bf16 v[220:223], a[56:59], a[240:243], v[220:223]
    v_mfma_f32_16x16x32_bf16 v[200:203], a[240:243], a[120:123], v[200:203]
    v_mfma_f32_16x16x32_bf16 v[204:207], a[240:243], a[124:127], v[204:207]
    v_mfma_f32_16x16x32_bf16 v[208:211], a[240:243], a[128:131], v[208:211]
    s_waitcnt lgkmcnt(1)
    ds_read_b128 a[240:243], v226 offset:4544
    v_mfma_f32_16x16x32_bf16 v[212:215], a[60:63], a[244:247], v[212:215]
    v_mfma_f32_16x16x32_bf16 v[216:219], a[64:67], a[244:247], v[216:219]
    v_mfma_f32_16x16x32_bf16 v[220:223], a[68:71], a[244:247], v[220:223]
    v_mfma_f32_16x16x32_bf16 v[200:203], a[244:247], a[132:135], v[200:203]
    v_mfma_f32_16x16x32_bf16 v[204:207], a[244:247], a[136:139], v[204:207]
    v_mfma_f32_16x16x32_bf16 v[208:211], a[244:247], a[140:143], v[208:211]
    ds_read_b128 a[244:247], v225 offset:8896
    s_nop 1
    v_cvt_pk_bf16_f32 v30, v212, v213
    v_cvt_pk_bf16_f32 v31, v214, v215
    v_mfma_f32_16x16x32_bf16 v[212:215], a[144:147], a[248:251], 0
    s_waitcnt vmcnt(4) lgkmcnt(1)
    v_cvt_pk_bf16_f32 v32, v216, v217
    v_cvt_pk_bf16_f32 v33, v218, v219
    v_mfma_f32_16x16x32_bf16 v[216:219], a[148:151], a[248:251], 0
    s_barrier
    v_cvt_pk_bf16_f32 v34, v220, v221
    v_cvt_pk_bf16_f32 v35, v222, v223
    v_mfma_f32_16x16x32_bf16 v[156:159], v[30:33], v[132:135], v[156:159]
    v_cvt_pk_bf16_f32 v70, v200, v201
    v_cvt_pk_bf16_f32 v71, v202, v203
    v_mfma_f32_16x16x32_bf16 v[220:223], a[152:155], a[248:251], 0
    v_cvt_pk_bf16_f32 v92, v204, v205
    v_cvt_pk_bf16_f32 v93, v206, v207
    v_mfma_f32_16x16x32_bf16 v[212:215], a[156:159], a[252:255], v[212:215]
    v_cvt_pk_bf16_f32 v114, v208, v209
    v_cvt_pk_bf16_f32 v115, v210, v211
    v_mfma_f32_16x16x16_bf16 v[156:159], v[34:35], v[136:137], v[156:159]
    ds_read_b128 a[248:251], v225 offset:8960
    v_mfma_f32_16x16x32_bf16 v[216:219], a[160:163], a[252:255], v[216:219]
    buffer_load_dwordx4 v246, s[4:7], s56 offen lds
    v_mfma_f32_16x16x32_bf16 v[220:223], a[164:167], a[252:255], v[220:223]
    s_add_u32 m0, s42, 0xb580
    ds_read_b128 a[252:255], v225 offset:9024
    v_mfma_f32_16x16x32_bf16 v[212:215], a[168:171], v[252:255], v[212:215]
    buffer_load_dwordx4 v247, s[4:7], s56 offen lds
    v_mfma_f32_16x16x32_bf16 v[216:219], a[172:175], v[252:255], v[216:219]
    s_add_u32 s56, s39, 0x276000
    v_max3_f32 v249, v249, v156, v157
    v_max3_f32 v248, v248, v158, v159
    v_mfma_f32_16x16x32_bf16 v[220:223], a[176:179], v[252:255], v[220:223]
    s_add_u32 m0, s41, 0xd3c0
    ds_read_b128 v[252:255], v225 offset:9088
    v_max3_f32 v249, v249, v160, v161
    v_mfma_f32_16x16x32_bf16 v[212:215], a[180:183], a[232:235], v[212:215]
    buffer_load_dwordx4 v246, s[4:7], s56 offen lds
    v_mfma_f32_16x16x32_bf16 v[216:219], a[184:187], a[232:235], v[216:219]
    s_add_u32 m0, s42, 0xd3c0
    v_max3_f32 v248, v248, v162, v163
    v_max_f32 v248, v248, v249
    v_mfma_f32_16x16x32_bf16 v[220:223], a[188:191], a[232:235], v[220:223]
    ds_read_b128 a[232:235], v225 offset:9152
    v_mov_b32 v249, v248
    v_mfma_f32_16x16x32_bf16 v[212:215], a[192:195], a[236:239], v[212:215]
    buffer_load_dwordx4 v247, s[4:7], s56 offen lds
    v_mfma_f32_16x16x32_bf16 v[216:219], a[196:199], a[236:239], v[216:219]
    s_add_u32 s56, s39, 0x2a0000
    v_permlane16_swap_b32 v248, v249
    v_mfma_f32_16x16x32_bf16 v[220:223], a[200:203], a[236:239], v[220:223]
    s_add_u32 m0, s41, 0
    ds_read_b128 a[236:239], v225 offset:9216
    v_max_f32 v248, v248, v249
    v_mfma_f32_16x16x32_bf16 v[212:215], a[204:207], a[240:243], v[212:215]
    v_mov_b32 v249, v248
    v_mfma_f32_16x16x32_bf16 v[216:219], a[208:211], a[240:243], v[216:219]
    v_mfma_f32_16x16x32_bf16 v[220:223], a[212:215], a[240:243], v[220:223]
    s_waitcnt lgkmcnt(3)
    ds_read_b128 a[240:243], v239 offset:12288
    v_mfma_f32_16x16x32_bf16 v[200:203], a[144:147], a[244:247], 0
    v_permlane32_swap_b32 v248, v249
    v_mfma_f32_16x16x32_bf16 v[204:207], a[148:151], a[244:247], 0
    v_max_f32 v248, v248, v249
    v_cvt_pk_bf16_f32 v138, v212, v213
    v_mfma_f32_16x16x32_bf16 v[208:211], a[152:155], a[244:247], 0
    v_cvt_pk_bf16_f32 v139, v214, v215
    v_cvt_pk_bf16_f32 v140, v216, v217
    v_mfma_f32_16x16x32_bf16 v[200:203], a[156:159], a[248:251], v[200:203]
    v_cvt_pk_bf16_f32 v141, v218, v219
    v_cvt_pk_bf16_f32 v142, v220, v221
    v_mfma_f32_16x16x32_bf16 v[204:207], a[160:163], a[248:251], v[204:207]
    ds_read_b128 a[244:247], v239 offset:18432
    v_cvt_pk_bf16_f32 v143, v222, v223
    v_mfma_f32_16x16x32_bf16 v[208:211], a[164:167], a[248:251], v[208:211]
    ds_read_b128 a[248:251], v239 offset:13312
    v_mul_f32 v250, s37, v248
    v_mfma_f32_16x16x32_bf16 v[200:203], a[168:171], a[252:255], v[200:203]
    v_fma_f32 v164, v164, s37, -v250
    v_fma_f32 v165, v165, s37, -v250
    v_mfma_f32_16x16x32_bf16 v[204:207], a[172:175], a[252:255], v[204:207]
    v_fma_f32 v166, v166, s37, -v250
    v_fma_f32 v167, v167, s37, -v250
    v_mfma_f32_16x16x32_bf16 v[208:211], a[176:179], a[252:255], v[208:211]
    s_waitcnt lgkmcnt(3)
    ds_read_b128 a[252:255], v239 offset:19456
    v_fma_f32 v168, v168, s37, -v250
    v_mfma_f32_16x16x32_bf16 v[200:203], a[180:183], v[252:255], v[200:203]
    v_exp_f32 v164, v164
    v_mfma_f32_16x16x32_bf16 v[204:207], a[184:187], v[252:255], v[204:207]
    v_exp_f32 v165, v165
    v_mfma_f32_16x16x32_bf16 v[208:211], a[188:191], v[252:255], v[208:211]
    ds_read_b64_tr_b16 v[252:253], v240 offset:12288
    ds_read_b64_tr_b16 v[254:255], v240 offset:26112
    v_mfma_f32_16x16x32_bf16 v[200:203], a[192:195], a[232:235], v[200:203]
    v_exp_f32 v166, v166
    v_mfma_f32_16x16x32_bf16 v[204:207], a[196:199], a[232:235], v[204:207]
    v_exp_f32 v167, v167
    v_mfma_f32_16x16x32_bf16 v[208:211], a[200:203], a[232:235], v[208:211]
    ds_read_b64_tr_b16 a[232:233], v240 offset:12296
    ds_read_b64_tr_b16 a[234:235], v240 offset:26120
    v_mfma_f32_16x16x32_bf16 v[200:203], a[204:207], a[236:239], v[200:203]
    v_cvt_pk_bf16_f32 v180, v164, v165
    v_cvt_pk_bf16_f32 v181, v166, v167
    v_mfma_f32_16x16x32_bf16 v[204:207], a[208:211], a[236:239], v[204:207]
    ds_read_b128 v[164:167], v230 offset:640
    v_fma_f32 v169, v169, s37, -v250
    v_mfma_f32_16x16x32_bf16 v[208:211], a[212:215], a[236:239], v[208:211]
    s_waitcnt lgkmcnt(6)
    ds_read_b64_tr_b16 a[236:237], v241 offset:12288
    ds_read_b64_tr_b16 a[238:239], v241 offset:26112
    v_mfma_f32_16x16x32_bf16 v[212:215], a[220:223], a[240:243], 0
    v_cvt_pk_bf16_f32 v132, v200, v201
    v_cvt_pk_bf16_f32 v133, v202, v203
    v_mfma_f32_16x16x32_bf16 v[200:203], a[220:223], a[244:247], 0
    v_cvt_pk_bf16_f32 v134, v204, v205
    v_cvt_pk_bf16_f32 v135, v206, v207
    v_mfma_f32_16x16x32_bf16 v[216:219], a[224:227], a[240:243], 0
    v_cvt_pk_bf16_f32 v136, v208, v209
    v_cvt_pk_bf16_f32 v137, v210, v211
    v_mfma_f32_16x16x32_bf16 v[204:207], a[224:227], a[244:247], 0
    v_fma_f32 v170, v170, s37, -v250
    v_fma_f32 v171, v171, s37, -v250
    v_mfma_f32_16x16x32_bf16 v[220:223], a[228:231], a[240:243], 0
    ds_read_b128 a[240:243], v239 offset:14336
    v_fma_f32 v172, v172, s37, -v250
    v_mfma_f32_16x16x32_bf16 v[208:211], a[228:231], a[244:247], 0
    s_waitcnt lgkmcnt(6)
    ds_read_b128 a[244:247], v239 offset:20480
    v_fma_f32 v173, v173, s37, -v250
    v_mfma_f32_16x16x32_bf16 v[212:215], v[252:255], a[248:251], v[212:215]
    v_exp_f32 v168, v168
    v_mfma_f32_16x16x32_bf16 v[200:203], v[252:255], a[252:255], v[200:203]
    s_waitcnt lgkmcnt(4)
    ds_read_b64_tr_b16 v[252:253], v241 offset:13824
    ds_read_b64_tr_b16 v[254:255], v241 offset:24576
    v_mfma_f32_16x16x32_bf16 v[164:167], v[36:39], v[138:141], v[164:167]
    v_exp_f32 v169, v169
    v_mfma_f32_16x16x32_bf16 v[216:219], a[232:235], a[248:251], v[216:219]
    v_exp_f32 v170, v170
    v_mfma_f32_16x16x32_bf16 v[204:207], a[232:235], a[252:255], v[204:207]
    ds_read_b128 a[232:235], v239 offset:15360
    v_cvt_pk_bf16_f32 v182, v168, v169
    v_mfma_f32_16x16x16_bf16 v[164:167], v[40:41], v[142:143], v[164:167]
    s_waitcnt lgkmcnt(5)
    v_exp_f32 v171, v171
    v_mfma_f32_16x16x32_bf16 v[220:223], a[236:239], a[248:251], v[220:223]
    ds_read_b64_tr_b16 a[248:249], v240 offset:13824
    ds_read_b64_tr_b16 a[250:251], v240 offset:24576
    v_mfma_f32_16x16x32_bf16 v[208:211], a[236:239], a[252:255], v[208:211]
    ds_read_b64_tr_b16 a[252:253], v240 offset:13832
    ds_read_b64_tr_b16 a[254:255], v240 offset:24584
    v_cvt_pk_bf16_f32 v183, v170, v171
    v_fma_f32 v174, v174, s37, -v250
    ds_read_b128 a[236:239], v239 offset:21504
    v_mfma_f32_16x16x32_bf16 v[196:199], a[216:219], v[180:183], 0
    ds_read_b128 v[168:171], v230 offset:1280
    v_fma_f32 v175, v175, s37, -v250
    v_mfma_f32_16x16x32_bf16 v[184:187], v[74:77], v[180:183], 0
    v_exp_f32 v172, v172
    v_mfma_f32_16x16x32_bf16 v[188:191], v[96:99], v[180:183], 0
    v_exp_f32 v173, v173
    v_mfma_f32_16x16x32_bf16 v[192:195], v[118:121], v[180:183], 0
    s_waitcnt lgkmcnt(7)
    v_exp_f32 v174, v174
    v_mfma_f32_16x16x32_bf16 v[220:223], v[252:255], a[240:243], v[220:223]
    v_exp_f32 v175, v175
    v_mfma_f32_16x16x32_bf16 v[208:211], v[252:255], a[244:247], v[208:211]
    s_waitcnt lgkmcnt(4)
    ds_read_b128 v[252:255], v239 offset:22528
    v_cvt_pk_bf16_f32 v176, v172, v173
    v_cvt_pk_bf16_f32 v177, v174, v175
    v_mfma_f32_16x16x32_bf16 v[212:215], a[248:251], a[240:243], v[212:215]
    ds_read_b128 v[172:175], v230 offset:1920
    v_fma_f32 v144, v144, s37, -v250
    v_mfma_f32_16x16x32_bf16 v[200:203], a[248:251], a[244:247], v[200:203]
    s_waitcnt lgkmcnt(4)
    ds_read_b64_tr_b16 a[248:249], v241 offset:36864
    ds_read_b64_tr_b16 a[250:251], v241 offset:38400
    v_mfma_f32_16x16x32_bf16 v[216:219], a[252:255], a[240:243], v[216:219]
    ds_read_b64_tr_b16 a[240:241], v240 offset:36864
    ds_read_b64_tr_b16 a[242:243], v240 offset:38400
    v_mfma_f32_16x16x32_bf16 v[204:207], a[252:255], a[244:247], v[204:207]
    s_waitcnt lgkmcnt(6)
    ds_read_b64_tr_b16 a[244:245], v240 offset:36872
    v_fma_f32 v145, v145, s37, -v250
    v_fma_f32 v146, v146, s37, -v250
    v_fma_f32 v147, v147, s37, -v250
    ds_read_b64_tr_b16 a[246:247], v240 offset:38408
    v_mfma_f32_16x16x32_bf16 v[168:171], v[42:45], v[138:141], v[168:171]
    ds_read_b128 a[252:255], v239 offset:16384
    v_fma_f32 v148, v148, s37, -v250
    v_exp_f32 v144, v144
    v_exp_f32 v145, v145
    v_exp_f32 v146, v146
    v_exp_f32 v147, v147
    v_mfma_f32_16x16x16_bf16 v[168:171], v[46:47], v[142:143], v[168:171]
    s_waitcnt lgkmcnt(7)
    v_cvt_pk_bf16_f32 v178, v144, v145
    v_cvt_pk_bf16_f32 v179, v146, v147
    ds_read_b128 v[144:147], v230 offset:2560
    v_mfma_f32_16x16x32_bf16 v[172:175], v[24:27], v[138:141], v[172:175]
    v_fma_f32 v149, v149, s37, -v250
    v_fma_f32 v150, v150, s37, -v250
    v_mfma_f32_16x16x32_bf16 v[196:199], a[216:219], v[176:179], v[196:199]
    v_fma_f32 v151, v151, s37, -v250
    v_fma_f32 v152, v152, s37, -v250
    v_mfma_f32_16x16x32_bf16 v[184:187], v[78:81], v[176:179], v[184:187]
    v_exp_f32 v148, v148
    v_mfma_f32_16x16x32_bf16 v[188:191], v[100:103], v[176:179], v[188:191]
    v_exp_f32 v149, v149
    v_mfma_f32_16x16x32_bf16 v[192:195], v[122:125], v[176:179], v[192:195]
    v_exp_f32 v150, v150
    v_mfma_f32_16x16x16_bf16 v[172:175], v[28:29], v[142:143], v[172:175]
    s_waitcnt lgkmcnt(3)
    v_exp_f32 v151, v151
    v_mfma_f32_16x16x32_bf16 v[212:215], a[240:243], a[232:235], v[212:215]
    v_cvt_pk_bf16_f32 v180, v148, v149
    v_cvt_pk_bf16_f32 v181, v150, v151
    v_mfma_f32_16x16x32_bf16 v[200:203], a[240:243], a[236:239], v[200:203]
    s_waitcnt lgkmcnt(1)
    ds_read_b64_tr_b16 a[240:241], v241 offset:49152
    ds_read_b64_tr_b16 a[242:243], v241 offset:62976
    v_mfma_f32_16x16x32_bf16 v[216:219], a[244:247], a[232:235], v[216:219]
    s_waitcnt lgkmcnt(2)
    ds_read_b128 v[148:151], v236
    v_bfe_u32 v236, s67, v233, 4
    v_mfma_f32_16x16x32_bf16 v[144:147], v[30:33], v[138:141], v[144:147]
    v_mad_u32_u24 v236, v236, s40, v231
    v_fma_f32 v153, v153, s37, -v250
    v_mfma_f32_16x16x32_bf16 v[204:207], a[244:247], a[236:239], v[204:207]
    ds_read_b128 a[244:247], v239 offset:17408
    v_fma_f32 v154, v154, s37, -v250
    v_mfma_f32_16x16x32_bf16 v[220:223], a[248:251], a[232:235], v[220:223]
    ds_read_b64_tr_b16 a[232:233], v240 offset:49152
    ds_read_b64_tr_b16 a[234:235], v240 offset:62976
    v_mfma_f32_16x16x16_bf16 v[144:147], v[34:35], v[142:143], v[144:147]
    v_fma_f32 v155, v155, s37, -v250
    v_fma_f32 v156, v156, s37, -v250
    v_mfma_f32_16x16x32_bf16 v[208:211], a[248:251], a[236:239], v[208:211]
    s_waitcnt lgkmcnt(4)
    ds_read_b64_tr_b16 a[236:237], v240 offset:49160
    ds_read_b64_tr_b16 a[238:239], v240 offset:62984
    ds_read_b128 a[248:251], v239 offset:23552
    v_exp_f32 v152, v152
    v_exp_f32 v153, v153
    v_exp_f32 v154, v154
    v_mfma_f32_16x16x32_bf16 v[220:223], a[240:243], a[252:255], v[220:223]
    v_exp_f32 v155, v155
    v_mfma_f32_16x16x32_bf16 v[208:211], a[240:243], v[252:255], v[208:211]
    s_waitcnt lgkmcnt(6)
    ds_read_b128 a[240:243], v224 offset:31040
    v_cvt_pk_bf16_f32 v182, v152, v153
    v_mfma_f32_16x16x32_bf16 v[148:151], v[54:57], v[138:141], v[148:151]
    v_cvt_pk_bf16_f32 v183, v154, v155
    v_fma_f32 v157, v157, s37, -v250
    ds_read_b128 v[152:155], v234
    v_mfma_f32_16x16x32_bf16 v[196:199], a[216:219], v[180:183], v[196:199]
    v_bfe_u32 v234, s72, v233, 4
    v_mad_u32_u24 v234, v234, s40, v231
    v_mfma_f32_16x16x32_bf16 v[184:187], v[66:69], v[180:183], v[184:187]
    v_fma_f32 v158, v158, s37, -v250
    v_fma_f32 v159, v159, s37, -v250
    v_mfma_f32_16x16x32_bf16 v[188:191], v[88:91], v[180:183], v[188:191]
    v_exp_f32 v156, v156
    v_mfma_f32_16x16x32_bf16 v[192:195], v[110:113], v[180:183], v[192:195]
    v_exp_f32 v157, v157
    v_mfma_f32_16x16x16_bf16 v[148:151], v[58:59], v[142:143], v[148:151]
    s_waitcnt lgkmcnt(3)
    v_exp_f32 v158, v158
    v_mfma_f32_16x16x32_bf16 v[212:215], a[232:235], a[252:255], v[212:215]
    v_exp_f32 v159, v159
    v_mfma_f32_16x16x32_bf16 v[200:203], a[232:235], v[252:255], v[200:203]
    ds_read_b64_tr_b16 a[232:233], v241 offset:50688
    ds_read_b64_tr_b16 a[234:235], v241 offset:61440
    v_mfma_f32_16x16x32_bf16 v[216:219], a[236:239], a[252:255], v[216:219]
    ds_read_b64_tr_b16 a[252:253], v240 offset:50688
    ds_read_b64_tr_b16 a[254:255], v240 offset:61440
    v_mfma_f32_16x16x32_bf16 v[204:207], a[236:239], v[252:255], v[204:207]
    s_waitcnt lgkmcnt(4)
    ds_read_b64_tr_b16 v[252:253], v240 offset:50696
    ds_read_b64_tr_b16 v[254:255], v240 offset:61448
    v_mfma_f32_16x16x32_bf16 v[152:155], v[60:63], v[138:141], v[152:155]
    ds_read_b128 a[236:239], v224 offset:30976
    v_cvt_pk_bf16_f32 v176, v156, v157
    v_cvt_pk_bf16_f32 v177, v158, v159
    v_fma_f32 v160, v160, s37, -v250
    ds_read_b128 v[156:159], v229 offset:640
    v_fma_f32 v161, v161, s37, -v250
    v_mfma_f32_16x16x16_bf16 v[152:155], v[64:65], v[142:143], v[152:155]
    s_waitcnt lgkmcnt(6)
    v_fma_f32 v162, v162, s37, -v250
    v_fma_f32 v163, v163, s37, -v250
    v_exp_f32 v160, v160
    v_exp_f32 v161, v161
    v_exp_f32 v162, v162
    v_exp_f32 v163, v163
    v_mfma_f32_16x16x32_bf16 v[220:223], a[232:235], a[244:247], v[220:223]
    v_cvt_pk_bf16_f32 v178, v160, v161
    v_cvt_pk_bf16_f32 v179, v162, v163
    v_mfma_f32_16x16x32_bf16 v[208:211], a[232:235], a[248:251], v[208:211]
    ds_read_b128 a[232:235], v224 offset:34048
    ds_read_b128 v[160:163], v228 offset:640
    v_mfma_f32_16x16x32_bf16 v[196:199], a[216:219], v[176:179], v[196:199]
    v_max3_f32 v248, v164, v165, v166
    v_max3_f32 v249, v167, v168, v169
    v_mfma_f32_16x16x32_bf16 v[184:187], v[70:73], v[176:179], v[184:187]
    v_cvt_pk_bf16_f32 v220, v220, v221
    v_cvt_pk_bf16_f32 v221, v222, v223
    v_mfma_f32_16x16x32_bf16 v[188:191], v[92:95], v[176:179], v[188:191]
    buffer_store_dwordx2 v[220:221], v243, s[20:23], s58 offen sc0 sc1
    v_mfma_f32_16x16x32_bf16 v[192:195], v[114:117], v[176:179], v[192:195]
    s_waitcnt lgkmcnt(4)
    v_cvt_pk_bf16_f32 v208, v208, v209
    v_cvt_pk_bf16_f32 v209, v210, v211
    v_mfma_f32_16x16x32_bf16 v[212:215], a[252:255], a[244:247], v[212:215]
    s_waitcnt lgkmcnt(2)
    buffer_store_dwordx2 v[208:209], v245, s[20:23], s59 offen sc0 sc1
    v_mfma_f32_16x16x32_bf16 v[156:159], v[42:45], v[132:135], v[156:159]
    v_rcp_f32 v197, v196
    v_mfma_f32_16x16x32_bf16 v[200:203], a[252:255], a[248:251], v[200:203]
    v_mul_f32 v184, v184, v197
    v_mul_f32 v185, v185, v197
    v_mfma_f32_16x16x32_bf16 v[216:219], v[252:255], a[244:247], v[216:219]
    v_cvt_pk_bf16_f32 v184, v184, v185
    v_cvt_pk_bf16_f32 v212, v212, v213
    v_mfma_f32_16x16x16_bf16 v[156:159], v[46:47], v[136:137], v[156:159]
    s_waitcnt lgkmcnt(0)
    v_cvt_pk_bf16_f32 v213, v214, v215
    v_mul_f32 v186, v186, v197
    v_mfma_f32_16x16x32_bf16 v[160:163], v[18:21], v[132:135], v[160:163]
    v_cvt_pk_bf16_f32 v200, v200, v201
    v_cvt_pk_bf16_f32 v201, v202, v203
    v_mfma_f32_16x16x32_bf16 v[204:207], v[252:255], a[248:251], v[204:207]
    v_cvt_pk_bf16_f32 v214, v216, v217
    v_cvt_pk_bf16_f32 v215, v218, v219
    v_mfma_f32_16x16x32_bf16 v[216:219], a[4:7], a[236:239], 0
    buffer_store_dwordx4 v[212:215], v242, s[20:23], s58 offen sc0 sc1
    v_mfma_f32_16x16x16_bf16 v[160:163], v[22:23], v[136:137], v[160:163]
    s_add_u32 s58, s51, 0xa8000
    v_mul_f32 v187, v187, v197
    v_cvt_pk_bf16_f32 v185, v186, v187
    v_mfma_f32_16x16x32_bf16 v[212:215], a[0:3], a[236:239], 0
    v_cvt_pk_bf16_f32 v202, v204, v205
    v_cvt_pk_bf16_f32 v203, v206, v207
    v_mfma_f32_16x16x32_bf16 v[220:223], a[8:11], a[236:239], 0
    buffer_store_dwordx4 v[200:203], v244, s[20:23], s59 offen sc0 sc1
    v_mfma_f32_16x16x32_bf16 v[204:207], a[236:239], a[76:79], 0
    s_add_u32 s59, s51, 0xa9800
    v_mul_f32 v188, v188, v197
    v_mul_f32 v189, v189, v197
    v_mfma_f32_16x16x32_bf16 v[200:203], a[236:239], a[72:75], 0
    v_cvt_pk_bf16_f32 v186, v188, v189
    v_mul_f32 v190, v190, v197
    v_mfma_f32_16x16x32_bf16 v[208:211], a[236:239], a[80:83], 0
    v_mul_f32 v191, v191, v197
    v_cvt_pk_bf16_f32 v187, v190, v191
    v_mfma_f32_16x16x32_bf16 v[212:215], a[12:15], a[240:243], v[212:215]
    v_mul_f32 v192, v192, v197
    v_mul_f32 v193, v193, v197
    v_mfma_f32_16x16x32_bf16 v[216:219], a[16:19], a[240:243], v[216:219]
    v_cvt_pk_bf16_f32 v188, v192, v193
    v_mul_f32 v194, v194, v197
    v_mfma_f32_16x16x32_bf16 v[220:223], a[20:23], a[240:243], v[220:223]
    ds_read_b128 a[244:247], v224 offset:31104
    v_mul_f32 v195, v195, v197
    v_mfma_f32_16x16x32_bf16 v[200:203], a[240:243], a[84:87], v[200:203]
    ds_read_b128 a[248:251], v224 offset:31168
    v_cvt_pk_bf16_f32 v189, v194, v195
    v_mfma_f32_16x16x32_bf16 v[204:207], a[240:243], a[88:91], v[204:207]
    ds_write_b128 v237, v[184:187]
    v_mfma_f32_16x16x32_bf16 v[208:211], a[240:243], a[92:95], v[208:211]
    s_waitcnt lgkmcnt(2)
    ds_write_b64 v238, v[188:189]
    ds_read_b128 a[252:255], v224 offset:31232
    ds_read_b128 v[252:255], v224 offset:31296
    ds_read_b128 a[236:239], v224 offset:34112
    v_max3_f32 v248, v248, v170, v171
    v_max3_f32 v249, v249, v172, v173
    v_max3_f32 v248, v248, v174, v175
    ds_read_b128 a[240:243], v224 offset:34176
    v_max3_f32 v249, v249, v144, v145
    v_max3_f32 v248, v248, v146, v147
    v_max3_f32 v249, v249, v148, v149
    v_max3_f32 v248, v248, v150, v151
    v_max3_f32 v249, v249, v152, v153
    v_mfma_f32_16x16x32_bf16 v[212:215], a[24:27], a[244:247], v[212:215]
    v_max3_f32 v248, v248, v154, v155
    v_max_f32 v248, v248, v249
    v_mfma_f32_16x16x32_bf16 v[216:219], a[28:31], a[244:247], v[216:219]
    v_mov_b32 v249, v248
    v_mfma_f32_16x16x32_bf16 v[220:223], a[32:35], a[244:247], v[220:223]
    v_mfma_f32_16x16x32_bf16 v[200:203], a[244:247], a[96:99], v[200:203]
    v_permlane16_swap_b32 v248, v249
    v_mfma_f32_16x16x32_bf16 v[204:207], a[244:247], a[100:103], v[204:207]
    v_max_f32 v248, v248, v249
    v_mov_b32 v249, v248
    v_mfma_f32_16x16x32_bf16 v[208:211], a[244:247], a[104:107], v[208:211]
    s_waitcnt lgkmcnt(4)
    ds_read_b128 a[244:247], v224 offset:34240
    v_mfma_f32_16x16x32_bf16 v[212:215], a[36:39], a[248:251], v[212:215]
    v_permlane32_swap_b32 v248, v249
    v_mfma_f32_16x16x32_bf16 v[216:219], a[40:43], a[248:251], v[216:219]
    v_max_f32 v248, v248, v249
    v_mul_f32 v250, s37, v248
    v_mfma_f32_16x16x32_bf16 v[220:223], a[44:47], a[248:251], v[220:223]
    v_fma_f32 v164, v164, s37, -v250
    v_fma_f32 v165, v165, s37, -v250
    v_mfma_f32_16x16x32_bf16 v[200:203], a[248:251], a[108:111], v[200:203]
    v_fma_f32 v166, v166, s37, -v250
    v_fma_f32 v167, v167, s37, -v250
    v_mfma_f32_16x16x32_bf16 v[204:207], a[248:251], a[112:115], v[204:207]
    v_exp_f32 v164, v164
    v_mfma_f32_16x16x32_bf16 v[208:211], a[248:251], a[116:119], v[208:211]
    s_waitcnt lgkmcnt(1)
    ds_read_b128 a[248:251], v224 offset:34304
    v_fma_f32 v168, v168, s37, -v250
    v_mfma_f32_16x16x32_bf16 v[212:215], a[48:51], a[252:255], v[212:215]
    v_exp_f32 v165, v165
    v_mfma_f32_16x16x32_bf16 v[216:219], a[52:55], a[252:255], v[216:219]
    v_exp_f32 v166, v166
    v_mfma_f32_16x16x32_bf16 v[220:223], a[56:59], a[252:255], v[220:223]
    v_exp_f32 v167, v167
    v_mfma_f32_16x16x32_bf16 v[200:203], a[252:255], a[120:123], v[200:203]
    v_cvt_pk_bf16_f32 v180, v164, v165
    v_cvt_pk_bf16_f32 v181, v166, v167
    v_mfma_f32_16x16x32_bf16 v[204:207], a[252:255], a[124:127], v[204:207]
    ds_read_b128 v[164:167], v228 offset:1280
    v_fma_f32 v169, v169, s37, -v250
    v_mfma_f32_16x16x32_bf16 v[208:211], a[252:255], a[128:131], v[208:211]
    ds_read_b128 a[252:255], v224 offset:34368
    v_fma_f32 v170, v170, s37, -v250
    v_mfma_f32_16x16x32_bf16 v[212:215], a[60:63], v[252:255], v[212:215]
    v_fma_f32 v171, v171, s37, -v250
    v_fma_f32 v172, v172, s37, -v250
    v_mfma_f32_16x16x32_bf16 v[216:219], a[64:67], v[252:255], v[216:219]
    v_exp_f32 v168, v168
    v_mfma_f32_16x16x32_bf16 v[220:223], a[68:71], v[252:255], v[220:223]
    v_exp_f32 v169, v169
    v_mfma_f32_16x16x32_bf16 v[200:203], v[252:255], a[132:135], v[200:203]
    v_exp_f32 v170, v170
    v_mfma_f32_16x16x32_bf16 v[204:207], v[252:255], a[136:139], v[204:207]
    v_cvt_pk_bf16_f32 v12, v212, v213
    v_cvt_pk_bf16_f32 v13, v214, v215
    v_mfma_f32_16x16x32_bf16 v[208:211], v[252:255], a[140:143], v[208:211]
    v_cvt_pk_bf16_f32 v14, v216, v217
    v_cvt_pk_bf16_f32 v15, v218, v219
    v_mfma_f32_16x16x32_bf16 v[212:215], a[0:3], a[232:235], 0
    v_cvt_pk_bf16_f32 v16, v220, v221
    v_cvt_pk_bf16_f32 v17, v222, v223
    v_mfma_f32_16x16x32_bf16 v[216:219], a[4:7], a[232:235], 0
    s_waitcnt lgkmcnt(1)
    v_cvt_pk_bf16_f32 v74, v200, v201
    v_cvt_pk_bf16_f32 v75, v202, v203
    v_mfma_f32_16x16x32_bf16 v[164:167], v[0:3], v[132:135], v[164:167]
    v_cvt_pk_bf16_f32 v96, v204, v205
    v_cvt_pk_bf16_f32 v97, v206, v207
    v_mfma_f32_16x16x32_bf16 v[220:223], a[8:11], a[232:235], 0
    v_cvt_pk_bf16_f32 v118, v208, v209
    v_cvt_pk_bf16_f32 v119, v210, v211
    v_mfma_f32_16x16x32_bf16 v[200:203], a[232:235], a[72:75], 0
    ds_read_b128 v[252:255], v225 offset:11968
    v_cvt_pk_bf16_f32 v182, v168, v169
    v_mfma_f32_16x16x16_bf16 v[164:167], v[4:5], v[136:137], v[164:167]
    v_exp_f32 v171, v171
    v_mfma_f32_16x16x32_bf16 v[204:207], a[232:235], a[76:79], 0
    v_cvt_pk_bf16_f32 v183, v170, v171
    v_fma_f32 v173, v173, s37, -v250
    v_mfma_f32_16x16x32_bf16 v[208:211], a[232:235], a[80:83], 0
    ds_read_b128 v[168:171], v229 offset:1280
    ds_read_b128 a[232:235], v225 offset:12032
    v_mfma_f32_16x16x32_bf16 v[196:199], a[216:219], v[180:183], 0
    v_fma_f32 v174, v174, s37, -v250
    v_fma_f32 v175, v175, s37, -v250
    v_mfma_f32_16x16x32_bf16 v[184:187], v[76:79], v[180:183], 0
    v_exp_f32 v172, v172
    v_mfma_f32_16x16x32_bf16 v[188:191], v[98:101], v[180:183], 0
    v_exp_f32 v173, v173
    v_mfma_f32_16x16x32_bf16 v[192:195], v[120:123], v[180:183], 0
    v_exp_f32 v174, v174
    v_mfma_f32_16x16x32_bf16 v[212:215], a[12:15], a[236:239], v[212:215]
    v_exp_f32 v175, v175
    v_mfma_f32_16x16x32_bf16 v[216:219], a[16:19], a[236:239], v[216:219]
    v_cvt_pk_bf16_f32 v176, v172, v173
    v_cvt_pk_bf16_f32 v177, v174, v175
    v_mfma_f32_16x16x32_bf16 v[220:223], a[20:23], a[236:239], v[220:223]
    ds_read_b128 v[172:175], v229 offset:1920
    v_fma_f32 v144, v144, s37, -v250
    v_mfma_f32_16x16x32_bf16 v[200:203], a[236:239], a[84:87], v[200:203]
    v_fma_f32 v145, v145, s37, -v250
    v_fma_f32 v146, v146, s37, -v250
    v_mfma_f32_16x16x32_bf16 v[204:207], a[236:239], a[88:91], v[204:207]
    s_waitcnt lgkmcnt(2)
    v_fma_f32 v147, v147, s37, -v250
    v_fma_f32 v148, v148, s37, -v250
    v_mfma_f32_16x16x32_bf16 v[168:171], v[24:27], v[132:135], v[168:171]
    v_exp_f32 v144, v144
    v_mfma_f32_16x16x32_bf16 v[208:211], a[236:239], a[92:95], v[208:211]
    ds_read_b128 a[236:239], v225 offset:12096
    v_fma_f32 v149, v149, s37, -v250
    v_mfma_f32_16x16x32_bf16 v[212:215], a[24:27], a[240:243], v[212:215]
    v_exp_f32 v145, v145
    v_mfma_f32_16x16x16_bf16 v[168:171], v[28:29], v[136:137], v[168:171]
    v_exp_f32 v146, v146
    v_mfma_f32_16x16x32_bf16 v[216:219], a[28:31], a[240:243], v[216:219]
    v_exp_f32 v147, v147
    v_mfma_f32_16x16x32_bf16 v[220:223], a[32:35], a[240:243], v[220:223]
    v_cvt_pk_bf16_f32 v178, v144, v145
    v_cvt_pk_bf16_f32 v179, v146, v147
    v_mfma_f32_16x16x32_bf16 v[200:203], a[240:243], a[96:99], v[200:203]
    ds_read_b128 v[144:147], v228 offset:1920
    v_fma_f32 v150, v150, s37, -v250
    v_mfma_f32_16x16x32_bf16 v[196:199], a[216:219], v[176:179], v[196:199]
    v_fma_f32 v151, v151, s37, -v250
    v_fma_f32 v152, v152, s37, -v250
    v_mfma_f32_16x16x32_bf16 v[184:187], v[68:71], v[176:179], v[184:187]
    v_exp_f32 v148, v148
    v_mfma_f32_16x16x32_bf16 v[188:191], v[90:93], v[176:179], v[188:191]
    v_exp_f32 v149, v149
    v_mfma_f32_16x16x32_bf16 v[192:195], v[112:115], v[176:179], v[192:195]
    s_waitcnt lgkmcnt(2)
    v_exp_f32 v150, v150
    v_mfma_f32_16x16x32_bf16 v[172:175], v[30:33], v[132:135], v[172:175]
    v_exp_f32 v151, v151
    v_mfma_f32_16x16x32_bf16 v[204:207], a[240:243], a[100:103], v[204:207]
    v_cvt_pk_bf16_f32 v180, v148, v149
    v_cvt_pk_bf16_f32 v181, v150, v151
    v_mfma_f32_16x16x32_bf16 v[208:211], a[240:243], a[104:107], v[208:211]
    ds_read_b128 v[148:151], v228 offset:2560
    ds_read_b128 a[240:243], v225 offset:12160
    v_mfma_f32_16x16x16_bf16 v[172:175], v[34:35], v[136:137], v[172:175]
    v_fma_f32 v153, v153, s37, -v250
    v_fma_f32 v154, v154, s37, -v250
    v_mfma_f32_16x16x32_bf16 v[212:215], a[36:39], a[244:247], v[212:215]
    s_waitcnt lgkmcnt(2)
    v_fma_f32 v155, v155, s37, -v250
    v_max3_f32 v248, v156, v157, v158
    v_mfma_f32_16x16x32_bf16 v[144:147], v[6:9], v[132:135], v[144:147]
    v_exp_f32 v152, v152
    v_mfma_f32_16x16x32_bf16 v[216:219], a[40:43], a[244:247], v[216:219]
    v_exp_f32 v153, v153
    v_mfma_f32_16x16x32_bf16 v[220:223], a[44:47], a[244:247], v[220:223]
    v_exp_f32 v154, v154
    v_mfma_f32_16x16x32_bf16 v[200:203], a[244:247], a[108:111], v[200:203]
    v_exp_f32 v155, v155
    v_mfma_f32_16x16x16_bf16 v[144:147], v[10:11], v[136:137], v[144:147]
    v_cvt_pk_bf16_f32 v182, v152, v153
    v_cvt_pk_bf16_f32 v183, v154, v155
    v_mfma_f32_16x16x32_bf16 v[204:207], a[244:247], a[112:115], v[204:207]
    ds_read_b128 v[152:155], v229 offset:2560
    v_max3_f32 v249, v159, v160, v161
    v_mfma_f32_16x16x32_bf16 v[196:199], a[216:219], v[180:183], v[196:199]
    v_max3_f32 v248, v248, v162, v163
    v_max3_f32 v249, v249, v164, v165
    v_mfma_f32_16x16x32_bf16 v[184:187], v[84:87], v[180:183], v[184:187]
    v_max3_f32 v248, v248, v166, v167
    v_max3_f32 v249, v249, v168, v169
    v_mfma_f32_16x16x32_bf16 v[188:191], v[106:109], v[180:183], v[188:191]
    v_max3_f32 v248, v248, v170, v171
    v_max3_f32 v249, v249, v172, v173
    v_mfma_f32_16x16x32_bf16 v[192:195], v[128:131], v[180:183], v[192:195]
    s_waitcnt lgkmcnt(1)
    v_rcp_f32 v197, v196
    v_mfma_f32_16x16x32_bf16 v[148:151], v[12:15], v[132:135], v[148:151]
    v_mul_f32 v184, v184, v197
    v_mul_f32 v185, v185, v197
    v_mfma_f32_16x16x32_bf16 v[208:211], a[244:247], a[116:119], v[208:211]
    v_cvt_pk_bf16_f32 v184, v184, v185
    v_mul_f32 v186, v186, v197
    v_mfma_f32_16x16x32_bf16 v[212:215], a[48:51], a[248:251], v[212:215]
    v_mul_f32 v187, v187, v197
    v_cvt_pk_bf16_f32 v185, v186, v187
    v_mfma_f32_16x16x16_bf16 v[148:151], v[16:17], v[136:137], v[148:151]
    v_mul_f32 v188, v188, v197
    v_mul_f32 v189, v189, v197
    v_mfma_f32_16x16x32_bf16 v[216:219], a[52:55], a[248:251], v[216:219]
    v_cvt_pk_bf16_f32 v186, v188, v189
    v_mul_f32 v190, v190, v197
    v_mfma_f32_16x16x32_bf16 v[220:223], a[56:59], a[248:251], v[220:223]
    v_mul_f32 v191, v191, v197
    v_cvt_pk_bf16_f32 v187, v190, v191
    v_mfma_f32_16x16x32_bf16 v[200:203], a[248:251], a[120:123], v[200:203]
    v_mul_f32 v192, v192, v197
    v_mul_f32 v193, v193, v197
    v_mfma_f32_16x16x32_bf16 v[204:207], a[248:251], a[124:127], v[204:207]
    v_cvt_pk_bf16_f32 v188, v192, v193
    v_mul_f32 v194, v194, v197
    v_mfma_f32_16x16x32_bf16 v[208:211], a[248:251], a[128:131], v[208:211]
    ds_read_b128 a[244:247], v225 offset:12224
    v_mul_f32 v195, v195, v197
    v_mfma_f32_16x16x32_bf16 v[212:215], a[60:63], a[252:255], v[212:215]
    ds_read_b128 a[248:251], v225 offset:12288
    v_cvt_pk_bf16_f32 v189, v194, v195
    v_mfma_f32_16x16x32_bf16 v[216:219], a[64:67], a[252:255], v[216:219]
    ds_write_b128 v237, v[184:187] offset:6144
    v_mfma_f32_16x16x32_bf16 v[220:223], a[68:71], a[252:255], v[220:223]
    ds_write_b64 v238, v[188:189] offset:6144
    v_mfma_f32_16x16x32_bf16 v[200:203], a[252:255], a[132:135], v[200:203]
    v_max3_f32 v248, v248, v174, v175
    v_cvt_pk_bf16_f32 v36, v212, v213
    v_mfma_f32_16x16x32_bf16 v[204:207], a[252:255], a[136:139], v[204:207]
    v_cvt_pk_bf16_f32 v37, v214, v215
    v_cvt_pk_bf16_f32 v38, v216, v217
    v_mfma_f32_16x16x32_bf16 v[208:211], a[252:255], a[140:143], v[208:211]
    v_cvt_pk_bf16_f32 v39, v218, v219
    v_cvt_pk_bf16_f32 v40, v220, v221
    v_mfma_f32_16x16x32_bf16 v[212:215], a[144:147], v[252:255], 0
    s_waitcnt lgkmcnt(4)
    v_cvt_pk_bf16_f32 v41, v222, v223
    v_cvt_pk_bf16_f32 v76, v200, v201
    v_mfma_f32_16x16x32_bf16 v[152:155], v[36:39], v[132:135], v[152:155]
    v_cvt_pk_bf16_f32 v77, v202, v203
    v_cvt_pk_bf16_f32 v98, v204, v205
    v_mfma_f32_16x16x32_bf16 v[216:219], a[148:151], v[252:255], 0
    v_cvt_pk_bf16_f32 v99, v206, v207
    v_cvt_pk_bf16_f32 v120, v208, v209
    v_mfma_f32_16x16x32_bf16 v[220:223], a[152:155], v[252:255], 0
    ds_read_b128 a[252:255], v225 offset:24384
    v_cvt_pk_bf16_f32 v121, v210, v211
    v_mfma_f32_16x16x16_bf16 v[152:155], v[40:41], v[136:137], v[152:155]
    s_waitcnt vmcnt(4) lgkmcnt(1)
    ds_read_b128 v[252:255], v225 offset:24448
    v_max3_f32 v249, v249, v144, v145
    v_mfma_f32_16x16x32_bf16 v[212:215], a[156:159], a[232:235], v[212:215]
    s_barrier
    buffer_load_dwordx4 v246, s[4:7], s56 offen lds
    v_mfma_f32_16x16x32_bf16 v[216:219], a[160:163], a[232:235], v[216:219]
    s_add_u32 m0, s42, 0
    v_max3_f32 v248, v248, v146, v147
    v_max3_f32 v249, v249, v148, v149
    v_mfma_f32_16x16x32_bf16 v[220:223], a[164:167], a[232:235], v[220:223]
    ds_read_b128 a[232:235], v225 offset:24512
    v_max3_f32 v248, v248, v150, v151
    v_mfma_f32_16x16x32_bf16 v[212:215], a[168:171], a[236:239], v[212:215]
    buffer_load_dwordx4 v247, s[4:7], s56 offen lds
    v_mfma_f32_16x16x32_bf16 v[216:219], a[172:175], a[236:239], v[216:219]
    s_add_u32 m0, s41, 0x1e40
    v_max3_f32 v249, v249, v152, v153
    v_max3_f32 v248, v248, v154, v155
    v_mfma_f32_16x16x32_bf16 v[220:223], a[176:179], a[236:239], v[220:223]
    ds_read_b128 a[236:239], v225 offset:24576
    v_max_f32 v248, v248, v249
    v_mfma_f32_16x16x32_bf16 v[212:215], a[180:183], a[240:243], v[212:215]
    buffer_load_dwordx4 v246, s[4:7], s46 offen lds
    v_mfma_f32_16x16x32_bf16 v[216:219], a[184:187], a[240:243], v[216:219]
    s_add_u32 m0, s42, 0x1e40
    v_mov_b32 v249, v248
    v_mfma_f32_16x16x32_bf16 v[220:223], a[188:191], a[240:243], v[220:223]
    ds_read_b128 a[240:243], v225 offset:24640
    v_mfma_f32_16x16x32_bf16 v[212:215], a[192:195], a[244:247], v[212:215]
    buffer_load_dwordx4 v247, s[4:7], s46 offen lds
    v_mfma_f32_16x16x32_bf16 v[216:219], a[196:199], a[244:247], v[216:219]
    s_add_u32 m0, s41, 0x3c80
    v_permlane16_swap_b32 v248, v249
    v_mfma_f32_16x16x32_bf16 v[220:223], a[200:203], a[244:247], v[220:223]
    ds_read_b128 a[244:247], v225 offset:24704
    v_max_f32 v248, v248, v249
    v_mfma_f32_16x16x32_bf16 v[212:215], a[204:207], a[248:251], v[212:215]
    v_mov_b32 v249, v248
    v_mfma_f32_16x16x32_bf16 v[216:219], a[208:211], a[248:251], v[216:219]
    v_mfma_f32_16x16x32_bf16 v[220:223], a[212:215], a[248:251], v[220:223]
    s_waitcnt lgkmcnt(3)
    ds_read_b128 a[248:251], v227 offset:37120
    v_mfma_f32_16x16x32_bf16 v[200:203], a[144:147], a[252:255], 0
    v_permlane32_swap_b32 v248, v249
    v_mfma_f32_16x16x32_bf16 v[204:207], a[148:151], a[252:255], 0
    v_max_f32 v248, v248, v249
    v_cvt_pk_bf16_f32 v138, v212, v213
    v_mfma_f32_16x16x32_bf16 v[208:211], a[152:155], a[252:255], 0
    v_cvt_pk_bf16_f32 v139, v214, v215
    v_cvt_pk_bf16_f32 v140, v216, v217
    v_mfma_f32_16x16x32_bf16 v[200:203], a[156:159], v[252:255], v[200:203]
    v_cvt_pk_bf16_f32 v141, v218, v219
    v_cvt_pk_bf16_f32 v142, v220, v221
    v_mfma_f32_16x16x32_bf16 v[204:207], a[160:163], v[252:255], v[204:207]
    ds_read_b128 a[252:255], v227 offset:37184
    v_cvt_pk_bf16_f32 v143, v222, v223
    v_mfma_f32_16x16x32_bf16 v[208:211], a[164:167], v[252:255], v[208:211]
    ds_read_b128 v[252:255], v227 offset:37248
    v_mul_f32 v250, s37, v248
    v_mfma_f32_16x16x32_bf16 v[200:203], a[168:171], a[232:235], v[200:203]
    v_fma_f32 v156, v156, s37, -v250
    v_fma_f32 v157, v157, s37, -v250
    v_mfma_f32_16x16x32_bf16 v[204:207], a[172:175], a[232:235], v[204:207]
    v_fma_f32 v158, v158, s37, -v250
    v_fma_f32 v159, v159, s37, -v250
    v_mfma_f32_16x16x32_bf16 v[208:211], a[176:179], a[232:235], v[208:211]
    s_waitcnt lgkmcnt(3)
    ds_read_b128 a[232:235], v227 offset:37312
    v_fma_f32 v160, v160, s37, -v250
    v_mfma_f32_16x16x32_bf16 v[200:203], a[180:183], a[236:239], v[200:203]
    v_exp_f32 v156, v156
    v_mfma_f32_16x16x32_bf16 v[204:207], a[184:187], a[236:239], v[204:207]
    v_exp_f32 v157, v157
    v_mfma_f32_16x16x32_bf16 v[208:211], a[188:191], a[236:239], v[208:211]
    ds_read_b128 a[236:239], v227 offset:37376
    v_cvt_pk_bf16_f32 v176, v156, v157
    v_mfma_f32_16x16x32_bf16 v[200:203], a[192:195], a[240:243], v[200:203]
    v_exp_f32 v158, v158
    v_mfma_f32_16x16x32_bf16 v[204:207], a[196:199], a[240:243], v[204:207]
    v_exp_f32 v159, v159
    v_mfma_f32_16x16x32_bf16 v[208:211], a[200:203], a[240:243], v[208:211]
    ds_read_b128 a[240:243], v227 offset:37440
    v_cvt_pk_bf16_f32 v177, v158, v159
    v_mfma_f32_16x16x32_bf16 v[200:203], a[204:207], a[244:247], v[200:203]
    ds_read_b128 v[156:159], v230 offset:2560
    v_fma_f32 v161, v161, s37, -v250
    v_mfma_f32_16x16x32_bf16 v[204:207], a[208:211], a[244:247], v[204:207]
    v_fma_f32 v162, v162, s37, -v250
    v_fma_f32 v163, v163, s37, -v250
    v_mfma_f32_16x16x32_bf16 v[208:211], a[212:215], a[244:247], v[208:211]
    s_waitcnt lgkmcnt(4)
    ds_read_b128 a[244:247], v239
    v_fma_f32 v164, v164, s37, -v250
    v_mfma_f32_16x16x32_bf16 v[212:215], a[0:3], a[248:251], 0
    v_cvt_pk_bf16_f32 v132, v200, v201
    v_cvt_pk_bf16_f32 v133, v202, v203
    v_mfma_f32_16x16x32_bf16 v[216:219], a[4:7], a[248:251], 0
    v_cvt_pk_bf16_f32 v134, v204, v205
    v_cvt_pk_bf16_f32 v135, v206, v207
    v_mfma_f32_16x16x32_bf16 v[220:223], a[8:11], a[248:251], 0
    v_cvt_pk_bf16_f32 v136, v208, v209
    v_cvt_pk_bf16_f32 v137, v210, v211
    v_mfma_f32_16x16x32_bf16 v[200:203], a[248:251], a[72:75], 0
    v_exp_f32 v160, v160
    v_mfma_f32_16x16x32_bf16 v[204:207], a[248:251], a[76:79], 0
    v_exp_f32 v161, v161
    v_mfma_f32_16x16x32_bf16 v[208:211], a[248:251], a[80:83], 0
    ds_read_b128 a[248:251], v239 offset:6144
    v_cvt_pk_bf16_f32 v178, v160, v161
    v_mfma_f32_16x16x32_bf16 v[212:215], a[12:15], a[252:255], v[212:215]
    s_waitcnt lgkmcnt(2)
    v_exp_f32 v162, v162
    v_mfma_f32_16x16x32_bf16 v[156:159], v[36:39], v[138:141], v[156:159]
    v_exp_f32 v163, v163
    v_mfma_f32_16x16x32_bf16 v[216:219], a[16:19], a[252:255], v[216:219]
    v_cvt_pk_bf16_f32 v179, v162, v163
    v_fma_f32 v165, v165, s37, -v250
    v_mfma_f32_16x16x32_bf16 v[220:223], a[20:23], a[252:255], v[220:223]
    ds_read_b128 v[160:163], v230 offset:640
    v_fma_f32 v166, v166, s37, -v250
    v_mfma_f32_16x16x32_bf16 v[196:199], a[216:219], v[176:179], 0
    v_fma_f32 v167, v167, s37, -v250
    v_fma_f32 v168, v168, s37, -v250
    v_mfma_f32_16x16x32_bf16 v[184:187], v[78:81], v[176:179], 0
    v_exp_f32 v164, v164
    v_mfma_f32_16x16x32_bf16 v[188:191], v[100:103], v[176:179], 0
    v_exp_f32 v165, v165
    v_mfma_f32_16x16x32_bf16 v[192:195], v[122:125], v[176:179], 0
    v_exp_f32 v166, v166
    v_mfma_f32_16x16x16_bf16 v[156:159], v[40:41], v[142:143], v[156:159]
    v_exp_f32 v167, v167
    v_mfma_f32_16x16x32_bf16 v[200:203], a[252:255], a[84:87], v[200:203]
    v_cvt_pk_bf16_f32 v180, v164, v165
    v_cvt_pk_bf16_f32 v181, v166, v167
    v_mfma_f32_16x16x32_bf16 v[204:207], a[252:255], a[88:91], v[204:207]
    ds_read_b128 v[164:167], v230 offset:1280
    v_fma_f32 v169, v169, s37, -v250
    v_mfma_f32_16x16x32_bf16 v[208:211], a[252:255], a[92:95], v[208:211]
    ds_read_b128 a[252:255], v239 offset:1024
    v_fma_f32 v170, v170, s37, -v250
    v_mfma_f32_16x16x32_bf16 v[212:215], a[24:27], v[252:255], v[212:215]
    s_waitcnt lgkmcnt(2)
    v_fma_f32 v171, v171, s37, -v250
    v_fma_f32 v172, v172, s37, -v250
    v_mfma_f32_16x16x32_bf16 v[160:163], v[42:45], v[138:141], v[160:163]
    v_exp_f32 v168, v168
    v_mfma_f32_16x16x32_bf16 v[216:219], a[28:31], v[252:255], v[216:219]
    v_exp_f32 v169, v169
    v_mfma_f32_16x16x32_bf16 v[220:223], a[32:35], v[252:255], v[220:223]
    v_exp_f32 v170, v170
    v_mfma_f32_16x16x32_bf16 v[200:203], v[252:255], a[96:99], v[200:203]
    v_exp_f32 v171, v171
    v_mfma_f32_16x16x16_bf16 v[160:163], v[46:47], v[142:143], v[160:163]
    v_cvt_pk_bf16_f32 v182, v168, v169
    v_cvt_pk_bf16_f32 v183, v170, v171
    v_mfma_f32_16x16x32_bf16 v[204:207], v[252:255], a[100:103], v[204:207]
    ds_read_b128 v[168:171], v230 offset:1920
    v_fma_f32 v173, v173, s37, -v250
    v_mfma_f32_16x16x32_bf16 v[196:199], a[216:219], v[180:183], v[196:199]
    v_fma_f32 v174, v174, s37, -v250
    v_fma_f32 v175, v175, s37, -v250
    v_mfma_f32_16x16x32_bf16 v[184:187], v[66:69], v[180:183], v[184:187]
    v_exp_f32 v172, v172
    v_mfma_f32_16x16x32_bf16 v[188:191], v[88:91], v[180:183], v[188:191]
    v_exp_f32 v173, v173
    v_mfma_f32_16x16x32_bf16 v[192:195], v[110:113], v[180:183], v[192:195]
    s_waitcnt lgkmcnt(1)
    v_exp_f32 v174, v174
    v_mfma_f32_16x16x32_bf16 v[164:167], v[24:27], v[138:141], v[164:167]
    v_exp_f32 v175, v175
    v_mfma_f32_16x16x32_bf16 v[208:211], v[252:255], a[104:107], v[208:211]
    ds_read_b128 v[252:255], v239 offset:7168
    v_cvt_pk_bf16_f32 v176, v172, v173
    v_mfma_f32_16x16x32_bf16 v[212:215], a[36:39], a[232:235], v[212:215]
    v_cvt_pk_bf16_f32 v177, v174, v175
    v_fma_f32 v144, v144, s37, -v250
    v_mfma_f32_16x16x16_bf16 v[164:167], v[28:29], v[142:143], v[164:167]
    ds_read_b128 v[172:175], v235
    v_bfe_u32 v235, s69, v233, 4
    v_mfma_f32_16x16x32_bf16 v[216:219], a[40:43], a[232:235], v[216:219]
    s_waitcnt lgkmcnt(2)
    v_mad_u32_u24 v235, v235, s40, v231
    v_fma_f32 v145, v145, s37, -v250
    v_mfma_f32_16x16x32_bf16 v[168:171], v[30:33], v[138:141], v[168:171]
    v_fma_f32 v146, v146, s37, -v250
    v_fma_f32 v147, v147, s37, -v250
    v_mfma_f32_16x16x32_bf16 v[220:223], a[44:47], a[232:235], v[220:223]
    v_exp_f32 v144, v144
    v_mfma_f32_16x16x32_bf16 v[200:203], a[232:235], a[108:111], v[200:203]
    v_exp_f32 v145, v145
    v_mfma_f32_16x16x16_bf16 v[168:171], v[34:35], v[142:143], v[168:171]
    v_exp_f32 v146, v146
    v_mfma_f32_16x16x32_bf16 v[204:207], a[232:235], a[112:115], v[204:207]
    v_exp_f32 v147, v147
    v_mfma_f32_16x16x32_bf16 v[208:211], a[232:235], a[116:119], v[208:211]
    ds_read_b64_tr_b16 a[232:233], v240 offset:12288
    ds_read_b64_tr_b16 a[234:235], v240 offset:26112
    v_mfma_f32_16x16x32_bf16 v[212:215], a[48:51], a[236:239], v[212:215]
    v_cvt_pk_bf16_f32 v178, v144, v145
    v_cvt_pk_bf16_f32 v179, v146, v147
    v_mfma_f32_16x16x32_bf16 v[216:219], a[52:55], a[236:239], v[216:219]
    ds_read_b128 v[144:147], v236
    v_bfe_u32 v236, s70, v233, 4
    v_mfma_f32_16x16x32_bf16 v[196:199], a[216:219], v[176:179], v[196:199]
    v_mad_u32_u24 v236, v236, s40, v231
    v_fma_f32 v148, v148, s37, -v250
    v_mfma_f32_16x16x32_bf16 v[184:187], v[70:73], v[176:179], v[184:187]
    v_fma_f32 v149, v149, s37, -v250
    v_fma_f32 v150, v150, s37, -v250
    v_mfma_f32_16x16x32_bf16 v[188:191], v[92:95], v[176:179], v[188:191]
    v_fma_f32 v151, v151, s37, -v250
    v_fma_f32 v152, v152, s37, -v250
    v_mfma_f32_16x16x32_bf16 v[192:195], v[114:117], v[176:179], v[192:195]
    s_waitcnt lgkmcnt(3)
    v_exp_f32 v148, v148
    v_mfma_f32_16x16x32_bf16 v[172:175], v[54:57], v[138:141], v[172:175]
    v_exp_f32 v149, v149
    v_mfma_f32_16x16x32_bf16 v[220:223], a[56:59], a[236:239], v[220:223]
    v_exp_f32 v150, v150
    v_mfma_f32_16x16x32_bf16 v[200:203], a[236:239], a[120:123], v[200:203]
    v_exp_f32 v151, v151
    v_mfma_f32_16x16x32_bf16 v[204:207], a[236:239], a[124:127], v[204:207]
    v_cvt_pk_bf16_f32 v180, v148, v149
    v_cvt_pk_bf16_f32 v181, v150, v151
    v_mfma_f32_16x16x16_bf16 v[172:175], v[58:59], v[142:143], v[172:175]
    s_waitcnt lgkmcnt(0)
    ds_read_b128 v[148:151], v234
    v_bfe_u32 v234, s73, v232, 4
    v_mfma_f32_16x16x32_bf16 v[144:147], v[60:63], v[138:141], v[144:147]
    v_fma_f32 v153, v153, s37, -v250
    v_fma_f32 v154, v154, s37, -v250
    v_mfma_f32_16x16x32_bf16 v[208:211], a[236:239], a[128:131], v[208:211]
    ds_read_b64_tr_b16 a[236:237], v240 offset:12296
    ds_read_b64_tr_b16 a[238:239], v240 offset:26120
    v_mfma_f32_16x16x32_bf16 v[212:215], a[60:63], a[240:243], v[212:215]
    v_fma_f32 v155, v155, s37, -v250
    v_max3_f32 v248, v156, v157, v158
    v_mfma_f32_16x16x16_bf16 v[144:147], v[64:65], v[142:143], v[144:147]
    v_exp_f32 v152, v152
    v_mfma_f32_16x16x32_bf16 v[216:219], a[64:67], a[240:243], v[216:219]
    v_exp_f32 v153, v153
    v_mfma_f32_16x16x32_bf16 v[220:223], a[68:71], a[240:243], v[220:223]
    v_exp_f32 v154, v154
    v_mfma_f32_16x16x32_bf16 v[200:203], a[240:243], a[132:135], v[200:203]
    v_cvt_pk_bf16_f32 v48, v212, v213
    v_cvt_pk_bf16_f32 v49, v214, v215
    v_mfma_f32_16x16x32_bf16 v[204:207], a[240:243], a[136:139], v[204:207]
    v_exp_f32 v155, v155
    v_mfma_f32_16x16x32_bf16 v[208:211], a[240:243], a[140:143], v[208:211]
    v_cvt_pk_bf16_f32 v50, v216, v217
    v_cvt_pk_bf16_f32 v51, v218, v219
    v_mfma_f32_16x16x32_bf16 v[212:215], a[220:223], a[244:247], 0
    s_waitcnt lgkmcnt(2)
    v_cvt_pk_bf16_f32 v52, v220, v221
    v_cvt_pk_bf16_f32 v53, v222, v223
    v_mfma_f32_16x16x32_bf16 v[148:151], v[48:51], v[138:141], v[148:151]
    v_cvt_pk_bf16_f32 v82, v200, v201
    v_cvt_pk_bf16_f32 v83, v202, v203
    v_mfma_f32_16x16x32_bf16 v[200:203], a[220:223], a[248:251], 0
    v_cvt_pk_bf16_f32 v104, v204, v205
    v_cvt_pk_bf16_f32 v105, v206, v207
    v_mfma_f32_16x16x32_bf16 v[216:219], a[224:227], a[244:247], 0
    v_cvt_pk_bf16_f32 v126, v208, v209
    v_cvt_pk_bf16_f32 v127, v210, v211
    v_mfma_f32_16x16x16_bf16 v[148:151], v[52:53], v[142:143], v[148:151]
    ds_read_b64_tr_b16 a[240:241], v241 offset:12288
    ds_read_b64_tr_b16 a[242:243], v241 offset:26112
    v_mfma_f32_16x16x32_bf16 v[204:207], a[224:227], a[248:251], 0
    v_cvt_pk_bf16_f32 v182, v152, v153
    v_cvt_pk_bf16_f32 v183, v154, v155
    v_mfma_f32_16x16x32_bf16 v[220:223], a[228:231], a[244:247], 0
    ds_read_b128 a[244:247], v239 offset:2048
    ds_read_b128 v[152:155], v228 offset:640
    v_mfma_f32_16x16x32_bf16 v[196:199], a[216:219], v[180:183], v[196:199]
    v_max3_f32 v249, v159, v160, v161
    v_max3_f32 v248, v248, v162, v163
    v_mfma_f32_16x16x32_bf16 v[184:187], v[74:77], v[180:183], v[184:187]
    v_max3_f32 v249, v249, v164, v165
    v_max3_f32 v248, v248, v166, v167
    v_mfma_f32_16x16x32_bf16 v[188:191], v[96:99], v[180:183], v[188:191]
    v_max3_f32 v249, v249, v168, v169
    v_max3_f32 v248, v248, v170, v171
    v_mfma_f32_16x16x32_bf16 v[192:195], v[118:121], v[180:183], v[192:195]
    v_rcp_f32 v197, v196
    v_mfma_f32_16x16x32_bf16 v[208:211], a[228:231], a[248:251], 0
    ds_read_b128 a[248:251], v239 offset:8192
    v_mul_f32 v184, v184, v197
    v_mfma_f32_16x16x32_bf16 v[212:215], a[232:235], a[252:255], v[212:215]
    v_mul_f32 v185, v185, v197
    v_cvt_pk_bf16_f32 v184, v184, v185
    v_mfma_f32_16x16x32_bf16 v[200:203], a[232:235], v[252:255], v[200:203]
    s_waitcnt lgkmcnt(4)
    ds_read_b64_tr_b16 a[232:233], v241 offset:13824
    ds_read_b64_tr_b16 a[234:235], v241 offset:24576
    v_mfma_f32_16x16x32_bf16 v[216:219], a[236:239], a[252:255], v[216:219]
    v_mul_f32 v186, v186, v197
    v_mul_f32 v187, v187, v197
    v_mfma_f32_16x16x32_bf16 v[204:207], a[236:239], v[252:255], v[204:207]
    s_waitcnt lgkmcnt(5)
    ds_read_b128 a[236:239], v239 offset:3072
    v_cvt_pk_bf16_f32 v185, v186, v187
    v_mfma_f32_16x16x32_bf16 v[220:223], a[240:243], a[252:255], v[220:223]
    s_waitcnt lgkmcnt(4)
    ds_read_b64_tr_b16 a[252:253], v240 offset:13824
    ds_read_b64_tr_b16 a[254:255], v240 offset:24576
    v_mfma_f32_16x16x32_bf16 v[152:155], v[0:3], v[132:135], v[152:155]
    v_mul_f32 v188, v188, v197
    v_mul_f32 v189, v189, v197
    v_mfma_f32_16x16x32_bf16 v[208:211], a[240:243], v[252:255], v[208:211]
    ds_read_b64_tr_b16 v[252:253], v240 offset:13832
    ds_read_b64_tr_b16 v[254:255], v240 offset:24584
    ds_read_b128 a[240:243], v239 offset:9216
    v_mfma_f32_16x16x16_bf16 v[152:155], v[4:5], v[136:137], v[152:155]
    s_waitcnt lgkmcnt(6)
    v_cvt_pk_bf16_f32 v186, v188, v189
    v_mul_f32 v190, v190, v197
    v_mul_f32 v191, v191, v197
    v_cvt_pk_bf16_f32 v187, v190, v191
    v_mul_f32 v192, v192, v197
    v_mul_f32 v193, v193, v197
    v_cvt_pk_bf16_f32 v188, v192, v193
    v_mfma_f32_16x16x32_bf16 v[220:223], a[232:235], a[244:247], v[220:223]
    v_mul_f32 v194, v194, v197
    v_mul_f32 v195, v195, v197
    v_mfma_f32_16x16x32_bf16 v[208:211], a[232:235], a[248:251], v[208:211]
    s_waitcnt lgkmcnt(3)
    ds_read_b128 a[232:235], v239 offset:10240
    v_cvt_pk_bf16_f32 v189, v194, v195
    ds_write_b128 v237, v[184:187] offset:12288
    ds_write_b64 v238, v[188:189] offset:12288
    v_mfma_f32_16x16x32_bf16 v[212:215], a[252:255], a[244:247], v[212:215]
    v_max3_f32 v249, v249, v172, v173
    v_max3_f32 v248, v248, v174, v175
    v_mfma_f32_16x16x32_bf16 v[200:203], a[252:255], a[248:251], v[200:203]
    s_waitcnt lgkmcnt(4)
    ds_read_b64_tr_b16 a[252:253], v241 offset:36864
    ds_read_b64_tr_b16 a[254:255], v241 offset:38400
    v_mfma_f32_16x16x32_bf16 v[216:219], v[252:255], a[244:247], v[216:219]
    ds_read_b64_tr_b16 a[244:245], v240 offset:36864
    ds_read_b64_tr_b16 a[246:247], v240 offset:38400
    v_mfma_f32_16x16x32_bf16 v[204:207], v[252:255], a[248:251], v[204:207]
    s_waitcnt lgkmcnt(2)
    ds_read_b64_tr_b16 a[248:249], v240 offset:36872
    ds_read_b64_tr_b16 a[250:251], v240 offset:38408
    v_max3_f32 v249, v249, v144, v145
    v_max3_f32 v248, v248, v146, v147
    ds_read_b128 v[252:255], v239 offset:4096
    v_max3_f32 v249, v249, v148, v149
    v_max3_f32 v248, v248, v150, v151
    v_max_f32 v248, v248, v249
    v_mov_b32 v249, v248
    s_nop 1
    v_permlane16_swap_b32 v248, v249
    v_max_f32 v248, v248, v249
    v_mov_b32 v249, v248
    s_nop 1
    v_permlane32_swap_b32 v248, v249
    v_max_f32 v248, v248, v249
    v_mul_f32 v250, s37, v248
    v_fma_f32 v156, v156, s37, -v250
    v_mfma_f32_16x16x32_bf16 v[220:223], a[252:255], a[236:239], v[220:223]
    v_fma_f32 v157, v157, s37, -v250
    v_fma_f32 v158, v158, s37, -v250
    v_mfma_f32_16x16x32_bf16 v[208:211], a[252:255], a[240:243], v[208:211]
    s_waitcnt lgkmcnt(3)
    ds_read_b128 a[252:255], v239 offset:11264
    v_fma_f32 v159, v159, s37, -v250
    v_mfma_f32_16x16x32_bf16 v[212:215], a[244:247], a[236:239], v[212:215]
    v_exp_f32 v156, v156
    v_mfma_f32_16x16x32_bf16 v[200:203], a[244:247], a[240:243], v[200:203]
    s_waitcnt lgkmcnt(2)
    ds_read_b64_tr_b16 a[244:245], v241 offset:49152
    ds_read_b64_tr_b16 a[246:247], v241 offset:62976
    v_mfma_f32_16x16x32_bf16 v[216:219], a[248:251], a[236:239], v[216:219]
    ds_read_b64_tr_b16 a[236:237], v240 offset:49152
    ds_read_b64_tr_b16 a[238:239], v240 offset:62976
    v_mfma_f32_16x16x32_bf16 v[204:207], a[248:251], a[240:243], v[204:207]
    s_waitcnt lgkmcnt(2)
    ds_read_b64_tr_b16 a[240:241], v240 offset:49160
    ds_read_b64_tr_b16 a[242:243], v240 offset:62984
    v_exp_f32 v157, v157
    ds_read_b128 a[248:251], v239 offset:5120
    v_exp_f32 v158, v158
    v_exp_f32 v159, v159
    v_cvt_pk_bf16_f32 v176, v156, v157
    v_cvt_pk_bf16_f32 v177, v158, v159
    ds_read_b128 v[156:159], v229 offset:640
    v_fma_f32 v160, v160, s37, -v250
    v_fma_f32 v161, v161, s37, -v250
    v_fma_f32 v162, v162, s37, -v250
    v_fma_f32 v163, v163, s37, -v250
    v_exp_f32 v160, v160
    v_exp_f32 v161, v161
    v_mfma_f32_16x16x32_bf16 v[220:223], a[244:247], v[252:255], v[220:223]
    v_exp_f32 v162, v162
    v_mfma_f32_16x16x32_bf16 v[208:211], a[244:247], a[232:235], v[208:211]
    s_waitcnt lgkmcnt(4)
    ds_read_b128 a[244:247], v224 offset:46528
    v_cvt_pk_bf16_f32 v178, v160, v161
    v_mfma_f32_16x16x32_bf16 v[212:215], a[236:239], v[252:255], v[212:215]
    v_exp_f32 v163, v163
    v_mfma_f32_16x16x32_bf16 v[200:203], a[236:239], a[232:235], v[200:203]
    s_waitcnt lgkmcnt(3)
    ds_read_b64_tr_b16 a[236:237], v241 offset:50688
    ds_read_b64_tr_b16 a[238:239], v241 offset:61440
    v_mfma_f32_16x16x32_bf16 v[216:219], a[240:243], v[252:255], v[216:219]
    ds_read_b64_tr_b16 v[252:253], v240 offset:50688
    ds_read_b64_tr_b16 v[254:255], v240 offset:61440
    v_mfma_f32_16x16x32_bf16 v[204:207], a[240:243], a[232:235], v[204:207]
    ds_read_b64_tr_b16 a[232:233], v240 offset:50696
    ds_read_b64_tr_b16 a[234:235], v240 offset:61448
    v_cvt_pk_bf16_f32 v179, v162, v163
    v_fma_f32 v164, v164, s37, -v250
    ds_read_b128 a[240:243], v224 offset:46464
    v_mfma_f32_16x16x32_bf16 v[196:199], a[216:219], v[176:179], 0
    ds_read_b128 v[160:163], v229 offset:1280
    v_fma_f32 v165, v165, s37, -v250
    v_mfma_f32_16x16x32_bf16 v[184:187], v[76:79], v[176:179], 0
    v_fma_f32 v166, v166, s37, -v250
    v_fma_f32 v167, v167, s37, -v250
    v_mfma_f32_16x16x32_bf16 v[188:191], v[98:101], v[176:179], 0
    v_exp_f32 v164, v164
    v_mfma_f32_16x16x32_bf16 v[192:195], v[120:123], v[176:179], 0
    s_waitcnt lgkmcnt(9)
    v_exp_f32 v165, v165
    v_mfma_f32_16x16x32_bf16 v[156:159], v[24:27], v[132:135], v[156:159]
    s_waitcnt lgkmcnt(6)
    v_exp_f32 v166, v166
    v_mfma_f32_16x16x32_bf16 v[220:223], a[236:239], a[248:251], v[220:223]
    v_exp_f32 v167, v167
    v_mfma_f32_16x16x32_bf16 v[208:211], a[236:239], a[252:255], v[208:211]
    ds_read_b128 a[236:239], v224 offset:49536
    v_cvt_pk_bf16_f32 v180, v164, v165
    v_mfma_f32_16x16x16_bf16 v[156:159], v[28:29], v[136:137], v[156:159]
    s_waitcnt lgkmcnt(5)
    v_cvt_pk_bf16_f32 v181, v166, v167
    v_fma_f32 v168, v168, s37, -v250
    v_mfma_f32_16x16x32_bf16 v[212:215], v[252:255], a[248:251], v[212:215]
    ds_read_b128 v[164:167], v228 offset:1280
    v_cvt_pk_bf16_f32 v220, v220, v221
    v_mfma_f32_16x16x32_bf16 v[200:203], v[252:255], a[252:255], v[200:203]
    s_waitcnt lgkmcnt(4)
    v_cvt_pk_bf16_f32 v221, v222, v223
    v_cvt_pk_bf16_f32 v208, v208, v209
    v_mfma_f32_16x16x32_bf16 v[216:219], a[232:235], a[248:251], v[216:219]
    s_waitcnt lgkmcnt(2)
    buffer_store_dwordx2 v[220:221], v243, s[20:23], s58 offen sc0 sc1
    v_mfma_f32_16x16x32_bf16 v[160:163], v[30:33], v[132:135], v[160:163]
    v_cvt_pk_bf16_f32 v212, v212, v213
    v_cvt_pk_bf16_f32 v213, v214, v215
    v_mfma_f32_16x16x32_bf16 v[204:207], a[232:235], a[252:255], v[204:207]
    v_cvt_pk_bf16_f32 v200, v200, v201
    v_cvt_pk_bf16_f32 v201, v202, v203
    v_mfma_f32_16x16x32_bf16 v[220:223], a[8:11], a[240:243], 0
    v_cvt_pk_bf16_f32 v214, v216, v217
    v_cvt_pk_bf16_f32 v215, v218, v219
    v_mfma_f32_16x16x16_bf16 v[160:163], v[34:35], v[136:137], v[160:163]
    buffer_store_dwordx4 v[212:215], v242, s[20:23], s58 offen sc0 sc1
    v_mfma_f32_16x16x32_bf16 v[216:219], a[4:7], a[240:243], 0
    s_add_u32 s58, s51, 0xfc000
    v_cvt_pk_bf16_f32 v202, v204, v205
    v_cvt_pk_bf16_f32 v203, v206, v207
    v_mfma_f32_16x16x32_bf16 v[212:215], a[0:3], a[240:243], 0
    s_waitcnt lgkmcnt(0)
    buffer_store_dwordx4 v[200:203], v244, s[20:23], s59 offen sc0 sc1
    v_mfma_f32_16x16x32_bf16 v[164:167], v[6:9], v[132:135], v[164:167]
    ds_read_b128 a[248:251], v224 offset:46592
    v_cvt_pk_bf16_f32 v209, v210, v211
    v_mfma_f32_16x16x32_bf16 v[200:203], a[240:243], a[72:75], 0
    buffer_store_dwordx2 v[208:209], v245, s[20:23], s59 offen sc0 sc1
    v_mfma_f32_16x16x32_bf16 v[204:207], a[240:243], a[76:79], 0
    s_add_u32 s59, s51, 0xfd800
    ds_read_b128 a[252:255], v224 offset:46656
    ds_read_b128 v[252:255], v224 offset:46720
    v_mfma_f32_16x16x16_bf16 v[164:167], v[10:11], v[136:137], v[164:167]
    ds_read_b128 a[232:235], v224 offset:46784
    v_fma_f32 v169, v169, s37, -v250
    v_mfma_f32_16x16x32_bf16 v[208:211], a[240:243], a[80:83], 0
    ds_read_b128 a[240:243], v224 offset:49600
    v_fma_f32 v170, v170, s37, -v250
    v_mfma_f32_16x16x32_bf16 v[212:215], a[12:15], a[244:247], v[212:215]
    v_fma_f32 v171, v171, s37, -v250
    v_fma_f32 v172, v172, s37, -v250
    v_mfma_f32_16x16x32_bf16 v[216:219], a[16:19], a[244:247], v[216:219]
    v_exp_f32 v168, v168
    v_mfma_f32_16x16x32_bf16 v[220:223], a[20:23], a[244:247], v[220:223]
    v_exp_f32 v169, v169
    v_mfma_f32_16x16x32_bf16 v[200:203], a[244:247], a[84:87], v[200:203]
    v_exp_f32 v170, v170
    v_mfma_f32_16x16x32_bf16 v[204:207], a[244:247], a[88:91], v[204:207]
    v_exp_f32 v171, v171
    v_mfma_f32_16x16x32_bf16 v[208:211], a[244:247], a[92:95], v[208:211]
    s_waitcnt lgkmcnt(4)
    ds_read_b128 a[244:247], v224 offset:49664
    v_cvt_pk_bf16_f32 v182, v168, v169
    v_mfma_f32_16x16x32_bf16 v[212:215], a[24:27], a[248:251], v[212:215]
    v_cvt_pk_bf16_f32 v183, v170, v171
    v_fma_f32 v173, v173, s37, -v250
    v_mfma_f32_16x16x32_bf16 v[216:219], a[28:31], a[248:251], v[216:219]
    ds_read_b128 v[168:171], v228 offset:1920
    v_fma_f32 v174, v174, s37, -v250
    v_mfma_f32_16x16x32_bf16 v[196:199], a[216:219], v[180:183], v[196:199]
    v_fma_f32 v175, v175, s37, -v250
    v_fma_f32 v144, v144, s37, -v250
    v_mfma_f32_16x16x32_bf16 v[184:187], v[68:71], v[180:183], v[184:187]
    v_exp_f32 v172, v172
    v_mfma_f32_16x16x32_bf16 v[188:191], v[90:93], v[180:183], v[188:191]
    v_exp_f32 v173, v173
    v_mfma_f32_16x16x32_bf16 v[192:195], v[112:115], v[180:183], v[192:195]
    v_exp_f32 v174, v174
    v_mfma_f32_16x16x32_bf16 v[220:223], a[32:35], a[248:251], v[220:223]
    v_exp_f32 v175, v175
    v_mfma_f32_16x16x32_bf16 v[200:203], a[248:251], a[96:99], v[200:203]
    v_cvt_pk_bf16_f32 v176, v172, v173
    v_cvt_pk_bf16_f32 v177, v174, v175
    v_mfma_f32_16x16x32_bf16 v[204:207], a[248:251], a[100:103], v[204:207]
    ds_read_b128 v[172:175], v229 offset:1920
    v_fma_f32 v145, v145, s37, -v250
    v_mfma_f32_16x16x32_bf16 v[208:211], a[248:251], a[104:107], v[208:211]
    s_waitcnt lgkmcnt(2)
    ds_read_b128 a[248:251], v224 offset:49728
    v_fma_f32 v146, v146, s37, -v250
    v_mfma_f32_16x16x32_bf16 v[212:215], a[36:39], a[252:255], v[212:215]
    s_waitcnt lgkmcnt(2)
    v_fma_f32 v147, v147, s37, -v250
    v_fma_f32 v148, v148, s37, -v250
    v_mfma_f32_16x16x32_bf16 v[168:171], v[12:15], v[132:135], v[168:171]
    v_exp_f32 v144, v144
    v_mfma_f32_16x16x32_bf16 v[216:219], a[40:43], a[252:255], v[216:219]
    v_exp_f32 v145, v145
    v_mfma_f32_16x16x32_bf16 v[220:223], a[44:47], a[252:255], v[220:223]
    v_exp_f32 v146, v146
    v_mfma_f32_16x16x32_bf16 v[200:203], a[252:255], a[108:111], v[200:203]
    v_exp_f32 v147, v147
    v_mfma_f32_16x16x16_bf16 v[168:171], v[16:17], v[136:137], v[168:171]
    v_cvt_pk_bf16_f32 v178, v144, v145
    v_cvt_pk_bf16_f32 v179, v146, v147
    v_mfma_f32_16x16x32_bf16 v[204:207], a[252:255], a[112:115], v[204:207]
    ds_read_b128 v[144:147], v229 offset:2560
    v_fma_f32 v149, v149, s37, -v250
    v_mfma_f32_16x16x32_bf16 v[196:199], a[216:219], v[176:179], v[196:199]
    v_fma_f32 v150, v150, s37, -v250
    v_fma_f32 v151, v151, s37, -v250
    v_mfma_f32_16x16x32_bf16 v[184:187], v[84:87], v[176:179], v[184:187]
    v_exp_f32 v148, v148
    v_mfma_f32_16x16x32_bf16 v[188:191], v[106:109], v[176:179], v[188:191]
    v_exp_f32 v149, v149
    v_mfma_f32_16x16x32_bf16 v[192:195], v[128:131], v[176:179], v[192:195]
    s_waitcnt lgkmcnt(1)
    v_exp_f32 v150, v150
    v_mfma_f32_16x16x32_bf16 v[172:175], v[36:39], v[132:135], v[172:175]
    v_exp_f32 v151, v151
    v_mfma_f32_16x16x32_bf16 v[208:211], a[252:255], a[116:119], v[208:211]
    ds_read_b128 a[252:255], v224 offset:49792
    v_cvt_pk_bf16_f32 v180, v148, v149
    v_mfma_f32_16x16x32_bf16 v[212:215], a[48:51], v[252:255], v[212:215]
    v_cvt_pk_bf16_f32 v181, v150, v151
    v_max3_f32 v248, v152, v153, v154
    v_mfma_f32_16x16x16_bf16 v[172:175], v[40:41], v[136:137], v[172:175]
    ds_read_b128 v[148:151], v228 offset:2560
    v_max3_f32 v249, v155, v156, v157
    v_mfma_f32_16x16x16_bf16 v[196:199], a[216:217], v[180:181], v[196:199]
    v_max3_f32 v248, v248, v158, v159
    v_max3_f32 v249, v249, v160, v161
    v_mfma_f32_16x16x16_bf16 v[184:187], v[82:83], v[180:181], v[184:187]
    v_max3_f32 v248, v248, v162, v163
    v_max3_f32 v249, v249, v164, v165
    v_mfma_f32_16x16x16_bf16 v[188:191], v[104:105], v[180:181], v[188:191]
    v_max3_f32 v248, v248, v166, v167
    v_max3_f32 v249, v249, v168, v169
    v_mfma_f32_16x16x16_bf16 v[192:195], v[126:127], v[180:181], v[192:195]
    v_rcp_f32 v197, v196
    v_mfma_f32_16x16x32_bf16 v[216:219], a[52:55], v[252:255], v[216:219]
    v_mul_f32 v184, v184, v197
    v_mul_f32 v185, v185, v197
    v_mfma_f32_16x16x32_bf16 v[220:223], a[56:59], v[252:255], v[220:223]
    v_cvt_pk_bf16_f32 v184, v184, v185
    v_mul_f32 v186, v186, v197
    v_mfma_f32_16x16x32_bf16 v[200:203], v[252:255], a[120:123], v[200:203]
    v_mul_f32 v187, v187, v197
    v_cvt_pk_bf16_f32 v185, v186, v187
    v_mfma_f32_16x16x32_bf16 v[204:207], v[252:255], a[124:127], v[204:207]
    v_mul_f32 v188, v188, v197
    v_mul_f32 v189, v189, v197
    v_mfma_f32_16x16x32_bf16 v[208:211], v[252:255], a[128:131], v[208:211]
    ds_read_b128 v[252:255], v224 offset:49856
    v_cvt_pk_bf16_f32 v186, v188, v189
    v_mfma_f32_16x16x32_bf16 v[212:215], a[60:63], a[232:235], v[212:215]
    v_mul_f32 v190, v190, v197
    v_mul_f32 v191, v191, v197
    v_mfma_f32_16x16x32_bf16 v[216:219], a[64:67], a[232:235], v[216:219]
    v_cvt_pk_bf16_f32 v187, v190, v191
    v_mul_f32 v192, v192, v197
    v_mfma_f32_16x16x32_bf16 v[220:223], a[68:71], a[232:235], v[220:223]
    v_mul_f32 v193, v193, v197
    v_cvt_pk_bf16_f32 v188, v192, v193
    v_mfma_f32_16x16x32_bf16 v[200:203], a[232:235], a[132:135], v[200:203]
    v_cvt_pk_bf16_f32 v18, v212, v213
    v_cvt_pk_bf16_f32 v19, v214, v215
    v_mfma_f32_16x16x32_bf16 v[204:207], a[232:235], a[136:139], v[204:207]
    v_cvt_pk_bf16_f32 v20, v216, v217
    v_cvt_pk_bf16_f32 v21, v218, v219
    v_mfma_f32_16x16x32_bf16 v[208:211], a[232:235], a[140:143], v[208:211]
    s_waitcnt lgkmcnt(1)
    v_cvt_pk_bf16_f32 v22, v220, v221
    v_cvt_pk_bf16_f32 v23, v222, v223
    v_mfma_f32_16x16x32_bf16 v[148:151], v[18:21], v[132:135], v[148:151]
    v_cvt_pk_bf16_f32 v80, v200, v201
    v_cvt_pk_bf16_f32 v81, v202, v203
    v_mfma_f32_16x16x32_bf16 v[212:215], a[0:3], a[236:239], 0
    v_cvt_pk_bf16_f32 v102, v204, v205
    v_cvt_pk_bf16_f32 v103, v206, v207
    v_mfma_f32_16x16x32_bf16 v[216:219], a[4:7], a[236:239], 0
    v_cvt_pk_bf16_f32 v124, v208, v209
    v_cvt_pk_bf16_f32 v125, v210, v211
    v_mfma_f32_16x16x16_bf16 v[148:151], v[22:23], v[136:137], v[148:151]
    v_mul_f32 v194, v194, v197
    v_mul_f32 v195, v195, v197
    v_mfma_f32_16x16x32_bf16 v[220:223], a[8:11], a[236:239], 0
    ds_read_b128 a[232:235], v225 offset:27456
    v_cvt_pk_bf16_f32 v189, v194, v195
    v_mfma_f32_16x16x32_bf16 v[200:203], a[236:239], a[72:75], 0
    ds_write_b128 v237, v[184:187] offset:18432
    v_mfma_f32_16x16x32_bf16 v[204:207], a[236:239], a[76:79], 0
    ds_write_b64 v238, v[188:189] offset:18432
    v_mfma_f32_16x16x32_bf16 v[208:211], a[236:239], a[80:83], 0
    ds_read_b128 a[236:239], v225 offset:27520
    v_max3_f32 v248, v248, v170, v171
    v_mfma_f32_16x16x32_bf16 v[212:215], a[12:15], a[240:243], v[212:215]
    v_max3_f32 v249, v249, v172, v173
    v_max3_f32 v248, v248, v174, v175
    v_mfma_f32_16x16x32_bf16 v[216:219], a[16:19], a[240:243], v[216:219]
    v_mfma_f32_16x16x32_bf16 v[220:223], a[20:23], a[240:243], v[220:223]
    v_mfma_f32_16x16x32_bf16 v[200:203], a[240:243], a[84:87], v[200:203]
    v_mfma_f32_16x16x32_bf16 v[204:207], a[240:243], a[88:91], v[204:207]
    v_mfma_f32_16x16x32_bf16 v[208:211], a[240:243], a[92:95], v[208:211]
    ds_read_b128 a[240:243], v225 offset:27584
    v_mfma_f32_16x16x32_bf16 v[212:215], a[24:27], a[244:247], v[212:215]
    v_mfma_f32_16x16x32_bf16 v[216:219], a[28:31], a[244:247], v[216:219]
    v_mfma_f32_16x16x32_bf16 v[220:223], a[32:35], a[244:247], v[220:223]
    v_mfma_f32_16x16x32_bf16 v[200:203], a[244:247], a[96:99], v[200:203]
    v_mfma_f32_16x16x32_bf16 v[204:207], a[244:247], a[100:103], v[204:207]
    v_mfma_f32_16x16x32_bf16 v[208:211], a[244:247], a[104:107], v[208:211]
    ds_read_b128 a[244:247], v225 offset:27648
    v_mfma_f32_16x16x32_bf16 v[212:215], a[36:39], a[248:251], v[212:215]
    v_mfma_f32_16x16x32_bf16 v[216:219], a[40:43], a[248:251], v[216:219]
    v_mfma_f32_16x16x32_bf16 v[220:223], a[44:47], a[248:251], v[220:223]
    v_mfma_f32_16x16x32_bf16 v[200:203], a[248:251], a[108:111], v[200:203]
    v_mfma_f32_16x16x32_bf16 v[204:207], a[248:251], a[112:115], v[204:207]
    v_mfma_f32_16x16x32_bf16 v[208:211], a[248:251], a[116:119], v[208:211]
    ds_read_b128 a[248:251], v225 offset:27712
    v_mfma_f32_16x16x32_bf16 v[212:215], a[48:51], a[252:255], v[212:215]
    v_mfma_f32_16x16x32_bf16 v[216:219], a[52:55], a[252:255], v[216:219]
    v_mfma_f32_16x16x32_bf16 v[220:223], a[56:59], a[252:255], v[220:223]
    v_mfma_f32_16x16x32_bf16 v[200:203], a[252:255], a[120:123], v[200:203]
    v_mfma_f32_16x16x32_bf16 v[204:207], a[252:255], a[124:127], v[204:207]
    v_mfma_f32_16x16x32_bf16 v[208:211], a[252:255], a[128:131], v[208:211]
    s_waitcnt lgkmcnt(1)
    ds_read_b128 a[252:255], v225 offset:27776
    v_mfma_f32_16x16x32_bf16 v[212:215], a[60:63], v[252:255], v[212:215]
    v_mfma_f32_16x16x32_bf16 v[216:219], a[64:67], v[252:255], v[216:219]
    v_mfma_f32_16x16x32_bf16 v[220:223], a[68:71], v[252:255], v[220:223]
    v_mfma_f32_16x16x32_bf16 v[200:203], v[252:255], a[132:135], v[200:203]
    v_mfma_f32_16x16x32_bf16 v[204:207], v[252:255], a[136:139], v[204:207]
    v_mfma_f32_16x16x32_bf16 v[208:211], v[252:255], a[140:143], v[208:211]
    ds_read_b128 v[252:255], v225 offset:39872
    s_nop 1
    v_cvt_pk_bf16_f32 v42, v212, v213
    v_cvt_pk_bf16_f32 v43, v214, v215
    v_mfma_f32_16x16x32_bf16 v[212:215], a[144:147], a[232:235], 0
    s_waitcnt vmcnt(4) lgkmcnt(1)
    v_cvt_pk_bf16_f32 v44, v216, v217
    v_cvt_pk_bf16_f32 v45, v218, v219
    v_mfma_f32_16x16x32_bf16 v[216:219], a[148:151], a[232:235], 0
    s_barrier
    v_cvt_pk_bf16_f32 v46, v220, v221
    v_cvt_pk_bf16_f32 v47, v222, v223
    v_mfma_f32_16x16x32_bf16 v[144:147], v[42:45], v[132:135], v[144:147]
    v_cvt_pk_bf16_f32 v78, v200, v201
    v_cvt_pk_bf16_f32 v79, v202, v203
    v_mfma_f32_16x16x32_bf16 v[220:223], a[152:155], a[232:235], 0
    v_cvt_pk_bf16_f32 v100, v204, v205
    v_cvt_pk_bf16_f32 v101, v206, v207
    v_mfma_f32_16x16x32_bf16 v[212:215], a[156:159], a[236:239], v[212:215]
    v_cvt_pk_bf16_f32 v122, v208, v209
    v_cvt_pk_bf16_f32 v123, v210, v211
    v_mfma_f32_16x16x16_bf16 v[144:147], v[46:47], v[136:137], v[144:147]
    ds_read_b128 a[232:235], v225 offset:39936
    v_mfma_f32_16x16x32_bf16 v[216:219], a[160:163], a[236:239], v[216:219]
    buffer_load_dwordx4 v246, s[4:7], s47 offen lds
    v_mfma_f32_16x16x32_bf16 v[220:223], a[164:167], a[236:239], v[220:223]
    s_add_u32 m0, s42, 0x3c80
    ds_read_b128 a[236:239], v225 offset:40000
    v_mfma_f32_16x16x32_bf16 v[212:215], a[168:171], a[240:243], v[212:215]
    buffer_load_dwordx4 v247, s[4:7], s47 offen lds
    v_mfma_f32_16x16x32_bf16 v[216:219], a[172:175], a[240:243], v[216:219]
    s_add_u32 m0, s41, 0x5ac0
    v_max3_f32 v249, v249, v144, v145
    v_max3_f32 v248, v248, v146, v147
    v_mfma_f32_16x16x32_bf16 v[220:223], a[176:179], a[240:243], v[220:223]
    ds_read_b128 a[240:243], v225 offset:40064
    v_max3_f32 v249, v249, v148, v149
    v_mfma_f32_16x16x32_bf16 v[212:215], a[180:183], a[244:247], v[212:215]
    buffer_load_dwordx4 v246, s[4:7], s48 offen lds
    v_mfma_f32_16x16x32_bf16 v[216:219], a[184:187], a[244:247], v[216:219]
    s_add_u32 m0, s42, 0x5ac0
    v_max3_f32 v248, v248, v150, v151
    v_max_f32 v248, v248, v249
    v_mfma_f32_16x16x32_bf16 v[220:223], a[188:191], a[244:247], v[220:223]
    ds_read_b128 a[244:247], v225 offset:40128
    v_mov_b32 v249, v248
    v_mfma_f32_16x16x32_bf16 v[212:215], a[192:195], a[248:251], v[212:215]
    buffer_load_dwordx4 v247, s[4:7], s48 offen lds
    v_mfma_f32_16x16x32_bf16 v[216:219], a[196:199], a[248:251], v[216:219]
    v_permlane16_swap_b32 v248, v249
    v_mfma_f32_16x16x32_bf16 v[220:223], a[200:203], a[248:251], v[220:223]
    ds_read_b128 a[248:251], v225 offset:40192
    v_max_f32 v248, v248, v249
    v_mfma_f32_16x16x32_bf16 v[212:215], a[204:207], a[252:255], v[212:215]
    v_mov_b32 v249, v248
    v_mfma_f32_16x16x32_bf16 v[216:219], a[208:211], a[252:255], v[216:219]
    v_mfma_f32_16x16x32_bf16 v[220:223], a[212:215], a[252:255], v[220:223]
    s_waitcnt lgkmcnt(3)
    ds_read_b128 a[252:255], v239 offset:12288
    v_mfma_f32_16x16x32_bf16 v[200:203], a[144:147], v[252:255], 0
    v_permlane32_swap_b32 v248, v249
    v_mfma_f32_16x16x32_bf16 v[204:207], a[148:151], v[252:255], 0
    v_max_f32 v248, v248, v249
    v_cvt_pk_bf16_f32 v138, v212, v213
    v_mfma_f32_16x16x32_bf16 v[208:211], a[152:155], v[252:255], 0
    v_cvt_pk_bf16_f32 v139, v214, v215
    v_cvt_pk_bf16_f32 v140, v216, v217
    v_mfma_f32_16x16x32_bf16 v[200:203], a[156:159], a[232:235], v[200:203]
    v_cvt_pk_bf16_f32 v141, v218, v219
    v_cvt_pk_bf16_f32 v142, v220, v221
    v_mfma_f32_16x16x32_bf16 v[204:207], a[160:163], a[232:235], v[204:207]
    ds_read_b128 v[252:255], v239 offset:18432
    v_cvt_pk_bf16_f32 v143, v222, v223
    v_mfma_f32_16x16x32_bf16 v[208:211], a[164:167], a[232:235], v[208:211]
    ds_read_b128 a[232:235], v239 offset:13312
    v_mul_f32 v250, s37, v248
    v_mfma_f32_16x16x32_bf16 v[200:203], a[168:171], a[236:239], v[200:203]
    v_fma_f32 v152, v152, s37, -v250
    v_fma_f32 v153, v153, s37, -v250
    v_mfma_f32_16x16x32_bf16 v[204:207], a[172:175], a[236:239], v[204:207]
    v_fma_f32 v154, v154, s37, -v250
    v_fma_f32 v155, v155, s37, -v250
    v_mfma_f32_16x16x32_bf16 v[208:211], a[176:179], a[236:239], v[208:211]
    s_waitcnt lgkmcnt(3)
    ds_read_b128 a[236:239], v239 offset:19456
    v_fma_f32 v156, v156, s37, -v250
    v_mfma_f32_16x16x32_bf16 v[200:203], a[180:183], a[240:243], v[200:203]
    v_exp_f32 v152, v152
    v_mfma_f32_16x16x32_bf16 v[204:207], a[184:187], a[240:243], v[204:207]
    v_exp_f32 v153, v153
    v_mfma_f32_16x16x32_bf16 v[208:211], a[188:191], a[240:243], v[208:211]
    ds_read_b64_tr_b16 a[240:241], v240 offset:12288
    ds_read_b64_tr_b16 a[242:243], v240 offset:26112
    v_mfma_f32_16x16x32_bf16 v[200:203], a[192:195], a[244:247], v[200:203]
    v_exp_f32 v154, v154
    v_mfma_f32_16x16x32_bf16 v[204:207], a[196:199], a[244:247], v[204:207]
    v_exp_f32 v155, v155
    v_mfma_f32_16x16x32_bf16 v[208:211], a[200:203], a[244:247], v[208:211]
    ds_read_b64_tr_b16 a[244:245], v240 offset:12296
    ds_read_b64_tr_b16 a[246:247], v240 offset:26120
    v_mfma_f32_16x16x32_bf16 v[200:203], a[204:207], a[248:251], v[200:203]
    v_cvt_pk_bf16_f32 v176, v152, v153
    v_cvt_pk_bf16_f32 v177, v154, v155
    v_mfma_f32_16x16x32_bf16 v[204:207], a[208:211], a[248:251], v[204:207]
    ds_read_b128 v[152:155], v230 offset:640
    v_fma_f32 v157, v157, s37, -v250
    v_mfma_f32_16x16x32_bf16 v[208:211], a[212:215], a[248:251], v[208:211]
    s_waitcnt lgkmcnt(6)
    ds_read_b64_tr_b16 a[248:249], v241 offset:12288
    ds_read_b64_tr_b16 a[250:251], v241 offset:26112
    v_mfma_f32_16x16x32_bf16 v[212:215], a[220:223], a[252:255], 0
    v_cvt_pk_bf16_f32 v132, v200, v201
    v_cvt_pk_bf16_f32 v133, v202, v203
    v_mfma_f32_16x16x32_bf16 v[200:203], a[220:223], v[252:255], 0
    v_cvt_pk_bf16_f32 v134, v204, v205
    v_cvt_pk_bf16_f32 v135, v206, v207
    v_mfma_f32_16x16x32_bf16 v[216:219], a[224:227], a[252:255], 0
    v_cvt_pk_bf16_f32 v136, v208, v209
    v_cvt_pk_bf16_f32 v137, v210, v211
    v_mfma_f32_16x16x32_bf16 v[204:207], a[224:227], v[252:255], 0
    v_fma_f32 v158, v158, s37, -v250
    v_fma_f32 v159, v159, s37, -v250
    v_mfma_f32_16x16x32_bf16 v[220:223], a[228:231], a[252:255], 0
    ds_read_b128 a[252:255], v239 offset:14336
    v_fma_f32 v160, v160, s37, -v250
    v_mfma_f32_16x16x32_bf16 v[208:211], a[228:231], v[252:255], 0
    s_waitcnt lgkmcnt(6)
    ds_read_b128 v[252:255], v239 offset:20480
    v_fma_f32 v161, v161, s37, -v250
    v_mfma_f32_16x16x32_bf16 v[212:215], a[240:243], a[232:235], v[212:215]
    v_exp_f32 v156, v156
    v_mfma_f32_16x16x32_bf16 v[200:203], a[240:243], a[236:239], v[200:203]
    s_waitcnt lgkmcnt(4)
    ds_read_b64_tr_b16 a[240:241], v241 offset:13824
    ds_read_b64_tr_b16 a[242:243], v241 offset:24576
    v_mfma_f32_16x16x32_bf16 v[152:155], v[24:27], v[138:141], v[152:155]
    v_exp_f32 v157, v157
    v_mfma_f32_16x16x32_bf16 v[216:219], a[244:247], a[232:235], v[216:219]
    v_exp_f32 v158, v158
    v_mfma_f32_16x16x32_bf16 v[204:207], a[244:247], a[236:239], v[204:207]
    ds_read_b128 a[244:247], v239 offset:15360
    v_cvt_pk_bf16_f32 v178, v156, v157
    v_mfma_f32_16x16x16_bf16 v[152:155], v[28:29], v[142:143], v[152:155]
    s_waitcnt lgkmcnt(5)
    v_exp_f32 v159, v159
    v_mfma_f32_16x16x32_bf16 v[220:223], a[248:251], a[232:235], v[220:223]
    ds_read_b64_tr_b16 a[232:233], v240 offset:13824
    ds_read_b64_tr_b16 a[234:235], v240 offset:24576
    v_mfma_f32_16x16x32_bf16 v[208:211], a[248:251], a[236:239], v[208:211]
    ds_read_b64_tr_b16 a[236:237], v240 offset:13832
    ds_read_b64_tr_b16 a[238:239], v240 offset:24584
    v_cvt_pk_bf16_f32 v179, v158, v159
    v_fma_f32 v162, v162, s37, -v250
    ds_read_b128 a[248:251], v239 offset:21504
    v_mfma_f32_16x16x32_bf16 v[196:199], a[216:219], v[176:179], 0
    ds_read_b128 v[156:159], v230 offset:1280
    v_fma_f32 v163, v163, s37, -v250
    v_mfma_f32_16x16x32_bf16 v[184:187], v[66:69], v[176:179], 0
    v_exp_f32 v160, v160
    v_mfma_f32_16x16x32_bf16 v[188:191], v[88:91], v[176:179], 0
    v_exp_f32 v161, v161
    v_mfma_f32_16x16x32_bf16 v[192:195], v[110:113], v[176:179], 0
    s_waitcnt lgkmcnt(7)
    v_exp_f32 v162, v162
    v_mfma_f32_16x16x32_bf16 v[220:223], a[240:243], a[252:255], v[220:223]
    v_exp_f32 v163, v163
    v_mfma_f32_16x16x32_bf16 v[208:211], a[240:243], v[252:255], v[208:211]
    s_waitcnt lgkmcnt(4)
    ds_read_b128 a[240:243], v239 offset:22528
    v_cvt_pk_bf16_f32 v180, v160, v161
    v_cvt_pk_bf16_f32 v181, v162, v163
    v_mfma_f32_16x16x32_bf16 v[212:215], a[232:235], a[252:255], v[212:215]
    ds_read_b128 v[160:163], v230 offset:1920
    v_fma_f32 v164, v164, s37, -v250
    v_mfma_f32_16x16x32_bf16 v[200:203], a[232:235], v[252:255], v[200:203]
    s_waitcnt lgkmcnt(4)
    ds_read_b64_tr_b16 a[232:233], v241 offset:36864
    ds_read_b64_tr_b16 a[234:235], v241 offset:38400
    v_mfma_f32_16x16x32_bf16 v[216:219], a[236:239], a[252:255], v[216:219]
    ds_read_b64_tr_b16 a[252:253], v240 offset:36864
    ds_read_b64_tr_b16 a[254:255], v240 offset:38400
    v_mfma_f32_16x16x32_bf16 v[204:207], a[236:239], v[252:255], v[204:207]
    s_waitcnt lgkmcnt(6)
    ds_read_b64_tr_b16 v[252:253], v240 offset:36872
    v_fma_f32 v165, v165, s37, -v250
    v_fma_f32 v166, v166, s37, -v250
    v_fma_f32 v167, v167, s37, -v250
    ds_read_b64_tr_b16 v[254:255], v240 offset:38408
    v_mfma_f32_16x16x32_bf16 v[156:159], v[30:33], v[138:141], v[156:159]
    ds_read_b128 a[236:239], v239 offset:16384
    v_fma_f32 v168, v168, s37, -v250
    v_exp_f32 v164, v164
    v_exp_f32 v165, v165
    v_exp_f32 v166, v166
    v_exp_f32 v167, v167
    v_mfma_f32_16x16x16_bf16 v[156:159], v[34:35], v[142:143], v[156:159]
    s_waitcnt lgkmcnt(7)
    v_cvt_pk_bf16_f32 v182, v164, v165
    v_cvt_pk_bf16_f32 v183, v166, v167
    ds_read_b128 v[164:167], v230 offset:2560
    v_mfma_f32_16x16x32_bf16 v[160:163], v[36:39], v[138:141], v[160:163]
    v_fma_f32 v169, v169, s37, -v250
    v_fma_f32 v170, v170, s37, -v250
    v_mfma_f32_16x16x32_bf16 v[196:199], a[216:219], v[180:183], v[196:199]
    v_fma_f32 v171, v171, s37, -v250
    v_fma_f32 v172, v172, s37, -v250
    v_mfma_f32_16x16x32_bf16 v[184:187], v[70:73], v[180:183], v[184:187]
    v_exp_f32 v168, v168
    v_mfma_f32_16x16x32_bf16 v[188:191], v[92:95], v[180:183], v[188:191]
    v_exp_f32 v169, v169
    v_mfma_f32_16x16x32_bf16 v[192:195], v[114:117], v[180:183], v[192:195]
    v_exp_f32 v170, v170
    v_mfma_f32_16x16x16_bf16 v[160:163], v[40:41], v[142:143], v[160:163]
    s_waitcnt lgkmcnt(3)
    v_exp_f32 v171, v171
    v_mfma_f32_16x16x32_bf16 v[212:215], a[252:255], a[244:247], v[212:215]
    v_cvt_pk_bf16_f32 v176, v168, v169
    v_cvt_pk_bf16_f32 v177, v170, v171
    v_mfma_f32_16x16x32_bf16 v[200:203], a[252:255], a[248:251], v[200:203]
    s_waitcnt lgkmcnt(1)
    ds_read_b64_tr_b16 a[252:253], v241 offset:49152
    ds_read_b64_tr_b16 a[254:255], v241 offset:62976
    v_mfma_f32_16x16x32_bf16 v[216:219], v[252:255], a[244:247], v[216:219]
    s_waitcnt lgkmcnt(2)
    ds_read_b128 v[168:171], v235
    v_mad_u32_u24 v235, v234, s40, v229
    v_mfma_f32_16x16x32_bf16 v[164:167], v[42:45], v[138:141], v[164:167]
    v_mad_u32_u24 v234, v234, s40, v228
    v_fma_f32 v173, v173, s37, -v250
    v_mfma_f32_16x16x32_bf16 v[204:207], v[252:255], a[248:251], v[204:207]
    ds_read_b128 v[252:255], v239 offset:17408
    v_fma_f32 v174, v174, s37, -v250
    v_mfma_f32_16x16x32_bf16 v[220:223], a[232:235], a[244:247], v[220:223]
    ds_read_b64_tr_b16 a[244:245], v240 offset:49152
    ds_read_b64_tr_b16 a[246:247], v240 offset:62976
    v_mfma_f32_16x16x16_bf16 v[164:167], v[46:47], v[142:143], v[164:167]
    v_fma_f32 v175, v175, s37, -v250
    v_fma_f32 v144, v144, s37, -v250
    v_mfma_f32_16x16x32_bf16 v[208:211], a[232:235], a[248:251], v[208:211]
    s_waitcnt lgkmcnt(4)
    ds_read_b64_tr_b16 a[248:249], v240 offset:49160
    ds_read_b64_tr_b16 a[250:251], v240 offset:62984
    ds_read_b128 a[232:235], v239 offset:23552
    v_exp_f32 v172, v172
    v_exp_f32 v173, v173
    v_exp_f32 v174, v174
    v_mfma_f32_16x16x32_bf16 v[220:223], a[252:255], a[236:239], v[220:223]
    v_exp_f32 v175, v175
    v_mfma_f32_16x16x32_bf16 v[208:211], a[252:255], a[240:243], v[208:211]
    s_waitcnt lgkmcnt(6)
    ds_read_b128 a[252:255], v224 offset:64
    v_cvt_pk_bf16_f32 v178, v172, v173
    v_mfma_f32_16x16x32_bf16 v[168:171], v[60:63], v[138:141], v[168:171]
    v_cvt_pk_bf16_f32 v179, v174, v175
    v_fma_f32 v145, v145, s37, -v250
    ds_read_b128 v[172:175], v236
    v_mfma_f32_16x16x32_bf16 v[196:199], a[216:219], v[176:179], v[196:199]
    v_bfe_u32 v236, s74, v232, 4
    v_fma_f32 v146, v146, s37, -v250
    v_mfma_f32_16x16x32_bf16 v[184:187], v[74:77], v[176:179], v[184:187]
    v_fma_f32 v147, v147, s37, -v250
    v_fma_f32 v148, v148, s37, -v250
    v_mfma_f32_16x16x32_bf16 v[188:191], v[96:99], v[176:179], v[188:191]
    v_exp_f32 v144, v144
    v_mfma_f32_16x16x32_bf16 v[192:195], v[118:121], v[176:179], v[192:195]
    v_exp_f32 v145, v145
    v_mfma_f32_16x16x16_bf16 v[168:171], v[64:65], v[142:143], v[168:171]
    s_waitcnt lgkmcnt(3)
    v_exp_f32 v146, v146
    v_mfma_f32_16x16x32_bf16 v[212:215], a[244:247], a[236:239], v[212:215]
    v_exp_f32 v147, v147
    v_mfma_f32_16x16x32_bf16 v[200:203], a[244:247], a[240:243], v[200:203]
    ds_read_b64_tr_b16 a[244:245], v241 offset:50688
    ds_read_b64_tr_b16 a[246:247], v241 offset:61440
    v_mfma_f32_16x16x32_bf16 v[216:219], a[248:251], a[236:239], v[216:219]
    ds_read_b64_tr_b16 a[236:237], v240 offset:50688
    ds_read_b64_tr_b16 a[238:239], v240 offset:61440
    v_mfma_f32_16x16x32_bf16 v[204:207], a[248:251], a[240:243], v[204:207]
    s_waitcnt lgkmcnt(4)
    ds_read_b64_tr_b16 a[240:241], v240 offset:50696
    ds_read_b64_tr_b16 a[242:243], v240 offset:61448
    v_mfma_f32_16x16x32_bf16 v[172:175], v[48:51], v[138:141], v[172:175]
    ds_read_b128 a[248:251], v224
    v_cvt_pk_bf16_f32 v180, v144, v145
    v_cvt_pk_bf16_f32 v181, v146, v147
    v_fma_f32 v149, v149, s37, -v250
    ds_read_b128 v[144:147], v235
    v_bfe_u32 v235, s74, v232, 4
    v_mfma_f32_16x16x16_bf16 v[172:175], v[52:53], v[142:143], v[172:175]
    s_waitcnt lgkmcnt(6)
    v_mad_u32_u24 v235, v235, s40, v230
    v_fma_f32 v150, v150, s37, -v250
    v_fma_f32 v151, v151, s37, -v250
    v_exp_f32 v148, v148
    v_exp_f32 v149, v149
    v_exp_f32 v150, v150
    v_exp_f32 v151, v151
    v_mfma_f32_16x16x32_bf16 v[220:223], a[244:247], v[252:255], v[220:223]
    v_cvt_pk_bf16_f32 v182, v148, v149
    v_cvt_pk_bf16_f32 v183, v150, v151
    v_mfma_f32_16x16x32_bf16 v[208:211], a[244:247], a[232:235], v[208:211]
    ds_read_b128 a[244:247], v224 offset:3072
    ds_read_b128 v[148:151], v234
    v_mfma_f32_16x16x32_bf16 v[196:199], a[216:219], v[180:183], v[196:199]
    v_mad_u32_u24 v234, v236, s40, v228
    v_mad_u32_u24 v236, v236, s40, v229
    v_mfma_f32_16x16x32_bf16 v[184:187], v[78:81], v[180:183], v[184:187]
    v_cvt_pk_bf16_f32 v220, v220, v221
    v_cvt_pk_bf16_f32 v221, v222, v223
    v_mfma_f32_16x16x32_bf16 v[188:191], v[100:103], v[180:183], v[188:191]
    buffer_store_dwordx2 v[220:221], v243, s[20:23], s58 offen sc0 sc1
    v_mfma_f32_16x16x32_bf16 v[192:195], v[122:125], v[180:183], v[192:195]
    s_waitcnt lgkmcnt(4)
    v_cvt_pk_bf16_f32 v208, v208, v209
    v_cvt_pk_bf16_f32 v209, v210, v211
    v_mfma_f32_16x16x32_bf16 v[212:215], a[236:239], v[252:255], v[212:215]
    s_waitcnt lgkmcnt(2)
    buffer_store_dwordx2 v[208:209], v245, s[20:23], s59 offen sc0 sc1
    v_mfma_f32_16x16x32_bf16 v[144:147], v[30:33], v[132:135], v[144:147]
    v_rcp_f32 v197, v196
    v_mfma_f32_16x16x32_bf16 v[200:203], a[236:239], a[232:235], v[200:203]
    v_mul_f32 v184, v184, v197
    v_mul_f32 v185, v185, v197
    v_mfma_f32_16x16x32_bf16 v[216:219], a[240:243], v[252:255], v[216:219]
    v_cvt_pk_bf16_f32 v184, v184, v185
    v_cvt_pk_bf16_f32 v212, v212, v213
    v_mfma_f32_16x16x16_bf16 v[144:147], v[34:35], v[136:137], v[144:147]
    s_waitcnt lgkmcnt(0)
    v_cvt_pk_bf16_f32 v213, v214, v215
    v_mul_f32 v186, v186, v197
    v_mfma_f32_16x16x32_bf16 v[148:151], v[6:9], v[132:135], v[148:151]
    v_cvt_pk_bf16_f32 v200, v200, v201
    v_cvt_pk_bf16_f32 v201, v202, v203
    v_mfma_f32_16x16x32_bf16 v[204:207], a[240:243], a[232:235], v[204:207]
    v_cvt_pk_bf16_f32 v214, v216, v217
    v_cvt_pk_bf16_f32 v215, v218, v219
    v_mfma_f32_16x16x32_bf16 v[216:219], a[4:7], a[248:251], 0
    buffer_store_dwordx4 v[212:215], v242, s[20:23], s58 offen sc0 sc1
    v_mfma_f32_16x16x16_bf16 v[148:151], v[10:11], v[136:137], v[148:151]
    s_add_u32 s58, s51, 0x150000
    v_mul_f32 v187, v187, v197
    v_cvt_pk_bf16_f32 v185, v186, v187
    v_mfma_f32_16x16x32_bf16 v[212:215], a[0:3], a[248:251], 0
    v_cvt_pk_bf16_f32 v202, v204, v205
    v_cvt_pk_bf16_f32 v203, v206, v207
    v_mfma_f32_16x16x32_bf16 v[220:223], a[8:11], a[248:251], 0
    buffer_store_dwordx4 v[200:203], v244, s[20:23], s59 offen sc0 sc1
    v_mfma_f32_16x16x32_bf16 v[204:207], a[248:251], a[76:79], 0
    s_add_u32 s59, s51, 0x151800
    v_mul_f32 v188, v188, v197
    v_mul_f32 v189, v189, v197
    v_mfma_f32_16x16x32_bf16 v[200:203], a[248:251], a[72:75], 0
    v_cvt_pk_bf16_f32 v186, v188, v189
    v_mul_f32 v190, v190, v197
    v_mfma_f32_16x16x32_bf16 v[208:211], a[248:251], a[80:83], 0
    v_mul_f32 v191, v191, v197
    v_cvt_pk_bf16_f32 v187, v190, v191
    v_mfma_f32_16x16x32_bf16 v[212:215], a[12:15], a[252:255], v[212:215]
    v_mul_f32 v192, v192, v197
    v_mul_f32 v193, v193, v197
    v_mfma_f32_16x16x32_bf16 v[216:219], a[16:19], a[252:255], v[216:219]
    v_cvt_pk_bf16_f32 v188, v192, v193
    v_mul_f32 v194, v194, v197
    v_mfma_f32_16x16x32_bf16 v[220:223], a[20:23], a[252:255], v[220:223]
    ds_read_b128 v[252:255], v224 offset:128
    v_mul_f32 v195, v195, v197
    v_mfma_f32_16x16x32_bf16 v[200:203], a[252:255], a[84:87], v[200:203]
    ds_read_b128 a[232:235], v224 offset:192
    v_cvt_pk_bf16_f32 v189, v194, v195
    v_mfma_f32_16x16x32_bf16 v[204:207], a[252:255], a[88:91], v[204:207]
    ds_write_b128 v237, v[184:187]
    v_mfma_f32_16x16x32_bf16 v[208:211], a[252:255], a[92:95], v[208:211]
    s_waitcnt lgkmcnt(2)
    ds_write_b64 v238, v[188:189]
    ds_read_b128 a[236:239], v224 offset:256
    ds_read_b128 a[240:243], v224 offset:320
    ds_read_b128 a[248:251], v224 offset:3136
    v_max3_f32 v248, v152, v153, v154
    v_max3_f32 v249, v155, v156, v157
    v_max3_f32 v248, v248, v158, v159
    ds_read_b128 a[252:255], v224 offset:3200
    v_max3_f32 v249, v249, v160, v161
    v_max3_f32 v248, v248, v162, v163
    v_max3_f32 v249, v249, v164, v165
    v_max3_f32 v248, v248, v166, v167
    v_max3_f32 v249, v249, v168, v169
    v_mfma_f32_16x16x32_bf16 v[212:215], a[24:27], v[252:255], v[212:215]
    v_max3_f32 v248, v248, v170, v171
    v_max3_f32 v249, v249, v172, v173
    v_mfma_f32_16x16x32_bf16 v[216:219], a[28:31], v[252:255], v[216:219]
    v_max3_f32 v248, v248, v174, v175
    v_max_f32 v248, v248, v249
    v_mfma_f32_16x16x32_bf16 v[220:223], a[32:35], v[252:255], v[220:223]
    v_mov_b32 v249, v248
    v_mfma_f32_16x16x32_bf16 v[200:203], v[252:255], a[96:99], v[200:203]
    v_mfma_f32_16x16x32_bf16 v[204:207], v[252:255], a[100:103], v[204:207]
    v_permlane16_swap_b32 v248, v249
    v_mfma_f32_16x16x32_bf16 v[208:211], v[252:255], a[104:107], v[208:211]
    s_waitcnt lgkmcnt(4)
    ds_read_b128 v[252:255], v224 offset:3264
    v_max_f32 v248, v248, v249
    v_mfma_f32_16x16x32_bf16 v[212:215], a[36:39], a[232:235], v[212:215]
    v_mov_b32 v249, v248
    v_mfma_f32_16x16x32_bf16 v[216:219], a[40:43], a[232:235], v[216:219]
    v_mfma_f32_16x16x32_bf16 v[220:223], a[44:47], a[232:235], v[220:223]
    v_permlane32_swap_b32 v248, v249
    v_mfma_f32_16x16x32_bf16 v[200:203], a[232:235], a[108:111], v[200:203]
    v_max_f32 v248, v248, v249
    v_mul_f32 v250, s37, v248
    v_mfma_f32_16x16x32_bf16 v[204:207], a[232:235], a[112:115], v[204:207]
    v_fma_f32 v152, v152, s37, -v250
    v_fma_f32 v153, v153, s37, -v250
    v_mfma_f32_16x16x32_bf16 v[208:211], a[232:235], a[116:119], v[208:211]
    s_waitcnt lgkmcnt(1)
    ds_read_b128 a[232:235], v224 offset:3328
    v_fma_f32 v154, v154, s37, -v250
    v_mfma_f32_16x16x32_bf16 v[212:215], a[48:51], a[236:239], v[212:215]
    v_fma_f32 v155, v155, s37, -v250
    v_fma_f32 v156, v156, s37, -v250
    v_mfma_f32_16x16x32_bf16 v[216:219], a[52:55], a[236:239], v[216:219]
    v_exp_f32 v152, v152
    v_mfma_f32_16x16x32_bf16 v[220:223], a[56:59], a[236:239], v[220:223]
    v_exp_f32 v153, v153
    v_mfma_f32_16x16x32_bf16 v[200:203], a[236:239], a[120:123], v[200:203]
    v_exp_f32 v154, v154
    v_mfma_f32_16x16x32_bf16 v[204:207], a[236:239], a[124:127], v[204:207]
    v_exp_f32 v155, v155
    v_mfma_f32_16x16x32_bf16 v[208:211], a[236:239], a[128:131], v[208:211]
    ds_read_b128 a[236:239], v224 offset:3392
    v_cvt_pk_bf16_f32 v176, v152, v153
    v_mfma_f32_16x16x32_bf16 v[212:215], a[60:63], a[240:243], v[212:215]
    v_cvt_pk_bf16_f32 v177, v154, v155
    v_fma_f32 v157, v157, s37, -v250
    v_mfma_f32_16x16x32_bf16 v[216:219], a[64:67], a[240:243], v[216:219]
    ds_read_b128 v[152:155], v228 offset:1280
    v_fma_f32 v158, v158, s37, -v250
    v_mfma_f32_16x16x32_bf16 v[220:223], a[68:71], a[240:243], v[220:223]
    v_fma_f32 v159, v159, s37, -v250
    v_fma_f32 v160, v160, s37, -v250
    v_mfma_f32_16x16x32_bf16 v[200:203], a[240:243], a[132:135], v[200:203]
    v_cvt_pk_bf16_f32 v0, v212, v213
    v_cvt_pk_bf16_f32 v1, v214, v215
    v_mfma_f32_16x16x32_bf16 v[204:207], a[240:243], a[136:139], v[204:207]
    v_cvt_pk_bf16_f32 v2, v216, v217
    v_cvt_pk_bf16_f32 v3, v218, v219
    v_mfma_f32_16x16x32_bf16 v[208:211], a[240:243], a[140:143], v[208:211]
    v_cvt_pk_bf16_f32 v4, v220, v221
    v_cvt_pk_bf16_f32 v5, v222, v223
    v_mfma_f32_16x16x32_bf16 v[212:215], a[0:3], a[244:247], 0
    v_cvt_pk_bf16_f32 v66, v200, v201
    v_cvt_pk_bf16_f32 v67, v202, v203
    v_mfma_f32_16x16x32_bf16 v[216:219], a[4:7], a[244:247], 0
    v_cvt_pk_bf16_f32 v88, v204, v205
    v_cvt_pk_bf16_f32 v89, v206, v207
    v_mfma_f32_16x16x32_bf16 v[220:223], a[8:11], a[244:247], 0
    v_cvt_pk_bf16_f32 v110, v208, v209
    v_cvt_pk_bf16_f32 v111, v210, v211
    v_mfma_f32_16x16x32_bf16 v[200:203], a[244:247], a[72:75], 0
    ds_read_b128 a[240:243], v225 offset:42944
    v_fma_f32 v161, v161, s37, -v250
    v_mfma_f32_16x16x32_bf16 v[204:207], a[244:247], a[76:79], 0
    s_waitcnt lgkmcnt(1)
    v_exp_f32 v156, v156
    v_mfma_f32_16x16x32_bf16 v[152:155], v[12:15], v[132:135], v[152:155]
    v_exp_f32 v157, v157
    v_mfma_f32_16x16x32_bf16 v[208:211], a[244:247], a[80:83], 0
    ds_read_b128 a[244:247], v225 offset:43008
    v_cvt_pk_bf16_f32 v178, v156, v157
    v_mfma_f32_16x16x32_bf16 v[212:215], a[12:15], a[248:251], v[212:215]
    v_exp_f32 v158, v158
    v_mfma_f32_16x16x16_bf16 v[152:155], v[16:17], v[136:137], v[152:155]
    v_exp_f32 v159, v159
    v_mfma_f32_16x16x32_bf16 v[216:219], a[16:19], a[248:251], v[216:219]
    v_cvt_pk_bf16_f32 v179, v158, v159
    v_fma_f32 v162, v162, s37, -v250
    v_mfma_f32_16x16x32_bf16 v[220:223], a[20:23], a[248:251], v[220:223]
    ds_read_b128 v[156:159], v229 offset:1280
    v_fma_f32 v163, v163, s37, -v250
    v_mfma_f32_16x16x32_bf16 v[196:199], a[216:219], v[176:179], 0
    v_exp_f32 v160, v160
    v_mfma_f32_16x16x32_bf16 v[184:187], v[68:71], v[176:179], 0
    v_exp_f32 v161, v161
    v_mfma_f32_16x16x32_bf16 v[188:191], v[90:93], v[176:179], 0
    v_exp_f32 v162, v162
    v_mfma_f32_16x16x32_bf16 v[192:195], v[112:115], v[176:179], 0
    v_exp_f32 v163, v163
    v_mfma_f32_16x16x32_bf16 v[200:203], a[248:251], a[84:87], v[200:203]
    v_cvt_pk_bf16_f32 v180, v160, v161
    v_cvt_pk_bf16_f32 v181, v162, v163
    v_mfma_f32_16x16x32_bf16 v[204:207], a[248:251], a[88:91], v[204:207]
    ds_read_b128 v[160:163], v229 offset:1920
    v_fma_f32 v164, v164, s37, -v250
    v_mfma_f32_16x16x32_bf16 v[208:211], a[248:251], a[92:95], v[208:211]
    ds_read_b128 a[248:251], v225 offset:43072
    v_fma_f32 v165, v165, s37, -v250
    v_mfma_f32_16x16x32_bf16 v[212:215], a[24:27], a[252:255], v[212:215]
    v_fma_f32 v166, v166, s37, -v250
    v_fma_f32 v167, v167, s37, -v250
    v_mfma_f32_16x16x32_bf16 v[216:219], a[28:31], a[252:255], v[216:219]
    s_waitcnt lgkmcnt(2)
    v_exp_f32 v164, v164
    v_mfma_f32_16x16x32_bf16 v[156:159], v[36:39], v[132:135], v[156:159]
    v_exp_f32 v165, v165
    v_mfma_f32_16x16x32_bf16 v[220:223], a[32:35], a[252:255], v[220:223]
    v_exp_f32 v166, v166
    v_mfma_f32_16x16x32_bf16 v[200:203], a[252:255], a[96:99], v[200:203]
    v_exp_f32 v167, v167
    v_mfma_f32_16x16x32_bf16 v[204:207], a[252:255], a[100:103], v[204:207]
    v_cvt_pk_bf16_f32 v182, v164, v165
    v_cvt_pk_bf16_f32 v183, v166, v167
    v_mfma_f32_16x16x16_bf16 v[156:159], v[40:41], v[136:137], v[156:159]
    ds_read_b128 v[164:167], v228 offset:1920
    v_fma_f32 v168, v168, s37, -v250
    v_mfma_f32_16x16x32_bf16 v[196:199], a[216:219], v[180:183], v[196:199]
    v_fma_f32 v169, v169, s37, -v250
    v_fma_f32 v170, v170, s37, -v250
    v_mfma_f32_16x16x32_bf16 v[184:187], v[76:79], v[180:183], v[184:187]
    v_fma_f32 v171, v171, s37, -v250
    v_fma_f32 v172, v172, s37, -v250
    v_mfma_f32_16x16x32_bf16 v[188:191], v[98:101], v[180:183], v[188:191]
    v_exp_f32 v168, v168
    v_mfma_f32_16x16x32_bf16 v[192:195], v[120:123], v[180:183], v[192:195]
    s_waitcnt lgkmcnt(1)
    v_exp_f32 v169, v169
    v_mfma_f32_16x16x32_bf16 v[160:163], v[42:45], v[132:135], v[160:163]
    v_exp_f32 v170, v170
    v_mfma_f32_16x16x32_bf16 v[208:211], a[252:255], a[104:107], v[208:211]
    ds_read_b128 a[252:255], v225 offset:43136
    v_cvt_pk_bf16_f32 v176, v168, v169
    v_mfma_f32_16x16x32_bf16 v[212:215], a[36:39], v[252:255], v[212:215]
    v_exp_f32 v171, v171
    v_mfma_f32_16x16x16_bf16 v[160:163], v[46:47], v[136:137], v[160:163]
    v_cvt_pk_bf16_f32 v177, v170, v171
    v_fma_f32 v173, v173, s37, -v250
    v_mfma_f32_16x16x32_bf16 v[216:219], a[40:43], v[252:255], v[216:219]
    ds_read_b128 v[168:171], v234
    v_bfe_u32 v234, s67, v233, 4
    v_mfma_f32_16x16x16_bf16 v[196:199], a[216:217], v[176:177], v[196:199]
    v_mad_u32_u24 v234, v234, s40, v231
    v_fma_f32 v174, v174, s37, -v250
    v_mfma_f32_16x16x16_bf16 v[184:187], v[86:87], v[176:177], v[184:187]
    v_fma_f32 v175, v175, s37, -v250
    v_max3_f32 v248, v144, v145, v146
    v_mfma_f32_16x16x16_bf16 v[188:191], v[108:109], v[176:177], v[188:191]
    v_exp_f32 v172, v172
    v_mfma_f32_16x16x16_bf16 v[192:195], v[130:131], v[176:177], v[192:195]
    s_waitcnt lgkmcnt(2)
    v_exp_f32 v173, v173
    v_mfma_f32_16x16x32_bf16 v[164:167], v[18:21], v[132:135], v[164:167]
    v_exp_f32 v174, v174
    v_mfma_f32_16x16x32_bf16 v[220:223], a[44:47], v[252:255], v[220:223]
    v_exp_f32 v175, v175
    v_mfma_f32_16x16x32_bf16 v[200:203], v[252:255], a[108:111], v[200:203]
    v_cvt_pk_bf16_f32 v180, v172, v173
    v_cvt_pk_bf16_f32 v181, v174, v175
    v_mfma_f32_16x16x16_bf16 v[164:167], v[22:23], v[136:137], v[164:167]
    ds_read_b128 v[172:175], v236
    v_bfe_u32 v236, s73, v232, 4
    v_mfma_f32_16x16x16_bf16 v[196:199], a[216:217], v[180:181], v[196:199]
    v_mad_u32_u24 v236, v236, s40, v230
    v_max3_f32 v249, v147, v148, v149
    v_mfma_f32_16x16x16_bf16 v[184:187], v[82:83], v[180:181], v[184:187]
    v_max3_f32 v248, v248, v150, v151
    v_max3_f32 v249, v249, v152, v153
    v_mfma_f32_16x16x16_bf16 v[188:191], v[104:105], v[180:181], v[188:191]
    v_max3_f32 v248, v248, v154, v155
    v_max3_f32 v249, v249, v156, v157
    v_mfma_f32_16x16x16_bf16 v[192:195], v[126:127], v[180:181], v[192:195]
    s_waitcnt lgkmcnt(1)
    v_rcp_f32 v197, v196
    v_mfma_f32_16x16x32_bf16 v[168:171], v[0:3], v[132:135], v[168:171]
    v_mul_f32 v184, v184, v197
    v_mul_f32 v185, v185, v197
    v_mfma_f32_16x16x32_bf16 v[204:207], v[252:255], a[112:115], v[204:207]
    v_cvt_pk_bf16_f32 v184, v184, v185
    v_mul_f32 v186, v186, v197
    v_mfma_f32_16x16x32_bf16 v[208:211], v[252:255], a[116:119], v[208:211]
    v_mul_f32 v187, v187, v197
    v_cvt_pk_bf16_f32 v185, v186, v187
    v_mfma_f32_16x16x16_bf16 v[168:171], v[4:5], v[136:137], v[168:171]
    v_mul_f32 v188, v188, v197
    v_mul_f32 v189, v189, v197
    v_mfma_f32_16x16x32_bf16 v[212:215], a[48:51], a[232:235], v[212:215]
    v_cvt_pk_bf16_f32 v186, v188, v189
    v_mul_f32 v190, v190, v197
    v_mfma_f32_16x16x32_bf16 v[216:219], a[52:55], a[232:235], v[216:219]
    v_mul_f32 v191, v191, v197
    v_cvt_pk_bf16_f32 v187, v190, v191
    v_mfma_f32_16x16x32_bf16 v[220:223], a[56:59], a[232:235], v[220:223]
    v_mul_f32 v192, v192, v197
    v_mul_f32 v193, v193, v197
    v_mfma_f32_16x16x32_bf16 v[200:203], a[232:235], a[120:123], v[200:203]
    v_cvt_pk_bf16_f32 v188, v192, v193
    v_mul_f32 v194, v194, v197
    v_mfma_f32_16x16x32_bf16 v[204:207], a[232:235], a[124:127], v[204:207]
    ds_read_b128 v[252:255], v225 offset:43200
    v_mul_f32 v195, v195, v197
    v_mfma_f32_16x16x32_bf16 v[208:211], a[232:235], a[128:131], v[208:211]
    ds_read_b128 a[232:235], v225 offset:43264
    v_cvt_pk_bf16_f32 v189, v194, v195
    v_mfma_f32_16x16x32_bf16 v[212:215], a[60:63], a[236:239], v[212:215]
    ds_write_b128 v237, v[184:187] offset:6144
    v_mfma_f32_16x16x32_bf16 v[216:219], a[64:67], a[236:239], v[216:219]
    ds_write_b64 v238, v[188:189] offset:6144
    v_mfma_f32_16x16x32_bf16 v[220:223], a[68:71], a[236:239], v[220:223]
    v_max3_f32 v248, v248, v158, v159
    v_max3_f32 v249, v249, v160, v161
    v_mfma_f32_16x16x32_bf16 v[200:203], a[236:239], a[132:135], v[200:203]
    v_max3_f32 v248, v248, v162, v163
    v_cvt_pk_bf16_f32 v24, v212, v213
    v_mfma_f32_16x16x32_bf16 v[204:207], a[236:239], a[136:139], v[204:207]
    v_cvt_pk_bf16_f32 v25, v214, v215
    v_cvt_pk_bf16_f32 v26, v216, v217
    v_mfma_f32_16x16x32_bf16 v[208:211], a[236:239], a[140:143], v[208:211]
    v_cvt_pk_bf16_f32 v27, v218, v219
    v_cvt_pk_bf16_f32 v28, v220, v221
    v_mfma_f32_16x16x32_bf16 v[212:215], a[144:147], a[240:243], 0
    s_waitcnt lgkmcnt(4)
    v_cvt_pk_bf16_f32 v29, v222, v223
    v_cvt_pk_bf16_f32 v68, v200, v201
    v_mfma_f32_16x16x32_bf16 v[172:175], v[24:27], v[132:135], v[172:175]
    v_cvt_pk_bf16_f32 v69, v202, v203
    v_cvt_pk_bf16_f32 v90, v204, v205
    v_mfma_f32_16x16x32_bf16 v[216:219], a[148:151], a[240:243], 0
    v_cvt_pk_bf16_f32 v91, v206, v207
    v_cvt_pk_bf16_f32 v112, v208, v209
    v_mfma_f32_16x16x32_bf16 v[220:223], a[152:155], a[240:243], 0
    s_waitcnt vmcnt(4) lgkmcnt(0)
    ds_read_b128 a[236:239], v226 offset:1152
    v_cvt_pk_bf16_f32 v113, v210, v211
    v_mfma_f32_16x16x16_bf16 v[172:175], v[28:29], v[136:137], v[172:175]
    s_barrier
    ds_read_b128 a[240:243], v226 offset:1216
    v_max3_f32 v249, v249, v164, v165
    v_mfma_f32_16x16x32_bf16 v[212:215], a[156:159], a[244:247], v[212:215]
    v_max3_f32 v248, v248, v166, v167
    v_max3_f32 v249, v249, v168, v169
    v_mfma_f32_16x16x32_bf16 v[216:219], a[160:163], a[244:247], v[216:219]
    v_max3_f32 v248, v248, v170, v171
    v_max3_f32 v249, v249, v172, v173
    v_mfma_f32_16x16x32_bf16 v[220:223], a[164:167], a[244:247], v[220:223]
    ds_read_b128 a[244:247], v226 offset:1280
    v_max3_f32 v248, v248, v174, v175
    v_mfma_f32_16x16x32_bf16 v[212:215], a[168:171], a[248:251], v[212:215]
    v_max_f32 v248, v248, v249
    v_mov_b32 v249, v248
    v_mfma_f32_16x16x32_bf16 v[216:219], a[172:175], a[248:251], v[216:219]
    v_mfma_f32_16x16x32_bf16 v[220:223], a[176:179], a[248:251], v[220:223]
    ds_read_b128 a[248:251], v226 offset:1344
    v_mfma_f32_16x16x32_bf16 v[212:215], a[180:183], a[252:255], v[212:215]
    v_permlane16_swap_b32 v248, v249
    v_mfma_f32_16x16x32_bf16 v[216:219], a[184:187], a[252:255], v[216:219]
    v_max_f32 v248, v248, v249
    v_mov_b32 v249, v248
    v_mfma_f32_16x16x32_bf16 v[220:223], a[188:191], a[252:255], v[220:223]
    ds_read_b128 a[252:255], v226 offset:1408
    v_mfma_f32_16x16x32_bf16 v[212:215], a[192:195], v[252:255], v[212:215]
    v_permlane32_swap_b32 v248, v249
    v_mfma_f32_16x16x32_bf16 v[216:219], a[196:199], v[252:255], v[216:219]
    v_max_f32 v248, v248, v249
    v_mul_f32 v250, s37, v248
    v_mfma_f32_16x16x32_bf16 v[220:223], a[200:203], v[252:255], v[220:223]
    ds_read_b128 v[252:255], v226 offset:1472
    v_fma_f32 v144, v144, s37, -v250
    v_mfma_f32_16x16x32_bf16 v[212:215], a[204:207], a[232:235], v[212:215]
    v_fma_f32 v145, v145, s37, -v250
    v_fma_f32 v146, v146, s37, -v250
    v_mfma_f32_16x16x32_bf16 v[216:219], a[208:211], a[232:235], v[216:219]
    v_fma_f32 v147, v147, s37, -v250
    v_fma_f32 v148, v148, s37, -v250
    v_mfma_f32_16x16x32_bf16 v[220:223], a[212:215], a[232:235], v[220:223]
    s_waitcnt lgkmcnt(3)
    ds_read_b128 a[232:235], v227 offset:6144
    v_fma_f32 v149, v149, s37, -v250
    v_mfma_f32_16x16x32_bf16 v[200:203], a[144:147], a[236:239], 0
    v_cvt_pk_bf16_f32 v138, v212, v213
    v_cvt_pk_bf16_f32 v139, v214, v215
    v_mfma_f32_16x16x32_bf16 v[204:207], a[148:151], a[236:239], 0
    v_cvt_pk_bf16_f32 v140, v216, v217
    v_cvt_pk_bf16_f32 v141, v218, v219
    v_mfma_f32_16x16x32_bf16 v[208:211], a[152:155], a[236:239], 0
    v_cvt_pk_bf16_f32 v142, v220, v221
    v_cvt_pk_bf16_f32 v143, v222, v223
    v_mfma_f32_16x16x32_bf16 v[200:203], a[156:159], a[240:243], v[200:203]
    ds_read_b128 a[236:239], v227 offset:6208
    v_fma_f32 v150, v150, s37, -v250
    v_mfma_f32_16x16x32_bf16 v[204:207], a[160:163], a[240:243], v[204:207]
    v_exp_f32 v144, v144
    v_mfma_f32_16x16x32_bf16 v[208:211], a[164:167], a[240:243], v[208:211]
    ds_read_b128 a[240:243], v227 offset:6272
    v_fma_f32 v151, v151, s37, -v250
    v_mfma_f32_16x16x32_bf16 v[200:203], a[168:171], a[244:247], v[200:203]
    v_exp_f32 v145, v145
    v_mfma_f32_16x16x32_bf16 v[204:207], a[172:175], a[244:247], v[204:207]
    v_exp_f32 v146, v146
    v_mfma_f32_16x16x32_bf16 v[208:211], a[176:179], a[244:247], v[208:211]
    s_waitcnt lgkmcnt(3)
    ds_read_b128 a[244:247], v227 offset:6336
    v_cvt_pk_bf16_f32 v176, v144, v145
    v_mfma_f32_16x16x32_bf16 v[200:203], a[180:183], a[248:251], v[200:203]
    v_exp_f32 v147, v147
    v_mfma_f32_16x16x32_bf16 v[204:207], a[184:187], a[248:251], v[204:207]
    v_cvt_pk_bf16_f32 v177, v146, v147
    v_fma_f32 v152, v152, s37, -v250
    v_mfma_f32_16x16x32_bf16 v[208:211], a[188:191], a[248:251], v[208:211]
    ds_read_b128 a[248:251], v227 offset:6400
    ds_read_b128 v[144:147], v235
    v_mfma_f32_16x16x32_bf16 v[200:203], a[192:195], a[252:255], v[200:203]
    v_bfe_u32 v235, s75, v233, 4
    v_mad_u32_u24 v235, v235, s40, v231
    v_mfma_f32_16x16x32_bf16 v[204:207], a[196:199], a[252:255], v[204:207]
    v_exp_f32 v148, v148
    v_mfma_f32_16x16x32_bf16 v[208:211], a[200:203], a[252:255], v[208:211]
    ds_read_b128 a[252:255], v227 offset:6464
    v_fma_f32 v153, v153, s37, -v250
    v_mfma_f32_16x16x32_bf16 v[200:203], a[204:207], v[252:255], v[200:203]
    v_exp_f32 v149, v149
    v_mfma_f32_16x16x32_bf16 v[204:207], a[208:211], v[252:255], v[204:207]
    v_exp_f32 v150, v150
    v_mfma_f32_16x16x32_bf16 v[208:211], a[212:215], v[252:255], v[208:211]
    s_waitcnt lgkmcnt(4)
    ds_read_b128 v[252:255], v239
    v_cvt_pk_bf16_f32 v178, v148, v149
    v_mfma_f32_16x16x32_bf16 v[212:215], a[0:3], a[232:235], 0
    v_exp_f32 v151, v151
    v_mfma_f32_16x16x32_bf16 v[216:219], a[4:7], a[232:235], 0
    v_cvt_pk_bf16_f32 v132, v200, v201
    v_cvt_pk_bf16_f32 v133, v202, v203
    v_mfma_f32_16x16x32_bf16 v[220:223], a[8:11], a[232:235], 0
    v_cvt_pk_bf16_f32 v134, v204, v205
    v_cvt_pk_bf16_f32 v135, v206, v207
    v_mfma_f32_16x16x32_bf16 v[200:203], a[232:235], a[72:75], 0
    s_waitcnt lgkmcnt(2)
    v_cvt_pk_bf16_f32 v136, v208, v209
    v_cvt_pk_bf16_f32 v137, v210, v211
    v_mfma_f32_16x16x32_bf16 v[144:147], v[24:27], v[138:141], v[144:147]
    v_cvt_pk_bf16_f32 v179, v150, v151
    v_fma_f32 v154, v154, s37, -v250
    v_mfma_f32_16x16x32_bf16 v[204:207], a[232:235], a[76:79], 0
    ds_read_b128 v[148:151], v236
    v_bfe_u32 v236, s76, v233, 4
    v_mfma_f32_16x16x32_bf16 v[196:199], a[216:219], v[176:179], 0
    v_mad_u32_u24 v236, v236, s40, v231
    v_fma_f32 v155, v155, s37, -v250
    v_mfma_f32_16x16x32_bf16 v[184:187], v[70:73], v[176:179], 0
    v_exp_f32 v152, v152
    v_mfma_f32_16x16x32_bf16 v[188:191], v[92:95], v[176:179], 0
    v_exp_f32 v153, v153
    v_mfma_f32_16x16x32_bf16 v[192:195], v[114:117], v[176:179], 0
    v_exp_f32 v154, v154
    v_mfma_f32_16x16x16_bf16 v[144:147], v[28:29], v[142:143], v[144:147]
    v_exp_f32 v155, v155
    v_mfma_f32_16x16x32_bf16 v[208:211], a[232:235], a[80:83], 0
    ds_read_b128 a[232:235], v239 offset:6144
    v_cvt_pk_bf16_f32 v180, v152, v153
    v_mfma_f32_16x16x32_bf16 v[212:215], a[12:15], a[236:239], v[212:215]
    v_cvt_pk_bf16_f32 v181, v154, v155
    v_fma_f32 v156, v156, s37, -v250
    v_mfma_f32_16x16x32_bf16 v[216:219], a[16:19], a[236:239], v[216:219]
    ds_read_b128 v[152:155], v230 offset:1280
    v_fma_f32 v157, v157, s37, -v250
    v_mfma_f32_16x16x32_bf16 v[220:223], a[20:23], a[236:239], v[220:223]
    s_waitcnt lgkmcnt(2)
    v_fma_f32 v158, v158, s37, -v250
    v_fma_f32 v159, v159, s37, -v250
    v_mfma_f32_16x16x32_bf16 v[148:151], v[30:33], v[138:141], v[148:151]
    v_exp_f32 v156, v156
    v_mfma_f32_16x16x32_bf16 v[200:203], a[236:239], a[84:87], v[200:203]
    v_exp_f32 v157, v157
    v_mfma_f32_16x16x32_bf16 v[204:207], a[236:239], a[88:91], v[204:207]
    v_exp_f32 v158, v158
    v_mfma_f32_16x16x32_bf16 v[208:211], a[236:239], a[92:95], v[208:211]
    ds_read_b128 a[236:239], v239 offset:1024
    v_cvt_pk_bf16_f32 v182, v156, v157
    v_mfma_f32_16x16x16_bf16 v[148:151], v[34:35], v[142:143], v[148:151]
    v_exp_f32 v159, v159
    v_mfma_f32_16x16x32_bf16 v[212:215], a[24:27], a[240:243], v[212:215]
    v_cvt_pk_bf16_f32 v183, v158, v159
    v_fma_f32 v160, v160, s37, -v250
    v_mfma_f32_16x16x32_bf16 v[216:219], a[28:31], a[240:243], v[216:219]
    ds_read_b128 v[156:159], v230 offset:1920
    v_fma_f32 v161, v161, s37, -v250
    v_mfma_f32_16x16x32_bf16 v[196:199], a[216:219], v[180:183], v[196:199]
    v_fma_f32 v162, v162, s37, -v250
    v_fma_f32 v163, v163, s37, -v250
    v_mfma_f32_16x16x32_bf16 v[184:187], v[74:77], v[180:183], v[184:187]
    v_exp_f32 v160, v160
    v_mfma_f32_16x16x32_bf16 v[188:191], v[96:99], v[180:183], v[188:191]
    v_exp_f32 v161, v161
    v_mfma_f32_16x16x32_bf16 v[192:195], v[118:121], v[180:183], v[192:195]
    s_waitcnt lgkmcnt(2)
    v_exp_f32 v162, v162
    v_mfma_f32_16x16x32_bf16 v[152:155], v[36:39], v[138:141], v[152:155]
    v_exp_f32 v163, v163
    v_mfma_f32_16x16x32_bf16 v[220:223], a[32:35], a[240:243], v[220:223]
    v_cvt_pk_bf16_f32 v176, v160, v161
    v_cvt_pk_bf16_f32 v177, v162, v163
    v_mfma_f32_16x16x32_bf16 v[200:203], a[240:243], a[96:99], v[200:203]
    ds_read_b128 v[160:163], v234
    v_bfe_u32 v234, s73, v232, 4
    v_mfma_f32_16x16x16_bf16 v[152:155], v[40:41], v[142:143], v[152:155]
    v_fma_f32 v164, v164, s37, -v250
    v_fma_f32 v165, v165, s37, -v250
    v_mfma_f32_16x16x32_bf16 v[204:207], a[240:243], a[100:103], v[204:207]
    s_waitcnt lgkmcnt(1)
    v_fma_f32 v166, v166, s37, -v250
    v_fma_f32 v167, v167, s37, -v250
    v_mfma_f32_16x16x32_bf16 v[156:159], v[42:45], v[138:141], v[156:159]
    v_exp_f32 v164, v164
    v_mfma_f32_16x16x32_bf16 v[208:211], a[240:243], a[104:107], v[208:211]
    ds_read_b128 a[240:243], v239 offset:7168
    v_fma_f32 v168, v168, s37, -v250
    v_mfma_f32_16x16x32_bf16 v[212:215], a[36:39], a[244:247], v[212:215]
    v_exp_f32 v165, v165
    v_mfma_f32_16x16x16_bf16 v[156:159], v[46:47], v[142:143], v[156:159]
    v_exp_f32 v166, v166
    v_mfma_f32_16x16x32_bf16 v[216:219], a[40:43], a[244:247], v[216:219]
    v_exp_f32 v167, v167
    v_mfma_f32_16x16x32_bf16 v[220:223], a[44:47], a[244:247], v[220:223]
    v_cvt_pk_bf16_f32 v178, v164, v165
    v_cvt_pk_bf16_f32 v179, v166, v167
    v_mfma_f32_16x16x32_bf16 v[200:203], a[244:247], a[108:111], v[200:203]
    ds_read_b128 v[164:167], v235
    v_mad_u32_u24 v235, v234, s40, v228
    v_mfma_f32_16x16x32_bf16 v[196:199], a[216:219], v[176:179], v[196:199]
    v_mad_u32_u24 v234, v234, s40, v229
    v_fma_f32 v169, v169, s37, -v250
    v_mfma_f32_16x16x32_bf16 v[184:187], v[78:81], v[176:179], v[184:187]
    v_fma_f32 v170, v170, s37, -v250
    v_fma_f32 v171, v171, s37, -v250
    v_mfma_f32_16x16x32_bf16 v[188:191], v[100:103], v[176:179], v[188:191]
    v_exp_f32 v168, v168
    v_mfma_f32_16x16x32_bf16 v[192:195], v[122:125], v[176:179], v[192:195]
    s_waitcnt lgkmcnt(2)
    v_exp_f32 v169, v169
    v_mfma_f32_16x16x32_bf16 v[160:163], v[48:51], v[138:141], v[160:163]
    v_exp_f32 v170, v170
    v_mfma_f32_16x16x32_bf16 v[204:207], a[244:247], a[112:115], v[204:207]
    v_exp_f32 v171, v171
    v_mfma_f32_16x16x32_bf16 v[208:211], a[244:247], a[116:119], v[208:211]
    ds_read_b64_tr_b16 a[244:245], v240 offset:12288
    ds_read_b64_tr_b16 a[246:247], v240 offset:26112
    v_mfma_f32_16x16x16_bf16 v[160:163], v[52:53], v[142:143], v[160:163]
    v_cvt_pk_bf16_f32 v180, v168, v169
    v_cvt_pk_bf16_f32 v181, v170, v171
    v_mfma_f32_16x16x32_bf16 v[212:215], a[48:51], a[248:251], v[212:215]
    ds_read_b128 v[168:171], v236
    v_bfe_u32 v236, s77, v232, 4
    v_mfma_f32_16x16x32_bf16 v[216:219], a[52:55], a[248:251], v[216:219]
    v_fma_f32 v172, v172, s37, -v250
    v_fma_f32 v173, v173, s37, -v250
    v_mfma_f32_16x16x32_bf16 v[220:223], a[56:59], a[248:251], v[220:223]
    v_fma_f32 v174, v174, s37, -v250
    v_fma_f32 v175, v175, s37, -v250
    v_mfma_f32_16x16x32_bf16 v[200:203], a[248:251], a[120:123], v[200:203]
    v_exp_f32 v172, v172
    v_mfma_f32_16x16x32_bf16 v[204:207], a[248:251], a[124:127], v[204:207]
    v_exp_f32 v173, v173
    v_mfma_f32_16x16x32_bf16 v[208:211], a[248:251], a[128:131], v[208:211]
    ds_read_b64_tr_b16 a[248:249], v240 offset:12296
    ds_read_b64_tr_b16 a[250:251], v240 offset:26120
    v_mfma_f32_16x16x32_bf16 v[212:215], a[60:63], a[252:255], v[212:215]
    v_exp_f32 v174, v174
    v_mfma_f32_16x16x32_bf16 v[216:219], a[64:67], a[252:255], v[216:219]
    v_exp_f32 v175, v175
    v_mfma_f32_16x16x32_bf16 v[220:223], a[68:71], a[252:255], v[220:223]
    v_cvt_pk_bf16_f32 v182, v172, v173
    v_cvt_pk_bf16_f32 v183, v174, v175
    v_mfma_f32_16x16x32_bf16 v[200:203], a[252:255], a[132:135], v[200:203]
    ds_read_b128 v[172:175], v235
    v_cvt_pk_bf16_f32 v54, v212, v213
    v_mfma_f32_16x16x32_bf16 v[196:199], a[216:219], v[180:183], v[196:199]
    v_cvt_pk_bf16_f32 v55, v214, v215
    v_cvt_pk_bf16_f32 v56, v216, v217
    v_mfma_f32_16x16x32_bf16 v[184:187], v[66:69], v[180:183], v[184:187]
    v_cvt_pk_bf16_f32 v57, v218, v219
    v_cvt_pk_bf16_f32 v58, v220, v221
    v_mfma_f32_16x16x32_bf16 v[188:191], v[88:91], v[180:183], v[188:191]
    v_cvt_pk_bf16_f32 v59, v222, v223
    v_cvt_pk_bf16_f32 v84, v200, v201
    v_mfma_f32_16x16x32_bf16 v[192:195], v[110:113], v[180:183], v[192:195]
    s_waitcnt lgkmcnt(3)
    v_cvt_pk_bf16_f32 v85, v202, v203
    v_bfe_u32 v235, s78, v232, 4
    v_mfma_f32_16x16x32_bf16 v[164:167], v[54:57], v[138:141], v[164:167]
    v_rcp_f32 v197, v196
    v_mfma_f32_16x16x32_bf16 v[168:171], v[60:63], v[138:141], v[168:171]
    v_mul_f32 v184, v184, v197
    v_mul_f32 v185, v185, v197
    v_mfma_f32_16x16x32_bf16 v[204:207], a[252:255], a[136:139], v[204:207]
    v_cvt_pk_bf16_f32 v184, v184, v185
    v_mul_f32 v186, v186, v197
    v_mfma_f32_16x16x16_bf16 v[164:167], v[58:59], v[142:143], v[164:167]
    v_mul_f32 v187, v187, v197
    v_cvt_pk_bf16_f32 v185, v186, v187
    v_mfma_f32_16x16x16_bf16 v[168:171], v[64:65], v[142:143], v[168:171]
    s_waitcnt lgkmcnt(0)
    v_mul_f32 v188, v188, v197
    v_mul_f32 v189, v189, v197
    v_mfma_f32_16x16x32_bf16 v[172:175], v[12:15], v[132:135], v[172:175]
    v_cvt_pk_bf16_f32 v106, v204, v205
    v_cvt_pk_bf16_f32 v107, v206, v207
    v_mfma_f32_16x16x32_bf16 v[208:211], a[252:255], a[140:143], v[208:211]
    ds_read_b64_tr_b16 a[252:253], v241 offset:12288
    ds_read_b64_tr_b16 a[254:255], v241 offset:26112
    v_mfma_f32_16x16x32_bf16 v[212:215], a[220:223], v[252:255], 0
    v_cvt_pk_bf16_f32 v186, v188, v189
    v_mul_f32 v190, v190, v197
    v_mfma_f32_16x16x16_bf16 v[172:175], v[16:17], v[136:137], v[172:175]
    v_mul_f32 v191, v191, v197
    v_cvt_pk_bf16_f32 v187, v190, v191
    v_mfma_f32_16x16x32_bf16 v[200:203], a[220:223], a[232:235], 0
    v_cvt_pk_bf16_f32 v128, v208, v209
    v_cvt_pk_bf16_f32 v129, v210, v211
    v_mfma_f32_16x16x32_bf16 v[216:219], a[224:227], v[252:255], 0
    v_mul_f32 v192, v192, v197
    v_mul_f32 v193, v193, v197
    v_mfma_f32_16x16x32_bf16 v[204:207], a[224:227], a[232:235], 0
    v_cvt_pk_bf16_f32 v188, v192, v193
    v_mul_f32 v194, v194, v197
    v_mfma_f32_16x16x32_bf16 v[220:223], a[228:231], v[252:255], 0
    ds_read_b128 v[252:255], v239 offset:2048
    v_mul_f32 v195, v195, v197
    v_mfma_f32_16x16x32_bf16 v[208:211], a[228:231], a[232:235], 0
    ds_read_b128 a[232:235], v239 offset:8192
    v_cvt_pk_bf16_f32 v189, v194, v195
    v_mfma_f32_16x16x32_bf16 v[212:215], a[244:247], a[236:239], v[212:215]
    ds_write_b128 v237, v[184:187] offset:12288
    v_mfma_f32_16x16x32_bf16 v[200:203], a[244:247], a[240:243], v[200:203]
    ds_read_b64_tr_b16 a[244:245], v241 offset:13824
    ds_read_b64_tr_b16 a[246:247], v241 offset:24576
    v_mfma_f32_16x16x32_bf16 v[216:219], a[248:251], a[236:239], v[216:219]
    ds_write_b64 v238, v[188:189] offset:12288
    v_mfma_f32_16x16x32_bf16 v[204:207], a[248:251], a[240:243], v[204:207]
    s_waitcnt lgkmcnt(6)
    ds_read_b128 a[248:251], v239 offset:3072
    v_max3_f32 v248, v144, v145, v146
    v_mfma_f32_16x16x32_bf16 v[220:223], a[252:255], a[236:239], v[220:223]
    ds_read_b64_tr_b16 a[236:237], v240 offset:13824
    ds_read_b64_tr_b16 a[238:239], v240 offset:24576
    v_mfma_f32_16x16x32_bf16 v[208:211], a[252:255], a[240:243], v[208:211]
    s_waitcnt lgkmcnt(4)
    ds_read_b64_tr_b16 a[240:241], v240 offset:13832
    ds_read_b64_tr_b16 a[242:243], v240 offset:24584
    v_max3_f32 v249, v147, v148, v149
    v_max3_f32 v248, v248, v150, v151
    ds_read_b128 a[252:255], v239 offset:9216
    v_max3_f32 v249, v249, v152, v153
    v_max3_f32 v248, v248, v154, v155
    v_max3_f32 v249, v249, v156, v157
    v_max3_f32 v248, v248, v158, v159
    v_max3_f32 v249, v249, v160, v161
    v_max3_f32 v248, v248, v162, v163
    v_max3_f32 v249, v249, v164, v165
    v_max3_f32 v248, v248, v166, v167
    v_max3_f32 v249, v249, v168, v169
    v_mfma_f32_16x16x32_bf16 v[220:223], a[244:247], v[252:255], v[220:223]
    v_max3_f32 v248, v248, v170, v171
    v_max_f32 v248, v248, v249
    v_mfma_f32_16x16x32_bf16 v[208:211], a[244:247], a[232:235], v[208:211]
    s_waitcnt lgkmcnt(3)
    ds_read_b128 a[244:247], v239 offset:10240
    v_mov_b32 v249, v248
    s_nop 1
    v_permlane16_swap_b32 v248, v249
    v_max_f32 v248, v248, v249
    v_mov_b32 v249, v248
    s_nop 1
    v_mfma_f32_16x16x32_bf16 v[212:215], a[236:239], v[252:255], v[212:215]
    v_permlane32_swap_b32 v248, v249
    v_mfma_f32_16x16x32_bf16 v[200:203], a[236:239], a[232:235], v[200:203]
    s_waitcnt lgkmcnt(2)
    ds_read_b64_tr_b16 a[236:237], v241 offset:36864
    ds_read_b64_tr_b16 a[238:239], v241 offset:38400
    v_mfma_f32_16x16x32_bf16 v[216:219], a[240:243], v[252:255], v[216:219]
    ds_read_b64_tr_b16 v[252:253], v240 offset:36864
    ds_read_b64_tr_b16 v[254:255], v240 offset:38400
    v_mfma_f32_16x16x32_bf16 v[204:207], a[240:243], a[232:235], v[204:207]
    s_waitcnt lgkmcnt(2)
    ds_read_b64_tr_b16 a[232:233], v240 offset:36872
    ds_read_b64_tr_b16 a[234:235], v240 offset:38408
    v_max_f32 v248, v248, v249
    v_mul_f32 v250, s37, v248
    ds_read_b128 a[240:243], v239 offset:4096
    v_fma_f32 v144, v144, s37, -v250
    v_fma_f32 v145, v145, s37, -v250
    v_fma_f32 v146, v146, s37, -v250
    v_fma_f32 v147, v147, s37, -v250
    v_exp_f32 v144, v144
    v_exp_f32 v145, v145
    v_exp_f32 v146, v146
    v_exp_f32 v147, v147
    v_cvt_pk_bf16_f32 v176, v144, v145
    v_cvt_pk_bf16_f32 v177, v146, v147
    ds_read_b128 v[144:147], v234
    v_mfma_f32_16x16x32_bf16 v[220:223], a[236:239], a[248:251], v[220:223]
    v_mad_u32_u24 v234, v236, s40, v228
    v_mad_u32_u24 v236, v236, s40, v229
    v_mfma_f32_16x16x32_bf16 v[208:211], a[236:239], a[252:255], v[208:211]
    s_waitcnt lgkmcnt(4)
    ds_read_b128 a[236:239], v239 offset:11264
    v_fma_f32 v148, v148, s37, -v250
    v_mfma_f32_16x16x32_bf16 v[212:215], v[252:255], a[248:251], v[212:215]
    v_fma_f32 v149, v149, s37, -v250
    v_fma_f32 v150, v150, s37, -v250
    v_mfma_f32_16x16x32_bf16 v[200:203], v[252:255], a[252:255], v[200:203]
    s_waitcnt lgkmcnt(3)
    ds_read_b64_tr_b16 v[252:253], v241 offset:49152
    ds_read_b64_tr_b16 v[254:255], v241 offset:62976
    v_mfma_f32_16x16x32_bf16 v[216:219], a[232:235], a[248:251], v[216:219]
    ds_read_b64_tr_b16 a[248:249], v240 offset:49152
    ds_read_b64_tr_b16 a[250:251], v240 offset:62976
    v_mfma_f32_16x16x32_bf16 v[204:207], a[232:235], a[252:255], v[204:207]
    s_waitcnt lgkmcnt(5)
    ds_read_b64_tr_b16 a[252:253], v240 offset:49160
    ds_read_b64_tr_b16 a[254:255], v240 offset:62984
    v_fma_f32 v151, v151, s37, -v250
    v_exp_f32 v148, v148
    ds_read_b128 a[232:235], v239 offset:5120
    v_exp_f32 v149, v149
    v_exp_f32 v150, v150
    v_exp_f32 v151, v151
    v_mfma_f32_16x16x32_bf16 v[144:147], v[36:39], v[132:135], v[144:147]
    v_cvt_pk_bf16_f32 v178, v148, v149
    v_cvt_pk_bf16_f32 v179, v150, v151
    ds_read_b128 v[148:151], v229 offset:1280
    v_fma_f32 v152, v152, s37, -v250
    v_mfma_f32_16x16x32_bf16 v[196:199], a[216:219], v[176:179], 0
    v_fma_f32 v153, v153, s37, -v250
    v_fma_f32 v154, v154, s37, -v250
    v_mfma_f32_16x16x32_bf16 v[184:187], v[68:71], v[176:179], 0
    v_fma_f32 v155, v155, s37, -v250
    v_fma_f32 v156, v156, s37, -v250
    v_mfma_f32_16x16x32_bf16 v[188:191], v[90:93], v[176:179], 0
    v_exp_f32 v152, v152
    v_mfma_f32_16x16x32_bf16 v[192:195], v[112:115], v[176:179], 0
    v_exp_f32 v153, v153
    v_mfma_f32_16x16x16_bf16 v[144:147], v[40:41], v[136:137], v[144:147]
    s_waitcnt lgkmcnt(4)
    v_exp_f32 v154, v154
    v_mfma_f32_16x16x32_bf16 v[212:215], a[248:251], a[240:243], v[212:215]
    v_exp_f32 v155, v155
    v_mfma_f32_16x16x32_bf16 v[200:203], a[248:251], a[244:247], v[200:203]
    s_waitcnt lgkmcnt(2)
    ds_read_b64_tr_b16 a[248:249], v241 offset:50688
    ds_read_b64_tr_b16 a[250:251], v241 offset:61440
    v_mfma_f32_16x16x32_bf16 v[216:219], a[252:255], a[240:243], v[216:219]
    v_cvt_pk_bf16_f32 v180, v152, v153
    v_cvt_pk_bf16_f32 v181, v154, v155
    v_mfma_f32_16x16x32_bf16 v[204:207], a[252:255], a[244:247], v[204:207]
    s_waitcnt lgkmcnt(2)
    ds_read_b128 a[252:255], v224 offset:15488
    ds_read_b128 v[152:155], v228 offset:1280
    v_mfma_f32_16x16x32_bf16 v[148:151], v[42:45], v[132:135], v[148:151]
    v_fma_f32 v157, v157, s37, -v250
    v_fma_f32 v158, v158, s37, -v250
    v_mfma_f32_16x16x32_bf16 v[220:223], v[252:255], a[240:243], v[220:223]
    ds_read_b64_tr_b16 a[240:241], v240 offset:50688
    ds_read_b64_tr_b16 a[242:243], v240 offset:61440
    v_mfma_f32_16x16x32_bf16 v[208:211], v[252:255], a[244:247], v[208:211]
    ds_read_b64_tr_b16 a[244:245], v240 offset:50696
    v_fma_f32 v159, v159, s37, -v250
    v_mfma_f32_16x16x16_bf16 v[148:151], v[46:47], v[136:137], v[148:151]
    s_waitcnt lgkmcnt(5)
    ds_read_b64_tr_b16 a[246:247], v240 offset:61448
    v_exp_f32 v156, v156
    v_exp_f32 v157, v157
    ds_read_b128 v[252:255], v224 offset:15552
    v_mfma_f32_16x16x32_bf16 v[220:223], a[248:251], a[232:235], v[220:223]
    v_exp_f32 v158, v158
    v_mfma_f32_16x16x32_bf16 v[208:211], a[248:251], a[236:239], v[208:211]
    ds_read_b128 a[248:251], v224 offset:18560
    v_exp_f32 v159, v159
    v_cvt_pk_bf16_f32 v182, v156, v157
    v_cvt_pk_bf16_f32 v183, v158, v159
    ds_read_b128 v[156:159], v234
    v_bfe_u32 v234, s73, v232, 4
    v_mfma_f32_16x16x32_bf16 v[196:199], a[216:219], v[180:183], v[196:199]
    v_cvt_pk_bf16_f32 v220, v220, v221
    v_cvt_pk_bf16_f32 v221, v222, v223
    v_mfma_f32_16x16x32_bf16 v[184:187], v[76:79], v[180:183], v[184:187]
    buffer_store_dwordx2 v[220:221], v243, s[20:23], s58 offen sc0 sc1
    v_mfma_f32_16x16x32_bf16 v[188:191], v[98:101], v[180:183], v[188:191]
    v_cvt_pk_bf16_f32 v208, v208, v209
    v_cvt_pk_bf16_f32 v209, v210, v211
    v_mfma_f32_16x16x32_bf16 v[192:195], v[120:123], v[180:183], v[192:195]
    s_waitcnt lgkmcnt(5)
    buffer_store_dwordx2 v[208:209], v245, s[20:23], s59 offen sc0 sc1
    v_mfma_f32_16x16x32_bf16 v[152:155], v[18:21], v[132:135], v[152:155]
    v_mad_u32_u24 v234, v234, s40, v230
    v_fma_f32 v160, v160, s37, -v250
    v_mfma_f32_16x16x32_bf16 v[212:215], a[240:243], a[232:235], v[212:215]
    v_fma_f32 v161, v161, s37, -v250
    v_fma_f32 v162, v162, s37, -v250
    v_mfma_f32_16x16x32_bf16 v[200:203], a[240:243], a[236:239], v[200:203]
    ds_read_b128 a[240:243], v224 offset:15744
    v_fma_f32 v163, v163, s37, -v250
    v_mfma_f32_16x16x16_bf16 v[152:155], v[22:23], v[136:137], v[152:155]
    s_waitcnt lgkmcnt(1)
    v_exp_f32 v160, v160
    v_mfma_f32_16x16x32_bf16 v[156:159], v[0:3], v[132:135], v[156:159]
    v_cvt_pk_bf16_f32 v212, v212, v213
    v_cvt_pk_bf16_f32 v213, v214, v215
    v_mfma_f32_16x16x32_bf16 v[216:219], a[244:247], a[232:235], v[216:219]
    ds_read_b128 a[232:235], v224 offset:15616
    v_cvt_pk_bf16_f32 v200, v200, v201
    v_mfma_f32_16x16x32_bf16 v[204:207], a[244:247], a[236:239], v[204:207]
    ds_read_b128 a[236:239], v224 offset:15680
    v_cvt_pk_bf16_f32 v201, v202, v203
    v_mfma_f32_16x16x16_bf16 v[156:159], v[4:5], v[136:137], v[156:159]
    ds_read_b128 a[244:247], v224 offset:15808
    v_fma_f32 v164, v164, s37, -v250
    v_mfma_f32_16x16x32_bf16 v[220:223], a[8:11], a[252:255], 0
    v_cvt_pk_bf16_f32 v214, v216, v217
    v_cvt_pk_bf16_f32 v215, v218, v219
    v_mfma_f32_16x16x32_bf16 v[216:219], a[4:7], a[252:255], 0
    buffer_store_dwordx4 v[212:215], v242, s[20:23], s58 offen sc0 sc1
    v_mfma_f32_16x16x32_bf16 v[208:211], a[252:255], a[80:83], 0
    s_add_u32 s58, s51, 0x1a4000
    v_cvt_pk_bf16_f32 v202, v204, v205
    v_cvt_pk_bf16_f32 v203, v206, v207
    v_mfma_f32_16x16x32_bf16 v[212:215], a[0:3], a[252:255], 0
    buffer_store_dwordx4 v[200:203], v244, s[20:23], s59 offen sc0 sc1
    v_mfma_f32_16x16x32_bf16 v[204:207], a[252:255], a[76:79], 0
    s_add_u32 s59, s51, 0x1a5800
    v_exp_f32 v161, v161
    v_mfma_f32_16x16x32_bf16 v[200:203], a[252:255], a[72:75], 0
    ds_read_b128 a[252:255], v224 offset:18624
    v_cvt_pk_bf16_f32 v176, v160, v161
    v_mfma_f32_16x16x32_bf16 v[212:215], a[12:15], v[252:255], v[212:215]
    v_exp_f32 v162, v162
    v_mfma_f32_16x16x32_bf16 v[216:219], a[16:19], v[252:255], v[216:219]
    v_exp_f32 v163, v163
    v_mfma_f32_16x16x32_bf16 v[220:223], a[20:23], v[252:255], v[220:223]
    v_cvt_pk_bf16_f32 v177, v162, v163
    v_fma_f32 v165, v165, s37, -v250
    v_mfma_f32_16x16x32_bf16 v[200:203], v[252:255], a[84:87], v[200:203]
    ds_read_b128 v[160:163], v236
    v_mad_u32_u24 v236, v235, s40, v229
    v_mfma_f32_16x16x16_bf16 v[196:199], a[216:217], v[176:177], v[196:199]
    v_mad_u32_u24 v235, v235, s40, v228
    v_fma_f32 v166, v166, s37, -v250
    v_mfma_f32_16x16x16_bf16 v[184:187], v[82:83], v[176:177], v[184:187]
    v_fma_f32 v167, v167, s37, -v250
    v_fma_f32 v168, v168, s37, -v250
    v_mfma_f32_16x16x16_bf16 v[188:191], v[104:105], v[176:177], v[188:191]
    v_exp_f32 v164, v164
    v_mfma_f32_16x16x16_bf16 v[192:195], v[126:127], v[176:177], v[192:195]
    v_exp_f32 v165, v165
    v_mfma_f32_16x16x32_bf16 v[204:207], v[252:255], a[88:91], v[204:207]
    v_exp_f32 v166, v166
    v_mfma_f32_16x16x32_bf16 v[208:211], v[252:255], a[92:95], v[208:211]
    s_waitcnt lgkmcnt(1)
    ds_read_b128 v[252:255], v224 offset:18688
    v_cvt_pk_bf16_f32 v180, v164, v165
    v_mfma_f32_16x16x32_bf16 v[212:215], a[24:27], a[232:235], v[212:215]
    v_exp_f32 v167, v167
    v_mfma_f32_16x16x32_bf16 v[216:219], a[28:31], a[232:235], v[216:219]
    v_cvt_pk_bf16_f32 v181, v166, v167
    v_fma_f32 v169, v169, s37, -v250
    v_mfma_f32_16x16x32_bf16 v[220:223], a[32:35], a[232:235], v[220:223]
    s_waitcnt lgkmcnt(1)
    ds_read_b128 v[164:167], v236
    v_bfe_u32 v236, s78, v232, 4
    v_mfma_f32_16x16x32_bf16 v[160:163], v[24:27], v[132:135], v[160:163]
    v_mad_u32_u24 v236, v236, s40, v230
    v_fma_f32 v170, v170, s37, -v250
    v_mfma_f32_16x16x32_bf16 v[200:203], a[232:235], a[96:99], v[200:203]
    v_fma_f32 v171, v171, s37, -v250
    v_max3_f32 v248, v172, v173, v174
    v_mfma_f32_16x16x32_bf16 v[204:207], a[232:235], a[100:103], v[204:207]
    v_exp_f32 v168, v168
    v_mfma_f32_16x16x16_bf16 v[160:163], v[28:29], v[136:137], v[160:163]
    v_exp_f32 v169, v169
    v_mfma_f32_16x16x32_bf16 v[208:211], a[232:235], a[104:107], v[208:211]
    ds_read_b128 a[232:235], v224 offset:18752
    v_cvt_pk_bf16_f32 v182, v168, v169
    v_mfma_f32_16x16x32_bf16 v[212:215], a[36:39], a[236:239], v[212:215]
    v_exp_f32 v170, v170
    v_mfma_f32_16x16x32_bf16 v[216:219], a[40:43], a[236:239], v[216:219]
    v_exp_f32 v171, v171
    v_mfma_f32_16x16x32_bf16 v[220:223], a[44:47], a[236:239], v[220:223]
    v_cvt_pk_bf16_f32 v183, v170, v171
    v_max3_f32 v249, v175, v144, v145
    v_mfma_f32_16x16x32_bf16 v[200:203], a[236:239], a[108:111], v[200:203]
    ds_read_b128 v[168:171], v235
    v_bfe_u32 v235, s77, v232, 4
    v_mfma_f32_16x16x32_bf16 v[196:199], a[216:219], v[180:183], v[196:199]
    v_mad_u32_u24 v235, v235, s40, v230
    v_max3_f32 v248, v248, v146, v147
    v_mfma_f32_16x16x32_bf16 v[184:187], v[84:87], v[180:183], v[184:187]
    v_max3_f32 v249, v249, v148, v149
    v_max3_f32 v248, v248, v150, v151
    v_mfma_f32_16x16x32_bf16 v[188:191], v[106:109], v[180:183], v[188:191]
    v_max3_f32 v249, v249, v152, v153
    v_max3_f32 v248, v248, v154, v155
    v_mfma_f32_16x16x32_bf16 v[192:195], v[128:131], v[180:183], v[192:195]
    v_rcp_f32 v197, v196
    v_mfma_f32_16x16x32_bf16 v[204:207], a[236:239], a[112:115], v[204:207]
    v_mul_f32 v184, v184, v197
    v_mul_f32 v185, v185, v197
    v_mfma_f32_16x16x32_bf16 v[208:211], a[236:239], a[116:119], v[208:211]
    ds_read_b128 a[236:239], v224 offset:18816
    v_cvt_pk_bf16_f32 v184, v184, v185
    v_mfma_f32_16x16x32_bf16 v[212:215], a[48:51], a[240:243], v[212:215]
    v_mul_f32 v186, v186, v197
    v_mul_f32 v187, v187, v197
    v_mfma_f32_16x16x32_bf16 v[216:219], a[52:55], a[240:243], v[216:219]
    v_cvt_pk_bf16_f32 v185, v186, v187
    v_mul_f32 v188, v188, v197
    v_mfma_f32_16x16x32_bf16 v[220:223], a[56:59], a[240:243], v[220:223]
    v_mul_f32 v189, v189, v197
    v_cvt_pk_bf16_f32 v186, v188, v189
    v_mfma_f32_16x16x32_bf16 v[200:203], a[240:243], a[120:123], v[200:203]
    v_mul_f32 v190, v190, v197
    v_mul_f32 v191, v191, v197
    v_mfma_f32_16x16x32_bf16 v[204:207], a[240:243], a[124:127], v[204:207]
    v_cvt_pk_bf16_f32 v187, v190, v191
    v_mul_f32 v192, v192, v197
    v_mfma_f32_16x16x32_bf16 v[208:211], a[240:243], a[128:131], v[208:211]
    ds_read_b128 a[240:243], v224 offset:18880
    v_mul_f32 v193, v193, v197
    v_mfma_f32_16x16x32_bf16 v[212:215], a[60:63], a[244:247], v[212:215]
    v_cvt_pk_bf16_f32 v188, v192, v193
    v_mul_f32 v194, v194, v197
    v_mfma_f32_16x16x32_bf16 v[216:219], a[64:67], a[244:247], v[216:219]
    v_mul_f32 v195, v195, v197
    v_cvt_pk_bf16_f32 v189, v194, v195
    v_mfma_f32_16x16x32_bf16 v[220:223], a[68:71], a[244:247], v[220:223]
    ds_write_b128 v237, v[184:187] offset:18432
    v_mfma_f32_16x16x32_bf16 v[200:203], a[244:247], a[132:135], v[200:203]
    v_cvt_pk_bf16_f32 v6, v212, v213
    v_cvt_pk_bf16_f32 v7, v214, v215
    v_mfma_f32_16x16x32_bf16 v[204:207], a[244:247], a[136:139], v[204:207]
    v_cvt_pk_bf16_f32 v8, v216, v217
    v_cvt_pk_bf16_f32 v9, v218, v219
    v_mfma_f32_16x16x32_bf16 v[208:211], a[244:247], a[140:143], v[208:211]
    s_waitcnt lgkmcnt(2)
    v_cvt_pk_bf16_f32 v10, v220, v221
    v_cvt_pk_bf16_f32 v11, v222, v223
    v_mfma_f32_16x16x32_bf16 v[168:171], v[6:9], v[132:135], v[168:171]
    v_cvt_pk_bf16_f32 v72, v200, v201
    v_cvt_pk_bf16_f32 v73, v202, v203
    v_mfma_f32_16x16x32_bf16 v[212:215], a[0:3], a[248:251], 0
    v_cvt_pk_bf16_f32 v94, v204, v205
    v_cvt_pk_bf16_f32 v95, v206, v207
    v_mfma_f32_16x16x32_bf16 v[216:219], a[4:7], a[248:251], 0
    v_cvt_pk_bf16_f32 v116, v208, v209
    v_cvt_pk_bf16_f32 v117, v210, v211
    v_mfma_f32_16x16x16_bf16 v[168:171], v[10:11], v[136:137], v[168:171]
    ds_write_b64 v238, v[188:189] offset:18432
    v_mfma_f32_16x16x32_bf16 v[220:223], a[8:11], a[248:251], 0
    ds_read_b128 a[244:247], v226 offset:4224
    v_max3_f32 v249, v249, v156, v157
    v_mfma_f32_16x16x32_bf16 v[200:203], a[248:251], a[72:75], 0
    v_max3_f32 v248, v248, v158, v159
    v_max3_f32 v249, v249, v160, v161
    v_mfma_f32_16x16x32_bf16 v[204:207], a[248:251], a[76:79], 0
    v_max3_f32 v248, v248, v162, v163
    v_mfma_f32_16x16x32_bf16 v[208:211], a[248:251], a[80:83], 0
    ds_read_b128 a[248:251], v226 offset:4288
    v_mfma_f32_16x16x32_bf16 v[212:215], a[12:15], a[252:255], v[212:215]
    ds_read_b64_tr_b16 a[12:13], v240 offset:12288
    ds_read_b64_tr_b16 a[14:15], v240 offset:26112
    v_mfma_f32_16x16x32_bf16 v[216:219], a[16:19], a[252:255], v[216:219]
    ds_read_b64_tr_b16 a[16:17], v240 offset:12296
    ds_read_b64_tr_b16 a[18:19], v240 offset:26120
    v_mfma_f32_16x16x32_bf16 v[220:223], a[20:23], a[252:255], v[220:223]
    s_waitcnt lgkmcnt(6)
    ds_read_b64_tr_b16 a[20:21], v241 offset:12288
    v_mfma_f32_16x16x32_bf16 v[200:203], a[252:255], a[84:87], v[200:203]
    s_barrier
    ds_read_b64_tr_b16 a[22:23], v241 offset:26112
    v_mfma_f32_16x16x32_bf16 v[204:207], a[252:255], a[88:91], v[204:207]
    v_mfma_f32_16x16x32_bf16 v[208:211], a[252:255], a[92:95], v[208:211]
    ds_read_b128 a[252:255], v226 offset:4352
    v_mfma_f32_16x16x32_bf16 v[212:215], a[24:27], v[252:255], v[212:215]
    ds_read_b64_tr_b16 a[24:25], v240 offset:13824
    ds_read_b64_tr_b16 a[26:27], v240 offset:24576
    v_mfma_f32_16x16x32_bf16 v[216:219], a[28:31], v[252:255], v[216:219]
    ds_read_b64_tr_b16 a[28:29], v240 offset:13832
    ds_read_b64_tr_b16 a[30:31], v240 offset:24584
    v_mfma_f32_16x16x32_bf16 v[220:223], a[32:35], v[252:255], v[220:223]
    ds_read_b64_tr_b16 a[32:33], v241 offset:13824
    v_mfma_f32_16x16x32_bf16 v[200:203], v[252:255], a[96:99], v[200:203]
    ds_read_b64_tr_b16 a[34:35], v241 offset:24576
    v_mfma_f32_16x16x32_bf16 v[204:207], v[252:255], a[100:103], v[204:207]
    v_mfma_f32_16x16x32_bf16 v[208:211], v[252:255], a[104:107], v[208:211]
    ds_read_b128 v[252:255], v226 offset:4416
    v_mfma_f32_16x16x32_bf16 v[212:215], a[36:39], a[232:235], v[212:215]
    ds_read_b64_tr_b16 a[36:37], v240 offset:36864
    ds_read_b64_tr_b16 a[38:39], v240 offset:38400
    v_mfma_f32_16x16x32_bf16 v[216:219], a[40:43], a[232:235], v[216:219]
    ds_read_b64_tr_b16 a[40:41], v240 offset:36872
    ds_read_b64_tr_b16 a[42:43], v240 offset:38408
    v_mfma_f32_16x16x32_bf16 v[220:223], a[44:47], a[232:235], v[220:223]
    ds_read_b64_tr_b16 a[44:45], v241 offset:36864
    v_mfma_f32_16x16x32_bf16 v[200:203], a[232:235], a[108:111], v[200:203]
    ds_read_b64_tr_b16 a[46:47], v241 offset:38400
    v_mfma_f32_16x16x32_bf16 v[204:207], a[232:235], a[112:115], v[204:207]
    v_mfma_f32_16x16x32_bf16 v[208:211], a[232:235], a[116:119], v[208:211]
    ds_read_b128 a[232:235], v226 offset:4480
    v_mfma_f32_16x16x32_bf16 v[212:215], a[48:51], a[236:239], v[212:215]
    ds_read_b64_tr_b16 a[48:49], v240 offset:49152
    ds_read_b64_tr_b16 a[50:51], v240 offset:62976
    v_mfma_f32_16x16x32_bf16 v[216:219], a[52:55], a[236:239], v[216:219]
    ds_read_b64_tr_b16 a[52:53], v240 offset:49160
    ds_read_b64_tr_b16 a[54:55], v240 offset:62984
    v_mfma_f32_16x16x32_bf16 v[220:223], a[56:59], a[236:239], v[220:223]
    ds_read_b64_tr_b16 a[56:57], v241 offset:49152
    v_mfma_f32_16x16x32_bf16 v[200:203], a[236:239], a[120:123], v[200:203]
    ds_read_b64_tr_b16 a[58:59], v241 offset:62976
    v_mfma_f32_16x16x32_bf16 v[204:207], a[236:239], a[124:127], v[204:207]
    v_mfma_f32_16x16x32_bf16 v[208:211], a[236:239], a[128:131], v[208:211]
    ds_read_b128 a[236:239], v226 offset:4544
    v_mfma_f32_16x16x32_bf16 v[212:215], a[60:63], a[240:243], v[212:215]
    ds_read_b64_tr_b16 a[60:61], v240 offset:50688
    ds_read_b64_tr_b16 a[62:63], v240 offset:61440
    v_mfma_f32_16x16x32_bf16 v[216:219], a[64:67], a[240:243], v[216:219]
    ds_read_b64_tr_b16 a[64:65], v240 offset:50696
    ds_read_b64_tr_b16 a[66:67], v240 offset:61448
    v_mfma_f32_16x16x32_bf16 v[220:223], a[68:71], a[240:243], v[220:223]
    ds_read_b64_tr_b16 a[68:69], v241 offset:50688
    v_mfma_f32_16x16x32_bf16 v[200:203], a[240:243], a[132:135], v[200:203]
    v_cvt_pk_bf16_f32 v30, v212, v213
    v_cvt_pk_bf16_f32 v31, v214, v215
    v_mfma_f32_16x16x32_bf16 v[204:207], a[240:243], a[136:139], v[204:207]
    v_cvt_pk_bf16_f32 v32, v216, v217
    v_cvt_pk_bf16_f32 v33, v218, v219
    v_mfma_f32_16x16x32_bf16 v[208:211], a[240:243], a[140:143], v[208:211]
    v_cvt_pk_bf16_f32 v34, v220, v221
    v_cvt_pk_bf16_f32 v35, v222, v223
    v_mfma_f32_16x16x32_bf16 v[164:167], v[30:33], v[132:135], v[164:167]
    s_waitcnt lgkmcnt(9)
    v_cvt_pk_bf16_f32 v70, v200, v201
    v_cvt_pk_bf16_f32 v71, v202, v203
    v_mfma_f32_16x16x32_bf16 v[212:215], a[144:147], a[244:247], 0
    v_cvt_pk_bf16_f32 v92, v204, v205
    v_cvt_pk_bf16_f32 v93, v206, v207
    v_mfma_f32_16x16x32_bf16 v[216:219], a[148:151], a[244:247], 0
    v_cvt_pk_bf16_f32 v114, v208, v209
    v_cvt_pk_bf16_f32 v115, v210, v211
    v_mfma_f32_16x16x16_bf16 v[164:167], v[34:35], v[136:137], v[164:167]
    ds_read_b64_tr_b16 a[70:71], v241 offset:61440
    ds_read_b128 a[240:243], v239 offset:12288
    v_mfma_f32_16x16x32_bf16 v[220:223], a[152:155], a[244:247], 0
    ds_read_b128 a[244:247], v239 offset:18432
    v_mfma_f32_16x16x32_bf16 v[212:215], a[156:159], a[248:251], v[212:215]
    v_mfma_f32_16x16x32_bf16 v[216:219], a[160:163], a[248:251], v[216:219]
    v_mfma_f32_16x16x32_bf16 v[220:223], a[164:167], a[248:251], v[220:223]
    ds_read_b128 a[248:251], v239 offset:13312
    v_max3_f32 v249, v249, v164, v165
    v_mfma_f32_16x16x32_bf16 v[212:215], a[168:171], a[252:255], v[212:215]
    v_max3_f32 v248, v248, v166, v167
    v_max3_f32 v249, v249, v168, v169
    v_mfma_f32_16x16x32_bf16 v[216:219], a[172:175], a[252:255], v[216:219]
    v_max3_f32 v248, v248, v170, v171
    v_max_f32 v248, v248, v249
    v_mfma_f32_16x16x32_bf16 v[220:223], a[176:179], a[252:255], v[220:223]
    ds_read_b128 a[252:255], v239 offset:19456
    v_mov_b32 v249, v248
    v_mfma_f32_16x16x32_bf16 v[212:215], a[180:183], v[252:255], v[212:215]
    v_mfma_f32_16x16x32_bf16 v[216:219], a[184:187], v[252:255], v[216:219]
    v_permlane16_swap_b32 v248, v249
    v_mfma_f32_16x16x32_bf16 v[220:223], a[188:191], v[252:255], v[220:223]
    ds_read_b128 v[252:255], v239 offset:14336
    v_max_f32 v248, v248, v249
    v_mfma_f32_16x16x32_bf16 v[212:215], a[192:195], a[232:235], v[212:215]
    v_mov_b32 v249, v248
    v_mfma_f32_16x16x32_bf16 v[216:219], a[196:199], a[232:235], v[216:219]
    v_mfma_f32_16x16x32_bf16 v[220:223], a[200:203], a[232:235], v[220:223]
    s_waitcnt lgkmcnt(3)
    ds_read_b128 a[232:235], v239 offset:20480
    v_mfma_f32_16x16x32_bf16 v[212:215], a[204:207], a[236:239], v[212:215]
    v_permlane32_swap_b32 v248, v249
    v_mfma_f32_16x16x32_bf16 v[216:219], a[208:211], a[236:239], v[216:219]
    v_max_f32 v248, v248, v249
    v_mul_f32 v250, s37, v248
    v_mfma_f32_16x16x32_bf16 v[220:223], a[212:215], a[236:239], v[220:223]
    ds_read_b128 a[236:239], v239 offset:15360
    v_fma_f32 v172, v172, s37, -v250
    v_mfma_f32_16x16x32_bf16 v[200:203], a[220:223], a[240:243], 0
    v_cvt_pk_bf16_f32 v138, v212, v213
    v_cvt_pk_bf16_f32 v139, v214, v215
    v_mfma_f32_16x16x32_bf16 v[212:215], a[220:223], a[244:247], 0
    v_cvt_pk_bf16_f32 v140, v216, v217
    v_cvt_pk_bf16_f32 v141, v218, v219
    v_mfma_f32_16x16x32_bf16 v[204:207], a[224:227], a[240:243], 0
    v_cvt_pk_bf16_f32 v142, v220, v221
    v_cvt_pk_bf16_f32 v143, v222, v223
    v_mfma_f32_16x16x32_bf16 v[216:219], a[224:227], a[244:247], 0
    v_fma_f32 v173, v173, s37, -v250
    v_fma_f32 v174, v174, s37, -v250
    v_mfma_f32_16x16x32_bf16 v[208:211], a[228:231], a[240:243], 0
    ds_read_b128 a[240:243], v239 offset:21504
    v_fma_f32 v175, v175, s37, -v250
    v_mfma_f32_16x16x32_bf16 v[220:223], a[228:231], a[244:247], 0
    s_waitcnt lgkmcnt(3)
    ds_read_b128 a[244:247], v239 offset:16384
    v_fma_f32 v144, v144, s37, -v250
    v_mfma_f32_16x16x32_bf16 v[200:203], a[12:15], a[248:251], v[200:203]
    v_exp_f32 v172, v172
    v_mfma_f32_16x16x32_bf16 v[212:215], a[12:15], a[252:255], v[212:215]
    v_exp_f32 v173, v173
    v_mfma_f32_16x16x32_bf16 v[204:207], a[16:19], a[248:251], v[204:207]
    v_exp_f32 v174, v174
    v_mfma_f32_16x16x32_bf16 v[216:219], a[16:19], a[252:255], v[216:219]
    v_exp_f32 v175, v175
    v_mfma_f32_16x16x32_bf16 v[208:211], a[20:23], a[248:251], v[208:211]
    ds_read_b128 a[248:251], v239 offset:22528
    v_cvt_pk_bf16_f32 v176, v172, v173
    v_mfma_f32_16x16x32_bf16 v[220:223], a[20:23], a[252:255], v[220:223]
    ds_read_b128 a[252:255], v239 offset:17408
    v_cvt_pk_bf16_f32 v177, v174, v175
    v_mfma_f32_16x16x32_bf16 v[200:203], a[24:27], v[252:255], v[200:203]
    s_waitcnt lgkmcnt(4)
    ds_read_b128 v[172:175], v234
    v_bfe_u32 v234, s79, v233, 4
    v_mfma_f32_16x16x32_bf16 v[212:215], a[24:27], a[232:235], v[212:215]
    v_mad_u32_u24 v234, v234, s40, v231
    v_fma_f32 v145, v145, s37, -v250
    v_mfma_f32_16x16x32_bf16 v[204:207], a[28:31], v[252:255], v[204:207]
    v_fma_f32 v146, v146, s37, -v250
    v_fma_f32 v147, v147, s37, -v250
    v_mfma_f32_16x16x32_bf16 v[216:219], a[28:31], a[232:235], v[216:219]
    v_exp_f32 v144, v144
    v_mfma_f32_16x16x32_bf16 v[208:211], a[32:35], v[252:255], v[208:211]
    ds_read_b128 v[252:255], v239 offset:23552
    v_fma_f32 v148, v148, s37, -v250
    v_mfma_f32_16x16x32_bf16 v[220:223], a[32:35], a[232:235], v[220:223]
    v_exp_f32 v145, v145
    v_mfma_f32_16x16x32_bf16 v[200:203], a[36:39], a[236:239], v[200:203]
    s_waitcnt lgkmcnt(4)
    v_exp_f32 v146, v146
    v_mfma_f32_16x16x32_bf16 v[212:215], a[36:39], a[240:243], v[212:215]
    v_exp_f32 v147, v147
    v_mfma_f32_16x16x32_bf16 v[204:207], a[40:43], a[236:239], v[204:207]
    v_cvt_pk_bf16_f32 v178, v144, v145
    v_cvt_pk_bf16_f32 v179, v146, v147
    v_mfma_f32_16x16x32_bf16 v[216:219], a[40:43], a[240:243], v[216:219]
    ds_read_b128 v[144:147], v230 offset:1280
    v_fma_f32 v149, v149, s37, -v250
    v_mfma_f32_16x16x32_bf16 v[196:199], a[216:219], v[176:179], 0
    v_fma_f32 v150, v150, s37, -v250
    v_fma_f32 v151, v151, s37, -v250
    v_mfma_f32_16x16x32_bf16 v[184:187], v[74:77], v[176:179], 0
    v_exp_f32 v148, v148
    v_mfma_f32_16x16x32_bf16 v[188:191], v[96:99], v[176:179], 0
    v_exp_f32 v149, v149
    v_mfma_f32_16x16x32_bf16 v[192:195], v[118:121], v[176:179], 0
    s_waitcnt lgkmcnt(2)
    v_exp_f32 v150, v150
    v_mfma_f32_16x16x32_bf16 v[172:175], v[36:39], v[138:141], v[172:175]
    v_exp_f32 v151, v151
    v_mfma_f32_16x16x32_bf16 v[208:211], a[44:47], a[236:239], v[208:211]
    v_cvt_pk_bf16_f32 v180, v148, v149
    v_cvt_pk_bf16_f32 v181, v150, v151
    v_mfma_f32_16x16x32_bf16 v[220:223], a[44:47], a[240:243], v[220:223]
    ds_read_b128 v[148:151], v235
    v_bfe_u32 v235, s80, v233, 4
    v_mfma_f32_16x16x16_bf16 v[172:175], v[40:41], v[142:143], v[172:175]
    v_mad_u32_u24 v235, v235, s40, v231
    v_fma_f32 v152, v152, s37, -v250
    v_mfma_f32_16x16x32_bf16 v[200:203], a[48:51], a[244:247], v[200:203]
    s_waitcnt lgkmcnt(1)
    v_fma_f32 v153, v153, s37, -v250
    v_fma_f32 v154, v154, s37, -v250
    v_mfma_f32_16x16x32_bf16 v[144:147], v[42:45], v[138:141], v[144:147]
    v_fma_f32 v155, v155, s37, -v250
    v_fma_f32 v156, v156, s37, -v250
    v_mfma_f32_16x16x32_bf16 v[212:215], a[48:51], a[248:251], v[212:215]
    v_exp_f32 v152, v152
    v_mfma_f32_16x16x32_bf16 v[204:207], a[52:55], a[244:247], v[204:207]
    v_exp_f32 v153, v153
    v_mfma_f32_16x16x16_bf16 v[144:147], v[46:47], v[142:143], v[144:147]
    v_exp_f32 v154, v154
    v_mfma_f32_16x16x32_bf16 v[216:219], a[52:55], a[248:251], v[216:219]
    v_exp_f32 v155, v155
    v_mfma_f32_16x16x32_bf16 v[208:211], a[56:59], a[244:247], v[208:211]
    v_cvt_pk_bf16_f32 v182, v152, v153
    v_cvt_pk_bf16_f32 v183, v154, v155
    v_mfma_f32_16x16x32_bf16 v[220:223], a[56:59], a[248:251], v[220:223]
    ds_read_b128 v[152:155], v236
    v_fma_f32 v157, v157, s37, -v250
    v_mfma_f32_16x16x32_bf16 v[196:199], a[216:219], v[180:183], v[196:199]
    v_fma_f32 v158, v158, s37, -v250
    v_fma_f32 v159, v159, s37, -v250
    v_mfma_f32_16x16x32_bf16 v[184:187], v[78:81], v[180:183], v[184:187]
    v_exp_f32 v156, v156
    v_mfma_f32_16x16x32_bf16 v[188:191], v[100:103], v[180:183], v[188:191]
    v_exp_f32 v157, v157
    v_mfma_f32_16x16x32_bf16 v[192:195], v[122:125], v[180:183], v[192:195]
    s_waitcnt lgkmcnt(1)
    v_exp_f32 v158, v158
    v_mfma_f32_16x16x32_bf16 v[148:151], v[24:27], v[138:141], v[148:151]
    v_exp_f32 v159, v159
    v_mfma_f32_16x16x32_bf16 v[200:203], a[60:63], a[252:255], v[200:203]
    v_cvt_pk_bf16_f32 v176, v156, v157
    v_cvt_pk_bf16_f32 v177, v158, v159
    v_mfma_f32_16x16x32_bf16 v[212:215], a[60:63], v[252:255], v[212:215]
    ds_read_b128 v[156:159], v234
    v_fma_f32 v160, v160, s37, -v250
    v_mfma_f32_16x16x16_bf16 v[148:151], v[28:29], v[142:143], v[148:151]
    v_fma_f32 v161, v161, s37, -v250
    v_fma_f32 v162, v162, s37, -v250
    v_mfma_f32_16x16x32_bf16 v[204:207], a[64:67], a[252:255], v[204:207]
    s_waitcnt lgkmcnt(1)
    v_cvt_pk_bf16_f32 v200, v200, v201
    v_cvt_pk_bf16_f32 v201, v202, v203
    v_mfma_f32_16x16x32_bf16 v[152:155], v[30:33], v[138:141], v[152:155]
    v_cvt_pk_bf16_f32 v212, v212, v213
    v_cvt_pk_bf16_f32 v213, v214, v215
    v_mfma_f32_16x16x32_bf16 v[216:219], a[64:67], v[252:255], v[216:219]
    v_fma_f32 v163, v163, s37, -v250
    v_fma_f32 v164, v164, s37, -v250
    v_mfma_f32_16x16x32_bf16 v[208:211], a[68:71], a[252:255], v[208:211]
    v_cvt_pk_bf16_f32 v202, v204, v205
    v_cvt_pk_bf16_f32 v203, v206, v207
    v_mfma_f32_16x16x16_bf16 v[152:155], v[34:35], v[142:143], v[152:155]
    buffer_store_dwordx4 v[200:203], v242, s[20:23], s58 offen sc0 sc1
    v_mfma_f32_16x16x32_bf16 v[220:223], a[68:71], v[252:255], v[220:223]
    s_waitcnt lgkmcnt(0)
    v_cvt_pk_bf16_f32 v214, v216, v217
    v_cvt_pk_bf16_f32 v215, v218, v219
    buffer_store_dwordx4 v[212:215], v244, s[20:23], s59 offen sc0 sc1
    v_mfma_f32_16x16x32_bf16 v[156:159], v[48:51], v[138:141], v[156:159]
    v_cvt_pk_bf16_f32 v208, v208, v209
    v_cvt_pk_bf16_f32 v209, v210, v211
    buffer_store_dwordx2 v[208:209], v243, s[20:23], s58 offen sc0 sc1
    s_add_u32 s58, s51, 0x1f8000
    v_cvt_pk_bf16_f32 v220, v220, v221
    v_cvt_pk_bf16_f32 v221, v222, v223
    v_mfma_f32_16x16x16_bf16 v[156:159], v[52:53], v[142:143], v[156:159]
    buffer_store_dwordx2 v[220:221], v245, s[20:23], s59 offen sc0 sc1
    s_add_u32 s59, s51, 0x1f9800
    v_exp_f32 v160, v160
    v_exp_f32 v161, v161
    v_exp_f32 v162, v162
    v_exp_f32 v163, v163
    v_cvt_pk_bf16_f32 v178, v160, v161
    v_cvt_pk_bf16_f32 v179, v162, v163
    ds_read_b128 v[160:163], v235
    v_fma_f32 v165, v165, s37, -v250
    v_mfma_f32_16x16x32_bf16 v[196:199], a[216:219], v[176:179], v[196:199]
    v_fma_f32 v166, v166, s37, -v250
    v_fma_f32 v167, v167, s37, -v250
    v_mfma_f32_16x16x32_bf16 v[184:187], v[66:69], v[176:179], v[184:187]
    v_exp_f32 v164, v164
    v_mfma_f32_16x16x32_bf16 v[188:191], v[88:91], v[176:179], v[188:191]
    v_exp_f32 v165, v165
    v_mfma_f32_16x16x32_bf16 v[192:195], v[110:113], v[176:179], v[192:195]
    s_waitcnt lgkmcnt(0)
    v_exp_f32 v166, v166
    v_exp_f32 v167, v167
    v_cvt_pk_bf16_f32 v180, v164, v165
    v_cvt_pk_bf16_f32 v181, v166, v167
    v_fma_f32 v168, v168, s37, -v250
    v_fma_f32 v169, v169, s37, -v250
    v_fma_f32 v170, v170, s37, -v250
    v_fma_f32 v171, v171, s37, -v250
    v_exp_f32 v168, v168
    v_exp_f32 v169, v169
    v_exp_f32 v170, v170
    v_exp_f32 v171, v171
    v_cvt_pk_bf16_f32 v182, v168, v169
    v_cvt_pk_bf16_f32 v183, v170, v171
    v_mfma_f32_16x16x32_bf16 v[160:163], v[54:57], v[138:141], v[160:163]
    v_max3_f32 v248, v172, v173, v174
    v_max3_f32 v249, v175, v144, v145
    v_mfma_f32_16x16x32_bf16 v[196:199], a[216:219], v[180:183], v[196:199]
    v_max3_f32 v248, v248, v146, v147
    v_max3_f32 v249, v249, v148, v149
    v_mfma_f32_16x16x32_bf16 v[184:187], v[70:73], v[180:183], v[184:187]
    v_max3_f32 v248, v248, v150, v151
    v_max3_f32 v249, v249, v152, v153
    v_mfma_f32_16x16x32_bf16 v[188:191], v[92:95], v[180:183], v[188:191]
    v_max3_f32 v248, v248, v154, v155
    v_max3_f32 v249, v249, v156, v157
    v_mfma_f32_16x16x32_bf16 v[192:195], v[114:117], v[180:183], v[192:195]
    v_rcp_f32 v197, v196
    v_mfma_f32_16x16x16_bf16 v[160:163], v[58:59], v[142:143], v[160:163]
    v_mul_f32 v184, v184, v197
    v_mul_f32 v185, v185, v197
    v_cvt_pk_bf16_f32 v184, v184, v185
    v_mul_f32 v186, v186, v197
    v_mul_f32 v187, v187, v197
    v_cvt_pk_bf16_f32 v185, v186, v187
    v_mul_f32 v188, v188, v197
    v_mul_f32 v189, v189, v197
    v_cvt_pk_bf16_f32 v186, v188, v189
    v_mul_f32 v190, v190, v197
    v_mul_f32 v191, v191, v197
    v_cvt_pk_bf16_f32 v187, v190, v191
    v_mul_f32 v192, v192, v197
    v_mul_f32 v193, v193, v197
    v_cvt_pk_bf16_f32 v188, v192, v193
    v_mul_f32 v194, v194, v197
    v_mul_f32 v195, v195, v197
    v_cvt_pk_bf16_f32 v189, v194, v195
    ds_write_b128 v237, v[184:187]
    ds_write_b64 v238, v[188:189]
    v_max3_f32 v248, v248, v158, v159
    v_max3_f32 v249, v249, v160, v161
    v_max3_f32 v248, v248, v162, v163
    v_max_f32 v248, v248, v249
    v_mov_b32 v249, v248
    s_nop 1
    v_permlane16_swap_b32 v248, v249
    v_max_f32 v248, v248, v249
    v_mov_b32 v249, v248
    s_nop 1
    v_permlane32_swap_b32 v248, v249
    v_max_f32 v248, v248, v249
    v_mul_f32 v250, s37, v248
    v_fma_f32 v172, v172, s37, -v250
    v_fma_f32 v173, v173, s37, -v250
    v_fma_f32 v174, v174, s37, -v250
    v_fma_f32 v175, v175, s37, -v250
    v_exp_f32 v172, v172
    v_exp_f32 v173, v173
    v_exp_f32 v174, v174
    v_exp_f32 v175, v175
    v_cvt_pk_bf16_f32 v176, v172, v173
    v_cvt_pk_bf16_f32 v177, v174, v175
    v_fma_f32 v144, v144, s37, -v250
    s_waitcnt lgkmcnt(0)
    s_barrier
    ds_read_b128 a[232:235], v239
    ds_read_b128 a[236:239], v239 offset:1024
    ds_read_b128 a[240:243], v239 offset:2048
    v_fma_f32 v145, v145, s37, -v250
    ds_read_b128 a[244:247], v239 offset:3072
    v_fma_f32 v146, v146, s37, -v250
    ds_read_b128 a[248:251], v239 offset:4096
    v_fma_f32 v147, v147, s37, -v250
    ds_read_b128 a[252:255], v239 offset:5120
    v_exp_f32 v144, v144
    v_exp_f32 v145, v145
    v_exp_f32 v146, v146
    v_exp_f32 v147, v147
    v_cvt_pk_bf16_f32 v178, v144, v145
    v_cvt_pk_bf16_f32 v179, v146, v147
    v_fma_f32 v148, v148, s37, -v250
    v_fma_f32 v149, v149, s37, -v250
    v_mfma_f32_16x16x32_bf16 v[196:199], a[216:219], v[176:179], 0
    v_fma_f32 v150, v150, s37, -v250
    v_fma_f32 v151, v151, s37, -v250
    v_mfma_f32_16x16x32_bf16 v[184:187], v[76:79], v[176:179], 0
    v_exp_f32 v148, v148
    v_mfma_f32_16x16x32_bf16 v[188:191], v[98:101], v[176:179], 0
    v_exp_f32 v149, v149
    v_mfma_f32_16x16x32_bf16 v[192:195], v[120:123], v[176:179], 0
    s_waitcnt lgkmcnt(5)
    v_exp_f32 v150, v150
    v_mfma_f32_16x16x32_bf16 v[200:203], a[220:223], a[232:235], 0
    v_exp_f32 v151, v151
    v_mfma_f32_16x16x32_bf16 v[204:207], a[224:227], a[232:235], 0
    v_cvt_pk_bf16_f32 v180, v148, v149
    v_cvt_pk_bf16_f32 v181, v150, v151
    v_mfma_f32_16x16x32_bf16 v[208:211], a[228:231], a[232:235], 0
    s_waitcnt lgkmcnt(2)
    v_fma_f32 v152, v152, s37, -v250
    v_fma_f32 v153, v153, s37, -v250
    v_mfma_f32_16x16x32_bf16 v[200:203], a[12:15], a[236:239], v[200:203]
    v_fma_f32 v154, v154, s37, -v250
    v_fma_f32 v155, v155, s37, -v250
    v_mfma_f32_16x16x32_bf16 v[204:207], a[16:19], a[236:239], v[204:207]
    v_exp_f32 v152, v152
    v_mfma_f32_16x16x32_bf16 v[208:211], a[20:23], a[236:239], v[208:211]
    v_exp_f32 v153, v153
    v_mfma_f32_16x16x32_bf16 v[200:203], a[24:27], a[240:243], v[200:203]
    v_exp_f32 v154, v154
    v_mfma_f32_16x16x32_bf16 v[204:207], a[28:31], a[240:243], v[204:207]
    v_exp_f32 v155, v155
    v_mfma_f32_16x16x32_bf16 v[208:211], a[32:35], a[240:243], v[208:211]
    v_cvt_pk_bf16_f32 v182, v152, v153
    v_cvt_pk_bf16_f32 v183, v154, v155
    v_mfma_f32_16x16x32_bf16 v[200:203], a[36:39], a[244:247], v[200:203]
    v_fma_f32 v156, v156, s37, -v250
    v_fma_f32 v157, v157, s37, -v250
    v_mfma_f32_16x16x32_bf16 v[196:199], a[216:219], v[180:183], v[196:199]
    v_fma_f32 v158, v158, s37, -v250
    v_fma_f32 v159, v159, s37, -v250
    v_mfma_f32_16x16x32_bf16 v[184:187], v[68:71], v[180:183], v[184:187]
    v_exp_f32 v156, v156
    v_mfma_f32_16x16x32_bf16 v[188:191], v[90:93], v[180:183], v[188:191]
    v_exp_f32 v157, v157
    v_mfma_f32_16x16x32_bf16 v[192:195], v[112:115], v[180:183], v[192:195]
    v_exp_f32 v158, v158
    v_mfma_f32_16x16x32_bf16 v[204:207], a[40:43], a[244:247], v[204:207]
    v_exp_f32 v159, v159
    v_mfma_f32_16x16x32_bf16 v[208:211], a[44:47], a[244:247], v[208:211]
    s_waitcnt lgkmcnt(0)
    v_cvt_pk_bf16_f32 v176, v156, v157
    v_cvt_pk_bf16_f32 v177, v158, v159
    v_mfma_f32_16x16x32_bf16 v[200:203], a[48:51], a[248:251], v[200:203]
    v_fma_f32 v160, v160, s37, -v250
    v_fma_f32 v161, v161, s37, -v250
    v_mfma_f32_16x16x32_bf16 v[204:207], a[52:55], a[248:251], v[204:207]
    v_fma_f32 v162, v162, s37, -v250
    v_fma_f32 v163, v163, s37, -v250
    v_mfma_f32_16x16x32_bf16 v[208:211], a[56:59], a[248:251], v[208:211]
    v_exp_f32 v160, v160
    v_mfma_f32_16x16x32_bf16 v[200:203], a[60:63], a[252:255], v[200:203]
    v_exp_f32 v161, v161
    v_mfma_f32_16x16x32_bf16 v[204:207], a[64:67], a[252:255], v[204:207]
    v_exp_f32 v162, v162
    v_mfma_f32_16x16x32_bf16 v[208:211], a[68:71], a[252:255], v[208:211]
    v_exp_f32 v163, v163
    v_cvt_pk_bf16_f32 v178, v160, v161
    v_cvt_pk_bf16_f32 v179, v162, v163
    s_nop 0
    v_cvt_pk_bf16_f32 v200, v200, v201
    v_mfma_f32_16x16x32_bf16 v[196:199], a[216:219], v[176:179], v[196:199]
    v_cvt_pk_bf16_f32 v201, v202, v203
    v_cvt_pk_bf16_f32 v202, v204, v205
    v_mfma_f32_16x16x32_bf16 v[184:187], v[82:85], v[176:179], v[184:187]
    v_cvt_pk_bf16_f32 v203, v206, v207
    v_cvt_pk_bf16_f32 v208, v208, v209
    v_mfma_f32_16x16x32_bf16 v[188:191], v[104:107], v[176:179], v[188:191]
    buffer_store_dwordx4 v[200:203], v242, s[20:23], s58 offen sc0 sc1
    v_mfma_f32_16x16x32_bf16 v[192:195], v[126:129], v[176:179], v[192:195]
    v_cvt_pk_bf16_f32 v209, v210, v211
    buffer_store_dwordx2 v[208:209], v243, s[20:23], s58 offen sc0 sc1
    v_rcp_f32 v197, v196
    s_nop 0
    v_mul_f32 v184, v184, v197
    v_mul_f32 v185, v185, v197
    v_cvt_pk_bf16_f32 v184, v184, v185
    v_mul_f32 v186, v186, v197
    v_mul_f32 v187, v187, v197
    v_cvt_pk_bf16_f32 v185, v186, v187
    v_mul_f32 v188, v188, v197
    v_mul_f32 v189, v189, v197
    v_cvt_pk_bf16_f32 v186, v188, v189
    v_mul_f32 v190, v190, v197
    v_mul_f32 v191, v191, v197
    v_cvt_pk_bf16_f32 v187, v190, v191
    v_mul_f32 v192, v192, v197
    v_mul_f32 v193, v193, v197
    v_cvt_pk_bf16_f32 v188, v192, v193
    v_mul_f32 v194, v194, v197
    v_mul_f32 v195, v195, v197
    v_cvt_pk_bf16_f32 v189, v194, v195
    ds_write_b128 v237, v[184:187] offset:6144
    ds_write_b64 v238, v[188:189] offset:6144
    s_waitcnt lgkmcnt(0)
    s_barrier
    ds_read_b128 v[252:255], v239 offset:6144
    ds_read_b128 a[232:235], v239 offset:7168
    ds_read_b128 a[236:239], v239 offset:8192
    ds_read_b128 a[240:243], v239 offset:9216
    ds_read_b128 a[244:247], v239 offset:10240
    ds_read_b128 a[248:251], v239 offset:11264
    s_waitcnt lgkmcnt(5)
    v_mfma_f32_16x16x32_bf16 v[212:215], a[220:223], v[252:255], 0
    v_mfma_f32_16x16x32_bf16 v[216:219], a[224:227], v[252:255], 0
    v_mfma_f32_16x16x32_bf16 v[220:223], a[228:231], v[252:255], 0
    s_waitcnt lgkmcnt(4)
    v_mfma_f32_16x16x32_bf16 v[212:215], a[12:15], a[232:235], v[212:215]
    v_mfma_f32_16x16x32_bf16 v[216:219], a[16:19], a[232:235], v[216:219]
    v_mfma_f32_16x16x32_bf16 v[220:223], a[20:23], a[232:235], v[220:223]
    s_waitcnt lgkmcnt(1)
    v_mfma_f32_16x16x32_bf16 v[212:215], a[24:27], a[236:239], v[212:215]
    v_mfma_f32_16x16x32_bf16 v[216:219], a[28:31], a[236:239], v[216:219]
    v_mfma_f32_16x16x32_bf16 v[220:223], a[32:35], a[236:239], v[220:223]
    v_mfma_f32_16x16x32_bf16 v[212:215], a[36:39], a[240:243], v[212:215]
    v_mfma_f32_16x16x32_bf16 v[216:219], a[40:43], a[240:243], v[216:219]
    v_mfma_f32_16x16x32_bf16 v[220:223], a[44:47], a[240:243], v[220:223]
    v_mfma_f32_16x16x32_bf16 v[212:215], a[48:51], a[244:247], v[212:215]
    v_mfma_f32_16x16x32_bf16 v[216:219], a[52:55], a[244:247], v[216:219]
    v_mfma_f32_16x16x32_bf16 v[220:223], a[56:59], a[244:247], v[220:223]
    s_waitcnt lgkmcnt(0)
    v_mfma_f32_16x16x32_bf16 v[212:215], a[60:63], a[248:251], v[212:215]
    v_mfma_f32_16x16x32_bf16 v[216:219], a[64:67], a[248:251], v[216:219]
    v_mfma_f32_16x16x32_bf16 v[220:223], a[68:71], a[248:251], v[220:223]
    s_nop 5
    v_cvt_pk_bf16_f32 v212, v212, v213
    v_cvt_pk_bf16_f32 v213, v214, v215
    v_cvt_pk_bf16_f32 v214, v216, v217
    v_cvt_pk_bf16_f32 v215, v218, v219
    buffer_store_dwordx4 v[212:215], v244, s[20:23], s59 offen sc0 sc1
    v_cvt_pk_bf16_f32 v220, v220, v221
    v_cvt_pk_bf16_f32 v221, v222, v223
    buffer_store_dwordx2 v[220:221], v245, s[20:23], s59 offen sc0 sc1
    s_endpgm
.section .rodata,"a"
.p2align 6
.amdhsa_kernel standalone__neighborhood_dinat__vision_kernel
  .amdhsa_next_free_vgpr 512
  .amdhsa_next_free_sgpr 102
  .amdhsa_accum_offset 256
  .amdhsa_group_segment_fixed_size 0
  .amdhsa_kernarg_size 56
  .amdhsa_user_sgpr_count 2
  .amdhsa_user_sgpr_kernarg_segment_ptr 1
  .amdhsa_system_sgpr_workgroup_id_x 1
.end_amdhsa_kernel
```

```asm
; @launch grid=(256,1,1) block=(256,1,1) lds=163344
.amdgcn_target "amdgcn-amd-amdhsa--gfx950"
.text
.globl standalone__neighborhood_dinat__vision_kernel
.p2align 8
.type standalone__neighborhood_dinat__vision_kernel,@function
standalone__neighborhood_dinat__vision_kernel:
    s_cmp_ge_u32 s2, 256
    s_cbranch_scc1 L_exit
L_go:
    s_load_dwordx4 s[24:27], s[0:1], 0
    s_load_dwordx4 s[28:31], s[0:1], 16
    s_load_dwordx2 s[32:33], s[0:1], 32
    s_getpc_b64 s[12:13]
    s_and_b32 s13, s13, 0xffff
    s_mov_b32 s14, L_end-L_go-64
    s_mov_b32 s15, 0x20000
    s_lshl_b32 s52, s2, 10
    v_lshlrev_b32 v189, 5, v0
    s_and_b32 s53, s52, 0xe000
    buffer_load_dword v188, v189, s[12:15], s53 offen
    v_lshrrev_b32 v74, 6, v0
    v_and_b32 v184, 63, v0
    v_readfirstlane_b32 s36, v74
    v_mul_u32_u24 v76, 0x2aab, v184
    v_lshrrev_b32 v76, 16, v76
    v_mul_u32_u24 v74, 6, v76
    v_sub_u32 v77, v184, v74
    v_lshrrev_b32 v74, 1, v76
    v_and_b32 v74, 4, v74
    v_xor_b32 v76, v76, v74
    v_mul_u32_u24 v74, 0x480, v76
    v_lshl_add_u32 v251, v77, 4, v74
    v_add_u32 v79, 64, v184
    v_mul_u32_u24 v78, 0x2aab, v79
    v_lshrrev_b32 v78, 16, v78
    v_mul_u32_u24 v74, 6, v78
    v_sub_u32 v79, v79, v74
    v_lshrrev_b32 v74, 1, v78
    v_and_b32 v74, 4, v74
    v_xor_b32 v78, v78, v74
    v_mul_u32_u24 v74, 0x480, v78
    v_lshl_add_u32 v252, v79, 4, v74
    v_add_u32 v81, 0x80, v184
    v_mul_u32_u24 v80, 0x2aab, v81
    v_lshrrev_b32 v80, 16, v80
    v_mul_u32_u24 v74, 6, v80
    v_sub_u32 v81, v81, v74
    v_lshrrev_b32 v74, 1, v80
    v_and_b32 v74, 4, v74
    v_xor_b32 v80, v80, v74
    v_mul_u32_u24 v74, 0x480, v80
    v_lshl_add_u32 v253, v81, 4, v74
    s_mul_i32 s49, s36, 0x60
    s_mul_i32 s50, s36, 0xc00
    s_add_u32 s50, s50, 0x15e00
    s_mov_b32 s10, 0x36000
    s_mov_b32 s11, 0x20000
    s_and_b32 s53, s52, 0x3e000
    s_add_u32 s57, s49, 0x180
    s_add_u32 m0, s50, 0
    s_and_b32 s54, s2, 1
    s_lshl_b32 s54, s54, 2
    s_lshl_b32 s41, s36, 10
    s_add_u32 s42, s41, 0x1000
    s_min_u32 s42, s42, 0x1a00
    s_mov_b32 s6, 0x1260000
    s_mov_b32 s7, 0x20000
    s_mov_b32 s14, 0x12000
    s_mov_b32 s15, 0x20000
    s_mov_b32 s18, 0x548
    s_mov_b32 s19, 0x20000
    s_mov_b32 s22, 0x1260000
    s_mov_b32 s23, 0x20000
    s_and_b32 s52, s52, 0x1e000
    v_lshlrev_b32 v199, 1, v184
    v_lshrrev_b32 v185, 4, v184
    v_and_b32 v186, 7, v184
    v_bfe_u32 v187, v184, 3, 1
    v_and_b32 v103, 1, v185
    v_mul_u32_u24 v102, 0x1e40, v187
    v_mul_u32_u24 v100, 0x180, v186
    v_mul_u32_u24 v74, 0x180, v76
    v_lshl_add_u32 v192, v77, 4, v74
    s_waitcnt lgkmcnt(0)
    s_mov_b32 s8, s26
    s_and_b32 s9, s27, 0xffff
    buffer_load_dword v188, v189, s[8:11], s53 offen
    buffer_load_dwordx4 v251, s[8:11], s57 offen lds
    s_add_u32 m0, s50, 0x400
    s_lshr_b32 s53, s2, 3
    buffer_load_dwordx4 v252, s[8:11], s57 offen lds
    s_add_u32 m0, s50, 0x800
    s_lshr_b32 s55, s53, 3
    buffer_load_dwordx4 v253, s[8:11], s57 offen lds
    s_or_b32 s34, s54, s55
    s_and_b32 s35, s53, 7
    s_bfe_u32 s54, s2, 0x10002
    s_mul_i32 s54, s54, 0x15000
    s_bfe_u32 s55, s2, 0x10001
    s_mul_i32 s55, s55, 0x180
    s_add_u32 s38, s54, s55
    s_mul_i32 s54, s35, 14
    s_sub_u32 s54, s54, 3
    s_movk_i32 s53, 0x6f
    s_lshr_b32 s55, s41, 4
    v_add_u32 v96, s55, v184
    v_mul_u32_u24 v97, 0xaab, v96
    v_lshrrev_b32 v97, 16, v97
    v_mul_u32_u24 v98, 24, v97
    v_sub_u32 v96, v96, v98
    v_and_b32 v98, 2, v97
    v_xor_b32 v96, v96, v98
    v_add_u32 v97, s54, v97
    v_med3_i32 v97, v97, 0, s53
    v_mul_u32_u24 v97, 0x300, v97
    v_lshl_add_u32 v246, v96, 4, v97
    s_lshr_b32 s55, s42, 4
    v_add_u32 v96, s55, v184
    v_mul_u32_u24 v97, 0xaab, v96
    v_lshrrev_b32 v97, 16, v97
    v_mul_u32_u24 v98, 24, v97
    v_sub_u32 v96, v96, v98
    v_and_b32 v98, 2, v97
    v_xor_b32 v96, v96, v98
    v_add_u32 v97, s54, v97
    v_med3_i32 v97, v97, 0, s53
    v_mul_u32_u24 v97, 0x300, v97
    v_lshl_add_u32 v247, v96, 4, v97
    s_mul_i32 s51, s34, 0x24c000
    s_add_u32 s51, s51, s38
    s_sub_u32 s39, s51, 0x7e000
    s_cmp_eq_u32 s34, 0
    s_cselect_b32 s43, 8, 0
    s_cselect_b32 s44, 9, 1
    s_cselect_b32 s45, 3, 2
    s_mul_i32 s43, s43, 0x2a000
    s_add_u32 s43, s43, s39
    s_mul_i32 s44, s44, 0x2a000
    s_add_u32 s44, s44, s39
    s_mul_i32 s45, s45, 0x2a000
    s_add_u32 s45, s45, s39
    s_mov_b32 s4, s24
    s_and_b32 s5, s25, 0xffff
    s_mov_b32 s12, s28
    s_and_b32 s13, s29, 0xffff
    s_mov_b32 s16, s30
    s_and_b32 s17, s31, 0xffff
    s_mov_b32 s20, s32
    s_and_b32 s21, s33, 0xffff
    s_add_u32 m0, s41, 0
    s_add_u32 s56, s39, 0x7e000
    buffer_load_dwordx4 v246, s[4:7], s43 offen lds
    s_add_u32 m0, s42, 0
    s_add_u32 s57, s49, 0x9180
    buffer_load_dwordx4 v247, s[4:7], s43 offen lds
    s_add_u32 m0, s41, 0x1e40
    s_mul_i32 s55, s36, 0x152
    buffer_load_dwordx4 v246, s[4:7], s44 offen lds
    s_add_u32 m0, s42, 0x1e40
    v_bfe_u32 v96, v184, 2, 2
    buffer_load_dwordx4 v247, s[4:7], s44 offen lds
    s_add_u32 m0, s41, 0x3c80
    v_and_b32 v97, 3, v184
    buffer_load_dwordx4 v246, s[4:7], s45 offen lds
    s_add_u32 m0, s42, 0x3c80
    v_lshl_add_u32 v99, v185, 3, v96
    v_lshl_add_u32 v99, v103, 2, v99
    v_lshl_add_u32 v101, v97, 3, s50
    s_movk_i32 s27, 0x60
    v_mad_u32_u24 v254, v99, s27, v101
    v_xor_b32 v99, 4, v99
    v_mad_u32_u24 v255, v99, s27, v101
    buffer_load_dwordx4 v247, s[4:7], s45 offen lds
    s_add_u32 m0, s41, 0x5ac0
    v_and_b32 v98, 2, v184
    v_xor_b32 v98, v98, v185
    v_lshlrev_b32 v98, 4, v98
    v_add3_u32 v224, v98, v100, v102
    v_mul_u32_u24 v99, 0x1e40, v96
    v_mul_u32_u24 v227, 0x180, v97
    v_add3_u32 v227, v227, v98, v99
    v_mul_u32_u24 v74, 0x180, v78
    v_lshl_add_u32 v193, v79, 4, v74
    v_mul_u32_u24 v74, 0x180, v80
    buffer_load_dwordx4 v246, s[4:7], s56 offen lds
    s_add_u32 m0, s42, 0x5ac0
    v_lshl_add_u32 v194, v81, 4, v74
    v_add_u32 v98, 3, v186
    v_and_b32 v98, 2, v98
    v_xor_b32 v98, v98, v185
    v_lshl_add_u32 v98, v98, 4, v100
    v_add_u32 v225, v98, v102
    v_xor_b32 v99, 1, v187
    v_mul_u32_u24 v99, 0xd3c0, v99
    v_add_u32 v226, v98, v99
    buffer_load_dwordx4 v247, s[4:7], s56 offen lds
    s_add_u32 m0, s50, 0x3000
    s_add_u32 s56, s39, 0xa8000
    v_lshl_add_u32 v99, v185, 2, v96
    v_and_b32 v98, 2, v185
    v_lshlrev_b32 v98, 1, v98
    v_xor_b32 v99, v99, v98
    v_mul_u32_u24 v99, 0x60, v99
    v_lshl_add_u32 v99, v97, 4, v99
    s_and_b32 s24, s36, 1
    s_lshl_b32 s25, s24, 5
    s_add_u32 s26, s25, s50
    v_add_u32 v241, s26, v99
    v_lshrrev_b32 v98, 1, v97
    buffer_load_dwordx4 v251, s[8:11], s57 offen lds
    s_add_u32 m0, s50, 0x3400
    v_mul_u32_u24 v98, 0xba0, v98
    s_lshr_b32 s27, s36, 1
    s_mul_i32 s26, s27, 0x1800
    s_add_u32 s26, s26, 0x15e40
    v_add3_u32 v242, v99, v98, s26
    v_mul_u32_u24 v99, 0x2a000, v187
    v_lshl_add_u32 v99, v100, 1, v99
    v_lshl_add_u32 v99, v185, 4, v99
    v_cmp_lt_u32 vcc, 5, v186
    v_add_u32 v98, 0x1800, v99
    v_bfrev_b32 v101, 1
    buffer_load_dwordx4 v252, s[8:11], s57 offen lds
    s_add_u32 m0, s50, 0x3800
    v_cndmask_b32 v98, v98, v101, vcc
    s_sub_u32 s59, 0, s24
    s_mov_b32 vcc_lo, s59
    s_mov_b32 vcc_hi, s59
    v_cndmask_b32 v101, v99, v98, vcc
    v_cndmask_b32 v102, v98, v99, vcc
    s_add_u32 s25, s25, s49
    v_add_u32 v243, s25, v101
    v_add_u32 v245, s25, v102
    s_mul_i32 s26, s27, 0xc0
    s_add_u32 s26, s26, 64
    v_add_u32 v244, s26, v101
    buffer_load_dwordx4 v253, s[8:11], s57 offen lds
    s_add_u32 s57, s49, 0x12180
    s_add_u32 m0, s50, 0x6000
    s_mul_i32 s25, s35, 0x2a00
    s_add_u32 s51, s51, s25
    s_add_u32 s58, s51, 0
    v_lshlrev_b32 v99, 4, v184
    v_add_u32 v99, 0x12e00, v99
    s_mul_i32 s25, s24, 0x1800
    v_add_u32 v239, s25, v99
    s_sub_u32 s25, 0x1800, s25
    v_add_u32 v240, s25, v99
    s_mul_i32 s25, s27, 0xc00
    s_lshl_b32 s26, s24, 11
    s_add_u32 s26, s26, s25
    v_add_u32 v237, s26, v99
    buffer_load_dwordx4 v251, s[8:11], s57 offen lds
    s_add_u32 m0, s50, 0x6400
    s_lshl_b32 s26, s24, 3
    s_add_u32 s26, s26, s25
    s_add_u32 s26, s26, 0x400
    v_add_u32 v238, s26, v99
    s_mov_b32 s37, 0x3e553b95
    s_mov_b32 s40, 0x140
    s_cmp_eq_u32 s34, 7
    s_cselect_b32 s46, 16, 17
    s_cselect_b32 s47, 10, 18
    s_cselect_b32 s48, 11, 19
    s_mul_i32 s46, s46, 0x2a000
    s_waitcnt vmcnt(12)
    ds_read_b64_tr_b16 a[0:1], v254
    ds_read_b64_tr_b16 a[2:3], v255
    ds_read_b64_tr_b16 a[4:5], v254 offset:32
    ds_read_b64_tr_b16 a[6:7], v255 offset:32
    buffer_load_dwordx4 v252, s[8:11], s57 offen lds
    s_add_u32 m0, s50, 0x6800
    ds_read_b64_tr_b16 a[8:9], v254 offset:64
    ds_read_b64_tr_b16 a[10:11], v255 offset:64
    s_add_u32 s46, s46, s39
    s_mul_i32 s47, s47, 0x2a000
    s_add_u32 s47, s47, s39
    s_mul_i32 s48, s48, 0x2a000
    s_add_u32 s48, s48, s39
    v_mov_b32 v96, 0x3f803f80
    v_accvgpr_write_b32 a216, v96
    v_accvgpr_write_b32 a217, v96
    v_accvgpr_write_b32 a218, v96
    v_accvgpr_write_b32 a219, v96
    v_mov_b32 v236, 1.0
    s_cmp_eq_u32 s35, 0
    s_cselect_b32 s29, 3, 0
    s_cselect_b32 s30, -3, -2
    buffer_load_dwordx4 v253, s[8:11], s57 offen lds
    s_add_u32 s57, s49, 0x1b180
    s_cmp_eq_u32 s35, 7
    s_cselect_b32 s33, 2, 64
    s_mul_i32 s32, s36, 0xf00
    s_add_u32 s32, s32, 0xf200
    v_lshrrev_b32 v60, 1, v185
    v_lshl_add_u32 v61, v187, 1, v60
    v_lshlrev_b32 v232, 2, v61
    v_lshl_add_u32 v61, v187, 2, v185
    v_lshlrev_b32 v233, 2, v61
    v_sub_u32 v60, v60, v187
    v_mul_i32_i24 v60, 0x140, v60
    s_sub_u32 s31, s32, 0x140
    buffer_load_dword v188, v189, s[12:15], s52 offen
    v_add_u32 v60, s31, v60
    v_lshl_add_u32 v61, v103, 2, 3
    buffer_load_ushort v196, v199, s[16:19], s55 offen
    buffer_load_ushort v197, v199, s[16:19], s55 offen offset:128
    v_cmp_gt_u32 vcc, s29, v186
    buffer_load_ushort v198, v199, s[16:19], s55 offen offset:256
    s_mov_b64 exec, 0
    s_cmp_eq_u32 s36, 0
    s_cbranch_scc1 L_pg1
    s_cmp_eq_u32 s36, 1
    s_cbranch_scc1 L_pg2
    s_cmp_eq_u32 s36, 2
    s_cbranch_scc1 L_pg3
    s_branch L_pg4
    .p2align 12
L_back:
    s_mov_b64 exec, -1
    s_add_u32 m0, s50, 0x9000
    v_sub_u32 v62, v61, v186
    buffer_load_dwordx4 v251, s[8:11], s57 offen lds
    s_add_u32 m0, s50, 0x9400
    v_min_u32 v63, 10, v62
    buffer_load_dwordx4 v252, s[8:11], s57 offen lds
    s_add_u32 m0, s50, 0x9800
    s_waitcnt vmcnt(12)
    s_barrier
    buffer_load_dwordx4 v253, s[8:11], s57 offen lds
    s_add_u32 s57, s49, 0x24180
    s_add_u32 m0, s50, 0xc000
    ds_read_b128 a[236:239], v224
    buffer_load_dwordx4 v251, s[8:11], s57 offen lds
    s_add_u32 m0, s50, 0xc400
    ds_read_b128 a[240:243], v224 offset:3072
    buffer_load_dwordx4 v252, s[8:11], s57 offen lds
    s_add_u32 m0, s50, 0xc800
    ds_read_b128 a[244:247], v224 offset:15488
    ds_read_b128 a[248:251], v224 offset:18560
    ds_read_b128 a[252:255], v227 offset:6144
    v_mad_u32_u24 v64, v186, 3, v103
    ds_read_b128 a[220:223], v224 offset:64
    v_add_u32 v65, 11, v64
    ds_read_b128 a[224:227], v224 offset:3136
    v_cndmask_b32 v63, v63, v65, vcc
    ds_read_b128 a[228:231], v224 offset:15552
    buffer_load_dwordx4 v253, s[8:11], s57 offen lds
    s_add_u32 s57, s49, 0x2d180
    s_add_u32 m0, s50, 0xf000
    ds_read_b128 a[232:235], v224 offset:18624
    v_lshl_add_u32 v228, v63, 4, v60
    v_add_u32 v62, 8, v62
    v_min_u32 v63, 10, v62
    v_lshl_add_u32 v62, v103, 4, v186
    s_waitcnt lgkmcnt(8)
    v_mfma_f32_16x16x32_bf16 v[12:15], a[0:3], a[236:239], 0
    s_mov_b32 s60, 0x2222
    v_cmp_gt_u32 vcc, s29, v62
    v_add_u32 v65, 13, v64
    v_mfma_f32_16x16x32_bf16 v[16:19], a[4:7], a[236:239], 0
    s_mov_b32 s61, 0x4444
    v_min_u32 v62, 5, v186
    v_cndmask_b32 v63, v63, v65, vcc
    v_mfma_f32_16x16x32_bf16 v[20:23], a[8:11], a[236:239], 0
    s_mov_b32 s62, 0x8808
    ds_read_b128 a[236:239], v227 offset:6208
    v_lshl_add_u32 v229, v63, 4, v60
    s_waitcnt lgkmcnt(8)
    v_mfma_f32_16x16x32_bf16 v[36:39], a[0:3], a[240:243], 0
    s_mov_b32 s63, 0x32104321
    buffer_load_dwordx4 v251, s[8:11], s57 offen lds
    v_mfma_f32_16x16x32_bf16 v[40:43], a[4:7], a[240:243], 0
    s_add_u32 m0, s50, 0xf400
    v_cmp_lt_u32 vcc, s33, v62
    v_sub_u32 v63, v61, v62
    v_mfma_f32_16x16x32_bf16 v[44:47], a[8:11], a[240:243], 0
    s_mov_b32 s64, 0x76540765
    ds_read_b128 a[240:243], v224 offset:128
    v_min_u32 v63, 10, v63
    s_waitcnt lgkmcnt(6)
    v_mfma_f32_16x16x32_bf16 v[132:135], a[0:3], a[244:247], 0
    s_mov_b32 s65, 0x2222
    v_mad_u32_u24 v64, v62, 3, 2
    v_add_u32 v65, v64, v103
    v_mfma_f32_16x16x32_bf16 v[136:139], a[4:7], a[244:247], 0
    s_mov_b32 s66, 0x10002100
    s_waitcnt vmcnt(14)
    ds_read_b64_tr_b16 a[12:13], v254 offset:12288
    ds_read_b64_tr_b16 a[14:15], v255 offset:12288
    v_mfma_f32_16x16x32_bf16 v[140:143], a[8:11], a[244:247], 0
    s_mov_b32 s67, 0x54326543
    buffer_load_dwordx4 v252, s[8:11], s57 offen lds
    v_mfma_f32_16x16x32_bf16 v[220:223], a[0:3], a[248:251], 0
    s_add_u32 m0, s50, 0xf800
    ds_read_b64_tr_b16 a[16:17], v254 offset:12320
    ds_read_b64_tr_b16 a[18:19], v255 offset:12320
    v_mfma_f32_16x16x32_bf16 v[216:219], a[4:7], a[248:251], 0
    s_mov_b32 s68, 0x760007
    ds_read_b64_tr_b16 a[20:21], v254 offset:12352
    ds_read_b64_tr_b16 a[22:23], v255 offset:12352
    v_mfma_f32_16x16x32_bf16 v[212:215], a[8:11], a[248:251], 0
    s_mov_b32 s69, 0x32104321
    ds_read_b128 a[244:247], v224 offset:3200
    ds_read_b128 a[248:251], v224 offset:15616
    v_mfma_f32_16x16x32_bf16 v[208:211], a[0:3], a[252:255], 0
    s_mov_b32 s70, 0x76540765
    v_cndmask_b32 v63, v63, v65, vcc
    v_lshl_add_u32 v230, v63, 4, v60
    v_mfma_f32_16x16x32_bf16 v[204:207], a[4:7], a[252:255], 0
    s_mov_b32 s71, 0x10002100
    v_sub_u32 v63, 11, v62
    v_min_u32 v63, 10, v63
    v_mfma_f32_16x16x32_bf16 v[200:203], a[8:11], a[252:255], 0
    s_mov_b32 s72, 0x760007
    buffer_load_dwordx4 v253, s[8:11], s57 offen lds
    s_add_u32 m0, s41, 0x7900
    s_add_u32 s57, s49, 0x300
    s_waitcnt lgkmcnt(6)
    v_mfma_f32_16x16x32_bf16 v[12:15], a[12:15], a[220:223], v[12:15]
    s_mov_b32 s73, 0x2222
    ds_read_b128 a[252:255], v224 offset:18688
    v_add_u32 v65, 2, v64
    v_mfma_f32_16x16x32_bf16 v[36:39], a[12:15], a[224:227], v[36:39]
    s_mov_b32 s74, 0x8808
    v_cndmask_b32 v63, v63, v65, vcc
    v_lshl_add_u32 v231, v63, 4, s32
    s_waitcnt lgkmcnt(5)
    v_mfma_f32_16x16x32_bf16 v[16:19], a[16:19], a[220:223], v[16:19]
    s_mov_b32 s75, 0x760007
    v_and_b32 v118, 31, v184
    v_min_u32 v118, 19, v118
    s_waitcnt lgkmcnt(3)
    v_mfma_f32_16x16x32_bf16 v[20:23], a[20:23], a[220:223], v[20:23]
    s_mov_b32 s76, 0x10002100
    ds_read_b128 a[220:223], v227 offset:6272
    v_lshrrev_b32 v119, 5, v184
    v_mfma_f32_16x16x32_bf16 v[40:43], a[16:19], a[224:227], v[40:43]
    s_mov_b32 s77, 0x6666
    buffer_load_dwordx4 v246, s[4:7], s56 offen lds
    v_mfma_f32_16x16x32_bf16 v[44:47], a[20:23], a[224:227], v[44:47]
    s_add_u32 m0, s42, 0x7900
    ds_read_b128 a[224:227], v224 offset:192
    v_add_u32 v120, -11, v118
    v_mfma_f32_16x16x32_bf16 v[132:135], a[12:15], a[228:231], v[132:135]
    s_mov_b32 s78, 0x8808
    v_max_i32 v120, 0, v120
    v_mul_u32_u24 v121, 11, v120
    v_mfma_f32_16x16x32_bf16 v[136:139], a[16:19], a[228:231], v[136:139]
    s_mov_b32 s79, 0x32104321
    v_lshrrev_b32 v121, 5, v121
    v_mul_u32_u24 v122, 3, v121
    v_mfma_f32_16x16x32_bf16 v[140:143], a[20:23], a[228:231], v[140:143]
    s_mov_b32 s80, 0x76540765
    s_waitcnt vmcnt(14)
    ds_read_b64_tr_b16 a[24:25], v254 offset:24576
    ds_read_b64_tr_b16 a[26:27], v255 offset:24576
    v_mfma_f32_16x16x32_bf16 v[220:223], a[12:15], a[232:235], v[220:223]
    s_cmp_eq_u32 s34, 0
    s_cmov_b32 s60, 0xbbbb
    s_cmov_b32 s61, 0x4241
    v_mfma_f32_16x16x32_bf16 v[216:219], a[16:19], a[232:235], v[216:219]
    s_cmp_eq_u32 s34, 0
    s_cmov_b32 s62, 0x8898
    s_cmov_b32 s63, 0x30a940ba
    v_mfma_f32_16x16x32_bf16 v[212:215], a[20:23], a[232:235], v[212:215]
    s_cmp_eq_u32 s34, 0
    s_cmov_b32 s64, 0x76549765
    s_cmov_b32 s65, 0x2221
    v_mfma_f32_16x16x32_bf16 v[208:211], a[12:15], a[236:239], v[208:211]
    s_cmp_eq_u32 s34, 0
    s_cmov_b32 s66, 0x10002000
    s_cmov_b32 s68, 0x760097
    v_mfma_f32_16x16x32_bf16 v[204:207], a[16:19], a[236:239], v[204:207]
    s_cmp_eq_u32 s34, 7
    s_cmov_b32 s73, 0x2d22
    s_cmov_b32 s74, 0x1808
    v_mfma_f32_16x16x32_bf16 v[200:203], a[20:23], a[236:239], v[200:203]
    s_cmp_eq_u32 s34, 7
    s_cmov_b32 s75, 0x60007
    s_cmov_b32 s76, 0x1b002100
    buffer_load_dwordx4 v247, s[4:7], s56 offen lds
    s_add_u32 s56, s39, 0xd2000
    s_add_u32 m0, s41, 0x9740
    ds_read_b64_tr_b16 a[28:29], v254 offset:24608
    buffer_load_dwordx4 v246, s[4:7], s56 offen lds
    s_waitcnt lgkmcnt(1)
    v_mfma_f32_16x16x32_bf16 v[12:15], a[24:27], a[240:243], v[12:15]
    s_add_u32 m0, s42, 0x9740
    ds_read_b64_tr_b16 a[30:31], v255 offset:24608
    ds_read_b64_tr_b16 a[32:33], v254 offset:24640
    v_mfma_f32_16x16x32_bf16 v[36:39], a[24:27], a[244:247], v[36:39]
    s_cmp_eq_u32 s34, 7
    s_cmov_b32 s77, 0x1606
    s_cmov_b32 s78, 0xbbbb
    v_mfma_f32_16x16x32_bf16 v[132:135], a[24:27], a[248:251], v[132:135]
    s_cmp_eq_u32 s34, 7
    s_cmov_b32 s79, 0x321b4321
    s_cmov_b32 s80, 0xa904ba05
    v_mfma_f32_16x16x32_bf16 v[220:223], a[24:27], a[252:255], v[220:223]
    s_lshl_b32 s31, s36, 10
    buffer_load_dwordx4 v247, s[4:7], s56 offen lds
    v_mfma_f32_16x16x32_bf16 v[208:211], a[24:27], a[220:223], v[208:211]
    s_add_u32 s56, s39, 0xfc000
    s_add_u32 m0, s41, 0xb580
    ds_read_b64_tr_b16 a[34:35], v255 offset:24640
    ds_read_b128 a[228:231], v224 offset:3264
    ds_read_b128 a[232:235], v224 offset:15680
    ds_read_b128 a[236:239], v224 offset:18752
    v_bfe_u32 v234, s60, v232, 4
    v_mad_u32_u24 v235, v234, s40, v228
    v_mad_u32_u24 v234, v234, s40, v229
    s_add_u32 s31, s31, 0x12e40
    v_sub_u32 v120, v120, v122
    v_lshlrev_b32 v120, 2, v120
    v_sub_u32 v121, v120, v121
    v_cmp_lt_u32 vcc, 10, v118
    v_add_u32 v121, s29, v121
    s_waitcnt lgkmcnt(5)
    v_mfma_f32_16x16x32_bf16 v[16:19], a[28:31], a[240:243], v[16:19]
    s_cmp_eq_u32 s34, 0
    s_cselect_b32 s28, 0x208, 0
    v_add_u32 v120, s30, v120
    v_mfma_f32_16x16x32_bf16 v[40:43], a[28:31], a[244:247], v[40:43]
    buffer_load_dwordx4 v246, s[4:7], s56 offen lds
    v_mfma_f32_16x16x32_bf16 v[136:139], a[28:31], a[248:251], v[136:139]
    s_add_u32 m0, s42, 0xb580
    v_add_u32 v122, -3, v118
    v_cndmask_b32 v121, v118, v121, vcc
    v_mfma_f32_16x16x32_bf16 v[216:219], a[28:31], a[252:255], v[216:219]
    s_waitcnt vmcnt(11)
    ds_read_b64_tr_b16 a[36:37], v254 offset:36864
    ds_read_b64_tr_b16 a[38:39], v255 offset:36864
    v_mfma_f32_16x16x32_bf16 v[204:207], a[28:31], a[220:223], v[204:207]
    s_waitcnt lgkmcnt(5)
    ds_read_b64_tr_b16 a[40:41], v254 offset:36896
    ds_read_b64_tr_b16 a[42:43], v255 offset:36896
    v_mfma_f32_16x16x32_bf16 v[20:23], a[32:35], a[240:243], v[20:23]
    ds_read_b64_tr_b16 a[44:45], v254 offset:36928
    ds_read_b64_tr_b16 a[46:47], v255 offset:36928
    v_mfma_f32_16x16x32_bf16 v[44:47], a[32:35], a[244:247], v[44:47]
    buffer_load_dwordx4 v247, s[4:7], s56 offen lds
    v_mfma_f32_16x16x32_bf16 v[140:143], a[32:35], a[248:251], v[140:143]
    s_add_u32 s56, s39, 0x126000
    ds_read_b128 a[240:243], v227 offset:6336
    ds_read_b128 a[244:247], v224 offset:256
    v_mfma_f32_16x16x32_bf16 v[212:215], a[32:35], a[252:255], v[212:215]
    s_add_u32 m0, s41, 0xd3c0
    ds_read_b128 a[248:251], v224 offset:3328
    ds_read_b128 a[252:255], v224 offset:15744
    v_mfma_f32_16x16x32_bf16 v[200:203], a[32:35], a[220:223], v[200:203]
    s_waitcnt lgkmcnt(6)
    ds_read_b128 a[220:223], v224 offset:18816
    v_cndmask_b32 v120, v122, v120, vcc
    s_mov_b32 vcc_lo, s59
    s_mov_b32 vcc_hi, s59
    v_mad_u32_u24 v121, v119, 13, v121
    v_lshl_add_u32 v121, v121, 2, s31
    v_add_u32 v122, s28, v121
    v_cmp_gt_u32 s[24:25], 7, v120
    v_mfma_f32_16x16x32_bf16 v[12:15], a[36:39], a[224:227], v[12:15]
    s_mov_b32 s28, 0x3fb8aa3b
    buffer_load_dwordx4 v246, s[4:7], s56 offen lds
    v_mfma_f32_16x16x32_bf16 v[16:19], a[40:43], a[224:227], v[16:19]
    s_add_u32 m0, s42, 0xd3c0
    v_add_u32 v120, 1, v120
    v_cmp_gt_u32 s[26:27], 7, v120
    s_waitcnt lgkmcnt(5)
    v_mfma_f32_16x16x32_bf16 v[20:23], a[44:47], a[224:227], v[20:23]
    ds_read_b128 a[224:227], v227 offset:6400
    v_add_u32 v120, 1, v120
    v_mfma_f32_16x16x32_bf16 v[36:39], a[36:39], a[228:231], v[36:39]
    v_cmp_gt_u32 s[52:53], 7, v120
    v_add_u32 v120, 1, v120
    v_mfma_f32_16x16x32_bf16 v[40:43], a[40:43], a[228:231], v[40:43]
    v_cmp_gt_u32 s[54:55], 7, v120
    v_lshl_add_u32 v118, v118, 4, s32
    v_mfma_f32_16x16x32_bf16 v[44:47], a[44:47], a[228:231], v[44:47]
    ds_read_b128 a[228:231], v224 offset:320
    v_mad_u32_u24 v123, v119, s40, v118
    v_mfma_f32_16x16x32_bf16 v[132:135], a[36:39], a[232:235], v[132:135]
    buffer_load_dwordx4 v247, s[4:7], s56 offen lds
    v_mfma_f32_16x16x32_bf16 v[136:139], a[40:43], a[232:235], v[136:139]
    s_add_u32 m0, s50, 0
    v_lshlrev_b32 v119, 3, v119
    v_mad_u32_u24 v124, v119, s40, v118
    v_mfma_f32_16x16x32_bf16 v[140:143], a[44:47], a[232:235], v[140:143]
    s_add_u32 s56, s39, 0x150000
    s_waitcnt vmcnt(11)
    ds_read_b64_tr_b16 a[48:49], v254 offset:49152
    ds_read_b64_tr_b16 a[50:51], v255 offset:49152
    v_mfma_f32_16x16x32_bf16 v[220:223], a[36:39], a[236:239], v[220:223]
    ds_read_b64_tr_b16 a[52:53], v254 offset:49184
    ds_read_b64_tr_b16 a[54:55], v255 offset:49184
    v_mfma_f32_16x16x32_bf16 v[216:219], a[40:43], a[236:239], v[216:219]
    ds_read_b64_tr_b16 a[56:57], v254 offset:49216
    ds_read_b64_tr_b16 a[58:59], v255 offset:49216
    v_mfma_f32_16x16x32_bf16 v[212:215], a[44:47], a[236:239], v[212:215]
    s_waitcnt lgkmcnt(8)
    buffer_load_dwordx4 v251, s[8:11], s57 offen lds
    v_mfma_f32_16x16x32_bf16 v[208:211], a[36:39], a[240:243], v[208:211]
    s_add_u32 m0, s50, 0x400
    ds_read_b128 a[232:235], v224 offset:3392
    ds_read_b128 a[236:239], v224 offset:15808
    v_mfma_f32_16x16x32_bf16 v[204:207], a[40:43], a[240:243], v[204:207]
    v_lshl_add_u32 v125, v184, 2, s31
    v_lshlrev_b32 v196, 16, v196
    v_mfma_f32_16x16x32_bf16 v[200:203], a[44:47], a[240:243], v[200:203]
    s_waitcnt lgkmcnt(6)
    ds_read_b128 a[240:243], v224 offset:18880
    v_mul_f32 v196, s28, v196
    ds_write_b32 v125, v196
    v_lshlrev_b32 v197, 16, v197
    v_mul_f32 v197, s28, v197
    v_mfma_f32_16x16x32_bf16 v[12:15], a[48:51], a[244:247], v[12:15]
    s_waitcnt lgkmcnt(4)
    buffer_load_dwordx4 v252, s[8:11], s57 offen lds
    v_mfma_f32_16x16x32_bf16 v[16:19], a[52:55], a[244:247], v[16:19]
    s_add_u32 m0, s50, 0x800
    ds_write_b32 v125, v197 offset:256
    v_mfma_f32_16x16x32_bf16 v[20:23], a[56:59], a[244:247], v[20:23]
    ds_read_b128 a[244:247], v227 offset:6464
    v_lshlrev_b32 v198, 16, v198
    v_mfma_f32_16x16x32_bf16 v[36:39], a[48:51], a[248:251], v[36:39]
    v_mul_f32 v198, s28, v198
    v_mov_b32 v168, 0xf149f2ca
    v_mfma_f32_16x16x32_bf16 v[40:43], a[52:55], a[248:251], v[40:43]
    ds_write_b32 v125, v198 offset:512
    v_mfma_f32_16x16x32_bf16 v[44:47], a[56:59], a[248:251], v[44:47]
    v_mov_b32 v169, 0xf149f2ca
    v_mov_b32 v170, 0xf149f2ca
    v_mfma_f32_16x16x32_bf16 v[132:135], a[48:51], a[252:255], v[132:135]
    buffer_load_dwordx4 v253, s[8:11], s57 offen lds
    v_mfma_f32_16x16x32_bf16 v[136:139], a[52:55], a[252:255], v[136:139]
    s_add_u32 s57, s49, 0x9300
    ds_read2_b32 v[144:145], v121 offset0:39 offset1:40
    v_mov_b32 v171, 0xf149f2ca
    v_mfma_f32_16x16x32_bf16 v[140:143], a[56:59], a[252:255], v[140:143]
    s_add_u32 m0, s50, 0x3000
    s_waitcnt vmcnt(11)
    ds_read_b64_tr_b16 a[60:61], v254 offset:61440
    ds_read_b64_tr_b16 a[62:63], v255 offset:61440
    v_mfma_f32_16x16x32_bf16 v[220:223], a[48:51], a[220:223], v[220:223]
    ds_read_b64_tr_b16 a[64:65], v254 offset:61472
    ds_read_b64_tr_b16 a[66:67], v255 offset:61472
    v_mfma_f32_16x16x32_bf16 v[216:219], a[52:55], a[220:223], v[216:219]
    ds_read_b64_tr_b16 a[68:69], v254 offset:61504
    ds_read_b64_tr_b16 a[70:71], v255 offset:61504
    v_mfma_f32_16x16x32_bf16 v[212:215], a[56:59], a[220:223], v[212:215]
    buffer_load_dwordx4 v251, s[8:11], s57 offen lds
    v_mfma_f32_16x16x32_bf16 v[208:211], a[48:51], a[224:227], v[208:211]
    s_add_u32 m0, s50, 0x3400
    ds_read2_b32 v[146:147], v121 offset0:41 offset1:42
    ds_read2_b32 v[148:149], v121 offset0:65 offset1:66
    v_mfma_f32_16x16x32_bf16 v[204:207], a[52:55], a[224:227], v[204:207]
    ds_read2_b32 v[150:151], v121 offset0:67 offset1:68
    ds_read2_b32 v[152:153], v121 offset0:91 offset1:92
    v_mfma_f32_16x16x32_bf16 v[200:203], a[56:59], a[224:227], v[200:203]
    s_waitcnt lgkmcnt(8)
    ds_read2_b32 v[154:155], v121 offset0:93 offset1:94
    ds_read2_b32 v[156:157], v121 offset0:117 offset1:118
    ds_read2_b32 v[158:159], v121 offset0:119 offset1:120
    ds_read2_b32 v[160:161], v122 offset0:0 offset1:1
    ds_read2_b32 v[162:163], v122 offset0:2 offset1:3
    ds_read2_b32 v[164:165], v122 offset0:13 offset1:14
    ds_read2_b32 v[166:167], v122 offset0:15 offset1:16
    v_cndmask_b32 v144, v168, v144, s[24:25]
    v_mfma_f32_16x16x32_bf16 v[12:15], a[60:63], a[228:231], v[12:15]
    s_waitcnt lgkmcnt(11)
    buffer_load_dwordx4 v252, s[8:11], s57 offen lds
    v_mfma_f32_16x16x32_bf16 v[16:19], a[64:67], a[228:231], v[16:19]
    s_add_u32 m0, s50, 0x3800
    v_cndmask_b32 v145, v168, v145, s[26:27]
    v_mfma_f32_16x16x32_bf16 v[20:23], a[68:71], a[228:231], v[20:23]
    v_mfma_f32_16x16x32_bf16 v[36:39], a[60:63], a[232:235], v[36:39]
    s_waitcnt lgkmcnt(10)
    v_cndmask_b32 v146, v168, v146, s[52:53]
    v_cndmask_b32 v147, v168, v147, s[54:55]
    v_mfma_f32_16x16x32_bf16 v[40:43], a[64:67], a[232:235], v[40:43]
    v_cvt_pk_bf16_f32 v0, v12, v13
    v_cvt_pk_bf16_f32 v1, v14, v15
    v_mfma_f32_16x16x32_bf16 v[44:47], a[68:71], a[232:235], v[44:47]
    v_cvt_pk_bf16_f32 v2, v16, v17
    v_cvt_pk_bf16_f32 v3, v18, v19
    v_mfma_f32_16x16x32_bf16 v[132:135], a[60:63], a[236:239], v[132:135]
    buffer_load_dwordx4 v253, s[8:11], s57 offen lds
    v_mfma_f32_16x16x32_bf16 v[136:139], a[64:67], a[236:239], v[136:139]
    s_add_u32 s57, s49, 0x12300
    v_cvt_pk_bf16_f32 v4, v20, v21
    v_cvt_pk_bf16_f32 v5, v22, v23
    v_mfma_f32_16x16x32_bf16 v[140:143], a[68:71], a[236:239], v[140:143]
    s_add_u32 m0, s50, 0x6000
    v_cvt_pk_bf16_f32 v24, v36, v37
    v_cvt_pk_bf16_f32 v25, v38, v39
    v_mfma_f32_16x16x32_bf16 v[220:223], a[60:63], a[240:243], v[220:223]
    v_cvt_pk_bf16_f32 v26, v40, v41
    v_cvt_pk_bf16_f32 v27, v42, v43
    v_mfma_f32_16x16x32_bf16 v[216:219], a[64:67], a[240:243], v[216:219]
    v_cvt_pk_bf16_f32 v28, v44, v45
    v_cvt_pk_bf16_f32 v29, v46, v47
    v_mfma_f32_16x16x32_bf16 v[212:215], a[68:71], a[240:243], v[212:215]
    buffer_load_dwordx4 v251, s[8:11], s57 offen lds
    v_mfma_f32_16x16x32_bf16 v[208:211], a[60:63], a[244:247], v[208:211]
    s_add_u32 m0, s50, 0x6400
    v_cvt_pk_bf16_f32 v6, v132, v133
    v_cvt_pk_bf16_f32 v7, v134, v135
    v_mfma_f32_16x16x32_bf16 v[204:207], a[64:67], a[244:247], v[204:207]
    s_waitcnt vmcnt(11)
    v_cvt_pk_bf16_f32 v8, v136, v137
    v_cvt_pk_bf16_f32 v9, v138, v139
    v_mfma_f32_16x16x32_bf16 v[200:203], a[68:71], a[244:247], v[200:203]
    s_barrier
    ds_read_b128 a[248:251], v224 offset:30976
    ds_read_b128 a[252:255], v224 offset:31040
    ds_read_b128 a[220:223], v224 offset:31104
    v_cvt_pk_bf16_f32 v10, v140, v141
    ds_read_b128 a[224:227], v224 offset:31168
    v_cvt_pk_bf16_f32 v11, v142, v143
    ds_read_b128 a[228:231], v224 offset:31232
    buffer_load_dwordx4 v252, s[8:11], s57 offen lds
    ds_read_b128 a[232:235], v224 offset:31296
    s_add_u32 m0, s50, 0x6800
    v_cvt_pk_bf16_f32 v30, v220, v221
    ds_read_b128 a[236:239], v224 offset:34048
    v_cvt_pk_bf16_f32 v31, v222, v223
    ds_read_b128 a[240:243], v224 offset:34112
    v_cvt_pk_bf16_f32 v32, v216, v217
    ds_read_b128 a[244:247], v224 offset:34176
    v_cvt_pk_bf16_f32 v33, v218, v219
    v_cvt_pk_bf16_f32 v34, v212, v213
    v_cvt_pk_bf16_f32 v35, v214, v215
    v_cvt_pk_bf16_f32 v48, v208, v209
    v_cvt_pk_bf16_f32 v49, v210, v211
    s_waitcnt lgkmcnt(8)
    v_mfma_f32_16x16x32_bf16 v[180:183], a[0:3], a[248:251], 0
    buffer_load_dwordx4 v253, s[8:11], s57 offen lds
    v_mfma_f32_16x16x32_bf16 v[176:179], a[4:7], a[248:251], 0
    s_add_u32 s57, s49, 0x1b300
    v_cvt_pk_bf16_f32 v50, v204, v205
    v_cvt_pk_bf16_f32 v51, v206, v207
    v_mfma_f32_16x16x32_bf16 v[172:175], a[8:11], a[248:251], 0
    s_add_u32 m0, s50, 0x9000
    ds_read_b128 a[248:251], v224 offset:34240
    v_cvt_pk_bf16_f32 v52, v200, v201
    s_waitcnt lgkmcnt(8)
    v_mfma_f32_16x16x32_bf16 v[180:183], a[12:15], a[252:255], v[180:183]
    v_cvt_pk_bf16_f32 v53, v202, v203
    v_cndmask_b32 v148, v168, v148, s[24:25]
    v_mfma_f32_16x16x32_bf16 v[176:179], a[16:19], a[252:255], v[176:179]
    ds_write_b128 v123, v[144:147] offset:320
    v_mfma_f32_16x16x32_bf16 v[172:175], a[20:23], a[252:255], v[172:175]
    s_waitcnt lgkmcnt(6)
    ds_read_b128 a[252:255], v224 offset:34304
    v_cndmask_b32 v149, v168, v149, s[26:27]
    v_mfma_f32_16x16x32_bf16 v[180:183], a[24:27], a[220:223], v[180:183]
    buffer_load_dwordx4 v251, s[8:11], s57 offen lds
    v_mfma_f32_16x16x32_bf16 v[176:179], a[28:31], a[220:223], v[176:179]
    s_add_u32 m0, s50, 0x9400
    v_cndmask_b32 v150, v168, v150, s[52:53]
    v_cndmask_b32 v151, v168, v151, s[54:55]
    v_mfma_f32_16x16x32_bf16 v[172:175], a[32:35], a[220:223], v[172:175]
    ds_read_b128 a[220:223], v224 offset:34368
    v_cndmask_b32 v152, v168, v152, s[24:25]
    v_mfma_f32_16x16x32_bf16 v[180:183], a[36:39], a[224:227], v[180:183]
    ds_write_b128 v123, v[148:151] offset:960
    v_mfma_f32_16x16x32_bf16 v[176:179], a[40:43], a[224:227], v[176:179]
    buffer_load_dwordx4 v252, s[8:11], s57 offen lds
    v_mfma_f32_16x16x32_bf16 v[172:175], a[44:47], a[224:227], v[172:175]
    s_add_u32 m0, s50, 0x9800
    v_cndmask_b32 v153, v168, v153, s[26:27]
    v_cndmask_b32 v154, v168, v154, s[52:53]
    v_mfma_f32_16x16x32_bf16 v[180:183], a[48:51], a[228:231], v[180:183]
    s_waitcnt vmcnt(11)
    s_barrier
    ds_read_b128 a[224:227], v224 offset:46464
    v_cndmask_b32 v155, v168, v155, s[54:55]
    v_mfma_f32_16x16x32_bf16 v[176:179], a[52:55], a[228:231], v[176:179]
    ds_write_b128 v123, v[152:155] offset:1600
    v_mfma_f32_16x16x32_bf16 v[172:175], a[56:59], a[228:231], v[172:175]
    s_waitcnt lgkmcnt(4)
    ds_read_b128 a[228:231], v224 offset:46528
    v_cndmask_b32 v156, v168, v156, s[24:25]
    v_mfma_f32_16x16x32_bf16 v[180:183], a[60:63], a[232:235], v[180:183]
    buffer_load_dwordx4 v253, s[8:11], s57 offen lds
    v_mfma_f32_16x16x32_bf16 v[176:179], a[64:67], a[232:235], v[176:179]
    s_add_u32 s57, s49, 0x24300
    v_cndmask_b32 v157, v168, v157, s[26:27]
    v_cndmask_b32 v158, v168, v158, s[52:53]
    v_mfma_f32_16x16x32_bf16 v[172:175], a[68:71], a[232:235], v[172:175]
    s_add_u32 m0, s50, 0xc000
    ds_read_b128 a[232:235], v224 offset:46592
    v_cvt_pk_bf16_f32 v12, v180, v181
    v_mfma_f32_16x16x32_bf16 v[220:223], a[0:3], a[236:239], 0
    v_cvt_pk_bf16_f32 v13, v182, v183
    v_cvt_pk_bf16_f32 v14, v176, v177
    v_mfma_f32_16x16x32_bf16 v[216:219], a[4:7], a[236:239], 0
    v_cvt_pk_bf16_f32 v15, v178, v179
    v_cvt_pk_bf16_f32 v16, v172, v173
    v_mfma_f32_16x16x32_bf16 v[212:215], a[8:11], a[236:239], 0
    ds_read_b128 a[236:239], v224 offset:46656
    v_cvt_pk_bf16_f32 v17, v174, v175
    v_mfma_f32_16x16x32_bf16 v[220:223], a[12:15], a[240:243], v[220:223]
    buffer_load_dwordx4 v251, s[8:11], s57 offen lds
    v_mfma_f32_16x16x32_bf16 v[216:219], a[16:19], a[240:243], v[216:219]
    s_add_u32 m0, s50, 0xc400
    v_cndmask_b32 v159, v168, v159, s[54:55]
    v_cndmask_b32 v160, v168, v160, s[24:25]
    v_mfma_f32_16x16x32_bf16 v[212:215], a[20:23], a[240:243], v[212:215]
    ds_read_b128 a[240:243], v224 offset:46720
    v_cndmask_b32 v161, v168, v161, s[26:27]
    v_mfma_f32_16x16x32_bf16 v[220:223], a[24:27], a[244:247], v[220:223]
    ds_write_b128 v123, v[156:159] offset:2240
    v_mfma_f32_16x16x32_bf16 v[216:219], a[28:31], a[244:247], v[216:219]
    buffer_load_dwordx4 v252, s[8:11], s57 offen lds
    v_mfma_f32_16x16x32_bf16 v[212:215], a[32:35], a[244:247], v[212:215]
    s_add_u32 m0, s50, 0xc800
    ds_read_b128 a[244:247], v224 offset:46784
    v_cndmask_b32 v162, v168, v162, s[52:53]
    v_mfma_f32_16x16x32_bf16 v[220:223], a[36:39], a[248:251], v[220:223]
    s_waitcnt vmcnt(11)
    ds_read_b64_tr_b16 a[72:73], v254
    ds_read_b64_tr_b16 a[74:75], v255
    v_mfma_f32_16x16x32_bf16 v[216:219], a[40:43], a[248:251], v[216:219]
    ds_read_b64_tr_b16 a[76:77], v254 offset:32
    ds_read_b64_tr_b16 a[78:79], v255 offset:32
    v_mfma_f32_16x16x32_bf16 v[212:215], a[44:47], a[248:251], v[212:215]
    ds_read_b128 a[248:251], v224 offset:49536
    ds_read_b64_tr_b16 a[80:81], v254 offset:64
    v_mfma_f32_16x16x32_bf16 v[220:223], a[48:51], a[252:255], v[220:223]
    buffer_load_dwordx4 v253, s[8:11], s57 offen lds
    v_mfma_f32_16x16x32_bf16 v[216:219], a[52:55], a[252:255], v[216:219]
    s_add_u32 s57, s49, 0x2d300
    ds_read_b64_tr_b16 a[82:83], v255 offset:64
    v_cndmask_b32 v163, v168, v163, s[54:55]
    v_mfma_f32_16x16x32_bf16 v[212:215], a[56:59], a[252:255], v[212:215]
    s_add_u32 m0, s50, 0xf000
    ds_read_b128 a[252:255], v224 offset:49600
    v_cndmask_b32 v164, v168, v164, s[24:25]
    s_waitcnt lgkmcnt(10)
    v_mfma_f32_16x16x32_bf16 v[220:223], a[60:63], a[220:223], v[220:223]
    s_lshl_b32 s25, s36, 2
    ds_write_b128 v123, v[160:163] offset:2880
    v_mfma_f32_16x16x32_bf16 v[216:219], a[64:67], a[220:223], v[216:219]
    s_add_u32 s25, s25, 0x27e00
    v_cndmask_b32 v165, v168, v165, s[26:27]
    v_cndmask_b32 v166, v168, v166, s[52:53]
    v_mfma_f32_16x16x32_bf16 v[212:215], a[68:71], a[220:223], v[212:215]
    ds_read_b128 a[220:223], v224 offset:49664
    v_cvt_pk_bf16_f32 v36, v220, v221
    v_mfma_f32_16x16x32_bf16 v[208:211], a[0:3], a[224:227], 0
    v_cvt_pk_bf16_f32 v37, v222, v223
    v_cvt_pk_bf16_f32 v38, v216, v217
    v_mfma_f32_16x16x32_bf16 v[204:207], a[4:7], a[224:227], 0
    v_cvt_pk_bf16_f32 v39, v218, v219
    v_cndmask_b32 v167, v168, v167, s[54:55]
    v_mfma_f32_16x16x32_bf16 v[200:203], a[8:11], a[224:227], 0
    v_cvt_pk_bf16_f32 v40, v212, v213
    v_cvt_pk_bf16_f32 v41, v214, v215
    v_mfma_f32_16x16x32_bf16 v[208:211], a[12:15], a[228:231], v[208:211]
    ds_read_b128 a[224:227], v224 offset:49728
    v_mfma_f32_16x16x32_bf16 v[204:207], a[16:19], a[228:231], v[204:207]
    buffer_load_dwordx4 v251, s[8:11], s57 offen lds
    v_mfma_f32_16x16x32_bf16 v[200:203], a[20:23], a[228:231], v[200:203]
    s_add_u32 m0, s50, 0xf400
    ds_read_b128 a[228:231], v224 offset:49792
    v_mfma_f32_16x16x32_bf16 v[208:211], a[24:27], a[232:235], v[208:211]
    s_waitcnt vmcnt(10)
    buffer_load_dwordx4 v252, s[8:11], s57 offen lds
    v_mfma_f32_16x16x32_bf16 v[204:207], a[28:31], a[232:235], v[204:207]
    s_add_u32 m0, s50, 0xf800
    ds_read_b64_tr_b16 a[84:85], v254 offset:12288
    ds_read_b64_tr_b16 a[86:87], v255 offset:12288
    v_mfma_f32_16x16x32_bf16 v[200:203], a[32:35], a[232:235], v[200:203]
    ds_read_b128 a[232:235], v224 offset:49856
    ds_read_b64_tr_b16 a[88:89], v254 offset:12320
    v_mfma_f32_16x16x32_bf16 v[208:211], a[36:39], a[236:239], v[208:211]
    ds_read_b64_tr_b16 a[90:91], v255 offset:12320
    ds_read_b64_tr_b16 a[92:93], v254 offset:12352
    v_mfma_f32_16x16x32_bf16 v[204:207], a[40:43], a[236:239], v[204:207]
    buffer_load_dwordx4 v253, s[8:11], s57 offen lds
    v_mfma_f32_16x16x32_bf16 v[200:203], a[44:47], a[236:239], v[200:203]
    s_add_u32 s57, s49, 0
    ds_read_b128 a[236:239], v227 offset:37120
    ds_read_b64_tr_b16 a[94:95], v255 offset:12352
    v_mfma_f32_16x16x32_bf16 v[208:211], a[48:51], a[240:243], v[208:211]
    s_add_u32 m0, s50, 0
    ds_write_b128 v123, v[164:167] offset:3200
    v_mfma_f32_16x16x32_bf16 v[204:207], a[52:55], a[240:243], v[204:207]
L_pg1:
    s_cbranch_execz L_pg5
    ds_write_b128 v124, v[168:171]
    v_mfma_f32_16x16x32_bf16 v[200:203], a[56:59], a[240:243], v[200:203]
    s_waitcnt lgkmcnt(10)
    ds_read_b128 a[240:243], v227 offset:37184
    ds_read_b128 v[144:147], v235
    v_mfma_f32_16x16x32_bf16 v[208:211], a[60:63], a[244:247], v[208:211]
    buffer_load_dwordx4 v251, s[8:11], s57 offen lds
    v_mfma_f32_16x16x32_bf16 v[204:207], a[64:67], a[244:247], v[204:207]
    s_add_u32 m0, s50, 0x400
    ds_read_b128 v[148:151], v234
    v_bfe_u32 v234, s61, v232, 4
    v_mfma_f32_16x16x32_bf16 v[200:203], a[68:71], a[244:247], v[200:203]
    v_mad_u32_u24 v235, v234, s40, v229
    v_mad_u32_u24 v234, v234, s40, v228
    v_mfma_f32_16x16x32_bf16 v[180:183], a[0:3], a[248:251], 0
    v_cvt_pk_bf16_f32 v18, v208, v209
    v_cvt_pk_bf16_f32 v19, v210, v211
    v_mfma_f32_16x16x32_bf16 v[176:179], a[4:7], a[248:251], 0
    v_cvt_pk_bf16_f32 v20, v204, v205
    v_cvt_pk_bf16_f32 v21, v206, v207
    v_mfma_f32_16x16x32_bf16 v[172:175], a[8:11], a[248:251], 0
    v_cvt_pk_bf16_f32 v22, v200, v201
    v_cvt_pk_bf16_f32 v23, v202, v203
    v_mfma_f32_16x16x32_bf16 v[180:183], a[12:15], a[252:255], v[180:183]
    ds_read_b128 a[244:247], v227 offset:37248
    ds_read_b128 a[248:251], v227 offset:37312
    v_mfma_f32_16x16x32_bf16 v[176:179], a[16:19], a[252:255], v[176:179]
    s_waitcnt vmcnt(10)
    buffer_load_dwordx4 v252, s[8:11], s57 offen lds
    v_mfma_f32_16x16x32_bf16 v[172:175], a[20:23], a[252:255], v[172:175]
    s_add_u32 m0, s50, 0x800
    ds_read_b128 a[252:255], v227 offset:37376
    ds_read_b64_tr_b16 a[96:97], v254 offset:24576
    v_mfma_f32_16x16x32_bf16 v[180:183], a[24:27], a[220:223], v[180:183]
    ds_read_b64_tr_b16 a[98:99], v255 offset:24576
    ds_read_b64_tr_b16 a[100:101], v254 offset:24608
    v_mfma_f32_16x16x32_bf16 v[176:179], a[28:31], a[220:223], v[176:179]
    buffer_load_dwordx4 v253, s[8:11], s57 offen lds
    v_mfma_f32_16x16x32_bf16 v[172:175], a[32:35], a[220:223], v[172:175]
    s_add_u32 s57, s49, 0x9000
    ds_read_b128 a[220:223], v227 offset:37440
    ds_read_b64_tr_b16 a[102:103], v255 offset:24608
    v_mfma_f32_16x16x32_bf16 v[180:183], a[36:39], a[224:227], v[180:183]
    s_add_u32 m0, s50, 0x3000
    ds_read_b64_tr_b16 a[104:105], v254 offset:24640
    ds_read_b64_tr_b16 a[106:107], v255 offset:24640
    v_mfma_f32_16x16x32_bf16 v[176:179], a[40:43], a[224:227], v[176:179]
    ds_read_b128 v[152:155], v235
    v_mfma_f32_16x16x32_bf16 v[172:175], a[44:47], a[224:227], v[172:175]
    ds_read_b128 a[224:227], v224
    v_mfma_f32_16x16x32_bf16 v[180:183], a[48:51], a[228:231], v[180:183]
    s_waitcnt lgkmcnt(12)
    buffer_load_dwordx4 v251, s[8:11], s57 offen lds
    v_mfma_f32_16x16x32_bf16 v[176:179], a[52:55], a[228:231], v[176:179]
    s_add_u32 m0, s50, 0x3400
    ds_read_b128 v[156:159], v234
    v_bfe_u32 v234, s62, v232, 4
    v_mfma_f32_16x16x32_bf16 v[172:175], a[56:59], a[228:231], v[172:175]
    ds_read_b128 a[228:231], v224 offset:64
    v_mad_u32_u24 v235, v234, s40, v229
    v_mfma_f32_16x16x32_bf16 v[180:183], a[60:63], a[232:235], v[180:183]
    v_mad_u32_u24 v234, v234, s40, v228
    v_mfma_f32_16x16x32_bf16 v[176:179], a[64:67], a[232:235], v[176:179]
    v_mfma_f32_16x16x32_bf16 v[172:175], a[68:71], a[232:235], v[172:175]
    ds_read_b128 a[232:235], v224 offset:128
    v_mfma_f32_16x16x32_bf16 v[220:223], a[0:3], a[236:239], 0
    buffer_load_dwordx4 v252, s[8:11], s57 offen lds
    v_mfma_f32_16x16x32_bf16 v[216:219], a[4:7], a[236:239], 0
    s_add_u32 m0, s50, 0x3800
    v_cvt_pk_bf16_f32 v42, v180, v181
    v_cvt_pk_bf16_f32 v43, v182, v183
    v_mfma_f32_16x16x32_bf16 v[212:215], a[8:11], a[236:239], 0
    v_cvt_pk_bf16_f32 v44, v176, v177
    v_cvt_pk_bf16_f32 v45, v178, v179
    v_mfma_f32_16x16x32_bf16 v[220:223], a[12:15], a[240:243], v[220:223]
    v_cvt_pk_bf16_f32 v46, v172, v173
    v_cvt_pk_bf16_f32 v47, v174, v175
    v_mfma_f32_16x16x32_bf16 v[216:219], a[16:19], a[240:243], v[216:219]
    s_waitcnt vmcnt(11)
    ds_read_b128 a[236:239], v224 offset:192
    ds_read_b64_tr_b16 a[108:109], v254 offset:36864
    v_mfma_f32_16x16x32_bf16 v[212:215], a[20:23], a[240:243], v[212:215]
    s_waitcnt lgkmcnt(5)
    ds_read_b128 a[240:243], v224 offset:256
    ds_read_b64_tr_b16 a[110:111], v255 offset:36864
    v_mfma_f32_16x16x32_bf16 v[220:223], a[24:27], a[244:247], v[220:223]
    buffer_load_dwordx4 v253, s[8:11], s57 offen lds
    v_mfma_f32_16x16x32_bf16 v[216:219], a[28:31], a[244:247], v[216:219]
    s_add_u32 s57, s49, 0x12000
    ds_read_b64_tr_b16 a[112:113], v254 offset:36896
    ds_read_b64_tr_b16 a[114:115], v255 offset:36896
    v_mfma_f32_16x16x32_bf16 v[212:215], a[32:35], a[244:247], v[212:215]
    s_add_u32 m0, s50, 0x6000
    ds_read_b128 a[244:247], v224 offset:320
    ds_read_b64_tr_b16 a[116:117], v254 offset:36928
    v_mfma_f32_16x16x32_bf16 v[220:223], a[36:39], a[248:251], v[220:223]
    ds_read_b64_tr_b16 a[118:119], v255 offset:36928
    v_mfma_f32_16x16x32_bf16 v[216:219], a[40:43], a[248:251], v[216:219]
    v_mfma_f32_16x16x32_bf16 v[212:215], a[44:47], a[248:251], v[212:215]
    ds_read_b128 a[248:251], v224 offset:3072
    v_mfma_f32_16x16x32_bf16 v[220:223], a[48:51], a[252:255], v[220:223]
    buffer_load_dwordx4 v251, s[8:11], s57 offen lds
    v_mfma_f32_16x16x32_bf16 v[216:219], a[52:55], a[252:255], v[216:219]
    s_add_u32 m0, s50, 0x6400
    v_mfma_f32_16x16x32_bf16 v[212:215], a[56:59], a[252:255], v[212:215]
    ds_read_b128 a[252:255], v224 offset:3136
    v_mfma_f32_16x16x32_bf16 v[220:223], a[60:63], a[220:223], v[220:223]
    v_mfma_f32_16x16x32_bf16 v[216:219], a[64:67], a[220:223], v[216:219]
    buffer_load_dwordx4 v252, s[8:11], s57 offen lds
    v_mfma_f32_16x16x32_bf16 v[212:215], a[68:71], a[220:223], v[212:215]
    s_add_u32 m0, s50, 0x6800
    ds_read_b128 a[220:223], v224 offset:3200
    v_mfma_f32_16x16x32_bf16 v[208:211], a[224:227], a[72:75], 0
    v_mfma_f32_16x16x32_bf16 v[204:207], a[224:227], a[76:79], 0
    s_waitcnt vmcnt(11)
    ds_read_b64_tr_b16 a[120:121], v254 offset:49152
    v_cvt_pk_bf16_f32 v54, v220, v221
    v_mfma_f32_16x16x32_bf16 v[200:203], a[224:227], a[80:83], 0
    s_waitcnt lgkmcnt(4)
    v_cvt_pk_bf16_f32 v55, v222, v223
    v_cvt_pk_bf16_f32 v56, v216, v217
    v_mfma_f32_16x16x32_bf16 v[208:211], a[228:231], a[84:87], v[208:211]
    v_cvt_pk_bf16_f32 v57, v218, v219
    v_cvt_pk_bf16_f32 v58, v212, v213
    v_mfma_f32_16x16x32_bf16 v[204:207], a[228:231], a[88:91], v[204:207]
    ds_read_b128 a[224:227], v224 offset:3264
    v_cvt_pk_bf16_f32 v59, v214, v215
    v_mfma_f32_16x16x32_bf16 v[200:203], a[228:231], a[92:95], v[200:203]
    ds_read_b128 a[228:231], v224 offset:3328
    ds_read_b64_tr_b16 a[122:123], v255 offset:49152
    v_mfma_f32_16x16x32_bf16 v[208:211], a[232:235], a[96:99], v[208:211]
    buffer_load_dwordx4 v253, s[8:11], s57 offen lds
    v_mfma_f32_16x16x32_bf16 v[204:207], a[232:235], a[100:103], v[204:207]
    s_add_u32 s57, s49, 0x1b000
    ds_read_b64_tr_b16 a[124:125], v254 offset:49184
    ds_read_b64_tr_b16 a[126:127], v255 offset:49184
    v_mfma_f32_16x16x32_bf16 v[200:203], a[232:235], a[104:107], v[200:203]
    s_add_u32 m0, s50, 0x9000
    ds_read_b128 a[232:235], v224 offset:3392
    ds_read_b64_tr_b16 a[128:129], v254 offset:49216
    v_mfma_f32_16x16x32_bf16 v[208:211], a[236:239], a[108:111], v[208:211]
    buffer_load_dwordx4 v251, s[8:11], s57 offen lds
    v_mfma_f32_16x16x32_bf16 v[204:207], a[236:239], a[112:115], v[204:207]
    s_add_u32 m0, s50, 0x9400
    ds_read_b64_tr_b16 a[130:131], v255 offset:49216
    v_mfma_f32_16x16x32_bf16 v[200:203], a[236:239], a[116:119], v[200:203]
    s_waitcnt lgkmcnt(8)
    ds_read_b128 a[236:239], v224 offset:15488
    v_mfma_f32_16x16x32_bf16 v[180:183], a[248:251], a[72:75], 0
    v_mfma_f32_16x16x32_bf16 v[176:179], a[248:251], a[76:79], 0
    s_waitcnt lgkmcnt(6)
    v_mfma_f32_16x16x32_bf16 v[208:211], a[240:243], a[120:123], v[208:211]
    v_mfma_f32_16x16x32_bf16 v[172:175], a[248:251], a[80:83], 0
    s_waitcnt lgkmcnt(4)
    ds_read_b128 a[248:251], v224 offset:15680
    v_mfma_f32_16x16x32_bf16 v[204:207], a[240:243], a[124:127], v[204:207]
    s_waitcnt vmcnt(10) lgkmcnt(2)
    buffer_load_dwordx4 v252, s[8:11], s57 offen lds
    v_mfma_f32_16x16x32_bf16 v[180:183], a[252:255], a[84:87], v[180:183]
    s_add_u32 m0, s50, 0x9800
    ds_read_b64_tr_b16 a[132:133], v254 offset:61440
    ds_read_b64_tr_b16 a[134:135], v255 offset:61440
    v_mfma_f32_16x16x32_bf16 v[200:203], a[240:243], a[128:131], v[200:203]
    ds_read_b128 a[240:243], v224 offset:15552
    ds_read_b64_tr_b16 a[136:137], v254 offset:61472
    v_mfma_f32_16x16x32_bf16 v[176:179], a[252:255], a[88:91], v[176:179]
    ds_read_b64_tr_b16 a[138:139], v255 offset:61472
    ds_read_b64_tr_b16 a[140:141], v254 offset:61504
    v_mfma_f32_16x16x32_bf16 v[172:175], a[252:255], a[92:95], v[172:175]
    ds_read_b128 a[252:255], v224 offset:15744
    ds_read_b64_tr_b16 a[142:143], v255 offset:61504
    v_mfma_f32_16x16x32_bf16 v[180:183], a[220:223], a[96:99], v[180:183]
    buffer_load_dwordx4 v253, s[8:11], s57 offen lds
    v_mfma_f32_16x16x32_bf16 v[176:179], a[220:223], a[100:103], v[176:179]
    s_add_u32 s57, s49, 0x24000
    s_add_u32 m0, s50, 0xc000
    v_mfma_f32_16x16x32_bf16 v[172:175], a[220:223], a[104:107], v[172:175]
    ds_read_b128 a[220:223], v224 offset:15808
    v_mfma_f32_16x16x32_bf16 v[180:183], a[224:227], a[108:111], v[180:183]
    v_mfma_f32_16x16x32_bf16 v[176:179], a[224:227], a[112:115], v[176:179]
    s_waitcnt lgkmcnt(7)
    v_mfma_f32_16x16x32_bf16 v[208:211], a[244:247], a[132:135], v[208:211]
    s_waitcnt lgkmcnt(4)
    buffer_load_dwordx4 v251, s[8:11], s57 offen lds
    v_mfma_f32_16x16x32_bf16 v[172:175], a[224:227], a[116:119], v[172:175]
    s_add_u32 m0, s50, 0xc400
    ds_read_b128 a[224:227], v224 offset:18560
    v_mfma_f32_16x16x32_bf16 v[204:207], a[244:247], a[136:139], v[204:207]
    v_mfma_f32_16x16x32_bf16 v[180:183], a[228:231], a[120:123], v[180:183]
    s_waitcnt lgkmcnt(2)
    v_mfma_f32_16x16x32_bf16 v[200:203], a[244:247], a[140:143], v[200:203]
    ds_read_b128 a[244:247], v224 offset:15616
    v_cvt_pk_bf16_f32 v66, v208, v209
    v_mfma_f32_16x16x32_bf16 v[176:179], a[228:231], a[124:127], v[176:179]
    v_cvt_pk_bf16_f32 v67, v210, v211
    v_mfma_f32_16x16x32_bf16 v[172:175], a[228:231], a[128:131], v[172:175]
    ds_read_b128 a[228:231], v224 offset:18624
    v_cvt_pk_bf16_f32 v88, v204, v205
    v_mfma_f32_16x16x32_bf16 v[180:183], a[232:235], a[132:135], v[180:183]
    v_cvt_pk_bf16_f32 v89, v206, v207
    v_cvt_pk_bf16_f32 v110, v200, v201
    v_mfma_f32_16x16x32_bf16 v[176:179], a[232:235], a[136:139], v[176:179]
    s_waitcnt vmcnt(10)
    ds_read_b64_tr_b16 a[144:145], v254
    v_cvt_pk_bf16_f32 v111, v202, v203
    v_mfma_f32_16x16x32_bf16 v[172:175], a[232:235], a[140:143], v[172:175]
    ds_read_b128 a[232:235], v224 offset:18688
    ds_read_b64_tr_b16 a[146:147], v255
    v_mfma_f32_16x16x32_bf16 v[220:223], a[236:239], a[72:75], 0
    v_cvt_pk_bf16_f32 v68, v180, v181
    v_cvt_pk_bf16_f32 v69, v182, v183
    v_mfma_f32_16x16x32_bf16 v[216:219], a[236:239], a[76:79], 0
    v_cvt_pk_bf16_f32 v90, v176, v177
    v_cvt_pk_bf16_f32 v91, v178, v179
    v_mfma_f32_16x16x32_bf16 v[212:215], a[236:239], a[80:83], 0
    v_cvt_pk_bf16_f32 v112, v172, v173
    v_cvt_pk_bf16_f32 v113, v174, v175
    v_mfma_f32_16x16x32_bf16 v[220:223], a[240:243], a[84:87], v[220:223]
    ds_read_b128 a[236:239], v224 offset:18752
    ds_read_b64_tr_b16 a[148:149], v254 offset:32
    v_mfma_f32_16x16x32_bf16 v[216:219], a[240:243], a[88:91], v[216:219]
    s_waitcnt lgkmcnt(6)
    buffer_load_dwordx4 v252, s[8:11], s57 offen lds
    v_mfma_f32_16x16x32_bf16 v[212:215], a[240:243], a[92:95], v[212:215]
    s_add_u32 m0, s50, 0xc800
    ds_read_b128 a[240:243], v224 offset:18816
    ds_read_b64_tr_b16 a[150:151], v255 offset:32
    v_mfma_f32_16x16x32_bf16 v[220:223], a[244:247], a[96:99], v[220:223]
    buffer_load_dwordx4 v253, s[8:11], s57 offen lds
    v_mfma_f32_16x16x32_bf16 v[216:219], a[244:247], a[100:103], v[216:219]
    s_add_u32 s57, s49, 0x2d000
    ds_read_b64_tr_b16 a[152:153], v254 offset:64
    ds_read_b64_tr_b16 a[154:155], v255 offset:64
    v_mfma_f32_16x16x32_bf16 v[212:215], a[244:247], a[104:107], v[212:215]
    s_add_u32 m0, s50, 0xf000
    ds_read_b128 a[244:247], v224 offset:18880
    v_mfma_f32_16x16x32_bf16 v[220:223], a[248:251], a[108:111], v[220:223]
    buffer_load_dwordx4 v251, s[8:11], s57 offen lds
    v_mfma_f32_16x16x32_bf16 v[216:219], a[248:251], a[112:115], v[216:219]
    s_add_u32 m0, s50, 0xf400
    v_mfma_f32_16x16x32_bf16 v[212:215], a[248:251], a[116:119], v[212:215]
    ds_read_b128 a[248:251], v227 offset:6144
    v_mfma_f32_16x16x32_bf16 v[220:223], a[252:255], a[120:123], v[220:223]
    buffer_load_dwordx4 v252, s[8:11], s57 offen lds
    v_mfma_f32_16x16x32_bf16 v[216:219], a[252:255], a[124:127], v[216:219]
    s_add_u32 m0, s50, 0xf800
    v_mfma_f32_16x16x32_bf16 v[212:215], a[252:255], a[128:131], v[212:215]
    s_waitcnt vmcnt(11)
    ds_read_b128 a[252:255], v227 offset:6208
    ds_read_b64_tr_b16 a[156:157], v254 offset:12288
    v_mfma_f32_16x16x32_bf16 v[220:223], a[220:223], a[132:135], v[220:223]
    ds_read_b64_tr_b16 a[158:159], v255 offset:12288
    ds_read_b64_tr_b16 a[160:161], v254 offset:12320
    v_mfma_f32_16x16x32_bf16 v[216:219], a[220:223], a[136:139], v[216:219]
    ds_read_b64_tr_b16 a[162:163], v255 offset:12320
    ds_read_b64_tr_b16 a[164:165], v254 offset:12352
    v_mfma_f32_16x16x32_bf16 v[212:215], a[220:223], a[140:143], v[212:215]
    ds_read_b128 a[220:223], v227 offset:6272
    ds_read_b64_tr_b16 a[166:167], v255 offset:12352
    v_mfma_f32_16x16x32_bf16 v[208:211], a[224:227], a[72:75], 0
    v_cvt_pk_bf16_f32 v72, v220, v221
    v_cvt_pk_bf16_f32 v73, v222, v223
    v_mfma_f32_16x16x32_bf16 v[204:207], a[224:227], a[76:79], 0
    v_cvt_pk_bf16_f32 v94, v216, v217
    v_cvt_pk_bf16_f32 v95, v218, v219
    v_mfma_f32_16x16x32_bf16 v[200:203], a[224:227], a[80:83], 0
    s_waitcnt lgkmcnt(9)
    v_cvt_pk_bf16_f32 v116, v212, v213
    v_cvt_pk_bf16_f32 v117, v214, v215
    v_mfma_f32_16x16x32_bf16 v[208:211], a[228:231], a[84:87], v[208:211]
    ds_read_b128 a[224:227], v227 offset:6336
    v_mfma_f32_16x16x32_bf16 v[204:207], a[228:231], a[88:91], v[204:207]
    buffer_load_dwordx4 v253, s[8:11], s57 offen lds
    v_mfma_f32_16x16x32_bf16 v[200:203], a[228:231], a[92:95], v[200:203]
    s_add_u32 s57, s49, 0
    ds_read_b128 a[228:231], v227 offset:6400
    s_add_u32 m0, s50, 0
    v_mfma_f32_16x16x32_bf16 v[208:211], a[232:235], a[96:99], v[208:211]
    buffer_load_dwordx4 v192, s[12:15], s57 offen lds
    v_mfma_f32_16x16x32_bf16 v[204:207], a[232:235], a[100:103], v[204:207]
    s_add_u32 m0, s50, 0x400
    v_mfma_f32_16x16x32_bf16 v[200:203], a[232:235], a[104:107], v[200:203]
    ds_read_b128 a[232:235], v227 offset:6464
    v_mfma_f32_16x16x32_bf16 v[208:211], a[236:239], a[108:111], v[208:211]
    v_mfma_f32_16x16x32_bf16 v[204:207], a[236:239], a[112:115], v[204:207]
    buffer_load_dwordx4 v193, s[12:15], s57 offen lds
    v_mfma_f32_16x16x32_bf16 v[200:203], a[236:239], a[116:119], v[200:203]
    s_add_u32 m0, s50, 0x800
    ds_read_b128 a[236:239], v225 offset:24384
    v_mfma_f32_16x16x32_bf16 v[208:211], a[240:243], a[120:123], v[208:211]
    v_mfma_f32_16x16x32_bf16 v[204:207], a[240:243], a[124:127], v[204:207]
    s_waitcnt vmcnt(11)
    ds_read_b64_tr_b16 a[168:169], v254 offset:24576
    ds_read_b64_tr_b16 a[170:171], v255 offset:24576
    v_mfma_f32_16x16x32_bf16 v[200:203], a[240:243], a[128:131], v[200:203]
    ds_read_b128 a[240:243], v225 offset:24448
    ds_read_b64_tr_b16 a[172:173], v254 offset:24608
    v_mfma_f32_16x16x32_bf16 v[208:211], a[244:247], a[132:135], v[208:211]
    ds_read_b64_tr_b16 a[174:175], v255 offset:24608
    ds_read_b64_tr_b16 a[176:177], v254 offset:24640
    v_mfma_f32_16x16x32_bf16 v[204:207], a[244:247], a[136:139], v[204:207]
    s_waitcnt lgkmcnt(8)
    buffer_load_dwordx4 v194, s[12:15], s57 offen lds
    v_mfma_f32_16x16x32_bf16 v[200:203], a[244:247], a[140:143], v[200:203]
    s_add_u32 s57, s49, 0x3000
    ds_read_b128 a[244:247], v225 offset:24512
    ds_read_b64_tr_b16 a[178:179], v255 offset:24640
    v_mfma_f32_16x16x32_bf16 v[180:183], a[248:251], a[72:75], 0
    s_add_u32 m0, s50, 0x3000
    v_cvt_pk_bf16_f32 v70, v208, v209
    v_cvt_pk_bf16_f32 v71, v210, v211
    v_mfma_f32_16x16x32_bf16 v[176:179], a[248:251], a[76:79], 0
    v_cvt_pk_bf16_f32 v92, v204, v205
    v_cvt_pk_bf16_f32 v93, v206, v207
    v_mfma_f32_16x16x32_bf16 v[172:175], a[248:251], a[80:83], 0
    v_cvt_pk_bf16_f32 v114, v200, v201
    v_cvt_pk_bf16_f32 v115, v202, v203
    v_mfma_f32_16x16x32_bf16 v[180:183], a[252:255], a[84:87], v[180:183]
    ds_read_b128 a[248:251], v225 offset:24576
    v_mfma_f32_16x16x32_bf16 v[176:179], a[252:255], a[88:91], v[176:179]
    buffer_load_dwordx4 v192, s[12:15], s57 offen lds
    v_mfma_f32_16x16x32_bf16 v[172:175], a[252:255], a[92:95], v[172:175]
    s_add_u32 m0, s50, 0x3400
    ds_read_b128 a[252:255], v225 offset:24640
    v_mfma_f32_16x16x32_bf16 v[180:183], a[220:223], a[96:99], v[180:183]
    v_mfma_f32_16x16x32_bf16 v[176:179], a[220:223], a[100:103], v[176:179]
    v_mfma_f32_16x16x32_bf16 v[172:175], a[220:223], a[104:107], v[172:175]
    ds_read_b128 a[220:223], v225 offset:24704
    v_mfma_f32_16x16x32_bf16 v[180:183], a[224:227], a[108:111], v[180:183]
    buffer_load_dwordx4 v193, s[12:15], s57 offen lds
    v_mfma_f32_16x16x32_bf16 v[176:179], a[224:227], a[112:115], v[176:179]
    s_add_u32 m0, s50, 0x3800
    v_mfma_f32_16x16x32_bf16 v[172:175], a[224:227], a[116:119], v[172:175]
    s_waitcnt vmcnt(11)
    ds_read_b128 a[224:227], v225 offset:27456
    ds_read_b64_tr_b16 a[180:181], v254 offset:36864
    v_mfma_f32_16x16x32_bf16 v[180:183], a[228:231], a[120:123], v[180:183]
    ds_read_b64_tr_b16 a[182:183], v255 offset:36864
    ds_read_b64_tr_b16 a[184:185], v254 offset:36896
    v_mfma_f32_16x16x32_bf16 v[176:179], a[228:231], a[124:127], v[176:179]
    ds_read_b64_tr_b16 a[186:187], v255 offset:36896
    ds_read_b64_tr_b16 a[188:189], v254 offset:36928
    v_mfma_f32_16x16x32_bf16 v[172:175], a[228:231], a[128:131], v[172:175]
    s_waitcnt lgkmcnt(8)
    ds_read_b128 a[228:231], v225 offset:27520
    ds_read_b64_tr_b16 a[190:191], v255 offset:36928
    v_mfma_f32_16x16x32_bf16 v[180:183], a[232:235], a[132:135], v[180:183]
    buffer_load_dwordx4 v194, s[12:15], s57 offen lds
    v_mfma_f32_16x16x32_bf16 v[176:179], a[232:235], a[136:139], v[176:179]
    s_add_u32 s57, s49, 0x6000
    s_add_u32 m0, s50, 0x6000
    v_mfma_f32_16x16x32_bf16 v[172:175], a[232:235], a[140:143], v[172:175]
    ds_read_b128 a[232:235], v225 offset:27584
    v_mfma_f32_16x16x32_bf16 v[220:223], a[144:147], a[236:239], 0
    v_mfma_f32_16x16x32_bf16 v[216:219], a[148:151], a[236:239], 0
    v_cvt_pk_bf16_f32 v82, v180, v181
    v_cvt_pk_bf16_f32 v83, v182, v183
    v_mfma_f32_16x16x32_bf16 v[212:215], a[152:155], a[236:239], 0
    v_cvt_pk_bf16_f32 v104, v176, v177
    v_cvt_pk_bf16_f32 v105, v178, v179
    v_mfma_f32_16x16x32_bf16 v[220:223], a[156:159], a[240:243], v[220:223]
    v_cvt_pk_bf16_f32 v126, v172, v173
    v_cvt_pk_bf16_f32 v127, v174, v175
    v_mfma_f32_16x16x32_bf16 v[216:219], a[160:163], a[240:243], v[216:219]
    ds_read_b128 a[236:239], v225 offset:27648
    v_mfma_f32_16x16x32_bf16 v[212:215], a[164:167], a[240:243], v[212:215]
    ds_read_b128 a[240:243], v225 offset:27712
    v_mfma_f32_16x16x32_bf16 v[220:223], a[168:171], a[244:247], v[220:223]
    buffer_load_dwordx4 v192, s[12:15], s57 offen lds
    v_mfma_f32_16x16x32_bf16 v[216:219], a[172:175], a[244:247], v[216:219]
    s_add_u32 m0, s50, 0x6400
    v_mfma_f32_16x16x32_bf16 v[212:215], a[176:179], a[244:247], v[212:215]
    s_waitcnt lgkmcnt(3)
    ds_read_b128 a[244:247], v225 offset:27776
    v_mfma_f32_16x16x32_bf16 v[220:223], a[180:183], a[248:251], v[220:223]
    s_waitcnt vmcnt(10)
    buffer_load_dwordx4 v193, s[12:15], s57 offen lds
    v_mfma_f32_16x16x32_bf16 v[216:219], a[184:187], a[248:251], v[216:219]
    s_add_u32 m0, s50, 0x6800
    ds_read_b64_tr_b16 a[192:193], v254 offset:49152
    ds_read_b64_tr_b16 a[194:195], v255 offset:49152
    v_mfma_f32_16x16x32_bf16 v[212:215], a[188:191], a[248:251], v[212:215]
    ds_read_b128 a[248:251], v224 offset:30976
    ds_read_b64_tr_b16 a[196:197], v254 offset:49184
    v_mfma_f32_16x16x32_bf16 v[208:211], a[144:147], a[224:227], 0
    ds_read_b64_tr_b16 a[198:199], v255 offset:49184
    ds_read_b64_tr_b16 a[200:201], v254 offset:49216
    v_mfma_f32_16x16x32_bf16 v[204:207], a[148:151], a[224:227], 0
    buffer_load_dwordx4 v194, s[12:15], s57 offen lds
    v_mfma_f32_16x16x32_bf16 v[200:203], a[152:155], a[224:227], 0
    s_add_u32 s57, s49, 0x9000
    ds_read_b128 a[224:227], v224 offset:31168
    ds_read_b64_tr_b16 a[202:203], v255 offset:49216
    v_mfma_f32_16x16x32_bf16 v[208:211], a[156:159], a[228:231], v[208:211]
    s_add_u32 m0, s50, 0x9000
    v_mfma_f32_16x16x32_bf16 v[204:207], a[160:163], a[228:231], v[204:207]
    s_waitcnt lgkmcnt(8)
    s_barrier
    v_mfma_f32_16x16x32_bf16 v[200:203], a[164:167], a[228:231], v[200:203]
    ds_read_b128 a[228:231], v224 offset:31232
    v_mfma_f32_16x16x32_bf16 v[208:211], a[168:171], a[232:235], v[208:211]
    s_waitcnt lgkmcnt(7)
    buffer_load_dwordx4 v192, s[12:15], s57 offen lds
    v_mfma_f32_16x16x32_bf16 v[220:223], a[192:195], a[252:255], v[220:223]
    s_add_u32 m0, s50, 0x9400
    v_mfma_f32_16x16x32_bf16 v[204:207], a[172:175], a[232:235], v[204:207]
    s_waitcnt lgkmcnt(4)
    v_mfma_f32_16x16x32_bf16 v[216:219], a[196:199], a[252:255], v[216:219]
    v_mfma_f32_16x16x32_bf16 v[200:203], a[176:179], a[232:235], v[200:203]
    s_waitcnt lgkmcnt(1)
    ds_read_b128 a[232:235], v224 offset:31296
    v_mfma_f32_16x16x32_bf16 v[212:215], a[200:203], a[252:255], v[212:215]
    ds_read_b128 a[252:255], v224 offset:31040
    v_mfma_f32_16x16x32_bf16 v[208:211], a[180:183], a[236:239], v[208:211]
    buffer_load_dwordx4 v193, s[12:15], s57 offen lds
    v_mfma_f32_16x16x32_bf16 v[204:207], a[184:187], a[236:239], v[204:207]
    s_add_u32 m0, s50, 0x9800
    v_mfma_f32_16x16x32_bf16 v[200:203], a[188:191], a[236:239], v[200:203]
    s_waitcnt vmcnt(11)
    ds_read_b128 a[236:239], v224 offset:34048
    ds_read_b64_tr_b16 a[204:205], v254 offset:61440
    v_mfma_f32_16x16x32_bf16 v[208:211], a[192:195], a[240:243], v[208:211]
    ds_read_b64_tr_b16 a[206:207], v255 offset:61440
    ds_read_b64_tr_b16 a[208:209], v254 offset:61472
    v_mfma_f32_16x16x32_bf16 v[204:207], a[196:199], a[240:243], v[204:207]
    ds_read_b64_tr_b16 a[210:211], v255 offset:61472
    ds_read_b64_tr_b16 a[212:213], v254 offset:61504
    v_mfma_f32_16x16x32_bf16 v[200:203], a[200:203], a[240:243], v[200:203]
    ds_read_b128 a[240:243], v224 offset:34112
    ds_read_b64_tr_b16 a[214:215], v255 offset:61504
    v_mfma_f32_16x16x32_bf16 v[180:183], a[248:251], a[72:75], 0
    buffer_load_dwordx4 v194, s[12:15], s57 offen lds
    v_mfma_f32_16x16x32_bf16 v[176:179], a[248:251], a[76:79], 0
    s_add_u32 s57, s49, 0xc000
    s_add_u32 m0, s50, 0xc000
    v_mfma_f32_16x16x32_bf16 v[172:175], a[248:251], a[80:83], 0
    s_waitcnt lgkmcnt(8)
    ds_read_b128 a[248:251], v224 offset:34240
    v_mfma_f32_16x16x32_bf16 v[180:183], a[252:255], a[84:87], v[180:183]
    v_mfma_f32_16x16x32_bf16 v[176:179], a[252:255], a[88:91], v[176:179]
    v_mfma_f32_16x16x32_bf16 v[172:175], a[252:255], a[92:95], v[172:175]
    s_waitcnt lgkmcnt(6)
    ds_read_b128 a[252:255], v224 offset:34304
    v_mfma_f32_16x16x32_bf16 v[220:223], a[204:207], a[220:223], v[220:223]
    s_waitcnt lgkmcnt(5)
    buffer_load_dwordx4 v192, s[12:15], s57 offen lds
    v_mfma_f32_16x16x32_bf16 v[216:219], a[208:211], a[220:223], v[216:219]
    s_add_u32 m0, s50, 0xc400
    v_mfma_f32_16x16x32_bf16 v[208:211], a[204:207], a[244:247], v[208:211]
    s_waitcnt lgkmcnt(2)
    v_mfma_f32_16x16x32_bf16 v[212:215], a[212:215], a[220:223], v[212:215]
    ds_read_b128 a[220:223], v224 offset:31104
    v_mfma_f32_16x16x32_bf16 v[204:207], a[208:211], a[244:247], v[204:207]
    buffer_load_dwordx4 v193, s[12:15], s57 offen lds
    v_mfma_f32_16x16x32_bf16 v[200:203], a[212:215], a[244:247], v[200:203]
    s_add_u32 m0, s50, 0xc800
    v_mul_f32 v220, s37, v220
    v_mul_f32 v221, s37, v221
    v_mul_f32 v222, s37, v222
    v_mul_f32 v223, s37, v223
    v_cvt_pk_bf16_f32 v132, v220, v221
    v_cvt_pk_bf16_f32 v133, v222, v223
    v_mfma_f32_16x16x32_bf16 v[220:223], a[236:239], a[72:75], 0
    v_mul_f32 v216, s37, v216
    v_mul_f32 v217, s37, v217
    v_mfma_f32_16x16x32_bf16 v[220:223], a[240:243], a[84:87], v[220:223]
    v_mul_f32 v218, s37, v218
    v_mul_f32 v219, s37, v219
    v_cvt_pk_bf16_f32 v134, v216, v217
    v_cvt_pk_bf16_f32 v135, v218, v219
    v_mfma_f32_16x16x32_bf16 v[216:219], a[236:239], a[76:79], 0
    v_mul_f32 v212, s37, v212
    v_mul_f32 v213, s37, v213
    v_mfma_f32_16x16x32_bf16 v[144:147], v[0:3], v[132:135], v[144:147]
    v_mul_f32 v214, s37, v214
    v_mul_f32 v215, s37, v215
    v_mfma_f32_16x16x32_bf16 v[148:151], v[24:27], v[132:135], v[148:151]
    v_cvt_pk_bf16_f32 v136, v212, v213
    v_cvt_pk_bf16_f32 v137, v214, v215
    v_mfma_f32_16x16x32_bf16 v[152:155], v[30:33], v[132:135], v[152:155]
    v_mul_f32 v208, s37, v208
    v_mul_f32 v209, s37, v209
    v_mfma_f32_16x16x16_bf16 v[144:147], v[4:5], v[136:137], v[144:147]
    v_mul_f32 v210, s37, v210
    v_mul_f32 v211, s37, v211
    v_mfma_f32_16x16x16_bf16 v[148:151], v[28:29], v[136:137], v[148:151]
    v_cvt_pk_bf16_f32 v138, v208, v209
    v_cvt_pk_bf16_f32 v139, v210, v211
    v_mfma_f32_16x16x16_bf16 v[152:155], v[34:35], v[136:137], v[152:155]
    v_mul_f32 v204, s37, v204
    v_mul_f32 v205, s37, v205
    v_mfma_f32_16x16x32_bf16 v[156:159], v[6:9], v[132:135], v[156:159]
    s_waitcnt lgkmcnt(0)
    v_mul_f32 v206, s37, v206
    v_mul_f32 v207, s37, v207
    v_mfma_f32_16x16x32_bf16 v[180:183], a[220:223], a[96:99], v[180:183]
    v_cvt_pk_bf16_f32 v140, v204, v205
    v_cvt_pk_bf16_f32 v141, v206, v207
    v_mfma_f32_16x16x32_bf16 v[176:179], a[220:223], a[100:103], v[176:179]
    v_mul_f32 v200, s37, v200
    v_mul_f32 v201, s37, v201
    v_mfma_f32_16x16x16_bf16 v[156:159], v[10:11], v[136:137], v[156:159]
    v_mul_f32 v202, s37, v202
    v_mul_f32 v203, s37, v203
    v_mfma_f32_16x16x32_bf16 v[172:175], a[220:223], a[104:107], v[172:175]
    v_cvt_pk_bf16_f32 v142, v200, v201
    v_cvt_pk_bf16_f32 v143, v202, v203
    v_mfma_f32_16x16x32_bf16 v[180:183], a[224:227], a[108:111], v[180:183]
    ds_read_b128 a[244:247], v224 offset:34176
    ds_read_b128 a[220:223], v224 offset:34368
    v_mfma_f32_16x16x32_bf16 v[176:179], a[224:227], a[112:115], v[176:179]
    buffer_load_dwordx4 v194, s[12:15], s57 offen lds
    v_mfma_f32_16x16x32_bf16 v[172:175], a[224:227], a[116:119], v[172:175]
    s_add_u32 s57, s49, 0xf000
    ds_read_b128 a[224:227], v224 offset:46464
    s_add_u32 m0, s50, 0xf000
    v_mfma_f32_16x16x32_bf16 v[180:183], a[228:231], a[120:123], v[180:183]
    buffer_load_dwordx4 v192, s[12:15], s57 offen lds
    v_mfma_f32_16x16x32_bf16 v[176:179], a[228:231], a[124:127], v[176:179]
    s_add_u32 m0, s50, 0xf400
    v_exp_f32 v144, v144
    v_mfma_f32_16x16x32_bf16 v[172:175], a[228:231], a[128:131], v[172:175]
    ds_read_b128 a[228:231], v224 offset:46528
    v_mfma_f32_16x16x32_bf16 v[180:183], a[232:235], a[132:135], v[180:183]
    buffer_load_dwordx4 v193, s[12:15], s57 offen lds
    v_mfma_f32_16x16x32_bf16 v[176:179], a[232:235], a[136:139], v[176:179]
    s_add_u32 m0, s50, 0xf800
    v_exp_f32 v145, v145
    v_mfma_f32_16x16x32_bf16 v[172:175], a[232:235], a[140:143], v[172:175]
    ds_read_b128 a[232:235], v224 offset:46592
    v_cvt_pk_bf16_f32 v160, v144, v145
    v_mfma_f32_16x16x32_bf16 v[212:215], a[236:239], a[80:83], 0
    v_cvt_pk_bf16_f32 v74, v180, v181
    v_cvt_pk_bf16_f32 v75, v182, v183
    v_mfma_f32_16x16x32_bf16 v[216:219], a[240:243], a[88:91], v[216:219]
    v_cvt_pk_bf16_f32 v96, v176, v177
    v_cvt_pk_bf16_f32 v97, v178, v179
    v_mfma_f32_16x16x32_bf16 v[212:215], a[240:243], a[92:95], v[212:215]
    s_waitcnt lgkmcnt(3)
    v_cvt_pk_bf16_f32 v118, v172, v173
    v_cvt_pk_bf16_f32 v119, v174, v175
    v_mfma_f32_16x16x32_bf16 v[220:223], a[244:247], a[96:99], v[220:223]
L_pg2:
    s_cbranch_execz L_pg6
    ds_read_b128 a[236:239], v224 offset:46656
    ds_read_b128 a[240:243], v224 offset:46720
    v_mfma_f32_16x16x32_bf16 v[216:219], a[244:247], a[100:103], v[216:219]
    buffer_load_dwordx4 v194, s[12:15], s57 offen lds
    v_mfma_f32_16x16x32_bf16 v[212:215], a[244:247], a[104:107], v[212:215]
    s_add_u32 m0, s41, 0
    ds_read_b128 a[244:247], v224 offset:46784
    v_mfma_f32_16x16x32_bf16 v[220:223], a[248:251], a[108:111], v[220:223]
    buffer_load_dwordx4 v246, s[4:7], s56 offen lds
    v_mfma_f32_16x16x32_bf16 v[216:219], a[248:251], a[112:115], v[216:219]
    s_add_u32 m0, s42, 0
    v_exp_f32 v146, v146
    v_mfma_f32_16x16x32_bf16 v[212:215], a[248:251], a[116:119], v[212:215]
    ds_read_b128 a[248:251], v224 offset:49536
    v_mfma_f32_16x16x32_bf16 v[220:223], a[252:255], a[120:123], v[220:223]
    buffer_load_dwordx4 v247, s[4:7], s56 offen lds
    v_mfma_f32_16x16x32_bf16 v[216:219], a[252:255], a[124:127], v[216:219]
    s_add_u32 s56, s39, 0x17a000
    v_exp_f32 v147, v147
    v_mfma_f32_16x16x32_bf16 v[212:215], a[252:255], a[128:131], v[212:215]
    s_add_u32 m0, s41, 0x1e40
    ds_read_b128 a[252:255], v224 offset:49600
    v_cvt_pk_bf16_f32 v161, v146, v147
    v_mfma_f32_16x16x32_bf16 v[220:223], a[220:223], a[132:135], v[220:223]
    buffer_load_dwordx4 v246, s[4:7], s56 offen lds
    v_mfma_f32_16x16x32_bf16 v[216:219], a[220:223], a[136:139], v[216:219]
    s_add_u32 m0, s42, 0x1e40
    ds_read_b128 v[144:147], v228 offset:1920
    v_mfma_f32_16x16x32_bf16 v[212:215], a[220:223], a[140:143], v[212:215]
    s_waitcnt lgkmcnt(4)
    ds_read_b128 a[220:223], v224 offset:49664
    v_mfma_f32_16x16x32_bf16 v[208:211], a[224:227], a[72:75], 0
    v_exp_f32 v148, v148
    v_mfma_f32_16x16x32_bf16 v[204:207], a[224:227], a[76:79], 0
    v_cvt_pk_bf16_f32 v76, v220, v221
    v_cvt_pk_bf16_f32 v77, v222, v223
    v_mfma_f32_16x16x32_bf16 v[200:203], a[224:227], a[80:83], 0
    v_cvt_pk_bf16_f32 v98, v216, v217
    v_cvt_pk_bf16_f32 v99, v218, v219
    v_mfma_f32_16x16x32_bf16 v[208:211], a[228:231], a[84:87], v[208:211]
    v_cvt_pk_bf16_f32 v120, v212, v213
    v_cvt_pk_bf16_f32 v121, v214, v215
    v_mfma_f32_16x16x32_bf16 v[204:207], a[228:231], a[88:91], v[204:207]
    ds_read_b128 a[224:227], v224 offset:49728
    v_mfma_f32_16x16x32_bf16 v[200:203], a[228:231], a[92:95], v[200:203]
    ds_read_b128 a[228:231], v224 offset:49792
    v_mfma_f32_16x16x32_bf16 v[208:211], a[232:235], a[96:99], v[208:211]
    s_waitcnt lgkmcnt(3)
    buffer_load_dwordx4 v247, s[4:7], s56 offen lds
    v_mfma_f32_16x16x32_bf16 v[204:207], a[232:235], a[100:103], v[204:207]
    s_add_u32 s56, s39, 0x1a4000
    v_exp_f32 v149, v149
    v_mfma_f32_16x16x32_bf16 v[144:147], v[12:15], v[132:135], v[144:147]
    s_add_u32 m0, s41, 0x3c80
    v_exp_f32 v150, v150
    v_mfma_f32_16x16x32_bf16 v[200:203], a[232:235], a[104:107], v[200:203]
    ds_read_b128 a[232:235], v224 offset:49856
    v_cvt_pk_bf16_f32 v162, v148, v149
    v_mfma_f32_16x16x32_bf16 v[208:211], a[236:239], a[108:111], v[208:211]
    buffer_load_dwordx4 v246, s[4:7], s56 offen lds
    v_mfma_f32_16x16x16_bf16 v[144:147], v[16:17], v[136:137], v[144:147]
    s_add_u32 m0, s42, 0x3c80
    v_exp_f32 v151, v151
    v_mfma_f32_16x16x32_bf16 v[204:207], a[236:239], a[112:115], v[204:207]
    v_cvt_pk_bf16_f32 v163, v150, v151
    v_mfma_f32_16x16x32_bf16 v[200:203], a[236:239], a[116:119], v[200:203]
    ds_read_b128 a[236:239], v227 offset:37120
    ds_read_b128 v[148:151], v229 offset:1920
    v_mfma_f32_16x16x32_bf16 v[196:199], a[216:219], v[160:163], 0
    buffer_load_dwordx4 v247, s[4:7], s56 offen lds
    v_mfma_f32_16x16x32_bf16 v[184:187], v[66:69], v[160:163], 0
    s_add_u32 s56, s39, 0x1ce000
    v_exp_f32 v152, v152
    v_mfma_f32_16x16x32_bf16 v[188:191], v[88:91], v[160:163], 0
    s_add_u32 m0, s41, 0x5ac0
    v_exp_f32 v153, v153
    v_mfma_f32_16x16x32_bf16 v[192:195], v[110:113], v[160:163], 0
    v_exp_f32 v154, v154
    v_mfma_f32_16x16x32_bf16 v[208:211], a[240:243], a[120:123], v[208:211]
    v_exp_f32 v155, v155
    v_mfma_f32_16x16x32_bf16 v[204:207], a[240:243], a[124:127], v[204:207]
    buffer_load_dwordx4 v246, s[4:7], s56 offen lds
    v_mfma_f32_16x16x32_bf16 v[200:203], a[240:243], a[128:131], v[200:203]
    s_add_u32 m0, s42, 0x5ac0
    ds_read_b128 a[240:243], v227 offset:37184
    v_cvt_pk_bf16_f32 v160, v152, v153
    v_mfma_f32_16x16x32_bf16 v[208:211], a[244:247], a[132:135], v[208:211]
    v_cvt_pk_bf16_f32 v161, v154, v155
    v_mfma_f32_16x16x32_bf16 v[204:207], a[244:247], a[136:139], v[204:207]
    ds_read_b128 v[152:155], v235
    v_bfe_u32 v235, s61, v232, 4
    v_mfma_f32_16x16x32_bf16 v[200:203], a[244:247], a[140:143], v[200:203]
    s_waitcnt lgkmcnt(2)
    ds_read_b128 a[244:247], v227 offset:37248
    v_mad_u32_u24 v235, v235, s40, v230
    v_mfma_f32_16x16x32_bf16 v[148:151], v[36:39], v[132:135], v[148:151]
    v_cvt_pk_bf16_f32 v80, v208, v209
    v_cvt_pk_bf16_f32 v81, v210, v211
    v_mfma_f32_16x16x32_bf16 v[180:183], a[248:251], a[72:75], 0
    v_cvt_pk_bf16_f32 v102, v204, v205
    v_cvt_pk_bf16_f32 v103, v206, v207
    v_mfma_f32_16x16x32_bf16 v[176:179], a[248:251], a[76:79], 0
    v_cvt_pk_bf16_f32 v124, v200, v201
    v_cvt_pk_bf16_f32 v125, v202, v203
    v_mfma_f32_16x16x16_bf16 v[148:151], v[40:41], v[136:137], v[148:151]
    buffer_load_dwordx4 v247, s[4:7], s56 offen lds
    v_mfma_f32_16x16x32_bf16 v[172:175], a[248:251], a[80:83], 0
    s_add_u32 s56, s39, 0x1f8000
    ds_read_b128 a[248:251], v227 offset:37312
    s_add_u32 m0, s41, 0x7900
    v_mfma_f32_16x16x32_bf16 v[180:183], a[252:255], a[84:87], v[180:183]
    v_exp_f32 v156, v156
    v_mfma_f32_16x16x32_bf16 v[176:179], a[252:255], a[88:91], v[176:179]
    v_exp_f32 v157, v157
    v_mfma_f32_16x16x32_bf16 v[172:175], a[252:255], a[92:95], v[172:175]
    s_waitcnt lgkmcnt(2)
    ds_read_b128 a[252:255], v227 offset:37376
    v_cvt_pk_bf16_f32 v162, v156, v157
    v_mfma_f32_16x16x32_bf16 v[152:155], v[42:45], v[132:135], v[152:155]
    v_exp_f32 v158, v158
    v_mfma_f32_16x16x32_bf16 v[180:183], a[220:223], a[96:99], v[180:183]
    v_exp_f32 v159, v159
    v_mfma_f32_16x16x32_bf16 v[176:179], a[220:223], a[100:103], v[176:179]
    v_cvt_pk_bf16_f32 v163, v158, v159
    v_mfma_f32_16x16x32_bf16 v[172:175], a[220:223], a[104:107], v[172:175]
    ds_read_b128 a[220:223], v227 offset:37440
    ds_read_b128 v[156:159], v234
    v_mfma_f32_16x16x32_bf16 v[196:199], a[216:219], v[160:163], v[196:199]
    v_bfe_u32 v234, s60, v232, 4
    v_mad_u32_u24 v234, v234, s40, v230
    v_mfma_f32_16x16x32_bf16 v[184:187], v[70:73], v[160:163], v[184:187]
    v_exp_f32 v144, v144
    v_mfma_f32_16x16x32_bf16 v[188:191], v[92:95], v[160:163], v[188:191]
    v_exp_f32 v145, v145
    v_mfma_f32_16x16x32_bf16 v[192:195], v[114:117], v[160:163], v[192:195]
    v_exp_f32 v146, v146
    v_mfma_f32_16x16x16_bf16 v[152:155], v[46:47], v[136:137], v[152:155]
    v_exp_f32 v147, v147
    v_mfma_f32_16x16x32_bf16 v[180:183], a[224:227], a[108:111], v[180:183]
    v_cvt_pk_bf16_f32 v160, v144, v145
    v_cvt_pk_bf16_f32 v161, v146, v147
    v_mfma_f32_16x16x32_bf16 v[176:179], a[224:227], a[112:115], v[176:179]
    ds_read_b128 v[144:147], v234
    v_bfe_u32 v234, s62, v232, 4
    v_mfma_f32_16x16x32_bf16 v[172:175], a[224:227], a[116:119], v[172:175]
    ds_read_b128 a[224:227], v225 offset:39872
    v_mad_u32_u24 v234, v234, s40, v230
    v_mfma_f32_16x16x32_bf16 v[180:183], a[228:231], a[120:123], v[180:183]
    v_exp_f32 v148, v148
    v_mfma_f32_16x16x32_bf16 v[176:179], a[228:231], a[124:127], v[176:179]
    s_waitcnt lgkmcnt(2)
    v_exp_f32 v149, v149
    v_mfma_f32_16x16x32_bf16 v[156:159], v[18:21], v[132:135], v[156:159]
    v_exp_f32 v150, v150
    v_mfma_f32_16x16x32_bf16 v[172:175], a[228:231], a[128:131], v[172:175]
    ds_read_b128 a[228:231], v225 offset:39936
    v_cvt_pk_bf16_f32 v162, v148, v149
    v_mfma_f32_16x16x32_bf16 v[180:183], a[232:235], a[132:135], v[180:183]
    v_exp_f32 v151, v151
    v_mfma_f32_16x16x16_bf16 v[156:159], v[22:23], v[136:137], v[156:159]
    v_cvt_pk_bf16_f32 v163, v150, v151
    v_mfma_f32_16x16x32_bf16 v[176:179], a[232:235], a[136:139], v[176:179]
    ds_read_b128 v[148:151], v235
    v_bfe_u32 v235, s63, v233, 4
    v_mfma_f32_16x16x32_bf16 v[196:199], a[216:219], v[160:163], v[196:199]
    v_mad_u32_u24 v235, v235, s40, v231
    v_cvt_pk_bf16_f32 v78, v180, v181
    v_mfma_f32_16x16x32_bf16 v[184:187], v[74:77], v[160:163], v[184:187]
    v_cvt_pk_bf16_f32 v79, v182, v183
    v_mfma_f32_16x16x32_bf16 v[188:191], v[96:99], v[160:163], v[188:191]
    v_cvt_pk_bf16_f32 v100, v176, v177
    v_cvt_pk_bf16_f32 v101, v178, v179
    v_mfma_f32_16x16x32_bf16 v[192:195], v[118:121], v[160:163], v[192:195]
    s_waitcnt lgkmcnt(2)
    v_exp_f32 v152, v152
    v_mfma_f32_16x16x32_bf16 v[144:147], v[24:27], v[138:141], v[144:147]
    v_exp_f32 v153, v153
    v_mfma_f32_16x16x32_bf16 v[172:175], a[232:235], a[140:143], v[172:175]
    ds_read_b128 a[232:235], v225 offset:40000
    v_cvt_pk_bf16_f32 v160, v152, v153
    v_mfma_f32_16x16x32_bf16 v[220:223], a[236:239], a[72:75], 0
    v_exp_f32 v154, v154
    v_mfma_f32_16x16x16_bf16 v[144:147], v[28:29], v[142:143], v[144:147]
    v_exp_f32 v155, v155
    v_mfma_f32_16x16x32_bf16 v[216:219], a[236:239], a[76:79], 0
    s_waitcnt lgkmcnt(1)
    v_cvt_pk_bf16_f32 v161, v154, v155
    v_cvt_pk_bf16_f32 v122, v172, v173
    v_mfma_f32_16x16x32_bf16 v[148:151], v[30:33], v[138:141], v[148:151]
    ds_read_b128 v[152:155], v230 offset:1920
    v_cvt_pk_bf16_f32 v123, v174, v175
    v_mfma_f32_16x16x32_bf16 v[212:215], a[236:239], a[80:83], 0
    ds_read_b128 a[236:239], v225 offset:40064
    v_mfma_f32_16x16x32_bf16 v[220:223], a[240:243], a[84:87], v[220:223]
    v_exp_f32 v156, v156
    v_mfma_f32_16x16x16_bf16 v[148:151], v[34:35], v[142:143], v[148:151]
    v_exp_f32 v157, v157
    v_mfma_f32_16x16x32_bf16 v[216:219], a[240:243], a[88:91], v[216:219]
    v_exp_f32 v158, v158
    v_mfma_f32_16x16x32_bf16 v[212:215], a[240:243], a[92:95], v[212:215]
    s_waitcnt vmcnt(4)
    ds_read_b128 a[240:243], v225 offset:40128
    v_cvt_pk_bf16_f32 v162, v156, v157
    v_mfma_f32_16x16x32_bf16 v[220:223], a[244:247], a[96:99], v[220:223]
    s_barrier
    ds_read_b128 v[252:255], v224 offset:320
    ds_read_b128 v[164:167], v224 offset:3072
    v_mfma_f32_16x16x32_bf16 v[216:219], a[244:247], a[100:103], v[216:219]
    ds_read_b128 v[168:171], v224 offset:3136
    ds_read_b128 v[248:251], v224 offset:3200
    v_mfma_f32_16x16x32_bf16 v[212:215], a[244:247], a[104:107], v[212:215]
    ds_read_b128 a[244:247], v225 offset:40192
    v_mfma_f32_16x16x32_bf16 v[220:223], a[248:251], a[108:111], v[220:223]
    s_waitcnt lgkmcnt(7)
    v_exp_f32 v159, v159
    v_mfma_f32_16x16x32_bf16 v[152:155], v[36:39], v[138:141], v[152:155]
    v_cvt_pk_bf16_f32 v163, v158, v159
    v_mfma_f32_16x16x32_bf16 v[216:219], a[248:251], a[112:115], v[216:219]
    ds_read_b128 v[156:159], v234
    v_bfe_u32 v234, s64, v233, 4
    v_mfma_f32_16x16x32_bf16 v[196:199], a[216:219], v[160:163], v[196:199]
    v_mad_u32_u24 v234, v234, s40, v231
    v_mfma_f32_16x16x32_bf16 v[184:187], v[78:81], v[160:163], v[184:187]
    v_exp_f32 v144, v144
    v_mfma_f32_16x16x32_bf16 v[188:191], v[100:103], v[160:163], v[188:191]
    v_exp_f32 v145, v145
    v_mfma_f32_16x16x32_bf16 v[192:195], v[122:125], v[160:163], v[192:195]
    v_exp_f32 v146, v146
    v_mfma_f32_16x16x16_bf16 v[152:155], v[40:41], v[142:143], v[152:155]
    v_rcp_f32 v197, v196
    v_mfma_f32_16x16x32_bf16 v[212:215], a[248:251], a[116:119], v[212:215]
    ds_read_b128 a[248:251], v224
    v_mul_f32 v184, v184, v197
    v_mfma_f32_16x16x32_bf16 v[220:223], a[252:255], a[120:123], v[220:223]
    v_mul_f32 v185, v185, v197
    v_cvt_pk_bf16_f32 v184, v184, v185
    v_mfma_f32_16x16x32_bf16 v[216:219], a[252:255], a[124:127], v[216:219]
    v_mul_f32 v186, v186, v197
    v_mul_f32 v187, v187, v197
    v_mfma_f32_16x16x32_bf16 v[212:215], a[252:255], a[128:131], v[212:215]
    s_waitcnt lgkmcnt(1)
    ds_read_b128 a[252:255], v224 offset:64
    v_cvt_pk_bf16_f32 v185, v186, v187
    v_mfma_f32_16x16x32_bf16 v[156:159], v[42:45], v[138:141], v[156:159]
    v_mul_f32 v188, v188, v197
    v_mul_f32 v189, v189, v197
    v_mfma_f32_16x16x32_bf16 v[220:223], a[220:223], a[132:135], v[220:223]
    v_cvt_pk_bf16_f32 v186, v188, v189
    v_mul_f32 v190, v190, v197
    v_mfma_f32_16x16x32_bf16 v[216:219], a[220:223], a[136:139], v[216:219]
    v_mul_f32 v191, v191, v197
    v_cvt_pk_bf16_f32 v187, v190, v191
    v_mfma_f32_16x16x16_bf16 v[156:159], v[46:47], v[142:143], v[156:159]
    v_mul_f32 v192, v192, v197
    v_mul_f32 v193, v193, v197
    v_mfma_f32_16x16x32_bf16 v[212:215], a[220:223], a[140:143], v[212:215]
    v_cvt_pk_bf16_f32 v84, v220, v221
    v_cvt_pk_bf16_f32 v85, v222, v223
    v_mfma_f32_16x16x32_bf16 v[208:211], a[144:147], a[224:227], 0
    v_cvt_pk_bf16_f32 v106, v216, v217
    v_cvt_pk_bf16_f32 v107, v218, v219
    v_mfma_f32_16x16x32_bf16 v[204:207], a[148:151], a[224:227], 0
    v_cvt_pk_bf16_f32 v188, v192, v193
    v_mul_f32 v194, v194, v197
    v_mfma_f32_16x16x32_bf16 v[200:203], a[152:155], a[224:227], 0
    v_cvt_pk_bf16_f32 v128, v212, v213
    v_cvt_pk_bf16_f32 v129, v214, v215
    v_mfma_f32_16x16x32_bf16 v[208:211], a[156:159], a[228:231], v[208:211]
    v_mul_f32 v195, v195, v197
    v_cvt_pk_bf16_f32 v189, v194, v195
    v_mfma_f32_16x16x32_bf16 v[204:207], a[160:163], a[228:231], v[204:207]
    ds_read_b64_tr_b16 a[220:221], v241
    v_max3_f32 v236, v236, v196, v197
    v_mfma_f32_16x16x32_bf16 v[200:203], a[164:167], a[228:231], v[200:203]
    ds_write_b128 v237, v[184:187]
    v_mfma_f32_16x16x32_bf16 v[208:211], a[168:171], a[232:235], v[208:211]
    ds_write_b64 v238, v[188:189]
    v_mfma_f32_16x16x32_bf16 v[204:207], a[172:175], a[232:235], v[204:207]
    ds_read_b64_tr_b16 a[222:223], v241 offset:1536
    ds_read_b64_tr_b16 a[224:225], v241 offset:8
    v_mfma_f32_16x16x32_bf16 v[200:203], a[176:179], a[232:235], v[200:203]
    ds_read_b64_tr_b16 a[226:227], v241 offset:1544
    ds_read_b64_tr_b16 a[228:229], v242
    v_mfma_f32_16x16x32_bf16 v[208:211], a[180:183], a[236:239], v[208:211]
    ds_read_b64_tr_b16 a[230:231], v242 offset:1536
    v_cvt_pk_bf16_f32 v160, v144, v145
    v_mfma_f32_16x16x32_bf16 v[204:207], a[184:187], a[236:239], v[204:207]
    ds_read_b64_tr_b16 a[232:233], v242 offset:8
    v_mfma_f32_16x16x32_bf16 v[200:203], a[188:191], a[236:239], v[200:203]
    ds_read_b128 a[236:239], v224 offset:128
    v_mfma_f32_16x16x32_bf16 v[208:211], a[192:195], a[240:243], v[208:211]
    ds_read_b64_tr_b16 a[234:235], v242 offset:1544
    v_mfma_f32_16x16x32_bf16 v[204:207], a[196:199], a[240:243], v[204:207]
    v_exp_f32 v147, v147
    v_mfma_f32_16x16x32_bf16 v[200:203], a[200:203], a[240:243], v[200:203]
    ds_read_b128 a[240:243], v224 offset:192
    v_cvt_pk_bf16_f32 v161, v146, v147
    v_mfma_f32_16x16x32_bf16 v[208:211], a[204:207], a[244:247], v[208:211]
    ds_read_b128 v[144:147], v235
    v_bfe_u32 v235, s65, v232, 4
    v_mfma_f32_16x16x32_bf16 v[204:207], a[208:211], a[244:247], v[204:207]
    v_exp_f32 v148, v148
    v_mfma_f32_16x16x32_bf16 v[200:203], a[212:215], a[244:247], v[200:203]
    s_waitcnt lgkmcnt(9)
    ds_read_b128 a[244:247], v224 offset:256
    v_mfma_f32_16x16x32_bf16 v[180:183], a[0:3], a[248:251], 0
    v_exp_f32 v149, v149
    v_mfma_f32_16x16x32_bf16 v[176:179], a[4:7], a[248:251], 0
    v_mul_f32 v208, s37, v208
    v_mul_f32 v209, s37, v209
    v_mfma_f32_16x16x32_bf16 v[172:175], a[8:11], a[248:251], 0
    v_mul_f32 v210, s37, v210
    v_mul_f32 v211, s37, v211
    v_mfma_f32_16x16x32_bf16 v[220:223], a[248:251], a[72:75], 0
    v_cvt_pk_bf16_f32 v132, v208, v209
    v_cvt_pk_bf16_f32 v133, v210, v211
    v_mfma_f32_16x16x32_bf16 v[216:219], a[248:251], a[76:79], 0
    v_mul_f32 v204, s37, v204
    v_mul_f32 v205, s37, v205
    v_mfma_f32_16x16x32_bf16 v[212:215], a[248:251], a[80:83], 0
    v_mul_f32 v206, s37, v206
    v_mul_f32 v207, s37, v207
    v_mfma_f32_16x16x32_bf16 v[180:183], a[12:15], a[252:255], v[180:183]
    v_cvt_pk_bf16_f32 v134, v204, v205
    v_cvt_pk_bf16_f32 v135, v206, v207
    v_mfma_f32_16x16x32_bf16 v[176:179], a[16:19], a[252:255], v[176:179]
    s_waitcnt lgkmcnt(1)
    v_mul_f32 v200, s37, v200
    v_mul_f32 v201, s37, v201
    v_mfma_f32_16x16x32_bf16 v[144:147], v[48:51], v[138:141], v[144:147]
    v_mul_f32 v202, s37, v202
    v_mul_f32 v203, s37, v203
    v_mfma_f32_16x16x32_bf16 v[172:175], a[20:23], a[252:255], v[172:175]
    v_cvt_pk_bf16_f32 v136, v200, v201
    v_cvt_pk_bf16_f32 v137, v202, v203
    v_mfma_f32_16x16x32_bf16 v[220:223], a[252:255], a[84:87], v[220:223]
    ds_read_b128 a[248:251], v224 offset:3264
    v_cvt_pk_bf16_f32 v162, v148, v149
    v_mfma_f32_16x16x16_bf16 v[144:147], v[52:53], v[142:143], v[144:147]
    v_exp_f32 v150, v150
    v_mfma_f32_16x16x32_bf16 v[216:219], a[252:255], a[88:91], v[216:219]
    v_exp_f32 v151, v151
    v_mfma_f32_16x16x32_bf16 v[212:215], a[252:255], a[92:95], v[212:215]
    ds_read_b128 a[252:255], v224 offset:3328
    v_cvt_pk_bf16_f32 v163, v150, v151
    v_mfma_f32_16x16x32_bf16 v[180:183], a[24:27], a[236:239], v[180:183]
    ds_read_b128 v[148:151], v234
    v_mad_u32_u24 v234, v235, s40, v229
    v_mfma_f32_16x16x32_bf16 v[196:199], a[216:219], v[160:163], 0
    v_mad_u32_u24 v235, v235, s40, v228
    v_mfma_f32_16x16x32_bf16 v[184:187], v[68:71], v[160:163], 0
    v_exp_f32 v152, v152
    v_mfma_f32_16x16x32_bf16 v[188:191], v[90:93], v[160:163], 0
    v_exp_f32 v153, v153
    v_mfma_f32_16x16x32_bf16 v[192:195], v[112:115], v[160:163], 0
    v_exp_f32 v154, v154
    v_mfma_f32_16x16x32_bf16 v[176:179], a[28:31], a[236:239], v[176:179]
    v_exp_f32 v155, v155
    v_mfma_f32_16x16x32_bf16 v[172:175], a[32:35], a[236:239], v[172:175]
    v_cvt_pk_bf16_f32 v160, v152, v153
    v_cvt_pk_bf16_f32 v161, v154, v155
    v_mfma_f32_16x16x32_bf16 v[220:223], a[236:239], a[96:99], v[220:223]
    ds_read_b128 v[152:155], v234
    v_mfma_f32_16x16x32_bf16 v[216:219], a[236:239], a[100:103], v[216:219]
    v_exp_f32 v156, v156
    v_mfma_f32_16x16x32_bf16 v[212:215], a[236:239], a[104:107], v[212:215]
    s_waitcnt lgkmcnt(1)
    ds_read_b128 a[236:239], v224 offset:3392
    v_mfma_f32_16x16x32_bf16 v[148:151], v[54:57], v[138:141], v[148:151]
    v_exp_f32 v157, v157
    v_mfma_f32_16x16x32_bf16 v[180:183], a[36:39], a[240:243], v[180:183]
    v_exp_f32 v158, v158
    v_mfma_f32_16x16x32_bf16 v[176:179], a[40:43], a[240:243], v[176:179]
    v_exp_f32 v159, v159
    v_mfma_f32_16x16x32_bf16 v[172:175], a[44:47], a[240:243], v[172:175]
    v_cvt_pk_bf16_f32 v162, v156, v157
    v_cvt_pk_bf16_f32 v163, v158, v159
    v_mfma_f32_16x16x16_bf16 v[148:151], v[58:59], v[142:143], v[148:151]
    ds_read_b128 v[156:159], v235
    v_bfe_u32 v235, s62, v232, 4
    v_mfma_f32_16x16x32_bf16 v[196:199], a[216:219], v[160:163], v[196:199]
    v_mad_u32_u24 v234, v235, s40, v228
    v_mad_u32_u24 v235, v235, s40, v229
    v_mfma_f32_16x16x32_bf16 v[184:187], v[76:79], v[160:163], v[184:187]
    v_exp_f32 v144, v144
    v_mfma_f32_16x16x32_bf16 v[188:191], v[98:101], v[160:163], v[188:191]
    v_exp_f32 v145, v145
    v_mfma_f32_16x16x32_bf16 v[192:195], v[120:123], v[160:163], v[192:195]
    s_waitcnt lgkmcnt(2)
    v_exp_f32 v146, v146
    v_mfma_f32_16x16x32_bf16 v[152:155], v[30:33], v[132:135], v[152:155]
    v_exp_f32 v147, v147
    v_mfma_f32_16x16x32_bf16 v[220:223], a[240:243], a[108:111], v[220:223]
    v_cvt_pk_bf16_f32 v160, v144, v145
    v_cvt_pk_bf16_f32 v161, v146, v147
    v_mfma_f32_16x16x32_bf16 v[216:219], a[240:243], a[112:115], v[216:219]
    ds_read_b128 v[144:147], v228 offset:1280
    v_mfma_f32_16x16x16_bf16 v[152:155], v[34:35], v[136:137], v[152:155]
    v_exp_f32 v148, v148
    v_mfma_f32_16x16x32_bf16 v[212:215], a[240:243], a[116:119], v[212:215]
    s_waitcnt lgkmcnt(1)
    ds_read_b128 a[240:243], v225 offset:42944
    v_mfma_f32_16x16x32_bf16 v[156:159], v[6:9], v[132:135], v[156:159]
    v_exp_f32 v149, v149
    v_mfma_f32_16x16x32_bf16 v[180:183], a[48:51], a[244:247], v[180:183]
    v_exp_f32 v150, v150
    v_mfma_f32_16x16x32_bf16 v[176:179], a[52:55], a[244:247], v[176:179]
    v_exp_f32 v151, v151
    v_mfma_f32_16x16x32_bf16 v[172:175], a[56:59], a[244:247], v[172:175]
    v_cvt_pk_bf16_f32 v162, v148, v149
    v_cvt_pk_bf16_f32 v163, v150, v151
    v_mfma_f32_16x16x16_bf16 v[156:159], v[10:11], v[136:137], v[156:159]
    ds_read_b128 v[148:151], v229 offset:1280
    v_mfma_f32_16x16x32_bf16 v[196:199], a[216:219], v[160:163], v[196:199]
    v_exp_f32 v152, v152
    v_mfma_f32_16x16x32_bf16 v[184:187], v[82:85], v[160:163], v[184:187]
    v_exp_f32 v153, v153
    v_mfma_f32_16x16x32_bf16 v[188:191], v[104:107], v[160:163], v[188:191]
    v_exp_f32 v154, v154
    v_mfma_f32_16x16x32_bf16 v[192:195], v[126:129], v[160:163], v[192:195]
    s_waitcnt lgkmcnt(2)
    v_exp_f32 v155, v155
    v_mfma_f32_16x16x32_bf16 v[144:147], v[12:15], v[132:135], v[144:147]
    v_rcp_f32 v197, v196
    v_mfma_f32_16x16x32_bf16 v[220:223], a[244:247], a[120:123], v[220:223]
    v_mul_f32 v184, v184, v197
    v_mul_f32 v185, v185, v197
    v_mfma_f32_16x16x32_bf16 v[216:219], a[244:247], a[124:127], v[216:219]
    v_cvt_pk_bf16_f32 v184, v184, v185
    v_mul_f32 v186, v186, v197
    v_mfma_f32_16x16x16_bf16 v[144:147], v[16:17], v[136:137], v[144:147]
    v_mul_f32 v187, v187, v197
    v_cvt_pk_bf16_f32 v185, v186, v187
    v_mfma_f32_16x16x32_bf16 v[212:215], a[244:247], a[128:131], v[212:215]
    s_waitcnt lgkmcnt(0)
    ds_read_b128 a[244:247], v225 offset:43008
    v_mul_f32 v188, v188, v197
    v_mfma_f32_16x16x32_bf16 v[148:151], v[36:39], v[132:135], v[148:151]
    v_mul_f32 v189, v189, v197
    v_cvt_pk_bf16_f32 v186, v188, v189
    v_mfma_f32_16x16x32_bf16 v[180:183], a[60:63], v[252:255], v[180:183]
    v_mul_f32 v190, v190, v197
    v_mul_f32 v191, v191, v197
    v_mfma_f32_16x16x32_bf16 v[176:179], a[64:67], v[252:255], v[176:179]
    v_cvt_pk_bf16_f32 v187, v190, v191
    v_mul_f32 v192, v192, v197
    v_mfma_f32_16x16x16_bf16 v[148:151], v[40:41], v[136:137], v[148:151]
    v_mul_f32 v193, v193, v197
    v_cvt_pk_bf16_f32 v188, v192, v193
    v_mfma_f32_16x16x32_bf16 v[172:175], a[68:71], v[252:255], v[172:175]
    v_cvt_pk_bf16_f32 v0, v180, v181
    v_cvt_pk_bf16_f32 v1, v182, v183
    v_mfma_f32_16x16x32_bf16 v[220:223], v[252:255], a[132:135], v[220:223]
    v_cvt_pk_bf16_f32 v2, v176, v177
    v_cvt_pk_bf16_f32 v3, v178, v179
    v_mfma_f32_16x16x32_bf16 v[216:219], v[252:255], a[136:139], v[216:219]
    v_mul_f32 v194, v194, v197
    v_mul_f32 v195, v195, v197
    v_mfma_f32_16x16x32_bf16 v[212:215], v[252:255], a[140:143], v[212:215]
    v_cvt_pk_bf16_f32 v4, v172, v173
    v_cvt_pk_bf16_f32 v5, v174, v175
    v_mfma_f32_16x16x32_bf16 v[208:211], a[0:3], v[164:167], 0
    v_cvt_pk_bf16_f32 v66, v220, v221
    v_cvt_pk_bf16_f32 v67, v222, v223
    v_mfma_f32_16x16x32_bf16 v[204:207], a[4:7], v[164:167], 0
    v_cvt_pk_bf16_f32 v88, v216, v217
    v_cvt_pk_bf16_f32 v89, v218, v219
    v_mfma_f32_16x16x32_bf16 v[200:203], a[8:11], v[164:167], 0
    v_cvt_pk_bf16_f32 v110, v212, v213
    v_cvt_pk_bf16_f32 v111, v214, v215
    v_mfma_f32_16x16x32_bf16 v[180:183], v[164:167], a[72:75], 0
    ds_read_b128 v[252:255], v225 offset:43072
    v_cvt_pk_bf16_f32 v189, v194, v195
    v_mfma_f32_16x16x32_bf16 v[176:179], v[164:167], a[76:79], 0
    v_max3_f32 v236, v236, v196, v197
    v_cvt_pk_bf16_f32 v160, v152, v153
    v_mfma_f32_16x16x32_bf16 v[172:175], v[164:167], a[80:83], 0
    ds_read_b128 v[164:167], v225 offset:43136
    v_cvt_pk_bf16_f32 v161, v154, v155
    v_mfma_f32_16x16x32_bf16 v[208:211], a[12:15], v[168:171], v[208:211]
    ds_write_b128 v237, v[184:187] offset:6144
    v_mfma_f32_16x16x32_bf16 v[204:207], a[16:19], v[168:171], v[204:207]
    ds_write_b64 v238, v[188:189] offset:6144
    v_mfma_f32_16x16x32_bf16 v[200:203], a[20:23], v[168:171], v[200:203]
    ds_read_b128 v[152:155], v229 offset:1920
    v_mfma_f32_16x16x32_bf16 v[180:183], v[168:171], a[84:87], v[180:183]
    v_exp_f32 v156, v156
    v_mfma_f32_16x16x32_bf16 v[176:179], v[168:171], a[88:91], v[176:179]
    v_exp_f32 v157, v157
    v_mfma_f32_16x16x32_bf16 v[172:175], v[168:171], a[92:95], v[172:175]
    ds_read_b128 v[168:171], v225 offset:43200
    v_cvt_pk_bf16_f32 v162, v156, v157
    v_mfma_f32_16x16x32_bf16 v[208:211], a[24:27], v[248:251], v[208:211]
    v_exp_f32 v158, v158
    v_mfma_f32_16x16x32_bf16 v[204:207], a[28:31], v[248:251], v[204:207]
    v_exp_f32 v159, v159
    v_mfma_f32_16x16x32_bf16 v[200:203], a[32:35], v[248:251], v[200:203]
    v_cvt_pk_bf16_f32 v163, v158, v159
    v_mfma_f32_16x16x32_bf16 v[180:183], v[248:251], a[96:99], v[180:183]
    ds_read_b128 v[156:159], v228 offset:1920
    v_mfma_f32_16x16x32_bf16 v[196:199], a[216:219], v[160:163], 0
    v_exp_f32 v144, v144
    v_mfma_f32_16x16x32_bf16 v[184:187], v[70:73], v[160:163], 0
    v_exp_f32 v145, v145
    v_mfma_f32_16x16x32_bf16 v[188:191], v[92:95], v[160:163], 0
    v_exp_f32 v146, v146
    v_mfma_f32_16x16x32_bf16 v[192:195], v[114:117], v[160:163], 0
    s_waitcnt lgkmcnt(2)
    v_exp_f32 v147, v147
    v_mfma_f32_16x16x32_bf16 v[152:155], v[42:45], v[132:135], v[152:155]
    v_cvt_pk_bf16_f32 v160, v144, v145
    v_cvt_pk_bf16_f32 v161, v146, v147
    v_mfma_f32_16x16x32_bf16 v[176:179], v[248:251], a[100:103], v[176:179]
    ds_read_b128 v[144:147], v234
    v_bfe_u32 v234, s65, v232, 4
    v_mfma_f32_16x16x32_bf16 v[172:175], v[248:251], a[104:107], v[172:175]
    ds_read_b128 v[248:251], v225 offset:43264
    v_mad_u32_u24 v234, v234, s40, v230
    v_mfma_f32_16x16x16_bf16 v[152:155], v[46:47], v[136:137], v[152:155]
    v_exp_f32 v148, v148
    v_mfma_f32_16x16x32_bf16 v[208:211], a[36:39], a[248:251], v[208:211]
    s_waitcnt lgkmcnt(2)
    v_exp_f32 v149, v149
    v_mfma_f32_16x16x32_bf16 v[156:159], v[18:21], v[132:135], v[156:159]
    v_exp_f32 v150, v150
    v_mfma_f32_16x16x32_bf16 v[204:207], a[40:43], a[248:251], v[204:207]
    v_exp_f32 v151, v151
    v_mfma_f32_16x16x32_bf16 v[200:203], a[44:47], a[248:251], v[200:203]
    v_cvt_pk_bf16_f32 v162, v148, v149
    v_cvt_pk_bf16_f32 v163, v150, v151
    v_mfma_f32_16x16x16_bf16 v[156:159], v[22:23], v[136:137], v[156:159]
    ds_read_b128 v[148:151], v235
    v_bfe_u32 v235, s62, v232, 4
    v_mfma_f32_16x16x32_bf16 v[196:199], a[216:219], v[160:163], v[196:199]
    v_mad_u32_u24 v235, v235, s40, v230
    v_mfma_f32_16x16x32_bf16 v[184:187], v[74:77], v[160:163], v[184:187]
    v_exp_f32 v152, v152
    v_mfma_f32_16x16x32_bf16 v[188:191], v[96:99], v[160:163], v[188:191]
    s_waitcnt vmcnt(0) lgkmcnt(1)
    v_exp_f32 v153, v153
    v_mfma_f32_16x16x32_bf16 v[192:195], v[118:121], v[160:163], v[192:195]
    s_barrier
    buffer_load_dwordx4 v246, s[4:7], s56 offen lds
    v_mfma_f32_16x16x32_bf16 v[144:147], v[0:3], v[132:135], v[144:147]
    s_add_u32 m0, s42, 0x7900
    v_exp_f32 v154, v154
    v_mfma_f32_16x16x32_bf16 v[180:183], a[248:251], a[108:111], v[180:183]
    v_exp_f32 v155, v155
    v_mfma_f32_16x16x32_bf16 v[176:179], a[248:251], a[112:115], v[176:179]
    v_cvt_pk_bf16_f32 v160, v152, v153
    v_cvt_pk_bf16_f32 v161, v154, v155
    v_mfma_f32_16x16x16_bf16 v[144:147], v[4:5], v[136:137], v[144:147]
    ds_read_b128 v[152:155], v235
    v_bfe_u32 v235, s66, v233, 4
    v_mfma_f32_16x16x32_bf16 v[172:175], a[248:251], a[116:119], v[172:175]
    ds_read_b128 a[248:251], v227 offset:6144
    v_mad_u32_u24 v235, v235, s40, v231
    v_mfma_f32_16x16x32_bf16 v[208:211], a[48:51], a[252:255], v[208:211]
    v_exp_f32 v156, v156
    v_mfma_f32_16x16x32_bf16 v[204:207], a[52:55], a[252:255], v[204:207]
    v_exp_f32 v157, v157
    v_mfma_f32_16x16x32_bf16 v[200:203], a[56:59], a[252:255], v[200:203]
    buffer_load_dwordx4 v247, s[4:7], s56 offen lds
    v_mfma_f32_16x16x32_bf16 v[180:183], a[252:255], a[120:123], v[180:183]
    s_add_u32 s56, s39, 0x222000
    v_exp_f32 v158, v158
    v_mfma_f32_16x16x32_bf16 v[176:179], a[252:255], a[124:127], v[176:179]
    s_add_u32 m0, s41, 0x9740
    v_exp_f32 v159, v159
    v_mfma_f32_16x16x32_bf16 v[172:175], a[252:255], a[128:131], v[172:175]
    ds_read_b128 a[252:255], v227 offset:6208
    v_cvt_pk_bf16_f32 v162, v156, v157
    v_mfma_f32_16x16x32_bf16 v[208:211], a[60:63], a[236:239], v[208:211]
    v_cvt_pk_bf16_f32 v163, v158, v159
    v_mfma_f32_16x16x32_bf16 v[204:207], a[64:67], a[236:239], v[204:207]
    ds_read_b128 v[156:159], v234
    v_bfe_u32 v234, s67, v233, 4
    v_mfma_f32_16x16x32_bf16 v[196:199], a[216:219], v[160:163], v[196:199]
L_pg3:
    s_cbranch_execz L_pg7
    v_mad_u32_u24 v234, v234, s40, v231
    v_mfma_f32_16x16x32_bf16 v[184:187], v[78:81], v[160:163], v[184:187]
    v_exp_f32 v144, v144
    v_mfma_f32_16x16x32_bf16 v[188:191], v[100:103], v[160:163], v[188:191]
    v_cvt_pk_bf16_f32 v24, v208, v209
    v_cvt_pk_bf16_f32 v25, v210, v211
    v_mfma_f32_16x16x32_bf16 v[192:195], v[122:125], v[160:163], v[192:195]
    v_cvt_pk_bf16_f32 v26, v204, v205
    v_cvt_pk_bf16_f32 v27, v206, v207
    v_mfma_f32_16x16x32_bf16 v[200:203], a[68:71], a[236:239], v[200:203]
    s_waitcnt lgkmcnt(2)
    buffer_load_dwordx4 v246, s[4:7], s56 offen lds
    v_mfma_f32_16x16x32_bf16 v[148:151], v[24:27], v[132:135], v[148:151]
    s_add_u32 m0, s42, 0x9740
    v_exp_f32 v145, v145
    v_mfma_f32_16x16x32_bf16 v[180:183], a[236:239], a[132:135], v[180:183]
    v_exp_f32 v146, v146
    v_mfma_f32_16x16x32_bf16 v[176:179], a[236:239], a[136:139], v[176:179]
    v_exp_f32 v147, v147
    v_mfma_f32_16x16x32_bf16 v[172:175], a[236:239], a[140:143], v[172:175]
    v_cvt_pk_bf16_f32 v28, v200, v201
    v_cvt_pk_bf16_f32 v29, v202, v203
    v_mfma_f32_16x16x32_bf16 v[220:223], a[144:147], a[240:243], 0
    ds_read_b128 a[236:239], v227 offset:6272
    v_cvt_pk_bf16_f32 v68, v180, v181
    v_mfma_f32_16x16x16_bf16 v[148:151], v[28:29], v[136:137], v[148:151]
    v_cvt_pk_bf16_f32 v69, v182, v183
    v_cvt_pk_bf16_f32 v90, v176, v177
    v_mfma_f32_16x16x32_bf16 v[216:219], a[148:151], a[240:243], 0
    v_cvt_pk_bf16_f32 v91, v178, v179
    v_cvt_pk_bf16_f32 v112, v172, v173
    v_mfma_f32_16x16x32_bf16 v[212:215], a[152:155], a[240:243], 0
    ds_read_b128 a[240:243], v227 offset:6336
    v_cvt_pk_bf16_f32 v113, v174, v175
    v_mfma_f32_16x16x32_bf16 v[220:223], a[156:159], a[244:247], v[220:223]
    buffer_load_dwordx4 v247, s[4:7], s56 offen lds
    v_mfma_f32_16x16x32_bf16 v[216:219], a[160:163], a[244:247], v[216:219]
    s_add_u32 s56, s39, 0x24c000
    v_cvt_pk_bf16_f32 v160, v144, v145
    v_cvt_pk_bf16_f32 v161, v146, v147
    v_mfma_f32_16x16x32_bf16 v[212:215], a[164:167], a[244:247], v[212:215]
    s_add_u32 m0, s41, 0xb580
    ds_read_b128 a[244:247], v239
    ds_read_b128 v[144:147], v230 offset:1280
    v_mfma_f32_16x16x32_bf16 v[220:223], a[168:171], v[252:255], v[220:223]
    v_exp_f32 v148, v148
    v_mfma_f32_16x16x32_bf16 v[216:219], a[172:175], v[252:255], v[216:219]
    v_exp_f32 v149, v149
    v_mfma_f32_16x16x32_bf16 v[212:215], a[176:179], v[252:255], v[212:215]
    ds_read_b128 v[252:255], v240
    v_cvt_pk_bf16_f32 v162, v148, v149
    v_mfma_f32_16x16x32_bf16 v[220:223], a[180:183], v[164:167], v[220:223]
    v_exp_f32 v150, v150
    v_mfma_f32_16x16x32_bf16 v[216:219], a[184:187], v[164:167], v[216:219]
    v_exp_f32 v151, v151
    v_mfma_f32_16x16x32_bf16 v[212:215], a[188:191], v[164:167], v[212:215]
    ds_read_b64_tr_b16 v[164:165], v241 offset:12288
    ds_read_b64_tr_b16 v[166:167], v241 offset:26112
    v_mfma_f32_16x16x32_bf16 v[220:223], a[192:195], v[168:171], v[220:223]
    v_cvt_pk_bf16_f32 v163, v150, v151
    v_mfma_f32_16x16x32_bf16 v[216:219], a[196:199], v[168:171], v[216:219]
    ds_read_b128 v[148:151], v230 offset:1920
    v_mfma_f32_16x16x32_bf16 v[196:199], a[216:219], v[160:163], v[196:199]
    v_mfma_f32_16x16x32_bf16 v[184:187], v[66:69], v[160:163], v[184:187]
    v_mfma_f32_16x16x32_bf16 v[188:191], v[88:91], v[160:163], v[188:191]
    v_mfma_f32_16x16x32_bf16 v[192:195], v[110:113], v[160:163], v[192:195]
    v_mfma_f32_16x16x32_bf16 v[212:215], a[200:203], v[168:171], v[212:215]
    ds_read_b64_tr_b16 v[168:169], v241 offset:12296
    ds_read_b64_tr_b16 v[170:171], v241 offset:26120
    v_mfma_f32_16x16x32_bf16 v[220:223], a[204:207], v[248:251], v[220:223]
    v_mfma_f32_16x16x32_bf16 v[216:219], a[208:211], v[248:251], v[216:219]
    v_rcp_f32 v197, v196
    v_mfma_f32_16x16x32_bf16 v[212:215], a[212:215], v[248:251], v[212:215]
    s_waitcnt lgkmcnt(4)
    v_mul_f32 v184, v184, v197
    v_mul_f32 v185, v185, v197
    v_mfma_f32_16x16x32_bf16 v[208:211], a[220:223], a[244:247], 0
    v_cvt_pk_bf16_f32 v184, v184, v185
    v_mul_f32 v186, v186, v197
    v_mfma_f32_16x16x32_bf16 v[200:203], a[220:223], v[252:255], 0
    v_mul_f32 v220, s37, v220
    v_mul_f32 v221, s37, v221
    v_mfma_f32_16x16x32_bf16 v[204:207], a[224:227], a[244:247], 0
    v_mul_f32 v222, s37, v222
    v_mul_f32 v223, s37, v223
    v_mfma_f32_16x16x32_bf16 v[180:183], a[224:227], v[252:255], 0
    v_cvt_pk_bf16_f32 v138, v220, v221
    v_cvt_pk_bf16_f32 v139, v222, v223
    v_mfma_f32_16x16x32_bf16 v[220:223], a[0:3], a[248:251], 0
    v_mul_f32 v216, s37, v216
    v_mul_f32 v217, s37, v217
    v_mfma_f32_16x16x32_bf16 v[220:223], a[12:15], a[252:255], v[220:223]
    v_mul_f32 v218, s37, v218
    v_mul_f32 v219, s37, v219
    v_mfma_f32_16x16x32_bf16 v[220:223], a[24:27], a[236:239], v[220:223]
    v_cvt_pk_bf16_f32 v140, v216, v217
    v_cvt_pk_bf16_f32 v141, v218, v219
    v_mfma_f32_16x16x32_bf16 v[216:219], a[4:7], a[248:251], 0
    v_mul_f32 v212, s37, v212
    v_mul_f32 v213, s37, v213
    v_mfma_f32_16x16x32_bf16 v[152:155], v[24:27], v[138:141], v[152:155]
    v_mul_f32 v214, s37, v214
    v_mul_f32 v215, s37, v215
    v_mfma_f32_16x16x32_bf16 v[156:159], v[30:33], v[138:141], v[156:159]
    v_cvt_pk_bf16_f32 v142, v212, v213
    v_cvt_pk_bf16_f32 v143, v214, v215
    v_mfma_f32_16x16x32_bf16 v[144:147], v[36:39], v[138:141], v[144:147]
    v_mul_f32 v187, v187, v197
    v_cvt_pk_bf16_f32 v185, v186, v187
    v_mfma_f32_16x16x16_bf16 v[152:155], v[28:29], v[142:143], v[152:155]
    v_mul_f32 v188, v188, v197
    v_mul_f32 v189, v189, v197
    v_mfma_f32_16x16x16_bf16 v[156:159], v[34:35], v[142:143], v[156:159]
    v_cvt_pk_bf16_f32 v186, v188, v189
    v_mul_f32 v190, v190, v197
    v_mfma_f32_16x16x16_bf16 v[144:147], v[40:41], v[142:143], v[144:147]
    s_waitcnt lgkmcnt(0)
    v_mul_f32 v191, v191, v197
    v_cvt_pk_bf16_f32 v187, v190, v191
    v_mfma_f32_16x16x32_bf16 v[148:151], v[42:45], v[138:141], v[148:151]
    v_mul_f32 v192, v192, v197
    v_mul_f32 v193, v193, v197
    v_mfma_f32_16x16x32_bf16 v[212:215], a[8:11], a[248:251], 0
    ds_read_b128 a[248:251], v227 offset:6400
    v_cvt_pk_bf16_f32 v188, v192, v193
    v_mfma_f32_16x16x32_bf16 v[216:219], a[16:19], a[252:255], v[216:219]
    v_mul_f32 v194, v194, v197
    v_mul_f32 v195, v195, v197
    v_mfma_f32_16x16x16_bf16 v[148:151], v[46:47], v[142:143], v[148:151]
    v_cvt_pk_bf16_f32 v189, v194, v195
    v_max3_f32 v236, v236, v196, v197
    v_mfma_f32_16x16x32_bf16 v[212:215], a[20:23], a[252:255], v[212:215]
    ds_read_b128 a[252:255], v227 offset:6464
    ds_read_b128 v[252:255], v240 offset:1024
    v_mfma_f32_16x16x32_bf16 v[216:219], a[28:31], a[236:239], v[216:219]
    ds_write_b128 v237, v[184:187] offset:12288
    v_mfma_f32_16x16x32_bf16 v[212:215], a[32:35], a[236:239], v[212:215]
    ds_read_b128 a[236:239], v227 offset:6144
    ds_read_b64_tr_b16 v[248:249], v242 offset:12288
    v_mfma_f32_16x16x32_bf16 v[220:223], a[36:39], a[240:243], v[220:223]
    v_exp_f32 v152, v152
    v_mfma_f32_16x16x32_bf16 v[216:219], a[40:43], a[240:243], v[216:219]
    ds_write_b64 v238, v[188:189] offset:12288
    v_mfma_f32_16x16x32_bf16 v[212:215], a[44:47], a[240:243], v[212:215]
    s_waitcnt lgkmcnt(6)
    ds_read_b128 a[240:243], v227 offset:6208
    ds_read_b64_tr_b16 v[250:251], v242 offset:26112
    v_mfma_f32_16x16x32_bf16 v[220:223], a[48:51], a[248:251], v[220:223]
    v_exp_f32 v153, v153
    v_mfma_f32_16x16x32_bf16 v[216:219], a[52:55], a[248:251], v[216:219]
    v_exp_f32 v154, v154
    v_mfma_f32_16x16x32_bf16 v[212:215], a[56:59], a[248:251], v[212:215]
    s_waitcnt lgkmcnt(7)
    ds_read_b128 a[248:251], v227 offset:6272
    v_cvt_pk_bf16_f32 v160, v152, v153
    v_mfma_f32_16x16x32_bf16 v[220:223], a[60:63], a[252:255], v[220:223]
    v_exp_f32 v155, v155
    v_mfma_f32_16x16x32_bf16 v[216:219], a[64:67], a[252:255], v[216:219]
    v_cvt_pk_bf16_f32 v161, v154, v155
    v_mfma_f32_16x16x32_bf16 v[212:215], a[68:71], a[252:255], v[212:215]
    ds_read_b128 a[252:255], v227 offset:6336
    ds_read_b128 v[152:155], v235
    v_mfma_f32_16x16x32_bf16 v[176:179], a[228:231], a[244:247], 0
    v_bfe_u32 v235, s68, v233, 4
    v_cvt_pk_bf16_f32 v60, v220, v221
    v_mfma_f32_16x16x32_bf16 v[172:175], a[232:235], a[244:247], 0
    s_waitcnt lgkmcnt(7)
    v_cvt_pk_bf16_f32 v61, v222, v223
    v_cvt_pk_bf16_f32 v62, v216, v217
    v_mfma_f32_16x16x32_bf16 v[220:223], a[236:239], a[72:75], 0
    v_cvt_pk_bf16_f32 v63, v218, v219
    v_cvt_pk_bf16_f32 v64, v212, v213
    v_mfma_f32_16x16x32_bf16 v[216:219], a[236:239], a[76:79], 0
    v_cvt_pk_bf16_f32 v65, v214, v215
    v_mad_u32_u24 v235, v235, s40, v231
    v_mfma_f32_16x16x32_bf16 v[212:215], a[236:239], a[80:83], 0
    s_waitcnt lgkmcnt(4)
    ds_read_b128 a[236:239], v227 offset:6400
    ds_read_b128 a[244:247], v239 offset:1024
    v_mfma_f32_16x16x32_bf16 v[220:223], a[240:243], a[84:87], v[220:223]
    v_exp_f32 v156, v156
    v_mfma_f32_16x16x32_bf16 v[216:219], a[240:243], a[88:91], v[216:219]
    v_exp_f32 v157, v157
    v_mfma_f32_16x16x32_bf16 v[212:215], a[240:243], a[92:95], v[212:215]
    s_waitcnt lgkmcnt(4)
    ds_read_b128 a[240:243], v227 offset:6464
    v_cvt_pk_bf16_f32 v162, v156, v157
    v_mfma_f32_16x16x32_bf16 v[220:223], a[248:251], a[96:99], v[220:223]
    v_exp_f32 v158, v158
    v_mfma_f32_16x16x32_bf16 v[216:219], a[248:251], a[100:103], v[216:219]
    s_waitcnt lgkmcnt(3)
    v_exp_f32 v159, v159
    v_mfma_f32_16x16x32_bf16 v[152:155], v[48:51], v[138:141], v[152:155]
    v_cvt_pk_bf16_f32 v163, v158, v159
    v_mfma_f32_16x16x32_bf16 v[212:215], a[248:251], a[104:107], v[212:215]
    ds_read_b128 a[248:251], v226 offset:1152
    ds_read_b128 v[156:159], v234
    v_mfma_f32_16x16x32_bf16 v[196:199], a[216:219], v[160:163], 0
    v_bfe_u32 v234, s69, v233, 4
    v_mad_u32_u24 v234, v234, s40, v231
    v_mfma_f32_16x16x32_bf16 v[184:187], v[68:71], v[160:163], 0
    v_exp_f32 v144, v144
    v_mfma_f32_16x16x32_bf16 v[188:191], v[90:93], v[160:163], 0
    v_exp_f32 v145, v145
    v_mfma_f32_16x16x32_bf16 v[192:195], v[112:115], v[160:163], 0
    v_exp_f32 v146, v146
    v_mfma_f32_16x16x16_bf16 v[152:155], v[52:53], v[142:143], v[152:155]
    v_exp_f32 v147, v147
    v_mfma_f32_16x16x32_bf16 v[220:223], a[252:255], a[108:111], v[220:223]
    v_cvt_pk_bf16_f32 v160, v144, v145
    v_cvt_pk_bf16_f32 v161, v146, v147
    v_mfma_f32_16x16x32_bf16 v[216:219], a[252:255], a[112:115], v[216:219]
    ds_read_b128 v[144:147], v235
    v_bfe_u32 v235, s70, v233, 4
    v_mfma_f32_16x16x32_bf16 v[212:215], a[252:255], a[116:119], v[212:215]
    s_waitcnt lgkmcnt(3)
    ds_read_b128 a[252:255], v226 offset:1216
    v_mad_u32_u24 v235, v235, s40, v231
    v_mfma_f32_16x16x32_bf16 v[220:223], a[236:239], a[120:123], v[220:223]
    v_exp_f32 v148, v148
    v_mfma_f32_16x16x32_bf16 v[216:219], a[236:239], a[124:127], v[216:219]
    s_waitcnt lgkmcnt(2)
    v_exp_f32 v149, v149
    v_mfma_f32_16x16x32_bf16 v[156:159], v[54:57], v[138:141], v[156:159]
    v_exp_f32 v150, v150
    v_mfma_f32_16x16x32_bf16 v[212:215], a[236:239], a[128:131], v[212:215]
    ds_read_b128 a[236:239], v226 offset:1280
    v_cvt_pk_bf16_f32 v162, v148, v149
    v_mfma_f32_16x16x32_bf16 v[220:223], a[240:243], a[132:135], v[220:223]
    v_exp_f32 v151, v151
    v_mfma_f32_16x16x16_bf16 v[156:159], v[58:59], v[142:143], v[156:159]
    v_cvt_pk_bf16_f32 v163, v150, v151
    v_mfma_f32_16x16x32_bf16 v[216:219], a[240:243], a[136:139], v[216:219]
    ds_read_b128 v[148:151], v228 offset:640
    v_mfma_f32_16x16x32_bf16 v[196:199], a[216:219], v[160:163], v[196:199]
    v_exp_f32 v152, v152
    v_mfma_f32_16x16x32_bf16 v[184:187], v[76:79], v[160:163], v[184:187]
    v_cvt_pk_bf16_f32 v86, v220, v221
    v_cvt_pk_bf16_f32 v87, v222, v223
    v_mfma_f32_16x16x32_bf16 v[188:191], v[98:101], v[160:163], v[188:191]
    v_exp_f32 v153, v153
    v_mfma_f32_16x16x32_bf16 v[192:195], v[120:123], v[160:163], v[192:195]
    s_waitcnt lgkmcnt(2)
    v_cvt_pk_bf16_f32 v108, v216, v217
    v_cvt_pk_bf16_f32 v109, v218, v219
    v_mfma_f32_16x16x32_bf16 v[144:147], v[60:63], v[138:141], v[144:147]
    v_exp_f32 v154, v154
    v_mfma_f32_16x16x32_bf16 v[212:215], a[240:243], a[140:143], v[212:215]
    ds_read_b128 a[240:243], v226 offset:1344
    v_cvt_pk_bf16_f32 v160, v152, v153
    v_mfma_f32_16x16x32_bf16 v[220:223], a[144:147], a[248:251], 0
    v_exp_f32 v155, v155
    v_mfma_f32_16x16x16_bf16 v[144:147], v[64:65], v[142:143], v[144:147]
    v_cvt_pk_bf16_f32 v161, v154, v155
    v_mfma_f32_16x16x32_bf16 v[216:219], a[148:151], a[248:251], 0
    ds_read_b128 v[152:155], v229 offset:640
    v_cvt_pk_bf16_f32 v130, v212, v213
    v_mfma_f32_16x16x32_bf16 v[220:223], a[156:159], a[252:255], v[220:223]
    v_cvt_pk_bf16_f32 v131, v214, v215
    v_mfma_f32_16x16x32_bf16 v[212:215], a[152:155], a[248:251], 0
    ds_read_b128 a[248:251], v226 offset:1408
    v_mfma_f32_16x16x32_bf16 v[216:219], a[160:163], a[252:255], v[216:219]
    v_exp_f32 v156, v156
    v_mfma_f32_16x16x32_bf16 v[212:215], a[164:167], a[252:255], v[212:215]
    s_waitcnt lgkmcnt(3)
    ds_read_b128 a[252:255], v226 offset:1472
    v_mfma_f32_16x16x32_bf16 v[220:223], a[168:171], a[236:239], v[220:223]
    v_exp_f32 v157, v157
    v_mfma_f32_16x16x32_bf16 v[216:219], a[172:175], a[236:239], v[216:219]
    v_exp_f32 v158, v158
    v_mfma_f32_16x16x32_bf16 v[212:215], a[176:179], a[236:239], v[212:215]
    s_waitcnt lgkmcnt(3)
    ds_read_b128 a[236:239], v224 offset:15488
    v_cvt_pk_bf16_f32 v162, v156, v157
    v_mfma_f32_16x16x32_bf16 v[220:223], a[180:183], a[240:243], v[220:223]
    v_exp_f32 v159, v159
    v_mfma_f32_16x16x32_bf16 v[216:219], a[184:187], a[240:243], v[216:219]
    v_cvt_pk_bf16_f32 v163, v158, v159
    v_mfma_f32_16x16x32_bf16 v[212:215], a[188:191], a[240:243], v[212:215]
    ds_read_b128 a[240:243], v224 offset:15552
    ds_read_b128 v[156:159], v229 offset:1280
    v_mfma_f32_16x16x32_bf16 v[196:199], a[216:219], v[160:163], v[196:199]
    v_exp_f32 v144, v144
    v_mfma_f32_16x16x32_bf16 v[184:187], v[82:85], v[160:163], v[184:187]
    v_exp_f32 v145, v145
    v_mfma_f32_16x16x32_bf16 v[188:191], v[104:107], v[160:163], v[188:191]
    v_exp_f32 v146, v146
    v_mfma_f32_16x16x32_bf16 v[192:195], v[126:129], v[160:163], v[192:195]
    s_waitcnt lgkmcnt(3)
    v_exp_f32 v147, v147
    v_mfma_f32_16x16x32_bf16 v[220:223], a[192:195], a[248:251], v[220:223]
    v_cvt_pk_bf16_f32 v160, v144, v145
    v_cvt_pk_bf16_f32 v161, v146, v147
    v_mfma_f32_16x16x32_bf16 v[216:219], a[196:199], a[248:251], v[216:219]
    ds_read_b128 v[144:147], v228 offset:1280
    v_mfma_f32_16x16x16_bf16 v[196:199], a[216:217], v[160:161], v[196:199]
    v_mfma_f32_16x16x16_bf16 v[184:187], v[86:87], v[160:161], v[184:187]
    v_mfma_f32_16x16x16_bf16 v[188:191], v[108:109], v[160:161], v[188:191]
    v_mfma_f32_16x16x16_bf16 v[192:195], v[130:131], v[160:161], v[192:195]
    v_mfma_f32_16x16x32_bf16 v[212:215], a[200:203], a[248:251], v[212:215]
    ds_read_b128 a[248:251], v224 offset:15616
    v_mfma_f32_16x16x32_bf16 v[220:223], a[204:207], a[252:255], v[220:223]
    v_mfma_f32_16x16x32_bf16 v[216:219], a[208:211], a[252:255], v[216:219]
    v_mfma_f32_16x16x32_bf16 v[212:215], a[212:215], a[252:255], v[212:215]
    ds_read_b128 a[252:255], v224 offset:15680
    v_mfma_f32_16x16x32_bf16 v[208:211], v[164:167], a[244:247], v[208:211]
    v_rcp_f32 v197, v196
    v_mfma_f32_16x16x32_bf16 v[200:203], v[164:167], v[252:255], v[200:203]
    v_mul_f32 v184, v184, v197
    v_mul_f32 v185, v185, v197
    v_mfma_f32_16x16x32_bf16 v[204:207], v[168:171], a[244:247], v[204:207]
    v_mul_f32 v220, s37, v220
    v_mul_f32 v221, s37, v221
    v_mfma_f32_16x16x32_bf16 v[180:183], v[168:171], v[252:255], v[180:183]
    v_mul_f32 v222, s37, v222
    v_mul_f32 v223, s37, v223
    v_mfma_f32_16x16x32_bf16 v[176:179], v[248:251], a[244:247], v[176:179]
    s_waitcnt lgkmcnt(2)
    v_cvt_pk_bf16_f32 v132, v220, v221
    v_cvt_pk_bf16_f32 v133, v222, v223
    v_mfma_f32_16x16x32_bf16 v[220:223], a[0:3], a[236:239], 0
    v_mul_f32 v216, s37, v216
    v_mul_f32 v217, s37, v217
    v_mfma_f32_16x16x32_bf16 v[220:223], a[12:15], a[240:243], v[220:223]
    s_waitcnt lgkmcnt(1)
    v_mul_f32 v218, s37, v218
    v_mul_f32 v219, s37, v219
    v_mfma_f32_16x16x32_bf16 v[220:223], a[24:27], a[248:251], v[220:223]
    v_cvt_pk_bf16_f32 v134, v216, v217
    v_cvt_pk_bf16_f32 v135, v218, v219
    v_mfma_f32_16x16x32_bf16 v[216:219], a[4:7], a[236:239], 0
    v_mul_f32 v212, s37, v212
    v_mul_f32 v213, s37, v213
    v_mfma_f32_16x16x32_bf16 v[148:151], v[12:15], v[132:135], v[148:151]
    v_mul_f32 v214, s37, v214
    v_mul_f32 v215, s37, v215
    v_mfma_f32_16x16x32_bf16 v[152:155], v[36:39], v[132:135], v[152:155]
    v_cvt_pk_bf16_f32 v136, v212, v213
    v_cvt_pk_bf16_f32 v137, v214, v215
    v_mfma_f32_16x16x32_bf16 v[156:159], v[42:45], v[132:135], v[156:159]
    v_cvt_pk_bf16_f32 v184, v184, v185
    v_mul_f32 v186, v186, v197
    v_mfma_f32_16x16x16_bf16 v[148:151], v[16:17], v[136:137], v[148:151]
    v_mul_f32 v187, v187, v197
    v_cvt_pk_bf16_f32 v185, v186, v187
    v_mfma_f32_16x16x16_bf16 v[152:155], v[40:41], v[136:137], v[152:155]
    v_mul_f32 v188, v188, v197
    v_mul_f32 v189, v189, v197
    v_mfma_f32_16x16x16_bf16 v[156:159], v[46:47], v[136:137], v[156:159]
    v_cvt_pk_bf16_f32 v186, v188, v189
    v_mul_f32 v190, v190, v197
    v_mfma_f32_16x16x32_bf16 v[144:147], v[18:21], v[132:135], v[144:147]
    v_mul_f32 v191, v191, v197
    v_cvt_pk_bf16_f32 v187, v190, v191
    v_mfma_f32_16x16x32_bf16 v[212:215], a[8:11], a[236:239], 0
    ds_read_b128 a[236:239], v224 offset:15744
    v_mul_f32 v192, v192, v197
    v_mfma_f32_16x16x32_bf16 v[216:219], a[16:19], a[240:243], v[216:219]
    v_mul_f32 v193, v193, v197
    v_cvt_pk_bf16_f32 v188, v192, v193
    v_mfma_f32_16x16x16_bf16 v[144:147], v[22:23], v[136:137], v[144:147]
    v_mul_f32 v194, v194, v197
    v_mul_f32 v195, v195, v197
    v_mfma_f32_16x16x32_bf16 v[212:215], a[20:23], a[240:243], v[212:215]
    ds_read_b128 a[240:243], v224 offset:15808
    v_cvt_pk_bf16_f32 v189, v194, v195
    v_mfma_f32_16x16x32_bf16 v[216:219], a[28:31], a[248:251], v[216:219]
    ds_read_b64_tr_b16 v[164:165], v242 offset:12296
    v_max3_f32 v236, v236, v196, v197
    v_mfma_f32_16x16x32_bf16 v[212:215], a[32:35], a[248:251], v[212:215]
    s_waitcnt lgkmcnt(3)
    ds_read_b128 a[248:251], v224 offset:15488
    ds_read_b64_tr_b16 v[166:167], v242 offset:26120
    v_mfma_f32_16x16x32_bf16 v[220:223], a[36:39], a[252:255], v[220:223]
    ds_write_b128 v237, v[184:187] offset:18432
    v_mfma_f32_16x16x32_bf16 v[216:219], a[40:43], a[252:255], v[216:219]
    ds_write_b64 v238, v[188:189] offset:18432
    v_mfma_f32_16x16x32_bf16 v[212:215], a[44:47], a[252:255], v[212:215]
    s_waitcnt lgkmcnt(6)
    ds_read_b128 a[252:255], v224 offset:15552
    ds_read_b128 v[252:255], v240 offset:2048
    v_mfma_f32_16x16x32_bf16 v[220:223], a[48:51], a[236:239], v[220:223]
    ds_read_b64_tr_b16 v[168:169], v241 offset:13824
    v_mfma_f32_16x16x32_bf16 v[216:219], a[52:55], a[236:239], v[216:219]
    ds_read_b64_tr_b16 v[170:171], v241 offset:24576
    v_mfma_f32_16x16x32_bf16 v[212:215], a[56:59], a[236:239], v[212:215]
    s_waitcnt lgkmcnt(9)
    ds_read_b128 a[236:239], v224 offset:15616
    v_mfma_f32_16x16x32_bf16 v[220:223], a[60:63], a[240:243], v[220:223]
    ds_read_b64_tr_b16 v[248:249], v241 offset:13832
    v_mfma_f32_16x16x32_bf16 v[216:219], a[64:67], a[240:243], v[216:219]
    s_waitcnt lgkmcnt(8)
    ds_read_b64_tr_b16 v[250:251], v241 offset:24584
    v_mfma_f32_16x16x32_bf16 v[172:175], v[164:167], a[244:247], v[172:175]
    ds_read_b128 a[244:247], v239 offset:2048
    v_mfma_f32_16x16x32_bf16 v[212:215], a[68:71], a[240:243], v[212:215]
    ds_read_b128 a[240:243], v224 offset:15680
    v_exp_f32 v148, v148
    v_cvt_pk_bf16_f32 v6, v220, v221
    v_cvt_pk_bf16_f32 v7, v222, v223
    v_mfma_f32_16x16x32_bf16 v[220:223], a[248:251], a[72:75], 0
    v_cvt_pk_bf16_f32 v8, v216, v217
    v_cvt_pk_bf16_f32 v9, v218, v219
    v_mfma_f32_16x16x32_bf16 v[216:219], a[248:251], a[76:79], 0
    v_cvt_pk_bf16_f32 v10, v212, v213
    v_cvt_pk_bf16_f32 v11, v214, v215
    v_mfma_f32_16x16x32_bf16 v[212:215], a[248:251], a[80:83], 0
    s_waitcnt lgkmcnt(8)
    ds_read_b128 a[248:251], v224 offset:15744
    ds_read_b64_tr_b16 v[164:165], v242 offset:13824
    v_mfma_f32_16x16x32_bf16 v[220:223], a[252:255], a[84:87], v[220:223]
    s_waitcnt lgkmcnt(7)
    ds_read_b64_tr_b16 v[166:167], v242 offset:24576
    v_mfma_f32_16x16x32_bf16 v[200:203], v[168:171], v[252:255], v[200:203]
    v_exp_f32 v149, v149
    v_mfma_f32_16x16x32_bf16 v[216:219], a[252:255], a[88:91], v[216:219]
    v_exp_f32 v150, v150
    v_mfma_f32_16x16x32_bf16 v[212:215], a[252:255], a[92:95], v[212:215]
    s_waitcnt lgkmcnt(5)
    ds_read_b128 a[252:255], v224 offset:15808
    v_cvt_pk_bf16_f32 v160, v148, v149
    v_mfma_f32_16x16x32_bf16 v[180:183], v[248:251], v[252:255], v[180:183]
    s_waitcnt lgkmcnt(5)
    ds_read_b128 v[252:255], v240 offset:3072
    v_mfma_f32_16x16x32_bf16 v[208:211], v[168:171], a[244:247], v[208:211]
    ds_read_b64_tr_b16 v[168:169], v242 offset:13832
    ds_read_b64_tr_b16 v[170:171], v242 offset:24584
    v_mfma_f32_16x16x32_bf16 v[204:207], v[248:251], a[244:247], v[204:207]
    ds_read_b64_tr_b16 v[248:249], v241 offset:36864
    ds_read_b64_tr_b16 v[250:251], v241 offset:38400
    v_mfma_f32_16x16x32_bf16 v[220:223], a[236:239], a[96:99], v[220:223]
    v_exp_f32 v151, v151
    v_mfma_f32_16x16x32_bf16 v[216:219], a[236:239], a[100:103], v[216:219]
    v_cvt_pk_bf16_f32 v161, v150, v151
    v_mfma_f32_16x16x32_bf16 v[212:215], a[236:239], a[104:107], v[212:215]
    s_waitcnt lgkmcnt(6)
    ds_read_b128 a[236:239], v224 offset:18560
    ds_read_b128 v[148:151], v228 offset:1920
    v_mfma_f32_16x16x32_bf16 v[176:179], v[164:167], a[244:247], v[176:179]
    ds_read_b64_tr_b16 v[164:165], v241 offset:36872
    v_mfma_f32_16x16x32_bf16 v[220:223], a[240:243], a[108:111], v[220:223]
    ds_read_b64_tr_b16 v[166:167], v241 offset:38408
    v_mfma_f32_16x16x32_bf16 v[216:219], a[240:243], a[112:115], v[216:219]
    v_exp_f32 v152, v152
    v_mfma_f32_16x16x32_bf16 v[212:215], a[240:243], a[116:119], v[212:215]
    ds_read_b128 a[240:243], v224 offset:18624
    v_mfma_f32_16x16x32_bf16 v[220:223], a[248:251], a[120:123], v[220:223]
    s_waitcnt lgkmcnt(7)
    v_exp_f32 v153, v153
    v_mfma_f32_16x16x32_bf16 v[172:175], v[168:171], a[244:247], v[172:175]
    ds_read_b128 a[244:247], v239 offset:3072
    ds_read_b64_tr_b16 v[168:169], v242 offset:36864
    v_mfma_f32_16x16x32_bf16 v[216:219], a[248:251], a[124:127], v[216:219]
    ds_read_b64_tr_b16 v[170:171], v242 offset:38400
    v_cvt_pk_bf16_f32 v162, v152, v153
    v_mfma_f32_16x16x32_bf16 v[212:215], a[248:251], a[128:131], v[212:215]
    ds_read_b128 a[248:251], v224 offset:18688
    v_mfma_f32_16x16x32_bf16 v[220:223], a[252:255], a[132:135], v[220:223]
    v_exp_f32 v154, v154
    v_mfma_f32_16x16x32_bf16 v[216:219], a[252:255], a[136:139], v[216:219]
    s_waitcnt lgkmcnt(7)
    v_exp_f32 v155, v155
    v_mfma_f32_16x16x32_bf16 v[148:151], v[0:3], v[132:135], v[148:151]
    v_cvt_pk_bf16_f32 v163, v154, v155
    v_mfma_f32_16x16x32_bf16 v[212:215], a[252:255], a[140:143], v[212:215]
    ds_read_b128 a[252:255], v224 offset:18752
    ds_read_b128 v[152:155], v229 offset:1920
    v_mfma_f32_16x16x32_bf16 v[196:199], a[216:219], v[160:163], 0
    v_cvt_pk_bf16_f32 v72, v220, v221
    v_cvt_pk_bf16_f32 v73, v222, v223
    v_mfma_f32_16x16x32_bf16 v[184:187], v[74:77], v[160:163], 0
    v_cvt_pk_bf16_f32 v94, v216, v217
    v_cvt_pk_bf16_f32 v95, v218, v219
    v_mfma_f32_16x16x32_bf16 v[188:191], v[96:99], v[160:163], 0
    v_cvt_pk_bf16_f32 v116, v212, v213
    v_cvt_pk_bf16_f32 v117, v214, v215
    v_mfma_f32_16x16x32_bf16 v[192:195], v[118:121], v[160:163], 0
    v_exp_f32 v156, v156
    v_mfma_f32_16x16x16_bf16 v[148:151], v[4:5], v[136:137], v[148:151]
    s_waitcnt lgkmcnt(4)
    v_exp_f32 v157, v157
    v_mfma_f32_16x16x32_bf16 v[208:211], v[248:251], a[244:247], v[208:211]
    v_exp_f32 v158, v158
    v_mfma_f32_16x16x32_bf16 v[200:203], v[248:251], v[252:255], v[200:203]
    ds_read_b64_tr_b16 v[248:249], v242 offset:36872
    ds_read_b64_tr_b16 v[250:251], v242 offset:38408
    v_mfma_f32_16x16x32_bf16 v[204:207], v[164:167], a[244:247], v[204:207]
    v_exp_f32 v159, v159
    v_mfma_f32_16x16x32_bf16 v[180:183], v[164:167], v[252:255], v[180:183]
    s_waitcnt lgkmcnt(4)
    ds_read_b128 v[252:255], v240 offset:4096
    ds_read_b64_tr_b16 v[164:165], v241 offset:49152
    v_mfma_f32_16x16x32_bf16 v[176:179], v[168:171], a[244:247], v[176:179]
    s_waitcnt lgkmcnt(4)
    ds_read_b64_tr_b16 v[166:167], v241 offset:62976
    ds_read_b64_tr_b16 v[168:169], v241 offset:49160
    v_mfma_f32_16x16x32_bf16 v[152:155], v[24:27], v[132:135], v[152:155]
    ds_read_b64_tr_b16 v[170:171], v241 offset:62984
    v_cvt_pk_bf16_f32 v160, v156, v157
    v_mfma_f32_16x16x32_bf16 v[220:223], a[0:3], a[236:239], 0
    v_cvt_pk_bf16_f32 v161, v158, v159
    v_mfma_f32_16x16x32_bf16 v[216:219], a[4:7], a[236:239], 0
    ds_read_b128 v[156:159], v229 offset:2560
    v_mfma_f32_16x16x16_bf16 v[152:155], v[28:29], v[136:137], v[152:155]
    v_exp_f32 v144, v144
    v_mfma_f32_16x16x32_bf16 v[212:215], a[8:11], a[236:239], 0
    ds_read_b128 a[236:239], v224 offset:18816
    v_mfma_f32_16x16x32_bf16 v[220:223], a[12:15], a[240:243], v[220:223]
    s_waitcnt lgkmcnt(7)
    v_exp_f32 v145, v145
    v_mfma_f32_16x16x32_bf16 v[172:175], v[248:251], a[244:247], v[172:175]
    ds_read_b128 a[244:247], v239 offset:4096
    ds_read_b64_tr_b16 v[248:249], v242 offset:49152
    v_mfma_f32_16x16x32_bf16 v[216:219], a[16:19], a[240:243], v[216:219]
    ds_read_b64_tr_b16 v[250:251], v242 offset:62976
    v_cvt_pk_bf16_f32 v162, v144, v145
    v_mfma_f32_16x16x32_bf16 v[212:215], a[20:23], a[240:243], v[212:215]
    ds_read_b128 a[240:243], v224 offset:18880
    v_mfma_f32_16x16x32_bf16 v[220:223], a[24:27], a[248:251], v[220:223]
    v_exp_f32 v146, v146
    v_mfma_f32_16x16x32_bf16 v[216:219], a[28:31], a[248:251], v[216:219]
    v_exp_f32 v147, v147
    v_mfma_f32_16x16x32_bf16 v[212:215], a[32:35], a[248:251], v[212:215]
    ds_read_b128 a[248:251], v224 offset:18560
    v_cvt_pk_bf16_f32 v163, v146, v147
    v_mfma_f32_16x16x32_bf16 v[220:223], a[36:39], a[252:255], v[220:223]
    ds_read_b128 v[144:147], v228 offset:2560
    v_mfma_f32_16x16x32_bf16 v[196:199], a[216:219], v[160:163], v[196:199]
    v_exp_f32 v148, v148
    v_mfma_f32_16x16x32_bf16 v[184:187], v[78:81], v[160:163], v[184:187]
    v_exp_f32 v149, v149
    v_mfma_f32_16x16x32_bf16 v[188:191], v[100:103], v[160:163], v[188:191]
    v_exp_f32 v150, v150
    v_mfma_f32_16x16x32_bf16 v[192:195], v[122:125], v[160:163], v[192:195]
    v_exp_f32 v151, v151
    v_mfma_f32_16x16x32_bf16 v[216:219], a[40:43], a[252:255], v[216:219]
    v_cvt_pk_bf16_f32 v160, v148, v149
    v_cvt_pk_bf16_f32 v161, v150, v151
    v_mfma_f32_16x16x32_bf16 v[212:215], a[44:47], a[252:255], v[212:215]
    s_waitcnt lgkmcnt(3)
    ds_read_b128 a[252:255], v224 offset:18624
    ds_read_b128 v[148:151], v230 offset:640
    v_mfma_f32_16x16x32_bf16 v[220:223], a[48:51], a[236:239], v[220:223]
    v_exp_f32 v152, v152
    v_mfma_f32_16x16x32_bf16 v[216:219], a[52:55], a[236:239], v[216:219]
    v_exp_f32 v153, v153
    v_mfma_f32_16x16x32_bf16 v[212:215], a[56:59], a[236:239], v[212:215]
    s_waitcnt lgkmcnt(2)
    ds_read_b128 a[236:239], v224 offset:18688
    v_cvt_pk_bf16_f32 v162, v152, v153
    v_mfma_f32_16x16x32_bf16 v[144:147], v[6:9], v[132:135], v[144:147]
    v_exp_f32 v154, v154
    v_mfma_f32_16x16x32_bf16 v[220:223], a[60:63], a[240:243], v[220:223]
    v_exp_f32 v155, v155
    v_mfma_f32_16x16x32_bf16 v[216:219], a[64:67], a[240:243], v[216:219]
    v_cvt_pk_bf16_f32 v163, v154, v155
    v_mfma_f32_16x16x32_bf16 v[212:215], a[68:71], a[240:243], v[212:215]
    ds_read_b128 a[240:243], v224 offset:18752
    ds_read_b128 v[152:155], v230 offset:1280
    v_mfma_f32_16x16x32_bf16 v[196:199], a[216:219], v[160:163], v[196:199]
    v_mfma_f32_16x16x32_bf16 v[184:187], v[66:69], v[160:163], v[184:187]
    v_cvt_pk_bf16_f32 v30, v220, v221
    v_cvt_pk_bf16_f32 v31, v222, v223
    v_mfma_f32_16x16x32_bf16 v[188:191], v[88:91], v[160:163], v[188:191]
    v_cvt_pk_bf16_f32 v32, v216, v217
    v_cvt_pk_bf16_f32 v33, v218, v219
    v_mfma_f32_16x16x32_bf16 v[192:195], v[110:113], v[160:163], v[192:195]
    v_cvt_pk_bf16_f32 v34, v212, v213
    v_cvt_pk_bf16_f32 v35, v214, v215
    v_mfma_f32_16x16x32_bf16 v[156:159], v[30:33], v[132:135], v[156:159]
    v_mfma_f32_16x16x16_bf16 v[144:147], v[10:11], v[136:137], v[144:147]
    v_mfma_f32_16x16x32_bf16 v[208:211], v[164:167], a[244:247], v[208:211]
    v_mfma_f32_16x16x32_bf16 v[200:203], v[164:167], v[252:255], v[200:203]
    ds_read_b64_tr_b16 v[164:165], v242 offset:49160
    ds_read_b64_tr_b16 v[166:167], v242 offset:62984
    v_mfma_f32_16x16x32_bf16 v[204:207], v[168:171], a[244:247], v[204:207]
    v_mfma_f32_16x16x16_bf16 v[156:159], v[34:35], v[136:137], v[156:159]
    v_mfma_f32_16x16x32_bf16 v[180:183], v[168:171], v[252:255], v[180:183]
    ds_read_b128 v[252:255], v240 offset:5120
    ds_read_b64_tr_b16 v[168:169], v241 offset:50688
    v_mfma_f32_16x16x32_bf16 v[176:179], v[248:251], a[244:247], v[176:179]
L_pg4:
    s_cbranch_execz L_pg8
    ds_read_b64_tr_b16 v[170:171], v241 offset:61440
    ds_read_b64_tr_b16 v[248:249], v241 offset:50696
    v_mfma_f32_16x16x32_bf16 v[220:223], a[248:251], a[72:75], 0
    ds_read_b64_tr_b16 v[250:251], v241 offset:61448
    v_mfma_f32_16x16x32_bf16 v[216:219], a[248:251], a[76:79], 0
    v_exp_f32 v156, v156
    v_mfma_f32_16x16x32_bf16 v[212:215], a[248:251], a[80:83], 0
    s_waitcnt lgkmcnt(7)
    ds_read_b128 a[248:251], v224 offset:18816
    v_mfma_f32_16x16x32_bf16 v[220:223], a[252:255], a[84:87], v[220:223]
    v_exp_f32 v157, v157
    v_mfma_f32_16x16x32_bf16 v[216:219], a[252:255], a[88:91], v[216:219]
    s_waitcnt lgkmcnt(6)
    v_exp_f32 v158, v158
    v_mfma_f32_16x16x32_bf16 v[172:175], v[164:167], a[244:247], v[172:175]
    ds_read_b128 a[244:247], v239 offset:5120
    ds_read_b64_tr_b16 v[164:165], v242 offset:50688
    v_mfma_f32_16x16x32_bf16 v[212:215], a[252:255], a[92:95], v[212:215]
    ds_read_b128 a[252:255], v224 offset:18880
    ds_read_b64_tr_b16 v[166:167], v242 offset:61440
    v_mfma_f32_16x16x32_bf16 v[220:223], a[236:239], a[96:99], v[220:223]
    v_exp_f32 v159, v159
    v_mfma_f32_16x16x32_bf16 v[216:219], a[236:239], a[100:103], v[216:219]
    v_cvt_pk_bf16_f32 v160, v156, v157
    v_cvt_pk_bf16_f32 v161, v158, v159
    v_mfma_f32_16x16x32_bf16 v[212:215], a[236:239], a[104:107], v[212:215]
    ds_read_b128 a[236:239], v226 offset:4224
    ds_read_b128 v[156:159], v230 offset:1920
    v_mfma_f32_16x16x32_bf16 v[220:223], a[240:243], a[108:111], v[220:223]
    v_exp_f32 v144, v144
    v_mfma_f32_16x16x32_bf16 v[216:219], a[240:243], a[112:115], v[216:219]
    v_exp_f32 v145, v145
    v_mfma_f32_16x16x32_bf16 v[212:215], a[240:243], a[116:119], v[212:215]
    s_waitcnt lgkmcnt(6)
    ds_read_b128 a[240:243], v226 offset:4288
    v_cvt_pk_bf16_f32 v162, v144, v145
    v_mfma_f32_16x16x32_bf16 v[220:223], a[248:251], a[120:123], v[220:223]
    v_exp_f32 v146, v146
    v_mfma_f32_16x16x32_bf16 v[216:219], a[248:251], a[124:127], v[216:219]
    v_exp_f32 v147, v147
    v_mfma_f32_16x16x32_bf16 v[212:215], a[248:251], a[128:131], v[212:215]
    s_waitcnt lgkmcnt(4)
    ds_read_b128 a[248:251], v226 offset:4352
    v_cvt_pk_bf16_f32 v163, v146, v147
    v_mfma_f32_16x16x32_bf16 v[220:223], a[252:255], a[132:135], v[220:223]
    ds_read_b128 v[144:147], v230 offset:2560
    v_mfma_f32_16x16x32_bf16 v[196:199], a[216:219], v[160:163], v[196:199]
    v_mfma_f32_16x16x32_bf16 v[216:219], a[252:255], a[136:139], v[216:219]
    v_mfma_f32_16x16x32_bf16 v[212:215], a[252:255], a[140:143], v[212:215]
    ds_read_b128 a[252:255], v226 offset:4416
    v_mfma_f32_16x16x32_bf16 v[208:211], v[168:171], a[244:247], v[208:211]
    v_mfma_f32_16x16x32_bf16 v[200:203], v[168:171], v[252:255], v[200:203]
    ds_read_b64_tr_b16 v[168:169], v242 offset:50696
    v_cvt_pk_bf16_f32 v70, v220, v221
    v_mfma_f32_16x16x32_bf16 v[204:207], v[248:251], a[244:247], v[204:207]
    ds_read_b64_tr_b16 v[170:171], v242 offset:61448
    v_cvt_pk_bf16_f32 v71, v222, v223
    v_mfma_f32_16x16x32_bf16 v[180:183], v[248:251], v[252:255], v[180:183]
    v_cvt_pk_bf16_f32 v92, v216, v217
    v_cvt_pk_bf16_f32 v93, v218, v219
    v_mfma_f32_16x16x32_bf16 v[184:187], v[70:73], v[160:163], v[184:187]
    v_cvt_pk_bf16_f32 v114, v212, v213
    v_cvt_pk_bf16_f32 v115, v214, v215
    v_mfma_f32_16x16x32_bf16 v[188:191], v[92:95], v[160:163], v[188:191]
    v_cvt_pk_bf16_f32 v208, v208, v209
    v_cvt_pk_bf16_f32 v209, v210, v211
    v_mfma_f32_16x16x32_bf16 v[192:195], v[114:117], v[160:163], v[192:195]
    s_waitcnt lgkmcnt(4)
    v_cvt_pk_bf16_f32 v210, v204, v205
    v_cvt_pk_bf16_f32 v211, v206, v207
    v_mfma_f32_16x16x32_bf16 v[176:179], v[164:167], a[244:247], v[176:179]
    buffer_store_dwordx4 v[208:211], v243, s[20:23], s58 offen sc0 sc1
    v_mfma_f32_16x16x32_bf16 v[220:223], a[144:147], a[236:239], 0
    ds_read_b64_tr_b16 v[248:249], v241 offset:12288
    v_cvt_pk_bf16_f32 v200, v200, v201
    v_mfma_f32_16x16x32_bf16 v[216:219], a[148:151], a[236:239], 0
    s_waitcnt lgkmcnt(1)
    ds_read_b64_tr_b16 v[250:251], v241 offset:26112
    v_cvt_pk_bf16_f32 v201, v202, v203
    v_mfma_f32_16x16x32_bf16 v[172:175], v[168:171], a[244:247], v[172:175]
    v_cvt_pk_bf16_f32 v202, v180, v181
    v_cvt_pk_bf16_f32 v203, v182, v183
    v_mfma_f32_16x16x32_bf16 v[212:215], a[152:155], a[236:239], 0
    ds_read_b128 a[236:239], v226 offset:4480
    v_cvt_pk_bf16_f32 v176, v176, v177
    v_mfma_f32_16x16x32_bf16 v[220:223], a[156:159], a[240:243], v[220:223]
    ds_read_b64_tr_b16 v[164:165], v241 offset:12296
    v_cvt_pk_bf16_f32 v177, v178, v179
    v_mfma_f32_16x16x32_bf16 v[216:219], a[160:163], a[240:243], v[216:219]
    v_cvt_pk_bf16_f32 v178, v172, v173
    v_cvt_pk_bf16_f32 v179, v174, v175
    v_mfma_f32_16x16x32_bf16 v[212:215], a[164:167], a[240:243], v[212:215]
    ds_read_b128 a[240:243], v226 offset:4544
    ds_read_b64_tr_b16 v[166:167], v241 offset:26120
    v_mfma_f32_16x16x32_bf16 v[220:223], a[168:171], a[248:251], v[220:223]
    v_rcp_f32 v197, v196
    v_mfma_f32_16x16x32_bf16 v[216:219], a[172:175], a[248:251], v[216:219]
    v_mul_f32 v184, v184, v197
    v_mul_f32 v185, v185, v197
    v_mfma_f32_16x16x32_bf16 v[212:215], a[176:179], a[248:251], v[212:215]
    ds_read_b128 a[248:251], v225 offset:8896
    v_cvt_pk_bf16_f32 v184, v184, v185
    v_mfma_f32_16x16x32_bf16 v[220:223], a[180:183], a[252:255], v[220:223]
    v_mul_f32 v186, v186, v197
    v_mul_f32 v187, v187, v197
    v_mfma_f32_16x16x32_bf16 v[216:219], a[184:187], a[252:255], v[216:219]
    buffer_store_dwordx4 v[200:203], v245, s[20:23], s58 offen sc0 sc1
    v_mfma_f32_16x16x32_bf16 v[212:215], a[188:191], a[252:255], v[212:215]
    s_waitcnt lgkmcnt(4)
    ds_read_b128 a[252:255], v225 offset:8960
    v_cvt_pk_bf16_f32 v185, v186, v187
    v_mfma_f32_16x16x32_bf16 v[220:223], a[192:195], a[236:239], v[220:223]
    s_waitcnt vmcnt(2) lgkmcnt(3)
    v_mul_f32 v188, v188, v197
    v_mul_f32 v189, v189, v197
    v_mfma_f32_16x16x32_bf16 v[216:219], a[196:199], a[236:239], v[216:219]
    s_barrier
    v_cvt_pk_bf16_f32 v186, v188, v189
    v_mul_f32 v190, v190, v197
    v_mfma_f32_16x16x32_bf16 v[212:215], a[200:203], a[236:239], v[212:215]
    ds_read_b128 a[236:239], v225 offset:9024
    v_mul_f32 v191, v191, v197
    v_mfma_f32_16x16x32_bf16 v[220:223], a[204:207], a[240:243], v[220:223]
    v_cvt_pk_bf16_f32 v187, v190, v191
    v_mul_f32 v192, v192, v197
    v_mfma_f32_16x16x32_bf16 v[216:219], a[208:211], a[240:243], v[216:219]
    v_mul_f32 v193, v193, v197
    v_cvt_pk_bf16_f32 v188, v192, v193
    v_mfma_f32_16x16x32_bf16 v[212:215], a[212:215], a[240:243], v[212:215]
    s_waitcnt lgkmcnt(2)
    ds_read_b128 a[240:243], v225 offset:9088
    v_mul_f32 v194, v194, v197
    v_mul_f32 v220, s37, v220
    v_mul_f32 v221, s37, v221
    v_mul_f32 v222, s37, v222
    v_mul_f32 v223, s37, v223
    v_cvt_pk_bf16_f32 v138, v220, v221
    v_cvt_pk_bf16_f32 v139, v222, v223
    v_mfma_f32_16x16x32_bf16 v[220:223], a[144:147], a[248:251], 0
    s_waitcnt lgkmcnt(2)
    v_mul_f32 v216, s37, v216
    v_mul_f32 v217, s37, v217
    v_mfma_f32_16x16x32_bf16 v[220:223], a[156:159], a[252:255], v[220:223]
    v_mul_f32 v218, s37, v218
    v_mul_f32 v219, s37, v219
    v_cvt_pk_bf16_f32 v140, v216, v217
    v_cvt_pk_bf16_f32 v141, v218, v219
    v_mfma_f32_16x16x32_bf16 v[216:219], a[148:151], a[248:251], 0
    v_mul_f32 v212, s37, v212
    v_mul_f32 v213, s37, v213
    v_mfma_f32_16x16x32_bf16 v[148:151], v[36:39], v[138:141], v[148:151]
    v_mul_f32 v214, s37, v214
    v_mul_f32 v215, s37, v215
    v_mfma_f32_16x16x32_bf16 v[152:155], v[42:45], v[138:141], v[152:155]
    v_cvt_pk_bf16_f32 v142, v212, v213
    v_cvt_pk_bf16_f32 v143, v214, v215
    v_mfma_f32_16x16x32_bf16 v[156:159], v[24:27], v[138:141], v[156:159]
    buffer_store_dwordx4 v[176:179], v244, s[20:23], s58 offen sc0 sc1
    v_mfma_f32_16x16x16_bf16 v[148:151], v[40:41], v[142:143], v[148:151]
    s_add_u32 s58, s51, 0x54000
    v_mul_f32 v195, v195, v197
    v_cvt_pk_bf16_f32 v189, v194, v195
    v_mfma_f32_16x16x16_bf16 v[152:155], v[46:47], v[142:143], v[152:155]
    ds_read_b128 a[244:247], v239 offset:12288
    v_max3_f32 v236, v236, v196, v197
    v_mfma_f32_16x16x16_bf16 v[156:159], v[28:29], v[142:143], v[156:159]
    ds_write_b128 v237, v[184:187]
    v_mfma_f32_16x16x32_bf16 v[144:147], v[30:33], v[138:141], v[144:147]
    ds_write_b64 v238, v[188:189]
    v_mfma_f32_16x16x32_bf16 v[212:215], a[152:155], a[248:251], 0
    ds_read_b128 a[248:251], v225 offset:9152
    ds_read_b128 v[252:255], v240 offset:12288
    v_mfma_f32_16x16x32_bf16 v[216:219], a[160:163], a[252:255], v[216:219]
    ds_read_b64_tr_b16 v[168:169], v242 offset:12288
    ds_read_b64_tr_b16 v[170:171], v242 offset:26112
    v_mfma_f32_16x16x16_bf16 v[144:147], v[34:35], v[142:143], v[144:147]
    v_exp_f32 v148, v148
    v_mfma_f32_16x16x32_bf16 v[212:215], a[164:167], a[252:255], v[212:215]
    s_waitcnt lgkmcnt(7)
    ds_read_b128 a[252:255], v225 offset:9216
    v_mfma_f32_16x16x32_bf16 v[220:223], a[168:171], a[236:239], v[220:223]
    v_exp_f32 v149, v149
    v_mfma_f32_16x16x32_bf16 v[216:219], a[172:175], a[236:239], v[216:219]
    v_exp_f32 v150, v150
    v_mfma_f32_16x16x32_bf16 v[212:215], a[176:179], a[236:239], v[212:215]
    ds_read_b128 a[236:239], v224 offset:30976
    v_cvt_pk_bf16_f32 v160, v148, v149
    v_mfma_f32_16x16x32_bf16 v[220:223], a[180:183], a[240:243], v[220:223]
    buffer_load_dwordx4 v246, s[4:7], s56 offen lds
    v_mfma_f32_16x16x32_bf16 v[216:219], a[184:187], a[240:243], v[216:219]
    s_add_u32 m0, s42, 0xb580
    v_exp_f32 v151, v151
    v_mfma_f32_16x16x32_bf16 v[212:215], a[188:191], a[240:243], v[212:215]
    s_waitcnt lgkmcnt(5)
    ds_read_b128 a[240:243], v224 offset:31040
    v_cvt_pk_bf16_f32 v161, v150, v151
    v_mfma_f32_16x16x32_bf16 v[220:223], a[192:195], a[248:251], v[220:223]
    ds_read_b128 v[148:151], v234
    v_bfe_u32 v234, s71, v233, 4
    v_mfma_f32_16x16x32_bf16 v[216:219], a[196:199], a[248:251], v[216:219]
    v_mad_u32_u24 v234, v234, s40, v231
    v_mfma_f32_16x16x32_bf16 v[212:215], a[200:203], a[248:251], v[212:215]
    s_waitcnt lgkmcnt(3)
    ds_read_b128 a[248:251], v224 offset:31104
    v_mfma_f32_16x16x32_bf16 v[220:223], a[204:207], a[252:255], v[220:223]
    v_exp_f32 v152, v152
    v_mfma_f32_16x16x32_bf16 v[216:219], a[208:211], a[252:255], v[216:219]
    v_exp_f32 v153, v153
    v_mfma_f32_16x16x32_bf16 v[212:215], a[212:215], a[252:255], v[212:215]
    ds_read_b128 a[252:255], v224 offset:31168
    v_cvt_pk_bf16_f32 v162, v152, v153
    v_mfma_f32_16x16x32_bf16 v[208:211], a[220:223], a[244:247], 0
    buffer_load_dwordx4 v247, s[4:7], s56 offen lds
    v_mfma_f32_16x16x32_bf16 v[200:203], a[220:223], v[252:255], 0
    s_add_u32 s56, s39, 0x276000
    v_mul_f32 v220, s37, v220
    v_mul_f32 v221, s37, v221
    v_mfma_f32_16x16x32_bf16 v[204:207], a[224:227], a[244:247], 0
    s_add_u32 m0, s41, 0xd3c0
    v_mul_f32 v222, s37, v222
    v_mul_f32 v223, s37, v223
    v_mfma_f32_16x16x32_bf16 v[180:183], a[224:227], v[252:255], 0
    s_waitcnt lgkmcnt(2)
    v_cvt_pk_bf16_f32 v132, v220, v221
    v_cvt_pk_bf16_f32 v133, v222, v223
    v_mfma_f32_16x16x32_bf16 v[148:151], v[54:57], v[138:141], v[148:151]
    v_mul_f32 v216, s37, v216
    v_mul_f32 v217, s37, v217
    v_mfma_f32_16x16x32_bf16 v[176:179], a[228:231], a[244:247], 0
    v_mul_f32 v218, s37, v218
    v_mul_f32 v219, s37, v219
    v_mfma_f32_16x16x32_bf16 v[172:175], a[232:235], a[244:247], 0
    v_cvt_pk_bf16_f32 v134, v216, v217
    v_cvt_pk_bf16_f32 v135, v218, v219
    v_mfma_f32_16x16x16_bf16 v[148:151], v[58:59], v[142:143], v[148:151]
    v_mul_f32 v212, s37, v212
    v_mul_f32 v213, s37, v213
    v_mfma_f32_16x16x32_bf16 v[220:223], a[0:3], a[236:239], 0
    v_mul_f32 v214, s37, v214
    v_mul_f32 v215, s37, v215
    v_mfma_f32_16x16x32_bf16 v[216:219], a[4:7], a[236:239], 0
    v_cvt_pk_bf16_f32 v136, v212, v213
    v_cvt_pk_bf16_f32 v137, v214, v215
    v_mfma_f32_16x16x32_bf16 v[212:215], a[8:11], a[236:239], 0
    ds_read_b128 a[236:239], v224 offset:31232
    ds_read_b128 a[244:247], v239 offset:13312
    v_mfma_f32_16x16x32_bf16 v[220:223], a[12:15], a[240:243], v[220:223]
    buffer_load_dwordx4 v246, s[4:7], s56 offen lds
    v_mfma_f32_16x16x32_bf16 v[216:219], a[16:19], a[240:243], v[216:219]
    s_add_u32 m0, s42, 0xd3c0
    ds_read_b128 v[252:255], v240 offset:13312
    v_mfma_f32_16x16x32_bf16 v[212:215], a[20:23], a[240:243], v[212:215]
    s_waitcnt lgkmcnt(3)
    ds_read_b128 a[240:243], v224 offset:31296
    v_mfma_f32_16x16x32_bf16 v[220:223], a[24:27], a[248:251], v[220:223]
    v_exp_f32 v154, v154
    v_mfma_f32_16x16x32_bf16 v[216:219], a[28:31], a[248:251], v[216:219]
    v_exp_f32 v155, v155
    v_mfma_f32_16x16x32_bf16 v[212:215], a[32:35], a[248:251], v[212:215]
    ds_read_b128 a[248:251], v224 offset:30976
    v_cvt_pk_bf16_f32 v163, v154, v155
    v_mfma_f32_16x16x32_bf16 v[220:223], a[36:39], a[252:255], v[220:223]
    ds_read_b128 v[152:155], v235
    v_bfe_u32 v235, s67, v233, 4
    v_mfma_f32_16x16x32_bf16 v[196:199], a[216:219], v[160:163], 0
    v_mad_u32_u24 v235, v235, s40, v231
    v_mfma_f32_16x16x32_bf16 v[184:187], v[76:79], v[160:163], 0
    buffer_load_dwordx4 v247, s[4:7], s56 offen lds
    v_mfma_f32_16x16x32_bf16 v[188:191], v[98:101], v[160:163], 0
    s_add_u32 s56, s39, 0x2a0000
    v_exp_f32 v156, v156
    v_mfma_f32_16x16x32_bf16 v[192:195], v[120:123], v[160:163], 0
    s_add_u32 m0, s41, 0
    v_exp_f32 v157, v157
    v_mfma_f32_16x16x32_bf16 v[216:219], a[40:43], a[252:255], v[216:219]
    v_exp_f32 v158, v158
    v_mfma_f32_16x16x32_bf16 v[212:215], a[44:47], a[252:255], v[212:215]
    s_waitcnt lgkmcnt(2)
    ds_read_b128 a[252:255], v224 offset:31040
    v_cvt_pk_bf16_f32 v160, v156, v157
    v_mfma_f32_16x16x32_bf16 v[220:223], a[48:51], a[236:239], v[220:223]
    v_exp_f32 v159, v159
    v_mfma_f32_16x16x32_bf16 v[216:219], a[52:55], a[236:239], v[216:219]
    v_cvt_pk_bf16_f32 v161, v158, v159
    v_mfma_f32_16x16x32_bf16 v[212:215], a[56:59], a[236:239], v[212:215]
    s_waitcnt lgkmcnt(1)
    ds_read_b128 a[236:239], v224 offset:31104
    ds_read_b128 v[156:159], v229 offset:640
    v_mfma_f32_16x16x32_bf16 v[152:155], v[60:63], v[138:141], v[152:155]
    v_exp_f32 v144, v144
    v_mfma_f32_16x16x32_bf16 v[220:223], a[60:63], a[240:243], v[220:223]
    v_exp_f32 v145, v145
    v_mfma_f32_16x16x32_bf16 v[216:219], a[64:67], a[240:243], v[216:219]
    v_exp_f32 v146, v146
    v_mfma_f32_16x16x32_bf16 v[212:215], a[68:71], a[240:243], v[212:215]
    ds_read_b128 a[240:243], v224 offset:31168
    v_cvt_pk_bf16_f32 v162, v144, v145
    v_mfma_f32_16x16x16_bf16 v[152:155], v[64:65], v[142:143], v[152:155]
    v_exp_f32 v147, v147
    v_mfma_f32_16x16x32_bf16 v[208:211], v[248:251], a[244:247], v[208:211]
    v_cvt_pk_bf16_f32 v12, v220, v221
    v_cvt_pk_bf16_f32 v13, v222, v223
    v_mfma_f32_16x16x32_bf16 v[200:203], v[248:251], v[252:255], v[200:203]
    v_cvt_pk_bf16_f32 v14, v216, v217
    v_cvt_pk_bf16_f32 v15, v218, v219
    v_mfma_f32_16x16x32_bf16 v[204:207], v[164:167], a[244:247], v[204:207]
    v_cvt_pk_bf16_f32 v16, v212, v213
    v_cvt_pk_bf16_f32 v17, v214, v215
    v_mfma_f32_16x16x32_bf16 v[180:183], v[164:167], v[252:255], v[180:183]
    ds_read_b64_tr_b16 v[248:249], v242 offset:12296
    ds_read_b64_tr_b16 v[250:251], v242 offset:26120
    v_mfma_f32_16x16x32_bf16 v[176:179], v[168:171], a[244:247], v[176:179]
    s_waitcnt lgkmcnt(3)
    ds_read_b128 v[252:255], v240 offset:14336
    ds_read_b64_tr_b16 v[164:165], v241 offset:13824
    v_mfma_f32_16x16x32_bf16 v[156:159], v[42:45], v[132:135], v[156:159]
    ds_read_b64_tr_b16 v[166:167], v241 offset:24576
    v_cvt_pk_bf16_f32 v163, v146, v147
    v_mfma_f32_16x16x32_bf16 v[220:223], a[248:251], a[72:75], 0
    ds_read_b64_tr_b16 v[168:169], v241 offset:13832
    v_mfma_f32_16x16x32_bf16 v[196:199], a[216:219], v[160:163], v[196:199]
    ds_read_b64_tr_b16 v[170:171], v241 offset:24584
    v_mfma_f32_16x16x32_bf16 v[184:187], v[68:71], v[160:163], v[184:187]
    ds_read_b128 v[144:147], v228 offset:640
    v_mfma_f32_16x16x32_bf16 v[188:191], v[90:93], v[160:163], v[188:191]
    v_exp_f32 v148, v148
    v_mfma_f32_16x16x32_bf16 v[192:195], v[112:115], v[160:163], v[192:195]
    v_exp_f32 v149, v149
    v_mfma_f32_16x16x16_bf16 v[156:159], v[46:47], v[136:137], v[156:159]
    v_exp_f32 v150, v150
    v_mfma_f32_16x16x32_bf16 v[216:219], a[248:251], a[76:79], 0
    s_waitcnt lgkmcnt(6)
    v_exp_f32 v151, v151
    v_mfma_f32_16x16x32_bf16 v[172:175], v[248:251], a[244:247], v[172:175]
    ds_read_b128 a[244:247], v239 offset:14336
    ds_read_b64_tr_b16 v[248:249], v242 offset:13824
    v_mfma_f32_16x16x32_bf16 v[212:215], a[248:251], a[80:83], 0
    ds_read_b128 a[248:251], v224 offset:31232
    ds_read_b64_tr_b16 v[250:251], v242 offset:24576
    v_mfma_f32_16x16x32_bf16 v[220:223], a[252:255], a[84:87], v[220:223]
    v_cvt_pk_bf16_f32 v160, v148, v149
    v_cvt_pk_bf16_f32 v161, v150, v151
    v_mfma_f32_16x16x32_bf16 v[216:219], a[252:255], a[88:91], v[216:219]
    ds_read_b128 v[148:151], v228 offset:1280
    v_mfma_f32_16x16x32_bf16 v[212:215], a[252:255], a[92:95], v[212:215]
    ds_read_b128 a[252:255], v224 offset:31296
    v_mfma_f32_16x16x32_bf16 v[220:223], a[236:239], a[96:99], v[220:223]
    v_exp_f32 v152, v152
    v_mfma_f32_16x16x32_bf16 v[216:219], a[236:239], a[100:103], v[216:219]
    s_waitcnt lgkmcnt(6)
    v_exp_f32 v153, v153
    v_mfma_f32_16x16x32_bf16 v[144:147], v[18:21], v[132:135], v[144:147]
    v_exp_f32 v154, v154
    v_mfma_f32_16x16x32_bf16 v[212:215], a[236:239], a[104:107], v[212:215]
    ds_read_b128 a[236:239], v224 offset:34048
    v_cvt_pk_bf16_f32 v162, v152, v153
    v_mfma_f32_16x16x32_bf16 v[220:223], a[240:243], a[108:111], v[220:223]
    v_exp_f32 v155, v155
    v_mfma_f32_16x16x16_bf16 v[144:147], v[22:23], v[136:137], v[144:147]
    v_cvt_pk_bf16_f32 v163, v154, v155
    v_mfma_f32_16x16x32_bf16 v[216:219], a[240:243], a[112:115], v[216:219]
    ds_read_b128 v[152:155], v229 offset:1280
    v_mfma_f32_16x16x32_bf16 v[196:199], a[216:219], v[160:163], v[196:199]
    v_exp_f32 v156, v156
    v_mfma_f32_16x16x32_bf16 v[184:187], v[84:87], v[160:163], v[184:187]
    v_exp_f32 v157, v157
    v_mfma_f32_16x16x32_bf16 v[188:191], v[106:109], v[160:163], v[188:191]
    v_exp_f32 v158, v158
    v_mfma_f32_16x16x32_bf16 v[192:195], v[128:131], v[160:163], v[192:195]
    s_waitcnt lgkmcnt(3)
    v_exp_f32 v159, v159
    v_mfma_f32_16x16x32_bf16 v[148:151], v[0:3], v[132:135], v[148:151]
    v_rcp_f32 v197, v196
    v_mfma_f32_16x16x32_bf16 v[212:215], a[240:243], a[116:119], v[212:215]
    ds_read_b128 a[240:243], v224 offset:34112
    v_mul_f32 v184, v184, v197
    v_mfma_f32_16x16x32_bf16 v[220:223], a[248:251], a[120:123], v[220:223]
    v_mul_f32 v185, v185, v197
    v_cvt_pk_bf16_f32 v184, v184, v185
    v_mfma_f32_16x16x16_bf16 v[148:151], v[4:5], v[136:137], v[148:151]
    v_mul_f32 v186, v186, v197
    v_mul_f32 v187, v187, v197
    v_mfma_f32_16x16x32_bf16 v[216:219], a[248:251], a[124:127], v[216:219]
    s_waitcnt lgkmcnt(1)
    v_cvt_pk_bf16_f32 v185, v186, v187
    v_mul_f32 v188, v188, v197
    v_mfma_f32_16x16x32_bf16 v[152:155], v[24:27], v[132:135], v[152:155]
    v_mul_f32 v189, v189, v197
    v_cvt_pk_bf16_f32 v186, v188, v189
    v_mfma_f32_16x16x32_bf16 v[212:215], a[248:251], a[128:131], v[212:215]
    ds_read_b128 a[248:251], v224 offset:34176
    v_mul_f32 v190, v190, v197
    v_mfma_f32_16x16x32_bf16 v[220:223], a[252:255], a[132:135], v[220:223]
    v_mul_f32 v191, v191, v197
    v_cvt_pk_bf16_f32 v187, v190, v191
    v_mfma_f32_16x16x16_bf16 v[152:155], v[28:29], v[136:137], v[152:155]
    v_mul_f32 v192, v192, v197
    v_mul_f32 v193, v193, v197
    v_mfma_f32_16x16x32_bf16 v[216:219], a[252:255], a[136:139], v[216:219]
    v_cvt_pk_bf16_f32 v188, v192, v193
    v_mul_f32 v194, v194, v197
    v_mfma_f32_16x16x32_bf16 v[212:215], a[252:255], a[140:143], v[212:215]
    v_cvt_pk_bf16_f32 v74, v220, v221
    v_cvt_pk_bf16_f32 v75, v222, v223
    v_mfma_f32_16x16x32_bf16 v[208:211], v[164:167], a[244:247], v[208:211]
    ds_read_b128 a[252:255], v224 offset:34240
    v_mul_f32 v195, v195, v197
    v_mfma_f32_16x16x32_bf16 v[200:203], v[164:167], v[252:255], v[200:203]
    v_cvt_pk_bf16_f32 v96, v216, v217
    v_cvt_pk_bf16_f32 v97, v218, v219
    v_mfma_f32_16x16x32_bf16 v[204:207], v[168:171], a[244:247], v[204:207]
    v_cvt_pk_bf16_f32 v118, v212, v213
    v_cvt_pk_bf16_f32 v119, v214, v215
    v_mfma_f32_16x16x32_bf16 v[180:183], v[168:171], v[252:255], v[180:183]
    v_cvt_pk_bf16_f32 v189, v194, v195
    v_max3_f32 v236, v236, v196, v197
    v_mfma_f32_16x16x32_bf16 v[176:179], v[248:251], a[244:247], v[176:179]
    ds_write_b128 v237, v[184:187] offset:6144
    v_mfma_f32_16x16x32_bf16 v[220:223], a[0:3], a[236:239], 0
    ds_write_b64 v238, v[188:189] offset:6144
    v_mfma_f32_16x16x32_bf16 v[216:219], a[4:7], a[236:239], 0
    ds_read_b64_tr_b16 v[164:165], v242 offset:13832
    ds_read_b64_tr_b16 v[166:167], v242 offset:24584
    v_mfma_f32_16x16x32_bf16 v[212:215], a[8:11], a[236:239], 0
    s_waitcnt lgkmcnt(5)
    ds_read_b128 a[236:239], v224 offset:34304
    ds_read_b128 v[252:255], v240 offset:15360
    v_mfma_f32_16x16x32_bf16 v[220:223], a[12:15], a[240:243], v[220:223]
    ds_read_b64_tr_b16 v[168:169], v241 offset:36864
    v_cvt_pk_bf16_f32 v160, v156, v157
    v_mfma_f32_16x16x32_bf16 v[216:219], a[16:19], a[240:243], v[216:219]
    ds_read_b64_tr_b16 v[170:171], v241 offset:38400
    v_cvt_pk_bf16_f32 v161, v158, v159
    v_mfma_f32_16x16x32_bf16 v[212:215], a[20:23], a[240:243], v[212:215]
    ds_read_b128 a[240:243], v224 offset:34368
    v_mfma_f32_16x16x32_bf16 v[220:223], a[24:27], a[248:251], v[220:223]
    ds_read_b64_tr_b16 v[248:249], v241 offset:36872
    v_mfma_f32_16x16x32_bf16 v[216:219], a[28:31], a[248:251], v[216:219]
    ds_read_b64_tr_b16 v[250:251], v241 offset:38408
    v_mfma_f32_16x16x32_bf16 v[212:215], a[32:35], a[248:251], v[212:215]
    s_waitcnt lgkmcnt(11)
    ds_read_b128 a[248:251], v224 offset:34048
    v_mfma_f32_16x16x32_bf16 v[220:223], a[36:39], a[252:255], v[220:223]
    ds_read_b128 v[156:159], v229 offset:1920
    v_mfma_f32_16x16x32_bf16 v[216:219], a[40:43], a[252:255], v[216:219]
    s_waitcnt lgkmcnt(9)
    v_exp_f32 v144, v144
    v_mfma_f32_16x16x32_bf16 v[172:175], v[164:167], a[244:247], v[172:175]
    ds_read_b128 a[244:247], v239 offset:15360
    v_mfma_f32_16x16x32_bf16 v[212:215], a[44:47], a[252:255], v[212:215]
    s_waitcnt lgkmcnt(9)
    ds_read_b128 a[252:255], v224 offset:34112
    v_mfma_f32_16x16x32_bf16 v[220:223], a[48:51], a[236:239], v[220:223]
    ds_read_b64_tr_b16 v[164:165], v242 offset:36864
    v_mfma_f32_16x16x32_bf16 v[216:219], a[52:55], a[236:239], v[216:219]
    ds_read_b64_tr_b16 v[166:167], v242 offset:38400
    v_mfma_f32_16x16x32_bf16 v[212:215], a[56:59], a[236:239], v[212:215]
    s_waitcnt lgkmcnt(8)
    ds_read_b128 a[236:239], v224 offset:34176
    v_mfma_f32_16x16x32_bf16 v[220:223], a[60:63], a[240:243], v[220:223]
    v_exp_f32 v145, v145
    v_mfma_f32_16x16x32_bf16 v[216:219], a[64:67], a[240:243], v[216:219]
    v_exp_f32 v146, v146
    v_mfma_f32_16x16x32_bf16 v[212:215], a[68:71], a[240:243], v[212:215]
    ds_read_b128 a[240:243], v224 offset:34240
    v_cvt_pk_bf16_f32 v162, v144, v145
    v_mfma_f32_16x16x32_bf16 v[200:203], v[168:171], v[252:255], v[200:203]
    s_waitcnt lgkmcnt(8)
    v_exp_f32 v147, v147
    v_mfma_f32_16x16x32_bf16 v[180:183], v[248:251], v[252:255], v[180:183]
    s_waitcnt lgkmcnt(6)
    v_cvt_pk_bf16_f32 v36, v220, v221
    v_cvt_pk_bf16_f32 v37, v222, v223
    v_mfma_f32_16x16x32_bf16 v[156:159], v[30:33], v[132:135], v[156:159]
    s_waitcnt lgkmcnt(5)
    v_cvt_pk_bf16_f32 v38, v216, v217
    v_cvt_pk_bf16_f32 v39, v218, v219
    v_mfma_f32_16x16x32_bf16 v[208:211], v[168:171], a[244:247], v[208:211]
    v_cvt_pk_bf16_f32 v40, v212, v213
    v_cvt_pk_bf16_f32 v41, v214, v215
    v_mfma_f32_16x16x32_bf16 v[204:207], v[248:251], a[244:247], v[204:207]
    ds_read_b64_tr_b16 v[168:169], v242 offset:36872
    ds_read_b64_tr_b16 v[170:171], v242 offset:38408
    v_mfma_f32_16x16x16_bf16 v[156:159], v[34:35], v[136:137], v[156:159]
    s_waitcnt lgkmcnt(4)
    ds_read_b128 v[252:255], v240 offset:16384
    ds_read_b64_tr_b16 v[248:249], v241 offset:49152
    v_mfma_f32_16x16x32_bf16 v[176:179], v[164:167], a[244:247], v[176:179]
    ds_read_b64_tr_b16 v[250:251], v241 offset:62976
    v_cvt_pk_bf16_f32 v163, v146, v147
    v_mfma_f32_16x16x32_bf16 v[220:223], a[248:251], a[72:75], 0
    ds_read_b64_tr_b16 v[164:165], v241 offset:49160
    v_mfma_f32_16x16x32_bf16 v[196:199], a[216:219], v[160:163], 0
    ds_read_b64_tr_b16 v[166:167], v241 offset:62984
    v_mfma_f32_16x16x32_bf16 v[184:187], v[78:81], v[160:163], 0
    ds_read_b128 v[144:147], v228 offset:1920
    v_mfma_f32_16x16x32_bf16 v[188:191], v[100:103], v[160:163], 0
    v_exp_f32 v148, v148
    v_mfma_f32_16x16x32_bf16 v[192:195], v[122:125], v[160:163], 0
    v_exp_f32 v149, v149
    v_mfma_f32_16x16x32_bf16 v[216:219], a[248:251], a[76:79], 0
    v_exp_f32 v150, v150
    v_mfma_f32_16x16x32_bf16 v[212:215], a[248:251], a[80:83], 0
    s_waitcnt lgkmcnt(6)
    ds_read_b128 a[248:251], v224 offset:34304
    v_cvt_pk_bf16_f32 v160, v148, v149
    v_mfma_f32_16x16x32_bf16 v[172:175], v[168:171], a[244:247], v[172:175]
    ds_read_b128 a[244:247], v239 offset:16384
    ds_read_b64_tr_b16 v[168:169], v242 offset:49152
    v_mfma_f32_16x16x32_bf16 v[220:223], a[252:255], a[84:87], v[220:223]
    ds_read_b64_tr_b16 v[170:171], v242 offset:62976
    v_mfma_f32_16x16x32_bf16 v[216:219], a[252:255], a[88:91], v[216:219]
    v_exp_f32 v151, v151
    v_mfma_f32_16x16x32_bf16 v[212:215], a[252:255], a[92:95], v[212:215]
    ds_read_b128 a[252:255], v224 offset:34368
    v_cvt_pk_bf16_f32 v161, v150, v151
    v_mfma_f32_16x16x32_bf16 v[220:223], a[236:239], a[96:99], v[220:223]
    ds_read_b128 v[148:151], v228 offset:2560
    v_mfma_f32_16x16x32_bf16 v[216:219], a[236:239], a[100:103], v[216:219]
    v_exp_f32 v152, v152
    v_mfma_f32_16x16x32_bf16 v[212:215], a[236:239], a[104:107], v[212:215]
    s_waitcnt lgkmcnt(6)
    ds_read_b128 a[236:239], v225 offset:11968
    v_mfma_f32_16x16x32_bf16 v[144:147], v[6:9], v[132:135], v[144:147]
    v_exp_f32 v153, v153
    v_mfma_f32_16x16x32_bf16 v[220:223], a[240:243], a[108:111], v[220:223]
    v_exp_f32 v154, v154
    v_mfma_f32_16x16x32_bf16 v[216:219], a[240:243], a[112:115], v[216:219]
    v_exp_f32 v155, v155
    v_mfma_f32_16x16x32_bf16 v[212:215], a[240:243], a[116:119], v[212:215]
    ds_read_b128 a[240:243], v225 offset:12032
    v_cvt_pk_bf16_f32 v162, v152, v153
    v_mfma_f32_16x16x16_bf16 v[144:147], v[10:11], v[136:137], v[144:147]
    s_waitcnt lgkmcnt(5)
    v_cvt_pk_bf16_f32 v163, v154, v155
    v_mfma_f32_16x16x32_bf16 v[220:223], a[248:251], a[120:123], v[220:223]
    ds_read_b128 v[152:155], v229 offset:2560
    v_mfma_f32_16x16x32_bf16 v[196:199], a[216:219], v[160:163], v[196:199]
    v_exp_f32 v156, v156
    v_mfma_f32_16x16x32_bf16 v[184:187], v[66:69], v[160:163], v[184:187]
    v_exp_f32 v157, v157
    v_mfma_f32_16x16x32_bf16 v[188:191], v[88:91], v[160:163], v[188:191]
    v_exp_f32 v158, v158
    v_mfma_f32_16x16x32_bf16 v[192:195], v[110:113], v[160:163], v[192:195]
    s_waitcnt lgkmcnt(2)
    v_exp_f32 v159, v159
    v_mfma_f32_16x16x32_bf16 v[148:151], v[12:15], v[132:135], v[148:151]
    v_cvt_pk_bf16_f32 v160, v156, v157
    v_cvt_pk_bf16_f32 v161, v158, v159
    v_mfma_f32_16x16x32_bf16 v[216:219], a[248:251], a[124:127], v[216:219]
    ds_read_b128 v[156:159], v230 offset:2560
    v_mfma_f32_16x16x32_bf16 v[212:215], a[248:251], a[128:131], v[212:215]
    ds_read_b128 a[248:251], v225 offset:12096
    v_mfma_f32_16x16x16_bf16 v[148:151], v[16:17], v[136:137], v[148:151]
    v_exp_f32 v144, v144
    v_mfma_f32_16x16x32_bf16 v[220:223], a[252:255], a[132:135], v[220:223]
    s_waitcnt lgkmcnt(2)
    v_exp_f32 v145, v145
    v_mfma_f32_16x16x32_bf16 v[152:155], v[36:39], v[132:135], v[152:155]
    v_exp_f32 v146, v146
    v_mfma_f32_16x16x32_bf16 v[216:219], a[252:255], a[136:139], v[216:219]
    v_exp_f32 v147, v147
    v_mfma_f32_16x16x32_bf16 v[212:215], a[252:255], a[140:143], v[212:215]
    ds_read_b128 a[252:255], v225 offset:12160
    v_cvt_pk_bf16_f32 v162, v144, v145
    v_mfma_f32_16x16x16_bf16 v[152:155], v[40:41], v[136:137], v[152:155]
    v_cvt_pk_bf16_f32 v76, v220, v221
    v_cvt_pk_bf16_f32 v77, v222, v223
    v_mfma_f32_16x16x32_bf16 v[208:211], v[248:251], a[244:247], v[208:211]
    v_cvt_pk_bf16_f32 v98, v216, v217
    v_cvt_pk_bf16_f32 v99, v218, v219
    v_mfma_f32_16x16x32_bf16 v[200:203], v[248:251], v[252:255], v[200:203]
    v_cvt_pk_bf16_f32 v120, v212, v213
    v_cvt_pk_bf16_f32 v121, v214, v215
    v_mfma_f32_16x16x32_bf16 v[204:207], v[164:167], a[244:247], v[204:207]
    ds_read_b64_tr_b16 v[248:249], v242 offset:49160
    ds_read_b64_tr_b16 v[250:251], v242 offset:62984
    v_mfma_f32_16x16x32_bf16 v[180:183], v[164:167], v[252:255], v[180:183]
    ds_read_b128 v[252:255], v240 offset:17408
    ds_read_b64_tr_b16 v[164:165], v241 offset:50688
    v_mfma_f32_16x16x32_bf16 v[176:179], v[168:171], a[244:247], v[176:179]
    ds_read_b64_tr_b16 v[166:167], v241 offset:61440
    v_cvt_pk_bf16_f32 v163, v146, v147
    v_mfma_f32_16x16x32_bf16 v[220:223], a[144:147], a[236:239], 0
L_pg5:
    s_cbranch_execz L_back
    ds_read_b64_tr_b16 v[168:169], v241 offset:50696
    v_mfma_f32_16x16x32_bf16 v[196:199], a[216:219], v[160:163], v[196:199]
    ds_read_b64_tr_b16 v[170:171], v241 offset:61448
    v_mfma_f32_16x16x32_bf16 v[184:187], v[70:73], v[160:163], v[184:187]
    ds_read_b128 v[144:147], v230 offset:640
    v_mfma_f32_16x16x32_bf16 v[188:191], v[92:95], v[160:163], v[188:191]
    v_exp_f32 v148, v148
    v_mfma_f32_16x16x32_bf16 v[192:195], v[114:117], v[160:163], v[192:195]
    v_exp_f32 v149, v149
    v_mfma_f32_16x16x32_bf16 v[216:219], a[148:151], a[236:239], 0
    v_exp_f32 v150, v150
    v_mfma_f32_16x16x32_bf16 v[212:215], a[152:155], a[236:239], 0
    s_waitcnt lgkmcnt(6)
    ds_read_b128 a[236:239], v225 offset:12224
    v_cvt_pk_bf16_f32 v160, v148, v149
    v_mfma_f32_16x16x32_bf16 v[172:175], v[248:251], a[244:247], v[172:175]
    ds_read_b128 a[244:247], v239 offset:17408
    ds_read_b64_tr_b16 v[248:249], v242 offset:50688
    v_mfma_f32_16x16x32_bf16 v[220:223], a[156:159], a[240:243], v[220:223]
    ds_read_b64_tr_b16 v[250:251], v242 offset:61440
    v_mfma_f32_16x16x32_bf16 v[216:219], a[160:163], a[240:243], v[216:219]
    v_exp_f32 v151, v151
    v_mfma_f32_16x16x32_bf16 v[212:215], a[164:167], a[240:243], v[212:215]
    ds_read_b128 a[240:243], v225 offset:12288
    v_cvt_pk_bf16_f32 v161, v150, v151
    v_mfma_f32_16x16x32_bf16 v[220:223], a[168:171], a[248:251], v[220:223]
    ds_read_b128 v[148:151], v230 offset:1280
    v_mfma_f32_16x16x32_bf16 v[216:219], a[172:175], a[248:251], v[216:219]
    v_exp_f32 v152, v152
    v_mfma_f32_16x16x32_bf16 v[212:215], a[176:179], a[248:251], v[212:215]
    v_exp_f32 v153, v153
    v_mfma_f32_16x16x32_bf16 v[220:223], a[180:183], a[252:255], v[220:223]
    v_exp_f32 v154, v154
    v_mfma_f32_16x16x32_bf16 v[216:219], a[184:187], a[252:255], v[216:219]
    v_exp_f32 v155, v155
    v_mfma_f32_16x16x32_bf16 v[212:215], a[188:191], a[252:255], v[212:215]
    s_waitcnt lgkmcnt(5)
    v_cvt_pk_bf16_f32 v162, v152, v153
    v_cvt_pk_bf16_f32 v163, v154, v155
    v_mfma_f32_16x16x32_bf16 v[220:223], a[192:195], a[236:239], v[220:223]
    s_waitcnt vmcnt(0) lgkmcnt(1)
    ds_read_b128 v[152:155], v230 offset:1920
    v_mfma_f32_16x16x32_bf16 v[196:199], a[216:219], v[160:163], v[196:199]
    s_barrier
    ds_read_b128 a[248:251], v227 offset:37120
    v_mfma_f32_16x16x32_bf16 v[184:187], v[74:77], v[160:163], v[184:187]
    ds_read_b128 a[252:255], v227 offset:37184
    v_mfma_f32_16x16x32_bf16 v[188:191], v[96:99], v[160:163], v[188:191]
    buffer_load_dwordx4 v246, s[4:7], s56 offen lds
    v_mfma_f32_16x16x32_bf16 v[192:195], v[118:121], v[160:163], v[192:195]
    s_add_u32 m0, s42, 0
    v_rcp_f32 v197, v196
    v_mfma_f32_16x16x32_bf16 v[216:219], a[196:199], a[236:239], v[216:219]
    v_max3_f32 v236, v236, v196, v197
    v_mul_f32 v184, v184, v197
    v_mfma_f32_16x16x32_bf16 v[212:215], a[200:203], a[236:239], v[212:215]
    ds_read_b128 a[236:239], v227 offset:37248
    v_mul_f32 v185, v185, v197
    v_mfma_f32_16x16x32_bf16 v[220:223], a[204:207], a[240:243], v[220:223]
    v_cvt_pk_bf16_f32 v184, v184, v185
    v_mul_f32 v186, v186, v197
    v_mfma_f32_16x16x32_bf16 v[216:219], a[208:211], a[240:243], v[216:219]
    v_mul_f32 v187, v187, v197
    v_cvt_pk_bf16_f32 v185, v186, v187
    v_mfma_f32_16x16x32_bf16 v[212:215], a[212:215], a[240:243], v[212:215]
    ds_read_b128 a[240:243], v227 offset:37312
    v_mul_f32 v188, v188, v197
    v_mfma_f32_16x16x32_bf16 v[208:211], v[164:167], a[244:247], v[208:211]
    v_mul_f32 v220, s37, v220
    v_mul_f32 v221, s37, v221
    v_mfma_f32_16x16x32_bf16 v[200:203], v[164:167], v[252:255], v[200:203]
    v_mul_f32 v222, s37, v222
    v_mul_f32 v223, s37, v223
    v_mfma_f32_16x16x32_bf16 v[204:207], v[168:171], a[244:247], v[204:207]
    v_cvt_pk_bf16_f32 v138, v220, v221
    v_cvt_pk_bf16_f32 v139, v222, v223
    v_mfma_f32_16x16x32_bf16 v[180:183], v[168:171], v[252:255], v[180:183]
    v_mul_f32 v216, s37, v216
    v_mul_f32 v217, s37, v217
    v_mfma_f32_16x16x32_bf16 v[176:179], v[248:251], a[244:247], v[176:179]
    s_waitcnt lgkmcnt(2)
    v_mul_f32 v218, s37, v218
    v_mul_f32 v219, s37, v219
    v_mfma_f32_16x16x32_bf16 v[220:223], a[0:3], a[248:251], 0
    v_cvt_pk_bf16_f32 v140, v216, v217
    v_cvt_pk_bf16_f32 v141, v218, v219
    v_mfma_f32_16x16x32_bf16 v[216:219], a[4:7], a[248:251], 0
    v_mul_f32 v212, s37, v212
    v_mul_f32 v213, s37, v213
    v_mfma_f32_16x16x32_bf16 v[156:159], v[36:39], v[138:141], v[156:159]
    v_mul_f32 v214, s37, v214
    v_mul_f32 v215, s37, v215
    v_mfma_f32_16x16x32_bf16 v[144:147], v[42:45], v[138:141], v[144:147]
    v_cvt_pk_bf16_f32 v142, v212, v213
    v_cvt_pk_bf16_f32 v143, v214, v215
    v_mfma_f32_16x16x32_bf16 v[148:151], v[24:27], v[138:141], v[148:151]
    ds_read_b64_tr_b16 v[164:165], v242 offset:50696
    ds_read_b64_tr_b16 v[166:167], v242 offset:61448
    v_mfma_f32_16x16x16_bf16 v[156:159], v[40:41], v[142:143], v[156:159]
    v_cvt_pk_bf16_f32 v208, v208, v209
    v_cvt_pk_bf16_f32 v209, v210, v211
    v_mfma_f32_16x16x16_bf16 v[144:147], v[46:47], v[142:143], v[144:147]
    v_cvt_pk_bf16_f32 v210, v204, v205
    v_cvt_pk_bf16_f32 v211, v206, v207
    v_mfma_f32_16x16x16_bf16 v[148:151], v[28:29], v[142:143], v[148:151]
    buffer_store_dwordx4 v[208:211], v243, s[20:23], s58 offen sc0 sc1
    v_mfma_f32_16x16x32_bf16 v[152:155], v[30:33], v[138:141], v[152:155]
    v_cvt_pk_bf16_f32 v200, v200, v201
    v_cvt_pk_bf16_f32 v201, v202, v203
    v_mfma_f32_16x16x32_bf16 v[212:215], a[8:11], a[248:251], 0
    ds_read_b128 a[248:251], v227 offset:37376
    v_cvt_pk_bf16_f32 v202, v180, v181
    v_mfma_f32_16x16x32_bf16 v[220:223], a[12:15], a[252:255], v[220:223]
    v_cvt_pk_bf16_f32 v203, v182, v183
    v_cvt_pk_bf16_f32 v176, v176, v177
    v_mfma_f32_16x16x16_bf16 v[152:155], v[34:35], v[142:143], v[152:155]
    v_cvt_pk_bf16_f32 v177, v178, v179
    v_mul_f32 v189, v189, v197
    v_mfma_f32_16x16x32_bf16 v[216:219], a[16:19], a[252:255], v[216:219]
    s_waitcnt lgkmcnt(1)
    v_cvt_pk_bf16_f32 v186, v188, v189
    v_mul_f32 v190, v190, v197
    v_mfma_f32_16x16x32_bf16 v[172:175], v[164:167], a[244:247], v[172:175]
    v_mul_f32 v191, v191, v197
    v_cvt_pk_bf16_f32 v187, v190, v191
    v_mfma_f32_16x16x32_bf16 v[212:215], a[20:23], a[252:255], v[212:215]
    ds_read_b128 a[252:255], v227 offset:37440
    v_mul_f32 v192, v192, v197
    v_mfma_f32_16x16x32_bf16 v[220:223], a[24:27], a[236:239], v[220:223]
    v_mul_f32 v193, v193, v197
    v_cvt_pk_bf16_f32 v188, v192, v193
    v_mfma_f32_16x16x32_bf16 v[216:219], a[28:31], a[236:239], v[216:219]
    v_cvt_pk_bf16_f32 v178, v172, v173
    v_cvt_pk_bf16_f32 v179, v174, v175
    v_mfma_f32_16x16x32_bf16 v[212:215], a[32:35], a[236:239], v[212:215]
    ds_read_b128 a[236:239], v227 offset:37120
    v_mul_f32 v194, v194, v197
    v_mfma_f32_16x16x32_bf16 v[220:223], a[36:39], a[240:243], v[220:223]
    ds_read_b128 a[244:247], v239
    v_mul_f32 v195, v195, v197
    v_mfma_f32_16x16x32_bf16 v[216:219], a[40:43], a[240:243], v[216:219]
    buffer_store_dwordx4 v[200:203], v245, s[20:23], s58 offen sc0 sc1
    v_mfma_f32_16x16x32_bf16 v[212:215], a[44:47], a[240:243], v[212:215]
    s_waitcnt lgkmcnt(3)
    ds_read_b128 a[240:243], v227 offset:37184
    v_cvt_pk_bf16_f32 v189, v194, v195
    v_mfma_f32_16x16x32_bf16 v[220:223], a[48:51], a[248:251], v[220:223]
    ds_write_b128 v237, v[184:187] offset:12288
    v_mfma_f32_16x16x32_bf16 v[216:219], a[52:55], a[248:251], v[216:219]
    ds_write_b64 v238, v[188:189] offset:12288
    v_mfma_f32_16x16x32_bf16 v[212:215], a[56:59], a[248:251], v[212:215]
    s_waitcnt lgkmcnt(5)
    ds_read_b128 a[248:251], v227 offset:37248
    ds_read_b128 v[252:255], v240
    v_mfma_f32_16x16x32_bf16 v[220:223], a[60:63], a[252:255], v[220:223]
    ds_read_b64_tr_b16 v[168:169], v241 offset:12288
    ds_read_b64_tr_b16 v[170:171], v241 offset:26112
    v_mfma_f32_16x16x32_bf16 v[216:219], a[64:67], a[252:255], v[216:219]
    ds_read_b64_tr_b16 v[248:249], v241 offset:12296
    v_mfma_f32_16x16x32_bf16 v[212:215], a[68:71], a[252:255], v[212:215]
    s_waitcnt lgkmcnt(8)
    ds_read_b128 a[252:255], v227 offset:37312
    v_mfma_f32_16x16x32_bf16 v[208:211], a[220:223], a[244:247], 0
    ds_read_b64_tr_b16 v[250:251], v241 offset:26120
    v_cvt_pk_bf16_f32 v48, v220, v221
    v_mfma_f32_16x16x32_bf16 v[204:207], a[224:227], a[244:247], 0
    ds_read_b64_tr_b16 v[164:165], v242 offset:12288
    v_cvt_pk_bf16_f32 v49, v222, v223
    v_mfma_f32_16x16x32_bf16 v[172:175], a[232:235], a[244:247], 0
    v_cvt_pk_bf16_f32 v50, v216, v217
    v_cvt_pk_bf16_f32 v51, v218, v219
    v_mfma_f32_16x16x32_bf16 v[220:223], a[236:239], a[72:75], 0
    v_cvt_pk_bf16_f32 v52, v212, v213
    v_cvt_pk_bf16_f32 v53, v214, v215
    v_mfma_f32_16x16x32_bf16 v[216:219], a[236:239], a[76:79], 0
    s_waitcnt lgkmcnt(6)
    buffer_store_dwordx4 v[176:179], v244, s[20:23], s58 offen sc0 sc1
    v_mfma_f32_16x16x32_bf16 v[200:203], a[220:223], v[252:255], 0
    s_add_u32 s58, s51, 0xa8000
    ds_read_b64_tr_b16 v[166:167], v242 offset:26112
    v_mfma_f32_16x16x32_bf16 v[180:183], a[224:227], v[252:255], 0
    ds_read_b128 v[252:255], v240 offset:1024
    v_mfma_f32_16x16x32_bf16 v[176:179], a[228:231], a[244:247], 0
    ds_read_b128 a[244:247], v239 offset:1024
    v_mfma_f32_16x16x32_bf16 v[212:215], a[236:239], a[80:83], 0
    ds_read_b128 a[236:239], v227 offset:37376
    v_mfma_f32_16x16x32_bf16 v[220:223], a[240:243], a[84:87], v[220:223]
    v_exp_f32 v156, v156
    v_mfma_f32_16x16x32_bf16 v[216:219], a[240:243], a[88:91], v[216:219]
    v_exp_f32 v157, v157
    v_mfma_f32_16x16x32_bf16 v[212:215], a[240:243], a[92:95], v[212:215]
    ds_read_b128 a[240:243], v227 offset:37440
    v_cvt_pk_bf16_f32 v160, v156, v157
    v_mfma_f32_16x16x32_bf16 v[220:223], a[248:251], a[96:99], v[220:223]
    v_exp_f32 v158, v158
    v_mfma_f32_16x16x32_bf16 v[216:219], a[248:251], a[100:103], v[216:219]
    v_exp_f32 v159, v159
    v_mfma_f32_16x16x32_bf16 v[212:215], a[248:251], a[104:107], v[212:215]
    s_waitcnt lgkmcnt(5)
    ds_read_b128 a[248:251], v225 offset:24384
    v_cvt_pk_bf16_f32 v161, v158, v159
    v_mfma_f32_16x16x32_bf16 v[220:223], a[252:255], a[108:111], v[220:223]
    ds_read_b128 v[156:159], v234
    v_bfe_u32 v234, s72, v233, 4
    v_mfma_f32_16x16x32_bf16 v[216:219], a[252:255], a[112:115], v[216:219]
    s_waitcnt lgkmcnt(3)
    buffer_load_dwordx4 v247, s[4:7], s56 offen lds
    v_mfma_f32_16x16x32_bf16 v[212:215], a[252:255], a[116:119], v[212:215]
    s_add_u32 m0, s41, 0x1e40
    ds_read_b128 a[252:255], v225 offset:24448
    v_mad_u32_u24 v234, v234, s40, v231
    v_mfma_f32_16x16x32_bf16 v[220:223], a[236:239], a[120:123], v[220:223]
    v_exp_f32 v144, v144
    v_mfma_f32_16x16x32_bf16 v[216:219], a[236:239], a[124:127], v[216:219]
    v_exp_f32 v145, v145
    v_mfma_f32_16x16x32_bf16 v[212:215], a[236:239], a[128:131], v[212:215]
    s_waitcnt lgkmcnt(3)
    ds_read_b128 a[236:239], v225 offset:24512
    v_cvt_pk_bf16_f32 v162, v144, v145
    v_mfma_f32_16x16x32_bf16 v[220:223], a[240:243], a[132:135], v[220:223]
    v_exp_f32 v146, v146
    v_mfma_f32_16x16x32_bf16 v[216:219], a[240:243], a[136:139], v[216:219]
    v_exp_f32 v147, v147
    v_mfma_f32_16x16x32_bf16 v[212:215], a[240:243], a[140:143], v[212:215]
    ds_read_b128 a[240:243], v225 offset:24576
    v_cvt_pk_bf16_f32 v163, v146, v147
    v_mfma_f32_16x16x32_bf16 v[208:211], v[168:171], a[244:247], v[208:211]
    buffer_load_dwordx4 v246, s[4:7], s46 offen lds
    v_mfma_f32_16x16x32_bf16 v[196:199], a[216:219], v[160:163], 0
    s_add_u32 m0, s42, 0x1e40
    v_cvt_pk_bf16_f32 v82, v220, v221
    v_cvt_pk_bf16_f32 v83, v222, v223
    v_mfma_f32_16x16x32_bf16 v[184:187], v[76:79], v[160:163], 0
    v_cvt_pk_bf16_f32 v104, v216, v217
    v_cvt_pk_bf16_f32 v105, v218, v219
    v_mfma_f32_16x16x32_bf16 v[188:191], v[98:101], v[160:163], 0
    v_cvt_pk_bf16_f32 v126, v212, v213
    v_cvt_pk_bf16_f32 v127, v214, v215
    v_mfma_f32_16x16x32_bf16 v[192:195], v[120:123], v[160:163], 0
    s_waitcnt lgkmcnt(2)
    ds_read_b128 v[144:147], v235
    v_bfe_u32 v235, s69, v233, 4
    v_mfma_f32_16x16x32_bf16 v[156:159], v[54:57], v[138:141], v[156:159]
    v_mad_u32_u24 v235, v235, s40, v231
    v_mfma_f32_16x16x32_bf16 v[220:223], a[144:147], a[248:251], 0
    v_exp_f32 v148, v148
    v_mfma_f32_16x16x32_bf16 v[216:219], a[148:151], a[248:251], 0
    v_exp_f32 v149, v149
    v_mfma_f32_16x16x32_bf16 v[212:215], a[152:155], a[248:251], 0
    ds_read_b128 a[248:251], v225 offset:24640
    v_cvt_pk_bf16_f32 v160, v148, v149
    v_mfma_f32_16x16x16_bf16 v[156:159], v[58:59], v[142:143], v[156:159]
    buffer_load_dwordx4 v247, s[4:7], s46 offen lds
    v_mfma_f32_16x16x32_bf16 v[220:223], a[156:159], a[252:255], v[220:223]
    s_add_u32 m0, s41, 0x3c80
    v_exp_f32 v150, v150
    v_mfma_f32_16x16x32_bf16 v[216:219], a[160:163], a[252:255], v[216:219]
    v_exp_f32 v151, v151
    v_mfma_f32_16x16x32_bf16 v[212:215], a[164:167], a[252:255], v[212:215]
    s_waitcnt lgkmcnt(2)
    ds_read_b128 a[252:255], v225 offset:24704
    v_cvt_pk_bf16_f32 v161, v150, v151
    v_mfma_f32_16x16x32_bf16 v[220:223], a[168:171], a[236:239], v[220:223]
    s_waitcnt lgkmcnt(2)
    ds_read_b128 v[148:151], v234
    v_bfe_u32 v234, s70, v233, 4
    v_mfma_f32_16x16x32_bf16 v[144:147], v[60:63], v[138:141], v[144:147]
    v_mad_u32_u24 v234, v234, s40, v231
    v_mfma_f32_16x16x32_bf16 v[216:219], a[172:175], a[236:239], v[216:219]
    v_exp_f32 v152, v152
    v_mfma_f32_16x16x32_bf16 v[212:215], a[176:179], a[236:239], v[212:215]
    ds_read_b128 a[236:239], v224 offset:46464
    v_mfma_f32_16x16x32_bf16 v[220:223], a[180:183], a[240:243], v[220:223]
    v_exp_f32 v153, v153
    v_mfma_f32_16x16x16_bf16 v[144:147], v[64:65], v[142:143], v[144:147]
    v_exp_f32 v154, v154
    v_mfma_f32_16x16x32_bf16 v[216:219], a[184:187], a[240:243], v[216:219]
    v_exp_f32 v155, v155
    v_mfma_f32_16x16x32_bf16 v[212:215], a[188:191], a[240:243], v[212:215]
    s_waitcnt lgkmcnt(3)
    ds_read_b128 a[240:243], v224 offset:46528
    v_cvt_pk_bf16_f32 v162, v152, v153
    v_mfma_f32_16x16x32_bf16 v[220:223], a[192:195], a[248:251], v[220:223]
    v_cvt_pk_bf16_f32 v163, v154, v155
    v_mfma_f32_16x16x32_bf16 v[216:219], a[196:199], a[248:251], v[216:219]
    ds_read_b128 v[152:155], v228 offset:640
    v_mfma_f32_16x16x32_bf16 v[196:199], a[216:219], v[160:163], v[196:199]
    v_exp_f32 v156, v156
    v_mfma_f32_16x16x32_bf16 v[184:187], v[68:71], v[160:163], v[184:187]
    v_exp_f32 v157, v157
    v_mfma_f32_16x16x32_bf16 v[188:191], v[90:93], v[160:163], v[188:191]
    v_exp_f32 v158, v158
    v_mfma_f32_16x16x32_bf16 v[192:195], v[112:115], v[160:163], v[192:195]
    s_waitcnt lgkmcnt(2)
    v_exp_f32 v159, v159
    v_mfma_f32_16x16x32_bf16 v[148:151], v[48:51], v[138:141], v[148:151]
    v_cvt_pk_bf16_f32 v160, v156, v157
    v_cvt_pk_bf16_f32 v161, v158, v159
    v_mfma_f32_16x16x32_bf16 v[212:215], a[200:203], a[248:251], v[212:215]
    ds_read_b128 a[248:251], v224 offset:46592
    ds_read_b128 v[156:159], v229 offset:640
    v_mfma_f32_16x16x32_bf16 v[220:223], a[204:207], a[252:255], v[220:223]
    v_exp_f32 v144, v144
    v_mfma_f32_16x16x16_bf16 v[148:151], v[52:53], v[142:143], v[148:151]
    v_exp_f32 v145, v145
    v_mfma_f32_16x16x32_bf16 v[216:219], a[208:211], a[252:255], v[216:219]
    v_exp_f32 v146, v146
    v_mfma_f32_16x16x32_bf16 v[212:215], a[212:215], a[252:255], v[212:215]
    ds_read_b128 a[252:255], v224 offset:46656
    v_cvt_pk_bf16_f32 v162, v144, v145
    v_mfma_f32_16x16x32_bf16 v[200:203], v[168:171], v[252:255], v[200:203]
    v_mul_f32 v220, s37, v220
    v_mul_f32 v221, s37, v221
    v_mfma_f32_16x16x32_bf16 v[204:207], v[248:251], a[244:247], v[204:207]
    v_mul_f32 v222, s37, v222
    v_mul_f32 v223, s37, v223
    v_mfma_f32_16x16x32_bf16 v[180:183], v[248:251], v[252:255], v[180:183]
    v_cvt_pk_bf16_f32 v132, v220, v221
    v_cvt_pk_bf16_f32 v133, v222, v223
    v_mfma_f32_16x16x32_bf16 v[176:179], v[164:167], a[244:247], v[176:179]
    v_mul_f32 v216, s37, v216
    v_mul_f32 v217, s37, v217
    v_mfma_f32_16x16x32_bf16 v[220:223], a[0:3], a[236:239], 0
    s_waitcnt lgkmcnt(3)
    v_mul_f32 v218, s37, v218
    v_mul_f32 v219, s37, v219
    v_mfma_f32_16x16x32_bf16 v[220:223], a[12:15], a[240:243], v[220:223]
    v_cvt_pk_bf16_f32 v134, v216, v217
    v_cvt_pk_bf16_f32 v135, v218, v219
    v_mfma_f32_16x16x32_bf16 v[216:219], a[4:7], a[236:239], 0
    v_mul_f32 v212, s37, v212
    v_mul_f32 v213, s37, v213
    v_mfma_f32_16x16x32_bf16 v[152:155], v[0:3], v[132:135], v[152:155]
    s_waitcnt lgkmcnt(1)
    v_mul_f32 v214, s37, v214
    v_mul_f32 v215, s37, v215
    v_mfma_f32_16x16x32_bf16 v[156:159], v[24:27], v[132:135], v[156:159]
    v_cvt_pk_bf16_f32 v136, v212, v213
    v_cvt_pk_bf16_f32 v137, v214, v215
    v_mfma_f32_16x16x32_bf16 v[212:215], a[8:11], a[236:239], 0
    ds_read_b128 a[236:239], v224 offset:46720
    ds_read_b64_tr_b16 v[168:169], v242 offset:12296
    v_mfma_f32_16x16x16_bf16 v[152:155], v[4:5], v[136:137], v[152:155]
    ds_read_b64_tr_b16 v[170:171], v242 offset:26120
    ds_read_b128 v[252:255], v240 offset:2048
    v_mfma_f32_16x16x16_bf16 v[156:159], v[28:29], v[136:137], v[156:159]
    ds_read_b64_tr_b16 v[248:249], v241 offset:13824
    v_mfma_f32_16x16x32_bf16 v[216:219], a[16:19], a[240:243], v[216:219]
    ds_read_b64_tr_b16 v[250:251], v241 offset:24576
    v_mfma_f32_16x16x32_bf16 v[212:215], a[20:23], a[240:243], v[212:215]
    ds_read_b128 a[240:243], v224 offset:46784
    v_mfma_f32_16x16x32_bf16 v[220:223], a[24:27], a[248:251], v[220:223]
    ds_read_b64_tr_b16 v[164:165], v241 offset:13832
    v_mfma_f32_16x16x32_bf16 v[216:219], a[28:31], a[248:251], v[216:219]
    ds_read_b64_tr_b16 v[166:167], v241 offset:24584
    v_mfma_f32_16x16x32_bf16 v[212:215], a[32:35], a[248:251], v[212:215]
    s_waitcnt lgkmcnt(9)
    ds_read_b128 a[248:251], v224 offset:46464
    v_mfma_f32_16x16x32_bf16 v[220:223], a[36:39], a[252:255], v[220:223]
    v_exp_f32 v147, v147
    v_mfma_f32_16x16x32_bf16 v[216:219], a[40:43], a[252:255], v[216:219]
    v_cvt_pk_bf16_f32 v163, v146, v147
    v_mfma_f32_16x16x32_bf16 v[212:215], a[44:47], a[252:255], v[212:215]
    ds_read_b128 a[252:255], v224 offset:46528
    ds_read_b128 v[144:147], v229 offset:1280
    v_mfma_f32_16x16x32_bf16 v[196:199], a[216:219], v[160:163], v[196:199]
    v_exp_f32 v148, v148
    v_mfma_f32_16x16x32_bf16 v[184:187], v[84:87], v[160:163], v[184:187]
    v_exp_f32 v149, v149
    v_mfma_f32_16x16x32_bf16 v[188:191], v[106:109], v[160:163], v[188:191]
    v_exp_f32 v150, v150
    v_mfma_f32_16x16x32_bf16 v[192:195], v[128:131], v[160:163], v[192:195]
    s_waitcnt lgkmcnt(7)
    v_exp_f32 v151, v151
    v_mfma_f32_16x16x32_bf16 v[172:175], v[168:171], a[244:247], v[172:175]
    ds_read_b128 a[244:247], v239 offset:2048
    ds_read_b64_tr_b16 v[168:169], v242 offset:13824
    v_mfma_f32_16x16x32_bf16 v[220:223], a[48:51], a[236:239], v[220:223]
    ds_read_b64_tr_b16 v[170:171], v242 offset:24576
    v_cvt_pk_bf16_f32 v160, v148, v149
    v_mfma_f32_16x16x32_bf16 v[216:219], a[52:55], a[236:239], v[216:219]
    v_cvt_pk_bf16_f32 v161, v150, v151
    v_mfma_f32_16x16x32_bf16 v[212:215], a[56:59], a[236:239], v[212:215]
    ds_read_b128 a[236:239], v224 offset:46592
    ds_read_b128 v[148:151], v228 offset:1280
    v_mfma_f32_16x16x16_bf16 v[196:199], a[216:217], v[160:161], v[196:199]
    v_exp_f32 v152, v152
    v_mfma_f32_16x16x16_bf16 v[184:187], v[82:83], v[160:161], v[184:187]
    v_exp_f32 v153, v153
    v_mfma_f32_16x16x16_bf16 v[188:191], v[104:105], v[160:161], v[188:191]
    v_exp_f32 v154, v154
    v_mfma_f32_16x16x16_bf16 v[192:195], v[126:127], v[160:161], v[192:195]
    s_waitcnt lgkmcnt(5)
    v_exp_f32 v155, v155
    v_mfma_f32_16x16x32_bf16 v[144:147], v[30:33], v[132:135], v[144:147]
    v_rcp_f32 v197, v196
    v_mfma_f32_16x16x32_bf16 v[220:223], a[60:63], a[240:243], v[220:223]
    v_mul_f32 v184, v184, v197
    v_mul_f32 v185, v185, v197
    v_mfma_f32_16x16x32_bf16 v[216:219], a[64:67], a[240:243], v[216:219]
    v_cvt_pk_bf16_f32 v184, v184, v185
    v_mul_f32 v186, v186, v197
    v_mfma_f32_16x16x16_bf16 v[144:147], v[34:35], v[136:137], v[144:147]
    v_mul_f32 v187, v187, v197
    v_cvt_pk_bf16_f32 v185, v186, v187
    v_mfma_f32_16x16x32_bf16 v[212:215], a[68:71], a[240:243], v[212:215]
    s_waitcnt lgkmcnt(2)
    v_cvt_pk_bf16_f32 v18, v220, v221
    v_cvt_pk_bf16_f32 v19, v222, v223
    v_mfma_f32_16x16x32_bf16 v[208:211], v[248:251], a[244:247], v[208:211]
    s_waitcnt lgkmcnt(0)
    v_cvt_pk_bf16_f32 v20, v216, v217
    v_cvt_pk_bf16_f32 v21, v218, v219
    v_mfma_f32_16x16x32_bf16 v[148:151], v[6:9], v[132:135], v[148:151]
    ds_read_b128 a[240:243], v224 offset:46656
    v_mul_f32 v188, v188, v197
    v_mfma_f32_16x16x32_bf16 v[200:203], v[248:251], v[252:255], v[200:203]
    v_cvt_pk_bf16_f32 v22, v212, v213
    v_cvt_pk_bf16_f32 v23, v214, v215
    v_mfma_f32_16x16x32_bf16 v[204:207], v[164:167], a[244:247], v[204:207]
    v_mul_f32 v189, v189, v197
    v_cvt_pk_bf16_f32 v186, v188, v189
    v_mfma_f32_16x16x16_bf16 v[148:151], v[10:11], v[136:137], v[148:151]
    v_mul_f32 v190, v190, v197
    v_mul_f32 v191, v191, v197
    v_mfma_f32_16x16x32_bf16 v[180:183], v[164:167], v[252:255], v[180:183]
    v_cvt_pk_bf16_f32 v187, v190, v191
    v_mul_f32 v192, v192, v197
    v_mfma_f32_16x16x32_bf16 v[176:179], v[168:171], a[244:247], v[176:179]
    v_mul_f32 v193, v193, v197
    v_cvt_pk_bf16_f32 v188, v192, v193
    v_mfma_f32_16x16x32_bf16 v[220:223], a[248:251], a[72:75], 0
    v_mul_f32 v194, v194, v197
    v_mul_f32 v195, v195, v197
    v_mfma_f32_16x16x32_bf16 v[216:219], a[248:251], a[76:79], 0
    v_cvt_pk_bf16_f32 v189, v194, v195
    v_max3_f32 v236, v236, v196, v197
    v_mfma_f32_16x16x32_bf16 v[212:215], a[248:251], a[80:83], 0
    ds_read_b128 a[248:251], v224 offset:46720
    ds_read_b64_tr_b16 v[248:249], v242 offset:13832
    v_mfma_f32_16x16x32_bf16 v[220:223], a[252:255], a[84:87], v[220:223]
    ds_write_b128 v237, v[184:187] offset:18432
    v_mfma_f32_16x16x32_bf16 v[216:219], a[252:255], a[88:91], v[216:219]
    ds_write_b64 v238, v[188:189] offset:18432
    v_mfma_f32_16x16x32_bf16 v[212:215], a[252:255], a[92:95], v[212:215]
    ds_read_b128 a[252:255], v224 offset:46784
    ds_read_b64_tr_b16 v[250:251], v242 offset:24584
    v_mfma_f32_16x16x32_bf16 v[220:223], a[236:239], a[96:99], v[220:223]
    ds_read_b128 v[252:255], v240 offset:3072
    v_cvt_pk_bf16_f32 v160, v152, v153
    v_mfma_f32_16x16x32_bf16 v[216:219], a[236:239], a[100:103], v[216:219]
    ds_read_b64_tr_b16 v[164:165], v241 offset:36864
    v_cvt_pk_bf16_f32 v161, v154, v155
    v_mfma_f32_16x16x32_bf16 v[212:215], a[236:239], a[104:107], v[212:215]
    s_waitcnt lgkmcnt(8)
    ds_read_b128 a[236:239], v224 offset:49536
    v_mfma_f32_16x16x32_bf16 v[220:223], a[240:243], a[108:111], v[220:223]
    ds_read_b64_tr_b16 v[166:167], v241 offset:38400
    v_mfma_f32_16x16x32_bf16 v[216:219], a[240:243], a[112:115], v[216:219]
    ds_read_b64_tr_b16 v[168:169], v241 offset:36872
    v_mfma_f32_16x16x32_bf16 v[212:215], a[240:243], a[116:119], v[212:215]
    s_waitcnt lgkmcnt(10)
    ds_read_b128 a[240:243], v224 offset:49600
    v_mfma_f32_16x16x32_bf16 v[220:223], a[248:251], a[120:123], v[220:223]
    ds_read_b64_tr_b16 v[170:171], v241 offset:38408
    v_mfma_f32_16x16x32_bf16 v[216:219], a[248:251], a[124:127], v[216:219]
    ds_read_b128 v[152:155], v228 offset:1920
    v_mfma_f32_16x16x32_bf16 v[212:215], a[248:251], a[128:131], v[212:215]
    s_waitcnt lgkmcnt(9)
    v_exp_f32 v156, v156
    v_mfma_f32_16x16x32_bf16 v[220:223], a[252:255], a[132:135], v[220:223]
    s_waitcnt lgkmcnt(8)
    ds_read_b128 a[248:251], v224 offset:49664
    v_mfma_f32_16x16x32_bf16 v[172:175], v[248:251], a[244:247], v[172:175]
    ds_read_b128 a[244:247], v239 offset:3072
    v_mfma_f32_16x16x32_bf16 v[216:219], a[252:255], a[136:139], v[216:219]
    ds_read_b64_tr_b16 v[248:249], v242 offset:36864
    v_mfma_f32_16x16x32_bf16 v[212:215], a[252:255], a[140:143], v[212:215]
    s_waitcnt lgkmcnt(7)
    ds_read_b128 a[252:255], v224 offset:49728
    v_exp_f32 v157, v157
    v_cvt_pk_bf16_f32 v80, v220, v221
    v_mfma_f32_16x16x32_bf16 v[200:203], v[164:167], v[252:255], v[200:203]
    v_cvt_pk_bf16_f32 v81, v222, v223
    v_cvt_pk_bf16_f32 v162, v156, v157
    v_mfma_f32_16x16x32_bf16 v[220:223], a[0:3], a[236:239], 0
    v_cvt_pk_bf16_f32 v102, v216, v217
    v_cvt_pk_bf16_f32 v103, v218, v219
    v_mfma_f32_16x16x32_bf16 v[216:219], a[4:7], a[236:239], 0
    s_waitcnt lgkmcnt(5)
    v_cvt_pk_bf16_f32 v124, v212, v213
    v_cvt_pk_bf16_f32 v125, v214, v215
    v_mfma_f32_16x16x32_bf16 v[180:183], v[168:171], v[252:255], v[180:183]
    ds_read_b64_tr_b16 v[250:251], v242 offset:38400
    ds_read_b128 v[252:255], v240 offset:4096
    v_mfma_f32_16x16x32_bf16 v[212:215], a[8:11], a[236:239], 0
    s_waitcnt lgkmcnt(6)
    ds_read_b128 a[236:239], v224 offset:49792
    v_mfma_f32_16x16x32_bf16 v[152:155], v[12:15], v[132:135], v[152:155]
    v_exp_f32 v158, v158
    v_mfma_f32_16x16x32_bf16 v[220:223], a[12:15], a[240:243], v[220:223]
    s_waitcnt lgkmcnt(5)
    v_exp_f32 v159, v159
    v_mfma_f32_16x16x32_bf16 v[208:211], v[164:167], a[244:247], v[208:211]
    ds_read_b64_tr_b16 v[164:165], v242 offset:36872
    ds_read_b64_tr_b16 v[166:167], v242 offset:38408
    v_mfma_f32_16x16x16_bf16 v[152:155], v[16:17], v[136:137], v[152:155]
    v_cvt_pk_bf16_f32 v163, v158, v159
    v_mfma_f32_16x16x32_bf16 v[204:207], v[168:171], a[244:247], v[204:207]
    ds_read_b64_tr_b16 v[168:169], v241 offset:49152
    ds_read_b64_tr_b16 v[170:171], v241 offset:62976
    v_mfma_f32_16x16x32_bf16 v[196:199], a[216:219], v[160:163], 0
    ds_read_b128 v[156:159], v229 offset:1920
    v_mfma_f32_16x16x32_bf16 v[184:187], v[66:69], v[160:163], 0
    v_exp_f32 v144, v144
    v_mfma_f32_16x16x32_bf16 v[188:191], v[88:91], v[160:163], 0
    v_exp_f32 v145, v145
    v_mfma_f32_16x16x32_bf16 v[192:195], v[110:113], v[160:163], 0
    s_waitcnt lgkmcnt(7)
    v_exp_f32 v146, v146
    v_mfma_f32_16x16x32_bf16 v[176:179], v[248:251], a[244:247], v[176:179]
    ds_read_b64_tr_b16 v[248:249], v241 offset:49160
    ds_read_b64_tr_b16 v[250:251], v241 offset:62984
    v_mfma_f32_16x16x32_bf16 v[216:219], a[16:19], a[240:243], v[216:219]
    v_exp_f32 v147, v147
    v_mfma_f32_16x16x32_bf16 v[212:215], a[20:23], a[240:243], v[212:215]
    s_waitcnt lgkmcnt(5)
    ds_read_b128 a[240:243], v224 offset:49856
    v_cvt_pk_bf16_f32 v160, v144, v145
    v_mfma_f32_16x16x32_bf16 v[172:175], v[164:167], a[244:247], v[172:175]
    ds_read_b128 a[244:247], v239 offset:4096
    ds_read_b64_tr_b16 v[164:165], v242 offset:49152
    v_mfma_f32_16x16x32_bf16 v[220:223], a[24:27], a[248:251], v[220:223]
    ds_read_b64_tr_b16 v[166:167], v242 offset:62976
    v_cvt_pk_bf16_f32 v161, v146, v147
    v_mfma_f32_16x16x32_bf16 v[216:219], a[28:31], a[248:251], v[216:219]
    ds_read_b128 v[144:147], v229 offset:2560
    v_mfma_f32_16x16x32_bf16 v[212:215], a[32:35], a[248:251], v[212:215]
    s_waitcnt lgkmcnt(7)
    ds_read_b128 a[248:251], v224 offset:49536
    v_mfma_f32_16x16x32_bf16 v[156:159], v[36:39], v[132:135], v[156:159]
    v_exp_f32 v148, v148
    v_mfma_f32_16x16x32_bf16 v[220:223], a[36:39], a[252:255], v[220:223]
    v_exp_f32 v149, v149
    v_mfma_f32_16x16x32_bf16 v[216:219], a[40:43], a[252:255], v[216:219]
    v_exp_f32 v150, v150
    v_mfma_f32_16x16x32_bf16 v[212:215], a[44:47], a[252:255], v[212:215]
    ds_read_b128 a[252:255], v224 offset:49600
    v_cvt_pk_bf16_f32 v162, v148, v149
    v_mfma_f32_16x16x16_bf16 v[156:159], v[40:41], v[136:137], v[156:159]
    v_exp_f32 v151, v151
    v_mfma_f32_16x16x32_bf16 v[220:223], a[48:51], a[236:239], v[220:223]
    v_cvt_pk_bf16_f32 v163, v150, v151
    v_mfma_f32_16x16x32_bf16 v[216:219], a[52:55], a[236:239], v[216:219]
    ds_read_b128 v[148:151], v228 offset:2560
    v_mfma_f32_16x16x32_bf16 v[196:199], a[216:219], v[160:163], v[196:199]
    v_exp_f32 v152, v152
    v_mfma_f32_16x16x32_bf16 v[184:187], v[70:73], v[160:163], v[184:187]
    v_exp_f32 v153, v153
    v_mfma_f32_16x16x32_bf16 v[188:191], v[92:95], v[160:163], v[188:191]
    v_exp_f32 v154, v154
    v_mfma_f32_16x16x32_bf16 v[192:195], v[114:117], v[160:163], v[192:195]
    v_exp_f32 v155, v155
    v_mfma_f32_16x16x32_bf16 v[212:215], a[56:59], a[236:239], v[212:215]
    s_waitcnt lgkmcnt(2)
    ds_read_b128 a[236:239], v224 offset:49664
    v_cvt_pk_bf16_f32 v160, v152, v153
    v_mfma_f32_16x16x32_bf16 v[220:223], a[60:63], a[240:243], v[220:223]
    v_cvt_pk_bf16_f32 v161, v154, v155
    v_mfma_f32_16x16x32_bf16 v[216:219], a[64:67], a[240:243], v[216:219]
    ds_read_b128 v[152:155], v230 offset:640
    v_mfma_f32_16x16x32_bf16 v[212:215], a[68:71], a[240:243], v[212:215]
    ds_read_b128 a[240:243], v224 offset:49728
    v_mfma_f32_16x16x32_bf16 v[208:211], v[168:171], a[244:247], v[208:211]
    s_waitcnt lgkmcnt(3)
    v_exp_f32 v156, v156
    v_mfma_f32_16x16x32_bf16 v[148:151], v[18:21], v[132:135], v[148:151]
    v_cvt_pk_bf16_f32 v42, v220, v221
    v_cvt_pk_bf16_f32 v43, v222, v223
    v_mfma_f32_16x16x32_bf16 v[200:203], v[168:171], v[252:255], v[200:203]
    v_cvt_pk_bf16_f32 v44, v216, v217
    v_cvt_pk_bf16_f32 v45, v218, v219
    v_mfma_f32_16x16x32_bf16 v[204:207], v[248:251], a[244:247], v[204:207]
    v_cvt_pk_bf16_f32 v46, v212, v213
    v_cvt_pk_bf16_f32 v47, v214, v215
    v_mfma_f32_16x16x32_bf16 v[144:147], v[42:45], v[132:135], v[144:147]
L_pg6:
    s_cbranch_execz L_back
    ds_read_b64_tr_b16 v[168:169], v242 offset:49160
    ds_read_b64_tr_b16 v[170:171], v242 offset:62984
    v_mfma_f32_16x16x16_bf16 v[148:151], v[22:23], v[136:137], v[148:151]
    v_exp_f32 v157, v157
    v_mfma_f32_16x16x32_bf16 v[180:183], v[248:251], v[252:255], v[180:183]
    ds_read_b128 v[252:255], v240 offset:5120
    ds_read_b64_tr_b16 v[248:249], v241 offset:50688
    v_mfma_f32_16x16x16_bf16 v[144:147], v[46:47], v[136:137], v[144:147]
    ds_read_b64_tr_b16 v[250:251], v241 offset:61440
    v_cvt_pk_bf16_f32 v162, v156, v157
    v_mfma_f32_16x16x32_bf16 v[176:179], v[164:167], a[244:247], v[176:179]
    ds_read_b64_tr_b16 v[164:165], v241 offset:50696
    ds_read_b64_tr_b16 v[166:167], v241 offset:61448
    v_mfma_f32_16x16x32_bf16 v[220:223], a[248:251], a[72:75], 0
    v_exp_f32 v158, v158
    v_mfma_f32_16x16x32_bf16 v[216:219], a[248:251], a[76:79], 0
    v_exp_f32 v159, v159
    v_mfma_f32_16x16x32_bf16 v[212:215], a[248:251], a[80:83], 0
    ds_read_b128 a[248:251], v224 offset:49792
    v_cvt_pk_bf16_f32 v163, v158, v159
    v_mfma_f32_16x16x32_bf16 v[220:223], a[252:255], a[84:87], v[220:223]
    ds_read_b128 v[156:159], v230 offset:1280
    v_mfma_f32_16x16x32_bf16 v[196:199], a[216:219], v[160:163], v[196:199]
    v_exp_f32 v144, v144
    v_mfma_f32_16x16x32_bf16 v[184:187], v[74:77], v[160:163], v[184:187]
    v_exp_f32 v145, v145
    v_mfma_f32_16x16x32_bf16 v[188:191], v[96:99], v[160:163], v[188:191]
    v_exp_f32 v146, v146
    v_mfma_f32_16x16x32_bf16 v[192:195], v[118:121], v[160:163], v[192:195]
    s_waitcnt lgkmcnt(6)
    v_exp_f32 v147, v147
    v_mfma_f32_16x16x32_bf16 v[172:175], v[168:171], a[244:247], v[172:175]
    ds_read_b128 a[244:247], v239 offset:5120
    ds_read_b64_tr_b16 v[168:169], v242 offset:50688
    v_mfma_f32_16x16x32_bf16 v[216:219], a[252:255], a[88:91], v[216:219]
    ds_read_b64_tr_b16 v[170:171], v242 offset:61440
    v_cvt_pk_bf16_f32 v160, v144, v145
    v_mfma_f32_16x16x32_bf16 v[212:215], a[252:255], a[92:95], v[212:215]
    ds_read_b128 a[252:255], v224 offset:49856
    v_cvt_pk_bf16_f32 v161, v146, v147
    v_mfma_f32_16x16x32_bf16 v[220:223], a[236:239], a[96:99], v[220:223]
    ds_read_b128 v[144:147], v230 offset:1920
    v_mfma_f32_16x16x32_bf16 v[216:219], a[236:239], a[100:103], v[216:219]
    v_exp_f32 v148, v148
    v_mfma_f32_16x16x32_bf16 v[212:215], a[236:239], a[104:107], v[212:215]
    ds_read_b128 a[236:239], v225 offset:27456
    v_mfma_f32_16x16x32_bf16 v[220:223], a[240:243], a[108:111], v[220:223]
    v_exp_f32 v149, v149
    v_mfma_f32_16x16x32_bf16 v[216:219], a[240:243], a[112:115], v[216:219]
    v_exp_f32 v150, v150
    v_mfma_f32_16x16x32_bf16 v[212:215], a[240:243], a[116:119], v[212:215]
    s_waitcnt lgkmcnt(6)
    ds_read_b128 a[240:243], v225 offset:27520
    v_cvt_pk_bf16_f32 v162, v148, v149
    v_mfma_f32_16x16x32_bf16 v[220:223], a[248:251], a[120:123], v[220:223]
    v_exp_f32 v151, v151
    v_mfma_f32_16x16x32_bf16 v[216:219], a[248:251], a[124:127], v[216:219]
    v_cvt_pk_bf16_f32 v163, v150, v151
    v_mfma_f32_16x16x32_bf16 v[212:215], a[248:251], a[128:131], v[212:215]
    ds_read_b128 a[248:251], v225 offset:27584
    ds_read_b128 v[148:151], v230 offset:2560
    v_mfma_f32_16x16x32_bf16 v[196:199], a[216:219], v[160:163], v[196:199]
    s_waitcnt lgkmcnt(5)
    v_mfma_f32_16x16x32_bf16 v[220:223], a[252:255], a[132:135], v[220:223]
    v_mfma_f32_16x16x32_bf16 v[216:219], a[252:255], a[136:139], v[216:219]
    v_mfma_f32_16x16x32_bf16 v[212:215], a[252:255], a[140:143], v[212:215]
    ds_read_b128 a[252:255], v225 offset:27648
    v_mfma_f32_16x16x32_bf16 v[208:211], v[248:251], a[244:247], v[208:211]
    v_mfma_f32_16x16x32_bf16 v[200:203], v[248:251], v[252:255], v[200:203]
    ds_read_b64_tr_b16 v[248:249], v242 offset:50696
    ds_read_b64_tr_b16 v[250:251], v242 offset:61448
    v_mfma_f32_16x16x32_bf16 v[204:207], v[164:167], a[244:247], v[204:207]
    v_cvt_pk_bf16_f32 v78, v220, v221
    v_cvt_pk_bf16_f32 v79, v222, v223
    v_mfma_f32_16x16x32_bf16 v[180:183], v[164:167], v[252:255], v[180:183]
    v_cvt_pk_bf16_f32 v100, v216, v217
    v_cvt_pk_bf16_f32 v101, v218, v219
    v_mfma_f32_16x16x32_bf16 v[184:187], v[78:81], v[160:163], v[184:187]
    v_cvt_pk_bf16_f32 v122, v212, v213
    v_cvt_pk_bf16_f32 v123, v214, v215
    v_mfma_f32_16x16x32_bf16 v[188:191], v[100:103], v[160:163], v[188:191]
    v_cvt_pk_bf16_f32 v208, v208, v209
    v_cvt_pk_bf16_f32 v209, v210, v211
    v_mfma_f32_16x16x32_bf16 v[192:195], v[122:125], v[160:163], v[192:195]
    v_cvt_pk_bf16_f32 v210, v204, v205
    v_cvt_pk_bf16_f32 v211, v206, v207
    v_mfma_f32_16x16x32_bf16 v[176:179], v[168:171], a[244:247], v[176:179]
    s_waitcnt lgkmcnt(3)
    buffer_store_dwordx4 v[208:211], v243, s[20:23], s58 offen sc0 sc1
    v_mfma_f32_16x16x32_bf16 v[220:223], a[144:147], a[236:239], 0
    ds_read_b64_tr_b16 v[164:165], v241 offset:12288
    v_cvt_pk_bf16_f32 v200, v200, v201
    v_mfma_f32_16x16x32_bf16 v[216:219], a[148:151], a[236:239], 0
    s_waitcnt lgkmcnt(1)
    ds_read_b64_tr_b16 v[166:167], v241 offset:26112
    v_cvt_pk_bf16_f32 v201, v202, v203
    v_mfma_f32_16x16x32_bf16 v[172:175], v[248:251], a[244:247], v[172:175]
    v_cvt_pk_bf16_f32 v202, v180, v181
    v_cvt_pk_bf16_f32 v203, v182, v183
    v_mfma_f32_16x16x32_bf16 v[212:215], a[152:155], a[236:239], 0
    ds_read_b128 a[236:239], v225 offset:27712
    v_cvt_pk_bf16_f32 v176, v176, v177
    v_mfma_f32_16x16x32_bf16 v[220:223], a[156:159], a[240:243], v[220:223]
    ds_read_b64_tr_b16 v[168:169], v241 offset:12296
    v_cvt_pk_bf16_f32 v177, v178, v179
    v_mfma_f32_16x16x32_bf16 v[216:219], a[160:163], a[240:243], v[216:219]
    v_cvt_pk_bf16_f32 v178, v172, v173
    v_cvt_pk_bf16_f32 v179, v174, v175
    v_mfma_f32_16x16x32_bf16 v[212:215], a[164:167], a[240:243], v[212:215]
    ds_read_b128 a[240:243], v225 offset:27776
    ds_read_b64_tr_b16 v[170:171], v241 offset:26120
    v_mfma_f32_16x16x32_bf16 v[220:223], a[168:171], a[248:251], v[220:223]
    v_rcp_f32 v197, v196
    v_mfma_f32_16x16x32_bf16 v[216:219], a[172:175], a[248:251], v[216:219]
    v_mul_f32 v184, v184, v197
    v_mul_f32 v185, v185, v197
    v_mfma_f32_16x16x32_bf16 v[212:215], a[176:179], a[248:251], v[212:215]
    ds_read_b128 a[248:251], v225 offset:39872
    v_cvt_pk_bf16_f32 v184, v184, v185
    v_mfma_f32_16x16x32_bf16 v[220:223], a[180:183], a[252:255], v[220:223]
    v_mul_f32 v186, v186, v197
    v_mul_f32 v187, v187, v197
    v_mfma_f32_16x16x32_bf16 v[216:219], a[184:187], a[252:255], v[216:219]
    buffer_store_dwordx4 v[200:203], v245, s[20:23], s58 offen sc0 sc1
    v_mfma_f32_16x16x32_bf16 v[212:215], a[188:191], a[252:255], v[212:215]
    s_waitcnt lgkmcnt(4)
    ds_read_b128 a[252:255], v225 offset:39936
    v_cvt_pk_bf16_f32 v185, v186, v187
    v_mfma_f32_16x16x32_bf16 v[220:223], a[192:195], a[236:239], v[220:223]
    s_waitcnt vmcnt(2) lgkmcnt(3)
    v_mul_f32 v188, v188, v197
    v_mul_f32 v189, v189, v197
    v_mfma_f32_16x16x32_bf16 v[216:219], a[196:199], a[236:239], v[216:219]
    s_barrier
    v_cvt_pk_bf16_f32 v186, v188, v189
    v_mul_f32 v190, v190, v197
    v_mfma_f32_16x16x32_bf16 v[212:215], a[200:203], a[236:239], v[212:215]
    ds_read_b128 a[236:239], v225 offset:40000
    v_mul_f32 v191, v191, v197
    v_mfma_f32_16x16x32_bf16 v[220:223], a[204:207], a[240:243], v[220:223]
    v_cvt_pk_bf16_f32 v187, v190, v191
    v_mul_f32 v192, v192, v197
    v_mfma_f32_16x16x32_bf16 v[216:219], a[208:211], a[240:243], v[216:219]
    v_mul_f32 v193, v193, v197
    v_cvt_pk_bf16_f32 v188, v192, v193
    v_mfma_f32_16x16x32_bf16 v[212:215], a[212:215], a[240:243], v[212:215]
    s_waitcnt lgkmcnt(2)
    ds_read_b128 a[240:243], v225 offset:40064
    v_mul_f32 v194, v194, v197
    v_mul_f32 v220, s37, v220
    v_mul_f32 v221, s37, v221
    v_mul_f32 v222, s37, v222
    v_mul_f32 v223, s37, v223
    v_cvt_pk_bf16_f32 v138, v220, v221
    v_cvt_pk_bf16_f32 v139, v222, v223
    v_mfma_f32_16x16x32_bf16 v[220:223], a[144:147], a[248:251], 0
    s_waitcnt lgkmcnt(2)
    v_mul_f32 v216, s37, v216
    v_mul_f32 v217, s37, v217
    v_mfma_f32_16x16x32_bf16 v[220:223], a[156:159], a[252:255], v[220:223]
    v_mul_f32 v218, s37, v218
    v_mul_f32 v219, s37, v219
    v_cvt_pk_bf16_f32 v140, v216, v217
    v_cvt_pk_bf16_f32 v141, v218, v219
    v_mfma_f32_16x16x32_bf16 v[216:219], a[148:151], a[248:251], 0
    v_mul_f32 v212, s37, v212
    v_mul_f32 v213, s37, v213
    v_mfma_f32_16x16x32_bf16 v[152:155], v[24:27], v[138:141], v[152:155]
    v_mul_f32 v214, s37, v214
    v_mul_f32 v215, s37, v215
    v_mfma_f32_16x16x32_bf16 v[156:159], v[30:33], v[138:141], v[156:159]
    v_cvt_pk_bf16_f32 v142, v212, v213
    v_cvt_pk_bf16_f32 v143, v214, v215
    v_mfma_f32_16x16x32_bf16 v[144:147], v[36:39], v[138:141], v[144:147]
    buffer_store_dwordx4 v[176:179], v244, s[20:23], s58 offen sc0 sc1
    v_mfma_f32_16x16x16_bf16 v[152:155], v[28:29], v[142:143], v[152:155]
    s_add_u32 s58, s51, 0xfc000
    v_mul_f32 v195, v195, v197
    v_cvt_pk_bf16_f32 v189, v194, v195
    v_mfma_f32_16x16x16_bf16 v[156:159], v[34:35], v[142:143], v[156:159]
    ds_read_b128 a[244:247], v239 offset:12288
    v_max3_f32 v236, v236, v196, v197
    v_mfma_f32_16x16x16_bf16 v[144:147], v[40:41], v[142:143], v[144:147]
    ds_write_b128 v237, v[184:187]
    v_mfma_f32_16x16x32_bf16 v[148:151], v[42:45], v[138:141], v[148:151]
    ds_write_b64 v238, v[188:189]
    v_mfma_f32_16x16x32_bf16 v[212:215], a[152:155], a[248:251], 0
    ds_read_b128 a[248:251], v225 offset:40128
    ds_read_b128 v[252:255], v240 offset:12288
    v_mfma_f32_16x16x32_bf16 v[216:219], a[160:163], a[252:255], v[216:219]
    ds_read_b64_tr_b16 v[248:249], v242 offset:12288
    ds_read_b64_tr_b16 v[250:251], v242 offset:26112
    v_mfma_f32_16x16x16_bf16 v[148:151], v[46:47], v[142:143], v[148:151]
    v_exp_f32 v152, v152
    v_mfma_f32_16x16x32_bf16 v[212:215], a[164:167], a[252:255], v[212:215]
    s_waitcnt lgkmcnt(7)
    ds_read_b128 a[252:255], v225 offset:40192
    v_mfma_f32_16x16x32_bf16 v[220:223], a[168:171], a[236:239], v[220:223]
    v_exp_f32 v153, v153
    v_mfma_f32_16x16x32_bf16 v[216:219], a[172:175], a[236:239], v[216:219]
    v_exp_f32 v154, v154
    v_mfma_f32_16x16x32_bf16 v[212:215], a[176:179], a[236:239], v[212:215]
    ds_read_b128 a[236:239], v224
    v_cvt_pk_bf16_f32 v160, v152, v153
    v_mfma_f32_16x16x32_bf16 v[220:223], a[180:183], a[240:243], v[220:223]
    buffer_load_dwordx4 v246, s[4:7], s47 offen lds
    v_mfma_f32_16x16x32_bf16 v[216:219], a[184:187], a[240:243], v[216:219]
    s_add_u32 m0, s42, 0x3c80
    v_exp_f32 v155, v155
    v_mfma_f32_16x16x32_bf16 v[212:215], a[188:191], a[240:243], v[212:215]
    s_waitcnt lgkmcnt(5)
    ds_read_b128 a[240:243], v224 offset:64
    v_cvt_pk_bf16_f32 v161, v154, v155
    v_mfma_f32_16x16x32_bf16 v[220:223], a[192:195], a[248:251], v[220:223]
    ds_read_b128 v[152:155], v235
    v_bfe_u32 v235, s73, v232, 4
    v_mfma_f32_16x16x32_bf16 v[216:219], a[196:199], a[248:251], v[216:219]
    v_exp_f32 v156, v156
    v_mfma_f32_16x16x32_bf16 v[212:215], a[200:203], a[248:251], v[212:215]
    s_waitcnt lgkmcnt(3)
    ds_read_b128 a[248:251], v224 offset:128
    v_mfma_f32_16x16x32_bf16 v[220:223], a[204:207], a[252:255], v[220:223]
    v_exp_f32 v157, v157
    v_mfma_f32_16x16x32_bf16 v[216:219], a[208:211], a[252:255], v[216:219]
    v_exp_f32 v158, v158
    v_mfma_f32_16x16x32_bf16 v[212:215], a[212:215], a[252:255], v[212:215]
    ds_read_b128 a[252:255], v224 offset:192
    v_cvt_pk_bf16_f32 v162, v156, v157
    v_mfma_f32_16x16x32_bf16 v[208:211], a[220:223], a[244:247], 0
    buffer_load_dwordx4 v247, s[4:7], s47 offen lds
    v_mfma_f32_16x16x32_bf16 v[200:203], a[220:223], v[252:255], 0
    s_add_u32 m0, s41, 0x5ac0
    v_mul_f32 v220, s37, v220
    v_mul_f32 v221, s37, v221
    v_mfma_f32_16x16x32_bf16 v[204:207], a[224:227], a[244:247], 0
    v_mul_f32 v222, s37, v222
    v_mul_f32 v223, s37, v223
    v_mfma_f32_16x16x32_bf16 v[180:183], a[224:227], v[252:255], 0
    s_waitcnt lgkmcnt(2)
    v_cvt_pk_bf16_f32 v132, v220, v221
    v_cvt_pk_bf16_f32 v133, v222, v223
    v_mfma_f32_16x16x32_bf16 v[152:155], v[60:63], v[138:141], v[152:155]
    v_mul_f32 v216, s37, v216
    v_mul_f32 v217, s37, v217
    v_mfma_f32_16x16x32_bf16 v[176:179], a[228:231], a[244:247], 0
    v_mul_f32 v218, s37, v218
    v_mul_f32 v219, s37, v219
    v_mfma_f32_16x16x32_bf16 v[172:175], a[232:235], a[244:247], 0
    v_cvt_pk_bf16_f32 v134, v216, v217
    v_cvt_pk_bf16_f32 v135, v218, v219
    v_mfma_f32_16x16x16_bf16 v[152:155], v[64:65], v[142:143], v[152:155]
    v_mul_f32 v212, s37, v212
    v_mul_f32 v213, s37, v213
    v_mfma_f32_16x16x32_bf16 v[220:223], a[0:3], a[236:239], 0
    v_mul_f32 v214, s37, v214
    v_mul_f32 v215, s37, v215
    v_mfma_f32_16x16x32_bf16 v[216:219], a[4:7], a[236:239], 0
    v_cvt_pk_bf16_f32 v136, v212, v213
    v_cvt_pk_bf16_f32 v137, v214, v215
    v_mfma_f32_16x16x32_bf16 v[212:215], a[8:11], a[236:239], 0
    ds_read_b128 a[236:239], v224 offset:256
    ds_read_b128 a[244:247], v239 offset:13312
    v_mfma_f32_16x16x32_bf16 v[220:223], a[12:15], a[240:243], v[220:223]
    buffer_load_dwordx4 v246, s[4:7], s48 offen lds
    v_mfma_f32_16x16x32_bf16 v[216:219], a[16:19], a[240:243], v[216:219]
    s_add_u32 m0, s42, 0x5ac0
    ds_read_b128 v[252:255], v240 offset:13312
    v_cndmask_b32 v246, v245, v243, vcc
    v_mfma_f32_16x16x32_bf16 v[212:215], a[20:23], a[240:243], v[212:215]
    s_waitcnt lgkmcnt(3)
    ds_read_b128 a[240:243], v224 offset:320
    v_mfma_f32_16x16x32_bf16 v[220:223], a[24:27], a[248:251], v[220:223]
    v_exp_f32 v159, v159
    v_mfma_f32_16x16x32_bf16 v[216:219], a[28:31], a[248:251], v[216:219]
    v_cvt_pk_bf16_f32 v163, v158, v159
    v_mfma_f32_16x16x32_bf16 v[212:215], a[32:35], a[248:251], v[212:215]
    ds_read_b128 a[248:251], v224
    ds_read_b128 v[156:159], v234
    v_mfma_f32_16x16x32_bf16 v[196:199], a[216:219], v[160:163], 0
    v_mad_u32_u24 v234, v235, s40, v229
    v_mad_u32_u24 v235, v235, s40, v228
    v_mfma_f32_16x16x32_bf16 v[184:187], v[68:71], v[160:163], 0
    v_exp_f32 v144, v144
    v_mfma_f32_16x16x32_bf16 v[188:191], v[90:93], v[160:163], 0
    buffer_load_dwordx4 v247, s[4:7], s48 offen lds
    v_mfma_f32_16x16x32_bf16 v[192:195], v[112:115], v[160:163], 0
    v_bfrev_b32 v247, 1
    v_mfma_f32_16x16x32_bf16 v[220:223], a[36:39], a[252:255], v[220:223]
    v_exp_f32 v145, v145
    v_mfma_f32_16x16x32_bf16 v[216:219], a[40:43], a[252:255], v[216:219]
    v_exp_f32 v146, v146
    v_mfma_f32_16x16x32_bf16 v[212:215], a[44:47], a[252:255], v[212:215]
    s_waitcnt lgkmcnt(2)
    ds_read_b128 a[252:255], v224 offset:64
    v_cvt_pk_bf16_f32 v160, v144, v145
    v_mfma_f32_16x16x32_bf16 v[220:223], a[48:51], a[236:239], v[220:223]
    v_exp_f32 v147, v147
    v_mfma_f32_16x16x32_bf16 v[216:219], a[52:55], a[236:239], v[216:219]
    v_cvt_pk_bf16_f32 v161, v146, v147
    v_mfma_f32_16x16x32_bf16 v[212:215], a[56:59], a[236:239], v[212:215]
    s_waitcnt lgkmcnt(1)
    ds_read_b128 a[236:239], v224 offset:128
    ds_read_b128 v[144:147], v234
    v_mfma_f32_16x16x32_bf16 v[156:159], v[48:51], v[138:141], v[156:159]
    v_exp_f32 v148, v148
    v_mfma_f32_16x16x32_bf16 v[220:223], a[60:63], a[240:243], v[220:223]
    v_exp_f32 v149, v149
    v_mfma_f32_16x16x32_bf16 v[216:219], a[64:67], a[240:243], v[216:219]
    v_exp_f32 v150, v150
    v_mfma_f32_16x16x32_bf16 v[212:215], a[68:71], a[240:243], v[212:215]
    ds_read_b128 a[240:243], v224 offset:192
    v_cvt_pk_bf16_f32 v162, v148, v149
    v_mfma_f32_16x16x16_bf16 v[156:159], v[52:53], v[142:143], v[156:159]
    v_exp_f32 v151, v151
    v_mfma_f32_16x16x32_bf16 v[208:211], v[164:167], a[244:247], v[208:211]
    v_cvt_pk_bf16_f32 v0, v220, v221
    v_cvt_pk_bf16_f32 v1, v222, v223
    v_mfma_f32_16x16x32_bf16 v[200:203], v[164:167], v[252:255], v[200:203]
    v_cvt_pk_bf16_f32 v2, v216, v217
    v_cvt_pk_bf16_f32 v3, v218, v219
    v_mfma_f32_16x16x32_bf16 v[204:207], v[168:171], a[244:247], v[204:207]
    v_cvt_pk_bf16_f32 v4, v212, v213
    v_cvt_pk_bf16_f32 v5, v214, v215
    v_mfma_f32_16x16x32_bf16 v[180:183], v[168:171], v[252:255], v[180:183]
    ds_read_b64_tr_b16 v[164:165], v242 offset:12296
    ds_read_b64_tr_b16 v[166:167], v242 offset:26120
    v_mfma_f32_16x16x32_bf16 v[176:179], v[248:251], a[244:247], v[176:179]
    s_waitcnt lgkmcnt(3)
    ds_read_b128 v[252:255], v240 offset:14336
    ds_read_b64_tr_b16 v[168:169], v241 offset:13824
    v_mfma_f32_16x16x32_bf16 v[144:147], v[30:33], v[132:135], v[144:147]
    ds_read_b64_tr_b16 v[170:171], v241 offset:24576
    v_cvt_pk_bf16_f32 v163, v150, v151
    v_mfma_f32_16x16x32_bf16 v[220:223], a[248:251], a[72:75], 0
    ds_read_b64_tr_b16 v[248:249], v241 offset:13832
    v_mfma_f32_16x16x32_bf16 v[196:199], a[216:219], v[160:163], v[196:199]
    ds_read_b64_tr_b16 v[250:251], v241 offset:24584
    v_mfma_f32_16x16x32_bf16 v[184:187], v[76:79], v[160:163], v[184:187]
    ds_read_b128 v[148:151], v235
    v_bfe_u32 v235, s74, v232, 4
    v_mfma_f32_16x16x32_bf16 v[188:191], v[98:101], v[160:163], v[188:191]
    v_mad_u32_u24 v234, v235, s40, v228
    v_mad_u32_u24 v235, v235, s40, v229
    v_mfma_f32_16x16x32_bf16 v[192:195], v[120:123], v[160:163], v[192:195]
    v_exp_f32 v152, v152
    v_mfma_f32_16x16x16_bf16 v[144:147], v[34:35], v[136:137], v[144:147]
    v_exp_f32 v153, v153
    v_mfma_f32_16x16x32_bf16 v[216:219], a[248:251], a[76:79], 0
    s_waitcnt lgkmcnt(6)
    v_exp_f32 v154, v154
    v_mfma_f32_16x16x32_bf16 v[172:175], v[164:167], a[244:247], v[172:175]
    ds_read_b128 a[244:247], v239 offset:14336
    ds_read_b64_tr_b16 v[164:165], v242 offset:13824
    v_mfma_f32_16x16x32_bf16 v[212:215], a[248:251], a[80:83], 0
    ds_read_b128 a[248:251], v224 offset:256
    ds_read_b64_tr_b16 v[166:167], v242 offset:24576
    v_mfma_f32_16x16x32_bf16 v[220:223], a[252:255], a[84:87], v[220:223]
    v_exp_f32 v155, v155
    v_mfma_f32_16x16x32_bf16 v[216:219], a[252:255], a[88:91], v[216:219]
    v_cvt_pk_bf16_f32 v160, v152, v153
    v_cvt_pk_bf16_f32 v161, v154, v155
    v_mfma_f32_16x16x32_bf16 v[212:215], a[252:255], a[92:95], v[212:215]
    ds_read_b128 a[252:255], v224 offset:320
    ds_read_b128 v[152:155], v228 offset:1280
    v_mfma_f32_16x16x16_bf16 v[196:199], a[216:217], v[160:161], v[196:199]
    v_exp_f32 v156, v156
    v_mfma_f32_16x16x16_bf16 v[184:187], v[86:87], v[160:161], v[184:187]
    v_exp_f32 v157, v157
    v_mfma_f32_16x16x16_bf16 v[188:191], v[108:109], v[160:161], v[188:191]
    v_exp_f32 v158, v158
    v_mfma_f32_16x16x16_bf16 v[192:195], v[130:131], v[160:161], v[192:195]
    s_waitcnt lgkmcnt(6)
    v_exp_f32 v159, v159
    v_mfma_f32_16x16x32_bf16 v[148:151], v[6:9], v[132:135], v[148:151]
    v_cvt_pk_bf16_f32 v160, v156, v157
    v_cvt_pk_bf16_f32 v161, v158, v159
    v_mfma_f32_16x16x32_bf16 v[220:223], a[236:239], a[96:99], v[220:223]
    ds_read_b128 v[156:159], v229 offset:1280
    v_mfma_f32_16x16x16_bf16 v[196:199], a[216:217], v[160:161], v[196:199]
    v_exp_f32 v144, v144
    v_mfma_f32_16x16x16_bf16 v[184:187], v[82:83], v[160:161], v[184:187]
    v_exp_f32 v145, v145
    v_mfma_f32_16x16x16_bf16 v[188:191], v[104:105], v[160:161], v[188:191]
    v_exp_f32 v146, v146
    v_mfma_f32_16x16x16_bf16 v[192:195], v[126:127], v[160:161], v[192:195]
    v_exp_f32 v147, v147
    v_mfma_f32_16x16x16_bf16 v[148:151], v[10:11], v[136:137], v[148:151]
    s_waitcnt lgkmcnt(1)
    v_rcp_f32 v197, v196
    v_mfma_f32_16x16x32_bf16 v[152:155], v[12:15], v[132:135], v[152:155]
    v_mul_f32 v184, v184, v197
    v_mul_f32 v185, v185, v197
    v_mfma_f32_16x16x32_bf16 v[216:219], a[236:239], a[100:103], v[216:219]
    v_cvt_pk_bf16_f32 v184, v184, v185
    v_mul_f32 v186, v186, v197
    v_mfma_f32_16x16x32_bf16 v[212:215], a[236:239], a[104:107], v[212:215]
    ds_read_b128 a[236:239], v224 offset:3072
    v_mul_f32 v187, v187, v197
    v_mfma_f32_16x16x16_bf16 v[152:155], v[16:17], v[136:137], v[152:155]
    s_waitcnt lgkmcnt(1)
    v_cvt_pk_bf16_f32 v185, v186, v187
    v_mul_f32 v188, v188, v197
    v_mfma_f32_16x16x32_bf16 v[156:159], v[36:39], v[132:135], v[156:159]
    v_mul_f32 v189, v189, v197
    v_cvt_pk_bf16_f32 v186, v188, v189
    v_mfma_f32_16x16x32_bf16 v[220:223], a[240:243], a[108:111], v[220:223]
    v_mul_f32 v190, v190, v197
    v_mul_f32 v191, v191, v197
    v_mfma_f32_16x16x32_bf16 v[216:219], a[240:243], a[112:115], v[216:219]
    v_cvt_pk_bf16_f32 v187, v190, v191
    v_mul_f32 v192, v192, v197
    v_mfma_f32_16x16x16_bf16 v[156:159], v[40:41], v[136:137], v[156:159]
    v_mul_f32 v193, v193, v197
    v_cvt_pk_bf16_f32 v188, v192, v193
    v_mfma_f32_16x16x32_bf16 v[212:215], a[240:243], a[116:119], v[212:215]
    ds_read_b128 a[240:243], v224 offset:3136
    v_mul_f32 v194, v194, v197
    v_mfma_f32_16x16x32_bf16 v[220:223], a[248:251], a[120:123], v[220:223]
    v_mul_f32 v195, v195, v197
    v_cvt_pk_bf16_f32 v189, v194, v195
    v_mfma_f32_16x16x32_bf16 v[216:219], a[248:251], a[124:127], v[216:219]
    v_max3_f32 v236, v236, v196, v197
    v_cvt_pk_bf16_f32 v160, v144, v145
    v_mfma_f32_16x16x32_bf16 v[212:215], a[248:251], a[128:131], v[212:215]
    ds_read_b128 a[248:251], v224 offset:3200
    v_cvt_pk_bf16_f32 v161, v146, v147
    v_mfma_f32_16x16x32_bf16 v[220:223], a[252:255], a[132:135], v[220:223]
    ds_write_b128 v237, v[184:187] offset:6144
    v_mfma_f32_16x16x32_bf16 v[216:219], a[252:255], a[136:139], v[216:219]
    ds_write_b64 v238, v[188:189] offset:6144
    v_mfma_f32_16x16x32_bf16 v[212:215], a[252:255], a[140:143], v[212:215]
    ds_read_b128 a[252:255], v224 offset:3264
    ds_read_b128 v[144:147], v229 offset:1920
    v_mfma_f32_16x16x32_bf16 v[208:211], v[168:171], a[244:247], v[208:211]
    v_exp_f32 v148, v148
    v_mfma_f32_16x16x32_bf16 v[200:203], v[168:171], v[252:255], v[200:203]
    v_cvt_pk_bf16_f32 v66, v220, v221
    v_cvt_pk_bf16_f32 v67, v222, v223
    v_mfma_f32_16x16x32_bf16 v[204:207], v[248:251], a[244:247], v[204:207]
    v_cvt_pk_bf16_f32 v88, v216, v217
    v_cvt_pk_bf16_f32 v89, v218, v219
    v_mfma_f32_16x16x32_bf16 v[180:183], v[248:251], v[252:255], v[180:183]
    v_cvt_pk_bf16_f32 v110, v212, v213
    v_cvt_pk_bf16_f32 v111, v214, v215
    v_mfma_f32_16x16x32_bf16 v[176:179], v[164:167], a[244:247], v[176:179]
    s_waitcnt lgkmcnt(5)
    ds_read_b64_tr_b16 v[168:169], v242 offset:13832
    ds_read_b64_tr_b16 v[170:171], v242 offset:24584
    v_mfma_f32_16x16x32_bf16 v[220:223], a[0:3], a[236:239], 0
    ds_read_b128 v[252:255], v240 offset:15360
    ds_read_b64_tr_b16 v[248:249], v241 offset:36864
    v_mfma_f32_16x16x32_bf16 v[216:219], a[4:7], a[236:239], 0
    ds_read_b64_tr_b16 v[250:251], v241 offset:38400
    v_mfma_f32_16x16x32_bf16 v[212:215], a[8:11], a[236:239], 0
    ds_read_b128 a[236:239], v224 offset:3328
    v_mfma_f32_16x16x32_bf16 v[220:223], a[12:15], a[240:243], v[220:223]
    ds_read_b64_tr_b16 v[164:165], v241 offset:36872
    v_mfma_f32_16x16x32_bf16 v[216:219], a[16:19], a[240:243], v[216:219]
    s_waitcnt lgkmcnt(7)
    ds_read_b64_tr_b16 v[166:167], v241 offset:38408
    v_mfma_f32_16x16x32_bf16 v[144:147], v[42:45], v[132:135], v[144:147]
    v_exp_f32 v149, v149
    v_mfma_f32_16x16x32_bf16 v[212:215], a[20:23], a[240:243], v[212:215]
    ds_read_b128 a[240:243], v224 offset:3392
    v_cvt_pk_bf16_f32 v162, v148, v149
    v_mfma_f32_16x16x32_bf16 v[220:223], a[24:27], a[248:251], v[220:223]
    v_exp_f32 v150, v150
    v_mfma_f32_16x16x16_bf16 v[144:147], v[46:47], v[136:137], v[144:147]
    s_waitcnt lgkmcnt(7)
    v_exp_f32 v151, v151
    v_mfma_f32_16x16x32_bf16 v[172:175], v[168:171], a[244:247], v[172:175]
    ds_read_b128 a[244:247], v239 offset:15360
    ds_read_b64_tr_b16 v[168:169], v242 offset:36864
    v_mfma_f32_16x16x32_bf16 v[216:219], a[28:31], a[248:251], v[216:219]
    ds_read_b64_tr_b16 v[170:171], v242 offset:38400
    v_cvt_pk_bf16_f32 v163, v150, v151
    v_mfma_f32_16x16x32_bf16 v[212:215], a[32:35], a[248:251], v[212:215]
    ds_read_b128 a[248:251], v224 offset:3072
    ds_read_b128 v[148:151], v228 offset:1920
    v_mfma_f32_16x16x32_bf16 v[196:199], a[216:219], v[160:163], 0
    v_exp_f32 v152, v152
    v_mfma_f32_16x16x32_bf16 v[184:187], v[70:73], v[160:163], 0
    v_exp_f32 v153, v153
    v_mfma_f32_16x16x32_bf16 v[188:191], v[92:95], v[160:163], 0
    v_exp_f32 v154, v154
    v_mfma_f32_16x16x32_bf16 v[192:195], v[114:117], v[160:163], 0
    v_exp_f32 v155, v155
    v_mfma_f32_16x16x32_bf16 v[220:223], a[36:39], a[252:255], v[220:223]
    v_cvt_pk_bf16_f32 v160, v152, v153
    v_cvt_pk_bf16_f32 v161, v154, v155
    v_mfma_f32_16x16x32_bf16 v[216:219], a[40:43], a[252:255], v[216:219]
    ds_read_b128 v[152:155], v234
    v_bfe_u32 v234, s73, v232, 4
    v_mfma_f32_16x16x32_bf16 v[212:215], a[44:47], a[252:255], v[212:215]
    s_waitcnt lgkmcnt(6)
    ds_read_b128 a[252:255], v224 offset:3136
    v_mad_u32_u24 v234, v234, s40, v230
    v_mfma_f32_16x16x32_bf16 v[220:223], a[48:51], a[236:239], v[220:223]
    v_exp_f32 v156, v156
    v_mfma_f32_16x16x32_bf16 v[216:219], a[52:55], a[236:239], v[216:219]
    v_exp_f32 v157, v157
    v_mfma_f32_16x16x32_bf16 v[212:215], a[56:59], a[236:239], v[212:215]
    ds_read_b128 a[236:239], v224 offset:3200
    v_cvt_pk_bf16_f32 v162, v156, v157
    v_mfma_f32_16x16x32_bf16 v[220:223], a[60:63], a[240:243], v[220:223]
    s_waitcnt lgkmcnt(3)
    v_exp_f32 v158, v158
    v_mfma_f32_16x16x32_bf16 v[148:151], v[18:21], v[132:135], v[148:151]
    v_exp_f32 v159, v159
    v_mfma_f32_16x16x32_bf16 v[216:219], a[64:67], a[240:243], v[216:219]
    v_cvt_pk_bf16_f32 v163, v158, v159
    v_mfma_f32_16x16x32_bf16 v[212:215], a[68:71], a[240:243], v[212:215]
    ds_read_b128 a[240:243], v224 offset:3264
    ds_read_b128 v[156:159], v235
    v_mfma_f32_16x16x32_bf16 v[196:199], a[216:219], v[160:163], v[196:199]
    v_cvt_pk_bf16_f32 v24, v220, v221
    v_cvt_pk_bf16_f32 v25, v222, v223
    v_mfma_f32_16x16x32_bf16 v[184:187], v[74:77], v[160:163], v[184:187]
    v_cvt_pk_bf16_f32 v26, v216, v217
    v_cvt_pk_bf16_f32 v27, v218, v219
    v_mfma_f32_16x16x32_bf16 v[188:191], v[96:99], v[160:163], v[188:191]
    v_cvt_pk_bf16_f32 v28, v212, v213
    v_cvt_pk_bf16_f32 v29, v214, v215
    v_mfma_f32_16x16x32_bf16 v[192:195], v[118:121], v[160:163], v[192:195]
    v_bfe_u32 v235, s74, v232, 4
    v_mad_u32_u24 v235, v235, s40, v230
    v_mfma_f32_16x16x16_bf16 v[148:151], v[22:23], v[136:137], v[148:151]
    s_waitcnt lgkmcnt(3)
    v_exp_f32 v144, v144
    v_mfma_f32_16x16x32_bf16 v[152:155], v[0:3], v[132:135], v[152:155]
    v_exp_f32 v145, v145
    v_mfma_f32_16x16x32_bf16 v[208:211], v[248:251], a[244:247], v[208:211]
    v_exp_f32 v146, v146
    v_mfma_f32_16x16x32_bf16 v[200:203], v[248:251], v[252:255], v[200:203]
    ds_read_b64_tr_b16 v[248:249], v242 offset:36872
    ds_read_b64_tr_b16 v[250:251], v242 offset:38408
    v_mfma_f32_16x16x16_bf16 v[152:155], v[4:5], v[136:137], v[152:155]
    v_exp_f32 v147, v147
    v_mfma_f32_16x16x32_bf16 v[204:207], v[164:167], a[244:247], v[204:207]
    s_waitcnt lgkmcnt(2)
    v_cvt_pk_bf16_f32 v160, v144, v145
    v_cvt_pk_bf16_f32 v161, v146, v147
    v_mfma_f32_16x16x32_bf16 v[156:159], v[24:27], v[132:135], v[156:159]
    ds_read_b128 v[144:147], v235
    v_bfe_u32 v235, s67, v233, 4
    v_mfma_f32_16x16x32_bf16 v[180:183], v[164:167], v[252:255], v[180:183]
    ds_read_b128 v[252:255], v240 offset:16384
    ds_read_b64_tr_b16 v[164:165], v241 offset:49152
    v_mfma_f32_16x16x32_bf16 v[176:179], v[168:171], a[244:247], v[176:179]
    ds_read_b64_tr_b16 v[166:167], v241 offset:62976
    v_mad_u32_u24 v235, v235, s40, v231
    v_mfma_f32_16x16x16_bf16 v[156:159], v[28:29], v[136:137], v[156:159]
    ds_read_b64_tr_b16 v[168:169], v241 offset:49160
    v_mfma_f32_16x16x32_bf16 v[220:223], a[248:251], a[72:75], 0
    ds_read_b64_tr_b16 v[170:171], v241 offset:62984
    v_mfma_f32_16x16x32_bf16 v[216:219], a[248:251], a[76:79], 0
    v_exp_f32 v148, v148
    v_mfma_f32_16x16x32_bf16 v[212:215], a[248:251], a[80:83], 0
    s_waitcnt lgkmcnt(6)
    ds_read_b128 a[248:251], v224 offset:3328
    v_mfma_f32_16x16x32_bf16 v[172:175], v[248:251], a[244:247], v[172:175]
    ds_read_b128 a[244:247], v239 offset:16384
    ds_read_b64_tr_b16 v[248:249], v242 offset:49152
    v_mfma_f32_16x16x32_bf16 v[220:223], a[252:255], a[84:87], v[220:223]
    ds_read_b64_tr_b16 v[250:251], v242 offset:62976
    v_mfma_f32_16x16x32_bf16 v[216:219], a[252:255], a[88:91], v[216:219]
    v_exp_f32 v149, v149
    v_mfma_f32_16x16x32_bf16 v[212:215], a[252:255], a[92:95], v[212:215]
    ds_read_b128 a[252:255], v224 offset:3392
    v_cvt_pk_bf16_f32 v162, v148, v149
    v_mfma_f32_16x16x32_bf16 v[220:223], a[236:239], a[96:99], v[220:223]
    v_exp_f32 v150, v150
    v_mfma_f32_16x16x32_bf16 v[216:219], a[236:239], a[100:103], v[216:219]
    v_exp_f32 v151, v151
    v_mfma_f32_16x16x32_bf16 v[212:215], a[236:239], a[104:107], v[212:215]
    ds_read_b128 a[236:239], v225 offset:42944
    v_cvt_pk_bf16_f32 v163, v150, v151
    v_mfma_f32_16x16x32_bf16 v[220:223], a[240:243], a[108:111], v[220:223]
    ds_read_b128 v[148:151], v234
    v_bfe_u32 v234, s75, v233, 4
    v_mfma_f32_16x16x32_bf16 v[196:199], a[216:219], v[160:163], v[196:199]
L_pg7:
    s_cbranch_execz L_back
    v_mad_u32_u24 v234, v234, s40, v231
    v_mfma_f32_16x16x32_bf16 v[184:187], v[78:81], v[160:163], v[184:187]
    v_exp_f32 v152, v152
    v_mfma_f32_16x16x32_bf16 v[188:191], v[100:103], v[160:163], v[188:191]
    v_exp_f32 v153, v153
    v_mfma_f32_16x16x32_bf16 v[192:195], v[122:125], v[160:163], v[192:195]
    v_exp_f32 v154, v154
    v_mfma_f32_16x16x32_bf16 v[216:219], a[240:243], a[112:115], v[216:219]
    v_exp_f32 v155, v155
    v_mfma_f32_16x16x32_bf16 v[212:215], a[240:243], a[116:119], v[212:215]
    s_waitcnt lgkmcnt(3)
    ds_read_b128 a[240:243], v225 offset:43008
    v_cvt_pk_bf16_f32 v160, v152, v153
    v_mfma_f32_16x16x32_bf16 v[220:223], a[248:251], a[120:123], v[220:223]
    v_cvt_pk_bf16_f32 v161, v154, v155
    v_mfma_f32_16x16x32_bf16 v[216:219], a[248:251], a[124:127], v[216:219]
    ds_read_b128 v[152:155], v230 offset:1280
    v_mfma_f32_16x16x32_bf16 v[212:215], a[248:251], a[128:131], v[212:215]
    s_waitcnt lgkmcnt(3)
    ds_read_b128 a[248:251], v225 offset:43072
    v_mfma_f32_16x16x32_bf16 v[220:223], a[252:255], a[132:135], v[220:223]
    v_exp_f32 v156, v156
    v_mfma_f32_16x16x32_bf16 v[216:219], a[252:255], a[136:139], v[216:219]
    v_exp_f32 v157, v157
    v_mfma_f32_16x16x32_bf16 v[212:215], a[252:255], a[140:143], v[212:215]
    ds_read_b128 a[252:255], v225 offset:43136
    v_cvt_pk_bf16_f32 v162, v156, v157
    v_mfma_f32_16x16x32_bf16 v[208:211], v[164:167], a[244:247], v[208:211]
    v_exp_f32 v158, v158
    v_mfma_f32_16x16x32_bf16 v[200:203], v[164:167], v[252:255], v[200:203]
    v_cvt_pk_bf16_f32 v68, v220, v221
    v_cvt_pk_bf16_f32 v69, v222, v223
    v_mfma_f32_16x16x32_bf16 v[204:207], v[168:171], a[244:247], v[204:207]
    v_cvt_pk_bf16_f32 v90, v216, v217
    v_cvt_pk_bf16_f32 v91, v218, v219
    v_mfma_f32_16x16x32_bf16 v[180:183], v[168:171], v[252:255], v[180:183]
    v_cvt_pk_bf16_f32 v112, v212, v213
    v_cvt_pk_bf16_f32 v113, v214, v215
    v_mfma_f32_16x16x32_bf16 v[176:179], v[248:251], a[244:247], v[176:179]
    ds_read_b64_tr_b16 v[164:165], v242 offset:49160
    ds_read_b64_tr_b16 v[166:167], v242 offset:62984
    v_mfma_f32_16x16x32_bf16 v[220:223], a[144:147], a[236:239], 0
    ds_read_b128 v[252:255], v240 offset:17408
    ds_read_b64_tr_b16 v[168:169], v241 offset:50688
    v_mfma_f32_16x16x32_bf16 v[216:219], a[148:151], a[236:239], 0
    ds_read_b64_tr_b16 v[170:171], v241 offset:61440
    v_mfma_f32_16x16x32_bf16 v[212:215], a[152:155], a[236:239], 0
    s_waitcnt lgkmcnt(6)
    ds_read_b128 a[236:239], v225 offset:43200
    v_mfma_f32_16x16x32_bf16 v[220:223], a[156:159], a[240:243], v[220:223]
    ds_read_b64_tr_b16 v[248:249], v241 offset:50696
    v_mfma_f32_16x16x32_bf16 v[216:219], a[160:163], a[240:243], v[216:219]
    ds_read_b64_tr_b16 v[250:251], v241 offset:61448
    v_mfma_f32_16x16x32_bf16 v[212:215], a[164:167], a[240:243], v[212:215]
    ds_read_b128 a[240:243], v225 offset:43264
    v_cndmask_b32 v225, v243, v245, vcc
    v_mfma_f32_16x16x32_bf16 v[220:223], a[168:171], a[248:251], v[220:223]
    v_exp_f32 v159, v159
    v_mfma_f32_16x16x32_bf16 v[216:219], a[172:175], a[248:251], v[216:219]
    v_cvt_pk_bf16_f32 v163, v158, v159
    v_mfma_f32_16x16x32_bf16 v[212:215], a[176:179], a[248:251], v[212:215]
    ds_read_b128 v[156:159], v230 offset:1920
    v_mfma_f32_16x16x32_bf16 v[196:199], a[216:219], v[160:163], v[196:199]
    v_mfma_f32_16x16x32_bf16 v[184:187], v[66:69], v[160:163], v[184:187]
    v_mfma_f32_16x16x32_bf16 v[188:191], v[88:91], v[160:163], v[188:191]
    v_mfma_f32_16x16x32_bf16 v[192:195], v[110:113], v[160:163], v[192:195]
    s_waitcnt lgkmcnt(6)
    v_mfma_f32_16x16x32_bf16 v[172:175], v[164:167], a[244:247], v[172:175]
    ds_read_b128 a[244:247], v239 offset:17408
    ds_read_b64_tr_b16 v[164:165], v242 offset:50688
    v_mfma_f32_16x16x32_bf16 v[220:223], a[180:183], a[252:255], v[220:223]
    ds_read_b64_tr_b16 v[166:167], v242 offset:61440
    v_mfma_f32_16x16x32_bf16 v[216:219], a[184:187], a[252:255], v[216:219]
    v_rcp_f32 v197, v196
    v_mfma_f32_16x16x32_bf16 v[212:215], a[188:191], a[252:255], v[212:215]
    s_waitcnt lgkmcnt(5)
    v_mul_f32 v184, v184, v197
    v_mul_f32 v185, v185, v197
    v_mfma_f32_16x16x32_bf16 v[220:223], a[192:195], a[236:239], v[220:223]
    v_cvt_pk_bf16_f32 v184, v184, v185
    v_mul_f32 v186, v186, v197
    v_mfma_f32_16x16x32_bf16 v[216:219], a[196:199], a[236:239], v[216:219]
    v_mul_f32 v187, v187, v197
    v_cvt_pk_bf16_f32 v185, v186, v187
    v_mfma_f32_16x16x32_bf16 v[212:215], a[200:203], a[236:239], v[212:215]
    s_waitcnt lgkmcnt(3)
    v_mul_f32 v188, v188, v197
    v_mul_f32 v189, v189, v197
    v_mfma_f32_16x16x32_bf16 v[220:223], a[204:207], a[240:243], v[220:223]
    v_cvt_pk_bf16_f32 v186, v188, v189
    v_mul_f32 v190, v190, v197
    v_mfma_f32_16x16x32_bf16 v[216:219], a[208:211], a[240:243], v[216:219]
    s_waitcnt vmcnt(0) lgkmcnt(2)
    v_mul_f32 v191, v191, v197
    v_cvt_pk_bf16_f32 v187, v190, v191
    v_mfma_f32_16x16x32_bf16 v[212:215], a[212:215], a[240:243], v[212:215]
    s_barrier
    ds_read_b128 a[248:251], v227 offset:6144
    v_mul_f32 v220, s37, v220
    v_mfma_f32_16x16x32_bf16 v[208:211], v[168:171], a[244:247], v[208:211]
    v_mul_f32 v221, s37, v221
    v_mul_f32 v222, s37, v222
    v_mfma_f32_16x16x32_bf16 v[200:203], v[168:171], v[252:255], v[200:203]
    v_mul_f32 v223, s37, v223
    v_cvt_pk_bf16_f32 v138, v220, v221
    v_mfma_f32_16x16x32_bf16 v[204:207], v[248:251], a[244:247], v[204:207]
    v_cvt_pk_bf16_f32 v139, v222, v223
    v_mul_f32 v216, s37, v216
    v_mfma_f32_16x16x32_bf16 v[180:183], v[248:251], v[252:255], v[180:183]
    s_waitcnt lgkmcnt(1)
    v_mul_f32 v217, s37, v217
    v_mul_f32 v218, s37, v218
    v_mfma_f32_16x16x32_bf16 v[176:179], v[164:167], a[244:247], v[176:179]
    v_mul_f32 v219, s37, v219
    v_cvt_pk_bf16_f32 v140, v216, v217
    v_cvt_pk_bf16_f32 v141, v218, v219
    v_mul_f32 v212, s37, v212
    v_mul_f32 v213, s37, v213
    v_mfma_f32_16x16x32_bf16 v[144:147], v[24:27], v[138:141], v[144:147]
    v_mul_f32 v214, s37, v214
    v_mul_f32 v215, s37, v215
    v_mfma_f32_16x16x32_bf16 v[148:151], v[30:33], v[138:141], v[148:151]
    v_cvt_pk_bf16_f32 v142, v212, v213
    v_cvt_pk_bf16_f32 v143, v214, v215
    v_mfma_f32_16x16x32_bf16 v[152:155], v[36:39], v[138:141], v[152:155]
    ds_read_b128 a[252:255], v227 offset:6208
    ds_read_b128 a[236:239], v227 offset:6272
    v_mfma_f32_16x16x16_bf16 v[144:147], v[28:29], v[142:143], v[144:147]
    ds_read_b128 a[240:243], v227 offset:6336
    ds_read_b64_tr_b16 v[168:169], v242 offset:50696
    v_mfma_f32_16x16x16_bf16 v[148:151], v[34:35], v[142:143], v[148:151]
    ds_read_b64_tr_b16 v[170:171], v242 offset:61448
    v_cvt_pk_bf16_f32 v208, v208, v209
    v_mfma_f32_16x16x16_bf16 v[152:155], v[40:41], v[142:143], v[152:155]
    v_cvt_pk_bf16_f32 v209, v210, v211
    v_cvt_pk_bf16_f32 v210, v204, v205
    v_mfma_f32_16x16x32_bf16 v[156:159], v[42:45], v[138:141], v[156:159]
    s_waitcnt lgkmcnt(5)
    v_cvt_pk_bf16_f32 v211, v206, v207
    v_cvt_pk_bf16_f32 v200, v200, v201
    v_mfma_f32_16x16x32_bf16 v[220:223], a[0:3], a[248:251], 0
    buffer_store_dwordx4 v[208:211], v243, s[20:23], s58 offen sc0 sc1
    v_mfma_f32_16x16x32_bf16 v[216:219], a[4:7], a[248:251], 0
    v_cvt_pk_bf16_f32 v201, v202, v203
    v_cvt_pk_bf16_f32 v202, v180, v181
    v_mfma_f32_16x16x16_bf16 v[156:159], v[46:47], v[142:143], v[156:159]
    v_cvt_pk_bf16_f32 v203, v182, v183
    v_cvt_pk_bf16_f32 v176, v176, v177
    v_mfma_f32_16x16x32_bf16 v[212:215], a[8:11], a[248:251], 0
    s_waitcnt lgkmcnt(4)
    ds_read_b128 a[248:251], v227 offset:6400
    v_cvt_pk_bf16_f32 v177, v178, v179
    v_mfma_f32_16x16x32_bf16 v[220:223], a[12:15], a[252:255], v[220:223]
    v_mul_f32 v192, v192, v197
    v_mul_f32 v193, v193, v197
    v_mfma_f32_16x16x32_bf16 v[216:219], a[16:19], a[252:255], v[216:219]
    v_cvt_pk_bf16_f32 v188, v192, v193
    v_mul_f32 v194, v194, v197
    v_mfma_f32_16x16x32_bf16 v[212:215], a[20:23], a[252:255], v[212:215]
    s_waitcnt lgkmcnt(1)
    ds_read_b128 a[252:255], v227 offset:6464
    v_mul_f32 v195, v195, v197
    v_mfma_f32_16x16x32_bf16 v[172:175], v[168:171], a[244:247], v[172:175]
    v_cvt_pk_bf16_f32 v189, v194, v195
    v_max3_f32 v236, v236, v196, v197
    v_mfma_f32_16x16x32_bf16 v[220:223], a[24:27], a[236:239], v[220:223]
    ds_write_b128 v237, v[184:187] offset:12288
    v_mfma_f32_16x16x32_bf16 v[216:219], a[28:31], a[236:239], v[216:219]
    ds_write_b64 v238, v[188:189] offset:12288
    v_mfma_f32_16x16x32_bf16 v[212:215], a[32:35], a[236:239], v[212:215]
    ds_read_b128 a[236:239], v227 offset:6144
    v_cvt_pk_bf16_f32 v178, v172, v173
    v_mfma_f32_16x16x32_bf16 v[220:223], a[36:39], a[240:243], v[220:223]
    buffer_store_dwordx4 v[200:203], v245, s[20:23], s58 offen sc0 sc1
    v_mfma_f32_16x16x32_bf16 v[216:219], a[40:43], a[240:243], v[216:219]
    ds_read_b128 a[244:247], v239
    v_cvt_pk_bf16_f32 v179, v174, v175
    v_mfma_f32_16x16x32_bf16 v[212:215], a[44:47], a[240:243], v[212:215]
    s_waitcnt lgkmcnt(5)
    ds_read_b128 a[240:243], v227 offset:6208
    ds_read_b128 v[252:255], v240
    v_mfma_f32_16x16x32_bf16 v[220:223], a[48:51], a[248:251], v[220:223]
    ds_read_b64_tr_b16 v[248:249], v241 offset:12288
    ds_read_b64_tr_b16 v[250:251], v241 offset:26112
    v_mfma_f32_16x16x32_bf16 v[216:219], a[52:55], a[248:251], v[216:219]
    ds_read_b64_tr_b16 v[164:165], v241 offset:12296
    v_mfma_f32_16x16x32_bf16 v[212:215], a[56:59], a[248:251], v[212:215]
    s_waitcnt lgkmcnt(9)
    ds_read_b128 a[248:251], v227 offset:6272
    v_mfma_f32_16x16x32_bf16 v[220:223], a[60:63], a[252:255], v[220:223]
    ds_read_b64_tr_b16 v[166:167], v241 offset:26120
    v_mfma_f32_16x16x32_bf16 v[216:219], a[64:67], a[252:255], v[216:219]
    ds_read_b64_tr_b16 v[168:169], v242 offset:12288
    v_mfma_f32_16x16x32_bf16 v[212:215], a[68:71], a[252:255], v[212:215]
    s_waitcnt lgkmcnt(8)
    ds_read_b128 a[252:255], v227 offset:6336
    v_exp_f32 v144, v144
    v_exp_f32 v145, v145
    v_mfma_f32_16x16x32_bf16 v[208:211], a[220:223], a[244:247], 0
    v_cvt_pk_bf16_f32 v54, v220, v221
    v_cvt_pk_bf16_f32 v55, v222, v223
    v_mfma_f32_16x16x32_bf16 v[204:207], a[224:227], a[244:247], 0
    s_waitcnt lgkmcnt(7)
    v_cvt_pk_bf16_f32 v56, v216, v217
    v_cvt_pk_bf16_f32 v57, v218, v219
    v_mfma_f32_16x16x32_bf16 v[200:203], a[220:223], v[252:255], 0
    v_cvt_pk_bf16_f32 v58, v212, v213
    v_cvt_pk_bf16_f32 v59, v214, v215
    v_mfma_f32_16x16x32_bf16 v[180:183], a[224:227], v[252:255], 0
    buffer_store_dwordx4 v[176:179], v244, s[20:23], s58 offen sc0 sc1
    v_mfma_f32_16x16x32_bf16 v[172:175], a[232:235], a[244:247], 0
    s_add_u32 s58, s51, 0x150000
    ds_read_b128 v[252:255], v240 offset:1024
    ds_read_b64_tr_b16 v[170:171], v242 offset:26112
    v_mfma_f32_16x16x32_bf16 v[176:179], a[228:231], a[244:247], 0
    ds_read_b128 a[244:247], v239 offset:1024
    v_cvt_pk_bf16_f32 v160, v144, v145
    v_mfma_f32_16x16x32_bf16 v[220:223], a[236:239], a[72:75], 0
    v_exp_f32 v146, v146
    v_mfma_f32_16x16x32_bf16 v[216:219], a[236:239], a[76:79], 0
    v_exp_f32 v147, v147
    v_mfma_f32_16x16x32_bf16 v[212:215], a[236:239], a[80:83], 0
    ds_read_b128 a[236:239], v227 offset:6400
    v_cvt_pk_bf16_f32 v161, v146, v147
    v_mfma_f32_16x16x32_bf16 v[220:223], a[240:243], a[84:87], v[220:223]
    ds_read_b128 v[144:147], v235
    v_bfe_u32 v235, s76, v233, 4
    v_mfma_f32_16x16x32_bf16 v[216:219], a[240:243], a[88:91], v[216:219]
    v_mad_u32_u24 v235, v235, s40, v231
    v_mfma_f32_16x16x32_bf16 v[212:215], a[240:243], a[92:95], v[212:215]
    s_waitcnt lgkmcnt(5)
    ds_read_b128 a[240:243], v227 offset:6464
    v_cndmask_b32 v227, v240, v239, vcc
    v_mfma_f32_16x16x32_bf16 v[220:223], a[248:251], a[96:99], v[220:223]
    v_exp_f32 v148, v148
    v_mfma_f32_16x16x32_bf16 v[216:219], a[248:251], a[100:103], v[216:219]
    v_exp_f32 v149, v149
    v_mfma_f32_16x16x32_bf16 v[212:215], a[248:251], a[104:107], v[212:215]
    ds_read_b128 a[248:251], v226 offset:1152
    v_cvt_pk_bf16_f32 v162, v148, v149
    v_mfma_f32_16x16x32_bf16 v[220:223], a[252:255], a[108:111], v[220:223]
    v_exp_f32 v150, v150
    v_mfma_f32_16x16x32_bf16 v[216:219], a[252:255], a[112:115], v[216:219]
    v_exp_f32 v151, v151
    v_mfma_f32_16x16x32_bf16 v[212:215], a[252:255], a[116:119], v[212:215]
    s_waitcnt lgkmcnt(3)
    ds_read_b128 a[252:255], v226 offset:1216
    v_cvt_pk_bf16_f32 v163, v150, v151
    v_mfma_f32_16x16x32_bf16 v[220:223], a[236:239], a[120:123], v[220:223]
    ds_read_b128 v[148:151], v234
    v_bfe_u32 v234, s73, v232, 4
    v_mfma_f32_16x16x32_bf16 v[196:199], a[216:219], v[160:163], 0
    v_exp_f32 v152, v152
    v_mfma_f32_16x16x32_bf16 v[184:187], v[68:71], v[160:163], 0
    v_exp_f32 v153, v153
    v_mfma_f32_16x16x32_bf16 v[188:191], v[90:93], v[160:163], 0
    v_exp_f32 v154, v154
    v_mfma_f32_16x16x32_bf16 v[192:195], v[112:115], v[160:163], 0
    s_waitcnt lgkmcnt(3)
    v_exp_f32 v155, v155
    v_mfma_f32_16x16x32_bf16 v[144:147], v[48:51], v[138:141], v[144:147]
    v_cvt_pk_bf16_f32 v160, v152, v153
    v_cvt_pk_bf16_f32 v161, v154, v155
    v_mfma_f32_16x16x32_bf16 v[216:219], a[236:239], a[124:127], v[216:219]
    ds_read_b128 v[152:155], v235
    v_mad_u32_u24 v235, v234, s40, v228
    v_mfma_f32_16x16x32_bf16 v[212:215], a[236:239], a[128:131], v[212:215]
    ds_read_b128 a[236:239], v226 offset:1280
    v_mad_u32_u24 v234, v234, s40, v229
    v_mfma_f32_16x16x16_bf16 v[144:147], v[52:53], v[142:143], v[144:147]
    v_exp_f32 v156, v156
    v_mfma_f32_16x16x32_bf16 v[220:223], a[240:243], a[132:135], v[220:223]
    s_waitcnt lgkmcnt(2)
    v_exp_f32 v157, v157
    v_mfma_f32_16x16x32_bf16 v[148:151], v[54:57], v[138:141], v[148:151]
    v_exp_f32 v158, v158
    v_mfma_f32_16x16x32_bf16 v[216:219], a[240:243], a[136:139], v[216:219]
    v_exp_f32 v159, v159
    v_mfma_f32_16x16x32_bf16 v[212:215], a[240:243], a[140:143], v[212:215]
    ds_read_b128 a[240:243], v226 offset:1344
    v_cvt_pk_bf16_f32 v162, v156, v157
    v_mfma_f32_16x16x16_bf16 v[148:151], v[58:59], v[142:143], v[148:151]
    v_cvt_pk_bf16_f32 v84, v220, v221
    v_cvt_pk_bf16_f32 v85, v222, v223
    v_mfma_f32_16x16x32_bf16 v[220:223], a[144:147], a[248:251], 0
    v_cvt_pk_bf16_f32 v106, v216, v217
    v_cvt_pk_bf16_f32 v107, v218, v219
    v_mfma_f32_16x16x32_bf16 v[216:219], a[148:151], a[248:251], 0
    s_waitcnt lgkmcnt(2)
    v_cvt_pk_bf16_f32 v128, v212, v213
    v_cvt_pk_bf16_f32 v129, v214, v215
    v_mfma_f32_16x16x32_bf16 v[152:155], v[60:63], v[138:141], v[152:155]
    v_cvt_pk_bf16_f32 v163, v158, v159
    v_mfma_f32_16x16x32_bf16 v[212:215], a[152:155], a[248:251], 0
    ds_read_b128 a[248:251], v226 offset:1408
    ds_read_b128 v[156:159], v235
    v_mfma_f32_16x16x32_bf16 v[196:199], a[216:219], v[160:163], v[196:199]
    v_exp_f32 v144, v144
    v_mfma_f32_16x16x32_bf16 v[184:187], v[76:79], v[160:163], v[184:187]
    v_exp_f32 v145, v145
    v_mfma_f32_16x16x32_bf16 v[188:191], v[98:101], v[160:163], v[188:191]
    v_exp_f32 v146, v146
    v_mfma_f32_16x16x32_bf16 v[192:195], v[120:123], v[160:163], v[192:195]
    v_exp_f32 v147, v147
    v_mfma_f32_16x16x16_bf16 v[152:155], v[64:65], v[142:143], v[152:155]
    v_cvt_pk_bf16_f32 v160, v144, v145
    v_cvt_pk_bf16_f32 v161, v146, v147
    v_mfma_f32_16x16x32_bf16 v[220:223], a[156:159], a[252:255], v[220:223]
    ds_read_b128 v[144:147], v234
    v_bfe_u32 v234, s77, v232, 4
    v_mfma_f32_16x16x16_bf16 v[196:199], a[216:217], v[160:161], v[196:199]
    v_mad_u32_u24 v235, v234, s40, v228
    v_mad_u32_u24 v234, v234, s40, v229
    v_mfma_f32_16x16x16_bf16 v[184:187], v[82:83], v[160:161], v[184:187]
    v_exp_f32 v148, v148
    v_mfma_f32_16x16x16_bf16 v[188:191], v[104:105], v[160:161], v[188:191]
    v_exp_f32 v149, v149
    v_mfma_f32_16x16x16_bf16 v[192:195], v[126:127], v[160:161], v[192:195]
    v_exp_f32 v150, v150
    v_mfma_f32_16x16x32_bf16 v[216:219], a[160:163], a[252:255], v[216:219]
    v_exp_f32 v151, v151
    v_mfma_f32_16x16x32_bf16 v[212:215], a[164:167], a[252:255], v[212:215]
    s_waitcnt lgkmcnt(1)
    ds_read_b128 a[252:255], v226 offset:1472
    v_cvt_pk_bf16_f32 v160, v148, v149
    v_mfma_f32_16x16x32_bf16 v[220:223], a[168:171], a[236:239], v[220:223]
    v_cvt_pk_bf16_f32 v161, v150, v151
    v_mfma_f32_16x16x32_bf16 v[216:219], a[172:175], a[236:239], v[216:219]
    ds_read_b128 v[148:151], v229 offset:1280
    v_mfma_f32_16x16x32_bf16 v[212:215], a[176:179], a[236:239], v[212:215]
    ds_read_b128 a[236:239], v224 offset:15488
    v_mfma_f32_16x16x32_bf16 v[220:223], a[180:183], a[240:243], v[220:223]
    v_exp_f32 v152, v152
    v_mfma_f32_16x16x32_bf16 v[216:219], a[184:187], a[240:243], v[216:219]
    v_exp_f32 v153, v153
    v_mfma_f32_16x16x32_bf16 v[212:215], a[188:191], a[240:243], v[212:215]
    ds_read_b128 a[240:243], v224 offset:15552
    v_cvt_pk_bf16_f32 v162, v152, v153
    v_mfma_f32_16x16x32_bf16 v[220:223], a[192:195], a[248:251], v[220:223]
    v_exp_f32 v154, v154
    v_mfma_f32_16x16x32_bf16 v[216:219], a[196:199], a[248:251], v[216:219]
    v_exp_f32 v155, v155
    v_mfma_f32_16x16x32_bf16 v[212:215], a[200:203], a[248:251], v[212:215]
    s_waitcnt lgkmcnt(3)
    ds_read_b128 a[248:251], v224 offset:15616
    v_cvt_pk_bf16_f32 v163, v154, v155
    v_mfma_f32_16x16x32_bf16 v[220:223], a[204:207], a[252:255], v[220:223]
    ds_read_b128 v[152:155], v228 offset:1280
    v_mfma_f32_16x16x32_bf16 v[196:199], a[216:219], v[160:163], v[196:199]
    v_mfma_f32_16x16x32_bf16 v[184:187], v[84:87], v[160:163], v[184:187]
    v_mfma_f32_16x16x32_bf16 v[188:191], v[106:109], v[160:163], v[188:191]
    v_mfma_f32_16x16x32_bf16 v[192:195], v[128:131], v[160:163], v[192:195]
    v_mfma_f32_16x16x32_bf16 v[216:219], a[208:211], a[252:255], v[216:219]
    v_mfma_f32_16x16x32_bf16 v[212:215], a[212:215], a[252:255], v[212:215]
    ds_read_b128 a[252:255], v224 offset:15680
    v_mul_f32 v220, s37, v220
    v_mfma_f32_16x16x32_bf16 v[208:211], v[248:251], a[244:247], v[208:211]
    v_mul_f32 v221, s37, v221
    v_mul_f32 v222, s37, v222
    v_mfma_f32_16x16x32_bf16 v[200:203], v[248:251], v[252:255], v[200:203]
    v_mul_f32 v223, s37, v223
    v_cvt_pk_bf16_f32 v132, v220, v221
    v_mfma_f32_16x16x32_bf16 v[204:207], v[164:167], a[244:247], v[204:207]
    v_cvt_pk_bf16_f32 v133, v222, v223
    v_mul_f32 v216, s37, v216
    v_mfma_f32_16x16x32_bf16 v[180:183], v[164:167], v[252:255], v[180:183]
    v_mul_f32 v217, s37, v217
    v_mul_f32 v218, s37, v218
    v_mfma_f32_16x16x32_bf16 v[176:179], v[168:171], a[244:247], v[176:179]
    s_waitcnt lgkmcnt(1)
    v_mul_f32 v219, s37, v219
    v_cvt_pk_bf16_f32 v134, v216, v217
    v_mfma_f32_16x16x32_bf16 v[220:223], a[0:3], a[236:239], 0
    v_cvt_pk_bf16_f32 v135, v218, v219
    v_mul_f32 v212, s37, v212
    v_mfma_f32_16x16x32_bf16 v[216:219], a[4:7], a[236:239], 0
    v_mul_f32 v213, s37, v213
    v_mul_f32 v214, s37, v214
    v_mfma_f32_16x16x32_bf16 v[156:159], v[12:15], v[132:135], v[156:159]
    v_mul_f32 v215, s37, v215
    v_cvt_pk_bf16_f32 v136, v212, v213
    v_mfma_f32_16x16x32_bf16 v[144:147], v[36:39], v[132:135], v[144:147]
    ds_read_b64_tr_b16 v[248:249], v242 offset:12296
    v_cvt_pk_bf16_f32 v137, v214, v215
    v_mfma_f32_16x16x32_bf16 v[148:151], v[42:45], v[132:135], v[148:151]
    v_rcp_f32 v197, v196
    v_mfma_f32_16x16x16_bf16 v[156:159], v[16:17], v[136:137], v[156:159]
    v_mul_f32 v184, v184, v197
    v_mul_f32 v185, v185, v197
    v_mfma_f32_16x16x16_bf16 v[144:147], v[40:41], v[136:137], v[144:147]
    v_cvt_pk_bf16_f32 v184, v184, v185
    v_mul_f32 v186, v186, v197
    v_mfma_f32_16x16x16_bf16 v[148:151], v[46:47], v[136:137], v[148:151]
    v_mul_f32 v187, v187, v197
    v_cvt_pk_bf16_f32 v185, v186, v187
    v_mfma_f32_16x16x32_bf16 v[152:155], v[18:21], v[132:135], v[152:155]
    v_mul_f32 v188, v188, v197
    v_mul_f32 v189, v189, v197
    v_mfma_f32_16x16x32_bf16 v[212:215], a[8:11], a[236:239], 0
    ds_read_b128 a[236:239], v224 offset:15744
    v_cvt_pk_bf16_f32 v186, v188, v189
    v_mfma_f32_16x16x32_bf16 v[220:223], a[12:15], a[240:243], v[220:223]
    v_mul_f32 v190, v190, v197
    v_mul_f32 v191, v191, v197
    v_mfma_f32_16x16x16_bf16 v[152:155], v[22:23], v[136:137], v[152:155]
    v_cvt_pk_bf16_f32 v187, v190, v191
    v_mul_f32 v192, v192, v197
    v_mfma_f32_16x16x32_bf16 v[216:219], a[16:19], a[240:243], v[216:219]
    v_mul_f32 v193, v193, v197
    v_cvt_pk_bf16_f32 v188, v192, v193
    v_mfma_f32_16x16x32_bf16 v[212:215], a[20:23], a[240:243], v[212:215]
    ds_read_b128 a[240:243], v224 offset:15808
    v_mul_f32 v194, v194, v197
    v_mfma_f32_16x16x32_bf16 v[220:223], a[24:27], a[248:251], v[220:223]
    v_mul_f32 v195, v195, v197
    v_cvt_pk_bf16_f32 v189, v194, v195
    v_mfma_f32_16x16x32_bf16 v[216:219], a[28:31], a[248:251], v[216:219]
    ds_read_b64_tr_b16 v[250:251], v242 offset:26120
    v_max3_f32 v236, v236, v196, v197
    v_mfma_f32_16x16x32_bf16 v[212:215], a[32:35], a[248:251], v[212:215]
    s_waitcnt lgkmcnt(3)
    ds_read_b128 a[248:251], v224 offset:15488
    ds_read_b128 v[252:255], v240 offset:2048
    v_mfma_f32_16x16x32_bf16 v[220:223], a[36:39], a[252:255], v[220:223]
    ds_write_b128 v237, v[184:187] offset:18432
    v_mfma_f32_16x16x32_bf16 v[216:219], a[40:43], a[252:255], v[216:219]
    ds_write_b64 v238, v[188:189] offset:18432
    v_mfma_f32_16x16x32_bf16 v[212:215], a[44:47], a[252:255], v[212:215]
    s_waitcnt lgkmcnt(6)
    ds_read_b128 a[252:255], v224 offset:15552
    ds_read_b64_tr_b16 v[164:165], v241 offset:13824
    v_mfma_f32_16x16x32_bf16 v[220:223], a[48:51], a[236:239], v[220:223]
    ds_read_b64_tr_b16 v[166:167], v241 offset:24576
    v_mfma_f32_16x16x32_bf16 v[216:219], a[52:55], a[236:239], v[216:219]
    ds_read_b64_tr_b16 v[168:169], v241 offset:13832
    v_mfma_f32_16x16x32_bf16 v[212:215], a[56:59], a[236:239], v[212:215]
    s_waitcnt lgkmcnt(8)
    ds_read_b128 a[236:239], v224 offset:15616
    v_mfma_f32_16x16x32_bf16 v[172:175], v[248:251], a[244:247], v[172:175]
    ds_read_b128 a[244:247], v239 offset:2048
    v_mfma_f32_16x16x32_bf16 v[220:223], a[60:63], a[240:243], v[220:223]
    ds_read_b64_tr_b16 v[170:171], v241 offset:24584
    v_mfma_f32_16x16x32_bf16 v[216:219], a[64:67], a[240:243], v[216:219]
    ds_read_b64_tr_b16 v[248:249], v242 offset:13824
    v_mfma_f32_16x16x32_bf16 v[212:215], a[68:71], a[240:243], v[212:215]
    s_waitcnt lgkmcnt(10)
    ds_read_b128 a[240:243], v224 offset:15680
    v_exp_f32 v156, v156
    v_exp_f32 v157, v157
    ds_read_b64_tr_b16 v[250:251], v242 offset:24576
    v_cvt_pk_bf16_f32 v6, v220, v221
    v_cvt_pk_bf16_f32 v7, v222, v223
    v_mfma_f32_16x16x32_bf16 v[220:223], a[248:251], a[72:75], 0
    v_cvt_pk_bf16_f32 v8, v216, v217
    v_cvt_pk_bf16_f32 v9, v218, v219
    v_mfma_f32_16x16x32_bf16 v[216:219], a[248:251], a[76:79], 0
    s_waitcnt lgkmcnt(7)
    v_cvt_pk_bf16_f32 v10, v212, v213
    v_cvt_pk_bf16_f32 v11, v214, v215
    v_mfma_f32_16x16x32_bf16 v[200:203], v[164:167], v[252:255], v[200:203]
    v_exp_f32 v158, v158
    v_mfma_f32_16x16x32_bf16 v[212:215], a[248:251], a[80:83], 0
    ds_read_b128 a[248:251], v224 offset:15744
    v_cvt_pk_bf16_f32 v160, v156, v157
    v_mfma_f32_16x16x32_bf16 v[220:223], a[252:255], a[84:87], v[220:223]
    s_waitcnt lgkmcnt(5)
    v_exp_f32 v159, v159
    v_mfma_f32_16x16x32_bf16 v[208:211], v[164:167], a[244:247], v[208:211]
    s_waitcnt lgkmcnt(4)
    ds_read_b64_tr_b16 v[164:165], v242 offset:13832
    ds_read_b64_tr_b16 v[166:167], v242 offset:24584
    v_mfma_f32_16x16x32_bf16 v[204:207], v[168:171], a[244:247], v[204:207]
    v_cvt_pk_bf16_f32 v161, v158, v159
    v_mfma_f32_16x16x32_bf16 v[180:183], v[168:171], v[252:255], v[180:183]
    ds_read_b128 v[252:255], v240 offset:3072
    ds_read_b64_tr_b16 v[168:169], v241 offset:36864
    v_mfma_f32_16x16x32_bf16 v[216:219], a[252:255], a[88:91], v[216:219]
    s_waitcnt lgkmcnt(5)
    ds_read_b64_tr_b16 v[170:171], v241 offset:38400
    ds_read_b128 v[156:159], v235
    v_mfma_f32_16x16x32_bf16 v[176:179], v[248:251], a[244:247], v[176:179]
    v_exp_f32 v144, v144
    v_mfma_f32_16x16x32_bf16 v[212:215], a[252:255], a[92:95], v[212:215]
    ds_read_b128 a[252:255], v224 offset:15808
    v_mfma_f32_16x16x32_bf16 v[220:223], a[236:239], a[96:99], v[220:223]
    ds_read_b64_tr_b16 v[248:249], v241 offset:36872
    v_mfma_f32_16x16x32_bf16 v[216:219], a[236:239], a[100:103], v[216:219]
    ds_read_b64_tr_b16 v[250:251], v241 offset:38408
    v_mfma_f32_16x16x32_bf16 v[212:215], a[236:239], a[104:107], v[212:215]
    ds_read_b128 a[236:239], v224 offset:18560
    v_mfma_f32_16x16x32_bf16 v[220:223], a[240:243], a[108:111], v[220:223]
    s_waitcnt lgkmcnt(8)
    v_exp_f32 v145, v145
    v_mfma_f32_16x16x32_bf16 v[172:175], v[164:167], a[244:247], v[172:175]
    ds_read_b128 a[244:247], v239 offset:3072
    ds_read_b64_tr_b16 v[164:165], v242 offset:36864
    v_mfma_f32_16x16x32_bf16 v[216:219], a[240:243], a[112:115], v[216:219]
    ds_read_b64_tr_b16 v[166:167], v242 offset:38400
    v_cvt_pk_bf16_f32 v162, v144, v145
    v_mfma_f32_16x16x32_bf16 v[212:215], a[240:243], a[116:119], v[212:215]
    ds_read_b128 a[240:243], v224 offset:18624
    v_mfma_f32_16x16x32_bf16 v[220:223], a[248:251], a[120:123], v[220:223]
    v_exp_f32 v146, v146
    v_mfma_f32_16x16x32_bf16 v[216:219], a[248:251], a[124:127], v[216:219]
    s_waitcnt lgkmcnt(8)
    v_exp_f32 v147, v147
    v_mfma_f32_16x16x32_bf16 v[156:159], v[0:3], v[132:135], v[156:159]
    v_cvt_pk_bf16_f32 v163, v146, v147
    v_mfma_f32_16x16x32_bf16 v[212:215], a[248:251], a[128:131], v[212:215]
    ds_read_b128 a[248:251], v224 offset:18688
    ds_read_b128 v[144:147], v234
    v_mfma_f32_16x16x32_bf16 v[196:199], a[216:219], v[160:163], 0
    v_bfe_u32 v234, s78, v232, 4
    v_mad_u32_u24 v235, v234, s40, v229
    v_mfma_f32_16x16x32_bf16 v[184:187], v[74:77], v[160:163], 0
    v_mad_u32_u24 v234, v234, s40, v228
    v_mfma_f32_16x16x32_bf16 v[188:191], v[96:99], v[160:163], 0
    v_exp_f32 v148, v148
    v_mfma_f32_16x16x32_bf16 v[192:195], v[118:121], v[160:163], 0
    v_exp_f32 v149, v149
    v_mfma_f32_16x16x16_bf16 v[156:159], v[4:5], v[136:137], v[156:159]
    s_waitcnt lgkmcnt(5)
    v_mov_b32 v5, s25
    v_cvt_pk_bf16_f32 v160, v148, v149
    v_mfma_f32_16x16x32_bf16 v[220:223], a[252:255], a[132:135], v[220:223]
    v_exp_f32 v150, v150
    v_mfma_f32_16x16x32_bf16 v[216:219], a[252:255], a[136:139], v[216:219]
    v_exp_f32 v151, v151
    v_mfma_f32_16x16x32_bf16 v[212:215], a[252:255], a[140:143], v[212:215]
    ds_read_b128 a[252:255], v224 offset:18752
    v_cvt_pk_bf16_f32 v161, v150, v151
    v_mfma_f32_16x16x32_bf16 v[208:211], v[168:171], a[244:247], v[208:211]
    ds_read_b128 v[148:151], v235
    v_cvt_pk_bf16_f32 v72, v220, v221
    v_mfma_f32_16x16x32_bf16 v[200:203], v[168:171], v[252:255], v[200:203]
    s_waitcnt lgkmcnt(2)
    v_cvt_pk_bf16_f32 v73, v222, v223
    v_cvt_pk_bf16_f32 v94, v216, v217
    v_mfma_f32_16x16x32_bf16 v[144:147], v[24:27], v[132:135], v[144:147]
    v_cvt_pk_bf16_f32 v95, v218, v219
    v_cvt_pk_bf16_f32 v116, v212, v213
    v_mfma_f32_16x16x32_bf16 v[204:207], v[248:251], a[244:247], v[204:207]
    ds_read_b64_tr_b16 v[168:169], v242 offset:36872
    v_cvt_pk_bf16_f32 v117, v214, v215
    v_mfma_f32_16x16x32_bf16 v[180:183], v[248:251], v[252:255], v[180:183]
    ds_read_b64_tr_b16 v[170:171], v242 offset:38408
    ds_read_b128 v[252:255], v240 offset:4096
    v_mfma_f32_16x16x16_bf16 v[144:147], v[28:29], v[136:137], v[144:147]
    ds_read_b64_tr_b16 v[248:249], v242 offset:50688
    ds_read_b64_tr_b16 v[250:251], v242 offset:61440
    v_mfma_f32_16x16x32_bf16 v[176:179], v[164:167], a[244:247], v[176:179]
    ds_read_b64_tr_b16 v[164:165], v242 offset:50696
    v_bfe_u32 v235, s77, v232, 4
    v_mfma_f32_16x16x32_bf16 v[220:223], a[0:3], a[236:239], 0
    ds_read_b64_tr_b16 a[0:1], v241 offset:12288
    v_mad_u32_u24 v235, v235, s40, v230
    v_mfma_f32_16x16x32_bf16 v[216:219], a[4:7], a[236:239], 0
    ds_read_b64_tr_b16 a[2:3], v241 offset:26112
    v_mfma_f32_16x16x32_bf16 v[212:215], a[8:11], a[236:239], 0
    ds_read_b128 a[236:239], v224 offset:18816
    v_mfma_f32_16x16x32_bf16 v[220:223], a[12:15], a[240:243], v[220:223]
    ds_read_b64_tr_b16 a[4:5], v241 offset:12296
    v_mfma_f32_16x16x32_bf16 v[216:219], a[16:19], a[240:243], v[216:219]
    ds_read_b64_tr_b16 a[6:7], v241 offset:26120
    v_mfma_f32_16x16x32_bf16 v[212:215], a[20:23], a[240:243], v[212:215]
    s_waitcnt lgkmcnt(9)
    ds_read_b128 a[240:243], v224 offset:18880
    v_mfma_f32_16x16x32_bf16 v[172:175], v[168:171], a[244:247], v[172:175]
    ds_read_b64_tr_b16 a[8:9], v242 offset:12288
    v_mfma_f32_16x16x32_bf16 v[220:223], a[24:27], a[248:251], v[220:223]
    ds_read_b64_tr_b16 a[10:11], v242 offset:26112
    v_mfma_f32_16x16x32_bf16 v[216:219], a[28:31], a[248:251], v[216:219]
    ds_read_b64_tr_b16 a[12:13], v242 offset:12296
    v_mfma_f32_16x16x32_bf16 v[212:215], a[32:35], a[248:251], v[212:215]
    ds_read_b128 a[248:251], v224 offset:18560
    v_mfma_f32_16x16x32_bf16 v[220:223], a[36:39], a[252:255], v[220:223]
    ds_read_b64_tr_b16 a[14:15], v242 offset:26120
    v_mfma_f32_16x16x32_bf16 v[216:219], a[40:43], a[252:255], v[216:219]
    ds_read_b64_tr_b16 a[16:17], v241 offset:13824
    v_mfma_f32_16x16x32_bf16 v[212:215], a[44:47], a[252:255], v[212:215]
    s_waitcnt lgkmcnt(9)
    ds_read_b128 a[252:255], v224 offset:18624
    v_mfma_f32_16x16x32_bf16 v[220:223], a[48:51], a[236:239], v[220:223]
L_pg8:
    s_cbranch_execz L_back
    ds_read_b64_tr_b16 a[18:19], v241 offset:24576
    v_mfma_f32_16x16x32_bf16 v[216:219], a[52:55], a[236:239], v[216:219]
    ds_read_b64_tr_b16 a[20:21], v241 offset:13832
    v_mfma_f32_16x16x32_bf16 v[212:215], a[56:59], a[236:239], v[212:215]
    s_waitcnt lgkmcnt(9)
    ds_read_b128 a[236:239], v224 offset:18688
    v_mfma_f32_16x16x32_bf16 v[220:223], a[60:63], a[240:243], v[220:223]
    ds_read_b64_tr_b16 a[22:23], v241 offset:24584
    v_mfma_f32_16x16x32_bf16 v[216:219], a[64:67], a[240:243], v[216:219]
    ds_read_b64_tr_b16 a[24:25], v242 offset:13824
    v_mfma_f32_16x16x32_bf16 v[212:215], a[68:71], a[240:243], v[212:215]
    s_waitcnt lgkmcnt(8)
    ds_read_b128 a[240:243], v224 offset:18752
    v_exp_f32 v152, v152
    v_exp_f32 v153, v153
    ds_read_b64_tr_b16 a[26:27], v242 offset:24576
    v_cvt_pk_bf16_f32 v30, v220, v221
    v_cvt_pk_bf16_f32 v31, v222, v223
    v_mfma_f32_16x16x32_bf16 v[220:223], a[248:251], a[72:75], 0
    v_cvt_pk_bf16_f32 v32, v216, v217
    v_cvt_pk_bf16_f32 v33, v218, v219
    v_mfma_f32_16x16x32_bf16 v[216:219], a[248:251], a[76:79], 0
    v_cvt_pk_bf16_f32 v34, v212, v213
    v_cvt_pk_bf16_f32 v35, v214, v215
    v_mfma_f32_16x16x32_bf16 v[148:151], v[30:33], v[132:135], v[148:151]
    ds_read_b64_tr_b16 a[28:29], v242 offset:13832
    ds_read_b64_tr_b16 a[30:31], v242 offset:24584
    v_mfma_f32_16x16x32_bf16 v[212:215], a[248:251], a[80:83], 0
    s_waitcnt lgkmcnt(9)
    ds_read_b128 a[248:251], v224 offset:18816
    ds_read_b64_tr_b16 a[32:33], v241 offset:36864
    v_mfma_f32_16x16x32_bf16 v[220:223], a[252:255], a[84:87], v[220:223]
    ds_read_b64_tr_b16 a[34:35], v241 offset:38400
    v_cvt_pk_bf16_f32 v162, v152, v153
    v_mfma_f32_16x16x16_bf16 v[148:151], v[34:35], v[136:137], v[148:151]
    ds_read_b64_tr_b16 a[36:37], v241 offset:36872
    v_mfma_f32_16x16x32_bf16 v[216:219], a[252:255], a[88:91], v[216:219]
    ds_read_b64_tr_b16 a[38:39], v241 offset:38408
    v_mfma_f32_16x16x32_bf16 v[212:215], a[252:255], a[92:95], v[212:215]
    s_waitcnt lgkmcnt(10)
    ds_read_b128 a[252:255], v224 offset:18880
    v_cndmask_b32 v224, v239, v240, vcc
    v_mfma_f32_16x16x32_bf16 v[220:223], a[236:239], a[96:99], v[220:223]
    ds_read_b64_tr_b16 a[40:41], v242 offset:36864
    v_mfma_f32_16x16x32_bf16 v[216:219], a[236:239], a[100:103], v[216:219]
    ds_read_b64_tr_b16 a[42:43], v242 offset:38400
    v_mfma_f32_16x16x32_bf16 v[212:215], a[236:239], a[104:107], v[212:215]
    s_waitcnt lgkmcnt(10)
    ds_read_b128 a[236:239], v226 offset:4224
    v_mfma_f32_16x16x32_bf16 v[220:223], a[240:243], a[108:111], v[220:223]
    ds_read_b64_tr_b16 a[44:45], v242 offset:36872
    v_mfma_f32_16x16x32_bf16 v[216:219], a[240:243], a[112:115], v[216:219]
    ds_read_b64_tr_b16 a[46:47], v242 offset:38408
    v_mfma_f32_16x16x32_bf16 v[212:215], a[240:243], a[116:119], v[212:215]
    s_waitcnt lgkmcnt(10)
    ds_read_b128 a[240:243], v226 offset:4288
    v_mfma_f32_16x16x32_bf16 v[220:223], a[248:251], a[120:123], v[220:223]
    ds_read_b64_tr_b16 a[48:49], v241 offset:49152
    v_mfma_f32_16x16x32_bf16 v[216:219], a[248:251], a[124:127], v[216:219]
    ds_read_b64_tr_b16 a[50:51], v241 offset:62976
    v_mfma_f32_16x16x32_bf16 v[212:215], a[248:251], a[128:131], v[212:215]
    s_waitcnt lgkmcnt(8)
    ds_read_b128 a[248:251], v226 offset:4352
    v_exp_f32 v154, v154
    v_exp_f32 v155, v155
    v_mfma_f32_16x16x32_bf16 v[220:223], a[252:255], a[132:135], v[220:223]
    ds_read_b64_tr_b16 a[52:53], v241 offset:49160
    ds_read_b64_tr_b16 a[54:55], v241 offset:62984
    v_mfma_f32_16x16x32_bf16 v[216:219], a[252:255], a[136:139], v[216:219]
    v_cvt_pk_bf16_f32 v163, v154, v155
    v_mfma_f32_16x16x32_bf16 v[212:215], a[252:255], a[140:143], v[212:215]
    ds_read_b128 a[252:255], v226 offset:4416
    ds_read_b64_tr_b16 a[56:57], v242 offset:49152
    v_mfma_f32_16x16x32_bf16 v[196:199], a[216:219], v[160:163], v[196:199]
    v_cvt_pk_bf16_f32 v70, v220, v221
    v_cvt_pk_bf16_f32 v71, v222, v223
    v_mfma_f32_16x16x32_bf16 v[184:187], v[78:81], v[160:163], v[184:187]
    v_cvt_pk_bf16_f32 v92, v216, v217
    v_cvt_pk_bf16_f32 v93, v218, v219
    v_mfma_f32_16x16x32_bf16 v[188:191], v[100:103], v[160:163], v[188:191]
    v_cvt_pk_bf16_f32 v114, v212, v213
    v_cvt_pk_bf16_f32 v115, v214, v215
    v_mfma_f32_16x16x32_bf16 v[192:195], v[122:125], v[160:163], v[192:195]
    s_waitcnt lgkmcnt(8)
    ds_read_b64_tr_b16 a[58:59], v242 offset:62976
    ds_read_b64_tr_b16 a[60:61], v242 offset:49160
    v_mfma_f32_16x16x32_bf16 v[220:223], a[144:147], a[236:239], 0
    s_waitcnt lgkmcnt(7)
    ds_read_b64_tr_b16 a[62:63], v242 offset:62984
    ds_read_b64_tr_b16 a[64:65], v241 offset:50688
    v_mfma_f32_16x16x32_bf16 v[200:203], a[48:51], v[252:255], v[200:203]
    ds_read_b64_tr_b16 a[66:67], v241 offset:61440
    v_mfma_f32_16x16x32_bf16 v[216:219], a[148:151], a[236:239], 0
    ds_read_b64_tr_b16 a[68:69], v241 offset:50696
    v_mfma_f32_16x16x32_bf16 v[212:215], a[152:155], a[236:239], 0
    s_waitcnt lgkmcnt(8)
    ds_read_b128 a[236:239], v226 offset:4480
    v_mfma_f32_16x16x32_bf16 v[180:183], a[52:55], v[252:255], v[180:183]
    ds_read_b64_tr_b16 a[70:71], v241 offset:61448
    v_mfma_f32_16x16x32_bf16 v[220:223], a[156:159], a[240:243], v[220:223]
    ds_read_b128 a[244:247], v239 offset:4096
    v_mfma_f32_16x16x32_bf16 v[216:219], a[160:163], a[240:243], v[216:219]
    ds_read_b128 v[168:171], v239 offset:5120
    v_mfma_f32_16x16x32_bf16 v[212:215], a[164:167], a[240:243], v[212:215]
    ds_read_b128 a[240:243], v226 offset:4544
    v_cndmask_b32 v226, v244, v247, vcc
    v_mfma_f32_16x16x32_bf16 v[220:223], a[168:171], a[248:251], v[220:223]
    ds_read_b64_tr_b16 v[166:167], v242 offset:61448
    v_cndmask_b32 v247, v247, v244, vcc
    v_mfma_f32_16x16x32_bf16 v[216:219], a[172:175], a[248:251], v[216:219]
    ds_read_b128 v[152:155], v234
    v_bfe_u32 v234, s73, v232, 4
    v_mfma_f32_16x16x32_bf16 v[212:215], a[176:179], a[248:251], v[212:215]
    s_waitcnt lgkmcnt(11)
    v_mad_u32_u24 v234, v234, s40, v230
    v_mfma_f32_16x16x32_bf16 v[220:223], a[180:183], a[252:255], v[220:223]
    v_exp_f32 v156, v156
    v_mfma_f32_16x16x32_bf16 v[216:219], a[184:187], a[252:255], v[216:219]
    v_exp_f32 v157, v157
    v_mfma_f32_16x16x32_bf16 v[212:215], a[188:191], a[252:255], v[212:215]
    s_waitcnt lgkmcnt(6)
    v_exp_f32 v158, v158
    v_mfma_f32_16x16x32_bf16 v[220:223], a[192:195], a[236:239], v[220:223]
    v_exp_f32 v159, v159
    v_mfma_f32_16x16x32_bf16 v[216:219], a[196:199], a[236:239], v[216:219]
    s_waitcnt lgkmcnt(4)
    v_cvt_pk_bf16_f32 v160, v156, v157
    v_cvt_pk_bf16_f32 v161, v158, v159
    v_mfma_f32_16x16x32_bf16 v[208:211], a[48:51], a[244:247], v[208:211]
    ds_read_b128 v[156:159], v234
    v_bfe_u32 v234, s78, v232, 4
    v_mfma_f32_16x16x32_bf16 v[204:207], a[52:55], a[244:247], v[204:207]
    v_mad_u32_u24 v234, v234, s40, v230
    v_mfma_f32_16x16x32_bf16 v[176:179], a[56:59], a[244:247], v[176:179]
    v_exp_f32 v144, v144
    v_mfma_f32_16x16x32_bf16 v[172:175], a[60:63], a[244:247], v[172:175]
    s_waitcnt lgkmcnt(3)
    ds_read_b128 a[244:247], v240 offset:5120
    v_mfma_f32_16x16x32_bf16 v[208:211], a[64:67], v[168:171], v[208:211]
    s_waitcnt lgkmcnt(2)
    v_exp_f32 v145, v145
    v_mfma_f32_16x16x32_bf16 v[152:155], v[6:9], v[132:135], v[152:155]
    v_exp_f32 v146, v146
    v_mfma_f32_16x16x32_bf16 v[204:207], a[68:71], v[168:171], v[204:207]
    v_exp_f32 v147, v147
    v_mfma_f32_16x16x32_bf16 v[176:179], v[248:251], v[168:171], v[176:179]
    ds_read_b64_tr_b16 v[248:249], v242 offset:50688
    ds_read_b64_tr_b16 v[250:251], v242 offset:61440
    v_mfma_f32_16x16x16_bf16 v[152:155], v[10:11], v[136:137], v[152:155]
    v_cvt_pk_bf16_f32 v208, v208, v209
    v_cvt_pk_bf16_f32 v209, v210, v211
    v_mfma_f32_16x16x32_bf16 v[172:175], v[164:167], v[168:171], v[172:175]
    v_cvt_pk_bf16_f32 v210, v204, v205
    v_cvt_pk_bf16_f32 v211, v206, v207
    v_mfma_f32_16x16x32_bf16 v[212:215], a[200:203], a[236:239], v[212:215]
    s_waitcnt lgkmcnt(2)
    buffer_store_dwordx4 v[208:211], v243, s[20:23], s58 offen sc0 sc1
    v_mfma_f32_16x16x32_bf16 v[200:203], a[64:67], a[244:247], v[200:203]
    s_barrier
    ds_read_b128 v[252:255], v239 offset:12288
    v_cvt_pk_bf16_f32 v176, v176, v177
    v_mfma_f32_16x16x32_bf16 v[180:183], a[68:71], a[244:247], v[180:183]
    ds_read_b128 v[168:171], v240 offset:12288
    v_cvt_pk_bf16_f32 v177, v178, v179
    v_mfma_f32_16x16x32_bf16 v[220:223], a[204:207], a[240:243], v[220:223]
    v_cvt_pk_bf16_f32 v178, v172, v173
    v_cvt_pk_bf16_f32 v200, v200, v201
    v_mfma_f32_16x16x32_bf16 v[216:219], a[208:211], a[240:243], v[216:219]
    v_cvt_pk_bf16_f32 v201, v202, v203
    v_cvt_pk_bf16_f32 v179, v174, v175
    v_mfma_f32_16x16x32_bf16 v[212:215], a[212:215], a[240:243], v[212:215]
    v_cvt_pk_bf16_f32 v202, v180, v181
    v_cvt_pk_bf16_f32 v203, v182, v183
    v_mul_f32 v220, s37, v220
    v_mul_f32 v221, s37, v221
    v_mul_f32 v222, s37, v222
    v_mul_f32 v223, s37, v223
    v_cvt_pk_bf16_f32 v138, v220, v221
    v_cvt_pk_bf16_f32 v139, v222, v223
    v_mul_f32 v216, s37, v216
    v_mul_f32 v217, s37, v217
    v_mul_f32 v218, s37, v218
    v_mul_f32 v219, s37, v219
    v_cvt_pk_bf16_f32 v140, v216, v217
    v_cvt_pk_bf16_f32 v141, v218, v219
    v_mul_f32 v212, s37, v212
    v_mul_f32 v213, s37, v213
    v_mfma_f32_16x16x32_bf16 v[156:159], v[36:39], v[138:141], v[156:159]
    s_waitcnt lgkmcnt(1)
    v_mul_f32 v214, s37, v214
    v_mul_f32 v215, s37, v215
    v_mfma_f32_16x16x32_bf16 v[208:211], a[220:223], v[252:255], 0
    v_cvt_pk_bf16_f32 v142, v212, v213
    v_cvt_pk_bf16_f32 v143, v214, v215
    v_mfma_f32_16x16x32_bf16 v[204:207], a[224:227], v[252:255], 0
    buffer_store_dwordx4 v[200:203], v245, s[20:23], s58 offen sc0 sc1
    v_mfma_f32_16x16x16_bf16 v[156:159], v[40:41], v[142:143], v[156:159]
    s_waitcnt lgkmcnt(0)
    ds_read_b128 a[244:247], v239 offset:13312
    ds_read_b64_tr_b16 v[164:165], v242 offset:50696
    v_mfma_f32_16x16x32_bf16 v[200:203], a[220:223], v[168:171], 0
    ds_read_b64_tr_b16 v[166:167], v242 offset:61448
    v_cvt_pk_bf16_f32 v162, v144, v145
    v_mfma_f32_16x16x32_bf16 v[180:183], a[224:227], v[168:171], 0
    ds_read_b128 v[168:171], v239 offset:14336
    v_cvt_pk_bf16_f32 v163, v146, v147
    v_mfma_f32_16x16x32_bf16 v[172:175], a[232:235], v[252:255], 0
    ds_read_b128 v[144:147], v230 offset:1280
    v_mov_b32 v6, 0x27e00
    v_mfma_f32_16x16x32_bf16 v[196:199], a[216:219], v[160:163], v[196:199]
    v_exp_f32 v148, v148
    v_mfma_f32_16x16x32_bf16 v[184:187], v[66:69], v[160:163], v[184:187]
    v_exp_f32 v149, v149
    v_mfma_f32_16x16x32_bf16 v[188:191], v[88:91], v[160:163], v[188:191]
    v_exp_f32 v150, v150
    v_mfma_f32_16x16x32_bf16 v[192:195], v[110:113], v[160:163], v[192:195]
    s_waitcnt lgkmcnt(4)
    v_exp_f32 v151, v151
    v_cvt_pk_bf16_f32 v160, v148, v149
    v_cvt_pk_bf16_f32 v161, v150, v151
    v_mfma_f32_16x16x32_bf16 v[208:211], a[0:3], a[244:247], v[208:211]
    ds_read_b128 v[148:151], v235
    v_bfe_u32 v235, s79, v233, 4
    v_mfma_f32_16x16x32_bf16 v[204:207], a[4:7], a[244:247], v[204:207]
    v_mad_u32_u24 v235, v235, s40, v231
    v_mfma_f32_16x16x32_bf16 v[172:175], a[12:15], a[244:247], v[172:175]
    s_waitcnt lgkmcnt(2)
    buffer_store_dwordx4 v[176:179], v244, s[20:23], s58 offen sc0 sc1
    v_mfma_f32_16x16x32_bf16 v[208:211], a[16:19], v[168:171], v[208:211]
    s_add_u32 s58, s51, 0x1a4000
    v_exp_f32 v152, v152
    v_mfma_f32_16x16x32_bf16 v[176:179], a[228:231], v[252:255], 0
    s_waitcnt lgkmcnt(1)
    ds_read_b128 v[252:255], v240 offset:13312
    v_mfma_f32_16x16x32_bf16 v[144:147], v[42:45], v[138:141], v[144:147]
    v_exp_f32 v153, v153
    v_mfma_f32_16x16x32_bf16 v[176:179], a[8:11], a[244:247], v[176:179]
    ds_read_b128 a[244:247], v240 offset:14336
    v_cvt_pk_bf16_f32 v162, v152, v153
    v_mfma_f32_16x16x32_bf16 v[204:207], a[20:23], v[168:171], v[204:207]
    v_exp_f32 v154, v154
    v_mfma_f32_16x16x16_bf16 v[144:147], v[46:47], v[142:143], v[144:147]
    s_waitcnt lgkmcnt(2)
    v_exp_f32 v155, v155
    v_mfma_f32_16x16x32_bf16 v[148:151], v[24:27], v[138:141], v[148:151]
    v_cvt_pk_bf16_f32 v163, v154, v155
    v_mfma_f32_16x16x32_bf16 v[176:179], a[24:27], v[168:171], v[176:179]
    ds_read_b128 v[152:155], v234
    v_bfe_u32 v234, s80, v233, 4
    v_mfma_f32_16x16x32_bf16 v[196:199], a[216:219], v[160:163], v[196:199]
    v_mad_u32_u24 v234, v234, s40, v231
    v_mfma_f32_16x16x32_bf16 v[184:187], v[70:73], v[160:163], v[184:187]
    v_exp_f32 v156, v156
    v_mfma_f32_16x16x32_bf16 v[188:191], v[92:95], v[160:163], v[188:191]
    v_exp_f32 v157, v157
    v_mfma_f32_16x16x32_bf16 v[192:195], v[114:117], v[160:163], v[192:195]
    v_exp_f32 v158, v158
    v_mfma_f32_16x16x16_bf16 v[148:151], v[28:29], v[142:143], v[148:151]
    s_waitcnt lgkmcnt(2)
    v_rcp_f32 v197, v196
    v_mfma_f32_16x16x32_bf16 v[200:203], a[0:3], v[252:255], v[200:203]
    v_mul_f32 v184, v184, v197
    v_mul_f32 v185, v185, v197
    v_mfma_f32_16x16x32_bf16 v[180:183], a[4:7], v[252:255], v[180:183]
    s_waitcnt lgkmcnt(1)
    v_cvt_pk_bf16_f32 v184, v184, v185
    v_mul_f32 v186, v186, v197
    v_mfma_f32_16x16x32_bf16 v[200:203], a[16:19], a[244:247], v[200:203]
    v_mul_f32 v187, v187, v197
    v_cvt_pk_bf16_f32 v185, v186, v187
    v_mfma_f32_16x16x32_bf16 v[180:183], a[20:23], a[244:247], v[180:183]
    s_waitcnt lgkmcnt(0)
    v_mul_f32 v188, v188, v197
    v_mul_f32 v189, v189, v197
    v_mfma_f32_16x16x32_bf16 v[152:155], v[30:33], v[138:141], v[152:155]
    v_cvt_pk_bf16_f32 v186, v188, v189
    v_mul_f32 v190, v190, v197
    v_mfma_f32_16x16x32_bf16 v[172:175], a[28:31], v[168:171], v[172:175]
    v_mul_f32 v191, v191, v197
    v_cvt_pk_bf16_f32 v187, v190, v191
    v_mul_f32 v192, v192, v197
    v_mfma_f32_16x16x16_bf16 v[152:155], v[34:35], v[142:143], v[152:155]
    v_mul_f32 v193, v193, v197
    v_cvt_pk_bf16_f32 v188, v192, v193
    v_mul_f32 v194, v194, v197
    v_mul_f32 v195, v195, v197
    v_cvt_pk_bf16_f32 v189, v194, v195
    v_max3_f32 v236, v236, v196, v197
    ds_write_b128 v237, v[184:187]
    ds_write_b64 v238, v[188:189]
    ds_read_b128 v[252:255], v239 offset:15360
    ds_read_b128 v[168:171], v240 offset:15360
    v_exp_f32 v159, v159
    ds_read_b128 a[244:247], v239 offset:16384
    v_cvt_pk_bf16_f32 v160, v156, v157
    v_cvt_pk_bf16_f32 v161, v158, v159
    ds_read_b128 v[156:159], v235
    v_exp_f32 v144, v144
    v_exp_f32 v145, v145
    v_exp_f32 v146, v146
    v_exp_f32 v147, v147
    v_cvt_pk_bf16_f32 v162, v144, v145
    v_cvt_pk_bf16_f32 v163, v146, v147
    ds_read_b128 v[144:147], v234
    v_exp_f32 v148, v148
    v_mfma_f32_16x16x32_bf16 v[196:199], a[216:219], v[160:163], 0
    s_waitcnt lgkmcnt(5)
    v_exp_f32 v149, v149
    v_mfma_f32_16x16x32_bf16 v[184:187], v[76:79], v[160:163], 0
    s_barrier
    v_exp_f32 v150, v150
    v_mfma_f32_16x16x32_bf16 v[188:191], v[98:101], v[160:163], 0
    v_exp_f32 v151, v151
    v_mfma_f32_16x16x32_bf16 v[192:195], v[120:123], v[160:163], 0
    s_waitcnt lgkmcnt(4)
    v_cvt_pk_bf16_f32 v160, v148, v149
    v_cvt_pk_bf16_f32 v161, v150, v151
    v_mfma_f32_16x16x32_bf16 v[208:211], a[32:35], v[252:255], v[208:211]
    s_waitcnt lgkmcnt(3)
    v_exp_f32 v152, v152
    v_mfma_f32_16x16x32_bf16 v[200:203], a[32:35], v[168:171], v[200:203]
    v_exp_f32 v153, v153
    v_mfma_f32_16x16x32_bf16 v[204:207], a[36:39], v[252:255], v[204:207]
    s_waitcnt lgkmcnt(1)
    v_exp_f32 v154, v154
    v_mfma_f32_16x16x32_bf16 v[156:159], v[48:51], v[138:141], v[156:159]
    v_exp_f32 v155, v155
    v_mfma_f32_16x16x32_bf16 v[180:183], a[36:39], v[168:171], v[180:183]
    s_waitcnt lgkmcnt(0)
    ds_read_b128 v[168:171], v239 offset:17408
    v_cvt_pk_bf16_f32 v162, v152, v153
    v_mfma_f32_16x16x32_bf16 v[144:147], v[54:57], v[138:141], v[144:147]
    v_cvt_pk_bf16_f32 v163, v154, v155
    v_mfma_f32_16x16x16_bf16 v[156:159], v[52:53], v[142:143], v[156:159]
    v_mfma_f32_16x16x32_bf16 v[176:179], a[40:43], v[252:255], v[176:179]
    v_mfma_f32_16x16x32_bf16 v[196:199], a[216:219], v[160:163], v[196:199]
    v_mfma_f32_16x16x32_bf16 v[184:187], v[68:71], v[160:163], v[184:187]
    v_mfma_f32_16x16x32_bf16 v[188:191], v[90:93], v[160:163], v[188:191]
    v_mfma_f32_16x16x32_bf16 v[192:195], v[112:115], v[160:163], v[192:195]
    v_mfma_f32_16x16x16_bf16 v[144:147], v[58:59], v[142:143], v[144:147]
    v_mfma_f32_16x16x32_bf16 v[172:175], a[44:47], v[252:255], v[172:175]
    ds_read_b128 v[252:255], v240 offset:16384
    v_mfma_f32_16x16x32_bf16 v[208:211], a[48:51], a[244:247], v[208:211]
    v_exp_f32 v156, v156
    v_mfma_f32_16x16x32_bf16 v[204:207], a[52:55], a[244:247], v[204:207]
    v_exp_f32 v157, v157
    v_mfma_f32_16x16x32_bf16 v[176:179], a[56:59], a[244:247], v[176:179]
    v_exp_f32 v158, v158
    v_mfma_f32_16x16x32_bf16 v[172:175], a[60:63], a[244:247], v[172:175]
    s_waitcnt lgkmcnt(1)
    ds_read_b128 a[244:247], v240 offset:17408
    v_cvt_pk_bf16_f32 v160, v156, v157
    v_mfma_f32_16x16x32_bf16 v[208:211], a[64:67], v[168:171], v[208:211]
    v_exp_f32 v159, v159
    v_mfma_f32_16x16x32_bf16 v[204:207], a[68:71], v[168:171], v[204:207]
    v_cvt_pk_bf16_f32 v161, v158, v159
    v_mfma_f32_16x16x32_bf16 v[176:179], v[248:251], v[168:171], v[176:179]
    ds_read_b64_tr_b16 v[248:249], v242 offset:50688
    ds_read_b64_tr_b16 v[250:251], v242 offset:61440
    v_mfma_f32_16x16x32_bf16 v[172:175], v[164:167], v[168:171], v[172:175]
    s_waitcnt lgkmcnt(3)
    ds_read_b128 v[168:171], v224 offset:1024
    v_cvt_pk_bf16_f32 v208, v208, v209
    v_mfma_f32_16x16x32_bf16 v[200:203], a[48:51], v[252:255], v[200:203]
    ds_read_b64_tr_b16 v[164:165], v242 offset:50696
    v_cvt_pk_bf16_f32 v209, v210, v211
    v_mfma_f32_16x16x32_bf16 v[180:183], a[52:55], v[252:255], v[180:183]
    s_waitcnt lgkmcnt(4)
    v_cvt_pk_bf16_f32 v210, v204, v205
    v_cvt_pk_bf16_f32 v211, v206, v207
    buffer_store_dwordx4 v[208:211], v243, s[20:23], s58 offen sc0 sc1
    v_mfma_f32_16x16x32_bf16 v[200:203], a[64:67], a[244:247], v[200:203]
    ds_read_b128 v[252:255], v224
    v_cvt_pk_bf16_f32 v176, v176, v177
    v_mfma_f32_16x16x32_bf16 v[180:183], a[68:71], a[244:247], v[180:183]
    v_cvt_pk_bf16_f32 v177, v178, v179
    v_cvt_pk_bf16_f32 v178, v172, v173
    v_cvt_pk_bf16_f32 v179, v174, v175
    ds_read_b128 a[244:247], v224 offset:2048
    ds_read_b64_tr_b16 v[166:167], v242 offset:61448
    v_cvt_pk_bf16_f32 v200, v200, v201
    v_cvt_pk_bf16_f32 v201, v202, v203
    v_exp_f32 v144, v144
    v_cvt_pk_bf16_f32 v202, v180, v181
    v_cvt_pk_bf16_f32 v203, v182, v183
    v_exp_f32 v145, v145
    v_exp_f32 v146, v146
    v_exp_f32 v147, v147
    v_cvt_pk_bf16_f32 v162, v144, v145
    v_cvt_pk_bf16_f32 v163, v146, v147
    s_nop 1
    v_mfma_f32_16x16x32_bf16 v[196:199], a[216:219], v[160:163], v[196:199]
    v_mfma_f32_16x16x32_bf16 v[184:187], v[82:85], v[160:163], v[184:187]
    v_mfma_f32_16x16x32_bf16 v[188:191], v[104:107], v[160:163], v[188:191]
    v_mfma_f32_16x16x32_bf16 v[192:195], v[126:129], v[160:163], v[192:195]
    s_waitcnt lgkmcnt(2)
    buffer_store_dwordx4 v[200:203], v245, s[20:23], s58 offen sc0 sc1
    v_mfma_f32_16x16x32_bf16 v[208:211], a[220:223], v[252:255], 0
    v_mfma_f32_16x16x32_bf16 v[204:207], a[224:227], v[252:255], 0
    v_mfma_f32_16x16x32_bf16 v[200:203], a[228:231], v[252:255], 0
    v_mfma_f32_16x16x32_bf16 v[180:183], a[232:235], v[252:255], 0
    ds_read_b128 v[252:255], v224 offset:3072
    v_mfma_f32_16x16x32_bf16 v[208:211], a[0:3], v[168:171], v[208:211]
    v_rcp_f32 v197, v196
    v_mfma_f32_16x16x32_bf16 v[204:207], a[4:7], v[168:171], v[204:207]
    v_mul_f32 v184, v184, v197
    v_mul_f32 v185, v185, v197
    v_mfma_f32_16x16x32_bf16 v[200:203], a[8:11], v[168:171], v[200:203]
    v_cvt_pk_bf16_f32 v184, v184, v185
    v_mul_f32 v186, v186, v197
    v_mfma_f32_16x16x32_bf16 v[180:183], a[12:15], v[168:171], v[180:183]
    s_waitcnt lgkmcnt(1)
    ds_read_b128 v[168:171], v224 offset:4096
    v_mul_f32 v187, v187, v197
    v_mfma_f32_16x16x32_bf16 v[208:211], a[16:19], a[244:247], v[208:211]
    v_cvt_pk_bf16_f32 v185, v186, v187
    v_mul_f32 v188, v188, v197
    v_mfma_f32_16x16x32_bf16 v[204:207], a[20:23], a[244:247], v[204:207]
    v_mul_f32 v189, v189, v197
    v_cvt_pk_bf16_f32 v186, v188, v189
    v_mfma_f32_16x16x32_bf16 v[200:203], a[24:27], a[244:247], v[200:203]
    v_mul_f32 v190, v190, v197
    v_mul_f32 v191, v191, v197
    v_mfma_f32_16x16x32_bf16 v[180:183], a[28:31], a[244:247], v[180:183]
    s_waitcnt lgkmcnt(1)
    buffer_store_dwordx4 v[176:179], v244, s[20:23], s58 offen sc0 sc1
    v_mfma_f32_16x16x32_bf16 v[208:211], a[32:35], v[252:255], v[208:211]
    s_add_u32 s58, s51, 0x1f8000
    ds_read_b128 a[244:247], v224 offset:5120
    v_cvt_pk_bf16_f32 v187, v190, v191
    v_mfma_f32_16x16x32_bf16 v[204:207], a[36:39], v[252:255], v[204:207]
    v_mul_f32 v192, v192, v197
    v_mul_f32 v193, v193, v197
    v_mfma_f32_16x16x32_bf16 v[200:203], a[40:43], v[252:255], v[200:203]
    v_cvt_pk_bf16_f32 v188, v192, v193
    v_mul_f32 v194, v194, v197
    v_mfma_f32_16x16x32_bf16 v[180:183], a[44:47], v[252:255], v[180:183]
    s_waitcnt lgkmcnt(1)
    v_mul_f32 v195, v195, v197
    v_cvt_pk_bf16_f32 v189, v194, v195
    v_mfma_f32_16x16x32_bf16 v[208:211], a[48:51], v[168:171], v[208:211]
    v_max3_f32 v236, v236, v196, v197
    v_cmp_lt_f32 vcc, 0x53800000, v236
    v_mfma_f32_16x16x32_bf16 v[204:207], a[52:55], v[168:171], v[204:207]
    ds_write_b128 v237, v[184:187] offset:6144
    v_mfma_f32_16x16x32_bf16 v[200:203], a[56:59], v[168:171], v[200:203]
    s_or_b32 s24, vcc_lo, vcc_hi
    ds_write_b64 v238, v[188:189] offset:6144
    v_mfma_f32_16x16x32_bf16 v[180:183], a[60:63], v[168:171], v[180:183]
    s_waitcnt lgkmcnt(2)
    v_mov_b32 v4, s24
    v_mfma_f32_16x16x32_bf16 v[208:211], a[64:67], a[244:247], v[208:211]
    ds_write_b32 v5, v4
    v_mfma_f32_16x16x32_bf16 v[204:207], a[68:71], a[244:247], v[204:207]
    v_mfma_f32_16x16x32_bf16 v[200:203], v[248:251], a[244:247], v[200:203]
    ds_read_b64_tr_b16 v[248:249], v242 offset:50688
    ds_read_b64_tr_b16 v[250:251], v242 offset:61440
    v_mfma_f32_16x16x32_bf16 v[180:183], v[164:167], a[244:247], v[180:183]
    s_waitcnt lgkmcnt(2)
    ds_read_b64_tr_b16 v[164:165], v242 offset:50696
    ds_read_b64_tr_b16 v[166:167], v242 offset:61448
    v_cvt_pk_bf16_f32 v208, v208, v209
    v_cvt_pk_bf16_f32 v209, v210, v211
    v_cvt_pk_bf16_f32 v210, v204, v205
    v_cvt_pk_bf16_f32 v211, v206, v207
    buffer_store_dwordx4 v[208:211], v225, s[20:23], s58 offen sc0 sc1
    v_cvt_pk_bf16_f32 v200, v200, v201
    v_cvt_pk_bf16_f32 v201, v202, v203
    v_cvt_pk_bf16_f32 v202, v180, v181
    v_cvt_pk_bf16_f32 v203, v182, v183
    s_barrier
    ds_read_b128 v[252:255], v227
    ds_read_b128 v[168:171], v227 offset:1024
    ds_read_b128 a[244:247], v227 offset:2048
    ds_read_b128 v[0:3], v6
    s_waitcnt lgkmcnt(3)
    v_mfma_f32_16x16x32_bf16 v[176:179], a[220:223], v[252:255], 0
    v_mfma_f32_16x16x32_bf16 v[172:175], a[224:227], v[252:255], 0
    s_waitcnt lgkmcnt(0)
    buffer_store_dwordx4 v[200:203], v226, s[20:23], s58 offen sc0 sc1
    v_mfma_f32_16x16x32_bf16 v[208:211], a[228:231], v[252:255], 0
    s_add_u32 s58, s51, 0x1f8000
    v_or3_b32 v0, v0, v1, v2
    v_or_b32 v0, v0, v3
    v_mfma_f32_16x16x32_bf16 v[204:207], a[232:235], v[252:255], 0
    ds_read_b128 v[252:255], v227 offset:3072
    v_readfirstlane_b32 s24, v0
    v_mfma_f32_16x16x32_bf16 v[176:179], a[0:3], v[168:171], v[176:179]
    v_mfma_f32_16x16x32_bf16 v[172:175], a[4:7], v[168:171], v[172:175]
    v_mfma_f32_16x16x32_bf16 v[208:211], a[8:11], v[168:171], v[208:211]
    v_mfma_f32_16x16x32_bf16 v[204:207], a[12:15], v[168:171], v[204:207]
    ds_read_b128 v[168:171], v227 offset:4096
    v_mfma_f32_16x16x32_bf16 v[176:179], a[16:19], a[244:247], v[176:179]
    v_mfma_f32_16x16x32_bf16 v[172:175], a[20:23], a[244:247], v[172:175]
    v_mfma_f32_16x16x32_bf16 v[208:211], a[24:27], a[244:247], v[208:211]
    v_mfma_f32_16x16x32_bf16 v[204:207], a[28:31], a[244:247], v[204:207]
    s_waitcnt lgkmcnt(1)
    ds_read_b128 a[244:247], v227 offset:5120
    v_mfma_f32_16x16x32_bf16 v[176:179], a[32:35], v[252:255], v[176:179]
    v_mfma_f32_16x16x32_bf16 v[172:175], a[36:39], v[252:255], v[172:175]
    v_mfma_f32_16x16x32_bf16 v[208:211], a[40:43], v[252:255], v[208:211]
    v_mfma_f32_16x16x32_bf16 v[204:207], a[44:47], v[252:255], v[204:207]
    s_waitcnt lgkmcnt(1)
    v_mfma_f32_16x16x32_bf16 v[176:179], a[48:51], v[168:171], v[176:179]
    v_mfma_f32_16x16x32_bf16 v[172:175], a[52:55], v[168:171], v[172:175]
    v_mfma_f32_16x16x32_bf16 v[208:211], a[56:59], v[168:171], v[208:211]
    v_mfma_f32_16x16x32_bf16 v[204:207], a[60:63], v[168:171], v[204:207]
    s_waitcnt lgkmcnt(0)
    v_mfma_f32_16x16x32_bf16 v[176:179], a[64:67], a[244:247], v[176:179]
    v_mfma_f32_16x16x32_bf16 v[172:175], a[68:71], a[244:247], v[172:175]
    v_mfma_f32_16x16x32_bf16 v[208:211], v[248:251], a[244:247], v[208:211]
    v_mfma_f32_16x16x32_bf16 v[204:207], v[164:167], a[244:247], v[204:207]
    s_nop 4
    v_cvt_pk_bf16_f32 v176, v176, v177
    v_cvt_pk_bf16_f32 v177, v178, v179
    v_cvt_pk_bf16_f32 v178, v172, v173
    v_cvt_pk_bf16_f32 v179, v174, v175
    buffer_store_dwordx4 v[176:179], v246, s[20:23], s58 offen sc0 sc1
    v_cvt_pk_bf16_f32 v208, v208, v209
    v_cvt_pk_bf16_f32 v209, v210, v211
    v_cvt_pk_bf16_f32 v210, v204, v205
    v_cvt_pk_bf16_f32 v211, v206, v207
    buffer_store_dwordx4 v[208:211], v247, s[20:23], s58 offen sc0 sc1
    s_nop 1
    s_cmp_lg_u32 s24, 0
    s_cbranch_scc1 L_safe
L_exit:
    s_endpgm
L_end:
L_safe:
    s_waitcnt vmcnt(0) lgkmcnt(0)
    s_barrier
    v_mbcnt_lo_u32_b32 v0, -1, 0
    v_mbcnt_hi_u32_b32 v0, -1, v0
    s_lshl_b32 s24, s36, 6
    v_add_u32 v0, s24, v0
    s_load_dwordx4 s[24:27], s[0:1], 0
    s_load_dwordx4 s[28:31], s[0:1], 16
    s_load_dwordx2 s[32:33], s[0:1], 32
    v_lshrrev_b32 v74, 6, v0
    v_and_b32 v184, 63, v0
    v_readfirstlane_b32 s36, v74
    v_mul_u32_u24 v76, 0x2aab, v184
    v_lshrrev_b32 v76, 16, v76
    v_mul_u32_u24 v74, 6, v76
    v_sub_u32 v77, v184, v74
    v_lshrrev_b32 v74, 1, v76
    v_and_b32 v74, 4, v74
    v_xor_b32 v76, v76, v74
    v_mul_u32_u24 v74, 0x480, v76
    v_lshl_add_u32 v251, v77, 4, v74
    v_add_u32 v79, 64, v184
    v_mul_u32_u24 v78, 0x2aab, v79
    v_lshrrev_b32 v78, 16, v78
    v_mul_u32_u24 v74, 6, v78
    v_sub_u32 v79, v79, v74
    v_lshrrev_b32 v74, 1, v78
    v_and_b32 v74, 4, v74
    v_xor_b32 v78, v78, v74
    v_mul_u32_u24 v74, 0x480, v78
    v_lshl_add_u32 v252, v79, 4, v74
    v_add_u32 v81, 0x80, v184
    v_mul_u32_u24 v80, 0x2aab, v81
    v_lshrrev_b32 v80, 16, v80
    v_mul_u32_u24 v74, 6, v80
    v_sub_u32 v81, v81, v74
    v_lshrrev_b32 v74, 1, v80
    v_and_b32 v74, 4, v74
    v_xor_b32 v80, v80, v74
    v_mul_u32_u24 v74, 0x480, v80
    v_lshl_add_u32 v253, v81, 4, v74
    s_mul_i32 s49, s36, 0x60
    s_mul_i32 s50, s36, 0xc00
    s_add_u32 s50, s50, 0x15e00
    s_mov_b32 s10, 0x36000
    s_mov_b32 s11, 0x20000
    s_add_u32 s57, s49, 0x180
    s_add_u32 m0, s50, 0
    s_lshr_b32 s53, s2, 3
    s_and_b32 s54, s2, 1
    s_lshl_b32 s54, s54, 2
    s_lshr_b32 s55, s53, 3
    s_or_b32 s34, s54, s55
    s_and_b32 s35, s53, 7
    s_bfe_u32 s54, s2, 0x10002
    s_mul_i32 s54, s54, 0x15000
    s_bfe_u32 s55, s2, 0x10001
    s_mul_i32 s55, s55, 0x180
    s_add_u32 s38, s54, s55
    s_lshl_b32 s41, s36, 10
    s_add_u32 s42, s41, 0x1000
    s_min_u32 s42, s42, 0x1a00
    s_mul_i32 s54, s35, 14
    s_sub_u32 s54, s54, 3
    s_movk_i32 s53, 0x6f
    s_lshr_b32 s55, s41, 4
    v_add_u32 v96, s55, v184
    v_mul_u32_u24 v97, 0xaab, v96
    v_lshrrev_b32 v97, 16, v97
    v_mul_u32_u24 v98, 24, v97
    v_sub_u32 v96, v96, v98
    v_and_b32 v98, 2, v97
    v_xor_b32 v96, v96, v98
    v_add_u32 v97, s54, v97
    v_med3_i32 v97, v97, 0, s53
    v_mul_u32_u24 v97, 0x300, v97
    v_lshl_add_u32 v246, v96, 4, v97
    s_lshr_b32 s55, s42, 4
    v_add_u32 v96, s55, v184
    s_waitcnt lgkmcnt(0)
    s_mov_b32 s8, s26
    s_and_b32 s9, s27, 0xffff
    buffer_load_dwordx4 v251, s[8:11], s57 offen lds
    s_add_u32 m0, s50, 0x400
    v_mul_u32_u24 v97, 0xaab, v96
    buffer_load_dwordx4 v252, s[8:11], s57 offen lds
    s_add_u32 m0, s50, 0x800
    v_lshrrev_b32 v97, 16, v97
    buffer_load_dwordx4 v253, s[8:11], s57 offen lds
    v_mul_u32_u24 v98, 24, v97
    v_sub_u32 v96, v96, v98
    v_and_b32 v98, 2, v97
    v_xor_b32 v96, v96, v98
    v_add_u32 v97, s54, v97
    v_med3_i32 v97, v97, 0, s53
    v_mul_u32_u24 v97, 0x300, v97
    v_lshl_add_u32 v247, v96, 4, v97
    s_mul_i32 s51, s34, 0x24c000
    s_add_u32 s51, s51, s38
    s_sub_u32 s39, s51, 0x7e000
    s_cmp_eq_u32 s34, 0
    s_cselect_b32 s43, 8, 0
    s_cselect_b32 s44, 9, 1
    s_cselect_b32 s45, 3, 2
    s_mul_i32 s43, s43, 0x2a000
    s_add_u32 s43, s43, s39
    s_mul_i32 s44, s44, 0x2a000
    s_add_u32 s44, s44, s39
    s_mul_i32 s45, s45, 0x2a000
    s_add_u32 s45, s45, s39
    s_mov_b32 s4, s24
    s_and_b32 s5, s25, 0xffff
    s_mov_b32 s6, 0x1260000
    s_mov_b32 s7, 0x20000
    s_mov_b32 s12, s28
    s_and_b32 s13, s29, 0xffff
    s_mov_b32 s14, 0x12000
    s_mov_b32 s15, 0x20000
    s_mov_b32 s16, s30
    s_and_b32 s17, s31, 0xffff
    s_mov_b32 s18, 0x548
    s_mov_b32 s19, 0x20000
    s_mov_b32 s20, s32
    s_and_b32 s21, s33, 0xffff
    s_mov_b32 s22, 0x1260000
    s_mov_b32 s23, 0x20000
    s_add_u32 m0, s41, 0
    s_add_u32 s56, s39, 0x7e000
    buffer_load_dwordx4 v246, s[4:7], s43 offen lds
    s_add_u32 m0, s42, 0
    s_add_u32 s57, s49, 0x9180
    buffer_load_dwordx4 v247, s[4:7], s43 offen lds
    s_add_u32 m0, s41, 0x1e40
    s_mul_i32 s55, s36, 0x152
    buffer_load_dwordx4 v246, s[4:7], s44 offen lds
    s_add_u32 m0, s42, 0x1e40
    v_lshlrev_b32 v199, 1, v184
    buffer_load_dwordx4 v247, s[4:7], s44 offen lds
    s_add_u32 m0, s41, 0x3c80
    v_lshrrev_b32 v185, 4, v184
    buffer_load_dwordx4 v246, s[4:7], s45 offen lds
    s_add_u32 m0, s42, 0x3c80
    v_and_b32 v186, 7, v184
    v_bfe_u32 v187, v184, 3, 1
    v_bfe_u32 v96, v184, 2, 2
    v_and_b32 v97, 3, v184
    v_and_b32 v103, 1, v185
    v_lshl_add_u32 v99, v185, 3, v96
    v_lshl_add_u32 v99, v103, 2, v99
    v_lshl_add_u32 v101, v97, 3, s50
    s_movk_i32 s27, 0x60
    v_mad_u32_u24 v254, v99, s27, v101
    buffer_load_dwordx4 v247, s[4:7], s45 offen lds
    s_add_u32 m0, s41, 0x5ac0
    v_xor_b32 v99, 4, v99
    v_mad_u32_u24 v255, v99, s27, v101
    v_mul_u32_u24 v102, 0x1e40, v187
    v_and_b32 v98, 2, v184
    v_xor_b32 v98, v98, v185
    v_lshlrev_b32 v98, 4, v98
    v_mul_u32_u24 v100, 0x180, v186
    v_add3_u32 v224, v98, v100, v102
    v_mul_u32_u24 v99, 0x1e40, v96
    v_mul_u32_u24 v227, 0x180, v97
    buffer_load_dwordx4 v246, s[4:7], s56 offen lds
    s_add_u32 m0, s42, 0x5ac0
    v_add3_u32 v227, v227, v98, v99
    v_mul_u32_u24 v74, 0x180, v76
    v_lshl_add_u32 v192, v77, 4, v74
    v_mul_u32_u24 v74, 0x180, v78
    v_lshl_add_u32 v193, v79, 4, v74
    v_mul_u32_u24 v74, 0x180, v80
    v_lshl_add_u32 v194, v81, 4, v74
    v_add_u32 v98, 3, v186
    v_and_b32 v98, 2, v98
    buffer_load_dwordx4 v247, s[4:7], s56 offen lds
    s_add_u32 m0, s50, 0x3000
    s_add_u32 s56, s39, 0xa8000
    v_xor_b32 v98, v98, v185
    v_lshl_add_u32 v98, v98, 4, v100
    v_add_u32 v225, v98, v102
    v_xor_b32 v99, 1, v187
    v_mul_u32_u24 v99, 0xd3c0, v99
    v_add_u32 v226, v98, v99
    v_lshl_add_u32 v99, v185, 2, v96
    v_and_b32 v98, 2, v185
    v_lshlrev_b32 v98, 1, v98
    v_xor_b32 v99, v99, v98
    buffer_load_dwordx4 v251, s[8:11], s57 offen lds
    s_add_u32 m0, s50, 0x3400
    v_mul_u32_u24 v99, 0x60, v99
    v_lshl_add_u32 v99, v97, 4, v99
    s_and_b32 s24, s36, 1
    s_lshl_b32 s25, s24, 5
    s_add_u32 s26, s25, s50
    v_add_u32 v241, s26, v99
    v_lshrrev_b32 v98, 1, v97
    v_mul_u32_u24 v98, 0xba0, v98
    s_lshr_b32 s27, s36, 1
    s_mul_i32 s26, s27, 0x1800
    s_add_u32 s26, s26, 0x15e40
    v_add3_u32 v242, v99, v98, s26
    buffer_load_dwordx4 v252, s[8:11], s57 offen lds
    s_add_u32 m0, s50, 0x3800
    v_mul_u32_u24 v99, 0x2a000, v187
    v_lshl_add_u32 v99, v100, 1, v99
    v_lshl_add_u32 v99, v185, 4, v99
    v_cmp_lt_u32 vcc, 5, v186
    v_add_u32 v98, 0x1800, v99
    v_bfrev_b32 v101, 1
    v_cndmask_b32 v98, v98, v101, vcc
    s_sub_u32 s59, 0, s24
    s_mov_b32 vcc_lo, s59
    s_mov_b32 vcc_hi, s59
    v_cndmask_b32 v101, v99, v98, vcc
    buffer_load_dwordx4 v253, s[8:11], s57 offen lds
    s_add_u32 s57, s49, 0x12180
    s_add_u32 m0, s50, 0x6000
    v_cndmask_b32 v102, v98, v99, vcc
    s_add_u32 s25, s25, s49
    v_add_u32 v243, s25, v101
    v_add_u32 v245, s25, v102
    s_mul_i32 s26, s27, 0xc0
    s_add_u32 s26, s26, 64
    v_add_u32 v244, s26, v101
    s_mul_i32 s25, s35, 0x2a00
    s_add_u32 s51, s51, s25
    s_add_u32 s58, s51, 0
    v_lshlrev_b32 v99, 4, v184
    v_add_u32 v99, 0x12e00, v99
    buffer_load_dwordx4 v251, s[8:11], s57 offen lds
    s_add_u32 m0, s50, 0x6400
    s_mul_i32 s25, s24, 0x1800
    v_add_u32 v239, s25, v99
    s_sub_u32 s25, 0x1800, s25
    v_add_u32 v240, s25, v99
    s_mul_i32 s25, s27, 0xc00
    s_lshl_b32 s26, s24, 11
    s_add_u32 s26, s26, s25
    s_waitcnt vmcnt(12)
    ds_read_b64_tr_b16 a[0:1], v254
    ds_read_b64_tr_b16 a[2:3], v255
    ds_read_b64_tr_b16 a[4:5], v254 offset:32
    ds_read_b64_tr_b16 a[6:7], v255 offset:32
    ds_read_b64_tr_b16 a[8:9], v254 offset:64
    ds_read_b64_tr_b16 a[10:11], v255 offset:64
    v_add_u32 v237, s26, v99
    buffer_load_dwordx4 v252, s[8:11], s57 offen lds
    s_add_u32 m0, s50, 0x6800
    s_lshl_b32 s26, s24, 3
    s_add_u32 s26, s26, s25
    s_add_u32 s26, s26, 0x400
    v_add_u32 v238, s26, v99
    s_mov_b32 s37, 0x3e553b95
    s_mov_b32 s40, 0x140
    s_cmp_eq_u32 s34, 7
    s_cselect_b32 s46, 16, 17
    s_cselect_b32 s47, 10, 18
    s_cselect_b32 s48, 11, 19
    s_mul_i32 s46, s46, 0x2a000
    s_add_u32 s46, s46, s39
    s_mul_i32 s47, s47, 0x2a000
    s_add_u32 s47, s47, s39
    s_mul_i32 s48, s48, 0x2a000
    s_add_u32 s48, s48, s39
    buffer_load_dwordx4 v253, s[8:11], s57 offen lds
    s_add_u32 s57, s49, 0x1b180
    s_add_u32 m0, s50, 0x9000
    v_mov_b32 v96, 0x3f803f80
    v_accvgpr_write_b32 a216, v96
    v_accvgpr_write_b32 a217, v96
    v_accvgpr_write_b32 a218, v96
    v_accvgpr_write_b32 a219, v96
    s_cmp_eq_u32 s35, 0
    s_cselect_b32 s29, 3, 0
    s_cselect_b32 s30, -3, -2
    s_cmp_eq_u32 s35, 7
    s_cselect_b32 s33, 2, 64
    s_mul_i32 s32, s36, 0xf00
    s_add_u32 s32, s32, 0xf200
    v_lshrrev_b32 v60, 1, v185
    buffer_load_ushort v196, v199, s[16:19], s55 offen
    buffer_load_ushort v197, v199, s[16:19], s55 offen offset:128
    v_lshl_add_u32 v61, v187, 1, v60
    v_lshlrev_b32 v232, 2, v61
    buffer_load_ushort v198, v199, s[16:19], s55 offen offset:256
    buffer_load_dwordx4 v251, s[8:11], s57 offen lds
    s_add_u32 m0, s50, 0x9400
    v_lshl_add_u32 v61, v187, 2, v185
    v_lshlrev_b32 v233, 2, v61
    v_sub_u32 v60, v60, v187
    v_mul_i32_i24 v60, 0x140, v60
    s_sub_u32 s31, s32, 0x140
    v_add_u32 v60, s31, v60
    v_lshl_add_u32 v61, v103, 2, 3
    v_cmp_gt_u32 vcc, s29, v186
    v_sub_u32 v62, v61, v186
    v_min_u32 v63, 10, v62
    v_mad_u32_u24 v64, v186, 3, v103
    buffer_load_dwordx4 v252, s[8:11], s57 offen lds
    s_add_u32 m0, s50, 0x9800
    s_waitcnt vmcnt(15)
    s_barrier
    ds_read_b128 a[236:239], v224
    ds_read_b128 a[240:243], v224 offset:64
    ds_read_b128 a[244:247], v224 offset:128
    v_add_u32 v65, 11, v64
    ds_read_b128 a[248:251], v224 offset:192
    v_cndmask_b32 v63, v63, v65, vcc
    ds_read_b128 a[252:255], v224 offset:256
    ds_read_b128 a[220:223], v224 offset:320
    v_lshl_add_u32 v228, v63, 4, v60
    buffer_load_dwordx4 v253, s[8:11], s57 offen lds
    s_add_u32 s57, s49, 0x24180
    s_add_u32 m0, s50, 0xc000
    ds_read_b128 a[224:227], v224 offset:3072
    ds_read_b128 a[228:231], v224 offset:3136
    v_add_u32 v62, 8, v62
    ds_read_b128 a[232:235], v224 offset:3200
    v_min_u32 v63, 10, v62
    v_lshl_add_u32 v62, v103, 4, v186
    v_cmp_gt_u32 vcc, s29, v62
    s_waitcnt lgkmcnt(8)
    v_mfma_f32_16x16x32_bf16 v[220:223], a[0:3], a[236:239], 0
    s_mov_b32 s60, 0x2222
    v_add_u32 v65, 13, v64
    s_mov_b32 s61, 0x4444
    v_mfma_f32_16x16x32_bf16 v[216:219], a[4:7], a[236:239], 0
    s_mov_b32 s62, 0x8808
    buffer_load_dwordx4 v251, s[8:11], s57 offen lds
    v_mfma_f32_16x16x32_bf16 v[212:215], a[8:11], a[236:239], 0
    s_add_u32 m0, s50, 0xc400
    ds_read_b128 a[236:239], v224 offset:3264
    v_min_u32 v62, 5, v186
    v_cndmask_b32 v63, v63, v65, vcc
    v_lshl_add_u32 v229, v63, 4, v60
    v_cmp_lt_u32 vcc, s33, v62
    v_sub_u32 v63, v61, v62
    v_min_u32 v63, 10, v63
    v_mad_u32_u24 v64, v62, 3, 2
    v_add_u32 v65, v64, v103
    s_waitcnt lgkmcnt(3)
    v_mfma_f32_16x16x32_bf16 v[208:211], a[0:3], a[224:227], 0
    s_mov_b32 s63, 0x32104321
    v_cndmask_b32 v63, v63, v65, vcc
    v_lshl_add_u32 v230, v63, 4, v60
    v_mfma_f32_16x16x32_bf16 v[204:207], a[4:7], a[224:227], 0
    s_mov_b32 s64, 0x76540765
    buffer_load_dwordx4 v252, s[8:11], s57 offen lds
    v_mfma_f32_16x16x32_bf16 v[200:203], a[8:11], a[224:227], 0
    s_add_u32 m0, s50, 0xc800
    v_sub_u32 v63, 11, v62
    v_min_u32 v63, 10, v63
    v_add_u32 v65, 2, v64
    v_cndmask_b32 v63, v63, v65, vcc
    v_lshl_add_u32 v231, v63, 4, s32
    s_mov_b32 s65, 0x2222
    s_mov_b32 s66, 0x10002100
    s_mov_b32 s67, 0x54326543
    s_mov_b32 s68, 0x760007
    s_mov_b32 s69, 0x32104321
    s_mov_b32 s70, 0x76540765
    s_mov_b32 s71, 0x10002100
    s_mov_b32 s72, 0x760007
    s_mov_b32 s73, 0x2222
    s_mov_b32 s74, 0x8808
    buffer_load_dwordx4 v253, s[8:11], s57 offen lds
    s_add_u32 s57, s49, 0x2d180
    s_add_u32 m0, s50, 0xf000
    s_waitcnt vmcnt(15)
    s_barrier
    ds_read_b128 a[224:227], v224 offset:15680
    s_mov_b32 s75, 0x760007
    s_mov_b32 s76, 0x10002100
    s_mov_b32 s77, 0x6666
    s_mov_b32 s78, 0x8808
    s_mov_b32 s79, 0x32104321
    s_mov_b32 s80, 0x76540765
    s_cmp_eq_u32 s34, 0
    s_cmov_b32 s60, 0xbbbb
    s_cmov_b32 s61, 0x4241
    v_bfe_u32 v234, s60, v232, 4
    v_mad_u32_u24 v235, v234, s40, v228
    v_mad_u32_u24 v234, v234, s40, v229
    v_bfe_u32 v250, s61, v232, 4
    s_cmp_eq_u32 s34, 0
    s_cmov_b32 s62, 0x8898
    s_cmov_b32 s63, 0x30a940ba
    buffer_load_dwordx4 v251, s[8:11], s57 offen lds
    s_add_u32 m0, s50, 0xf400
    s_cmp_eq_u32 s34, 0
    s_cmov_b32 s64, 0x76549765
    s_cmov_b32 s65, 0x2221
    s_cmp_eq_u32 s34, 0
    s_cmov_b32 s66, 0x10002000
    s_cmov_b32 s68, 0x760097
    s_cmp_eq_u32 s34, 7
    s_cmov_b32 s73, 0x2d22
    s_cmov_b32 s74, 0x1808
    s_cmp_eq_u32 s34, 7
    s_cmov_b32 s75, 0x60007
    s_cmov_b32 s76, 0x1b002100
    s_cmp_eq_u32 s34, 7
    s_cmov_b32 s77, 0x1606
    s_cmov_b32 s78, 0xbbbb
    s_cmp_eq_u32 s34, 7
    s_cmov_b32 s79, 0x321b4321
    s_cmov_b32 s80, 0xa904ba05
    s_lshl_b32 s31, s36, 10
    buffer_load_dwordx4 v252, s[8:11], s57 offen lds
    s_add_u32 m0, s50, 0xf800
    s_add_u32 s31, s31, 0x12e40
    v_and_b32 v118, 31, v184
    v_min_u32 v118, 19, v118
    v_lshrrev_b32 v119, 5, v184
    v_add_u32 v120, -11, v118
    v_max_i32 v120, 0, v120
    v_mul_u32_u24 v121, 11, v120
    v_lshrrev_b32 v121, 5, v121
    v_mul_u32_u24 v122, 3, v121
    v_sub_u32 v120, v120, v122
    v_lshlrev_b32 v120, 2, v120
    v_sub_u32 v121, v120, v121
    v_cmp_lt_u32 vcc, 10, v118
    v_add_u32 v121, s29, v121
    v_add_u32 v120, s30, v120
    v_add_u32 v122, -3, v118
    v_cndmask_b32 v121, v118, v121, vcc
    v_cndmask_b32 v120, v122, v120, vcc
    s_mov_b32 vcc_lo, s59
    s_mov_b32 vcc_hi, s59
    buffer_load_dwordx4 v253, s[8:11], s57 offen lds
    s_add_u32 m0, s41, 0x7900
    s_waitcnt vmcnt(15)
    ds_read_b64_tr_b16 a[12:13], v254 offset:12288
    ds_read_b64_tr_b16 a[14:15], v255 offset:12288
    ds_read_b64_tr_b16 a[16:17], v254 offset:12320
    ds_read_b64_tr_b16 a[18:19], v255 offset:12320
    ds_read_b64_tr_b16 a[20:21], v254 offset:12352
    ds_read_b64_tr_b16 a[22:23], v255 offset:12352
    s_add_u32 s57, s49, 0x300
    v_mad_u32_u24 v121, v119, 13, v121
    v_lshl_add_u32 v121, v121, 2, s31
    s_cmp_eq_u32 s34, 0
    s_cselect_b32 s28, 0x208, 0
    v_add_u32 v122, s28, v121
    v_cmp_gt_u32 s[24:25], 7, v120
    v_add_u32 v120, 1, v120
    v_cmp_gt_u32 s[26:27], 7, v120
    v_add_u32 v120, 1, v120
    v_cmp_gt_u32 s[52:53], 7, v120
    v_add_u32 v120, 1, v120
    buffer_load_dwordx4 v246, s[4:7], s56 offen lds
    s_add_u32 m0, s42, 0x7900
    v_cmp_gt_u32 s[54:55], 7, v120
    v_lshl_add_u32 v118, v118, 4, s32
    v_mad_u32_u24 v123, v119, s40, v118
    v_lshlrev_b32 v119, 3, v119
    v_mad_u32_u24 v124, v119, s40, v118
    v_lshl_add_u32 v125, v184, 2, s31
    s_mov_b32 s28, 0x40ddb3d7
    v_mov_b32 v168, 0xf149f2ca
    v_mov_b32 v169, 0xf149f2ca
    s_waitcnt lgkmcnt(4)
    v_mfma_f32_16x16x32_bf16 v[220:223], a[12:15], a[240:243], v[220:223]
    s_waitcnt lgkmcnt(2)
    v_mov_b32 v170, 0xf149f2ca
    v_mov_b32 v171, 0xf149f2ca
    v_mfma_f32_16x16x32_bf16 v[216:219], a[16:19], a[240:243], v[216:219]
    s_waitcnt lgkmcnt(0)
    v_mfma_f32_16x16x32_bf16 v[212:215], a[20:23], a[240:243], v[212:215]
    buffer_load_dwordx4 v247, s[4:7], s56 offen lds
    v_mfma_f32_16x16x32_bf16 v[208:211], a[12:15], a[228:231], v[208:211]
    s_add_u32 s56, s39, 0xd2000
    ds_read_b128 a[240:243], v224 offset:3328
    s_add_u32 m0, s41, 0x9740
    v_mfma_f32_16x16x32_bf16 v[204:207], a[16:19], a[228:231], v[204:207]
    v_mfma_f32_16x16x32_bf16 v[200:203], a[20:23], a[228:231], v[200:203]
    s_waitcnt vmcnt(11)
    ds_read_b128 a[228:231], v224 offset:15744
    buffer_load_dwordx4 v246, s[4:7], s56 offen lds
    s_add_u32 m0, s42, 0x9740
    ds_read_b64_tr_b16 a[24:25], v254 offset:24576
    ds_read_b64_tr_b16 a[26:27], v255 offset:24576
    ds_read_b64_tr_b16 a[28:29], v254 offset:24608
    ds_read_b64_tr_b16 a[30:31], v255 offset:24608
    ds_read_b64_tr_b16 a[32:33], v254 offset:24640
    ds_read_b64_tr_b16 a[34:35], v255 offset:24640
    v_lshlrev_b32 v196, 16, v196
    v_mul_f32 v196, s28, v196
    ds_write_b32 v125, v196
    v_lshlrev_b32 v197, 16, v197
    v_mul_f32 v197, s28, v197
    ds_write_b32 v125, v197 offset:256
    v_lshlrev_b32 v198, 16, v198
    buffer_load_dwordx4 v247, s[4:7], s56 offen lds
    s_add_u32 s56, s39, 0xfc000
    s_add_u32 m0, s41, 0xb580
    v_mul_f32 v198, s28, v198
    ds_write_b32 v125, v198 offset:512
    ds_read2_b32 v[144:145], v121 offset0:39 offset1:40
    ds_read2_b32 v[146:147], v121 offset0:41 offset1:42
    s_waitcnt lgkmcnt(9)
    v_mfma_f32_16x16x32_bf16 v[220:223], a[24:27], a[244:247], v[220:223]
    s_waitcnt lgkmcnt(7)
    ds_read2_b32 v[148:149], v121 offset0:65 offset1:66
    ds_read2_b32 v[150:151], v121 offset0:67 offset1:68
    v_mfma_f32_16x16x32_bf16 v[216:219], a[28:31], a[244:247], v[216:219]
    s_waitcnt lgkmcnt(7)
    ds_read2_b32 v[152:153], v121 offset0:91 offset1:92
    ds_read2_b32 v[154:155], v121 offset0:93 offset1:94
    v_mfma_f32_16x16x32_bf16 v[212:215], a[32:35], a[244:247], v[212:215]
    buffer_load_dwordx4 v246, s[4:7], s56 offen lds
    v_mfma_f32_16x16x32_bf16 v[208:211], a[24:27], a[232:235], v[208:211]
    s_add_u32 m0, s42, 0xb580
    ds_read_b128 a[244:247], v224 offset:3392
    ds_read2_b32 v[156:157], v121 offset0:117 offset1:118
    v_mfma_f32_16x16x32_bf16 v[204:207], a[28:31], a[232:235], v[204:207]
    ds_read2_b32 v[158:159], v121 offset0:119 offset1:120
    ds_read2_b32 v[160:161], v122 offset0:0 offset1:1
    v_mfma_f32_16x16x32_bf16 v[200:203], a[32:35], a[232:235], v[200:203]
    s_waitcnt vmcnt(11) lgkmcnt(4)
    ds_read_b128 a[232:235], v224 offset:15808
    ds_read2_b32 v[162:163], v122 offset0:2 offset1:3
    ds_read2_b32 v[164:165], v122 offset0:13 offset1:14
    ds_read2_b32 v[166:167], v122 offset0:15 offset1:16
    v_cndmask_b32 v144, v168, v144, s[24:25]
    v_cndmask_b32 v145, v168, v145, s[26:27]
    v_cndmask_b32 v146, v168, v146, s[52:53]
    buffer_load_dwordx4 v247, s[4:7], s56 offen lds
    s_add_u32 s56, s39, 0x126000
    s_add_u32 m0, s41, 0xd3c0
    v_cndmask_b32 v147, v168, v147, s[54:55]
    ds_write_b128 v123, v[144:147] offset:320
    v_cndmask_b32 v148, v168, v148, s[24:25]
    ds_read_b64_tr_b16 a[36:37], v254 offset:36864
    ds_read_b64_tr_b16 a[38:39], v255 offset:36864
    ds_read_b64_tr_b16 a[40:41], v254 offset:36896
    ds_read_b64_tr_b16 a[42:43], v255 offset:36896
    ds_read_b64_tr_b16 a[44:45], v254 offset:36928
    buffer_load_dwordx4 v246, s[4:7], s56 offen lds
    s_add_u32 m0, s42, 0xd3c0
    ds_read_b64_tr_b16 a[46:47], v255 offset:36928
    v_cndmask_b32 v149, v168, v149, s[26:27]
    v_cndmask_b32 v150, v168, v150, s[52:53]
    v_cndmask_b32 v151, v168, v151, s[54:55]
    ds_write_b128 v123, v[148:151] offset:960
    v_cndmask_b32 v152, v168, v152, s[24:25]
    v_cndmask_b32 v153, v168, v153, s[26:27]
    v_cndmask_b32 v154, v168, v154, s[52:53]
    v_cndmask_b32 v155, v168, v155, s[54:55]
    ds_write_b128 v123, v[152:155] offset:1600
    buffer_load_dwordx4 v247, s[4:7], s56 offen lds
    s_waitcnt lgkmcnt(6)
    v_mfma_f32_16x16x32_bf16 v[220:223], a[36:39], a[248:251], v[220:223]
    s_add_u32 m0, s50, 0
    v_cndmask_b32 v156, v168, v156, s[24:25]
    v_cndmask_b32 v157, v168, v157, s[26:27]
    s_waitcnt lgkmcnt(4)
    v_mfma_f32_16x16x32_bf16 v[216:219], a[40:43], a[248:251], v[216:219]
    s_add_u32 s56, s39, 0x150000
    v_cndmask_b32 v158, v168, v158, s[52:53]
    v_cndmask_b32 v159, v168, v159, s[54:55]
    s_waitcnt lgkmcnt(2)
    v_mfma_f32_16x16x32_bf16 v[212:215], a[44:47], a[248:251], v[212:215]
    ds_read_b128 a[248:251], v224 offset:15488
    v_cndmask_b32 v160, v168, v160, s[24:25]
    v_mfma_f32_16x16x32_bf16 v[208:211], a[36:39], a[236:239], v[208:211]
    ds_write_b128 v123, v[156:159] offset:2240
    v_mfma_f32_16x16x32_bf16 v[204:207], a[40:43], a[236:239], v[204:207]
    s_waitcnt vmcnt(11)
    buffer_load_dwordx4 v251, s[8:11], s57 offen lds
    v_mfma_f32_16x16x32_bf16 v[200:203], a[44:47], a[236:239], v[200:203]
    s_add_u32 m0, s50, 0x400
    ds_read_b128 a[236:239], v224 offset:18560
    v_cndmask_b32 v161, v168, v161, s[26:27]
    v_cndmask_b32 v162, v168, v162, s[52:53]
    v_cndmask_b32 v163, v168, v163, s[54:55]
    ds_write_b128 v123, v[160:163] offset:2880
    ds_read_b64_tr_b16 a[48:49], v254 offset:49152
    ds_read_b64_tr_b16 a[50:51], v255 offset:49152
    ds_read_b64_tr_b16 a[52:53], v254 offset:49184
    ds_read_b64_tr_b16 a[54:55], v255 offset:49184
    ds_read_b64_tr_b16 a[56:57], v254 offset:49216
    ds_read_b64_tr_b16 a[58:59], v255 offset:49216
    buffer_load_dwordx4 v252, s[8:11], s57 offen lds
    s_add_u32 m0, s50, 0x800
    v_cndmask_b32 v164, v168, v164, s[24:25]
    v_cndmask_b32 v165, v168, v165, s[26:27]
    v_cndmask_b32 v166, v168, v166, s[52:53]
    v_cndmask_b32 v167, v168, v167, s[54:55]
    ds_write_b128 v123, v[164:167] offset:3200
    ds_write_b128 v124, v[168:171]
    buffer_load_dwordx4 v253, s[8:11], s57 offen lds
    s_add_u32 s57, s49, 0x9300
    s_add_u32 m0, s50, 0x3000
    ds_read_b128 v[144:147], v235
    v_bfe_u32 v235, s62, v232, 4
    ds_read_b128 v[148:151], v234
    v_mad_u32_u24 v234, v250, s40, v229
    s_waitcnt lgkmcnt(8)
    v_mfma_f32_16x16x32_bf16 v[220:223], a[48:51], a[252:255], v[220:223]
    s_waitcnt lgkmcnt(6)
    v_mad_u32_u24 v250, v250, s40, v228
    v_mfma_f32_16x16x32_bf16 v[216:219], a[52:55], a[252:255], v[216:219]
    s_waitcnt lgkmcnt(4)
    ds_read_b128 v[152:155], v234
    v_bfe_u32 v234, s60, v232, 4
    v_mfma_f32_16x16x32_bf16 v[212:215], a[56:59], a[252:255], v[212:215]
    v_mad_u32_u24 v234, v234, s40, v230
    v_mfma_f32_16x16x32_bf16 v[208:211], a[48:51], a[240:243], v[208:211]
    ds_read_b128 a[252:255], v224 offset:15552
    v_mfma_f32_16x16x32_bf16 v[204:207], a[52:55], a[240:243], v[204:207]
    s_waitcnt vmcnt(11)
    buffer_load_dwordx4 v251, s[8:11], s57 offen lds
    v_mfma_f32_16x16x32_bf16 v[200:203], a[56:59], a[240:243], v[200:203]
    s_add_u32 m0, s50, 0x3400
    ds_read_b128 a[240:243], v224 offset:18624
    ds_read_b128 v[156:159], v250
    v_mad_u32_u24 v250, v235, s40, v229
    v_mad_u32_u24 v235, v235, s40, v228
    ds_read_b64_tr_b16 a[60:61], v254 offset:61440
    ds_read_b64_tr_b16 a[62:63], v255 offset:61440
    ds_read_b64_tr_b16 a[64:65], v254 offset:61472
    ds_read_b64_tr_b16 a[66:67], v255 offset:61472
    buffer_load_dwordx4 v252, s[8:11], s57 offen lds
    ds_read_b64_tr_b16 a[68:69], v254 offset:61504
    ds_read_b64_tr_b16 a[70:71], v255 offset:61504
    s_add_u32 m0, s50, 0x3800
    ds_read_b128 v[160:163], v228 offset:1920
    ds_read_b128 v[164:167], v229 offset:1920
    buffer_load_dwordx4 v253, s[8:11], s57 offen lds
    s_add_u32 s57, s49, 0x12300
    s_add_u32 m0, s50, 0x6000
    ds_read_b128 v[168:171], v250
    v_bfe_u32 v250, s62, v232, 4
    v_mad_u32_u24 v250, v250, s40, v230
    ds_read_b128 v[172:175], v235
    v_bfe_u32 v235, s61, v232, 4
    v_mad_u32_u24 v235, v235, s40, v230
    s_waitcnt lgkmcnt(8)
    v_mfma_f32_16x16x32_bf16 v[220:223], a[60:63], a[220:223], v[220:223]
    s_waitcnt lgkmcnt(6)
    v_mfma_f32_16x16x32_bf16 v[216:219], a[64:67], a[220:223], v[216:219]
    s_waitcnt lgkmcnt(4)
    v_mfma_f32_16x16x32_bf16 v[212:215], a[68:71], a[220:223], v[212:215]
    ds_read_b128 a[220:223], v224 offset:15616
    v_mfma_f32_16x16x32_bf16 v[208:211], a[60:63], a[244:247], v[208:211]
    buffer_load_dwordx4 v251, s[8:11], s57 offen lds
    v_mfma_f32_16x16x32_bf16 v[204:207], a[64:67], a[244:247], v[204:207]
    s_add_u32 m0, s50, 0x6400
    v_mfma_f32_16x16x32_bf16 v[200:203], a[68:71], a[244:247], v[200:203]
    v_cvt_pk_bf16_f32 v0, v220, v221
    v_cvt_pk_bf16_f32 v1, v222, v223
    v_mfma_f32_16x16x32_bf16 v[220:223], a[0:3], a[248:251], 0
    v_cvt_pk_bf16_f32 v2, v216, v217
    v_cvt_pk_bf16_f32 v3, v218, v219
    v_mfma_f32_16x16x32_bf16 v[216:219], a[4:7], a[248:251], 0
    v_cvt_pk_bf16_f32 v4, v212, v213
    v_cvt_pk_bf16_f32 v5, v214, v215
    v_mfma_f32_16x16x32_bf16 v[212:215], a[8:11], a[248:251], 0
    v_cvt_pk_bf16_f32 v24, v208, v209
    v_cvt_pk_bf16_f32 v25, v210, v211
    v_mfma_f32_16x16x32_bf16 v[220:223], a[12:15], a[252:255], v[220:223]
    v_cvt_pk_bf16_f32 v26, v204, v205
    v_cvt_pk_bf16_f32 v27, v206, v207
    v_mfma_f32_16x16x32_bf16 v[216:219], a[16:19], a[252:255], v[216:219]
    v_cvt_pk_bf16_f32 v28, v200, v201
    v_cvt_pk_bf16_f32 v29, v202, v203
    v_mfma_f32_16x16x32_bf16 v[212:215], a[20:23], a[252:255], v[212:215]
    s_waitcnt vmcnt(11) lgkmcnt(0)
    ds_read_b128 a[244:247], v224 offset:18688
    ds_read_b128 a[248:251], v224 offset:18752
    v_mfma_f32_16x16x32_bf16 v[220:223], a[24:27], a[220:223], v[220:223]
    s_barrier
    ds_read_b128 a[252:255], v224 offset:18816
    v_mfma_f32_16x16x32_bf16 v[216:219], a[28:31], a[220:223], v[216:219]
    buffer_load_dwordx4 v252, s[8:11], s57 offen lds
    v_mfma_f32_16x16x32_bf16 v[212:215], a[32:35], a[220:223], v[212:215]
    s_add_u32 m0, s50, 0x6800
    ds_read_b128 a[220:223], v224 offset:18880
    v_mfma_f32_16x16x32_bf16 v[220:223], a[36:39], a[224:227], v[220:223]
    buffer_load_dwordx4 v253, s[8:11], s57 offen lds
    v_mfma_f32_16x16x32_bf16 v[216:219], a[40:43], a[224:227], v[216:219]
    s_add_u32 s57, s49, 0x1b300
    s_add_u32 m0, s50, 0x9000
    v_mfma_f32_16x16x32_bf16 v[212:215], a[44:47], a[224:227], v[212:215]
    ds_read_b128 a[224:227], v227 offset:6144
    v_mfma_f32_16x16x32_bf16 v[220:223], a[48:51], a[228:231], v[220:223]
    v_mfma_f32_16x16x32_bf16 v[216:219], a[52:55], a[228:231], v[216:219]
    buffer_load_dwordx4 v251, s[8:11], s57 offen lds
    v_mfma_f32_16x16x32_bf16 v[212:215], a[56:59], a[228:231], v[212:215]
    s_add_u32 m0, s50, 0x9400
    ds_read_b128 a[228:231], v227 offset:6208
    v_mfma_f32_16x16x32_bf16 v[220:223], a[60:63], a[232:235], v[220:223]
    v_mfma_f32_16x16x32_bf16 v[216:219], a[64:67], a[232:235], v[216:219]
    v_mfma_f32_16x16x32_bf16 v[212:215], a[68:71], a[232:235], v[212:215]
    ds_read_b128 a[232:235], v227 offset:6272
    v_mfma_f32_16x16x32_bf16 v[208:211], a[0:3], a[236:239], 0
    buffer_load_dwordx4 v252, s[8:11], s57 offen lds
    v_mfma_f32_16x16x32_bf16 v[204:207], a[4:7], a[236:239], 0
    s_add_u32 m0, s50, 0x9800
    v_mfma_f32_16x16x32_bf16 v[200:203], a[8:11], a[236:239], 0
    v_cvt_pk_bf16_f32 v6, v220, v221
    v_cvt_pk_bf16_f32 v7, v222, v223
    v_mfma_f32_16x16x32_bf16 v[208:211], a[12:15], a[240:243], v[208:211]
    v_cvt_pk_bf16_f32 v8, v216, v217
    v_cvt_pk_bf16_f32 v9, v218, v219
    v_mfma_f32_16x16x32_bf16 v[204:207], a[16:19], a[240:243], v[204:207]
    v_cvt_pk_bf16_f32 v10, v212, v213
    v_cvt_pk_bf16_f32 v11, v214, v215
    v_mfma_f32_16x16x32_bf16 v[200:203], a[20:23], a[240:243], v[200:203]
    s_waitcnt lgkmcnt(2)
    ds_read_b128 a[236:239], v227 offset:6336
    ds_read_b128 a[240:243], v227 offset:6400
    v_mfma_f32_16x16x32_bf16 v[208:211], a[24:27], a[244:247], v[208:211]
    buffer_load_dwordx4 v253, s[8:11], s57 offen lds
    v_mfma_f32_16x16x32_bf16 v[204:207], a[28:31], a[244:247], v[204:207]
    s_add_u32 s57, s49, 0x24300
    s_add_u32 m0, s50, 0xc000
    v_mfma_f32_16x16x32_bf16 v[200:203], a[32:35], a[244:247], v[200:203]
    ds_read_b128 a[244:247], v227 offset:6464
    v_mfma_f32_16x16x32_bf16 v[208:211], a[36:39], a[248:251], v[208:211]
    s_waitcnt vmcnt(12)
    v_mfma_f32_16x16x32_bf16 v[204:207], a[40:43], a[248:251], v[204:207]
    s_barrier
    v_mfma_f32_16x16x32_bf16 v[200:203], a[44:47], a[248:251], v[200:203]
    ds_read_b128 a[248:251], v224 offset:30976
    v_mfma_f32_16x16x32_bf16 v[208:211], a[48:51], a[252:255], v[208:211]
    buffer_load_dwordx4 v251, s[8:11], s57 offen lds
    v_mfma_f32_16x16x32_bf16 v[204:207], a[52:55], a[252:255], v[204:207]
    s_add_u32 m0, s50, 0xc400
    v_mfma_f32_16x16x32_bf16 v[200:203], a[56:59], a[252:255], v[200:203]
    ds_read_b128 a[252:255], v224 offset:31040
    v_mfma_f32_16x16x32_bf16 v[208:211], a[60:63], a[220:223], v[208:211]
    v_mfma_f32_16x16x32_bf16 v[204:207], a[64:67], a[220:223], v[204:207]
    v_mfma_f32_16x16x32_bf16 v[200:203], a[68:71], a[220:223], v[200:203]
    ds_read_b128 a[220:223], v224 offset:31104
    v_mfma_f32_16x16x32_bf16 v[220:223], a[0:3], a[224:227], 0
    buffer_load_dwordx4 v252, s[8:11], s57 offen lds
    v_mfma_f32_16x16x32_bf16 v[216:219], a[4:7], a[224:227], 0
    s_add_u32 m0, s50, 0xc800
    v_mfma_f32_16x16x32_bf16 v[212:215], a[8:11], a[224:227], 0
    s_waitcnt lgkmcnt(3)
    v_cvt_pk_bf16_f32 v30, v208, v209
    v_cvt_pk_bf16_f32 v31, v210, v211
    v_mfma_f32_16x16x32_bf16 v[220:223], a[12:15], a[228:231], v[220:223]
    v_cvt_pk_bf16_f32 v32, v204, v205
    v_cvt_pk_bf16_f32 v33, v206, v207
    v_mfma_f32_16x16x32_bf16 v[216:219], a[16:19], a[228:231], v[216:219]
    v_cvt_pk_bf16_f32 v34, v200, v201
    v_cvt_pk_bf16_f32 v35, v202, v203
    v_mfma_f32_16x16x32_bf16 v[212:215], a[20:23], a[228:231], v[212:215]
    ds_read_b128 a[224:227], v224 offset:31168
    ds_read_b128 a[228:231], v224 offset:31232
    v_mfma_f32_16x16x32_bf16 v[220:223], a[24:27], a[232:235], v[220:223]
    buffer_load_dwordx4 v253, s[8:11], s57 offen lds
    v_mfma_f32_16x16x32_bf16 v[216:219], a[28:31], a[232:235], v[216:219]
    s_add_u32 s57, s49, 0x2d300
    s_add_u32 m0, s50, 0xf000
    v_mfma_f32_16x16x32_bf16 v[212:215], a[32:35], a[232:235], v[212:215]
    s_waitcnt vmcnt(12)
    ds_read_b128 a[232:235], v224 offset:31296
    ds_read_b64_tr_b16 a[72:73], v254
    v_mfma_f32_16x16x32_bf16 v[220:223], a[36:39], a[236:239], v[220:223]
    ds_read_b64_tr_b16 a[74:75], v255
    ds_read_b64_tr_b16 a[76:77], v254 offset:32
    v_mfma_f32_16x16x32_bf16 v[216:219], a[40:43], a[236:239], v[216:219]
    buffer_load_dwordx4 v251, s[8:11], s57 offen lds
    v_mfma_f32_16x16x32_bf16 v[212:215], a[44:47], a[236:239], v[212:215]
    s_add_u32 m0, s50, 0xf400
    ds_read_b128 a[236:239], v224 offset:34048
    ds_read_b64_tr_b16 a[78:79], v255 offset:32
    v_mfma_f32_16x16x32_bf16 v[220:223], a[48:51], a[240:243], v[220:223]
    ds_read_b64_tr_b16 a[80:81], v254 offset:64
    ds_read_b64_tr_b16 a[82:83], v255 offset:64
    v_mfma_f32_16x16x32_bf16 v[216:219], a[52:55], a[240:243], v[216:219]
    v_mfma_f32_16x16x32_bf16 v[212:215], a[56:59], a[240:243], v[212:215]
    ds_read_b128 a[240:243], v224 offset:34112
    v_mfma_f32_16x16x32_bf16 v[220:223], a[60:63], a[244:247], v[220:223]
    buffer_load_dwordx4 v252, s[8:11], s57 offen lds
    v_mfma_f32_16x16x32_bf16 v[216:219], a[64:67], a[244:247], v[216:219]
    s_add_u32 m0, s50, 0xf800
    v_mfma_f32_16x16x32_bf16 v[212:215], a[68:71], a[244:247], v[212:215]
    s_waitcnt lgkmcnt(9)
    ds_read_b128 a[244:247], v224 offset:34176
    v_mfma_f32_16x16x32_bf16 v[208:211], a[0:3], a[248:251], 0
    v_mfma_f32_16x16x32_bf16 v[204:207], a[4:7], a[248:251], 0
    v_mfma_f32_16x16x32_bf16 v[200:203], a[8:11], a[248:251], 0
    v_cvt_pk_bf16_f32 v48, v220, v221
    v_cvt_pk_bf16_f32 v49, v222, v223
    v_mfma_f32_16x16x32_bf16 v[208:211], a[12:15], a[252:255], v[208:211]
    v_cvt_pk_bf16_f32 v50, v216, v217
    v_cvt_pk_bf16_f32 v51, v218, v219
    v_mfma_f32_16x16x32_bf16 v[204:207], a[16:19], a[252:255], v[204:207]
    v_cvt_pk_bf16_f32 v52, v212, v213
    v_cvt_pk_bf16_f32 v53, v214, v215
    v_mfma_f32_16x16x32_bf16 v[200:203], a[20:23], a[252:255], v[200:203]
    ds_read_b128 a[248:251], v224 offset:34240
    ds_read_b128 a[252:255], v224 offset:34304
    v_mfma_f32_16x16x32_bf16 v[208:211], a[24:27], a[220:223], v[208:211]
    s_waitcnt vmcnt(11)
    buffer_load_dwordx4 v253, s[8:11], s57 offen lds
    v_mfma_f32_16x16x32_bf16 v[204:207], a[28:31], a[220:223], v[204:207]
    s_add_u32 s57, s49, 0
    ds_read_b64_tr_b16 a[84:85], v254 offset:12288
    ds_read_b64_tr_b16 a[86:87], v255 offset:12288
    v_mfma_f32_16x16x32_bf16 v[200:203], a[32:35], a[220:223], v[200:203]
    s_add_u32 m0, s50, 0
    ds_read_b128 a[220:223], v224 offset:34368
    ds_read_b64_tr_b16 a[88:89], v254 offset:12320
    v_mfma_f32_16x16x32_bf16 v[208:211], a[36:39], a[224:227], v[208:211]
    s_waitcnt lgkmcnt(6)
    buffer_load_dwordx4 v251, s[8:11], s57 offen lds
    v_mfma_f32_16x16x32_bf16 v[204:207], a[40:43], a[224:227], v[204:207]
    s_add_u32 m0, s50, 0x400
    ds_read_b64_tr_b16 a[90:91], v255 offset:12320
    ds_read_b64_tr_b16 a[92:93], v254 offset:12352
    v_mfma_f32_16x16x32_bf16 v[200:203], a[44:47], a[224:227], v[200:203]
    ds_read_b128 a[224:227], v224 offset:46464
    ds_read_b64_tr_b16 a[94:95], v255 offset:12352
    v_mfma_f32_16x16x32_bf16 v[208:211], a[48:51], a[228:231], v[208:211]
    v_mfma_f32_16x16x32_bf16 v[204:207], a[52:55], a[228:231], v[204:207]
    v_mfma_f32_16x16x32_bf16 v[200:203], a[56:59], a[228:231], v[200:203]
    ds_read_b128 a[228:231], v224 offset:46528
    v_mfma_f32_16x16x32_bf16 v[208:211], a[60:63], a[232:235], v[208:211]
    buffer_load_dwordx4 v252, s[8:11], s57 offen lds
    v_mfma_f32_16x16x32_bf16 v[204:207], a[64:67], a[232:235], v[204:207]
    s_add_u32 m0, s50, 0x800
    v_mfma_f32_16x16x32_bf16 v[200:203], a[68:71], a[232:235], v[200:203]
    ds_read_b128 a[232:235], v224 offset:46592
    v_mfma_f32_16x16x32_bf16 v[220:223], a[0:3], a[236:239], 0
    v_mfma_f32_16x16x32_bf16 v[216:219], a[4:7], a[236:239], 0
    buffer_load_dwordx4 v253, s[8:11], s57 offen lds
    v_mfma_f32_16x16x32_bf16 v[212:215], a[8:11], a[236:239], 0
    s_add_u32 s57, s49, 0x9000
    v_cvt_pk_bf16_f32 v12, v208, v209
    v_cvt_pk_bf16_f32 v13, v210, v211
    v_mfma_f32_16x16x32_bf16 v[220:223], a[12:15], a[240:243], v[220:223]
    s_add_u32 m0, s50, 0x3000
    v_cvt_pk_bf16_f32 v14, v204, v205
    v_cvt_pk_bf16_f32 v15, v206, v207
    v_mfma_f32_16x16x32_bf16 v[216:219], a[16:19], a[240:243], v[216:219]
    v_cvt_pk_bf16_f32 v16, v200, v201
    v_cvt_pk_bf16_f32 v17, v202, v203
    v_mfma_f32_16x16x32_bf16 v[212:215], a[20:23], a[240:243], v[212:215]
    ds_read_b128 a[236:239], v224 offset:46656
    ds_read_b128 a[240:243], v224 offset:46720
    v_mfma_f32_16x16x32_bf16 v[220:223], a[24:27], a[244:247], v[220:223]
    s_waitcnt vmcnt(12)
    ds_read_b64_tr_b16 a[96:97], v254 offset:24576
    ds_read_b64_tr_b16 a[98:99], v255 offset:24576
    v_mfma_f32_16x16x32_bf16 v[216:219], a[28:31], a[244:247], v[216:219]
    s_waitcnt lgkmcnt(5)
    buffer_load_dwordx4 v251, s[8:11], s57 offen lds
    v_mfma_f32_16x16x32_bf16 v[212:215], a[32:35], a[244:247], v[212:215]
    s_add_u32 m0, s50, 0x3400
    ds_read_b128 a[244:247], v224 offset:46784
    ds_read_b64_tr_b16 a[100:101], v254 offset:24608
    v_mfma_f32_16x16x32_bf16 v[220:223], a[36:39], a[248:251], v[220:223]
    ds_read_b64_tr_b16 a[102:103], v255 offset:24608
    ds_read_b64_tr_b16 a[104:105], v254 offset:24640
    v_mfma_f32_16x16x32_bf16 v[216:219], a[40:43], a[248:251], v[216:219]
    ds_read_b64_tr_b16 a[106:107], v255 offset:24640
    v_mfma_f32_16x16x32_bf16 v[212:215], a[44:47], a[248:251], v[212:215]
    ds_read_b128 a[248:251], v224 offset:49536
    v_mfma_f32_16x16x32_bf16 v[220:223], a[48:51], a[252:255], v[220:223]
    buffer_load_dwordx4 v252, s[8:11], s57 offen lds
    v_mfma_f32_16x16x32_bf16 v[216:219], a[52:55], a[252:255], v[216:219]
    s_add_u32 m0, s50, 0x3800
    v_mfma_f32_16x16x32_bf16 v[212:215], a[56:59], a[252:255], v[212:215]
    ds_read_b128 a[252:255], v224 offset:49600
    v_mfma_f32_16x16x32_bf16 v[220:223], a[60:63], a[220:223], v[220:223]
    v_mfma_f32_16x16x32_bf16 v[216:219], a[64:67], a[220:223], v[216:219]
    v_mfma_f32_16x16x32_bf16 v[212:215], a[68:71], a[220:223], v[212:215]
    ds_read_b128 a[220:223], v224 offset:49664
    v_mfma_f32_16x16x32_bf16 v[208:211], a[0:3], a[224:227], 0
    buffer_load_dwordx4 v253, s[8:11], s57 offen lds
    v_mfma_f32_16x16x32_bf16 v[204:207], a[4:7], a[224:227], 0
    s_add_u32 s57, s49, 0x12000
    s_add_u32 m0, s50, 0x6000
    v_cvt_pk_bf16_f32 v36, v220, v221
    v_mfma_f32_16x16x32_bf16 v[200:203], a[8:11], a[224:227], 0
    v_cvt_pk_bf16_f32 v37, v222, v223
    v_cvt_pk_bf16_f32 v38, v216, v217
    v_mfma_f32_16x16x32_bf16 v[208:211], a[12:15], a[228:231], v[208:211]
    v_cvt_pk_bf16_f32 v39, v218, v219
    v_cvt_pk_bf16_f32 v40, v212, v213
    v_mfma_f32_16x16x32_bf16 v[204:207], a[16:19], a[228:231], v[204:207]
    ds_read_b128 a[224:227], v224 offset:49728
    v_cvt_pk_bf16_f32 v41, v214, v215
    v_mfma_f32_16x16x32_bf16 v[200:203], a[20:23], a[228:231], v[200:203]
    s_waitcnt vmcnt(12) lgkmcnt(3)
    ds_read_b128 a[228:231], v224 offset:49792
    ds_read_b64_tr_b16 a[108:109], v254 offset:36864
    v_mfma_f32_16x16x32_bf16 v[208:211], a[24:27], a[232:235], v[208:211]
    buffer_load_dwordx4 v251, s[8:11], s57 offen lds
    v_mfma_f32_16x16x32_bf16 v[204:207], a[28:31], a[232:235], v[204:207]
    s_add_u32 m0, s50, 0x6400
    ds_read_b64_tr_b16 a[110:111], v255 offset:36864
    ds_read_b64_tr_b16 a[112:113], v254 offset:36896
    v_mfma_f32_16x16x32_bf16 v[200:203], a[32:35], a[232:235], v[200:203]
    ds_read_b128 a[232:235], v224 offset:49856
    ds_read_b64_tr_b16 a[114:115], v255 offset:36896
    v_mfma_f32_16x16x32_bf16 v[208:211], a[36:39], a[236:239], v[208:211]
    ds_read_b64_tr_b16 a[116:117], v254 offset:36928
    ds_read_b64_tr_b16 a[118:119], v255 offset:36928
    v_mfma_f32_16x16x32_bf16 v[204:207], a[40:43], a[236:239], v[204:207]
    v_mfma_f32_16x16x32_bf16 v[200:203], a[44:47], a[236:239], v[200:203]
    ds_read_b128 a[236:239], v227 offset:37120
    v_mfma_f32_16x16x32_bf16 v[208:211], a[48:51], a[240:243], v[208:211]
    buffer_load_dwordx4 v252, s[8:11], s57 offen lds
    v_mfma_f32_16x16x32_bf16 v[204:207], a[52:55], a[240:243], v[204:207]
    s_add_u32 m0, s50, 0x6800
    v_mfma_f32_16x16x32_bf16 v[200:203], a[56:59], a[240:243], v[200:203]
    ds_read_b128 a[240:243], v227 offset:37184
    v_mfma_f32_16x16x32_bf16 v[208:211], a[60:63], a[244:247], v[208:211]
    v_mfma_f32_16x16x32_bf16 v[204:207], a[64:67], a[244:247], v[204:207]
    buffer_load_dwordx4 v253, s[8:11], s57 offen lds
    v_mfma_f32_16x16x32_bf16 v[200:203], a[68:71], a[244:247], v[200:203]
    s_add_u32 s57, s49, 0x1b000
    ds_read_b128 a[244:247], v227 offset:37248
    s_add_u32 m0, s50, 0x9000
    v_mfma_f32_16x16x32_bf16 v[220:223], a[0:3], a[248:251], 0
    v_mfma_f32_16x16x32_bf16 v[216:219], a[4:7], a[248:251], 0
    v_cvt_pk_bf16_f32 v18, v208, v209
    v_cvt_pk_bf16_f32 v19, v210, v211
    v_mfma_f32_16x16x32_bf16 v[212:215], a[8:11], a[248:251], 0
    s_waitcnt lgkmcnt(3)
    v_cvt_pk_bf16_f32 v20, v204, v205
    v_cvt_pk_bf16_f32 v21, v206, v207
    v_mfma_f32_16x16x32_bf16 v[220:223], a[12:15], a[252:255], v[220:223]
    v_cvt_pk_bf16_f32 v22, v200, v201
    v_cvt_pk_bf16_f32 v23, v202, v203
    v_mfma_f32_16x16x32_bf16 v[216:219], a[16:19], a[252:255], v[216:219]
    s_waitcnt vmcnt(12)
    ds_read_b128 a[248:251], v227 offset:37312
    ds_read_b64_tr_b16 a[120:121], v254 offset:49152
    v_mfma_f32_16x16x32_bf16 v[212:215], a[20:23], a[252:255], v[212:215]
    ds_read_b128 a[252:255], v227 offset:37376
    ds_read_b64_tr_b16 a[122:123], v255 offset:49152
    v_mfma_f32_16x16x32_bf16 v[220:223], a[24:27], a[220:223], v[220:223]
    buffer_load_dwordx4 v251, s[8:11], s57 offen lds
    v_mfma_f32_16x16x32_bf16 v[216:219], a[28:31], a[220:223], v[216:219]
    s_add_u32 m0, s50, 0x9400
    ds_read_b64_tr_b16 a[124:125], v254 offset:49184
    ds_read_b64_tr_b16 a[126:127], v255 offset:49184
    v_mfma_f32_16x16x32_bf16 v[212:215], a[32:35], a[220:223], v[212:215]
    ds_read_b128 a[220:223], v227 offset:37440
    ds_read_b64_tr_b16 a[128:129], v254 offset:49216
    v_mfma_f32_16x16x32_bf16 v[220:223], a[36:39], a[224:227], v[220:223]
    buffer_load_dwordx4 v252, s[8:11], s57 offen lds
    v_mfma_f32_16x16x32_bf16 v[216:219], a[40:43], a[224:227], v[216:219]
    s_add_u32 m0, s50, 0x9800
    ds_read_b64_tr_b16 a[130:131], v255 offset:49216
    v_mfma_f32_16x16x32_bf16 v[212:215], a[44:47], a[224:227], v[212:215]
    ds_read_b128 a[224:227], v224
    v_mfma_f32_16x16x32_bf16 v[220:223], a[48:51], a[228:231], v[220:223]
    v_mfma_f32_16x16x32_bf16 v[216:219], a[52:55], a[228:231], v[216:219]
    v_mfma_f32_16x16x32_bf16 v[212:215], a[56:59], a[228:231], v[212:215]
    ds_read_b128 a[228:231], v224 offset:64
    v_mfma_f32_16x16x32_bf16 v[220:223], a[60:63], a[232:235], v[220:223]
    buffer_load_dwordx4 v253, s[8:11], s57 offen lds
    v_mfma_f32_16x16x32_bf16 v[216:219], a[64:67], a[232:235], v[216:219]
    s_add_u32 s57, s49, 0x24000
    s_add_u32 m0, s50, 0xc000
    v_mfma_f32_16x16x32_bf16 v[212:215], a[68:71], a[232:235], v[212:215]
    s_waitcnt lgkmcnt(5)
    ds_read_b128 a[232:235], v224 offset:128
    v_mfma_f32_16x16x32_bf16 v[208:211], a[0:3], a[236:239], 0
    v_mfma_f32_16x16x32_bf16 v[204:207], a[4:7], a[236:239], 0
    v_cvt_pk_bf16_f32 v42, v220, v221
    v_cvt_pk_bf16_f32 v43, v222, v223
    v_mfma_f32_16x16x32_bf16 v[200:203], a[8:11], a[236:239], 0
    v_cvt_pk_bf16_f32 v44, v216, v217
    v_cvt_pk_bf16_f32 v45, v218, v219
    v_mfma_f32_16x16x32_bf16 v[208:211], a[12:15], a[240:243], v[208:211]
    v_cvt_pk_bf16_f32 v46, v212, v213
    v_cvt_pk_bf16_f32 v47, v214, v215
    v_mfma_f32_16x16x32_bf16 v[204:207], a[16:19], a[240:243], v[204:207]
    s_waitcnt vmcnt(12)
    ds_read_b128 a[236:239], v224 offset:192
    ds_read_b64_tr_b16 a[132:133], v254 offset:61440
    v_mfma_f32_16x16x32_bf16 v[200:203], a[20:23], a[240:243], v[200:203]
    ds_read_b128 a[240:243], v224 offset:256
    ds_read_b64_tr_b16 a[134:135], v255 offset:61440
    v_mfma_f32_16x16x32_bf16 v[208:211], a[24:27], a[244:247], v[208:211]
    s_waitcnt lgkmcnt(5)
    buffer_load_dwordx4 v251, s[8:11], s57 offen lds
    v_mfma_f32_16x16x32_bf16 v[204:207], a[28:31], a[244:247], v[204:207]
    s_add_u32 m0, s50, 0xc400
    ds_read_b64_tr_b16 a[136:137], v254 offset:61472
    ds_read_b64_tr_b16 a[138:139], v255 offset:61472
    v_mfma_f32_16x16x32_bf16 v[200:203], a[32:35], a[244:247], v[200:203]
    ds_read_b128 a[244:247], v224 offset:320
    ds_read_b64_tr_b16 a[140:141], v254 offset:61504
    v_mfma_f32_16x16x32_bf16 v[208:211], a[36:39], a[248:251], v[208:211]
    buffer_load_dwordx4 v252, s[8:11], s57 offen lds
    v_mfma_f32_16x16x32_bf16 v[204:207], a[40:43], a[248:251], v[204:207]
    s_add_u32 m0, s50, 0xc800
    ds_read_b64_tr_b16 a[142:143], v255 offset:61504
    v_mfma_f32_16x16x32_bf16 v[200:203], a[44:47], a[248:251], v[200:203]
    ds_read_b128 a[248:251], v224 offset:3072
    v_mfma_f32_16x16x32_bf16 v[208:211], a[48:51], a[252:255], v[208:211]
    v_mfma_f32_16x16x32_bf16 v[204:207], a[52:55], a[252:255], v[204:207]
    buffer_load_dwordx4 v253, s[8:11], s57 offen lds
    v_mfma_f32_16x16x32_bf16 v[200:203], a[56:59], a[252:255], v[200:203]
    s_add_u32 s57, s49, 0x2d000
    ds_read_b128 a[252:255], v224 offset:3136
    s_add_u32 m0, s50, 0xf000
    v_mfma_f32_16x16x32_bf16 v[208:211], a[60:63], a[220:223], v[208:211]
    v_mfma_f32_16x16x32_bf16 v[204:207], a[64:67], a[220:223], v[204:207]
    v_mfma_f32_16x16x32_bf16 v[200:203], a[68:71], a[220:223], v[200:203]
    s_waitcnt vmcnt(12)
    ds_read_b128 a[220:223], v224 offset:3200
    ds_read_b64_tr_b16 a[144:145], v254
    v_mfma_f32_16x16x32_bf16 v[220:223], a[224:227], a[72:75], 0
    ds_read_b64_tr_b16 a[146:147], v255
    ds_read_b64_tr_b16 a[148:149], v254 offset:32
    v_mfma_f32_16x16x32_bf16 v[216:219], a[224:227], a[76:79], 0
    v_cvt_pk_bf16_f32 v54, v208, v209
    v_cvt_pk_bf16_f32 v55, v210, v211
    v_mfma_f32_16x16x32_bf16 v[212:215], a[224:227], a[80:83], 0
    v_cvt_pk_bf16_f32 v56, v204, v205
    v_cvt_pk_bf16_f32 v57, v206, v207
    v_mfma_f32_16x16x32_bf16 v[220:223], a[228:231], a[84:87], v[220:223]
    v_cvt_pk_bf16_f32 v58, v200, v201
    v_cvt_pk_bf16_f32 v59, v202, v203
    v_mfma_f32_16x16x32_bf16 v[216:219], a[228:231], a[88:91], v[216:219]
    ds_read_b128 a[224:227], v224 offset:3264
    ds_read_b64_tr_b16 a[150:151], v255 offset:32
    v_mfma_f32_16x16x32_bf16 v[212:215], a[228:231], a[92:95], v[212:215]
    s_waitcnt lgkmcnt(7)
    ds_read_b128 a[228:231], v224 offset:3328
    ds_read_b64_tr_b16 a[152:153], v254 offset:64
    v_mfma_f32_16x16x32_bf16 v[220:223], a[232:235], a[96:99], v[220:223]
    buffer_load_dwordx4 v251, s[8:11], s57 offen lds
    v_mfma_f32_16x16x32_bf16 v[216:219], a[232:235], a[100:103], v[216:219]
    s_add_u32 m0, s50, 0xf400
    ds_read_b64_tr_b16 a[154:155], v255 offset:64
    v_mfma_f32_16x16x32_bf16 v[212:215], a[232:235], a[104:107], v[212:215]
    ds_read_b128 a[232:235], v224 offset:3392
    v_mfma_f32_16x16x32_bf16 v[220:223], a[236:239], a[108:111], v[220:223]
    buffer_load_dwordx4 v252, s[8:11], s57 offen lds
    v_mfma_f32_16x16x32_bf16 v[216:219], a[236:239], a[112:115], v[216:219]
    s_add_u32 m0, s50, 0xf800
    v_mfma_f32_16x16x32_bf16 v[212:215], a[236:239], a[116:119], v[212:215]
    ds_read_b128 a[236:239], v224 offset:15488
    v_mfma_f32_16x16x32_bf16 v[220:223], a[240:243], a[120:123], v[220:223]
    buffer_load_dwordx4 v253, s[8:11], s57 offen lds
    v_mfma_f32_16x16x32_bf16 v[216:219], a[240:243], a[124:127], v[216:219]
    s_add_u32 s57, s49, 0
    s_add_u32 m0, s50, 0
    v_mfma_f32_16x16x32_bf16 v[212:215], a[240:243], a[128:131], v[212:215]
    ds_read_b128 a[240:243], v224 offset:15552
    v_mfma_f32_16x16x32_bf16 v[220:223], a[244:247], a[132:135], v[220:223]
    v_mfma_f32_16x16x32_bf16 v[216:219], a[244:247], a[136:139], v[216:219]
    s_waitcnt vmcnt(12)
    ds_read_b64_tr_b16 a[156:157], v254 offset:12288
    ds_read_b64_tr_b16 a[158:159], v255 offset:12288
    v_mfma_f32_16x16x32_bf16 v[212:215], a[244:247], a[140:143], v[212:215]
    ds_read_b128 a[244:247], v224 offset:15616
    ds_read_b64_tr_b16 a[160:161], v254 offset:12320
    v_mfma_f32_16x16x32_bf16 v[208:211], a[248:251], a[72:75], 0
    s_waitcnt lgkmcnt(6)
    buffer_load_dwordx4 v192, s[12:15], s57 offen lds
    v_mfma_f32_16x16x32_bf16 v[204:207], a[248:251], a[76:79], 0
    s_add_u32 m0, s50, 0x400
    v_cvt_pk_bf16_f32 v66, v220, v221
    v_cvt_pk_bf16_f32 v67, v222, v223
    v_mfma_f32_16x16x32_bf16 v[200:203], a[248:251], a[80:83], 0
    v_cvt_pk_bf16_f32 v88, v216, v217
    v_cvt_pk_bf16_f32 v89, v218, v219
    v_mfma_f32_16x16x32_bf16 v[208:211], a[252:255], a[84:87], v[208:211]
    v_cvt_pk_bf16_f32 v110, v212, v213
    v_cvt_pk_bf16_f32 v111, v214, v215
    v_mfma_f32_16x16x32_bf16 v[204:207], a[252:255], a[88:91], v[204:207]
    ds_read_b128 a[248:251], v224 offset:15680
    ds_read_b64_tr_b16 a[162:163], v255 offset:12320
    v_mfma_f32_16x16x32_bf16 v[200:203], a[252:255], a[92:95], v[200:203]
    ds_read_b128 a[252:255], v224 offset:15744
    ds_read_b64_tr_b16 a[164:165], v254 offset:12352
    v_mfma_f32_16x16x32_bf16 v[208:211], a[220:223], a[96:99], v[208:211]
    buffer_load_dwordx4 v193, s[12:15], s57 offen lds
    v_mfma_f32_16x16x32_bf16 v[204:207], a[220:223], a[100:103], v[204:207]
    s_add_u32 m0, s50, 0x800
    ds_read_b64_tr_b16 a[166:167], v255 offset:12352
    v_mfma_f32_16x16x32_bf16 v[200:203], a[220:223], a[104:107], v[200:203]
    ds_read_b128 a[220:223], v224 offset:15808
    v_mfma_f32_16x16x32_bf16 v[208:211], a[224:227], a[108:111], v[208:211]
    v_mfma_f32_16x16x32_bf16 v[204:207], a[224:227], a[112:115], v[204:207]
    buffer_load_dwordx4 v194, s[12:15], s57 offen lds
    v_mfma_f32_16x16x32_bf16 v[200:203], a[224:227], a[116:119], v[200:203]
    s_add_u32 s57, s49, 0x3000
    ds_read_b128 a[224:227], v224 offset:18560
    s_add_u32 m0, s50, 0x3000
    v_mfma_f32_16x16x32_bf16 v[208:211], a[228:231], a[120:123], v[208:211]
    v_mfma_f32_16x16x32_bf16 v[204:207], a[228:231], a[124:127], v[204:207]
    v_mfma_f32_16x16x32_bf16 v[200:203], a[228:231], a[128:131], v[200:203]
    s_waitcnt vmcnt(12)
    ds_read_b128 a[228:231], v224 offset:18624
    ds_read_b64_tr_b16 a[168:169], v254 offset:24576
    v_mfma_f32_16x16x32_bf16 v[208:211], a[232:235], a[132:135], v[208:211]
    ds_read_b64_tr_b16 a[170:171], v255 offset:24576
    ds_read_b64_tr_b16 a[172:173], v254 offset:24608
    v_mfma_f32_16x16x32_bf16 v[204:207], a[232:235], a[136:139], v[204:207]
    s_waitcnt lgkmcnt(6)
    buffer_load_dwordx4 v192, s[12:15], s57 offen lds
    v_mfma_f32_16x16x32_bf16 v[200:203], a[232:235], a[140:143], v[200:203]
    s_add_u32 m0, s50, 0x3400
    ds_read_b128 a[232:235], v224 offset:18688
    ds_read_b64_tr_b16 a[174:175], v255 offset:24608
    v_mfma_f32_16x16x32_bf16 v[220:223], a[236:239], a[72:75], 0
    v_cvt_pk_bf16_f32 v68, v208, v209
    v_cvt_pk_bf16_f32 v69, v210, v211
    v_mfma_f32_16x16x32_bf16 v[216:219], a[236:239], a[76:79], 0
    v_cvt_pk_bf16_f32 v90, v204, v205
    v_cvt_pk_bf16_f32 v91, v206, v207
    v_mfma_f32_16x16x32_bf16 v[212:215], a[236:239], a[80:83], 0
    v_cvt_pk_bf16_f32 v112, v200, v201
    v_cvt_pk_bf16_f32 v113, v202, v203
    v_mfma_f32_16x16x32_bf16 v[220:223], a[240:243], a[84:87], v[220:223]
    ds_read_b128 a[236:239], v224 offset:18752
    ds_read_b64_tr_b16 a[176:177], v254 offset:24640
    v_mfma_f32_16x16x32_bf16 v[216:219], a[240:243], a[88:91], v[216:219]
    buffer_load_dwordx4 v193, s[12:15], s57 offen lds
    v_mfma_f32_16x16x32_bf16 v[212:215], a[240:243], a[92:95], v[212:215]
    s_add_u32 m0, s50, 0x3800
    ds_read_b128 a[240:243], v224 offset:18816
    ds_read_b64_tr_b16 a[178:179], v255 offset:24640
    v_mfma_f32_16x16x32_bf16 v[220:223], a[244:247], a[96:99], v[220:223]
    v_mfma_f32_16x16x32_bf16 v[216:219], a[244:247], a[100:103], v[216:219]
    v_mfma_f32_16x16x32_bf16 v[212:215], a[244:247], a[104:107], v[212:215]
    ds_read_b128 a[244:247], v224 offset:18880
    v_mfma_f32_16x16x32_bf16 v[220:223], a[248:251], a[108:111], v[220:223]
    buffer_load_dwordx4 v194, s[12:15], s57 offen lds
    v_mfma_f32_16x16x32_bf16 v[216:219], a[248:251], a[112:115], v[216:219]
    s_add_u32 s57, s49, 0x6000
    s_add_u32 m0, s50, 0x6000
    v_mfma_f32_16x16x32_bf16 v[212:215], a[248:251], a[116:119], v[212:215]
    ds_read_b128 a[248:251], v227 offset:6144
    v_mfma_f32_16x16x32_bf16 v[220:223], a[252:255], a[120:123], v[220:223]
    v_mfma_f32_16x16x32_bf16 v[216:219], a[252:255], a[124:127], v[216:219]
    s_waitcnt vmcnt(12)
    ds_read_b64_tr_b16 a[180:181], v254 offset:36864
    ds_read_b64_tr_b16 a[182:183], v255 offset:36864
    v_mfma_f32_16x16x32_bf16 v[212:215], a[252:255], a[128:131], v[212:215]
    s_waitcnt lgkmcnt(6)
    ds_read_b128 a[252:255], v227 offset:6208
    ds_read_b64_tr_b16 a[184:185], v254 offset:36896
    v_mfma_f32_16x16x32_bf16 v[220:223], a[220:223], a[132:135], v[220:223]
    s_waitcnt lgkmcnt(6)
    buffer_load_dwordx4 v192, s[12:15], s57 offen lds
    v_mfma_f32_16x16x32_bf16 v[216:219], a[220:223], a[136:139], v[216:219]
    s_add_u32 m0, s50, 0x6400
    ds_read_b64_tr_b16 a[186:187], v255 offset:36896
    ds_read_b64_tr_b16 a[188:189], v254 offset:36928
    v_mfma_f32_16x16x32_bf16 v[212:215], a[220:223], a[140:143], v[212:215]
    ds_read_b128 a[220:223], v227 offset:6272
    ds_read_b64_tr_b16 a[190:191], v255 offset:36928
    v_mfma_f32_16x16x32_bf16 v[208:211], a[224:227], a[72:75], 0
    v_cvt_pk_bf16_f32 v72, v220, v221
    v_cvt_pk_bf16_f32 v73, v222, v223
    v_mfma_f32_16x16x32_bf16 v[204:207], a[224:227], a[76:79], 0
    v_cvt_pk_bf16_f32 v94, v216, v217
    v_cvt_pk_bf16_f32 v95, v218, v219
    v_mfma_f32_16x16x32_bf16 v[200:203], a[224:227], a[80:83], 0
    v_cvt_pk_bf16_f32 v116, v212, v213
    v_cvt_pk_bf16_f32 v117, v214, v215
    v_mfma_f32_16x16x32_bf16 v[208:211], a[228:231], a[84:87], v[208:211]
    ds_read_b128 a[224:227], v227 offset:6336
    v_mfma_f32_16x16x32_bf16 v[204:207], a[228:231], a[88:91], v[204:207]
    buffer_load_dwordx4 v193, s[12:15], s57 offen lds
    v_mfma_f32_16x16x32_bf16 v[200:203], a[228:231], a[92:95], v[200:203]
    s_add_u32 m0, s50, 0x6800
    ds_read_b128 a[228:231], v227 offset:6400
    v_mfma_f32_16x16x32_bf16 v[208:211], a[232:235], a[96:99], v[208:211]
    v_mfma_f32_16x16x32_bf16 v[204:207], a[232:235], a[100:103], v[204:207]
    buffer_load_dwordx4 v194, s[12:15], s57 offen lds
    v_mfma_f32_16x16x32_bf16 v[200:203], a[232:235], a[104:107], v[200:203]
    s_add_u32 s57, s49, 0x9000
    ds_read_b128 a[232:235], v227 offset:6464
    s_add_u32 m0, s50, 0x9000
    v_mfma_f32_16x16x32_bf16 v[208:211], a[236:239], a[108:111], v[208:211]
    v_mfma_f32_16x16x32_bf16 v[204:207], a[236:239], a[112:115], v[204:207]
    v_mfma_f32_16x16x32_bf16 v[200:203], a[236:239], a[116:119], v[200:203]
    s_waitcnt vmcnt(12)
    ds_read_b128 a[236:239], v225 offset:24384
    ds_read_b64_tr_b16 a[192:193], v254 offset:49152
    v_mfma_f32_16x16x32_bf16 v[208:211], a[240:243], a[120:123], v[208:211]
    ds_read_b64_tr_b16 a[194:195], v255 offset:49152
    ds_read_b64_tr_b16 a[196:197], v254 offset:49184
    v_mfma_f32_16x16x32_bf16 v[204:207], a[240:243], a[124:127], v[204:207]
    s_waitcnt lgkmcnt(6)
    buffer_load_dwordx4 v192, s[12:15], s57 offen lds
    v_mfma_f32_16x16x32_bf16 v[200:203], a[240:243], a[128:131], v[200:203]
    s_add_u32 m0, s50, 0x9400
    ds_read_b128 a[240:243], v225 offset:24448
    ds_read_b64_tr_b16 a[198:199], v255 offset:49184
    v_mfma_f32_16x16x32_bf16 v[208:211], a[244:247], a[132:135], v[208:211]
    ds_read_b64_tr_b16 a[200:201], v254 offset:49216
    ds_read_b64_tr_b16 a[202:203], v255 offset:49216
    v_mfma_f32_16x16x32_bf16 v[204:207], a[244:247], a[136:139], v[204:207]
    v_mfma_f32_16x16x32_bf16 v[200:203], a[244:247], a[140:143], v[200:203]
    ds_read_b128 a[244:247], v225 offset:24512
    v_mfma_f32_16x16x32_bf16 v[220:223], a[248:251], a[72:75], 0
    buffer_load_dwordx4 v193, s[12:15], s57 offen lds
    v_mfma_f32_16x16x32_bf16 v[216:219], a[248:251], a[76:79], 0
    s_add_u32 m0, s50, 0x9800
    v_cvt_pk_bf16_f32 v70, v208, v209
    v_cvt_pk_bf16_f32 v71, v210, v211
    v_mfma_f32_16x16x32_bf16 v[212:215], a[248:251], a[80:83], 0
    v_cvt_pk_bf16_f32 v92, v204, v205
    v_cvt_pk_bf16_f32 v93, v206, v207
    v_mfma_f32_16x16x32_bf16 v[220:223], a[252:255], a[84:87], v[220:223]
    v_cvt_pk_bf16_f32 v114, v200, v201
    v_cvt_pk_bf16_f32 v115, v202, v203
    v_mfma_f32_16x16x32_bf16 v[216:219], a[252:255], a[88:91], v[216:219]
    ds_read_b128 a[248:251], v225 offset:24576
    v_mfma_f32_16x16x32_bf16 v[212:215], a[252:255], a[92:95], v[212:215]
    ds_read_b128 a[252:255], v225 offset:24640
    v_mfma_f32_16x16x32_bf16 v[220:223], a[220:223], a[96:99], v[220:223]
    buffer_load_dwordx4 v194, s[12:15], s57 offen lds
    v_mfma_f32_16x16x32_bf16 v[216:219], a[220:223], a[100:103], v[216:219]
    s_add_u32 s57, s49, 0xc000
    s_add_u32 m0, s50, 0xc000
    v_mfma_f32_16x16x32_bf16 v[212:215], a[220:223], a[104:107], v[212:215]
    ds_read_b128 a[220:223], v225 offset:24704
    v_mfma_f32_16x16x32_bf16 v[220:223], a[224:227], a[108:111], v[220:223]
    v_mfma_f32_16x16x32_bf16 v[216:219], a[224:227], a[112:115], v[216:219]
    s_waitcnt vmcnt(12)
    ds_read_b64_tr_b16 a[204:205], v254 offset:61440
    ds_read_b64_tr_b16 a[206:207], v255 offset:61440
    v_mfma_f32_16x16x32_bf16 v[212:215], a[224:227], a[116:119], v[212:215]
    s_waitcnt lgkmcnt(5)
    ds_read_b128 a[224:227], v225 offset:27456
    ds_read_b64_tr_b16 a[208:209], v254 offset:61472
    v_mfma_f32_16x16x32_bf16 v[220:223], a[228:231], a[120:123], v[220:223]
    buffer_load_dwordx4 v192, s[12:15], s57 offen lds
    v_mfma_f32_16x16x32_bf16 v[216:219], a[228:231], a[124:127], v[216:219]
    s_add_u32 m0, s50, 0xc400
    ds_read_b64_tr_b16 a[210:211], v255 offset:61472
    ds_read_b64_tr_b16 a[212:213], v254 offset:61504
    v_mfma_f32_16x16x32_bf16 v[212:215], a[228:231], a[128:131], v[212:215]
    ds_read_b128 a[228:231], v225 offset:27520
    ds_read_b64_tr_b16 a[214:215], v255 offset:61504
    v_mfma_f32_16x16x32_bf16 v[220:223], a[232:235], a[132:135], v[220:223]
    v_mfma_f32_16x16x32_bf16 v[216:219], a[232:235], a[136:139], v[216:219]
    v_mfma_f32_16x16x32_bf16 v[212:215], a[232:235], a[140:143], v[212:215]
    ds_read_b128 a[232:235], v225 offset:27584
    v_mfma_f32_16x16x32_bf16 v[208:211], a[144:147], a[236:239], 0
    buffer_load_dwordx4 v193, s[12:15], s57 offen lds
    v_mfma_f32_16x16x32_bf16 v[204:207], a[148:151], a[236:239], 0
    s_add_u32 m0, s50, 0xc800
    v_mfma_f32_16x16x32_bf16 v[200:203], a[152:155], a[236:239], 0
    v_cvt_pk_bf16_f32 v82, v220, v221
    v_cvt_pk_bf16_f32 v83, v222, v223
    v_mfma_f32_16x16x32_bf16 v[208:211], a[156:159], a[240:243], v[208:211]
    v_cvt_pk_bf16_f32 v104, v216, v217
    v_cvt_pk_bf16_f32 v105, v218, v219
    v_mfma_f32_16x16x32_bf16 v[204:207], a[160:163], a[240:243], v[204:207]
    v_cvt_pk_bf16_f32 v126, v212, v213
    v_cvt_pk_bf16_f32 v127, v214, v215
    v_mfma_f32_16x16x32_bf16 v[200:203], a[164:167], a[240:243], v[200:203]
    ds_read_b128 a[236:239], v225 offset:27648
    ds_read_b128 a[240:243], v225 offset:27712
    v_mfma_f32_16x16x32_bf16 v[208:211], a[168:171], a[244:247], v[208:211]
    buffer_load_dwordx4 v194, s[12:15], s57 offen lds
    v_mfma_f32_16x16x32_bf16 v[204:207], a[172:175], a[244:247], v[204:207]
    s_add_u32 s57, s49, 0xf000
    s_add_u32 m0, s50, 0xf000
    v_mfma_f32_16x16x32_bf16 v[200:203], a[176:179], a[244:247], v[200:203]
    s_waitcnt lgkmcnt(3)
    ds_read_b128 a[244:247], v225 offset:27776
    v_mfma_f32_16x16x32_bf16 v[208:211], a[180:183], a[248:251], v[208:211]
    v_mfma_f32_16x16x32_bf16 v[204:207], a[184:187], a[248:251], v[204:207]
    buffer_load_dwordx4 v192, s[12:15], s57 offen lds
    v_mfma_f32_16x16x32_bf16 v[200:203], a[188:191], a[248:251], v[200:203]
    s_add_u32 m0, s50, 0xf400
    ds_read_b128 a[248:251], v224 offset:30976
    v_mfma_f32_16x16x32_bf16 v[208:211], a[192:195], a[252:255], v[208:211]
    v_mfma_f32_16x16x32_bf16 v[204:207], a[196:199], a[252:255], v[204:207]
    v_mfma_f32_16x16x32_bf16 v[200:203], a[200:203], a[252:255], v[200:203]
    ds_read_b128 a[252:255], v224 offset:31040
    v_mfma_f32_16x16x32_bf16 v[208:211], a[204:207], a[220:223], v[208:211]
    s_waitcnt lgkmcnt(2)
    buffer_load_dwordx4 v193, s[12:15], s57 offen lds
    v_mfma_f32_16x16x32_bf16 v[204:207], a[208:211], a[220:223], v[204:207]
    s_add_u32 m0, s50, 0xf800
    s_barrier
    v_mfma_f32_16x16x32_bf16 v[200:203], a[212:215], a[220:223], v[200:203]
    ds_read_b128 a[220:223], v224 offset:31104
    v_mfma_f32_16x16x32_bf16 v[220:223], a[144:147], a[224:227], 0
    v_mfma_f32_16x16x32_bf16 v[216:219], a[148:151], a[224:227], 0
    v_cvt_pk_bf16_f32 v132, v208, v209
    v_cvt_pk_bf16_f32 v133, v210, v211
    v_mfma_f32_16x16x32_bf16 v[212:215], a[152:155], a[224:227], 0
    v_cvt_pk_bf16_f32 v134, v204, v205
    v_cvt_pk_bf16_f32 v135, v206, v207
    v_mfma_f32_16x16x32_bf16 v[220:223], a[156:159], a[228:231], v[220:223]
    v_cvt_pk_bf16_f32 v136, v200, v201
    v_cvt_pk_bf16_f32 v137, v202, v203
    v_mfma_f32_16x16x32_bf16 v[144:147], v[0:3], v[132:135], v[144:147]
    ds_read_b128 a[224:227], v224 offset:31168
    v_mfma_f32_16x16x32_bf16 v[148:151], v[24:27], v[132:135], v[148:151]
    buffer_load_dwordx4 v194, s[12:15], s57 offen lds
    v_mfma_f32_16x16x32_bf16 v[152:155], v[30:33], v[132:135], v[152:155]
    s_add_u32 m0, s41, 0
    v_mfma_f32_16x16x32_bf16 v[156:159], v[6:9], v[132:135], v[156:159]
    v_mfma_f32_16x16x16_bf16 v[144:147], v[4:5], v[136:137], v[144:147]
    buffer_load_dwordx4 v246, s[4:7], s56 offen lds
    v_mfma_f32_16x16x16_bf16 v[148:151], v[28:29], v[136:137], v[148:151]
    s_add_u32 m0, s42, 0
    v_mfma_f32_16x16x16_bf16 v[152:155], v[34:35], v[136:137], v[152:155]
    v_mfma_f32_16x16x32_bf16 v[160:163], v[12:15], v[132:135], v[160:163]
    v_mfma_f32_16x16x16_bf16 v[156:159], v[10:11], v[136:137], v[156:159]
    v_mfma_f32_16x16x32_bf16 v[164:167], v[36:39], v[132:135], v[164:167]
    v_mfma_f32_16x16x32_bf16 v[168:171], v[42:45], v[132:135], v[168:171]
    buffer_load_dwordx4 v247, s[4:7], s56 offen lds
    v_mfma_f32_16x16x32_bf16 v[172:175], v[18:21], v[132:135], v[172:175]
    s_add_u32 s56, s39, 0x17a000
    v_max3_f32 v248, v144, v145, v146
    v_max3_f32 v249, v147, v148, v149
    v_mfma_f32_16x16x16_bf16 v[160:163], v[16:17], v[136:137], v[160:163]
    s_add_u32 m0, s41, 0x1e40
    v_max3_f32 v248, v248, v150, v151
    v_max3_f32 v249, v249, v152, v153
    v_mfma_f32_16x16x16_bf16 v[164:167], v[40:41], v[136:137], v[164:167]
    v_max3_f32 v248, v248, v154, v155
    v_max3_f32 v249, v249, v156, v157
    v_mfma_f32_16x16x16_bf16 v[168:171], v[46:47], v[136:137], v[168:171]
    v_max3_f32 v248, v248, v158, v159
    v_max3_f32 v249, v249, v160, v161
    v_mfma_f32_16x16x16_bf16 v[172:175], v[22:23], v[136:137], v[172:175]
    buffer_load_dwordx4 v246, s[4:7], s56 offen lds
    v_mfma_f32_16x16x32_bf16 v[216:219], a[160:163], a[228:231], v[216:219]
    s_add_u32 m0, s42, 0x1e40
    v_max3_f32 v248, v248, v162, v163
    v_max3_f32 v249, v249, v164, v165
    v_mfma_f32_16x16x32_bf16 v[212:215], a[164:167], a[228:231], v[212:215]
    ds_read_b128 a[228:231], v224 offset:31232
    v_max3_f32 v248, v248, v166, v167
    v_mfma_f32_16x16x32_bf16 v[220:223], a[168:171], a[232:235], v[220:223]
    v_max3_f32 v249, v249, v168, v169
    v_max3_f32 v248, v248, v170, v171
    v_mfma_f32_16x16x32_bf16 v[216:219], a[172:175], a[232:235], v[216:219]
    v_max3_f32 v249, v249, v172, v173
    v_max3_f32 v248, v248, v174, v175
    v_mfma_f32_16x16x32_bf16 v[212:215], a[176:179], a[232:235], v[212:215]
    ds_read_b128 a[232:235], v224 offset:31296
    v_max_f32 v248, v248, v249
    v_mfma_f32_16x16x32_bf16 v[220:223], a[180:183], a[236:239], v[220:223]
    buffer_load_dwordx4 v247, s[4:7], s56 offen lds
    v_mfma_f32_16x16x32_bf16 v[216:219], a[184:187], a[236:239], v[216:219]
    s_add_u32 s56, s39, 0x1a4000
    v_mov_b32 v249, v248
    s_add_u32 m0, s41, 0x3c80
    v_mfma_f32_16x16x32_bf16 v[212:215], a[188:191], a[236:239], v[212:215]
    ds_read_b128 a[236:239], v224 offset:34048
    v_mfma_f32_16x16x32_bf16 v[220:223], a[192:195], a[240:243], v[220:223]
    v_permlane16_swap_b32 v248, v249
    v_mfma_f32_16x16x32_bf16 v[216:219], a[196:199], a[240:243], v[216:219]
    v_max_f32 v248, v248, v249
    v_mov_b32 v249, v248
    v_mfma_f32_16x16x32_bf16 v[212:215], a[200:203], a[240:243], v[212:215]
    ds_read_b128 a[240:243], v224 offset:34112
    v_mfma_f32_16x16x32_bf16 v[220:223], a[204:207], a[244:247], v[220:223]
    buffer_load_dwordx4 v246, s[4:7], s56 offen lds
    v_mfma_f32_16x16x32_bf16 v[216:219], a[208:211], a[244:247], v[216:219]
    s_add_u32 m0, s42, 0x3c80
    v_permlane32_swap_b32 v248, v249
    v_mfma_f32_16x16x32_bf16 v[212:215], a[212:215], a[244:247], v[212:215]
    s_waitcnt lgkmcnt(3)
    ds_read_b128 a[244:247], v224 offset:34176
    v_max_f32 v248, v248, v249
    v_mfma_f32_16x16x32_bf16 v[208:211], a[248:251], a[72:75], 0
    v_cvt_pk_bf16_f32 v138, v220, v221
    v_cvt_pk_bf16_f32 v139, v222, v223
    v_mfma_f32_16x16x32_bf16 v[204:207], a[248:251], a[76:79], 0
    v_cvt_pk_bf16_f32 v140, v216, v217
    v_cvt_pk_bf16_f32 v141, v218, v219
    v_mfma_f32_16x16x32_bf16 v[200:203], a[248:251], a[80:83], 0
    v_cvt_pk_bf16_f32 v142, v212, v213
    v_cvt_pk_bf16_f32 v143, v214, v215
    v_mfma_f32_16x16x32_bf16 v[208:211], a[252:255], a[84:87], v[208:211]
    ds_read_b128 a[248:251], v224 offset:34240
    v_mul_f32 v236, s37, v248
    v_mfma_f32_16x16x32_bf16 v[204:207], a[252:255], a[88:91], v[204:207]
    buffer_load_dwordx4 v247, s[4:7], s56 offen lds
    v_mfma_f32_16x16x32_bf16 v[200:203], a[252:255], a[92:95], v[200:203]
    s_add_u32 s56, s39, 0x1ce000
    ds_read_b128 a[252:255], v224 offset:34304
    v_fma_f32 v144, v144, s37, -v236
    v_mfma_f32_16x16x32_bf16 v[208:211], a[220:223], a[96:99], v[208:211]
    s_add_u32 m0, s41, 0x5ac0
    v_fma_f32 v145, v145, s37, -v236
    v_fma_f32 v146, v146, s37, -v236
    v_mfma_f32_16x16x32_bf16 v[204:207], a[220:223], a[100:103], v[204:207]
    buffer_load_dwordx4 v246, s[4:7], s56 offen lds
    v_mfma_f32_16x16x32_bf16 v[200:203], a[220:223], a[104:107], v[200:203]
    s_add_u32 m0, s42, 0x5ac0
    ds_read_b128 a[220:223], v224 offset:34368
    v_fma_f32 v147, v147, s37, -v236
    v_mfma_f32_16x16x32_bf16 v[208:211], a[224:227], a[108:111], v[208:211]
    v_exp_f32 v144, v144
    v_mfma_f32_16x16x32_bf16 v[204:207], a[224:227], a[112:115], v[204:207]
    v_exp_f32 v145, v145
    v_mfma_f32_16x16x32_bf16 v[200:203], a[224:227], a[116:119], v[200:203]
    ds_read_b128 a[224:227], v224 offset:46464
    v_cvt_pk_bf16_f32 v176, v144, v145
    v_mfma_f32_16x16x32_bf16 v[208:211], a[228:231], a[120:123], v[208:211]
    v_exp_f32 v146, v146
    v_mfma_f32_16x16x32_bf16 v[204:207], a[228:231], a[124:127], v[204:207]
    s_waitcnt lgkmcnt(3)
    buffer_load_dwordx4 v247, s[4:7], s56 offen lds
    v_mfma_f32_16x16x32_bf16 v[200:203], a[228:231], a[128:131], v[200:203]
    s_add_u32 s56, s39, 0x1f8000
    ds_read_b128 a[228:231], v224 offset:46528
    v_fma_f32 v148, v148, s37, -v236
    v_mfma_f32_16x16x32_bf16 v[208:211], a[232:235], a[132:135], v[208:211]
    s_add_u32 m0, s41, 0x7900
    v_exp_f32 v147, v147
    v_mfma_f32_16x16x32_bf16 v[204:207], a[232:235], a[136:139], v[204:207]
    v_cvt_pk_bf16_f32 v177, v146, v147
    v_fma_f32 v149, v149, s37, -v236
    v_mfma_f32_16x16x32_bf16 v[200:203], a[232:235], a[140:143], v[200:203]
    ds_read_b128 a[232:235], v224 offset:46592
    ds_read_b128 v[144:147], v234
    v_mfma_f32_16x16x32_bf16 v[220:223], a[236:239], a[72:75], 0
    v_cvt_pk_bf16_f32 v74, v208, v209
    v_cvt_pk_bf16_f32 v75, v210, v211
    v_mfma_f32_16x16x32_bf16 v[216:219], a[236:239], a[76:79], 0
    v_cvt_pk_bf16_f32 v96, v204, v205
    v_cvt_pk_bf16_f32 v97, v206, v207
    v_mfma_f32_16x16x32_bf16 v[212:215], a[236:239], a[80:83], 0
    v_cvt_pk_bf16_f32 v118, v200, v201
    v_cvt_pk_bf16_f32 v119, v202, v203
    v_mfma_f32_16x16x32_bf16 v[220:223], a[240:243], a[84:87], v[220:223]
    ds_read_b128 a[236:239], v224 offset:46656
    v_bfe_u32 v234, s63, v233, 4
    v_mfma_f32_16x16x32_bf16 v[216:219], a[240:243], a[88:91], v[216:219]
    v_mad_u32_u24 v234, v234, s40, v231
    v_fma_f32 v150, v150, s37, -v236
    v_mfma_f32_16x16x32_bf16 v[212:215], a[240:243], a[92:95], v[212:215]
    ds_read_b128 a[240:243], v224 offset:46720
    v_fma_f32 v151, v151, s37, -v236
    v_mfma_f32_16x16x32_bf16 v[220:223], a[244:247], a[96:99], v[220:223]
    v_exp_f32 v148, v148
    v_mfma_f32_16x16x32_bf16 v[216:219], a[244:247], a[100:103], v[216:219]
    v_exp_f32 v149, v149
    v_mfma_f32_16x16x32_bf16 v[212:215], a[244:247], a[104:107], v[212:215]
    ds_read_b128 a[244:247], v224 offset:46784
    v_cvt_pk_bf16_f32 v178, v148, v149
    v_mfma_f32_16x16x32_bf16 v[220:223], a[248:251], a[108:111], v[220:223]
    s_waitcnt lgkmcnt(3)
    v_exp_f32 v150, v150
    v_mfma_f32_16x16x32_bf16 v[144:147], v[24:27], v[138:141], v[144:147]
    v_exp_f32 v151, v151
    v_mfma_f32_16x16x32_bf16 v[216:219], a[248:251], a[112:115], v[216:219]
    v_cvt_pk_bf16_f32 v179, v150, v151
    v_fma_f32 v152, v152, s37, -v236
    v_mfma_f32_16x16x32_bf16 v[212:215], a[248:251], a[116:119], v[212:215]
    ds_read_b128 a[248:251], v224 offset:49536
    ds_read_b128 v[148:151], v235
    v_mfma_f32_16x16x32_bf16 v[196:199], a[216:219], v[176:179], 0
    v_bfe_u32 v235, s64, v233, 4
    v_mad_u32_u24 v235, v235, s40, v231
    v_mfma_f32_16x16x32_bf16 v[184:187], v[66:69], v[176:179], 0
    v_fma_f32 v153, v153, s37, -v236
    v_fma_f32 v154, v154, s37, -v236
    v_mfma_f32_16x16x32_bf16 v[188:191], v[88:91], v[176:179], 0
    v_fma_f32 v155, v155, s37, -v236
    v_fma_f32 v156, v156, s37, -v236
    v_mfma_f32_16x16x32_bf16 v[192:195], v[110:113], v[176:179], 0
    v_exp_f32 v152, v152
    v_mfma_f32_16x16x16_bf16 v[144:147], v[28:29], v[142:143], v[144:147]
    v_exp_f32 v153, v153
    v_mfma_f32_16x16x32_bf16 v[220:223], a[252:255], a[120:123], v[220:223]
    v_exp_f32 v154, v154
    v_mfma_f32_16x16x32_bf16 v[216:219], a[252:255], a[124:127], v[216:219]
    v_exp_f32 v155, v155
    v_mfma_f32_16x16x32_bf16 v[212:215], a[252:255], a[128:131], v[212:215]
    ds_read_b128 a[252:255], v224 offset:49600
    v_cvt_pk_bf16_f32 v180, v152, v153
    v_mfma_f32_16x16x32_bf16 v[220:223], a[220:223], a[132:135], v[220:223]
    v_cvt_pk_bf16_f32 v181, v154, v155
    v_fma_f32 v157, v157, s37, -v236
    v_mfma_f32_16x16x32_bf16 v[216:219], a[220:223], a[136:139], v[216:219]
    s_waitcnt lgkmcnt(1)
    ds_read_b128 v[152:155], v230 offset:1920
    v_fma_f32 v158, v158, s37, -v236
    v_mfma_f32_16x16x32_bf16 v[148:151], v[30:33], v[138:141], v[148:151]
    v_fma_f32 v159, v159, s37, -v236
    v_fma_f32 v160, v160, s37, -v236
    v_mfma_f32_16x16x32_bf16 v[212:215], a[220:223], a[140:143], v[212:215]
    v_cvt_pk_bf16_f32 v76, v220, v221
    v_cvt_pk_bf16_f32 v77, v222, v223
    v_mfma_f32_16x16x32_bf16 v[208:211], a[224:227], a[72:75], 0
    v_cvt_pk_bf16_f32 v98, v216, v217
    v_cvt_pk_bf16_f32 v99, v218, v219
    v_mfma_f32_16x16x16_bf16 v[148:151], v[34:35], v[142:143], v[148:151]
    ds_read_b128 a[220:223], v224 offset:49664
    v_fma_f32 v161, v161, s37, -v236
    v_mfma_f32_16x16x32_bf16 v[204:207], a[224:227], a[76:79], 0
    v_cvt_pk_bf16_f32 v120, v212, v213
    v_cvt_pk_bf16_f32 v121, v214, v215
    v_mfma_f32_16x16x32_bf16 v[200:203], a[224:227], a[80:83], 0
    ds_read_b128 a[224:227], v224 offset:49728
    v_fma_f32 v162, v162, s37, -v236
    v_mfma_f32_16x16x32_bf16 v[208:211], a[228:231], a[84:87], v[208:211]
    v_exp_f32 v156, v156
    v_mfma_f32_16x16x32_bf16 v[204:207], a[228:231], a[88:91], v[204:207]
    v_exp_f32 v157, v157
    v_mfma_f32_16x16x32_bf16 v[200:203], a[228:231], a[92:95], v[200:203]
    s_waitcnt lgkmcnt(2)
    ds_read_b128 a[228:231], v224 offset:49792
    v_cvt_pk_bf16_f32 v182, v156, v157
    v_mfma_f32_16x16x32_bf16 v[152:155], v[36:39], v[138:141], v[152:155]
    v_exp_f32 v158, v158
    v_mfma_f32_16x16x32_bf16 v[208:211], a[232:235], a[96:99], v[208:211]
    v_exp_f32 v159, v159
    v_mfma_f32_16x16x32_bf16 v[204:207], a[232:235], a[100:103], v[204:207]
    v_cvt_pk_bf16_f32 v183, v158, v159
    v_fma_f32 v163, v163, s37, -v236
    v_mfma_f32_16x16x16_bf16 v[152:155], v[40:41], v[142:143], v[152:155]
    ds_read_b128 v[156:159], v250
    v_bfe_u32 v250, s65, v232, 4
    v_mfma_f32_16x16x32_bf16 v[196:199], a[216:219], v[180:183], v[196:199]
    v_exp_f32 v160, v160
    v_mfma_f32_16x16x32_bf16 v[184:187], v[70:73], v[180:183], v[184:187]
    v_exp_f32 v161, v161
    v_mfma_f32_16x16x32_bf16 v[188:191], v[92:95], v[180:183], v[188:191]
    v_exp_f32 v162, v162
    v_mfma_f32_16x16x32_bf16 v[192:195], v[114:117], v[180:183], v[192:195]
    v_exp_f32 v163, v163
    v_mfma_f32_16x16x32_bf16 v[200:203], a[232:235], a[104:107], v[200:203]
    ds_read_b128 a[232:235], v224 offset:49856
    v_cvt_pk_bf16_f32 v176, v160, v161
    v_mfma_f32_16x16x32_bf16 v[208:211], a[236:239], a[108:111], v[208:211]
    v_cvt_pk_bf16_f32 v177, v162, v163
    v_fma_f32 v164, v164, s37, -v236
    v_mfma_f32_16x16x32_bf16 v[204:207], a[236:239], a[112:115], v[204:207]
    s_waitcnt vmcnt(4)
    ds_read_b128 v[160:163], v234
    v_mad_u32_u24 v234, v250, s40, v229
    v_mfma_f32_16x16x32_bf16 v[200:203], a[236:239], a[116:119], v[200:203]
    s_barrier
    ds_read_b128 a[236:239], v225 offset:39872
    ds_read_b128 v[252:255], v224 offset:320
    v_mfma_f32_16x16x32_bf16 v[208:211], a[240:243], a[120:123], v[208:211]
    s_waitcnt lgkmcnt(4)
    v_mad_u32_u24 v250, v250, s40, v228
    v_fma_f32 v165, v165, s37, -v236
    v_mfma_f32_16x16x32_bf16 v[156:159], v[42:45], v[138:141], v[156:159]
    v_fma_f32 v166, v166, s37, -v236
    v_fma_f32 v167, v167, s37, -v236
    v_mfma_f32_16x16x32_bf16 v[204:207], a[240:243], a[124:127], v[204:207]
    v_exp_f32 v164, v164
    v_mfma_f32_16x16x32_bf16 v[200:203], a[240:243], a[128:131], v[200:203]
    ds_read_b128 a[240:243], v225 offset:39936
    v_fma_f32 v168, v168, s37, -v236
    v_mfma_f32_16x16x16_bf16 v[156:159], v[46:47], v[142:143], v[156:159]
    v_exp_f32 v165, v165
    v_mfma_f32_16x16x32_bf16 v[208:211], a[244:247], a[132:135], v[208:211]
    v_exp_f32 v166, v166
    v_mfma_f32_16x16x32_bf16 v[204:207], a[244:247], a[136:139], v[204:207]
    v_exp_f32 v167, v167
    v_mfma_f32_16x16x32_bf16 v[200:203], a[244:247], a[140:143], v[200:203]
    s_waitcnt lgkmcnt(3)
    ds_read_b128 a[244:247], v225 offset:40000
    v_cvt_pk_bf16_f32 v178, v164, v165
    v_mfma_f32_16x16x32_bf16 v[160:163], v[48:51], v[138:141], v[160:163]
    v_cvt_pk_bf16_f32 v179, v166, v167
    v_cvt_pk_bf16_f32 v80, v208, v209
    v_mfma_f32_16x16x32_bf16 v[220:223], a[248:251], a[72:75], 0
    v_cvt_pk_bf16_f32 v81, v210, v211
    v_cvt_pk_bf16_f32 v102, v204, v205
    v_mfma_f32_16x16x32_bf16 v[196:199], a[216:219], v[176:179], v[196:199]
    v_cvt_pk_bf16_f32 v103, v206, v207
    v_cvt_pk_bf16_f32 v124, v200, v201
    v_mfma_f32_16x16x32_bf16 v[184:187], v[74:77], v[176:179], v[184:187]
    ds_read_b128 v[164:167], v235
    v_cvt_pk_bf16_f32 v125, v202, v203
    v_mfma_f32_16x16x32_bf16 v[188:191], v[96:99], v[176:179], v[188:191]
    v_bfe_u32 v235, s62, v232, 4
    v_fma_f32 v169, v169, s37, -v236
    v_mfma_f32_16x16x32_bf16 v[192:195], v[118:121], v[176:179], v[192:195]
    v_fma_f32 v170, v170, s37, -v236
    v_fma_f32 v171, v171, s37, -v236
    v_mfma_f32_16x16x16_bf16 v[160:163], v[52:53], v[142:143], v[160:163]
    v_exp_f32 v168, v168
    v_mfma_f32_16x16x32_bf16 v[216:219], a[248:251], a[76:79], 0
    v_exp_f32 v169, v169
    v_mfma_f32_16x16x32_bf16 v[212:215], a[248:251], a[80:83], 0
    ds_read_b128 a[248:251], v225 offset:40064
    v_cvt_pk_bf16_f32 v180, v168, v169
    v_mfma_f32_16x16x32_bf16 v[220:223], a[252:255], a[84:87], v[220:223]
    v_exp_f32 v170, v170
    v_mfma_f32_16x16x32_bf16 v[216:219], a[252:255], a[88:91], v[216:219]
    v_exp_f32 v171, v171
    v_mfma_f32_16x16x32_bf16 v[212:215], a[252:255], a[92:95], v[212:215]
    ds_read_b128 a[252:255], v225 offset:40128
    v_cvt_pk_bf16_f32 v181, v170, v171
    v_mfma_f32_16x16x32_bf16 v[220:223], a[220:223], a[96:99], v[220:223]
    s_waitcnt lgkmcnt(2)
    ds_read_b128 v[168:171], v234
    v_bfe_u32 v234, s62, v232, 4
    v_mfma_f32_16x16x32_bf16 v[164:167], v[54:57], v[138:141], v[164:167]
    v_mad_u32_u24 v234, v234, s40, v230
    v_fma_f32 v172, v172, s37, -v236
    v_mfma_f32_16x16x32_bf16 v[216:219], a[220:223], a[100:103], v[216:219]
    v_fma_f32 v173, v173, s37, -v236
    v_fma_f32 v174, v174, s37, -v236
    v_mfma_f32_16x16x32_bf16 v[212:215], a[220:223], a[104:107], v[212:215]
    ds_read_b128 a[220:223], v225 offset:40192
    v_fma_f32 v175, v175, s37, -v236
    v_mfma_f32_16x16x16_bf16 v[164:167], v[58:59], v[142:143], v[164:167]
    v_exp_f32 v172, v172
    v_mfma_f32_16x16x32_bf16 v[220:223], a[224:227], a[108:111], v[220:223]
    v_exp_f32 v173, v173
    v_mfma_f32_16x16x32_bf16 v[216:219], a[224:227], a[112:115], v[216:219]
    v_exp_f32 v174, v174
    v_mfma_f32_16x16x32_bf16 v[212:215], a[224:227], a[116:119], v[212:215]
    ds_read_b128 a[224:227], v227 offset:37120
    v_cvt_pk_bf16_f32 v182, v172, v173
    v_mfma_f32_16x16x32_bf16 v[220:223], a[228:231], a[120:123], v[220:223]
    v_exp_f32 v175, v175
    v_mfma_f32_16x16x32_bf16 v[216:219], a[228:231], a[124:127], v[216:219]
    v_cvt_pk_bf16_f32 v183, v174, v175
    v_max3_f32 v248, v144, v145, v146
    v_mfma_f32_16x16x32_bf16 v[212:215], a[228:231], a[128:131], v[212:215]
    ds_read_b128 a[228:231], v227 offset:37184
    ds_read_b128 v[172:175], v250
    v_mfma_f32_16x16x32_bf16 v[196:199], a[216:219], v[180:183], v[196:199]
    v_mad_u32_u24 v250, v235, s40, v228
    v_mad_u32_u24 v235, v235, s40, v229
    v_mfma_f32_16x16x32_bf16 v[220:223], a[232:235], a[132:135], v[220:223]
    v_max3_f32 v249, v147, v148, v149
    v_max3_f32 v248, v248, v150, v151
    v_mfma_f32_16x16x32_bf16 v[216:219], a[232:235], a[136:139], v[216:219]
    v_max3_f32 v249, v249, v152, v153
    v_max3_f32 v248, v248, v154, v155
    v_mfma_f32_16x16x32_bf16 v[212:215], a[232:235], a[140:143], v[212:215]
    ds_read_b128 a[232:235], v227 offset:37248
    v_max3_f32 v249, v249, v156, v157
    v_mfma_f32_16x16x32_bf16 v[208:211], a[144:147], a[236:239], 0
    v_cvt_pk_bf16_f32 v78, v220, v221
    v_cvt_pk_bf16_f32 v79, v222, v223
    v_mfma_f32_16x16x32_bf16 v[204:207], a[148:151], a[236:239], 0
    v_cvt_pk_bf16_f32 v100, v216, v217
    v_cvt_pk_bf16_f32 v101, v218, v219
    v_mfma_f32_16x16x32_bf16 v[184:187], v[78:81], v[180:183], v[184:187]
    v_cvt_pk_bf16_f32 v122, v212, v213
    v_cvt_pk_bf16_f32 v123, v214, v215
    v_mfma_f32_16x16x32_bf16 v[188:191], v[100:103], v[180:183], v[188:191]
    v_rcp_f32 v197, v196
    v_mfma_f32_16x16x32_bf16 v[192:195], v[122:125], v[180:183], v[192:195]
    v_max3_f32 v248, v248, v158, v159
    v_max3_f32 v249, v249, v160, v161
    v_mfma_f32_16x16x32_bf16 v[200:203], a[152:155], a[236:239], 0
    ds_read_b128 a[236:239], v227 offset:37312
    v_mul_f32 v184, v184, v197
    v_mfma_f32_16x16x32_bf16 v[208:211], a[156:159], a[240:243], v[208:211]
    v_mul_f32 v185, v185, v197
    v_cvt_pk_bf16_f32 v184, v184, v185
    v_mfma_f32_16x16x32_bf16 v[204:207], a[160:163], a[240:243], v[204:207]
    v_mul_f32 v186, v186, v197
    v_mul_f32 v187, v187, v197
    v_mfma_f32_16x16x32_bf16 v[200:203], a[164:167], a[240:243], v[200:203]
    ds_read_b128 a[240:243], v227 offset:37376
    v_cvt_pk_bf16_f32 v185, v186, v187
    v_mfma_f32_16x16x32_bf16 v[208:211], a[168:171], a[244:247], v[208:211]
    v_mul_f32 v188, v188, v197
    v_mul_f32 v189, v189, v197
    v_mfma_f32_16x16x32_bf16 v[204:207], a[172:175], a[244:247], v[204:207]
    v_cvt_pk_bf16_f32 v186, v188, v189
    v_mul_f32 v190, v190, v197
    v_mfma_f32_16x16x32_bf16 v[200:203], a[176:179], a[244:247], v[200:203]
    s_waitcnt lgkmcnt(2)
    ds_read_b128 a[244:247], v227 offset:37440
    v_mul_f32 v191, v191, v197
    v_mfma_f32_16x16x32_bf16 v[208:211], a[180:183], a[248:251], v[208:211]
    v_cvt_pk_bf16_f32 v187, v190, v191
    v_mul_f32 v192, v192, v197
    v_mfma_f32_16x16x32_bf16 v[204:207], a[184:187], a[248:251], v[204:207]
    v_mul_f32 v193, v193, v197
    v_cvt_pk_bf16_f32 v188, v192, v193
    v_mfma_f32_16x16x32_bf16 v[200:203], a[188:191], a[248:251], v[200:203]
    ds_read_b128 a[248:251], v224
    v_mul_f32 v194, v194, v197
    v_mfma_f32_16x16x32_bf16 v[208:211], a[192:195], a[252:255], v[208:211]
    v_mul_f32 v195, v195, v197
    v_cvt_pk_bf16_f32 v189, v194, v195
    v_mfma_f32_16x16x32_bf16 v[204:207], a[196:199], a[252:255], v[204:207]
    ds_write_b128 v237, v[184:187]
    v_mfma_f32_16x16x32_bf16 v[200:203], a[200:203], a[252:255], v[200:203]
    ds_read_b128 a[252:255], v224 offset:64
    v_max3_f32 v248, v248, v162, v163
    v_mfma_f32_16x16x32_bf16 v[208:211], a[204:207], a[220:223], v[208:211]
    ds_write_b64 v238, v[188:189]
    v_mfma_f32_16x16x32_bf16 v[204:207], a[208:211], a[220:223], v[204:207]
    v_max3_f32 v249, v249, v164, v165
    v_max3_f32 v248, v248, v166, v167
    v_mfma_f32_16x16x32_bf16 v[200:203], a[212:215], a[220:223], v[200:203]
    ds_read_b64_tr_b16 a[220:221], v241
    ds_read_b64_tr_b16 a[222:223], v241 offset:1536
    v_mfma_f32_16x16x32_bf16 v[220:223], a[224:227], a[72:75], 0
    v_cvt_pk_bf16_f32 v132, v208, v209
    v_cvt_pk_bf16_f32 v133, v210, v211
    v_mfma_f32_16x16x32_bf16 v[216:219], a[224:227], a[76:79], 0
    v_cvt_pk_bf16_f32 v134, v204, v205
    v_cvt_pk_bf16_f32 v135, v206, v207
    v_mfma_f32_16x16x32_bf16 v[212:215], a[224:227], a[80:83], 0
    v_cvt_pk_bf16_f32 v136, v200, v201
    v_cvt_pk_bf16_f32 v137, v202, v203
    v_mfma_f32_16x16x32_bf16 v[168:171], v[30:33], v[132:135], v[168:171]
    ds_read_b64_tr_b16 a[224:225], v241 offset:8
    ds_read_b64_tr_b16 a[226:227], v241 offset:1544
    v_mfma_f32_16x16x32_bf16 v[172:175], v[6:9], v[132:135], v[172:175]
    v_max_f32 v248, v248, v249
    v_mov_b32 v249, v248
    v_mfma_f32_16x16x32_bf16 v[220:223], a[228:231], a[84:87], v[220:223]
    v_mfma_f32_16x16x16_bf16 v[168:171], v[34:35], v[136:137], v[168:171]
    v_permlane16_swap_b32 v248, v249
    v_mfma_f32_16x16x32_bf16 v[216:219], a[228:231], a[88:91], v[216:219]
    v_max_f32 v248, v248, v249
    v_mov_b32 v249, v248
    v_mfma_f32_16x16x16_bf16 v[172:175], v[10:11], v[136:137], v[172:175]
    v_mfma_f32_16x16x32_bf16 v[212:215], a[228:231], a[92:95], v[212:215]
    ds_read_b64_tr_b16 a[228:229], v242
    ds_read_b64_tr_b16 a[230:231], v242 offset:1536
    v_mfma_f32_16x16x32_bf16 v[220:223], a[232:235], a[96:99], v[220:223]
    v_permlane32_swap_b32 v248, v249
    v_mfma_f32_16x16x32_bf16 v[216:219], a[232:235], a[100:103], v[216:219]
    v_max_f32 v248, v248, v249
    v_mul_f32 v236, s37, v248
    v_mfma_f32_16x16x32_bf16 v[212:215], a[232:235], a[104:107], v[212:215]
    s_waitcnt lgkmcnt(4)
    ds_read_b64_tr_b16 a[232:233], v242 offset:8
    ds_read_b64_tr_b16 a[234:235], v242 offset:1544
    v_mfma_f32_16x16x32_bf16 v[220:223], a[236:239], a[108:111], v[220:223]
    v_fma_f32 v144, v144, s37, -v236
    v_fma_f32 v145, v145, s37, -v236
    v_mfma_f32_16x16x32_bf16 v[216:219], a[236:239], a[112:115], v[216:219]
    v_fma_f32 v146, v146, s37, -v236
    v_fma_f32 v147, v147, s37, -v236
    v_mfma_f32_16x16x32_bf16 v[212:215], a[236:239], a[116:119], v[212:215]
    ds_read_b128 a[236:239], v224 offset:128
    v_fma_f32 v148, v148, s37, -v236
    v_mfma_f32_16x16x32_bf16 v[220:223], a[240:243], a[120:123], v[220:223]
    v_exp_f32 v144, v144
    v_mfma_f32_16x16x32_bf16 v[216:219], a[240:243], a[124:127], v[216:219]
    v_exp_f32 v145, v145
    v_mfma_f32_16x16x32_bf16 v[212:215], a[240:243], a[128:131], v[212:215]
    ds_read_b128 a[240:243], v224 offset:192
    v_cvt_pk_bf16_f32 v176, v144, v145
    v_mfma_f32_16x16x32_bf16 v[220:223], a[244:247], a[132:135], v[220:223]
    v_exp_f32 v146, v146
    v_mfma_f32_16x16x32_bf16 v[216:219], a[244:247], a[136:139], v[216:219]
    v_exp_f32 v147, v147
    v_mfma_f32_16x16x32_bf16 v[212:215], a[244:247], a[140:143], v[212:215]
    ds_read_b128 a[244:247], v224 offset:256
    v_cvt_pk_bf16_f32 v177, v146, v147
    v_mfma_f32_16x16x32_bf16 v[208:211], a[0:3], a[248:251], 0
    ds_read_b128 v[144:147], v228 offset:1280
    v_cvt_pk_bf16_f32 v84, v220, v221
    v_mfma_f32_16x16x32_bf16 v[204:207], a[4:7], a[248:251], 0
    v_cvt_pk_bf16_f32 v85, v222, v223
    v_cvt_pk_bf16_f32 v106, v216, v217
    v_mfma_f32_16x16x32_bf16 v[200:203], a[8:11], a[248:251], 0
    v_cvt_pk_bf16_f32 v107, v218, v219
    v_cvt_pk_bf16_f32 v128, v212, v213
    v_mfma_f32_16x16x32_bf16 v[220:223], a[248:251], a[72:75], 0
    v_cvt_pk_bf16_f32 v129, v214, v215
    v_fma_f32 v149, v149, s37, -v236
    v_mfma_f32_16x16x32_bf16 v[216:219], a[248:251], a[76:79], 0
    v_fma_f32 v150, v150, s37, -v236
    v_fma_f32 v151, v151, s37, -v236
    v_mfma_f32_16x16x32_bf16 v[212:215], a[248:251], a[80:83], 0
    ds_read_b128 a[248:251], v224 offset:3072
    v_fma_f32 v152, v152, s37, -v236
    v_mfma_f32_16x16x32_bf16 v[208:211], a[12:15], a[252:255], v[208:211]
    v_exp_f32 v148, v148
    v_mfma_f32_16x16x32_bf16 v[204:207], a[16:19], a[252:255], v[204:207]
    v_exp_f32 v149, v149
    v_mfma_f32_16x16x32_bf16 v[200:203], a[20:23], a[252:255], v[200:203]
    v_exp_f32 v150, v150
    v_mfma_f32_16x16x32_bf16 v[220:223], a[252:255], a[84:87], v[220:223]
    s_waitcnt lgkmcnt(1)
    v_exp_f32 v151, v151
    v_mfma_f32_16x16x32_bf16 v[144:147], v[12:15], v[132:135], v[144:147]
    v_cvt_pk_bf16_f32 v178, v148, v149
    v_cvt_pk_bf16_f32 v179, v150, v151
    v_mfma_f32_16x16x32_bf16 v[216:219], a[252:255], a[88:91], v[216:219]
    ds_read_b128 v[148:151], v229 offset:1280
    v_fma_f32 v153, v153, s37, -v236
    v_mfma_f32_16x16x32_bf16 v[196:199], a[216:219], v[176:179], 0
    v_fma_f32 v154, v154, s37, -v236
    v_fma_f32 v155, v155, s37, -v236
    v_mfma_f32_16x16x32_bf16 v[184:187], v[68:71], v[176:179], 0
    v_exp_f32 v152, v152
    v_mfma_f32_16x16x32_bf16 v[188:191], v[90:93], v[176:179], 0
    v_exp_f32 v153, v153
    v_mfma_f32_16x16x32_bf16 v[192:195], v[112:115], v[176:179], 0
    v_exp_f32 v154, v154
    v_mfma_f32_16x16x16_bf16 v[144:147], v[16:17], v[136:137], v[144:147]
    v_exp_f32 v155, v155
    v_mfma_f32_16x16x32_bf16 v[212:215], a[252:255], a[92:95], v[212:215]
    ds_read_b128 a[252:255], v224 offset:3136
    v_cvt_pk_bf16_f32 v180, v152, v153
    v_mfma_f32_16x16x32_bf16 v[208:211], a[24:27], a[236:239], v[208:211]
    v_cvt_pk_bf16_f32 v181, v154, v155
    v_fma_f32 v156, v156, s37, -v236
    v_mfma_f32_16x16x32_bf16 v[204:207], a[28:31], a[236:239], v[204:207]
    ds_read_b128 v[152:155], v229 offset:1920
    v_fma_f32 v157, v157, s37, -v236
    v_mfma_f32_16x16x32_bf16 v[200:203], a[32:35], a[236:239], v[200:203]
    s_waitcnt lgkmcnt(2)
    v_fma_f32 v158, v158, s37, -v236
    v_fma_f32 v159, v159, s37, -v236
    v_mfma_f32_16x16x32_bf16 v[148:151], v[36:39], v[132:135], v[148:151]
    v_exp_f32 v156, v156
    v_mfma_f32_16x16x32_bf16 v[220:223], a[236:239], a[96:99], v[220:223]
    v_exp_f32 v157, v157
    v_mfma_f32_16x16x32_bf16 v[216:219], a[236:239], a[100:103], v[216:219]
    v_exp_f32 v158, v158
    v_mfma_f32_16x16x32_bf16 v[212:215], a[236:239], a[104:107], v[212:215]
    ds_read_b128 a[236:239], v224 offset:3200
    v_cvt_pk_bf16_f32 v182, v156, v157
    v_mfma_f32_16x16x16_bf16 v[148:151], v[40:41], v[136:137], v[148:151]
    v_exp_f32 v159, v159
    v_mfma_f32_16x16x32_bf16 v[208:211], a[36:39], a[240:243], v[208:211]
    v_cvt_pk_bf16_f32 v183, v158, v159
    v_fma_f32 v160, v160, s37, -v236
    v_mfma_f32_16x16x32_bf16 v[204:207], a[40:43], a[240:243], v[204:207]
    ds_read_b128 v[156:159], v228 offset:1920
    v_fma_f32 v161, v161, s37, -v236
    v_mfma_f32_16x16x32_bf16 v[196:199], a[216:219], v[180:183], v[196:199]
    v_fma_f32 v162, v162, s37, -v236
    v_fma_f32 v163, v163, s37, -v236
    v_mfma_f32_16x16x32_bf16 v[184:187], v[76:79], v[180:183], v[184:187]
    v_exp_f32 v160, v160
    v_mfma_f32_16x16x32_bf16 v[188:191], v[98:101], v[180:183], v[188:191]
    v_exp_f32 v161, v161
    v_mfma_f32_16x16x32_bf16 v[192:195], v[120:123], v[180:183], v[192:195]
    s_waitcnt lgkmcnt(2)
    v_exp_f32 v162, v162
    v_mfma_f32_16x16x32_bf16 v[152:155], v[42:45], v[132:135], v[152:155]
    v_exp_f32 v163, v163
    v_mfma_f32_16x16x32_bf16 v[200:203], a[44:47], a[240:243], v[200:203]
    v_cvt_pk_bf16_f32 v176, v160, v161
    v_cvt_pk_bf16_f32 v177, v162, v163
    v_mfma_f32_16x16x32_bf16 v[220:223], a[240:243], a[108:111], v[220:223]
    ds_read_b128 v[160:163], v250
    v_bfe_u32 v250, s66, v233, 4
    v_mfma_f32_16x16x16_bf16 v[152:155], v[46:47], v[136:137], v[152:155]
    v_mad_u32_u24 v250, v250, s40, v231
    v_fma_f32 v164, v164, s37, -v236
    v_mfma_f32_16x16x32_bf16 v[216:219], a[240:243], a[112:115], v[216:219]
    s_waitcnt lgkmcnt(1)
    v_fma_f32 v165, v165, s37, -v236
    v_fma_f32 v166, v166, s37, -v236
    v_mfma_f32_16x16x32_bf16 v[156:159], v[18:21], v[132:135], v[156:159]
    v_fma_f32 v167, v167, s37, -v236
    v_max3_f32 v248, v168, v169, v170
    v_mfma_f32_16x16x32_bf16 v[212:215], a[240:243], a[116:119], v[212:215]
    ds_read_b128 a[240:243], v224 offset:3264
    v_max3_f32 v249, v171, v172, v173
    v_mfma_f32_16x16x32_bf16 v[208:211], a[48:51], a[244:247], v[208:211]
    v_exp_f32 v164, v164
    v_mfma_f32_16x16x16_bf16 v[156:159], v[22:23], v[136:137], v[156:159]
    v_exp_f32 v165, v165
    v_mfma_f32_16x16x32_bf16 v[204:207], a[52:55], a[244:247], v[204:207]
    v_exp_f32 v166, v166
    v_mfma_f32_16x16x32_bf16 v[200:203], a[56:59], a[244:247], v[200:203]
    v_exp_f32 v167, v167
    v_mfma_f32_16x16x32_bf16 v[220:223], a[244:247], a[120:123], v[220:223]
    v_cvt_pk_bf16_f32 v178, v164, v165
    v_cvt_pk_bf16_f32 v179, v166, v167
    v_mfma_f32_16x16x32_bf16 v[216:219], a[244:247], a[124:127], v[216:219]
    ds_read_b128 v[164:167], v235
    v_bfe_u32 v235, s65, v232, 4
    v_mfma_f32_16x16x32_bf16 v[196:199], a[216:219], v[176:179], v[196:199]
    v_mad_u32_u24 v235, v235, s40, v230
    v_max3_f32 v248, v248, v174, v175
    v_mfma_f32_16x16x32_bf16 v[184:187], v[82:85], v[176:179], v[184:187]
    v_max3_f32 v249, v249, v144, v145
    v_max3_f32 v248, v248, v146, v147
    v_mfma_f32_16x16x32_bf16 v[188:191], v[104:107], v[176:179], v[188:191]
    v_max3_f32 v249, v249, v148, v149
    v_max3_f32 v248, v248, v150, v151
    v_mfma_f32_16x16x32_bf16 v[192:195], v[126:129], v[176:179], v[192:195]
    v_rcp_f32 v197, v196
    v_mfma_f32_16x16x32_bf16 v[212:215], a[244:247], a[128:131], v[212:215]
    ds_read_b128 a[244:247], v224 offset:3328
    v_mul_f32 v184, v184, v197
    v_mfma_f32_16x16x32_bf16 v[208:211], a[60:63], v[252:255], v[208:211]
    v_mul_f32 v185, v185, v197
    v_cvt_pk_bf16_f32 v184, v184, v185
    v_mfma_f32_16x16x32_bf16 v[204:207], a[64:67], v[252:255], v[204:207]
    v_mul_f32 v186, v186, v197
    v_mul_f32 v187, v187, v197
    v_mfma_f32_16x16x32_bf16 v[200:203], a[68:71], v[252:255], v[200:203]
    v_cvt_pk_bf16_f32 v185, v186, v187
    v_mul_f32 v188, v188, v197
    v_mfma_f32_16x16x32_bf16 v[220:223], v[252:255], a[132:135], v[220:223]
    v_cvt_pk_bf16_f32 v0, v208, v209
    v_cvt_pk_bf16_f32 v1, v210, v211
    v_mfma_f32_16x16x32_bf16 v[216:219], v[252:255], a[136:139], v[216:219]
    v_cvt_pk_bf16_f32 v2, v204, v205
    v_cvt_pk_bf16_f32 v3, v206, v207
    v_mfma_f32_16x16x32_bf16 v[212:215], v[252:255], a[140:143], v[212:215]
    s_waitcnt lgkmcnt(1)
    v_cvt_pk_bf16_f32 v4, v200, v201
    v_cvt_pk_bf16_f32 v5, v202, v203
    v_mfma_f32_16x16x32_bf16 v[160:163], v[0:3], v[132:135], v[160:163]
    v_cvt_pk_bf16_f32 v66, v220, v221
    v_cvt_pk_bf16_f32 v67, v222, v223
    v_mfma_f32_16x16x32_bf16 v[208:211], a[0:3], a[248:251], 0
    v_cvt_pk_bf16_f32 v88, v216, v217
    v_cvt_pk_bf16_f32 v89, v218, v219
    v_mfma_f32_16x16x32_bf16 v[204:207], a[4:7], a[248:251], 0
    v_cvt_pk_bf16_f32 v110, v212, v213
    v_cvt_pk_bf16_f32 v111, v214, v215
    v_mfma_f32_16x16x16_bf16 v[160:163], v[4:5], v[136:137], v[160:163]
    ds_read_b128 v[252:255], v224 offset:3392
    v_mul_f32 v189, v189, v197
    v_mfma_f32_16x16x32_bf16 v[200:203], a[8:11], a[248:251], 0
    v_cvt_pk_bf16_f32 v186, v188, v189
    v_mul_f32 v190, v190, v197
    v_mfma_f32_16x16x32_bf16 v[220:223], a[248:251], a[72:75], 0
    v_mul_f32 v191, v191, v197
    v_cvt_pk_bf16_f32 v187, v190, v191
    v_mfma_f32_16x16x32_bf16 v[216:219], a[248:251], a[76:79], 0
    v_mul_f32 v192, v192, v197
    v_mul_f32 v193, v193, v197
    v_mfma_f32_16x16x32_bf16 v[212:215], a[248:251], a[80:83], 0
    ds_read_b128 a[248:251], v225 offset:42944
    v_cvt_pk_bf16_f32 v188, v192, v193
    v_mfma_f32_16x16x32_bf16 v[208:211], a[12:15], a[252:255], v[208:211]
    v_mul_f32 v194, v194, v197
    v_mul_f32 v195, v195, v197
    v_mfma_f32_16x16x32_bf16 v[204:207], a[16:19], a[252:255], v[204:207]
    v_cvt_pk_bf16_f32 v189, v194, v195
    v_max3_f32 v249, v249, v152, v153
    v_mfma_f32_16x16x32_bf16 v[200:203], a[20:23], a[252:255], v[200:203]
    ds_write_b128 v237, v[184:187] offset:6144
    v_mfma_f32_16x16x32_bf16 v[220:223], a[252:255], a[84:87], v[220:223]
    ds_write_b64 v238, v[188:189] offset:6144
    v_mfma_f32_16x16x32_bf16 v[216:219], a[252:255], a[88:91], v[216:219]
    v_max3_f32 v248, v248, v154, v155
    v_max3_f32 v249, v249, v156, v157
    v_mfma_f32_16x16x32_bf16 v[212:215], a[252:255], a[92:95], v[212:215]
    ds_read_b128 a[252:255], v225 offset:43008
    v_max3_f32 v248, v248, v158, v159
    v_mfma_f32_16x16x32_bf16 v[208:211], a[24:27], a[236:239], v[208:211]
    v_max3_f32 v249, v249, v160, v161
    v_max3_f32 v248, v248, v162, v163
    v_mfma_f32_16x16x32_bf16 v[204:207], a[28:31], a[236:239], v[204:207]
    v_mfma_f32_16x16x32_bf16 v[200:203], a[32:35], a[236:239], v[200:203]
    v_mfma_f32_16x16x32_bf16 v[220:223], a[236:239], a[96:99], v[220:223]
    v_mfma_f32_16x16x32_bf16 v[216:219], a[236:239], a[100:103], v[216:219]
    v_mfma_f32_16x16x32_bf16 v[212:215], a[236:239], a[104:107], v[212:215]
    ds_read_b128 a[236:239], v225 offset:43072
    v_mfma_f32_16x16x32_bf16 v[208:211], a[36:39], a[240:243], v[208:211]
    v_mfma_f32_16x16x32_bf16 v[204:207], a[40:43], a[240:243], v[204:207]
    v_mfma_f32_16x16x32_bf16 v[200:203], a[44:47], a[240:243], v[200:203]
    v_mfma_f32_16x16x32_bf16 v[220:223], a[240:243], a[108:111], v[220:223]
    v_mfma_f32_16x16x32_bf16 v[216:219], a[240:243], a[112:115], v[216:219]
    v_mfma_f32_16x16x32_bf16 v[212:215], a[240:243], a[116:119], v[212:215]
    s_waitcnt lgkmcnt(1)
    ds_read_b128 a[240:243], v225 offset:43136
    v_mfma_f32_16x16x32_bf16 v[208:211], a[48:51], a[244:247], v[208:211]
    v_mfma_f32_16x16x32_bf16 v[204:207], a[52:55], a[244:247], v[204:207]
    v_mfma_f32_16x16x32_bf16 v[200:203], a[56:59], a[244:247], v[200:203]
    v_mfma_f32_16x16x32_bf16 v[220:223], a[244:247], a[120:123], v[220:223]
    v_mfma_f32_16x16x32_bf16 v[216:219], a[244:247], a[124:127], v[216:219]
    v_mfma_f32_16x16x32_bf16 v[212:215], a[244:247], a[128:131], v[212:215]
    ds_read_b128 a[244:247], v225 offset:43200
    v_mfma_f32_16x16x32_bf16 v[208:211], a[60:63], v[252:255], v[208:211]
    v_mfma_f32_16x16x32_bf16 v[204:207], a[64:67], v[252:255], v[204:207]
    v_mfma_f32_16x16x32_bf16 v[200:203], a[68:71], v[252:255], v[200:203]
    v_mfma_f32_16x16x32_bf16 v[220:223], v[252:255], a[132:135], v[220:223]
    v_mfma_f32_16x16x32_bf16 v[216:219], v[252:255], a[136:139], v[216:219]
    v_mfma_f32_16x16x32_bf16 v[212:215], v[252:255], a[140:143], v[212:215]
    ds_read_b128 v[252:255], v225 offset:43264
    s_nop 1
    v_cvt_pk_bf16_f32 v24, v208, v209
    v_cvt_pk_bf16_f32 v25, v210, v211
    v_mfma_f32_16x16x32_bf16 v[208:211], a[144:147], a[248:251], 0
    v_cvt_pk_bf16_f32 v26, v204, v205
    v_cvt_pk_bf16_f32 v27, v206, v207
    v_mfma_f32_16x16x32_bf16 v[204:207], a[148:151], a[248:251], 0
    v_cvt_pk_bf16_f32 v28, v200, v201
    v_cvt_pk_bf16_f32 v29, v202, v203
    v_mfma_f32_16x16x32_bf16 v[164:167], v[24:27], v[132:135], v[164:167]
    v_cvt_pk_bf16_f32 v68, v220, v221
    v_cvt_pk_bf16_f32 v69, v222, v223
    v_mfma_f32_16x16x32_bf16 v[200:203], a[152:155], a[248:251], 0
    v_cvt_pk_bf16_f32 v90, v216, v217
    v_cvt_pk_bf16_f32 v91, v218, v219
    v_mfma_f32_16x16x32_bf16 v[208:211], a[156:159], a[252:255], v[208:211]
    v_cvt_pk_bf16_f32 v112, v212, v213
    v_cvt_pk_bf16_f32 v113, v214, v215
    v_mfma_f32_16x16x16_bf16 v[164:167], v[28:29], v[136:137], v[164:167]
    s_waitcnt vmcnt(0) lgkmcnt(0)
    ds_read_b128 a[248:251], v226 offset:1152
    v_mfma_f32_16x16x32_bf16 v[204:207], a[160:163], a[252:255], v[204:207]
    s_barrier
    v_mfma_f32_16x16x32_bf16 v[200:203], a[164:167], a[252:255], v[200:203]
    ds_read_b128 a[252:255], v226 offset:1216
    v_mfma_f32_16x16x32_bf16 v[208:211], a[168:171], a[236:239], v[208:211]
    buffer_load_dwordx4 v246, s[4:7], s56 offen lds
    v_mfma_f32_16x16x32_bf16 v[204:207], a[172:175], a[236:239], v[204:207]
    s_add_u32 m0, s42, 0x7900
    v_max3_f32 v249, v249, v164, v165
    v_max3_f32 v248, v248, v166, v167
    v_mfma_f32_16x16x32_bf16 v[200:203], a[176:179], a[236:239], v[200:203]
    ds_read_b128 a[236:239], v226 offset:1280
    v_max_f32 v248, v248, v249
    v_mfma_f32_16x16x32_bf16 v[208:211], a[180:183], a[240:243], v[208:211]
    v_mov_b32 v249, v248
    v_mfma_f32_16x16x32_bf16 v[204:207], a[184:187], a[240:243], v[204:207]
    v_mfma_f32_16x16x32_bf16 v[200:203], a[188:191], a[240:243], v[200:203]
    ds_read_b128 a[240:243], v226 offset:1344
    v_mfma_f32_16x16x32_bf16 v[208:211], a[192:195], a[244:247], v[208:211]
    v_permlane16_swap_b32 v248, v249
    v_mfma_f32_16x16x32_bf16 v[204:207], a[196:199], a[244:247], v[204:207]
    v_max_f32 v248, v248, v249
    v_mov_b32 v249, v248
    v_mfma_f32_16x16x32_bf16 v[200:203], a[200:203], a[244:247], v[200:203]
    ds_read_b128 a[244:247], v226 offset:1408
    v_mfma_f32_16x16x32_bf16 v[208:211], a[204:207], v[252:255], v[208:211]
    buffer_load_dwordx4 v247, s[4:7], s56 offen lds
    v_mfma_f32_16x16x32_bf16 v[204:207], a[208:211], v[252:255], v[204:207]
    s_add_u32 s56, s39, 0x222000
    v_permlane32_swap_b32 v248, v249
    v_mfma_f32_16x16x32_bf16 v[200:203], a[212:215], v[252:255], v[200:203]
    s_add_u32 m0, s41, 0x9740
    ds_read_b128 v[252:255], v226 offset:1472
    v_max_f32 v248, v248, v249
    s_waitcnt lgkmcnt(3)
    v_mfma_f32_16x16x32_bf16 v[220:223], a[144:147], a[248:251], 0
    v_cvt_pk_bf16_f32 v138, v208, v209
    v_cvt_pk_bf16_f32 v139, v210, v211
    v_mfma_f32_16x16x32_bf16 v[216:219], a[148:151], a[248:251], 0
    v_cvt_pk_bf16_f32 v140, v204, v205
    v_cvt_pk_bf16_f32 v141, v206, v207
    v_mfma_f32_16x16x32_bf16 v[212:215], a[152:155], a[248:251], 0
    v_cvt_pk_bf16_f32 v142, v200, v201
    v_cvt_pk_bf16_f32 v143, v202, v203
    v_mfma_f32_16x16x32_bf16 v[220:223], a[156:159], a[252:255], v[220:223]
    ds_read_b128 a[248:251], v227 offset:6144
    v_mul_f32 v236, s37, v248
    v_mfma_f32_16x16x32_bf16 v[216:219], a[160:163], a[252:255], v[216:219]
    v_fma_f32 v168, v168, s37, -v236
    v_fma_f32 v169, v169, s37, -v236
    v_mfma_f32_16x16x32_bf16 v[212:215], a[164:167], a[252:255], v[212:215]
    ds_read_b128 a[252:255], v227 offset:6208
    v_fma_f32 v170, v170, s37, -v236
    v_mfma_f32_16x16x32_bf16 v[220:223], a[168:171], a[236:239], v[220:223]
    buffer_load_dwordx4 v246, s[4:7], s56 offen lds
    v_mfma_f32_16x16x32_bf16 v[216:219], a[172:175], a[236:239], v[216:219]
    s_add_u32 m0, s42, 0x9740
    v_fma_f32 v171, v171, s37, -v236
    v_fma_f32 v172, v172, s37, -v236
    v_mfma_f32_16x16x32_bf16 v[212:215], a[176:179], a[236:239], v[212:215]
    s_waitcnt lgkmcnt(3)
    ds_read_b128 a[236:239], v227 offset:6272
    v_fma_f32 v173, v173, s37, -v236
    v_mfma_f32_16x16x32_bf16 v[220:223], a[180:183], a[240:243], v[220:223]
    v_exp_f32 v168, v168
    v_mfma_f32_16x16x32_bf16 v[216:219], a[184:187], a[240:243], v[216:219]
    v_exp_f32 v169, v169
    v_mfma_f32_16x16x32_bf16 v[212:215], a[188:191], a[240:243], v[212:215]
    ds_read_b128 a[240:243], v227 offset:6336
    v_cvt_pk_bf16_f32 v180, v168, v169
    v_mfma_f32_16x16x32_bf16 v[220:223], a[192:195], a[244:247], v[220:223]
    v_exp_f32 v170, v170
    v_mfma_f32_16x16x32_bf16 v[216:219], a[196:199], a[244:247], v[216:219]
    v_exp_f32 v171, v171
    v_mfma_f32_16x16x32_bf16 v[212:215], a[200:203], a[244:247], v[212:215]
    s_waitcnt lgkmcnt(3)
    ds_read_b128 a[244:247], v227 offset:6400
    v_cvt_pk_bf16_f32 v181, v170, v171
    v_mfma_f32_16x16x32_bf16 v[220:223], a[204:207], v[252:255], v[220:223]
    buffer_load_dwordx4 v247, s[4:7], s56 offen lds
    v_mfma_f32_16x16x32_bf16 v[216:219], a[208:211], v[252:255], v[216:219]
    s_add_u32 s56, s39, 0x24c000
    ds_read_b128 v[168:171], v234
    v_bfe_u32 v234, s67, v233, 4
    v_mfma_f32_16x16x32_bf16 v[212:215], a[212:215], v[252:255], v[212:215]
    s_add_u32 m0, s41, 0xb580
    ds_read_b128 v[252:255], v227 offset:6464
    v_cvt_pk_bf16_f32 v132, v220, v221
    v_mfma_f32_16x16x32_bf16 v[208:211], a[0:3], a[248:251], 0
    v_cvt_pk_bf16_f32 v133, v222, v223
    v_cvt_pk_bf16_f32 v134, v216, v217
    v_mfma_f32_16x16x32_bf16 v[204:207], a[4:7], a[248:251], 0
    v_cvt_pk_bf16_f32 v135, v218, v219
    v_cvt_pk_bf16_f32 v136, v212, v213
    v_mfma_f32_16x16x32_bf16 v[200:203], a[8:11], a[248:251], 0
    v_cvt_pk_bf16_f32 v137, v214, v215
    v_mad_u32_u24 v234, v234, s40, v231
    v_mfma_f32_16x16x32_bf16 v[220:223], a[248:251], a[72:75], 0
    v_fma_f32 v174, v174, s37, -v236
    v_fma_f32 v175, v175, s37, -v236
    v_mfma_f32_16x16x32_bf16 v[216:219], a[248:251], a[76:79], 0
    v_exp_f32 v172, v172
    v_mfma_f32_16x16x32_bf16 v[212:215], a[248:251], a[80:83], 0
    s_waitcnt lgkmcnt(3)
    ds_read_b128 a[248:251], v239
    v_fma_f32 v144, v144, s37, -v236
    v_mfma_f32_16x16x32_bf16 v[208:211], a[12:15], a[252:255], v[208:211]
    v_exp_f32 v173, v173
    v_mfma_f32_16x16x32_bf16 v[204:207], a[16:19], a[252:255], v[204:207]
    s_waitcnt lgkmcnt(2)
    v_exp_f32 v174, v174
    v_mfma_f32_16x16x32_bf16 v[168:171], v[24:27], v[138:141], v[168:171]
    v_exp_f32 v175, v175
    v_mfma_f32_16x16x32_bf16 v[200:203], a[20:23], a[252:255], v[200:203]
    v_cvt_pk_bf16_f32 v182, v172, v173
    v_cvt_pk_bf16_f32 v183, v174, v175
    v_mfma_f32_16x16x32_bf16 v[220:223], a[252:255], a[84:87], v[220:223]
    ds_read_b128 v[172:175], v235
    v_bfe_u32 v235, s68, v233, 4
    v_mfma_f32_16x16x32_bf16 v[196:199], a[216:219], v[180:183], 0
    v_mad_u32_u24 v235, v235, s40, v231
    v_fma_f32 v145, v145, s37, -v236
    v_mfma_f32_16x16x32_bf16 v[184:187], v[70:73], v[180:183], 0
    v_fma_f32 v146, v146, s37, -v236
    v_fma_f32 v147, v147, s37, -v236
    v_mfma_f32_16x16x32_bf16 v[188:191], v[92:95], v[180:183], 0
    v_exp_f32 v144, v144
    v_mfma_f32_16x16x32_bf16 v[192:195], v[114:117], v[180:183], 0
    v_exp_f32 v145, v145
    v_mfma_f32_16x16x16_bf16 v[168:171], v[28:29], v[142:143], v[168:171]
    v_exp_f32 v146, v146
    v_mfma_f32_16x16x32_bf16 v[216:219], a[252:255], a[88:91], v[216:219]
    v_exp_f32 v147, v147
    v_mfma_f32_16x16x32_bf16 v[212:215], a[252:255], a[92:95], v[212:215]
    ds_read_b128 a[252:255], v240
    v_cvt_pk_bf16_f32 v176, v144, v145
    v_mfma_f32_16x16x32_bf16 v[208:211], a[24:27], a[236:239], v[208:211]
    v_cvt_pk_bf16_f32 v177, v146, v147
    v_fma_f32 v148, v148, s37, -v236
    v_mfma_f32_16x16x32_bf16 v[204:207], a[28:31], a[236:239], v[204:207]
    s_waitcnt lgkmcnt(1)
    ds_read_b128 v[144:147], v230 offset:1280
    v_fma_f32 v149, v149, s37, -v236
    v_mfma_f32_16x16x32_bf16 v[172:175], v[30:33], v[138:141], v[172:175]
    v_fma_f32 v150, v150, s37, -v236
    v_fma_f32 v151, v151, s37, -v236
    v_mfma_f32_16x16x32_bf16 v[200:203], a[32:35], a[236:239], v[200:203]
    v_exp_f32 v148, v148
    v_mfma_f32_16x16x32_bf16 v[220:223], a[236:239], a[96:99], v[220:223]
    v_exp_f32 v149, v149
    v_mfma_f32_16x16x16_bf16 v[172:175], v[34:35], v[142:143], v[172:175]
    v_exp_f32 v150, v150
    v_mfma_f32_16x16x32_bf16 v[216:219], a[236:239], a[100:103], v[216:219]
    v_exp_f32 v151, v151
    v_mfma_f32_16x16x32_bf16 v[212:215], a[236:239], a[104:107], v[212:215]
    ds_read_b128 a[236:239], v239 offset:1024
    v_cvt_pk_bf16_f32 v178, v148, v149
    v_mfma_f32_16x16x32_bf16 v[208:211], a[36:39], a[240:243], v[208:211]
    v_cvt_pk_bf16_f32 v179, v150, v151
    v_fma_f32 v152, v152, s37, -v236
    v_mfma_f32_16x16x32_bf16 v[204:207], a[40:43], a[240:243], v[204:207]
    ds_read_b128 v[148:151], v230 offset:1920
    v_fma_f32 v153, v153, s37, -v236
    v_mfma_f32_16x16x32_bf16 v[196:199], a[216:219], v[176:179], v[196:199]
    v_fma_f32 v154, v154, s37, -v236
    v_fma_f32 v155, v155, s37, -v236
    v_mfma_f32_16x16x32_bf16 v[184:187], v[74:77], v[176:179], v[184:187]
    v_exp_f32 v152, v152
    v_mfma_f32_16x16x32_bf16 v[188:191], v[96:99], v[176:179], v[188:191]
    v_exp_f32 v153, v153
    v_mfma_f32_16x16x32_bf16 v[192:195], v[118:121], v[176:179], v[192:195]
    s_waitcnt lgkmcnt(2)
    v_exp_f32 v154, v154
    v_mfma_f32_16x16x32_bf16 v[144:147], v[36:39], v[138:141], v[144:147]
    v_exp_f32 v155, v155
    v_mfma_f32_16x16x32_bf16 v[200:203], a[44:47], a[240:243], v[200:203]
    v_cvt_pk_bf16_f32 v180, v152, v153
    v_cvt_pk_bf16_f32 v181, v154, v155
    v_mfma_f32_16x16x32_bf16 v[220:223], a[240:243], a[108:111], v[220:223]
    ds_read_b128 v[152:155], v250
    v_bfe_u32 v250, s69, v233, 4
    v_mfma_f32_16x16x16_bf16 v[144:147], v[40:41], v[142:143], v[144:147]
    v_mad_u32_u24 v250, v250, s40, v231
    v_fma_f32 v156, v156, s37, -v236
    v_mfma_f32_16x16x32_bf16 v[216:219], a[240:243], a[112:115], v[216:219]
    s_waitcnt lgkmcnt(1)
    v_fma_f32 v157, v157, s37, -v236
    v_fma_f32 v158, v158, s37, -v236
    v_mfma_f32_16x16x32_bf16 v[148:151], v[42:45], v[138:141], v[148:151]
    v_fma_f32 v159, v159, s37, -v236
    v_fma_f32 v160, v160, s37, -v236
    v_mfma_f32_16x16x32_bf16 v[212:215], a[240:243], a[116:119], v[212:215]
    ds_read_b128 a[240:243], v240 offset:1024
    v_fma_f32 v161, v161, s37, -v236
    v_mfma_f32_16x16x32_bf16 v[208:211], a[48:51], a[244:247], v[208:211]
    v_exp_f32 v156, v156
    v_mfma_f32_16x16x16_bf16 v[148:151], v[46:47], v[142:143], v[148:151]
    v_exp_f32 v157, v157
    v_mfma_f32_16x16x32_bf16 v[204:207], a[52:55], a[244:247], v[204:207]
    v_exp_f32 v158, v158
    v_mfma_f32_16x16x32_bf16 v[200:203], a[56:59], a[244:247], v[200:203]
    v_exp_f32 v159, v159
    v_mfma_f32_16x16x32_bf16 v[220:223], a[244:247], a[120:123], v[220:223]
    s_waitcnt lgkmcnt(1)
    v_cvt_pk_bf16_f32 v182, v156, v157
    v_cvt_pk_bf16_f32 v183, v158, v159
    v_mfma_f32_16x16x32_bf16 v[152:155], v[48:51], v[138:141], v[152:155]
    ds_read_b128 v[156:159], v234
    v_bfe_u32 v234, s70, v233, 4
    v_mfma_f32_16x16x32_bf16 v[196:199], a[216:219], v[180:183], v[196:199]
    v_mad_u32_u24 v234, v234, s40, v231
    v_fma_f32 v162, v162, s37, -v236
    v_mfma_f32_16x16x32_bf16 v[184:187], v[78:81], v[180:183], v[184:187]
    v_fma_f32 v163, v163, s37, -v236
    v_fma_f32 v164, v164, s37, -v236
    v_mfma_f32_16x16x32_bf16 v[188:191], v[100:103], v[180:183], v[188:191]
    v_exp_f32 v160, v160
    v_mfma_f32_16x16x32_bf16 v[192:195], v[122:125], v[180:183], v[192:195]
    v_exp_f32 v161, v161
    v_mfma_f32_16x16x16_bf16 v[152:155], v[52:53], v[142:143], v[152:155]
    v_exp_f32 v162, v162
    v_mfma_f32_16x16x32_bf16 v[216:219], a[244:247], a[124:127], v[216:219]
    v_exp_f32 v163, v163
    v_mfma_f32_16x16x32_bf16 v[212:215], a[244:247], a[128:131], v[212:215]
    ds_read_b64_tr_b16 a[244:245], v241 offset:12288
    ds_read_b64_tr_b16 a[246:247], v241 offset:26112
    v_mfma_f32_16x16x32_bf16 v[208:211], a[60:63], v[252:255], v[208:211]
    v_cvt_pk_bf16_f32 v176, v160, v161
    v_cvt_pk_bf16_f32 v177, v162, v163
    v_mfma_f32_16x16x32_bf16 v[204:207], a[64:67], v[252:255], v[204:207]
    s_waitcnt lgkmcnt(2)
    ds_read_b128 v[160:163], v235
    v_bfe_u32 v235, s71, v233, 4
    v_mfma_f32_16x16x32_bf16 v[156:159], v[54:57], v[138:141], v[156:159]
    v_mad_u32_u24 v235, v235, s40, v231
    v_fma_f32 v165, v165, s37, -v236
    v_mfma_f32_16x16x32_bf16 v[200:203], a[68:71], v[252:255], v[200:203]
    v_cvt_pk_bf16_f32 v60, v208, v209
    v_cvt_pk_bf16_f32 v61, v210, v211
    v_mfma_f32_16x16x32_bf16 v[220:223], v[252:255], a[132:135], v[220:223]
    v_cvt_pk_bf16_f32 v62, v204, v205
    v_cvt_pk_bf16_f32 v63, v206, v207
    v_mfma_f32_16x16x16_bf16 v[156:159], v[58:59], v[142:143], v[156:159]
    v_fma_f32 v166, v166, s37, -v236
    v_fma_f32 v167, v167, s37, -v236
    v_mfma_f32_16x16x32_bf16 v[216:219], v[252:255], a[136:139], v[216:219]
    v_cvt_pk_bf16_f32 v64, v200, v201
    v_cvt_pk_bf16_f32 v65, v202, v203
    v_mfma_f32_16x16x32_bf16 v[212:215], v[252:255], a[140:143], v[212:215]
    v_cvt_pk_bf16_f32 v86, v220, v221
    v_cvt_pk_bf16_f32 v87, v222, v223
    v_mfma_f32_16x16x32_bf16 v[208:211], a[220:223], a[248:251], 0
    ds_read_b64_tr_b16 v[252:253], v241 offset:12296
    ds_read_b64_tr_b16 v[254:255], v241 offset:26120
    v_mfma_f32_16x16x32_bf16 v[200:203], a[220:223], a[252:255], 0
    v_cvt_pk_bf16_f32 v108, v216, v217
    v_cvt_pk_bf16_f32 v109, v218, v219
    v_mfma_f32_16x16x32_bf16 v[204:207], a[224:227], a[248:251], 0
    s_waitcnt lgkmcnt(2)
    v_cvt_pk_bf16_f32 v130, v212, v213
    v_cvt_pk_bf16_f32 v131, v214, v215
    v_mfma_f32_16x16x32_bf16 v[160:163], v[60:63], v[138:141], v[160:163]
    v_exp_f32 v164, v164
    v_mfma_f32_16x16x32_bf16 v[220:223], a[224:227], a[252:255], 0
    ds_read_b64_tr_b16 a[252:253], v242 offset:12296
    ds_read_b64_tr_b16 a[254:255], v242 offset:26120
    v_mfma_f32_16x16x32_bf16 v[216:219], a[228:231], a[248:251], 0
    v_exp_f32 v165, v165
    v_mfma_f32_16x16x16_bf16 v[160:163], v[64:65], v[142:143], v[160:163]
    v_exp_f32 v166, v166
    v_mfma_f32_16x16x32_bf16 v[212:215], a[232:235], a[248:251], 0
    ds_read_b64_tr_b16 a[248:249], v242 offset:12288
    ds_read_b64_tr_b16 a[250:251], v242 offset:26112
    v_mfma_f32_16x16x32_bf16 v[208:211], a[244:247], a[236:239], v[208:211]
    v_exp_f32 v167, v167
    v_mfma_f32_16x16x32_bf16 v[200:203], a[244:247], a[240:243], v[200:203]
    s_waitcnt lgkmcnt(4)
    ds_read_b64_tr_b16 a[244:245], v241 offset:13824
    ds_read_b64_tr_b16 a[246:247], v241 offset:24576
    v_mfma_f32_16x16x32_bf16 v[204:207], v[252:255], a[236:239], v[204:207]
    v_cvt_pk_bf16_f32 v178, v164, v165
    v_cvt_pk_bf16_f32 v179, v166, v167
    v_mfma_f32_16x16x32_bf16 v[220:223], v[252:255], a[240:243], v[220:223]
    ds_read_b128 a[240:243], v240 offset:2048
    ds_read_b64_tr_b16 v[252:253], v241 offset:13832
    v_mfma_f32_16x16x32_bf16 v[196:199], a[216:219], v[176:179], v[196:199]
    ds_read_b64_tr_b16 v[254:255], v241 offset:24584
    ds_read_b128 v[164:167], v228 offset:640
    v_mfma_f32_16x16x32_bf16 v[184:187], v[66:69], v[176:179], v[184:187]
    v_max3_f32 v248, v168, v169, v170
    v_max3_f32 v249, v171, v172, v173
    v_mfma_f32_16x16x32_bf16 v[188:191], v[88:91], v[176:179], v[188:191]
    v_max3_f32 v248, v248, v174, v175
    v_max3_f32 v249, v249, v144, v145
    v_mfma_f32_16x16x32_bf16 v[192:195], v[110:113], v[176:179], v[192:195]
    s_waitcnt lgkmcnt(8)
    v_rcp_f32 v197, v196
    v_mfma_f32_16x16x32_bf16 v[212:215], a[252:255], a[236:239], v[212:215]
    s_waitcnt lgkmcnt(6)
    ds_read_b64_tr_b16 a[252:253], v242 offset:13832
    ds_read_b64_tr_b16 a[254:255], v242 offset:24584
    v_mfma_f32_16x16x32_bf16 v[216:219], a[248:251], a[236:239], v[216:219]
    s_waitcnt lgkmcnt(5)
    ds_read_b128 a[236:239], v239 offset:2048
    ds_read_b64_tr_b16 a[248:249], v242 offset:13824
    v_mul_f32 v184, v184, v197
    v_mul_f32 v185, v185, v197
    ds_read_b64_tr_b16 a[250:251], v242 offset:24576
    v_cvt_pk_bf16_f32 v184, v184, v185
    v_mfma_f32_16x16x32_bf16 v[200:203], a[244:247], a[240:243], v[200:203]
    s_waitcnt lgkmcnt(6)
    v_mul_f32 v186, v186, v197
    v_mul_f32 v187, v187, v197
    v_cvt_pk_bf16_f32 v185, v186, v187
    v_mul_f32 v188, v188, v197
    v_mul_f32 v189, v189, v197
    v_cvt_pk_bf16_f32 v186, v188, v189
    v_mfma_f32_16x16x32_bf16 v[220:223], v[252:255], a[240:243], v[220:223]
    s_waitcnt lgkmcnt(5)
    ds_read_b128 a[240:243], v240 offset:3072
    v_mul_f32 v190, v190, v197
    v_mul_f32 v191, v191, v197
    v_cvt_pk_bf16_f32 v187, v190, v191
    v_mul_f32 v192, v192, v197
    v_mul_f32 v193, v193, v197
    v_mfma_f32_16x16x32_bf16 v[164:167], v[12:15], v[132:135], v[164:167]
    s_waitcnt lgkmcnt(3)
    v_cvt_pk_bf16_f32 v188, v192, v193
    v_mul_f32 v194, v194, v197
    v_mul_f32 v195, v195, v197
    v_cvt_pk_bf16_f32 v189, v194, v195
    ds_write_b128 v237, v[184:187] offset:12288
    v_mfma_f32_16x16x32_bf16 v[208:211], a[244:247], a[236:239], v[208:211]
    ds_read_b64_tr_b16 a[244:245], v241 offset:36864
    ds_read_b64_tr_b16 a[246:247], v241 offset:38400
    v_mfma_f32_16x16x16_bf16 v[164:167], v[16:17], v[136:137], v[164:167]
    ds_write_b64 v238, v[188:189] offset:12288
    v_mfma_f32_16x16x32_bf16 v[204:207], v[252:255], a[236:239], v[204:207]
    s_waitcnt lgkmcnt(5)
    ds_read_b64_tr_b16 v[252:253], v241 offset:36872
    ds_read_b64_tr_b16 v[254:255], v241 offset:38408
    v_mfma_f32_16x16x32_bf16 v[216:219], a[248:251], a[236:239], v[216:219]
    ds_read_b64_tr_b16 a[248:249], v242 offset:36864
    v_max3_f32 v248, v248, v146, v147
    v_mfma_f32_16x16x32_bf16 v[212:215], a[252:255], a[236:239], v[212:215]
    s_waitcnt lgkmcnt(1)
    ds_read_b128 a[236:239], v239 offset:3072
    v_max3_f32 v249, v249, v148, v149
    v_max3_f32 v248, v248, v150, v151
    v_max3_f32 v249, v249, v152, v153
    ds_read_b64_tr_b16 a[250:251], v242 offset:38400
    v_max3_f32 v248, v248, v154, v155
    ds_read_b64_tr_b16 a[252:253], v242 offset:36872
    v_max3_f32 v249, v249, v156, v157
    ds_read_b64_tr_b16 a[254:255], v242 offset:38408
    v_max3_f32 v248, v248, v158, v159
    v_max3_f32 v249, v249, v160, v161
    v_max3_f32 v248, v248, v162, v163
    v_max_f32 v248, v248, v249
    v_mov_b32 v249, v248
    v_mfma_f32_16x16x32_bf16 v[200:203], a[244:247], a[240:243], v[200:203]
    s_nop 0
    v_permlane16_swap_b32 v248, v249
    v_max_f32 v248, v248, v249
    v_mov_b32 v249, v248
    s_nop 1
    v_permlane32_swap_b32 v248, v249
    v_mfma_f32_16x16x32_bf16 v[220:223], v[252:255], a[240:243], v[220:223]
    s_waitcnt lgkmcnt(3)
    ds_read_b128 a[240:243], v240 offset:4096
    v_max_f32 v248, v248, v249
    v_mul_f32 v236, s37, v248
    v_fma_f32 v168, v168, s37, -v236
    v_fma_f32 v169, v169, s37, -v236
    v_mfma_f32_16x16x32_bf16 v[208:211], a[244:247], a[236:239], v[208:211]
    ds_read_b64_tr_b16 a[244:245], v241 offset:49152
    ds_read_b64_tr_b16 a[246:247], v241 offset:62976
    v_mfma_f32_16x16x32_bf16 v[204:207], v[252:255], a[236:239], v[204:207]
    s_waitcnt lgkmcnt(5)
    ds_read_b64_tr_b16 v[252:253], v241 offset:49160
    ds_read_b64_tr_b16 v[254:255], v241 offset:62984
    v_mfma_f32_16x16x32_bf16 v[216:219], a[248:251], a[236:239], v[216:219]
    s_waitcnt lgkmcnt(5)
    ds_read_b64_tr_b16 a[248:249], v242 offset:49152
    v_fma_f32 v170, v170, s37, -v236
    v_mfma_f32_16x16x32_bf16 v[212:215], a[252:255], a[236:239], v[212:215]
    s_waitcnt lgkmcnt(3)
    ds_read_b128 a[236:239], v239 offset:4096
    v_fma_f32 v171, v171, s37, -v236
    v_exp_f32 v168, v168
    ds_read_b64_tr_b16 a[250:251], v242 offset:62976
    v_exp_f32 v169, v169
    ds_read_b64_tr_b16 a[252:253], v242 offset:49160
    ds_read_b64_tr_b16 a[254:255], v242 offset:62984
    v_exp_f32 v170, v170
    v_exp_f32 v171, v171
    v_cvt_pk_bf16_f32 v180, v168, v169
    v_cvt_pk_bf16_f32 v181, v170, v171
    ds_read_b128 v[168:171], v229 offset:640
    v_fma_f32 v172, v172, s37, -v236
    v_fma_f32 v173, v173, s37, -v236
    v_mfma_f32_16x16x32_bf16 v[200:203], a[244:247], a[240:243], v[200:203]
    s_waitcnt lgkmcnt(6)
    v_fma_f32 v174, v174, s37, -v236
    v_fma_f32 v175, v175, s37, -v236
    v_exp_f32 v172, v172
    v_exp_f32 v173, v173
    v_mfma_f32_16x16x32_bf16 v[220:223], v[252:255], a[240:243], v[220:223]
    s_waitcnt lgkmcnt(4)
    ds_read_b128 a[240:243], v240 offset:5120
    v_exp_f32 v174, v174
    v_exp_f32 v175, v175
    v_cvt_pk_bf16_f32 v182, v172, v173
    v_mfma_f32_16x16x32_bf16 v[208:211], a[244:247], a[236:239], v[208:211]
    ds_read_b64_tr_b16 a[244:245], v241 offset:50688
    ds_read_b64_tr_b16 a[246:247], v241 offset:61440
    v_mfma_f32_16x16x32_bf16 v[204:207], v[252:255], a[236:239], v[204:207]
    s_waitcnt lgkmcnt(6)
    ds_read_b64_tr_b16 v[252:253], v241 offset:50696
    ds_read_b64_tr_b16 v[254:255], v241 offset:61448
    v_mfma_f32_16x16x32_bf16 v[216:219], a[248:251], a[236:239], v[216:219]
    s_waitcnt lgkmcnt(6)
    ds_read_b64_tr_b16 a[248:249], v242 offset:50688
    v_cvt_pk_bf16_f32 v183, v174, v175
    v_mfma_f32_16x16x32_bf16 v[212:215], a[252:255], a[236:239], v[212:215]
    ds_read_b128 a[236:239], v239 offset:5120
    v_fma_f32 v144, v144, s37, -v236
    v_mfma_f32_16x16x32_bf16 v[196:199], a[216:219], v[180:183], 0
    ds_read_b64_tr_b16 a[250:251], v242 offset:61440
    v_fma_f32 v145, v145, s37, -v236
    v_mfma_f32_16x16x32_bf16 v[184:187], v[68:71], v[180:183], 0
    ds_read_b64_tr_b16 a[252:253], v242 offset:50696
    v_fma_f32 v146, v146, s37, -v236
    v_mfma_f32_16x16x32_bf16 v[188:191], v[90:93], v[180:183], 0
    ds_read_b64_tr_b16 a[254:255], v242 offset:61448
    v_fma_f32 v147, v147, s37, -v236
    v_mfma_f32_16x16x32_bf16 v[192:195], v[112:115], v[180:183], 0
    s_waitcnt lgkmcnt(10)
    ds_read_b128 v[172:175], v229 offset:1280
    v_fma_f32 v148, v148, s37, -v236
    v_mfma_f32_16x16x32_bf16 v[168:171], v[36:39], v[132:135], v[168:171]
    s_waitcnt lgkmcnt(8)
    v_exp_f32 v144, v144
    v_exp_f32 v145, v145
    v_mfma_f32_16x16x32_bf16 v[200:203], a[244:247], a[240:243], v[200:203]
    v_exp_f32 v146, v146
    v_exp_f32 v147, v147
    v_cvt_pk_bf16_f32 v176, v144, v145
    v_mfma_f32_16x16x16_bf16 v[168:171], v[40:41], v[136:137], v[168:171]
    s_waitcnt lgkmcnt(6)
    v_cvt_pk_bf16_f32 v177, v146, v147
    v_fma_f32 v149, v149, s37, -v236
    v_mfma_f32_16x16x32_bf16 v[220:223], v[252:255], a[240:243], v[220:223]
    s_waitcnt lgkmcnt(4)
    ds_read_b128 a[240:243], v224 offset:15552
    v_cvt_pk_bf16_f32 v200, v200, v201
    v_cvt_pk_bf16_f32 v201, v202, v203
    v_mfma_f32_16x16x32_bf16 v[208:211], a[244:247], a[236:239], v[208:211]
    ds_read_b128 a[244:247], v224 offset:15616
    ds_read_b128 v[144:147], v228 offset:1280
    v_mfma_f32_16x16x32_bf16 v[204:207], v[252:255], a[236:239], v[204:207]
    s_waitcnt lgkmcnt(6)
    ds_read_b128 v[252:255], v224 offset:15680
    v_cvt_pk_bf16_f32 v202, v220, v221
    v_mfma_f32_16x16x32_bf16 v[216:219], a[248:251], a[236:239], v[216:219]
    s_waitcnt lgkmcnt(5)
    ds_read_b128 a[248:251], v224 offset:15744
    v_cvt_pk_bf16_f32 v203, v222, v223
    v_mfma_f32_16x16x32_bf16 v[212:215], a[252:255], a[236:239], v[212:215]
    s_waitcnt lgkmcnt(5)
    ds_read_b128 a[236:239], v224 offset:15488
    v_cvt_pk_bf16_f32 v208, v208, v209
    v_cvt_pk_bf16_f32 v209, v210, v211
    v_cvt_pk_bf16_f32 v210, v204, v205
    ds_read_b128 a[252:255], v224 offset:15808
    v_mfma_f32_16x16x32_bf16 v[172:175], v[42:45], v[132:135], v[172:175]
    v_cvt_pk_bf16_f32 v211, v206, v207
    v_cvt_pk_bf16_f32 v216, v216, v217
    buffer_store_dwordx4 v[208:211], v243, s[20:23], s58 offen sc0 sc1
    v_cvt_pk_bf16_f32 v217, v218, v219
    v_cvt_pk_bf16_f32 v218, v212, v213
    v_cvt_pk_bf16_f32 v219, v214, v215
    v_mfma_f32_16x16x16_bf16 v[172:175], v[46:47], v[136:137], v[172:175]
    s_waitcnt lgkmcnt(4)
    v_fma_f32 v150, v150, s37, -v236
    v_fma_f32 v151, v151, s37, -v236
    v_exp_f32 v148, v148
    v_exp_f32 v149, v149
    v_mfma_f32_16x16x32_bf16 v[144:147], v[18:21], v[132:135], v[144:147]
    s_waitcnt lgkmcnt(1)
    v_exp_f32 v150, v150
    v_exp_f32 v151, v151
    v_cvt_pk_bf16_f32 v178, v148, v149
    v_cvt_pk_bf16_f32 v179, v150, v151
    ds_read_b128 v[148:151], v228 offset:1920
    v_mfma_f32_16x16x32_bf16 v[208:211], a[0:3], a[236:239], 0
    v_fma_f32 v152, v152, s37, -v236
    v_fma_f32 v153, v153, s37, -v236
    v_mfma_f32_16x16x32_bf16 v[196:199], a[216:219], v[176:179], v[196:199]
    v_fma_f32 v154, v154, s37, -v236
    v_fma_f32 v155, v155, s37, -v236
    v_mfma_f32_16x16x32_bf16 v[184:187], v[76:79], v[176:179], v[184:187]
    v_exp_f32 v152, v152
    v_mfma_f32_16x16x32_bf16 v[188:191], v[98:101], v[176:179], v[188:191]
    v_exp_f32 v153, v153
    v_mfma_f32_16x16x32_bf16 v[192:195], v[120:123], v[176:179], v[192:195]
    v_exp_f32 v154, v154
    v_mfma_f32_16x16x16_bf16 v[144:147], v[22:23], v[136:137], v[144:147]
    buffer_store_dwordx4 v[200:203], v245, s[20:23], s58 offen sc0 sc1
    v_mfma_f32_16x16x32_bf16 v[204:207], a[4:7], a[236:239], 0
    v_exp_f32 v155, v155
    v_mfma_f32_16x16x32_bf16 v[200:203], a[8:11], a[236:239], 0
    s_waitcnt lgkmcnt(0)
    v_cvt_pk_bf16_f32 v180, v152, v153
    v_cvt_pk_bf16_f32 v181, v154, v155
    v_mfma_f32_16x16x32_bf16 v[148:151], v[0:3], v[132:135], v[148:151]
    ds_read_b128 v[152:155], v229 offset:1920
    v_fma_f32 v156, v156, s37, -v236
    v_mfma_f32_16x16x32_bf16 v[220:223], a[236:239], a[72:75], 0
    v_fma_f32 v157, v157, s37, -v236
    v_fma_f32 v158, v158, s37, -v236
    v_mfma_f32_16x16x32_bf16 v[212:215], a[236:239], a[80:83], 0
    v_fma_f32 v159, v159, s37, -v236
    v_fma_f32 v160, v160, s37, -v236
    v_mfma_f32_16x16x16_bf16 v[148:151], v[4:5], v[136:137], v[148:151]
    v_exp_f32 v156, v156
    v_mfma_f32_16x16x32_bf16 v[208:211], a[12:15], a[240:243], v[208:211]
    v_exp_f32 v157, v157
    v_mfma_f32_16x16x32_bf16 v[204:207], a[16:19], a[240:243], v[204:207]
    v_exp_f32 v158, v158
    v_mfma_f32_16x16x32_bf16 v[200:203], a[20:23], a[240:243], v[200:203]
    v_exp_f32 v159, v159
    v_mfma_f32_16x16x32_bf16 v[220:223], a[240:243], a[84:87], v[220:223]
    v_cvt_pk_bf16_f32 v182, v156, v157
    v_cvt_pk_bf16_f32 v183, v158, v159
    v_mfma_f32_16x16x32_bf16 v[212:215], a[240:243], a[92:95], v[212:215]
    ds_read_b128 v[156:159], v229 offset:2560
    v_fma_f32 v161, v161, s37, -v236
    v_mfma_f32_16x16x32_bf16 v[196:199], a[216:219], v[180:183], v[196:199]
    buffer_store_dwordx4 v[216:219], v244, s[20:23], s58 offen sc0 sc1
    v_mfma_f32_16x16x32_bf16 v[184:187], v[82:85], v[180:183], v[184:187]
    s_add_u32 s58, s51, 0x54000
    v_fma_f32 v162, v162, s37, -v236
    v_fma_f32 v163, v163, s37, -v236
    v_mfma_f32_16x16x32_bf16 v[188:191], v[104:107], v[180:183], v[188:191]
    v_exp_f32 v160, v160
    v_mfma_f32_16x16x32_bf16 v[192:195], v[126:129], v[180:183], v[192:195]
    s_waitcnt lgkmcnt(1)
    v_exp_f32 v161, v161
    v_mfma_f32_16x16x32_bf16 v[152:155], v[24:27], v[132:135], v[152:155]
    v_exp_f32 v162, v162
    v_mfma_f32_16x16x32_bf16 v[216:219], a[236:239], a[76:79], 0
    ds_read_b128 a[236:239], v224 offset:18560
    v_cvt_pk_bf16_f32 v176, v160, v161
    v_mfma_f32_16x16x32_bf16 v[216:219], a[240:243], a[88:91], v[216:219]
    ds_read_b128 a[240:243], v224 offset:18624
    v_max3_f32 v248, v164, v165, v166
    v_mfma_f32_16x16x16_bf16 v[152:155], v[28:29], v[136:137], v[152:155]
    v_exp_f32 v163, v163
    v_mfma_f32_16x16x32_bf16 v[208:211], a[24:27], a[244:247], v[208:211]
    v_cvt_pk_bf16_f32 v177, v162, v163
    v_max3_f32 v249, v167, v168, v169
    v_mfma_f32_16x16x32_bf16 v[204:207], a[28:31], a[244:247], v[204:207]
    ds_read_b128 v[160:163], v228 offset:2560
    v_max3_f32 v248, v248, v170, v171
    v_mfma_f32_16x16x16_bf16 v[196:199], a[216:217], v[176:177], v[196:199]
    v_max3_f32 v249, v249, v172, v173
    v_max3_f32 v248, v248, v174, v175
    v_mfma_f32_16x16x16_bf16 v[184:187], v[86:87], v[176:177], v[184:187]
    v_max3_f32 v249, v249, v144, v145
    v_max3_f32 v248, v248, v146, v147
    v_mfma_f32_16x16x16_bf16 v[188:191], v[108:109], v[176:177], v[188:191]
    v_max3_f32 v249, v249, v148, v149
    v_max3_f32 v248, v248, v150, v151
    v_mfma_f32_16x16x16_bf16 v[192:195], v[130:131], v[176:177], v[192:195]
    v_rcp_f32 v197, v196
    v_mfma_f32_16x16x32_bf16 v[200:203], a[32:35], a[244:247], v[200:203]
    v_mul_f32 v184, v184, v197
    v_mul_f32 v185, v185, v197
    v_mfma_f32_16x16x32_bf16 v[220:223], a[244:247], a[96:99], v[220:223]
    v_cvt_pk_bf16_f32 v184, v184, v185
    v_mul_f32 v186, v186, v197
    v_mfma_f32_16x16x32_bf16 v[216:219], a[244:247], a[100:103], v[216:219]
    v_mul_f32 v187, v187, v197
    v_cvt_pk_bf16_f32 v185, v186, v187
    v_mfma_f32_16x16x32_bf16 v[212:215], a[244:247], a[104:107], v[212:215]
    ds_read_b128 a[244:247], v224 offset:18688
    v_mul_f32 v188, v188, v197
    v_mfma_f32_16x16x32_bf16 v[208:211], a[36:39], v[252:255], v[208:211]
    v_mul_f32 v189, v189, v197
    v_cvt_pk_bf16_f32 v186, v188, v189
    v_mfma_f32_16x16x32_bf16 v[204:207], a[40:43], v[252:255], v[204:207]
    v_mul_f32 v190, v190, v197
    v_mul_f32 v191, v191, v197
    v_mfma_f32_16x16x32_bf16 v[200:203], a[44:47], v[252:255], v[200:203]
    v_cvt_pk_bf16_f32 v187, v190, v191
    v_mul_f32 v192, v192, v197
    v_mfma_f32_16x16x32_bf16 v[220:223], v[252:255], a[108:111], v[220:223]
    v_mul_f32 v193, v193, v197
    v_cvt_pk_bf16_f32 v188, v192, v193
    v_mfma_f32_16x16x32_bf16 v[216:219], v[252:255], a[112:115], v[216:219]
    v_mul_f32 v194, v194, v197
    v_mul_f32 v195, v195, v197
    v_mfma_f32_16x16x32_bf16 v[212:215], v[252:255], a[116:119], v[212:215]
    ds_read_b128 v[252:255], v224 offset:18752
    v_cvt_pk_bf16_f32 v189, v194, v195
    v_mfma_f32_16x16x32_bf16 v[208:211], a[48:51], a[248:251], v[208:211]
    ds_write_b128 v237, v[184:187] offset:18432
    v_mfma_f32_16x16x32_bf16 v[204:207], a[52:55], a[248:251], v[204:207]
    ds_write_b64 v238, v[188:189] offset:18432
    v_mfma_f32_16x16x32_bf16 v[200:203], a[56:59], a[248:251], v[200:203]
    v_max3_f32 v249, v249, v152, v153
    v_max3_f32 v248, v248, v154, v155
    v_mfma_f32_16x16x32_bf16 v[220:223], a[248:251], a[120:123], v[220:223]
    v_mfma_f32_16x16x32_bf16 v[216:219], a[248:251], a[124:127], v[216:219]
    v_mfma_f32_16x16x32_bf16 v[212:215], a[248:251], a[128:131], v[212:215]
    ds_read_b128 a[248:251], v224 offset:18816
    v_mfma_f32_16x16x32_bf16 v[208:211], a[60:63], a[252:255], v[208:211]
    v_mfma_f32_16x16x32_bf16 v[204:207], a[64:67], a[252:255], v[204:207]
    v_mfma_f32_16x16x32_bf16 v[200:203], a[68:71], a[252:255], v[200:203]
    v_mfma_f32_16x16x32_bf16 v[220:223], a[252:255], a[132:135], v[220:223]
    v_mfma_f32_16x16x32_bf16 v[216:219], a[252:255], a[136:139], v[216:219]
    v_mfma_f32_16x16x32_bf16 v[212:215], a[252:255], a[140:143], v[212:215]
    s_waitcnt lgkmcnt(1)
    ds_read_b128 a[252:255], v224 offset:18880
    s_nop 1
    v_cvt_pk_bf16_f32 v6, v208, v209
    v_cvt_pk_bf16_f32 v7, v210, v211
    v_mfma_f32_16x16x32_bf16 v[208:211], a[0:3], a[236:239], 0
    v_cvt_pk_bf16_f32 v8, v204, v205
    v_cvt_pk_bf16_f32 v9, v206, v207
    v_mfma_f32_16x16x32_bf16 v[204:207], a[4:7], a[236:239], 0
    v_cvt_pk_bf16_f32 v10, v200, v201
    v_cvt_pk_bf16_f32 v11, v202, v203
    v_mfma_f32_16x16x32_bf16 v[160:163], v[6:9], v[132:135], v[160:163]
    v_cvt_pk_bf16_f32 v72, v220, v221
    v_cvt_pk_bf16_f32 v73, v222, v223
    v_mfma_f32_16x16x32_bf16 v[200:203], a[8:11], a[236:239], 0
    v_cvt_pk_bf16_f32 v94, v216, v217
    v_cvt_pk_bf16_f32 v95, v218, v219
    v_mfma_f32_16x16x32_bf16 v[220:223], a[236:239], a[72:75], 0
    v_cvt_pk_bf16_f32 v116, v212, v213
    v_cvt_pk_bf16_f32 v117, v214, v215
    v_mfma_f32_16x16x16_bf16 v[160:163], v[10:11], v[136:137], v[160:163]
    v_mfma_f32_16x16x32_bf16 v[216:219], a[236:239], a[76:79], 0
    v_mfma_f32_16x16x32_bf16 v[212:215], a[236:239], a[80:83], 0
    ds_read_b128 a[236:239], v226 offset:4224
    v_mfma_f32_16x16x32_bf16 v[208:211], a[12:15], a[240:243], v[208:211]
    v_mfma_f32_16x16x32_bf16 v[204:207], a[16:19], a[240:243], v[204:207]
    v_mfma_f32_16x16x32_bf16 v[200:203], a[20:23], a[240:243], v[200:203]
    v_mfma_f32_16x16x32_bf16 v[220:223], a[240:243], a[84:87], v[220:223]
    v_mfma_f32_16x16x32_bf16 v[216:219], a[240:243], a[88:91], v[216:219]
    v_mfma_f32_16x16x32_bf16 v[212:215], a[240:243], a[92:95], v[212:215]
    ds_read_b128 a[240:243], v226 offset:4288
    v_mfma_f32_16x16x32_bf16 v[208:211], a[24:27], a[244:247], v[208:211]
    v_mfma_f32_16x16x32_bf16 v[204:207], a[28:31], a[244:247], v[204:207]
    v_mfma_f32_16x16x32_bf16 v[200:203], a[32:35], a[244:247], v[200:203]
    v_mfma_f32_16x16x32_bf16 v[220:223], a[244:247], a[96:99], v[220:223]
    v_mfma_f32_16x16x32_bf16 v[216:219], a[244:247], a[100:103], v[216:219]
    v_mfma_f32_16x16x32_bf16 v[212:215], a[244:247], a[104:107], v[212:215]
    ds_read_b128 a[244:247], v226 offset:4352
    v_mfma_f32_16x16x32_bf16 v[208:211], a[36:39], v[252:255], v[208:211]
    v_mfma_f32_16x16x32_bf16 v[204:207], a[40:43], v[252:255], v[204:207]
    v_mfma_f32_16x16x32_bf16 v[200:203], a[44:47], v[252:255], v[200:203]
    v_mfma_f32_16x16x32_bf16 v[220:223], v[252:255], a[108:111], v[220:223]
    v_mfma_f32_16x16x32_bf16 v[216:219], v[252:255], a[112:115], v[216:219]
    v_mfma_f32_16x16x32_bf16 v[212:215], v[252:255], a[116:119], v[212:215]
    s_waitcnt lgkmcnt(1)
    ds_read_b128 v[252:255], v226 offset:4416
    v_mfma_f32_16x16x32_bf16 v[208:211], a[48:51], a[248:251], v[208:211]
    v_mfma_f32_16x16x32_bf16 v[204:207], a[52:55], a[248:251], v[204:207]
    v_mfma_f32_16x16x32_bf16 v[200:203], a[56:59], a[248:251], v[200:203]
    v_mfma_f32_16x16x32_bf16 v[220:223], a[248:251], a[120:123], v[220:223]
    v_mfma_f32_16x16x32_bf16 v[216:219], a[248:251], a[124:127], v[216:219]
    v_mfma_f32_16x16x32_bf16 v[212:215], a[248:251], a[128:131], v[212:215]
    ds_read_b128 a[248:251], v226 offset:4480
    v_mfma_f32_16x16x32_bf16 v[208:211], a[60:63], a[252:255], v[208:211]
    v_mfma_f32_16x16x32_bf16 v[204:207], a[64:67], a[252:255], v[204:207]
    v_mfma_f32_16x16x32_bf16 v[200:203], a[68:71], a[252:255], v[200:203]
    v_mfma_f32_16x16x32_bf16 v[220:223], a[252:255], a[132:135], v[220:223]
    v_mfma_f32_16x16x32_bf16 v[216:219], a[252:255], a[136:139], v[216:219]
    v_mfma_f32_16x16x32_bf16 v[212:215], a[252:255], a[140:143], v[212:215]
    ds_read_b128 a[252:255], v226 offset:4544
    s_nop 1
    v_cvt_pk_bf16_f32 v30, v208, v209
    v_cvt_pk_bf16_f32 v31, v210, v211
    v_mfma_f32_16x16x32_bf16 v[208:211], a[144:147], a[236:239], 0
    v_cvt_pk_bf16_f32 v32, v204, v205
    v_cvt_pk_bf16_f32 v33, v206, v207
    v_mfma_f32_16x16x32_bf16 v[204:207], a[148:151], a[236:239], 0
    v_cvt_pk_bf16_f32 v34, v200, v201
    v_cvt_pk_bf16_f32 v35, v202, v203
    v_mfma_f32_16x16x32_bf16 v[156:159], v[30:33], v[132:135], v[156:159]
    v_cvt_pk_bf16_f32 v70, v220, v221
    v_cvt_pk_bf16_f32 v71, v222, v223
    v_mfma_f32_16x16x32_bf16 v[200:203], a[152:155], a[236:239], 0
    v_cvt_pk_bf16_f32 v92, v216, v217
    v_cvt_pk_bf16_f32 v93, v218, v219
    v_mfma_f32_16x16x32_bf16 v[208:211], a[156:159], a[240:243], v[208:211]
    v_cvt_pk_bf16_f32 v114, v212, v213
    v_cvt_pk_bf16_f32 v115, v214, v215
    v_mfma_f32_16x16x16_bf16 v[156:159], v[34:35], v[136:137], v[156:159]
    s_waitcnt vmcnt(3) lgkmcnt(0)
    ds_read_b128 a[236:239], v225 offset:8896
    v_mfma_f32_16x16x32_bf16 v[204:207], a[160:163], a[240:243], v[204:207]
    s_barrier
    v_mfma_f32_16x16x32_bf16 v[200:203], a[164:167], a[240:243], v[200:203]
    ds_read_b128 a[240:243], v225 offset:8960
    v_mfma_f32_16x16x32_bf16 v[208:211], a[168:171], a[244:247], v[208:211]
    buffer_load_dwordx4 v246, s[4:7], s56 offen lds
    v_mfma_f32_16x16x32_bf16 v[204:207], a[172:175], a[244:247], v[204:207]
    s_add_u32 m0, s42, 0xb580
    v_max3_f32 v249, v249, v156, v157
    v_max3_f32 v248, v248, v158, v159
    v_mfma_f32_16x16x32_bf16 v[200:203], a[176:179], a[244:247], v[200:203]
    ds_read_b128 a[244:247], v225 offset:9024
    v_max3_f32 v249, v249, v160, v161
    v_mfma_f32_16x16x32_bf16 v[208:211], a[180:183], v[252:255], v[208:211]
    v_max3_f32 v248, v248, v162, v163
    v_max_f32 v248, v248, v249
    v_mfma_f32_16x16x32_bf16 v[204:207], a[184:187], v[252:255], v[204:207]
    v_mov_b32 v249, v248
    v_mfma_f32_16x16x32_bf16 v[200:203], a[188:191], v[252:255], v[200:203]
    ds_read_b128 v[252:255], v225 offset:9088
    v_mfma_f32_16x16x32_bf16 v[208:211], a[192:195], a[248:251], v[208:211]
    v_permlane16_swap_b32 v248, v249
    v_mfma_f32_16x16x32_bf16 v[204:207], a[196:199], a[248:251], v[204:207]
    v_max_f32 v248, v248, v249
    v_mov_b32 v249, v248
    v_mfma_f32_16x16x32_bf16 v[200:203], a[200:203], a[248:251], v[200:203]
    ds_read_b128 a[248:251], v225 offset:9152
    v_mfma_f32_16x16x32_bf16 v[208:211], a[204:207], a[252:255], v[208:211]
    buffer_load_dwordx4 v247, s[4:7], s56 offen lds
    v_mfma_f32_16x16x32_bf16 v[204:207], a[208:211], a[252:255], v[204:207]
    s_add_u32 s56, s39, 0x276000
    v_permlane32_swap_b32 v248, v249
    v_mfma_f32_16x16x32_bf16 v[200:203], a[212:215], a[252:255], v[200:203]
    s_add_u32 m0, s41, 0xd3c0
    ds_read_b128 a[252:255], v225 offset:9216
    v_max_f32 v248, v248, v249
    s_waitcnt lgkmcnt(3)
    v_mfma_f32_16x16x32_bf16 v[220:223], a[144:147], a[236:239], 0
    v_cvt_pk_bf16_f32 v138, v208, v209
    v_cvt_pk_bf16_f32 v139, v210, v211
    v_mfma_f32_16x16x32_bf16 v[216:219], a[148:151], a[236:239], 0
    v_cvt_pk_bf16_f32 v140, v204, v205
    v_cvt_pk_bf16_f32 v141, v206, v207
    v_mfma_f32_16x16x32_bf16 v[212:215], a[152:155], a[236:239], 0
    v_cvt_pk_bf16_f32 v142, v200, v201
    v_cvt_pk_bf16_f32 v143, v202, v203
    v_mfma_f32_16x16x32_bf16 v[220:223], a[156:159], a[240:243], v[220:223]
    ds_read_b128 a[236:239], v239 offset:12288
    v_mul_f32 v236, s37, v248
    v_mfma_f32_16x16x32_bf16 v[216:219], a[160:163], a[240:243], v[216:219]
    v_fma_f32 v164, v164, s37, -v236
    v_fma_f32 v165, v165, s37, -v236
    v_mfma_f32_16x16x32_bf16 v[212:215], a[164:167], a[240:243], v[212:215]
    buffer_load_dwordx4 v246, s[4:7], s56 offen lds
    v_mfma_f32_16x16x32_bf16 v[220:223], a[168:171], a[244:247], v[220:223]
    s_add_u32 m0, s42, 0xd3c0
    ds_read_b128 a[240:243], v240 offset:12288
    v_fma_f32 v166, v166, s37, -v236
    v_mfma_f32_16x16x32_bf16 v[216:219], a[172:175], a[244:247], v[216:219]
    v_fma_f32 v167, v167, s37, -v236
    v_fma_f32 v168, v168, s37, -v236
    v_mfma_f32_16x16x32_bf16 v[212:215], a[176:179], a[244:247], v[212:215]
    s_waitcnt lgkmcnt(3)
    ds_read_b128 a[244:247], v239 offset:13312
    v_fma_f32 v169, v169, s37, -v236
    v_mfma_f32_16x16x32_bf16 v[220:223], a[180:183], v[252:255], v[220:223]
    v_exp_f32 v164, v164
    v_mfma_f32_16x16x32_bf16 v[216:219], a[184:187], v[252:255], v[216:219]
    v_exp_f32 v165, v165
    v_mfma_f32_16x16x32_bf16 v[212:215], a[188:191], v[252:255], v[212:215]
    ds_read_b128 v[252:255], v240 offset:13312
    v_cvt_pk_bf16_f32 v180, v164, v165
    v_mfma_f32_16x16x32_bf16 v[220:223], a[192:195], a[248:251], v[220:223]
    v_exp_f32 v166, v166
    v_mfma_f32_16x16x32_bf16 v[216:219], a[196:199], a[248:251], v[216:219]
    s_waitcnt lgkmcnt(3)
    buffer_load_dwordx4 v247, s[4:7], s56 offen lds
    v_mfma_f32_16x16x32_bf16 v[212:215], a[200:203], a[248:251], v[212:215]
    s_add_u32 s56, s39, 0x2a0000
    ds_read_b64_tr_b16 a[248:249], v241 offset:12288
    ds_read_b64_tr_b16 a[250:251], v241 offset:26112
    v_mfma_f32_16x16x32_bf16 v[220:223], a[204:207], a[252:255], v[220:223]
    s_add_u32 m0, s41, 0
    v_exp_f32 v167, v167
    v_mfma_f32_16x16x32_bf16 v[216:219], a[208:211], a[252:255], v[216:219]
    v_cvt_pk_bf16_f32 v181, v166, v167
    v_fma_f32 v170, v170, s37, -v236
    v_mfma_f32_16x16x32_bf16 v[212:215], a[212:215], a[252:255], v[212:215]
    ds_read_b64_tr_b16 a[252:253], v241 offset:12296
    ds_read_b64_tr_b16 a[254:255], v241 offset:26120
    v_mfma_f32_16x16x32_bf16 v[208:211], a[220:223], a[236:239], 0
    s_waitcnt lgkmcnt(5)
    v_cvt_pk_bf16_f32 v132, v220, v221
    v_cvt_pk_bf16_f32 v133, v222, v223
    v_mfma_f32_16x16x32_bf16 v[200:203], a[220:223], a[240:243], 0
    v_cvt_pk_bf16_f32 v134, v216, v217
    v_cvt_pk_bf16_f32 v135, v218, v219
    v_mfma_f32_16x16x32_bf16 v[204:207], a[224:227], a[236:239], 0
    v_cvt_pk_bf16_f32 v136, v212, v213
    v_cvt_pk_bf16_f32 v137, v214, v215
    v_mfma_f32_16x16x32_bf16 v[220:223], a[224:227], a[240:243], 0
    ds_read_b64_tr_b16 a[240:241], v242 offset:12296
    ds_read_b64_tr_b16 a[242:243], v242 offset:26120
    v_mfma_f32_16x16x32_bf16 v[216:219], a[228:231], a[236:239], 0
    ds_read_b128 v[164:167], v230 offset:640
    v_fma_f32 v171, v171, s37, -v236
    v_mfma_f32_16x16x32_bf16 v[212:215], a[232:235], a[236:239], 0
    s_waitcnt lgkmcnt(5)
    ds_read_b64_tr_b16 a[236:237], v242 offset:12288
    v_fma_f32 v172, v172, s37, -v236
    v_mfma_f32_16x16x32_bf16 v[208:211], a[248:251], a[244:247], v[208:211]
    ds_read_b64_tr_b16 a[238:239], v242 offset:26112
    v_fma_f32 v173, v173, s37, -v236
    v_mfma_f32_16x16x32_bf16 v[200:203], a[248:251], v[252:255], v[200:203]
    s_waitcnt lgkmcnt(5)
    ds_read_b64_tr_b16 a[248:249], v241 offset:13824
    v_exp_f32 v168, v168
    v_exp_f32 v169, v169
    v_mfma_f32_16x16x32_bf16 v[204:207], a[252:255], a[244:247], v[204:207]
    ds_read_b64_tr_b16 a[250:251], v241 offset:24576
    v_cvt_pk_bf16_f32 v182, v168, v169
    v_mfma_f32_16x16x32_bf16 v[220:223], a[252:255], v[252:255], v[220:223]
    s_waitcnt lgkmcnt(5)
    ds_read_b128 v[252:255], v240 offset:14336
    ds_read_b64_tr_b16 a[252:253], v241 offset:13832
    v_exp_f32 v170, v170
    v_exp_f32 v171, v171
    ds_read_b64_tr_b16 a[254:255], v241 offset:24584
    v_mfma_f32_16x16x32_bf16 v[212:215], a[240:243], a[244:247], v[212:215]
    ds_read_b64_tr_b16 a[240:241], v242 offset:13832
    v_cvt_pk_bf16_f32 v183, v170, v171
    ds_read_b64_tr_b16 a[242:243], v242 offset:24584
    v_fma_f32 v174, v174, s37, -v236
    v_mfma_f32_16x16x32_bf16 v[196:199], a[216:219], v[180:183], 0
    ds_read_b128 v[168:171], v230 offset:1280
    v_fma_f32 v175, v175, s37, -v236
    v_mfma_f32_16x16x32_bf16 v[184:187], v[74:77], v[180:183], 0
    v_exp_f32 v172, v172
    v_mfma_f32_16x16x32_bf16 v[188:191], v[96:99], v[180:183], 0
    v_exp_f32 v173, v173
    v_mfma_f32_16x16x32_bf16 v[192:195], v[118:121], v[180:183], 0
    s_waitcnt lgkmcnt(8)
    v_exp_f32 v174, v174
    v_mfma_f32_16x16x32_bf16 v[164:167], v[36:39], v[138:141], v[164:167]
    v_exp_f32 v175, v175
    v_mfma_f32_16x16x32_bf16 v[216:219], a[236:239], a[244:247], v[216:219]
    s_waitcnt lgkmcnt(5)
    ds_read_b128 a[244:247], v239 offset:14336
    ds_read_b64_tr_b16 a[236:237], v242 offset:13824
    v_mfma_f32_16x16x32_bf16 v[200:203], a[248:251], v[252:255], v[200:203]
    ds_read_b64_tr_b16 a[238:239], v242 offset:24576
    v_cvt_pk_bf16_f32 v176, v172, v173
    v_mfma_f32_16x16x16_bf16 v[164:167], v[40:41], v[142:143], v[164:167]
    s_waitcnt lgkmcnt(6)
    v_cvt_pk_bf16_f32 v177, v174, v175
    v_fma_f32 v144, v144, s37, -v236
    v_mfma_f32_16x16x32_bf16 v[220:223], a[252:255], v[252:255], v[220:223]
    s_waitcnt lgkmcnt(3)
    ds_read_b128 v[252:255], v240 offset:15360
    ds_read_b128 v[172:175], v230 offset:1920
    v_fma_f32 v145, v145, s37, -v236
    v_fma_f32 v146, v146, s37, -v236
    v_fma_f32 v147, v147, s37, -v236
    v_exp_f32 v144, v144
    v_exp_f32 v145, v145
    v_exp_f32 v146, v146
    v_mfma_f32_16x16x32_bf16 v[168:171], v[42:45], v[138:141], v[168:171]
    s_waitcnt lgkmcnt(4)
    v_exp_f32 v147, v147
    v_cvt_pk_bf16_f32 v178, v144, v145
    v_cvt_pk_bf16_f32 v179, v146, v147
    ds_read_b128 v[144:147], v230 offset:2560
    v_mfma_f32_16x16x32_bf16 v[208:211], a[248:251], a[244:247], v[208:211]
    ds_read_b64_tr_b16 a[248:249], v241 offset:36864
    ds_read_b64_tr_b16 a[250:251], v241 offset:38400
    v_mfma_f32_16x16x32_bf16 v[196:199], a[216:219], v[176:179], v[196:199]
    v_fma_f32 v148, v148, s37, -v236
    v_fma_f32 v149, v149, s37, -v236
    v_mfma_f32_16x16x32_bf16 v[184:187], v[78:81], v[176:179], v[184:187]
    v_fma_f32 v150, v150, s37, -v236
    v_fma_f32 v151, v151, s37, -v236
    v_mfma_f32_16x16x32_bf16 v[188:191], v[100:103], v[176:179], v[188:191]
    v_exp_f32 v148, v148
    v_mfma_f32_16x16x32_bf16 v[192:195], v[122:125], v[176:179], v[192:195]
    v_exp_f32 v149, v149
    v_mfma_f32_16x16x16_bf16 v[168:171], v[46:47], v[142:143], v[168:171]
    s_waitcnt lgkmcnt(3)
    v_exp_f32 v150, v150
    v_mfma_f32_16x16x32_bf16 v[172:175], v[24:27], v[138:141], v[172:175]
    v_exp_f32 v151, v151
    v_mfma_f32_16x16x32_bf16 v[204:207], a[252:255], a[244:247], v[204:207]
    ds_read_b64_tr_b16 a[252:253], v241 offset:36872
    ds_read_b64_tr_b16 a[254:255], v241 offset:38408
    v_mfma_f32_16x16x32_bf16 v[216:219], a[236:239], a[244:247], v[216:219]
    ds_read_b64_tr_b16 a[236:237], v242 offset:36864
    ds_read_b64_tr_b16 a[238:239], v242 offset:38400
    v_mfma_f32_16x16x16_bf16 v[172:175], v[28:29], v[142:143], v[172:175]
    s_waitcnt lgkmcnt(6)
    v_cvt_pk_bf16_f32 v180, v148, v149
    v_cvt_pk_bf16_f32 v181, v150, v151
    v_mfma_f32_16x16x32_bf16 v[144:147], v[30:33], v[138:141], v[144:147]
    ds_read_b128 v[148:151], v250
    v_bfe_u32 v250, s67, v233, 4
    v_mfma_f32_16x16x32_bf16 v[212:215], a[240:243], a[244:247], v[212:215]
    s_waitcnt lgkmcnt(5)
    ds_read_b128 a[244:247], v239 offset:15360
    v_mad_u32_u24 v250, v250, s40, v231
    v_mfma_f32_16x16x32_bf16 v[200:203], a[248:251], v[252:255], v[200:203]
    ds_read_b64_tr_b16 a[240:241], v242 offset:36872
    v_fma_f32 v152, v152, s37, -v236
    v_mfma_f32_16x16x16_bf16 v[144:147], v[34:35], v[142:143], v[144:147]
    s_waitcnt lgkmcnt(5)
    ds_read_b64_tr_b16 a[242:243], v242 offset:38408
    v_fma_f32 v153, v153, s37, -v236
    v_fma_f32 v154, v154, s37, -v236
    v_fma_f32 v155, v155, s37, -v236
    v_exp_f32 v152, v152
    v_exp_f32 v153, v153
    v_exp_f32 v154, v154
    v_exp_f32 v155, v155
    v_mfma_f32_16x16x32_bf16 v[220:223], a[252:255], v[252:255], v[220:223]
    ds_read_b128 v[252:255], v240 offset:16384
    v_cvt_pk_bf16_f32 v182, v152, v153
    v_cvt_pk_bf16_f32 v183, v154, v155
    ds_read_b128 v[152:155], v234
    v_bfe_u32 v234, s72, v233, 4
    v_mfma_f32_16x16x32_bf16 v[196:199], a[216:219], v[180:183], v[196:199]
    v_mad_u32_u24 v234, v234, s40, v231
    v_fma_f32 v156, v156, s37, -v236
    v_mfma_f32_16x16x32_bf16 v[184:187], v[66:69], v[180:183], v[184:187]
    v_fma_f32 v157, v157, s37, -v236
    v_fma_f32 v158, v158, s37, -v236
    v_mfma_f32_16x16x32_bf16 v[188:191], v[88:91], v[180:183], v[188:191]
    v_fma_f32 v159, v159, s37, -v236
    v_fma_f32 v160, v160, s37, -v236
    v_mfma_f32_16x16x32_bf16 v[192:195], v[110:113], v[180:183], v[192:195]
    s_waitcnt lgkmcnt(5)
    v_exp_f32 v156, v156
    v_mfma_f32_16x16x32_bf16 v[148:151], v[54:57], v[138:141], v[148:151]
    s_waitcnt lgkmcnt(4)
    v_exp_f32 v157, v157
    v_mfma_f32_16x16x32_bf16 v[208:211], a[248:251], a[244:247], v[208:211]
    ds_read_b64_tr_b16 a[248:249], v241 offset:49152
    ds_read_b64_tr_b16 a[250:251], v241 offset:62976
    v_mfma_f32_16x16x32_bf16 v[204:207], a[252:255], a[244:247], v[204:207]
    ds_read_b64_tr_b16 a[252:253], v241 offset:49160
    ds_read_b64_tr_b16 a[254:255], v241 offset:62984
    v_mfma_f32_16x16x16_bf16 v[148:151], v[58:59], v[142:143], v[148:151]
    v_exp_f32 v158, v158
    v_mfma_f32_16x16x32_bf16 v[216:219], a[236:239], a[244:247], v[216:219]
    s_waitcnt lgkmcnt(4)
    ds_read_b64_tr_b16 a[236:237], v242 offset:49152
    ds_read_b64_tr_b16 a[238:239], v242 offset:62976
    v_mfma_f32_16x16x32_bf16 v[152:155], v[60:63], v[138:141], v[152:155]
    v_exp_f32 v159, v159
    v_mfma_f32_16x16x32_bf16 v[212:215], a[240:243], a[244:247], v[212:215]
    ds_read_b128 a[244:247], v239 offset:16384
    ds_read_b64_tr_b16 a[240:241], v242 offset:49160
    v_cvt_pk_bf16_f32 v176, v156, v157
    v_cvt_pk_bf16_f32 v177, v158, v159
    v_mfma_f32_16x16x16_bf16 v[152:155], v[64:65], v[142:143], v[152:155]
    s_waitcnt lgkmcnt(6)
    ds_read_b64_tr_b16 a[242:243], v242 offset:62984
    v_fma_f32 v161, v161, s37, -v236
    ds_read_b128 v[156:159], v229 offset:640
    v_fma_f32 v162, v162, s37, -v236
    v_fma_f32 v163, v163, s37, -v236
    v_exp_f32 v160, v160
    v_exp_f32 v161, v161
    v_mfma_f32_16x16x32_bf16 v[200:203], a[248:251], v[252:255], v[200:203]
    s_waitcnt lgkmcnt(6)
    v_exp_f32 v162, v162
    v_exp_f32 v163, v163
    v_cvt_pk_bf16_f32 v178, v160, v161
    v_mfma_f32_16x16x32_bf16 v[220:223], a[252:255], v[252:255], v[220:223]
    ds_read_b128 v[252:255], v240 offset:17408
    v_cvt_pk_bf16_f32 v179, v162, v163
    ds_read_b128 v[160:163], v228 offset:640
    v_max3_f32 v248, v164, v165, v166
    v_mfma_f32_16x16x32_bf16 v[196:199], a[216:219], v[176:179], v[196:199]
    v_max3_f32 v249, v167, v168, v169
    v_max3_f32 v248, v248, v170, v171
    v_mfma_f32_16x16x32_bf16 v[184:187], v[70:73], v[176:179], v[184:187]
    v_max3_f32 v249, v249, v172, v173
    v_max3_f32 v248, v248, v174, v175
    v_mfma_f32_16x16x32_bf16 v[188:191], v[92:95], v[176:179], v[188:191]
    v_max3_f32 v249, v249, v144, v145
    v_max3_f32 v248, v248, v146, v147
    v_mfma_f32_16x16x32_bf16 v[192:195], v[114:117], v[176:179], v[192:195]
    s_waitcnt lgkmcnt(4)
    v_rcp_f32 v197, v196
    v_mfma_f32_16x16x32_bf16 v[208:211], a[248:251], a[244:247], v[208:211]
    s_waitcnt lgkmcnt(2)
    ds_read_b64_tr_b16 a[248:249], v241 offset:50688
    ds_read_b64_tr_b16 a[250:251], v241 offset:61440
    v_mfma_f32_16x16x32_bf16 v[156:159], v[42:45], v[132:135], v[156:159]
    v_mul_f32 v184, v184, v197
    v_mul_f32 v185, v185, v197
    v_mfma_f32_16x16x32_bf16 v[204:207], a[252:255], a[244:247], v[204:207]
    ds_read_b64_tr_b16 a[252:253], v241 offset:50696
    ds_read_b64_tr_b16 a[254:255], v241 offset:61448
    v_mfma_f32_16x16x32_bf16 v[216:219], a[236:239], a[244:247], v[216:219]
    ds_read_b64_tr_b16 a[236:237], v242 offset:50688
    ds_read_b64_tr_b16 a[238:239], v242 offset:61440
    v_mfma_f32_16x16x16_bf16 v[156:159], v[46:47], v[136:137], v[156:159]
    s_waitcnt lgkmcnt(6)
    v_cvt_pk_bf16_f32 v184, v184, v185
    v_mul_f32 v186, v186, v197
    v_mfma_f32_16x16x32_bf16 v[160:163], v[18:21], v[132:135], v[160:163]
    v_mul_f32 v187, v187, v197
    v_cvt_pk_bf16_f32 v185, v186, v187
    v_mfma_f32_16x16x32_bf16 v[212:215], a[240:243], a[244:247], v[212:215]
    ds_read_b128 a[244:247], v239 offset:17408
    ds_read_b64_tr_b16 a[240:241], v242 offset:50696
    ds_read_b64_tr_b16 a[242:243], v242 offset:61448
    v_mfma_f32_16x16x16_bf16 v[160:163], v[22:23], v[136:137], v[160:163]
    s_waitcnt lgkmcnt(7)
    v_mul_f32 v188, v188, v197
    v_mul_f32 v189, v189, v197
    v_cvt_pk_bf16_f32 v186, v188, v189
    v_mul_f32 v190, v190, v197
    v_mul_f32 v191, v191, v197
    v_cvt_pk_bf16_f32 v187, v190, v191
    v_mul_f32 v192, v192, v197
    v_mfma_f32_16x16x32_bf16 v[200:203], a[248:251], v[252:255], v[200:203]
    s_waitcnt lgkmcnt(5)
    v_mul_f32 v193, v193, v197
    v_cvt_pk_bf16_f32 v188, v192, v193
    v_mul_f32 v194, v194, v197
    v_mul_f32 v195, v195, v197
    v_cvt_pk_bf16_f32 v189, v194, v195
    ds_write_b128 v237, v[184:187]
    v_mfma_f32_16x16x32_bf16 v[220:223], a[252:255], v[252:255], v[220:223]
    s_waitcnt lgkmcnt(3)
    ds_read_b128 v[252:255], v224 offset:31040
    v_cvt_pk_bf16_f32 v200, v200, v201
    v_cvt_pk_bf16_f32 v201, v202, v203
    ds_write_b64 v238, v[188:189]
    v_mfma_f32_16x16x32_bf16 v[208:211], a[248:251], a[244:247], v[208:211]
    ds_read_b128 a[248:251], v224 offset:31104
    v_max3_f32 v249, v249, v148, v149
    v_mfma_f32_16x16x32_bf16 v[204:207], a[252:255], a[244:247], v[204:207]
    ds_read_b128 a[252:255], v224 offset:31168
    v_cvt_pk_bf16_f32 v202, v220, v221
    v_mfma_f32_16x16x32_bf16 v[216:219], a[236:239], a[244:247], v[216:219]
    s_waitcnt lgkmcnt(5)
    ds_read_b128 a[236:239], v224 offset:31232
    v_cvt_pk_bf16_f32 v203, v222, v223
    v_mfma_f32_16x16x32_bf16 v[212:215], a[240:243], a[244:247], v[212:215]
    ds_read_b128 a[244:247], v224 offset:30976
    ds_read_b128 a[240:243], v224 offset:31296
    v_cvt_pk_bf16_f32 v208, v208, v209
    v_cvt_pk_bf16_f32 v209, v210, v211
    v_cvt_pk_bf16_f32 v210, v204, v205
    v_cvt_pk_bf16_f32 v211, v206, v207
    buffer_store_dwordx4 v[208:211], v243, s[20:23], s58 offen sc0 sc1
    v_cvt_pk_bf16_f32 v216, v216, v217
    v_cvt_pk_bf16_f32 v217, v218, v219
    v_cvt_pk_bf16_f32 v218, v212, v213
    v_cvt_pk_bf16_f32 v219, v214, v215
    v_max3_f32 v248, v248, v150, v151
    v_max3_f32 v249, v249, v152, v153
    v_max3_f32 v248, v248, v154, v155
    v_max_f32 v248, v248, v249
    v_mov_b32 v249, v248
    s_nop 1
    v_permlane16_swap_b32 v248, v249
    v_max_f32 v248, v248, v249
    v_mov_b32 v249, v248
    s_nop 1
    v_permlane32_swap_b32 v248, v249
    s_waitcnt lgkmcnt(1)
    v_mfma_f32_16x16x32_bf16 v[208:211], a[0:3], a[244:247], 0
    v_max_f32 v248, v248, v249
    v_mul_f32 v236, s37, v248
    v_mfma_f32_16x16x32_bf16 v[204:207], a[4:7], a[244:247], 0
    v_fma_f32 v164, v164, s37, -v236
    v_fma_f32 v165, v165, s37, -v236
    v_mfma_f32_16x16x32_bf16 v[220:223], a[244:247], a[72:75], 0
    v_fma_f32 v166, v166, s37, -v236
    v_fma_f32 v167, v167, s37, -v236
    v_mfma_f32_16x16x32_bf16 v[212:215], a[244:247], a[80:83], 0
    v_exp_f32 v164, v164
    v_mfma_f32_16x16x32_bf16 v[208:211], a[12:15], v[252:255], v[208:211]
    v_exp_f32 v165, v165
    v_mfma_f32_16x16x32_bf16 v[204:207], a[16:19], v[252:255], v[204:207]
    v_exp_f32 v166, v166
    v_mfma_f32_16x16x32_bf16 v[220:223], v[252:255], a[84:87], v[220:223]
    buffer_store_dwordx4 v[200:203], v245, s[20:23], s58 offen sc0 sc1
    v_mfma_f32_16x16x32_bf16 v[212:215], v[252:255], a[92:95], v[212:215]
    v_exp_f32 v167, v167
    v_mfma_f32_16x16x32_bf16 v[200:203], a[8:11], a[244:247], 0
    v_cvt_pk_bf16_f32 v180, v164, v165
    v_cvt_pk_bf16_f32 v181, v166, v167
    v_mfma_f32_16x16x32_bf16 v[200:203], a[20:23], v[252:255], v[200:203]
    ds_read_b128 v[164:167], v228 offset:1280
    v_fma_f32 v168, v168, s37, -v236
    v_mfma_f32_16x16x32_bf16 v[208:211], a[24:27], a[248:251], v[208:211]
    v_fma_f32 v169, v169, s37, -v236
    v_fma_f32 v170, v170, s37, -v236
    v_mfma_f32_16x16x32_bf16 v[204:207], a[28:31], a[248:251], v[204:207]
    v_fma_f32 v171, v171, s37, -v236
    v_fma_f32 v172, v172, s37, -v236
    v_mfma_f32_16x16x32_bf16 v[200:203], a[32:35], a[248:251], v[200:203]
    v_exp_f32 v168, v168
    v_mfma_f32_16x16x32_bf16 v[220:223], a[248:251], a[96:99], v[220:223]
    v_exp_f32 v169, v169
    v_mfma_f32_16x16x32_bf16 v[212:215], a[248:251], a[104:107], v[212:215]
    v_exp_f32 v170, v170
    v_mfma_f32_16x16x32_bf16 v[208:211], a[36:39], a[252:255], v[208:211]
    v_exp_f32 v171, v171
    v_mfma_f32_16x16x32_bf16 v[204:207], a[40:43], a[252:255], v[204:207]
    v_cvt_pk_bf16_f32 v182, v168, v169
    v_cvt_pk_bf16_f32 v183, v170, v171
    v_mfma_f32_16x16x32_bf16 v[200:203], a[44:47], a[252:255], v[200:203]
    ds_read_b128 v[168:171], v229 offset:1280
    v_fma_f32 v173, v173, s37, -v236
    v_mfma_f32_16x16x32_bf16 v[196:199], a[216:219], v[180:183], 0
    buffer_store_dwordx4 v[216:219], v244, s[20:23], s58 offen sc0 sc1
    v_mfma_f32_16x16x32_bf16 v[184:187], v[76:79], v[180:183], 0
    s_add_u32 s58, s51, 0xa8000
    v_fma_f32 v174, v174, s37, -v236
    v_fma_f32 v175, v175, s37, -v236
    v_mfma_f32_16x16x32_bf16 v[188:191], v[98:101], v[180:183], 0
    v_exp_f32 v172, v172
    v_mfma_f32_16x16x32_bf16 v[192:195], v[120:123], v[180:183], 0
    s_waitcnt lgkmcnt(1)
    v_exp_f32 v173, v173
    v_mfma_f32_16x16x32_bf16 v[164:167], v[0:3], v[132:135], v[164:167]
    v_exp_f32 v174, v174
    v_mfma_f32_16x16x32_bf16 v[216:219], a[244:247], a[76:79], 0
    ds_read_b128 a[244:247], v224 offset:34048
    v_cvt_pk_bf16_f32 v176, v172, v173
    v_mfma_f32_16x16x32_bf16 v[216:219], v[252:255], a[88:91], v[216:219]
    ds_read_b128 v[252:255], v224 offset:34112
    v_fma_f32 v144, v144, s37, -v236
    v_mfma_f32_16x16x16_bf16 v[164:167], v[4:5], v[136:137], v[164:167]
    s_waitcnt lgkmcnt(2)
    v_exp_f32 v175, v175
    v_mfma_f32_16x16x32_bf16 v[168:171], v[24:27], v[132:135], v[168:171]
    v_cvt_pk_bf16_f32 v177, v174, v175
    v_fma_f32 v145, v145, s37, -v236
    v_mfma_f32_16x16x32_bf16 v[216:219], a[248:251], a[100:103], v[216:219]
    ds_read_b128 a[248:251], v224 offset:34176
    ds_read_b128 v[172:175], v229 offset:1920
    v_mfma_f32_16x16x32_bf16 v[220:223], a[252:255], a[108:111], v[220:223]
    v_fma_f32 v146, v146, s37, -v236
    v_fma_f32 v147, v147, s37, -v236
    v_mfma_f32_16x16x16_bf16 v[168:171], v[28:29], v[136:137], v[168:171]
    v_exp_f32 v144, v144
    v_mfma_f32_16x16x32_bf16 v[216:219], a[252:255], a[112:115], v[216:219]
    v_exp_f32 v145, v145
    v_mfma_f32_16x16x32_bf16 v[212:215], a[252:255], a[116:119], v[212:215]
    ds_read_b128 a[252:255], v224 offset:34240
    v_cvt_pk_bf16_f32 v178, v144, v145
    v_mfma_f32_16x16x32_bf16 v[208:211], a[48:51], a[236:239], v[208:211]
    v_exp_f32 v146, v146
    v_mfma_f32_16x16x32_bf16 v[204:207], a[52:55], a[236:239], v[204:207]
    v_exp_f32 v147, v147
    v_mfma_f32_16x16x32_bf16 v[200:203], a[56:59], a[236:239], v[200:203]
    v_cvt_pk_bf16_f32 v179, v146, v147
    v_fma_f32 v148, v148, s37, -v236
    v_mfma_f32_16x16x32_bf16 v[220:223], a[236:239], a[120:123], v[220:223]
    ds_read_b128 v[144:147], v228 offset:1920
    v_fma_f32 v149, v149, s37, -v236
    v_mfma_f32_16x16x32_bf16 v[196:199], a[216:219], v[176:179], v[196:199]
    v_fma_f32 v150, v150, s37, -v236
    v_fma_f32 v151, v151, s37, -v236
    v_mfma_f32_16x16x32_bf16 v[184:187], v[68:71], v[176:179], v[184:187]
    v_exp_f32 v148, v148
    v_mfma_f32_16x16x32_bf16 v[188:191], v[90:93], v[176:179], v[188:191]
    v_exp_f32 v149, v149
    v_mfma_f32_16x16x32_bf16 v[192:195], v[112:115], v[176:179], v[192:195]
    s_waitcnt lgkmcnt(2)
    v_exp_f32 v150, v150
    v_mfma_f32_16x16x32_bf16 v[172:175], v[30:33], v[132:135], v[172:175]
    v_exp_f32 v151, v151
    v_mfma_f32_16x16x32_bf16 v[216:219], a[236:239], a[124:127], v[216:219]
    v_cvt_pk_bf16_f32 v180, v148, v149
    v_cvt_pk_bf16_f32 v181, v150, v151
    v_mfma_f32_16x16x32_bf16 v[212:215], a[236:239], a[128:131], v[212:215]
    ds_read_b128 a[236:239], v224 offset:34304
    ds_read_b128 v[148:151], v228 offset:2560
    v_mfma_f32_16x16x16_bf16 v[172:175], v[34:35], v[136:137], v[172:175]
    v_fma_f32 v152, v152, s37, -v236
    v_fma_f32 v153, v153, s37, -v236
    v_mfma_f32_16x16x32_bf16 v[208:211], a[60:63], a[240:243], v[208:211]
    s_waitcnt lgkmcnt(2)
    v_fma_f32 v154, v154, s37, -v236
    v_fma_f32 v155, v155, s37, -v236
    v_mfma_f32_16x16x32_bf16 v[144:147], v[6:9], v[132:135], v[144:147]
    v_exp_f32 v152, v152
    v_mfma_f32_16x16x32_bf16 v[204:207], a[64:67], a[240:243], v[204:207]
    v_exp_f32 v153, v153
    v_mfma_f32_16x16x32_bf16 v[200:203], a[68:71], a[240:243], v[200:203]
    v_exp_f32 v154, v154
    v_mfma_f32_16x16x32_bf16 v[220:223], a[240:243], a[132:135], v[220:223]
    v_cvt_pk_bf16_f32 v12, v208, v209
    v_cvt_pk_bf16_f32 v13, v210, v211
    v_mfma_f32_16x16x16_bf16 v[144:147], v[10:11], v[136:137], v[144:147]
    v_exp_f32 v155, v155
    v_mfma_f32_16x16x32_bf16 v[216:219], a[240:243], a[136:139], v[216:219]
    v_cvt_pk_bf16_f32 v14, v204, v205
    v_cvt_pk_bf16_f32 v15, v206, v207
    v_mfma_f32_16x16x32_bf16 v[212:215], a[240:243], a[140:143], v[212:215]
    v_cvt_pk_bf16_f32 v16, v200, v201
    v_cvt_pk_bf16_f32 v17, v202, v203
    v_mfma_f32_16x16x32_bf16 v[208:211], a[0:3], a[244:247], 0
    s_waitcnt lgkmcnt(0)
    v_cvt_pk_bf16_f32 v74, v220, v221
    v_cvt_pk_bf16_f32 v75, v222, v223
    v_mfma_f32_16x16x32_bf16 v[148:151], v[12:15], v[132:135], v[148:151]
    v_cvt_pk_bf16_f32 v96, v216, v217
    v_cvt_pk_bf16_f32 v97, v218, v219
    v_mfma_f32_16x16x32_bf16 v[204:207], a[4:7], a[244:247], 0
    v_cvt_pk_bf16_f32 v118, v212, v213
    v_cvt_pk_bf16_f32 v119, v214, v215
    v_mfma_f32_16x16x32_bf16 v[200:203], a[8:11], a[244:247], 0
    ds_read_b128 a[240:243], v224 offset:34368
    v_cvt_pk_bf16_f32 v182, v152, v153
    v_mfma_f32_16x16x16_bf16 v[148:151], v[16:17], v[136:137], v[148:151]
    v_cvt_pk_bf16_f32 v183, v154, v155
    v_max3_f32 v248, v156, v157, v158
    v_mfma_f32_16x16x32_bf16 v[220:223], a[244:247], a[72:75], 0
    ds_read_b128 v[152:155], v229 offset:2560
    v_max3_f32 v249, v159, v160, v161
    v_mfma_f32_16x16x32_bf16 v[196:199], a[216:219], v[180:183], v[196:199]
    v_max3_f32 v248, v248, v162, v163
    v_max3_f32 v249, v249, v164, v165
    v_mfma_f32_16x16x32_bf16 v[184:187], v[84:87], v[180:183], v[184:187]
    v_max3_f32 v248, v248, v166, v167
    v_max3_f32 v249, v249, v168, v169
    v_mfma_f32_16x16x32_bf16 v[188:191], v[106:109], v[180:183], v[188:191]
    v_max3_f32 v248, v248, v170, v171
    v_max3_f32 v249, v249, v172, v173
    v_mfma_f32_16x16x32_bf16 v[192:195], v[128:131], v[180:183], v[192:195]
    v_rcp_f32 v197, v196
    v_mfma_f32_16x16x32_bf16 v[216:219], a[244:247], a[76:79], 0
    v_mul_f32 v184, v184, v197
    v_mul_f32 v185, v185, v197
    v_mfma_f32_16x16x32_bf16 v[212:215], a[244:247], a[80:83], 0
    ds_read_b128 a[244:247], v225 offset:11968
    v_cvt_pk_bf16_f32 v184, v184, v185
    v_mfma_f32_16x16x32_bf16 v[208:211], a[12:15], v[252:255], v[208:211]
    v_mul_f32 v186, v186, v197
    v_mul_f32 v187, v187, v197
    v_mfma_f32_16x16x32_bf16 v[204:207], a[16:19], v[252:255], v[204:207]
    v_cvt_pk_bf16_f32 v185, v186, v187
    v_mul_f32 v188, v188, v197
    v_mfma_f32_16x16x32_bf16 v[200:203], a[20:23], v[252:255], v[200:203]
    v_mul_f32 v189, v189, v197
    v_cvt_pk_bf16_f32 v186, v188, v189
    v_mfma_f32_16x16x32_bf16 v[220:223], v[252:255], a[84:87], v[220:223]
    v_mul_f32 v190, v190, v197
    v_mul_f32 v191, v191, v197
    v_mfma_f32_16x16x32_bf16 v[216:219], v[252:255], a[88:91], v[216:219]
    v_cvt_pk_bf16_f32 v187, v190, v191
    v_mul_f32 v192, v192, v197
    v_mfma_f32_16x16x32_bf16 v[212:215], v[252:255], a[92:95], v[212:215]
    ds_read_b128 v[252:255], v225 offset:12032
    v_mul_f32 v193, v193, v197
    v_mfma_f32_16x16x32_bf16 v[208:211], a[24:27], a[248:251], v[208:211]
    v_cvt_pk_bf16_f32 v188, v192, v193
    v_mul_f32 v194, v194, v197
    v_mfma_f32_16x16x32_bf16 v[204:207], a[28:31], a[248:251], v[204:207]
    v_mul_f32 v195, v195, v197
    v_cvt_pk_bf16_f32 v189, v194, v195
    v_mfma_f32_16x16x32_bf16 v[200:203], a[32:35], a[248:251], v[200:203]
    ds_write_b128 v237, v[184:187] offset:6144
    v_mfma_f32_16x16x32_bf16 v[220:223], a[248:251], a[96:99], v[220:223]
    ds_write_b64 v238, v[188:189] offset:6144
    v_mfma_f32_16x16x32_bf16 v[216:219], a[248:251], a[100:103], v[216:219]
    v_max3_f32 v248, v248, v174, v175
    v_max3_f32 v249, v249, v144, v145
    v_mfma_f32_16x16x32_bf16 v[212:215], a[248:251], a[104:107], v[212:215]
    ds_read_b128 a[248:251], v225 offset:12096
    v_max3_f32 v248, v248, v146, v147
    v_mfma_f32_16x16x32_bf16 v[208:211], a[36:39], a[252:255], v[208:211]
    v_max3_f32 v249, v249, v148, v149
    v_max3_f32 v248, v248, v150, v151
    v_mfma_f32_16x16x32_bf16 v[204:207], a[40:43], a[252:255], v[204:207]
    v_mfma_f32_16x16x32_bf16 v[200:203], a[44:47], a[252:255], v[200:203]
    v_mfma_f32_16x16x32_bf16 v[220:223], a[252:255], a[108:111], v[220:223]
    v_mfma_f32_16x16x32_bf16 v[216:219], a[252:255], a[112:115], v[216:219]
    v_mfma_f32_16x16x32_bf16 v[212:215], a[252:255], a[116:119], v[212:215]
    ds_read_b128 a[252:255], v225 offset:12160
    v_mfma_f32_16x16x32_bf16 v[208:211], a[48:51], a[236:239], v[208:211]
    v_mfma_f32_16x16x32_bf16 v[204:207], a[52:55], a[236:239], v[204:207]
    v_mfma_f32_16x16x32_bf16 v[200:203], a[56:59], a[236:239], v[200:203]
    v_mfma_f32_16x16x32_bf16 v[220:223], a[236:239], a[120:123], v[220:223]
    v_mfma_f32_16x16x32_bf16 v[216:219], a[236:239], a[124:127], v[216:219]
    v_mfma_f32_16x16x32_bf16 v[212:215], a[236:239], a[128:131], v[212:215]
    s_waitcnt lgkmcnt(1)
    ds_read_b128 a[236:239], v225 offset:12224
    v_mfma_f32_16x16x32_bf16 v[208:211], a[60:63], a[240:243], v[208:211]
    v_mfma_f32_16x16x32_bf16 v[204:207], a[64:67], a[240:243], v[204:207]
    v_mfma_f32_16x16x32_bf16 v[200:203], a[68:71], a[240:243], v[200:203]
    v_mfma_f32_16x16x32_bf16 v[220:223], a[240:243], a[132:135], v[220:223]
    v_mfma_f32_16x16x32_bf16 v[216:219], a[240:243], a[136:139], v[216:219]
    v_mfma_f32_16x16x32_bf16 v[212:215], a[240:243], a[140:143], v[212:215]
    ds_read_b128 a[240:243], v225 offset:12288
    s_nop 1
    v_cvt_pk_bf16_f32 v36, v208, v209
    v_cvt_pk_bf16_f32 v37, v210, v211
    v_mfma_f32_16x16x32_bf16 v[208:211], a[144:147], a[244:247], 0
    v_cvt_pk_bf16_f32 v38, v204, v205
    v_cvt_pk_bf16_f32 v39, v206, v207
    v_mfma_f32_16x16x32_bf16 v[204:207], a[148:151], a[244:247], 0
    v_cvt_pk_bf16_f32 v40, v200, v201
    v_cvt_pk_bf16_f32 v41, v202, v203
    v_mfma_f32_16x16x32_bf16 v[152:155], v[36:39], v[132:135], v[152:155]
    v_cvt_pk_bf16_f32 v76, v220, v221
    v_cvt_pk_bf16_f32 v77, v222, v223
    v_mfma_f32_16x16x32_bf16 v[200:203], a[152:155], a[244:247], 0
    v_cvt_pk_bf16_f32 v98, v216, v217
    v_cvt_pk_bf16_f32 v99, v218, v219
    v_mfma_f32_16x16x32_bf16 v[208:211], a[156:159], v[252:255], v[208:211]
    v_cvt_pk_bf16_f32 v120, v212, v213
    v_cvt_pk_bf16_f32 v121, v214, v215
    v_mfma_f32_16x16x16_bf16 v[152:155], v[40:41], v[136:137], v[152:155]
    s_waitcnt vmcnt(3) lgkmcnt(0)
    ds_read_b128 a[244:247], v225 offset:24384
    v_mfma_f32_16x16x32_bf16 v[204:207], a[160:163], v[252:255], v[204:207]
    s_barrier
    v_mfma_f32_16x16x32_bf16 v[200:203], a[164:167], v[252:255], v[200:203]
    ds_read_b128 v[252:255], v225 offset:24448
    v_mfma_f32_16x16x32_bf16 v[208:211], a[168:171], a[248:251], v[208:211]
    buffer_load_dwordx4 v246, s[4:7], s56 offen lds
    v_mfma_f32_16x16x32_bf16 v[204:207], a[172:175], a[248:251], v[204:207]
    s_add_u32 m0, s42, 0
    v_max3_f32 v249, v249, v152, v153
    v_max3_f32 v248, v248, v154, v155
    v_mfma_f32_16x16x32_bf16 v[200:203], a[176:179], a[248:251], v[200:203]
    ds_read_b128 a[248:251], v225 offset:24512
    v_max_f32 v248, v248, v249
    v_mfma_f32_16x16x32_bf16 v[208:211], a[180:183], a[252:255], v[208:211]
    v_mov_b32 v249, v248
    v_mfma_f32_16x16x32_bf16 v[204:207], a[184:187], a[252:255], v[204:207]
    v_mfma_f32_16x16x32_bf16 v[200:203], a[188:191], a[252:255], v[200:203]
    ds_read_b128 a[252:255], v225 offset:24576
    v_mfma_f32_16x16x32_bf16 v[208:211], a[192:195], a[236:239], v[208:211]
    v_permlane16_swap_b32 v248, v249
    v_mfma_f32_16x16x32_bf16 v[204:207], a[196:199], a[236:239], v[204:207]
    v_max_f32 v248, v248, v249
    v_mov_b32 v249, v248
    v_mfma_f32_16x16x32_bf16 v[200:203], a[200:203], a[236:239], v[200:203]
    ds_read_b128 a[236:239], v225 offset:24640
    v_mfma_f32_16x16x32_bf16 v[208:211], a[204:207], a[240:243], v[208:211]
    buffer_load_dwordx4 v247, s[4:7], s56 offen lds
    v_mfma_f32_16x16x32_bf16 v[204:207], a[208:211], a[240:243], v[204:207]
    s_add_u32 m0, s41, 0x1e40
    v_permlane32_swap_b32 v248, v249
    v_mfma_f32_16x16x32_bf16 v[200:203], a[212:215], a[240:243], v[200:203]
    s_waitcnt lgkmcnt(3)
    ds_read_b128 a[240:243], v225 offset:24704
    v_max_f32 v248, v248, v249
    v_mfma_f32_16x16x32_bf16 v[220:223], a[144:147], a[244:247], 0
    v_cvt_pk_bf16_f32 v138, v208, v209
    v_cvt_pk_bf16_f32 v139, v210, v211
    v_mfma_f32_16x16x32_bf16 v[216:219], a[148:151], a[244:247], 0
    v_cvt_pk_bf16_f32 v140, v204, v205
    v_cvt_pk_bf16_f32 v141, v206, v207
    v_mfma_f32_16x16x32_bf16 v[212:215], a[152:155], a[244:247], 0
    v_cvt_pk_bf16_f32 v142, v200, v201
    v_cvt_pk_bf16_f32 v143, v202, v203
    v_mfma_f32_16x16x32_bf16 v[220:223], a[156:159], v[252:255], v[220:223]
    ds_read_b128 a[244:247], v227 offset:37120
    v_mul_f32 v236, s37, v248
    v_mfma_f32_16x16x32_bf16 v[216:219], a[160:163], v[252:255], v[216:219]
    v_fma_f32 v156, v156, s37, -v236
    v_fma_f32 v157, v157, s37, -v236
    v_mfma_f32_16x16x32_bf16 v[212:215], a[164:167], v[252:255], v[212:215]
    s_waitcnt lgkmcnt(3)
    ds_read_b128 v[252:255], v227 offset:37184
    v_fma_f32 v158, v158, s37, -v236
    v_mfma_f32_16x16x32_bf16 v[220:223], a[168:171], a[248:251], v[220:223]
    buffer_load_dwordx4 v246, s[4:7], s46 offen lds
    v_mfma_f32_16x16x32_bf16 v[216:219], a[172:175], a[248:251], v[216:219]
    s_add_u32 m0, s42, 0x1e40
    v_fma_f32 v159, v159, s37, -v236
    v_fma_f32 v160, v160, s37, -v236
    v_mfma_f32_16x16x32_bf16 v[212:215], a[176:179], a[248:251], v[212:215]
    ds_read_b128 a[248:251], v227 offset:37248
    v_fma_f32 v161, v161, s37, -v236
    v_mfma_f32_16x16x32_bf16 v[220:223], a[180:183], a[252:255], v[220:223]
    v_exp_f32 v156, v156
    v_mfma_f32_16x16x32_bf16 v[216:219], a[184:187], a[252:255], v[216:219]
    v_exp_f32 v157, v157
    v_mfma_f32_16x16x32_bf16 v[212:215], a[188:191], a[252:255], v[212:215]
    s_waitcnt lgkmcnt(3)
    ds_read_b128 a[252:255], v227 offset:37312
    v_cvt_pk_bf16_f32 v176, v156, v157
    v_mfma_f32_16x16x32_bf16 v[220:223], a[192:195], a[236:239], v[220:223]
    v_exp_f32 v158, v158
    v_mfma_f32_16x16x32_bf16 v[216:219], a[196:199], a[236:239], v[216:219]
    v_exp_f32 v159, v159
    v_mfma_f32_16x16x32_bf16 v[212:215], a[200:203], a[236:239], v[212:215]
    ds_read_b128 a[236:239], v227 offset:37376
    v_cvt_pk_bf16_f32 v177, v158, v159
    v_mfma_f32_16x16x32_bf16 v[220:223], a[204:207], a[240:243], v[220:223]
    buffer_load_dwordx4 v247, s[4:7], s46 offen lds
    v_mfma_f32_16x16x32_bf16 v[216:219], a[208:211], a[240:243], v[216:219]
    s_add_u32 m0, s41, 0x3c80
    ds_read_b128 v[156:159], v230 offset:2560
    v_fma_f32 v162, v162, s37, -v236
    v_mfma_f32_16x16x32_bf16 v[212:215], a[212:215], a[240:243], v[212:215]
    s_waitcnt lgkmcnt(4)
    ds_read_b128 a[240:243], v227 offset:37440
    v_fma_f32 v163, v163, s37, -v236
    v_mfma_f32_16x16x32_bf16 v[208:211], a[0:3], a[244:247], 0
    v_cvt_pk_bf16_f32 v132, v220, v221
    v_cvt_pk_bf16_f32 v133, v222, v223
    v_mfma_f32_16x16x32_bf16 v[204:207], a[4:7], a[244:247], 0
    v_cvt_pk_bf16_f32 v134, v216, v217
    v_cvt_pk_bf16_f32 v135, v218, v219
    v_mfma_f32_16x16x32_bf16 v[200:203], a[8:11], a[244:247], 0
    v_cvt_pk_bf16_f32 v136, v212, v213
    v_cvt_pk_bf16_f32 v137, v214, v215
    v_mfma_f32_16x16x32_bf16 v[220:223], a[244:247], a[72:75], 0
    v_exp_f32 v160, v160
    v_mfma_f32_16x16x32_bf16 v[216:219], a[244:247], a[76:79], 0
    v_exp_f32 v161, v161
    v_mfma_f32_16x16x32_bf16 v[212:215], a[244:247], a[80:83], 0
    ds_read_b128 a[244:247], v239
    v_cvt_pk_bf16_f32 v178, v160, v161
    v_mfma_f32_16x16x32_bf16 v[208:211], a[12:15], v[252:255], v[208:211]
    v_exp_f32 v162, v162
    v_mfma_f32_16x16x32_bf16 v[204:207], a[16:19], v[252:255], v[204:207]
    s_waitcnt lgkmcnt(2)
    v_exp_f32 v163, v163
    v_mfma_f32_16x16x32_bf16 v[156:159], v[36:39], v[138:141], v[156:159]
    v_cvt_pk_bf16_f32 v179, v162, v163
    v_fma_f32 v164, v164, s37, -v236
    v_mfma_f32_16x16x32_bf16 v[200:203], a[20:23], v[252:255], v[200:203]
    ds_read_b128 v[160:163], v230 offset:640
    v_fma_f32 v165, v165, s37, -v236
    v_mfma_f32_16x16x32_bf16 v[196:199], a[216:219], v[176:179], 0
    v_fma_f32 v166, v166, s37, -v236
    v_fma_f32 v167, v167, s37, -v236
    v_mfma_f32_16x16x32_bf16 v[184:187], v[78:81], v[176:179], 0
    v_exp_f32 v164, v164
    v_mfma_f32_16x16x32_bf16 v[188:191], v[100:103], v[176:179], 0
    v_exp_f32 v165, v165
    v_mfma_f32_16x16x32_bf16 v[192:195], v[122:125], v[176:179], 0
    v_exp_f32 v166, v166
    v_mfma_f32_16x16x16_bf16 v[156:159], v[40:41], v[142:143], v[156:159]
    v_exp_f32 v167, v167
    v_mfma_f32_16x16x32_bf16 v[220:223], v[252:255], a[84:87], v[220:223]
    v_cvt_pk_bf16_f32 v180, v164, v165
    v_cvt_pk_bf16_f32 v181, v166, v167
    v_mfma_f32_16x16x32_bf16 v[216:219], v[252:255], a[88:91], v[216:219]
    ds_read_b128 v[164:167], v230 offset:1280
    v_fma_f32 v168, v168, s37, -v236
    v_mfma_f32_16x16x32_bf16 v[212:215], v[252:255], a[92:95], v[212:215]
    ds_read_b128 v[252:255], v240
    v_fma_f32 v169, v169, s37, -v236
    v_mfma_f32_16x16x32_bf16 v[208:211], a[24:27], a[248:251], v[208:211]
    s_waitcnt lgkmcnt(2)
    v_fma_f32 v170, v170, s37, -v236
    v_fma_f32 v171, v171, s37, -v236
    v_mfma_f32_16x16x32_bf16 v[160:163], v[42:45], v[138:141], v[160:163]
    v_exp_f32 v168, v168
    v_mfma_f32_16x16x32_bf16 v[204:207], a[28:31], a[248:251], v[204:207]
    v_exp_f32 v169, v169
    v_mfma_f32_16x16x32_bf16 v[200:203], a[32:35], a[248:251], v[200:203]
    v_exp_f32 v170, v170
    v_mfma_f32_16x16x32_bf16 v[220:223], a[248:251], a[96:99], v[220:223]
    v_exp_f32 v171, v171
    v_mfma_f32_16x16x16_bf16 v[160:163], v[46:47], v[142:143], v[160:163]
    v_cvt_pk_bf16_f32 v182, v168, v169
    v_cvt_pk_bf16_f32 v183, v170, v171
    v_mfma_f32_16x16x32_bf16 v[216:219], a[248:251], a[100:103], v[216:219]
    ds_read_b128 v[168:171], v230 offset:1920
    v_fma_f32 v172, v172, s37, -v236
    v_mfma_f32_16x16x32_bf16 v[196:199], a[216:219], v[180:183], v[196:199]
    v_fma_f32 v173, v173, s37, -v236
    v_fma_f32 v174, v174, s37, -v236
    v_mfma_f32_16x16x32_bf16 v[184:187], v[66:69], v[180:183], v[184:187]
    v_fma_f32 v175, v175, s37, -v236
    v_fma_f32 v144, v144, s37, -v236
    v_mfma_f32_16x16x32_bf16 v[188:191], v[88:91], v[180:183], v[188:191]
    v_exp_f32 v172, v172
    v_mfma_f32_16x16x32_bf16 v[192:195], v[110:113], v[180:183], v[192:195]
    s_waitcnt lgkmcnt(1)
    v_exp_f32 v173, v173
    v_mfma_f32_16x16x32_bf16 v[164:167], v[24:27], v[138:141], v[164:167]
    v_exp_f32 v174, v174
    v_mfma_f32_16x16x32_bf16 v[212:215], a[248:251], a[104:107], v[212:215]
    ds_read_b128 a[248:251], v239 offset:1024
    v_cvt_pk_bf16_f32 v176, v172, v173
    v_mfma_f32_16x16x32_bf16 v[208:211], a[36:39], a[252:255], v[208:211]
    v_exp_f32 v175, v175
    v_mfma_f32_16x16x16_bf16 v[164:167], v[28:29], v[142:143], v[164:167]
    v_cvt_pk_bf16_f32 v177, v174, v175
    v_fma_f32 v145, v145, s37, -v236
    v_mfma_f32_16x16x32_bf16 v[204:207], a[40:43], a[252:255], v[204:207]
    s_waitcnt lgkmcnt(1)
    ds_read_b128 v[172:175], v235
    v_bfe_u32 v235, s69, v233, 4
    v_mfma_f32_16x16x32_bf16 v[168:171], v[30:33], v[138:141], v[168:171]
    v_mad_u32_u24 v235, v235, s40, v231
    v_fma_f32 v146, v146, s37, -v236
    v_mfma_f32_16x16x32_bf16 v[200:203], a[44:47], a[252:255], v[200:203]
    v_fma_f32 v147, v147, s37, -v236
    v_fma_f32 v148, v148, s37, -v236
    v_mfma_f32_16x16x32_bf16 v[220:223], a[252:255], a[108:111], v[220:223]
    v_exp_f32 v144, v144
    v_mfma_f32_16x16x16_bf16 v[168:171], v[34:35], v[142:143], v[168:171]
    v_exp_f32 v145, v145
    v_mfma_f32_16x16x32_bf16 v[216:219], a[252:255], a[112:115], v[216:219]
    v_exp_f32 v146, v146
    v_mfma_f32_16x16x32_bf16 v[212:215], a[252:255], a[116:119], v[212:215]
    ds_read_b128 a[252:255], v240 offset:1024
    v_cvt_pk_bf16_f32 v178, v144, v145
    v_mfma_f32_16x16x32_bf16 v[208:211], a[48:51], a[236:239], v[208:211]
    v_exp_f32 v147, v147
    v_mfma_f32_16x16x32_bf16 v[204:207], a[52:55], a[236:239], v[204:207]
    v_cvt_pk_bf16_f32 v179, v146, v147
    v_fma_f32 v149, v149, s37, -v236
    v_mfma_f32_16x16x32_bf16 v[200:203], a[56:59], a[236:239], v[200:203]
    ds_read_b128 v[144:147], v250
    v_bfe_u32 v250, s70, v233, 4
    v_mfma_f32_16x16x32_bf16 v[196:199], a[216:219], v[176:179], v[196:199]
    v_mad_u32_u24 v250, v250, s40, v231
    v_fma_f32 v150, v150, s37, -v236
    v_mfma_f32_16x16x32_bf16 v[184:187], v[70:73], v[176:179], v[184:187]
    v_fma_f32 v151, v151, s37, -v236
    v_fma_f32 v152, v152, s37, -v236
    v_mfma_f32_16x16x32_bf16 v[188:191], v[92:95], v[176:179], v[188:191]
    v_exp_f32 v148, v148
    v_mfma_f32_16x16x32_bf16 v[192:195], v[114:117], v[176:179], v[192:195]
    s_waitcnt lgkmcnt(2)
    v_exp_f32 v149, v149
    v_mfma_f32_16x16x32_bf16 v[172:175], v[54:57], v[138:141], v[172:175]
    v_exp_f32 v150, v150
    v_mfma_f32_16x16x32_bf16 v[220:223], a[236:239], a[120:123], v[220:223]
    v_exp_f32 v151, v151
    v_mfma_f32_16x16x32_bf16 v[216:219], a[236:239], a[124:127], v[216:219]
    v_cvt_pk_bf16_f32 v180, v148, v149
    v_cvt_pk_bf16_f32 v181, v150, v151
    v_mfma_f32_16x16x16_bf16 v[172:175], v[58:59], v[142:143], v[172:175]
    ds_read_b128 v[148:151], v234
    v_bfe_u32 v234, s73, v232, 4
    v_mfma_f32_16x16x32_bf16 v[212:215], a[236:239], a[128:131], v[212:215]
    s_waitcnt lgkmcnt(1)
    ds_read_b64_tr_b16 a[236:237], v241 offset:12288
    ds_read_b64_tr_b16 a[238:239], v241 offset:26112
    v_mfma_f32_16x16x32_bf16 v[144:147], v[60:63], v[138:141], v[144:147]
    v_fma_f32 v153, v153, s37, -v236
    v_fma_f32 v154, v154, s37, -v236
    v_mfma_f32_16x16x32_bf16 v[208:211], a[60:63], a[240:243], v[208:211]
    v_fma_f32 v155, v155, s37, -v236
    v_max3_f32 v248, v156, v157, v158
    v_mfma_f32_16x16x32_bf16 v[204:207], a[64:67], a[240:243], v[204:207]
    v_exp_f32 v152, v152
    v_mfma_f32_16x16x16_bf16 v[144:147], v[64:65], v[142:143], v[144:147]
    v_exp_f32 v153, v153
    v_mfma_f32_16x16x32_bf16 v[200:203], a[68:71], a[240:243], v[200:203]
    v_exp_f32 v154, v154
    v_mfma_f32_16x16x32_bf16 v[220:223], a[240:243], a[132:135], v[220:223]
    v_cvt_pk_bf16_f32 v48, v208, v209
    v_cvt_pk_bf16_f32 v49, v210, v211
    v_mfma_f32_16x16x32_bf16 v[216:219], a[240:243], a[136:139], v[216:219]
    v_cvt_pk_bf16_f32 v50, v204, v205
    v_cvt_pk_bf16_f32 v51, v206, v207
    v_mfma_f32_16x16x32_bf16 v[212:215], a[240:243], a[140:143], v[212:215]
    s_waitcnt lgkmcnt(2)
    v_cvt_pk_bf16_f32 v52, v200, v201
    v_cvt_pk_bf16_f32 v53, v202, v203
    v_mfma_f32_16x16x32_bf16 v[148:151], v[48:51], v[138:141], v[148:151]
    v_cvt_pk_bf16_f32 v82, v220, v221
    v_cvt_pk_bf16_f32 v83, v222, v223
    v_mfma_f32_16x16x32_bf16 v[208:211], a[220:223], a[244:247], 0
    v_cvt_pk_bf16_f32 v104, v216, v217
    v_cvt_pk_bf16_f32 v105, v218, v219
    v_mfma_f32_16x16x32_bf16 v[200:203], a[220:223], v[252:255], 0
    v_cvt_pk_bf16_f32 v126, v212, v213
    v_cvt_pk_bf16_f32 v127, v214, v215
    v_mfma_f32_16x16x16_bf16 v[148:151], v[52:53], v[142:143], v[148:151]
    ds_read_b64_tr_b16 a[240:241], v241 offset:12296
    ds_read_b64_tr_b16 a[242:243], v241 offset:26120
    v_mfma_f32_16x16x32_bf16 v[204:207], a[224:227], a[244:247], 0
    v_exp_f32 v155, v155
    v_mfma_f32_16x16x32_bf16 v[220:223], a[224:227], v[252:255], 0
    ds_read_b64_tr_b16 v[252:253], v242 offset:12296
    ds_read_b64_tr_b16 v[254:255], v242 offset:26120
    v_mfma_f32_16x16x32_bf16 v[216:219], a[228:231], a[244:247], 0
    v_cvt_pk_bf16_f32 v182, v152, v153
    v_cvt_pk_bf16_f32 v183, v154, v155
    v_mfma_f32_16x16x32_bf16 v[212:215], a[232:235], a[244:247], 0
    ds_read_b64_tr_b16 a[244:245], v242 offset:12288
    ds_read_b64_tr_b16 a[246:247], v242 offset:26112
    v_mfma_f32_16x16x32_bf16 v[196:199], a[216:219], v[180:183], v[196:199]
    ds_read_b128 v[152:155], v228 offset:640
    v_max3_f32 v249, v159, v160, v161
    v_mfma_f32_16x16x32_bf16 v[184:187], v[74:77], v[180:183], v[184:187]
    v_max3_f32 v248, v248, v162, v163
    v_max3_f32 v249, v249, v164, v165
    v_mfma_f32_16x16x32_bf16 v[188:191], v[96:99], v[180:183], v[188:191]
    v_max3_f32 v248, v248, v166, v167
    v_max3_f32 v249, v249, v168, v169
    v_mfma_f32_16x16x32_bf16 v[192:195], v[118:121], v[180:183], v[192:195]
    s_waitcnt lgkmcnt(7)
    v_rcp_f32 v197, v196
    v_mfma_f32_16x16x32_bf16 v[208:211], a[236:239], a[248:251], v[208:211]
    v_mul_f32 v184, v184, v197
    v_mul_f32 v185, v185, v197
    v_mfma_f32_16x16x32_bf16 v[200:203], a[236:239], a[252:255], v[200:203]
    s_waitcnt lgkmcnt(5)
    ds_read_b64_tr_b16 a[236:237], v241 offset:13824
    ds_read_b64_tr_b16 a[238:239], v241 offset:24576
    v_mfma_f32_16x16x32_bf16 v[204:207], a[240:243], a[248:251], v[204:207]
    v_cvt_pk_bf16_f32 v184, v184, v185
    v_mul_f32 v186, v186, v197
    v_mfma_f32_16x16x32_bf16 v[220:223], a[240:243], a[252:255], v[220:223]
    s_waitcnt lgkmcnt(5)
    ds_read_b128 a[252:255], v240 offset:2048
    ds_read_b64_tr_b16 a[240:241], v241 offset:13832
    v_mfma_f32_16x16x32_bf16 v[212:215], v[252:255], a[248:251], v[212:215]
    s_waitcnt lgkmcnt(5)
    ds_read_b64_tr_b16 a[242:243], v241 offset:24584
    ds_read_b64_tr_b16 v[252:253], v242 offset:13832
    v_mfma_f32_16x16x32_bf16 v[216:219], a[244:247], a[248:251], v[216:219]
    s_waitcnt lgkmcnt(6)
    ds_read_b128 a[248:251], v239 offset:2048
    v_mul_f32 v187, v187, v197
    v_cvt_pk_bf16_f32 v185, v186, v187
    v_mul_f32 v188, v188, v197
    v_mfma_f32_16x16x32_bf16 v[152:155], v[0:3], v[132:135], v[152:155]
    ds_read_b64_tr_b16 a[244:245], v242 offset:13824
    v_mul_f32 v189, v189, v197
    ds_read_b64_tr_b16 a[246:247], v242 offset:24576
    v_cvt_pk_bf16_f32 v186, v188, v189
    ds_read_b64_tr_b16 v[254:255], v242 offset:24584
    v_mul_f32 v190, v190, v197
    v_mfma_f32_16x16x16_bf16 v[152:155], v[4:5], v[136:137], v[152:155]
    s_waitcnt lgkmcnt(7)
    v_mul_f32 v191, v191, v197
    v_cvt_pk_bf16_f32 v187, v190, v191
    v_mul_f32 v192, v192, v197
    v_mul_f32 v193, v193, v197
    v_cvt_pk_bf16_f32 v188, v192, v193
    v_mul_f32 v194, v194, v197
    v_mfma_f32_16x16x32_bf16 v[200:203], a[236:239], a[252:255], v[200:203]
    s_waitcnt lgkmcnt(5)
    v_mul_f32 v195, v195, v197
    v_cvt_pk_bf16_f32 v189, v194, v195
    ds_write_b128 v237, v[184:187] offset:12288
    v_mfma_f32_16x16x32_bf16 v[220:223], a[240:243], a[252:255], v[220:223]
    s_waitcnt lgkmcnt(4)
    ds_read_b128 a[252:255], v240 offset:3072
    ds_write_b64 v238, v[188:189] offset:12288
    v_mfma_f32_16x16x32_bf16 v[208:211], a[236:239], a[248:251], v[208:211]
    ds_read_b64_tr_b16 a[236:237], v241 offset:36864
    ds_read_b64_tr_b16 a[238:239], v241 offset:38400
    v_mfma_f32_16x16x32_bf16 v[204:207], a[240:243], a[248:251], v[204:207]
    s_waitcnt lgkmcnt(6)
    ds_read_b64_tr_b16 a[240:241], v241 offset:36872
    v_max3_f32 v248, v248, v170, v171
    v_mfma_f32_16x16x32_bf16 v[216:219], a[244:247], a[248:251], v[216:219]
    s_waitcnt lgkmcnt(6)
    ds_read_b64_tr_b16 a[242:243], v241 offset:38408
    v_max3_f32 v249, v249, v172, v173
    v_mfma_f32_16x16x32_bf16 v[212:215], v[252:255], a[248:251], v[212:215]
    s_waitcnt lgkmcnt(2)
    ds_read_b128 a[248:251], v239 offset:3072
    v_max3_f32 v248, v248, v174, v175
    v_max3_f32 v249, v249, v144, v145
    ds_read_b64_tr_b16 a[244:245], v242 offset:36864
    v_max3_f32 v248, v248, v146, v147
    ds_read_b64_tr_b16 a[246:247], v242 offset:38400
    v_max3_f32 v249, v249, v148, v149
    ds_read_b64_tr_b16 v[252:253], v242 offset:36872
    v_max3_f32 v248, v248, v150, v151
    ds_read_b64_tr_b16 v[254:255], v242 offset:38408
    v_max_f32 v248, v248, v249
    v_mov_b32 v249, v248
    s_nop 1
    v_permlane16_swap_b32 v248, v249
    v_max_f32 v248, v248, v249
    v_mov_b32 v249, v248
    s_nop 1
    v_mfma_f32_16x16x32_bf16 v[200:203], a[236:239], a[252:255], v[200:203]
    s_waitcnt lgkmcnt(5)
    v_permlane32_swap_b32 v248, v249
    v_max_f32 v248, v248, v249
    v_mul_f32 v236, s37, v248
    v_fma_f32 v156, v156, s37, -v236
    v_mfma_f32_16x16x32_bf16 v[220:223], a[240:243], a[252:255], v[220:223]
    s_waitcnt lgkmcnt(4)
    ds_read_b128 a[252:255], v240 offset:4096
    v_fma_f32 v157, v157, s37, -v236
    v_mfma_f32_16x16x32_bf16 v[208:211], a[236:239], a[248:251], v[208:211]
    ds_read_b64_tr_b16 a[236:237], v241 offset:49152
    ds_read_b64_tr_b16 a[238:239], v241 offset:62976
    v_mfma_f32_16x16x32_bf16 v[204:207], a[240:243], a[248:251], v[204:207]
    s_waitcnt lgkmcnt(5)
    ds_read_b64_tr_b16 a[240:241], v241 offset:49160
    ds_read_b64_tr_b16 a[242:243], v241 offset:62984
    v_mfma_f32_16x16x32_bf16 v[216:219], a[244:247], a[248:251], v[216:219]
    s_waitcnt lgkmcnt(5)
    ds_read_b64_tr_b16 a[244:245], v242 offset:49152
    v_fma_f32 v158, v158, s37, -v236
    v_fma_f32 v159, v159, s37, -v236
    v_exp_f32 v156, v156
    ds_read_b64_tr_b16 a[246:247], v242 offset:62976
    v_mfma_f32_16x16x32_bf16 v[212:215], v[252:255], a[248:251], v[212:215]
    s_waitcnt lgkmcnt(4)
    ds_read_b128 a[248:251], v239 offset:4096
    v_exp_f32 v157, v157
    ds_read_b64_tr_b16 v[252:253], v242 offset:49160
    ds_read_b64_tr_b16 v[254:255], v242 offset:62984
    v_exp_f32 v158, v158
    v_exp_f32 v159, v159
    v_cvt_pk_bf16_f32 v176, v156, v157
    v_cvt_pk_bf16_f32 v177, v158, v159
    ds_read_b128 v[156:159], v229 offset:640
    v_fma_f32 v160, v160, s37, -v236
    v_fma_f32 v161, v161, s37, -v236
    v_mfma_f32_16x16x32_bf16 v[200:203], a[236:239], a[252:255], v[200:203]
    s_waitcnt lgkmcnt(6)
    v_fma_f32 v162, v162, s37, -v236
    v_fma_f32 v163, v163, s37, -v236
    v_exp_f32 v160, v160
    v_exp_f32 v161, v161
    v_mfma_f32_16x16x32_bf16 v[220:223], a[240:243], a[252:255], v[220:223]
    s_waitcnt lgkmcnt(3)
    ds_read_b128 a[252:255], v240 offset:5120
    v_exp_f32 v162, v162
    v_exp_f32 v163, v163
    v_cvt_pk_bf16_f32 v178, v160, v161
    v_cvt_pk_bf16_f32 v179, v162, v163
    ds_read_b128 v[160:163], v229 offset:1280
    v_mfma_f32_16x16x32_bf16 v[208:211], a[236:239], a[248:251], v[208:211]
    ds_read_b64_tr_b16 a[236:237], v241 offset:50688
    ds_read_b64_tr_b16 a[238:239], v241 offset:61440
    v_mfma_f32_16x16x32_bf16 v[196:199], a[216:219], v[176:179], 0
    v_fma_f32 v164, v164, s37, -v236
    v_fma_f32 v165, v165, s37, -v236
    v_mfma_f32_16x16x32_bf16 v[184:187], v[76:79], v[176:179], 0
    v_fma_f32 v166, v166, s37, -v236
    v_fma_f32 v167, v167, s37, -v236
    v_mfma_f32_16x16x32_bf16 v[188:191], v[98:101], v[176:179], 0
    v_exp_f32 v164, v164
    v_mfma_f32_16x16x32_bf16 v[192:195], v[120:123], v[176:179], 0
    s_waitcnt lgkmcnt(4)
    v_exp_f32 v165, v165
    v_mfma_f32_16x16x32_bf16 v[156:159], v[24:27], v[132:135], v[156:159]
    v_exp_f32 v166, v166
    v_mfma_f32_16x16x32_bf16 v[204:207], a[240:243], a[248:251], v[204:207]
    ds_read_b64_tr_b16 a[240:241], v241 offset:50696
    ds_read_b64_tr_b16 a[242:243], v241 offset:61448
    v_mfma_f32_16x16x32_bf16 v[216:219], a[244:247], a[248:251], v[216:219]
    ds_read_b64_tr_b16 a[244:245], v242 offset:50688
    ds_read_b64_tr_b16 a[246:247], v242 offset:61440
    v_mfma_f32_16x16x16_bf16 v[156:159], v[28:29], v[136:137], v[156:159]
    s_waitcnt lgkmcnt(6)
    v_exp_f32 v167, v167
    v_mfma_f32_16x16x32_bf16 v[160:163], v[30:33], v[132:135], v[160:163]
    v_cvt_pk_bf16_f32 v180, v164, v165
    v_cvt_pk_bf16_f32 v181, v166, v167
    v_mfma_f32_16x16x32_bf16 v[212:215], v[252:255], a[248:251], v[212:215]
    s_waitcnt lgkmcnt(4)
    ds_read_b128 a[248:251], v239 offset:5120
    ds_read_b64_tr_b16 v[252:253], v242 offset:50696
    v_mfma_f32_16x16x32_bf16 v[200:203], a[236:239], a[252:255], v[200:203]
    ds_read_b64_tr_b16 v[254:255], v242 offset:61448
    ds_read_b128 v[164:167], v228 offset:1280
    v_mfma_f32_16x16x16_bf16 v[160:163], v[34:35], v[136:137], v[160:163]
    s_waitcnt lgkmcnt(6)
    v_fma_f32 v168, v168, s37, -v236
    v_fma_f32 v169, v169, s37, -v236
    v_fma_f32 v170, v170, s37, -v236
    v_fma_f32 v171, v171, s37, -v236
    v_exp_f32 v168, v168
    v_cvt_pk_bf16_f32 v200, v200, v201
    v_cvt_pk_bf16_f32 v201, v202, v203
    v_exp_f32 v169, v169
    v_exp_f32 v170, v170
    v_mfma_f32_16x16x32_bf16 v[220:223], a[240:243], a[252:255], v[220:223]
    ds_read_b128 a[252:255], v224 offset:46528
    v_exp_f32 v171, v171
    v_cvt_pk_bf16_f32 v182, v168, v169
    v_cvt_pk_bf16_f32 v183, v170, v171
    ds_read_b128 v[168:171], v228 offset:1920
    v_fma_f32 v172, v172, s37, -v236
    v_mfma_f32_16x16x32_bf16 v[196:199], a[216:219], v[180:183], v[196:199]
    v_fma_f32 v173, v173, s37, -v236
    v_cvt_pk_bf16_f32 v202, v220, v221
    v_mfma_f32_16x16x32_bf16 v[184:187], v[68:71], v[180:183], v[184:187]
    v_cvt_pk_bf16_f32 v203, v222, v223
    v_fma_f32 v174, v174, s37, -v236
    v_mfma_f32_16x16x32_bf16 v[188:191], v[90:93], v[180:183], v[188:191]
    buffer_store_dwordx4 v[200:203], v245, s[20:23], s58 offen sc0 sc1
    v_mfma_f32_16x16x32_bf16 v[192:195], v[112:115], v[180:183], v[192:195]
    s_waitcnt lgkmcnt(2)
    v_fma_f32 v175, v175, s37, -v236
    v_fma_f32 v144, v144, s37, -v236
    v_mfma_f32_16x16x32_bf16 v[164:167], v[6:9], v[132:135], v[164:167]
    v_exp_f32 v172, v172
    v_mfma_f32_16x16x32_bf16 v[208:211], a[236:239], a[248:251], v[208:211]
    ds_read_b128 a[236:239], v224 offset:46592
    v_fma_f32 v145, v145, s37, -v236
    v_mfma_f32_16x16x32_bf16 v[204:207], a[240:243], a[248:251], v[204:207]
    ds_read_b128 a[240:243], v224 offset:46656
    v_fma_f32 v146, v146, s37, -v236
    v_mfma_f32_16x16x16_bf16 v[164:167], v[10:11], v[136:137], v[164:167]
    s_waitcnt lgkmcnt(2)
    v_exp_f32 v173, v173
    v_mfma_f32_16x16x32_bf16 v[168:171], v[12:15], v[132:135], v[168:171]
    v_cvt_pk_bf16_f32 v208, v208, v209
    v_cvt_pk_bf16_f32 v209, v210, v211
    v_mfma_f32_16x16x32_bf16 v[216:219], a[244:247], a[248:251], v[216:219]
    ds_read_b128 a[244:247], v224 offset:46720
    v_cvt_pk_bf16_f32 v210, v204, v205
    v_mfma_f32_16x16x32_bf16 v[212:215], v[252:255], a[248:251], v[212:215]
    ds_read_b128 a[248:251], v224 offset:46464
    ds_read_b128 v[252:255], v224 offset:46784
    v_mfma_f32_16x16x16_bf16 v[168:171], v[16:17], v[136:137], v[168:171]
    s_waitcnt lgkmcnt(1)
    v_cvt_pk_bf16_f32 v211, v206, v207
    v_exp_f32 v174, v174
    v_cvt_pk_bf16_f32 v216, v216, v217
    v_cvt_pk_bf16_f32 v217, v218, v219
    v_exp_f32 v175, v175
    v_cvt_pk_bf16_f32 v218, v212, v213
    v_cvt_pk_bf16_f32 v219, v214, v215
    buffer_store_dwordx4 v[208:211], v243, s[20:23], s58 offen sc0 sc1
    v_cvt_pk_bf16_f32 v176, v172, v173
    v_cvt_pk_bf16_f32 v177, v174, v175
    ds_read_b128 v[172:175], v229 offset:1920
    v_fma_f32 v147, v147, s37, -v236
    v_exp_f32 v144, v144
    v_exp_f32 v145, v145
    v_exp_f32 v146, v146
    v_mfma_f32_16x16x32_bf16 v[208:211], a[0:3], a[248:251], 0
    v_exp_f32 v147, v147
    v_mfma_f32_16x16x32_bf16 v[204:207], a[4:7], a[248:251], 0
    v_cvt_pk_bf16_f32 v178, v144, v145
    v_cvt_pk_bf16_f32 v179, v146, v147
    v_mfma_f32_16x16x32_bf16 v[200:203], a[8:11], a[248:251], 0
    ds_read_b128 v[144:147], v229 offset:2560
    v_fma_f32 v148, v148, s37, -v236
    v_mfma_f32_16x16x32_bf16 v[196:199], a[216:219], v[176:179], v[196:199]
    v_fma_f32 v149, v149, s37, -v236
    v_fma_f32 v150, v150, s37, -v236
    v_mfma_f32_16x16x32_bf16 v[184:187], v[84:87], v[176:179], v[184:187]
    v_fma_f32 v151, v151, s37, -v236
    v_max3_f32 v248, v152, v153, v154
    v_mfma_f32_16x16x32_bf16 v[188:191], v[106:109], v[176:179], v[188:191]
    v_exp_f32 v148, v148
    v_mfma_f32_16x16x32_bf16 v[192:195], v[128:131], v[176:179], v[192:195]
    s_waitcnt lgkmcnt(1)
    v_exp_f32 v149, v149
    v_mfma_f32_16x16x32_bf16 v[172:175], v[36:39], v[132:135], v[172:175]
    v_exp_f32 v150, v150
    v_mfma_f32_16x16x32_bf16 v[220:223], a[248:251], a[72:75], 0
    buffer_store_dwordx4 v[216:219], v244, s[20:23], s58 offen sc0 sc1
    v_mfma_f32_16x16x32_bf16 v[212:215], a[248:251], a[80:83], 0
    s_add_u32 s58, s51, 0xfc000
    v_exp_f32 v151, v151
    v_mfma_f32_16x16x16_bf16 v[172:175], v[40:41], v[136:137], v[172:175]
    v_cvt_pk_bf16_f32 v180, v148, v149
    v_cvt_pk_bf16_f32 v181, v150, v151
    v_mfma_f32_16x16x32_bf16 v[216:219], a[248:251], a[76:79], 0
    ds_read_b128 a[248:251], v224 offset:49536
    ds_read_b128 v[148:151], v228 offset:2560
    v_mfma_f32_16x16x16_bf16 v[196:199], a[216:217], v[180:181], v[196:199]
    v_max3_f32 v249, v155, v156, v157
    v_max3_f32 v248, v248, v158, v159
    v_mfma_f32_16x16x16_bf16 v[184:187], v[82:83], v[180:181], v[184:187]
    v_max3_f32 v249, v249, v160, v161
    v_max3_f32 v248, v248, v162, v163
    v_mfma_f32_16x16x16_bf16 v[188:191], v[104:105], v[180:181], v[188:191]
    v_max3_f32 v249, v249, v164, v165
    v_max3_f32 v248, v248, v166, v167
    v_mfma_f32_16x16x16_bf16 v[192:195], v[126:127], v[180:181], v[192:195]
    v_rcp_f32 v197, v196
    v_mfma_f32_16x16x32_bf16 v[208:211], a[12:15], a[252:255], v[208:211]
    v_mul_f32 v184, v184, v197
    v_mul_f32 v185, v185, v197
    v_mfma_f32_16x16x32_bf16 v[204:207], a[16:19], a[252:255], v[204:207]
    v_cvt_pk_bf16_f32 v184, v184, v185
    v_mul_f32 v186, v186, v197
    v_mfma_f32_16x16x32_bf16 v[200:203], a[20:23], a[252:255], v[200:203]
    v_mul_f32 v187, v187, v197
    v_cvt_pk_bf16_f32 v185, v186, v187
    v_mfma_f32_16x16x32_bf16 v[220:223], a[252:255], a[84:87], v[220:223]
    v_mul_f32 v188, v188, v197
    v_mul_f32 v189, v189, v197
    v_mfma_f32_16x16x32_bf16 v[216:219], a[252:255], a[88:91], v[216:219]
    v_cvt_pk_bf16_f32 v186, v188, v189
    v_mul_f32 v190, v190, v197
    v_mfma_f32_16x16x32_bf16 v[212:215], a[252:255], a[92:95], v[212:215]
    ds_read_b128 a[252:255], v224 offset:49600
    v_mul_f32 v191, v191, v197
    v_mfma_f32_16x16x32_bf16 v[208:211], a[24:27], a[236:239], v[208:211]
    v_cvt_pk_bf16_f32 v187, v190, v191
    v_mul_f32 v192, v192, v197
    v_mfma_f32_16x16x32_bf16 v[204:207], a[28:31], a[236:239], v[204:207]
    v_mul_f32 v193, v193, v197
    v_cvt_pk_bf16_f32 v188, v192, v193
    v_mfma_f32_16x16x32_bf16 v[200:203], a[32:35], a[236:239], v[200:203]
    v_mul_f32 v194, v194, v197
    v_mul_f32 v195, v195, v197
    v_mfma_f32_16x16x32_bf16 v[220:223], a[236:239], a[96:99], v[220:223]
    v_cvt_pk_bf16_f32 v189, v194, v195
    v_max3_f32 v249, v249, v168, v169
    v_mfma_f32_16x16x32_bf16 v[216:219], a[236:239], a[100:103], v[216:219]
    ds_write_b128 v237, v[184:187] offset:18432
    v_mfma_f32_16x16x32_bf16 v[212:215], a[236:239], a[104:107], v[212:215]
    ds_read_b128 a[236:239], v224 offset:49664
    v_max3_f32 v248, v248, v170, v171
    v_mfma_f32_16x16x32_bf16 v[208:211], a[36:39], a[240:243], v[208:211]
    ds_write_b64 v238, v[188:189] offset:18432
    v_mfma_f32_16x16x32_bf16 v[204:207], a[40:43], a[240:243], v[204:207]
    v_max3_f32 v249, v249, v172, v173
    v_max3_f32 v248, v248, v174, v175
    v_mfma_f32_16x16x32_bf16 v[200:203], a[44:47], a[240:243], v[200:203]
    v_mfma_f32_16x16x32_bf16 v[220:223], a[240:243], a[108:111], v[220:223]
    v_mfma_f32_16x16x32_bf16 v[216:219], a[240:243], a[112:115], v[216:219]
    v_mfma_f32_16x16x32_bf16 v[212:215], a[240:243], a[116:119], v[212:215]
    ds_read_b128 a[240:243], v224 offset:49728
    v_mfma_f32_16x16x32_bf16 v[208:211], a[48:51], a[244:247], v[208:211]
    v_mfma_f32_16x16x32_bf16 v[204:207], a[52:55], a[244:247], v[204:207]
    v_mfma_f32_16x16x32_bf16 v[200:203], a[56:59], a[244:247], v[200:203]
    v_mfma_f32_16x16x32_bf16 v[220:223], a[244:247], a[120:123], v[220:223]
    v_mfma_f32_16x16x32_bf16 v[216:219], a[244:247], a[124:127], v[216:219]
    v_mfma_f32_16x16x32_bf16 v[212:215], a[244:247], a[128:131], v[212:215]
    ds_read_b128 a[244:247], v224 offset:49792
    v_mfma_f32_16x16x32_bf16 v[208:211], a[60:63], v[252:255], v[208:211]
    v_mfma_f32_16x16x32_bf16 v[204:207], a[64:67], v[252:255], v[204:207]
    v_mfma_f32_16x16x32_bf16 v[200:203], a[68:71], v[252:255], v[200:203]
    v_mfma_f32_16x16x32_bf16 v[220:223], v[252:255], a[132:135], v[220:223]
    v_mfma_f32_16x16x32_bf16 v[216:219], v[252:255], a[136:139], v[216:219]
    v_mfma_f32_16x16x32_bf16 v[212:215], v[252:255], a[140:143], v[212:215]
    s_waitcnt lgkmcnt(1)
    ds_read_b128 v[252:255], v224 offset:49856
    s_nop 1
    v_cvt_pk_bf16_f32 v18, v208, v209
    v_cvt_pk_bf16_f32 v19, v210, v211
    v_mfma_f32_16x16x32_bf16 v[208:211], a[0:3], a[248:251], 0
    v_cvt_pk_bf16_f32 v20, v204, v205
    v_cvt_pk_bf16_f32 v21, v206, v207
    v_mfma_f32_16x16x32_bf16 v[204:207], a[4:7], a[248:251], 0
    v_cvt_pk_bf16_f32 v22, v200, v201
    v_cvt_pk_bf16_f32 v23, v202, v203
    v_mfma_f32_16x16x32_bf16 v[148:151], v[18:21], v[132:135], v[148:151]
    v_cvt_pk_bf16_f32 v80, v220, v221
    v_cvt_pk_bf16_f32 v81, v222, v223
    v_mfma_f32_16x16x32_bf16 v[200:203], a[8:11], a[248:251], 0
    v_cvt_pk_bf16_f32 v102, v216, v217
    v_cvt_pk_bf16_f32 v103, v218, v219
    v_mfma_f32_16x16x32_bf16 v[220:223], a[248:251], a[72:75], 0
    v_cvt_pk_bf16_f32 v124, v212, v213
    v_cvt_pk_bf16_f32 v125, v214, v215
    v_mfma_f32_16x16x16_bf16 v[148:151], v[22:23], v[136:137], v[148:151]
    v_mfma_f32_16x16x32_bf16 v[216:219], a[248:251], a[76:79], 0
    v_mfma_f32_16x16x32_bf16 v[212:215], a[248:251], a[80:83], 0
    ds_read_b128 a[248:251], v225 offset:27456
    v_mfma_f32_16x16x32_bf16 v[208:211], a[12:15], a[252:255], v[208:211]
    v_mfma_f32_16x16x32_bf16 v[204:207], a[16:19], a[252:255], v[204:207]
    v_mfma_f32_16x16x32_bf16 v[200:203], a[20:23], a[252:255], v[200:203]
    v_mfma_f32_16x16x32_bf16 v[220:223], a[252:255], a[84:87], v[220:223]
    v_mfma_f32_16x16x32_bf16 v[216:219], a[252:255], a[88:91], v[216:219]
    v_mfma_f32_16x16x32_bf16 v[212:215], a[252:255], a[92:95], v[212:215]
    ds_read_b128 a[252:255], v225 offset:27520
    v_mfma_f32_16x16x32_bf16 v[208:211], a[24:27], a[236:239], v[208:211]
    v_mfma_f32_16x16x32_bf16 v[204:207], a[28:31], a[236:239], v[204:207]
    v_mfma_f32_16x16x32_bf16 v[200:203], a[32:35], a[236:239], v[200:203]
    v_mfma_f32_16x16x32_bf16 v[220:223], a[236:239], a[96:99], v[220:223]
    v_mfma_f32_16x16x32_bf16 v[216:219], a[236:239], a[100:103], v[216:219]
    v_mfma_f32_16x16x32_bf16 v[212:215], a[236:239], a[104:107], v[212:215]
    ds_read_b128 a[236:239], v225 offset:27584
    v_mfma_f32_16x16x32_bf16 v[208:211], a[36:39], a[240:243], v[208:211]
    v_mfma_f32_16x16x32_bf16 v[204:207], a[40:43], a[240:243], v[204:207]
    v_mfma_f32_16x16x32_bf16 v[200:203], a[44:47], a[240:243], v[200:203]
    v_mfma_f32_16x16x32_bf16 v[220:223], a[240:243], a[108:111], v[220:223]
    v_mfma_f32_16x16x32_bf16 v[216:219], a[240:243], a[112:115], v[216:219]
    v_mfma_f32_16x16x32_bf16 v[212:215], a[240:243], a[116:119], v[212:215]
    s_waitcnt lgkmcnt(1)
    ds_read_b128 a[240:243], v225 offset:27648
    v_mfma_f32_16x16x32_bf16 v[208:211], a[48:51], a[244:247], v[208:211]
    v_mfma_f32_16x16x32_bf16 v[204:207], a[52:55], a[244:247], v[204:207]
    v_mfma_f32_16x16x32_bf16 v[200:203], a[56:59], a[244:247], v[200:203]
    v_mfma_f32_16x16x32_bf16 v[220:223], a[244:247], a[120:123], v[220:223]
    v_mfma_f32_16x16x32_bf16 v[216:219], a[244:247], a[124:127], v[216:219]
    v_mfma_f32_16x16x32_bf16 v[212:215], a[244:247], a[128:131], v[212:215]
    ds_read_b128 a[244:247], v225 offset:27712
    v_mfma_f32_16x16x32_bf16 v[208:211], a[60:63], v[252:255], v[208:211]
    v_mfma_f32_16x16x32_bf16 v[204:207], a[64:67], v[252:255], v[204:207]
    v_mfma_f32_16x16x32_bf16 v[200:203], a[68:71], v[252:255], v[200:203]
    v_mfma_f32_16x16x32_bf16 v[220:223], v[252:255], a[132:135], v[220:223]
    v_mfma_f32_16x16x32_bf16 v[216:219], v[252:255], a[136:139], v[216:219]
    v_mfma_f32_16x16x32_bf16 v[212:215], v[252:255], a[140:143], v[212:215]
    ds_read_b128 v[252:255], v225 offset:27776
    s_nop 1
    v_cvt_pk_bf16_f32 v42, v208, v209
    v_cvt_pk_bf16_f32 v43, v210, v211
    v_mfma_f32_16x16x32_bf16 v[208:211], a[144:147], a[248:251], 0
    v_cvt_pk_bf16_f32 v44, v204, v205
    v_cvt_pk_bf16_f32 v45, v206, v207
    v_mfma_f32_16x16x32_bf16 v[204:207], a[148:151], a[248:251], 0
    v_cvt_pk_bf16_f32 v46, v200, v201
    v_cvt_pk_bf16_f32 v47, v202, v203
    v_mfma_f32_16x16x32_bf16 v[144:147], v[42:45], v[132:135], v[144:147]
    v_cvt_pk_bf16_f32 v78, v220, v221
    v_cvt_pk_bf16_f32 v79, v222, v223
    v_mfma_f32_16x16x32_bf16 v[200:203], a[152:155], a[248:251], 0
    v_cvt_pk_bf16_f32 v100, v216, v217
    v_cvt_pk_bf16_f32 v101, v218, v219
    v_mfma_f32_16x16x32_bf16 v[208:211], a[156:159], a[252:255], v[208:211]
    v_cvt_pk_bf16_f32 v122, v212, v213
    v_cvt_pk_bf16_f32 v123, v214, v215
    v_mfma_f32_16x16x16_bf16 v[144:147], v[46:47], v[136:137], v[144:147]
    s_waitcnt vmcnt(3) lgkmcnt(0)
    ds_read_b128 a[248:251], v225 offset:39872
    v_mfma_f32_16x16x32_bf16 v[204:207], a[160:163], a[252:255], v[204:207]
    s_barrier
    v_mfma_f32_16x16x32_bf16 v[200:203], a[164:167], a[252:255], v[200:203]
    ds_read_b128 a[252:255], v225 offset:39936
    v_mfma_f32_16x16x32_bf16 v[208:211], a[168:171], a[236:239], v[208:211]
    buffer_load_dwordx4 v246, s[4:7], s47 offen lds
    v_mfma_f32_16x16x32_bf16 v[204:207], a[172:175], a[236:239], v[204:207]
    s_add_u32 m0, s42, 0x3c80
    v_max3_f32 v249, v249, v144, v145
    v_max3_f32 v248, v248, v146, v147
    v_mfma_f32_16x16x32_bf16 v[200:203], a[176:179], a[236:239], v[200:203]
    ds_read_b128 a[236:239], v225 offset:40000
    v_max3_f32 v249, v249, v148, v149
    v_mfma_f32_16x16x32_bf16 v[208:211], a[180:183], a[240:243], v[208:211]
    v_max3_f32 v248, v248, v150, v151
    v_max_f32 v248, v248, v249
    v_mfma_f32_16x16x32_bf16 v[204:207], a[184:187], a[240:243], v[204:207]
    v_mov_b32 v249, v248
    v_mfma_f32_16x16x32_bf16 v[200:203], a[188:191], a[240:243], v[200:203]
    ds_read_b128 a[240:243], v225 offset:40064
    v_mfma_f32_16x16x32_bf16 v[208:211], a[192:195], a[244:247], v[208:211]
    v_permlane16_swap_b32 v248, v249
    v_mfma_f32_16x16x32_bf16 v[204:207], a[196:199], a[244:247], v[204:207]
    v_max_f32 v248, v248, v249
    v_mov_b32 v249, v248
    v_mfma_f32_16x16x32_bf16 v[200:203], a[200:203], a[244:247], v[200:203]
    ds_read_b128 a[244:247], v225 offset:40128
    v_mfma_f32_16x16x32_bf16 v[208:211], a[204:207], v[252:255], v[208:211]
    buffer_load_dwordx4 v247, s[4:7], s47 offen lds
    v_mfma_f32_16x16x32_bf16 v[204:207], a[208:211], v[252:255], v[204:207]
    s_add_u32 m0, s41, 0x5ac0
    v_permlane32_swap_b32 v248, v249
    v_mfma_f32_16x16x32_bf16 v[200:203], a[212:215], v[252:255], v[200:203]
    s_waitcnt lgkmcnt(3)
    ds_read_b128 v[252:255], v225 offset:40192
    v_max_f32 v248, v248, v249
    v_mfma_f32_16x16x32_bf16 v[220:223], a[144:147], a[248:251], 0
    v_cvt_pk_bf16_f32 v138, v208, v209
    v_cvt_pk_bf16_f32 v139, v210, v211
    v_mfma_f32_16x16x32_bf16 v[216:219], a[148:151], a[248:251], 0
    v_cvt_pk_bf16_f32 v140, v204, v205
    v_cvt_pk_bf16_f32 v141, v206, v207
    v_mfma_f32_16x16x32_bf16 v[212:215], a[152:155], a[248:251], 0
    v_cvt_pk_bf16_f32 v142, v200, v201
    v_cvt_pk_bf16_f32 v143, v202, v203
    v_mfma_f32_16x16x32_bf16 v[220:223], a[156:159], a[252:255], v[220:223]
    ds_read_b128 a[248:251], v239 offset:12288
    v_mul_f32 v236, s37, v248
    v_mfma_f32_16x16x32_bf16 v[216:219], a[160:163], a[252:255], v[216:219]
    v_fma_f32 v152, v152, s37, -v236
    v_fma_f32 v153, v153, s37, -v236
    v_mfma_f32_16x16x32_bf16 v[212:215], a[164:167], a[252:255], v[212:215]
    s_waitcnt lgkmcnt(3)
    buffer_load_dwordx4 v246, s[4:7], s48 offen lds
    v_mfma_f32_16x16x32_bf16 v[220:223], a[168:171], a[236:239], v[220:223]
    s_add_u32 m0, s42, 0x5ac0
    ds_read_b128 a[252:255], v240 offset:12288
    v_cndmask_b32 v246, v245, v243, vcc
    v_mfma_f32_16x16x32_bf16 v[216:219], a[172:175], a[236:239], v[216:219]
    v_fma_f32 v154, v154, s37, -v236
    v_fma_f32 v155, v155, s37, -v236
    v_mfma_f32_16x16x32_bf16 v[212:215], a[176:179], a[236:239], v[212:215]
    ds_read_b128 a[236:239], v239 offset:13312
    v_fma_f32 v156, v156, s37, -v236
    v_mfma_f32_16x16x32_bf16 v[220:223], a[180:183], a[240:243], v[220:223]
    v_exp_f32 v152, v152
    v_mfma_f32_16x16x32_bf16 v[216:219], a[184:187], a[240:243], v[216:219]
    v_exp_f32 v153, v153
    v_mfma_f32_16x16x32_bf16 v[212:215], a[188:191], a[240:243], v[212:215]
    s_waitcnt lgkmcnt(3)
    ds_read_b128 a[240:243], v240 offset:13312
    v_cvt_pk_bf16_f32 v176, v152, v153
    v_mfma_f32_16x16x32_bf16 v[220:223], a[192:195], a[244:247], v[220:223]
    v_exp_f32 v154, v154
    v_mfma_f32_16x16x32_bf16 v[216:219], a[196:199], a[244:247], v[216:219]
    buffer_load_dwordx4 v247, s[4:7], s48 offen lds
    v_mfma_f32_16x16x32_bf16 v[212:215], a[200:203], a[244:247], v[212:215]
    ds_read_b64_tr_b16 a[244:245], v241 offset:12288
    ds_read_b64_tr_b16 a[246:247], v241 offset:26112
    v_mfma_f32_16x16x32_bf16 v[220:223], a[204:207], v[252:255], v[220:223]
    v_bfrev_b32 v247, 1
    v_fma_f32 v157, v157, s37, -v236
    v_mfma_f32_16x16x32_bf16 v[216:219], a[208:211], v[252:255], v[216:219]
    v_exp_f32 v155, v155
    v_mfma_f32_16x16x32_bf16 v[212:215], a[212:215], v[252:255], v[212:215]
    s_waitcnt lgkmcnt(4)
    ds_read_b64_tr_b16 v[252:253], v241 offset:12296
    ds_read_b64_tr_b16 v[254:255], v241 offset:26120
    v_mfma_f32_16x16x32_bf16 v[208:211], a[220:223], a[248:251], 0
    v_cvt_pk_bf16_f32 v132, v220, v221
    v_cvt_pk_bf16_f32 v133, v222, v223
    v_mfma_f32_16x16x32_bf16 v[200:203], a[220:223], a[252:255], 0
    v_cvt_pk_bf16_f32 v134, v216, v217
    v_cvt_pk_bf16_f32 v135, v218, v219
    v_mfma_f32_16x16x32_bf16 v[204:207], a[224:227], a[248:251], 0
    v_cvt_pk_bf16_f32 v136, v212, v213
    v_cvt_pk_bf16_f32 v137, v214, v215
    v_mfma_f32_16x16x32_bf16 v[220:223], a[224:227], a[252:255], 0
    ds_read_b64_tr_b16 a[252:253], v242 offset:12296
    ds_read_b64_tr_b16 a[254:255], v242 offset:26120
    v_mfma_f32_16x16x32_bf16 v[216:219], a[228:231], a[248:251], 0
    v_cvt_pk_bf16_f32 v177, v154, v155
    v_fma_f32 v158, v158, s37, -v236
    v_mfma_f32_16x16x32_bf16 v[212:215], a[232:235], a[248:251], 0
    s_waitcnt lgkmcnt(4)
    ds_read_b64_tr_b16 a[248:249], v242 offset:12288
    ds_read_b64_tr_b16 a[250:251], v242 offset:26112
    v_mfma_f32_16x16x32_bf16 v[208:211], a[244:247], a[236:239], v[208:211]
    ds_read_b128 v[152:155], v230 offset:640
    v_fma_f32 v159, v159, s37, -v236
    v_mfma_f32_16x16x32_bf16 v[200:203], a[244:247], a[240:243], v[200:203]
    s_waitcnt lgkmcnt(5)
    ds_read_b64_tr_b16 a[244:245], v241 offset:13824
    v_exp_f32 v156, v156
    v_exp_f32 v157, v157
    v_mfma_f32_16x16x32_bf16 v[204:207], v[252:255], a[236:239], v[204:207]
    ds_read_b64_tr_b16 a[246:247], v241 offset:24576
    v_cvt_pk_bf16_f32 v178, v156, v157
    v_mfma_f32_16x16x32_bf16 v[220:223], v[252:255], a[240:243], v[220:223]
    s_waitcnt lgkmcnt(5)
    ds_read_b128 a[240:243], v240 offset:14336
    ds_read_b64_tr_b16 v[252:253], v241 offset:13832
    v_exp_f32 v158, v158
    v_exp_f32 v159, v159
    ds_read_b64_tr_b16 v[254:255], v241 offset:24584
    v_mfma_f32_16x16x32_bf16 v[212:215], a[252:255], a[236:239], v[212:215]
    ds_read_b64_tr_b16 a[252:253], v242 offset:13832
    v_cvt_pk_bf16_f32 v179, v158, v159
    ds_read_b64_tr_b16 a[254:255], v242 offset:24584
    v_fma_f32 v160, v160, s37, -v236
    v_mfma_f32_16x16x32_bf16 v[196:199], a[216:219], v[176:179], 0
    ds_read_b128 v[156:159], v230 offset:1280
    v_fma_f32 v161, v161, s37, -v236
    v_mfma_f32_16x16x32_bf16 v[184:187], v[66:69], v[176:179], 0
    v_fma_f32 v162, v162, s37, -v236
    v_fma_f32 v163, v163, s37, -v236
    v_mfma_f32_16x16x32_bf16 v[188:191], v[88:91], v[176:179], 0
    v_exp_f32 v160, v160
    v_mfma_f32_16x16x32_bf16 v[192:195], v[110:113], v[176:179], 0
    s_waitcnt lgkmcnt(8)
    v_exp_f32 v161, v161
    v_mfma_f32_16x16x32_bf16 v[152:155], v[24:27], v[138:141], v[152:155]
    v_exp_f32 v162, v162
    v_mfma_f32_16x16x32_bf16 v[216:219], a[248:251], a[236:239], v[216:219]
    s_waitcnt lgkmcnt(5)
    ds_read_b128 a[236:239], v239 offset:14336
    ds_read_b64_tr_b16 a[248:249], v242 offset:13824
    v_mfma_f32_16x16x32_bf16 v[200:203], a[244:247], a[240:243], v[200:203]
    ds_read_b64_tr_b16 a[250:251], v242 offset:24576
    v_cvt_pk_bf16_f32 v180, v160, v161
    v_mfma_f32_16x16x16_bf16 v[152:155], v[28:29], v[142:143], v[152:155]
    s_waitcnt lgkmcnt(6)
    v_exp_f32 v163, v163
    v_mfma_f32_16x16x32_bf16 v[220:223], v[252:255], a[240:243], v[220:223]
    s_waitcnt lgkmcnt(3)
    ds_read_b128 a[240:243], v240 offset:15360
    v_cvt_pk_bf16_f32 v181, v162, v163
    ds_read_b128 v[160:163], v230 offset:1920
    v_fma_f32 v164, v164, s37, -v236
    v_fma_f32 v165, v165, s37, -v236
    v_fma_f32 v166, v166, s37, -v236
    v_fma_f32 v167, v167, s37, -v236
    v_exp_f32 v164, v164
    v_mfma_f32_16x16x32_bf16 v[156:159], v[30:33], v[138:141], v[156:159]
    s_waitcnt lgkmcnt(4)
    v_exp_f32 v165, v165
    v_exp_f32 v166, v166
    v_exp_f32 v167, v167
    v_cvt_pk_bf16_f32 v182, v164, v165
    v_mfma_f32_16x16x32_bf16 v[208:211], a[244:247], a[236:239], v[208:211]
    ds_read_b64_tr_b16 a[244:245], v241 offset:36864
    ds_read_b64_tr_b16 a[246:247], v241 offset:38400
    v_mfma_f32_16x16x16_bf16 v[156:159], v[34:35], v[142:143], v[156:159]
    v_cvt_pk_bf16_f32 v183, v166, v167
    v_fma_f32 v168, v168, s37, -v236
    v_mfma_f32_16x16x32_bf16 v[204:207], v[252:255], a[236:239], v[204:207]
    ds_read_b64_tr_b16 v[252:253], v241 offset:36872
    ds_read_b64_tr_b16 v[254:255], v241 offset:38408
    v_mfma_f32_16x16x32_bf16 v[196:199], a[216:219], v[180:183], v[196:199]
    ds_read_b128 v[164:167], v230 offset:2560
    v_fma_f32 v169, v169, s37, -v236
    v_mfma_f32_16x16x32_bf16 v[184:187], v[70:73], v[180:183], v[184:187]
    v_fma_f32 v170, v170, s37, -v236
    v_fma_f32 v171, v171, s37, -v236
    v_mfma_f32_16x16x32_bf16 v[188:191], v[92:95], v[180:183], v[188:191]
    v_exp_f32 v168, v168
    v_mfma_f32_16x16x32_bf16 v[192:195], v[114:117], v[180:183], v[192:195]
    s_waitcnt lgkmcnt(5)
    v_exp_f32 v169, v169
    v_mfma_f32_16x16x32_bf16 v[160:163], v[36:39], v[138:141], v[160:163]
    v_exp_f32 v170, v170
    v_mfma_f32_16x16x32_bf16 v[216:219], a[248:251], a[236:239], v[216:219]
    ds_read_b64_tr_b16 a[248:249], v242 offset:36864
    ds_read_b64_tr_b16 a[250:251], v242 offset:38400
    v_mfma_f32_16x16x32_bf16 v[212:215], a[252:255], a[236:239], v[212:215]
    ds_read_b128 a[236:239], v239 offset:15360
    ds_read_b64_tr_b16 a[252:253], v242 offset:36872
    v_mfma_f32_16x16x16_bf16 v[160:163], v[40:41], v[142:143], v[160:163]
    s_waitcnt lgkmcnt(7)
    ds_read_b64_tr_b16 a[254:255], v242 offset:38408
    v_cvt_pk_bf16_f32 v176, v168, v169
    v_mfma_f32_16x16x32_bf16 v[200:203], a[244:247], a[240:243], v[200:203]
    s_waitcnt lgkmcnt(6)
    v_exp_f32 v171, v171
    v_mfma_f32_16x16x32_bf16 v[220:223], v[252:255], a[240:243], v[220:223]
    s_waitcnt lgkmcnt(5)
    ds_read_b128 a[240:243], v240 offset:16384
    v_cvt_pk_bf16_f32 v177, v170, v171
    ds_read_b128 v[168:171], v235
    v_mfma_f32_16x16x32_bf16 v[164:167], v[42:45], v[138:141], v[164:167]
    v_mad_u32_u24 v235, v234, s40, v229
    v_mad_u32_u24 v234, v234, s40, v228
    v_fma_f32 v172, v172, s37, -v236
    v_fma_f32 v173, v173, s37, -v236
    v_fma_f32 v174, v174, s37, -v236
    v_fma_f32 v175, v175, s37, -v236
    v_mfma_f32_16x16x16_bf16 v[164:167], v[46:47], v[142:143], v[164:167]
    s_waitcnt lgkmcnt(4)
    v_exp_f32 v172, v172
    v_exp_f32 v173, v173
    v_exp_f32 v174, v174
    v_exp_f32 v175, v175
    v_cvt_pk_bf16_f32 v178, v172, v173
    v_mfma_f32_16x16x32_bf16 v[208:211], a[244:247], a[236:239], v[208:211]
    ds_read_b64_tr_b16 a[244:245], v241 offset:49152
    ds_read_b64_tr_b16 a[246:247], v241 offset:62976
    v_mfma_f32_16x16x32_bf16 v[204:207], v[252:255], a[236:239], v[204:207]
    ds_read_b64_tr_b16 v[252:253], v241 offset:49160
    ds_read_b64_tr_b16 v[254:255], v241 offset:62984
    v_mfma_f32_16x16x32_bf16 v[216:219], a[248:251], a[236:239], v[216:219]
    s_waitcnt lgkmcnt(6)
    ds_read_b64_tr_b16 a[248:249], v242 offset:49152
    v_cvt_pk_bf16_f32 v179, v174, v175
    v_mfma_f32_16x16x32_bf16 v[212:215], a[252:255], a[236:239], v[212:215]
    ds_read_b128 a[236:239], v239 offset:16384
    v_fma_f32 v144, v144, s37, -v236
    v_mfma_f32_16x16x32_bf16 v[196:199], a[216:219], v[176:179], v[196:199]
    ds_read_b64_tr_b16 a[250:251], v242 offset:62976
    v_fma_f32 v145, v145, s37, -v236
    v_mfma_f32_16x16x32_bf16 v[184:187], v[74:77], v[176:179], v[184:187]
    ds_read_b64_tr_b16 a[252:253], v242 offset:49160
    v_fma_f32 v146, v146, s37, -v236
    v_mfma_f32_16x16x32_bf16 v[188:191], v[96:99], v[176:179], v[188:191]
    ds_read_b64_tr_b16 a[254:255], v242 offset:62984
    v_fma_f32 v147, v147, s37, -v236
    v_mfma_f32_16x16x32_bf16 v[192:195], v[118:121], v[176:179], v[192:195]
    s_waitcnt lgkmcnt(9)
    ds_read_b128 v[172:175], v250
    v_bfe_u32 v250, s74, v232, 4
    v_mfma_f32_16x16x32_bf16 v[168:171], v[60:63], v[138:141], v[168:171]
    s_waitcnt lgkmcnt(8)
    v_exp_f32 v144, v144
    v_exp_f32 v145, v145
    v_mfma_f32_16x16x32_bf16 v[200:203], a[244:247], a[240:243], v[200:203]
    v_exp_f32 v146, v146
    v_exp_f32 v147, v147
    v_cvt_pk_bf16_f32 v180, v144, v145
    v_mfma_f32_16x16x16_bf16 v[168:171], v[64:65], v[142:143], v[168:171]
    s_waitcnt lgkmcnt(6)
    v_cvt_pk_bf16_f32 v181, v146, v147
    v_fma_f32 v148, v148, s37, -v236
    v_mfma_f32_16x16x32_bf16 v[220:223], v[252:255], a[240:243], v[220:223]
    s_waitcnt lgkmcnt(4)
    ds_read_b128 a[240:243], v240 offset:17408
    ds_read_b128 v[144:147], v235
    v_bfe_u32 v235, s74, v232, 4
    v_mfma_f32_16x16x32_bf16 v[208:211], a[244:247], a[236:239], v[208:211]
    ds_read_b64_tr_b16 a[244:245], v241 offset:50688
    v_mad_u32_u24 v235, v235, s40, v230
    v_mfma_f32_16x16x32_bf16 v[204:207], v[252:255], a[236:239], v[204:207]
    s_waitcnt lgkmcnt(6)
    ds_read_b64_tr_b16 a[246:247], v241 offset:61440
    v_fma_f32 v149, v149, s37, -v236
    v_mfma_f32_16x16x32_bf16 v[216:219], a[248:251], a[236:239], v[216:219]
    s_waitcnt lgkmcnt(5)
    ds_read_b64_tr_b16 v[252:253], v241 offset:50696
    v_fma_f32 v150, v150, s37, -v236
    v_mfma_f32_16x16x32_bf16 v[212:215], a[252:255], a[236:239], v[212:215]
    s_waitcnt lgkmcnt(5)
    ds_read_b128 a[236:239], v239 offset:17408
    v_fma_f32 v151, v151, s37, -v236
    v_exp_f32 v148, v148
    ds_read_b64_tr_b16 v[254:255], v241 offset:61448
    v_mfma_f32_16x16x32_bf16 v[172:175], v[48:51], v[138:141], v[172:175]
    ds_read_b64_tr_b16 a[248:249], v242 offset:50688
    v_max3_f32 v248, v152, v153, v154
    ds_read_b64_tr_b16 a[250:251], v242 offset:61440
    v_exp_f32 v149, v149
    ds_read_b64_tr_b16 a[252:253], v242 offset:50696
    ds_read_b64_tr_b16 a[254:255], v242 offset:61448
    v_mfma_f32_16x16x16_bf16 v[172:175], v[52:53], v[142:143], v[172:175]
    s_waitcnt lgkmcnt(9)
    v_exp_f32 v150, v150
    v_mfma_f32_16x16x32_bf16 v[144:147], v[30:33], v[132:135], v[144:147]
    s_waitcnt lgkmcnt(7)
    v_exp_f32 v151, v151
    v_cvt_pk_bf16_f32 v182, v148, v149
    v_cvt_pk_bf16_f32 v183, v150, v151
    ds_read_b128 v[148:151], v234
    v_mfma_f32_16x16x32_bf16 v[200:203], a[244:247], a[240:243], v[200:203]
    v_mad_u32_u24 v234, v250, s40, v228
    v_mad_u32_u24 v250, v250, s40, v229
    v_mfma_f32_16x16x32_bf16 v[196:199], a[216:219], v[180:183], v[196:199]
    v_max3_f32 v249, v155, v156, v157
    v_max3_f32 v248, v248, v158, v159
    v_mfma_f32_16x16x32_bf16 v[184:187], v[78:81], v[180:183], v[184:187]
    v_max3_f32 v249, v249, v160, v161
    v_max3_f32 v248, v248, v162, v163
    v_mfma_f32_16x16x32_bf16 v[188:191], v[100:103], v[180:183], v[188:191]
    v_cvt_pk_bf16_f32 v200, v200, v201
    v_cvt_pk_bf16_f32 v201, v202, v203
    v_mfma_f32_16x16x32_bf16 v[192:195], v[122:125], v[180:183], v[192:195]
    v_rcp_f32 v197, v196
    v_mfma_f32_16x16x16_bf16 v[144:147], v[34:35], v[136:137], v[144:147]
    s_waitcnt lgkmcnt(4)
    v_mul_f32 v184, v184, v197
    v_mul_f32 v185, v185, v197
    v_mfma_f32_16x16x32_bf16 v[208:211], a[244:247], a[236:239], v[208:211]
    ds_read_b128 a[244:247], v224 offset:128
    v_cvt_pk_bf16_f32 v184, v184, v185
    v_mfma_f32_16x16x32_bf16 v[204:207], v[252:255], a[236:239], v[204:207]
    v_mul_f32 v186, v186, v197
    v_mul_f32 v187, v187, v197
    v_mfma_f32_16x16x32_bf16 v[220:223], v[252:255], a[240:243], v[220:223]
    s_waitcnt lgkmcnt(1)
    ds_read_b128 a[240:243], v224 offset:64
    ds_read_b128 v[252:255], v224 offset:192
    v_mfma_f32_16x16x32_bf16 v[148:151], v[6:9], v[132:135], v[148:151]
    v_cvt_pk_bf16_f32 v208, v208, v209
    v_cvt_pk_bf16_f32 v209, v210, v211
    v_mfma_f32_16x16x32_bf16 v[216:219], a[248:251], a[236:239], v[216:219]
    ds_read_b128 a[248:251], v224 offset:256
    v_cvt_pk_bf16_f32 v210, v204, v205
    v_mfma_f32_16x16x32_bf16 v[212:215], a[252:255], a[236:239], v[212:215]
    ds_read_b128 a[236:239], v224
    ds_read_b128 a[252:255], v224 offset:320
    v_mfma_f32_16x16x16_bf16 v[148:151], v[10:11], v[136:137], v[148:151]
    s_waitcnt lgkmcnt(1)
    v_cvt_pk_bf16_f32 v211, v206, v207
    buffer_store_dwordx4 v[208:211], v243, s[20:23], s58 offen sc0 sc1
    v_cvt_pk_bf16_f32 v202, v220, v221
    v_cvt_pk_bf16_f32 v203, v222, v223
    v_cvt_pk_bf16_f32 v216, v216, v217
    v_cvt_pk_bf16_f32 v217, v218, v219
    v_cvt_pk_bf16_f32 v218, v212, v213
    v_cvt_pk_bf16_f32 v219, v214, v215
    v_cvt_pk_bf16_f32 v185, v186, v187
    v_mul_f32 v188, v188, v197
    v_mul_f32 v189, v189, v197
    v_cvt_pk_bf16_f32 v186, v188, v189
    v_mul_f32 v190, v190, v197
    v_mul_f32 v191, v191, v197
    v_cvt_pk_bf16_f32 v187, v190, v191
    v_mul_f32 v192, v192, v197
    v_mul_f32 v193, v193, v197
    v_cvt_pk_bf16_f32 v188, v192, v193
    v_mul_f32 v194, v194, v197
    v_mul_f32 v195, v195, v197
    v_cvt_pk_bf16_f32 v189, v194, v195
    ds_write_b128 v237, v[184:187]
    v_mfma_f32_16x16x32_bf16 v[208:211], a[0:3], a[236:239], 0
    ds_write_b64 v238, v[188:189]
    v_mfma_f32_16x16x32_bf16 v[204:207], a[4:7], a[236:239], 0
    v_max3_f32 v249, v249, v164, v165
    v_max3_f32 v248, v248, v166, v167
    v_mfma_f32_16x16x32_bf16 v[220:223], a[236:239], a[72:75], 0
    v_max3_f32 v249, v249, v168, v169
    v_max3_f32 v248, v248, v170, v171
    v_mfma_f32_16x16x32_bf16 v[212:215], a[236:239], a[80:83], 0
    v_max3_f32 v249, v249, v172, v173
    v_max3_f32 v248, v248, v174, v175
    v_mfma_f32_16x16x32_bf16 v[208:211], a[12:15], a[240:243], v[208:211]
    buffer_store_dwordx4 v[200:203], v245, s[20:23], s58 offen sc0 sc1
    v_mfma_f32_16x16x32_bf16 v[204:207], a[16:19], a[240:243], v[204:207]
    v_max_f32 v248, v248, v249
    v_mov_b32 v249, v248
    v_mfma_f32_16x16x32_bf16 v[200:203], a[8:11], a[236:239], 0
    v_mfma_f32_16x16x32_bf16 v[200:203], a[20:23], a[240:243], v[200:203]
    v_permlane16_swap_b32 v248, v249
    v_mfma_f32_16x16x32_bf16 v[220:223], a[240:243], a[84:87], v[220:223]
    v_max_f32 v248, v248, v249
    v_mov_b32 v249, v248
    v_mfma_f32_16x16x32_bf16 v[212:215], a[240:243], a[92:95], v[212:215]
    v_mfma_f32_16x16x32_bf16 v[208:211], a[24:27], a[244:247], v[208:211]
    v_permlane32_swap_b32 v248, v249
    v_mfma_f32_16x16x32_bf16 v[204:207], a[28:31], a[244:247], v[204:207]
    v_max_f32 v248, v248, v249
    v_mul_f32 v236, s37, v248
    v_mfma_f32_16x16x32_bf16 v[200:203], a[32:35], a[244:247], v[200:203]
    v_fma_f32 v152, v152, s37, -v236
    v_fma_f32 v153, v153, s37, -v236
    v_mfma_f32_16x16x32_bf16 v[220:223], a[244:247], a[96:99], v[220:223]
    v_fma_f32 v154, v154, s37, -v236
    v_fma_f32 v155, v155, s37, -v236
    v_mfma_f32_16x16x32_bf16 v[212:215], a[244:247], a[104:107], v[212:215]
    v_exp_f32 v152, v152
    v_mfma_f32_16x16x32_bf16 v[208:211], a[36:39], v[252:255], v[208:211]
    v_exp_f32 v153, v153
    v_mfma_f32_16x16x32_bf16 v[204:207], a[40:43], v[252:255], v[204:207]
    buffer_store_dwordx4 v[216:219], v244, s[20:23], s58 offen sc0 sc1
    v_mfma_f32_16x16x32_bf16 v[200:203], a[44:47], v[252:255], v[200:203]
    s_add_u32 s58, s51, 0x150000
    v_exp_f32 v154, v154
    v_mfma_f32_16x16x32_bf16 v[216:219], a[236:239], a[76:79], 0
    ds_read_b128 a[236:239], v224 offset:3072
    v_cvt_pk_bf16_f32 v176, v152, v153
    v_mfma_f32_16x16x32_bf16 v[216:219], a[240:243], a[88:91], v[216:219]
    ds_read_b128 a[240:243], v224 offset:3136
    v_fma_f32 v156, v156, s37, -v236
    v_mfma_f32_16x16x32_bf16 v[216:219], a[244:247], a[100:103], v[216:219]
    ds_read_b128 a[244:247], v224 offset:3200
    v_fma_f32 v157, v157, s37, -v236
    v_mfma_f32_16x16x32_bf16 v[220:223], v[252:255], a[108:111], v[220:223]
    v_exp_f32 v155, v155
    v_mfma_f32_16x16x32_bf16 v[216:219], v[252:255], a[112:115], v[216:219]
    v_cvt_pk_bf16_f32 v177, v154, v155
    v_fma_f32 v158, v158, s37, -v236
    v_mfma_f32_16x16x32_bf16 v[212:215], v[252:255], a[116:119], v[212:215]
    ds_read_b128 v[252:255], v224 offset:3264
    ds_read_b128 v[152:155], v228 offset:1280
    v_mfma_f32_16x16x32_bf16 v[208:211], a[48:51], a[248:251], v[208:211]
    v_fma_f32 v159, v159, s37, -v236
    v_fma_f32 v160, v160, s37, -v236
    v_mfma_f32_16x16x32_bf16 v[204:207], a[52:55], a[248:251], v[204:207]
    v_exp_f32 v156, v156
    v_mfma_f32_16x16x32_bf16 v[200:203], a[56:59], a[248:251], v[200:203]
    v_exp_f32 v157, v157
    v_mfma_f32_16x16x32_bf16 v[220:223], a[248:251], a[120:123], v[220:223]
    v_exp_f32 v158, v158
    v_mfma_f32_16x16x32_bf16 v[216:219], a[248:251], a[124:127], v[216:219]
    v_exp_f32 v159, v159
    v_mfma_f32_16x16x32_bf16 v[212:215], a[248:251], a[128:131], v[212:215]
    s_waitcnt lgkmcnt(3)
    ds_read_b128 a[248:251], v224 offset:3328
    v_cvt_pk_bf16_f32 v178, v156, v157
    v_mfma_f32_16x16x32_bf16 v[208:211], a[60:63], a[252:255], v[208:211]
    v_cvt_pk_bf16_f32 v179, v158, v159
    v_fma_f32 v161, v161, s37, -v236
    v_mfma_f32_16x16x32_bf16 v[204:207], a[64:67], a[252:255], v[204:207]
    ds_read_b128 v[156:159], v229 offset:1280
    v_fma_f32 v162, v162, s37, -v236
    v_mfma_f32_16x16x32_bf16 v[196:199], a[216:219], v[176:179], 0
    v_fma_f32 v163, v163, s37, -v236
    v_fma_f32 v164, v164, s37, -v236
    v_mfma_f32_16x16x32_bf16 v[184:187], v[68:71], v[176:179], 0
    v_cvt_pk_bf16_f32 v0, v208, v209
    v_cvt_pk_bf16_f32 v1, v210, v211
    v_mfma_f32_16x16x32_bf16 v[188:191], v[90:93], v[176:179], 0
    v_cvt_pk_bf16_f32 v2, v204, v205
    v_cvt_pk_bf16_f32 v3, v206, v207
    v_mfma_f32_16x16x32_bf16 v[192:195], v[112:115], v[176:179], 0
    s_waitcnt lgkmcnt(2)
    v_exp_f32 v160, v160
    v_mfma_f32_16x16x32_bf16 v[152:155], v[12:15], v[132:135], v[152:155]
    v_exp_f32 v161, v161
    v_mfma_f32_16x16x32_bf16 v[200:203], a[68:71], a[252:255], v[200:203]
    v_exp_f32 v162, v162
    v_mfma_f32_16x16x32_bf16 v[220:223], a[252:255], a[132:135], v[220:223]
    v_exp_f32 v163, v163
    v_mfma_f32_16x16x32_bf16 v[216:219], a[252:255], a[136:139], v[216:219]
    v_cvt_pk_bf16_f32 v180, v160, v161
    v_cvt_pk_bf16_f32 v181, v162, v163
    v_mfma_f32_16x16x16_bf16 v[152:155], v[16:17], v[136:137], v[152:155]
    s_waitcnt lgkmcnt(0)
    ds_read_b128 v[160:163], v229 offset:1920
    v_cvt_pk_bf16_f32 v4, v200, v201
    v_mfma_f32_16x16x32_bf16 v[156:159], v[36:39], v[132:135], v[156:159]
    v_cvt_pk_bf16_f32 v5, v202, v203
    v_cvt_pk_bf16_f32 v66, v220, v221
    v_mfma_f32_16x16x32_bf16 v[212:215], a[252:255], a[140:143], v[212:215]
    v_cvt_pk_bf16_f32 v67, v222, v223
    v_cvt_pk_bf16_f32 v88, v216, v217
    v_mfma_f32_16x16x32_bf16 v[208:211], a[0:3], a[236:239], 0
    ds_read_b128 a[252:255], v224 offset:3392
    v_cvt_pk_bf16_f32 v89, v218, v219
    v_mfma_f32_16x16x16_bf16 v[156:159], v[40:41], v[136:137], v[156:159]
    v_fma_f32 v165, v165, s37, -v236
    v_fma_f32 v166, v166, s37, -v236
    v_mfma_f32_16x16x32_bf16 v[204:207], a[4:7], a[236:239], 0
    v_cvt_pk_bf16_f32 v110, v212, v213
    v_cvt_pk_bf16_f32 v111, v214, v215
    v_mfma_f32_16x16x32_bf16 v[200:203], a[8:11], a[236:239], 0
    v_fma_f32 v167, v167, s37, -v236
    v_fma_f32 v168, v168, s37, -v236
    v_mfma_f32_16x16x32_bf16 v[220:223], a[236:239], a[72:75], 0
    v_exp_f32 v164, v164
    v_mfma_f32_16x16x32_bf16 v[216:219], a[236:239], a[76:79], 0
    v_exp_f32 v165, v165
    v_mfma_f32_16x16x32_bf16 v[212:215], a[236:239], a[80:83], 0
    s_waitcnt lgkmcnt(1)
    ds_read_b128 a[236:239], v225 offset:42944
    v_cvt_pk_bf16_f32 v182, v164, v165
    v_mfma_f32_16x16x32_bf16 v[160:163], v[42:45], v[132:135], v[160:163]
    v_exp_f32 v166, v166
    v_mfma_f32_16x16x32_bf16 v[208:211], a[12:15], a[240:243], v[208:211]
    v_exp_f32 v167, v167
    v_mfma_f32_16x16x32_bf16 v[204:207], a[16:19], a[240:243], v[204:207]
    v_cvt_pk_bf16_f32 v183, v166, v167
    v_fma_f32 v169, v169, s37, -v236
    v_mfma_f32_16x16x16_bf16 v[160:163], v[46:47], v[136:137], v[160:163]
    ds_read_b128 v[164:167], v228 offset:1920
    v_fma_f32 v170, v170, s37, -v236
    v_mfma_f32_16x16x32_bf16 v[196:199], a[216:219], v[180:183], v[196:199]
    v_fma_f32 v171, v171, s37, -v236
    v_fma_f32 v172, v172, s37, -v236
    v_mfma_f32_16x16x32_bf16 v[184:187], v[76:79], v[180:183], v[184:187]
    v_exp_f32 v168, v168
    v_mfma_f32_16x16x32_bf16 v[188:191], v[98:101], v[180:183], v[188:191]
    v_exp_f32 v169, v169
    v_mfma_f32_16x16x32_bf16 v[192:195], v[120:123], v[180:183], v[192:195]
    v_exp_f32 v170, v170
    v_mfma_f32_16x16x32_bf16 v[200:203], a[20:23], a[240:243], v[200:203]
    v_exp_f32 v171, v171
    v_mfma_f32_16x16x32_bf16 v[220:223], a[240:243], a[84:87], v[220:223]
    v_cvt_pk_bf16_f32 v176, v168, v169
    v_cvt_pk_bf16_f32 v177, v170, v171
    v_mfma_f32_16x16x32_bf16 v[216:219], a[240:243], a[88:91], v[216:219]
    ds_read_b128 v[168:171], v234
    v_bfe_u32 v234, s67, v233, 4
    v_mfma_f32_16x16x16_bf16 v[196:199], a[216:217], v[176:177], v[196:199]
    v_mad_u32_u24 v234, v234, s40, v231
    v_fma_f32 v173, v173, s37, -v236
    v_mfma_f32_16x16x16_bf16 v[184:187], v[86:87], v[176:177], v[184:187]
    v_fma_f32 v174, v174, s37, -v236
    v_fma_f32 v175, v175, s37, -v236
    v_mfma_f32_16x16x16_bf16 v[188:191], v[108:109], v[176:177], v[188:191]
    v_exp_f32 v172, v172
    v_mfma_f32_16x16x16_bf16 v[192:195], v[130:131], v[176:177], v[192:195]
    s_waitcnt lgkmcnt(1)
    v_exp_f32 v173, v173
    v_mfma_f32_16x16x32_bf16 v[164:167], v[18:21], v[132:135], v[164:167]
    v_exp_f32 v174, v174
    v_mfma_f32_16x16x32_bf16 v[212:215], a[240:243], a[92:95], v[212:215]
    ds_read_b128 a[240:243], v225 offset:43008
    v_cvt_pk_bf16_f32 v180, v172, v173
    v_mfma_f32_16x16x32_bf16 v[208:211], a[24:27], a[244:247], v[208:211]
    v_exp_f32 v175, v175
    v_mfma_f32_16x16x16_bf16 v[164:167], v[22:23], v[136:137], v[164:167]
    v_cvt_pk_bf16_f32 v181, v174, v175
    v_max3_f32 v248, v144, v145, v146
    v_mfma_f32_16x16x32_bf16 v[204:207], a[28:31], a[244:247], v[204:207]
    ds_read_b128 v[172:175], v250
    v_bfe_u32 v250, s73, v232, 4
    v_mfma_f32_16x16x16_bf16 v[196:199], a[216:217], v[180:181], v[196:199]
    v_mad_u32_u24 v250, v250, s40, v230
    v_max3_f32 v249, v147, v148, v149
    v_mfma_f32_16x16x16_bf16 v[184:187], v[82:83], v[180:181], v[184:187]
    v_max3_f32 v248, v248, v150, v151
    v_max3_f32 v249, v249, v152, v153
    v_mfma_f32_16x16x16_bf16 v[188:191], v[104:105], v[180:181], v[188:191]
    v_max3_f32 v248, v248, v154, v155
    v_max3_f32 v249, v249, v156, v157
    v_mfma_f32_16x16x16_bf16 v[192:195], v[126:127], v[180:181], v[192:195]
    s_waitcnt lgkmcnt(2)
    v_rcp_f32 v197, v196
    v_mfma_f32_16x16x32_bf16 v[168:171], v[0:3], v[132:135], v[168:171]
    v_mul_f32 v184, v184, v197
    v_mul_f32 v185, v185, v197
    v_mfma_f32_16x16x32_bf16 v[200:203], a[32:35], a[244:247], v[200:203]
    v_cvt_pk_bf16_f32 v184, v184, v185
    v_mul_f32 v186, v186, v197
    v_mfma_f32_16x16x32_bf16 v[220:223], a[244:247], a[96:99], v[220:223]
    v_mul_f32 v187, v187, v197
    v_cvt_pk_bf16_f32 v185, v186, v187
    v_mfma_f32_16x16x16_bf16 v[168:171], v[4:5], v[136:137], v[168:171]
    v_mul_f32 v188, v188, v197
    v_mul_f32 v189, v189, v197
    v_mfma_f32_16x16x32_bf16 v[216:219], a[244:247], a[100:103], v[216:219]
    v_cvt_pk_bf16_f32 v186, v188, v189
    v_mul_f32 v190, v190, v197
    v_mfma_f32_16x16x32_bf16 v[212:215], a[244:247], a[104:107], v[212:215]
    ds_read_b128 a[244:247], v225 offset:43072
    v_mul_f32 v191, v191, v197
    v_mfma_f32_16x16x32_bf16 v[208:211], a[36:39], v[252:255], v[208:211]
    v_cvt_pk_bf16_f32 v187, v190, v191
    v_mul_f32 v192, v192, v197
    v_mfma_f32_16x16x32_bf16 v[204:207], a[40:43], v[252:255], v[204:207]
    v_mul_f32 v193, v193, v197
    v_cvt_pk_bf16_f32 v188, v192, v193
    v_mfma_f32_16x16x32_bf16 v[200:203], a[44:47], v[252:255], v[200:203]
    v_mul_f32 v194, v194, v197
    v_mul_f32 v195, v195, v197
    v_mfma_f32_16x16x32_bf16 v[220:223], v[252:255], a[108:111], v[220:223]
    v_cvt_pk_bf16_f32 v189, v194, v195
    v_max3_f32 v248, v248, v158, v159
    v_mfma_f32_16x16x32_bf16 v[216:219], v[252:255], a[112:115], v[216:219]
    ds_write_b128 v237, v[184:187] offset:6144
    v_mfma_f32_16x16x32_bf16 v[212:215], v[252:255], a[116:119], v[212:215]
    ds_read_b128 v[252:255], v225 offset:43136
    v_max3_f32 v249, v249, v160, v161
    v_mfma_f32_16x16x32_bf16 v[208:211], a[48:51], a[248:251], v[208:211]
    ds_write_b64 v238, v[188:189] offset:6144
    v_mfma_f32_16x16x32_bf16 v[204:207], a[52:55], a[248:251], v[204:207]
    v_max3_f32 v248, v248, v162, v163
    v_max3_f32 v249, v249, v164, v165
    v_mfma_f32_16x16x32_bf16 v[200:203], a[56:59], a[248:251], v[200:203]
    v_max3_f32 v248, v248, v166, v167
    v_max3_f32 v249, v249, v168, v169
    v_mfma_f32_16x16x32_bf16 v[220:223], a[248:251], a[120:123], v[220:223]
    v_max3_f32 v248, v248, v170, v171
    v_mfma_f32_16x16x32_bf16 v[216:219], a[248:251], a[124:127], v[216:219]
    v_mfma_f32_16x16x32_bf16 v[212:215], a[248:251], a[128:131], v[212:215]
    ds_read_b128 a[248:251], v225 offset:43200
    v_mfma_f32_16x16x32_bf16 v[208:211], a[60:63], a[252:255], v[208:211]
    v_mfma_f32_16x16x32_bf16 v[204:207], a[64:67], a[252:255], v[204:207]
    s_waitcnt vmcnt(3) lgkmcnt(1)
    v_mfma_f32_16x16x32_bf16 v[200:203], a[68:71], a[252:255], v[200:203]
    s_barrier
    v_mfma_f32_16x16x32_bf16 v[220:223], a[252:255], a[132:135], v[220:223]
    v_mfma_f32_16x16x32_bf16 v[216:219], a[252:255], a[136:139], v[216:219]
    v_mfma_f32_16x16x32_bf16 v[212:215], a[252:255], a[140:143], v[212:215]
    ds_read_b128 a[252:255], v225 offset:43264
    v_cndmask_b32 v225, v243, v245, vcc
    v_cvt_pk_bf16_f32 v24, v208, v209
    v_cvt_pk_bf16_f32 v25, v210, v211
    v_mfma_f32_16x16x32_bf16 v[208:211], a[144:147], a[236:239], 0
    v_cvt_pk_bf16_f32 v26, v204, v205
    v_cvt_pk_bf16_f32 v27, v206, v207
    v_mfma_f32_16x16x32_bf16 v[204:207], a[148:151], a[236:239], 0
    v_cvt_pk_bf16_f32 v28, v200, v201
    v_cvt_pk_bf16_f32 v29, v202, v203
    v_mfma_f32_16x16x32_bf16 v[172:175], v[24:27], v[132:135], v[172:175]
    v_cvt_pk_bf16_f32 v68, v220, v221
    v_cvt_pk_bf16_f32 v69, v222, v223
    v_mfma_f32_16x16x32_bf16 v[200:203], a[152:155], a[236:239], 0
    v_cvt_pk_bf16_f32 v90, v216, v217
    v_cvt_pk_bf16_f32 v91, v218, v219
    v_mfma_f32_16x16x32_bf16 v[208:211], a[156:159], a[240:243], v[208:211]
    v_cvt_pk_bf16_f32 v112, v212, v213
    v_cvt_pk_bf16_f32 v113, v214, v215
    v_mfma_f32_16x16x16_bf16 v[172:175], v[28:29], v[136:137], v[172:175]
    ds_read_b128 a[236:239], v226 offset:1152
    v_mfma_f32_16x16x32_bf16 v[204:207], a[160:163], a[240:243], v[204:207]
    v_mfma_f32_16x16x32_bf16 v[200:203], a[164:167], a[240:243], v[200:203]
    ds_read_b128 a[240:243], v226 offset:1216
    v_mfma_f32_16x16x32_bf16 v[208:211], a[168:171], a[244:247], v[208:211]
    v_mfma_f32_16x16x32_bf16 v[204:207], a[172:175], a[244:247], v[204:207]
    v_mfma_f32_16x16x32_bf16 v[200:203], a[176:179], a[244:247], v[200:203]
    ds_read_b128 a[244:247], v226 offset:1280
    v_max3_f32 v249, v249, v172, v173
    v_mfma_f32_16x16x32_bf16 v[208:211], a[180:183], v[252:255], v[208:211]
    v_max3_f32 v248, v248, v174, v175
    v_max_f32 v248, v248, v249
    v_mfma_f32_16x16x32_bf16 v[204:207], a[184:187], v[252:255], v[204:207]
    v_mov_b32 v249, v248
    v_mfma_f32_16x16x32_bf16 v[200:203], a[188:191], v[252:255], v[200:203]
    s_waitcnt lgkmcnt(3)
    ds_read_b128 v[252:255], v226 offset:1344
    v_mfma_f32_16x16x32_bf16 v[208:211], a[192:195], a[248:251], v[208:211]
    v_permlane16_swap_b32 v248, v249
    v_mfma_f32_16x16x32_bf16 v[204:207], a[196:199], a[248:251], v[204:207]
    v_max_f32 v248, v248, v249
    v_mov_b32 v249, v248
    v_mfma_f32_16x16x32_bf16 v[200:203], a[200:203], a[248:251], v[200:203]
    ds_read_b128 a[248:251], v226 offset:1408
    v_mfma_f32_16x16x32_bf16 v[208:211], a[204:207], a[252:255], v[208:211]
    v_permlane32_swap_b32 v248, v249
    v_mfma_f32_16x16x32_bf16 v[204:207], a[208:211], a[252:255], v[204:207]
    v_max_f32 v248, v248, v249
    v_mul_f32 v236, s37, v248
    v_mfma_f32_16x16x32_bf16 v[200:203], a[212:215], a[252:255], v[200:203]
    s_waitcnt lgkmcnt(3)
    ds_read_b128 a[252:255], v226 offset:1472
    v_fma_f32 v144, v144, s37, -v236
    v_mfma_f32_16x16x32_bf16 v[220:223], a[144:147], a[236:239], 0
    v_cvt_pk_bf16_f32 v138, v208, v209
    v_cvt_pk_bf16_f32 v139, v210, v211
    v_mfma_f32_16x16x32_bf16 v[216:219], a[148:151], a[236:239], 0
    v_cvt_pk_bf16_f32 v140, v204, v205
    v_cvt_pk_bf16_f32 v141, v206, v207
    v_mfma_f32_16x16x32_bf16 v[212:215], a[152:155], a[236:239], 0
    v_cvt_pk_bf16_f32 v142, v200, v201
    v_cvt_pk_bf16_f32 v143, v202, v203
    v_mfma_f32_16x16x32_bf16 v[220:223], a[156:159], a[240:243], v[220:223]
    ds_read_b128 a[236:239], v227 offset:6144
    v_fma_f32 v145, v145, s37, -v236
    v_mfma_f32_16x16x32_bf16 v[216:219], a[160:163], a[240:243], v[216:219]
    v_fma_f32 v146, v146, s37, -v236
    v_fma_f32 v147, v147, s37, -v236
    v_mfma_f32_16x16x32_bf16 v[212:215], a[164:167], a[240:243], v[212:215]
    s_waitcnt lgkmcnt(3)
    ds_read_b128 a[240:243], v227 offset:6208
    v_fma_f32 v148, v148, s37, -v236
    v_mfma_f32_16x16x32_bf16 v[220:223], a[168:171], a[244:247], v[220:223]
    v_exp_f32 v144, v144
    v_mfma_f32_16x16x32_bf16 v[216:219], a[172:175], a[244:247], v[216:219]
    v_exp_f32 v145, v145
    v_mfma_f32_16x16x32_bf16 v[212:215], a[176:179], a[244:247], v[212:215]
    ds_read_b128 a[244:247], v227 offset:6272
    v_cvt_pk_bf16_f32 v176, v144, v145
    v_mfma_f32_16x16x32_bf16 v[220:223], a[180:183], v[252:255], v[220:223]
    v_exp_f32 v146, v146
    v_mfma_f32_16x16x32_bf16 v[216:219], a[184:187], v[252:255], v[216:219]
    v_exp_f32 v147, v147
    v_mfma_f32_16x16x32_bf16 v[212:215], a[188:191], v[252:255], v[212:215]
    s_waitcnt lgkmcnt(3)
    ds_read_b128 v[252:255], v227 offset:6336
    v_cvt_pk_bf16_f32 v177, v146, v147
    v_mfma_f32_16x16x32_bf16 v[220:223], a[192:195], a[248:251], v[220:223]
    ds_read_b128 v[144:147], v235
    v_bfe_u32 v235, s75, v233, 4
    v_mfma_f32_16x16x32_bf16 v[216:219], a[196:199], a[248:251], v[216:219]
    v_mad_u32_u24 v235, v235, s40, v231
    v_fma_f32 v149, v149, s37, -v236
    v_mfma_f32_16x16x32_bf16 v[212:215], a[200:203], a[248:251], v[212:215]
    ds_read_b128 a[248:251], v227 offset:6400
    v_fma_f32 v150, v150, s37, -v236
    v_mfma_f32_16x16x32_bf16 v[220:223], a[204:207], a[252:255], v[220:223]
    v_fma_f32 v151, v151, s37, -v236
    v_fma_f32 v152, v152, s37, -v236
    v_mfma_f32_16x16x32_bf16 v[216:219], a[208:211], a[252:255], v[216:219]
    v_exp_f32 v148, v148
    v_mfma_f32_16x16x32_bf16 v[212:215], a[212:215], a[252:255], v[212:215]
    s_waitcnt lgkmcnt(4)
    ds_read_b128 a[252:255], v227 offset:6464
    v_cndmask_b32 v227, v240, v239, vcc
    v_mfma_f32_16x16x32_bf16 v[208:211], a[0:3], a[236:239], 0
    v_cvt_pk_bf16_f32 v132, v220, v221
    v_cvt_pk_bf16_f32 v133, v222, v223
    v_mfma_f32_16x16x32_bf16 v[204:207], a[4:7], a[236:239], 0
    v_cvt_pk_bf16_f32 v134, v216, v217
    v_cvt_pk_bf16_f32 v135, v218, v219
    v_mfma_f32_16x16x32_bf16 v[200:203], a[8:11], a[236:239], 0
    v_cvt_pk_bf16_f32 v136, v212, v213
    v_cvt_pk_bf16_f32 v137, v214, v215
    v_mfma_f32_16x16x32_bf16 v[220:223], a[236:239], a[72:75], 0
    s_waitcnt lgkmcnt(2)
    v_exp_f32 v149, v149
    v_mfma_f32_16x16x32_bf16 v[144:147], v[24:27], v[138:141], v[144:147]
    v_exp_f32 v150, v150
    v_mfma_f32_16x16x32_bf16 v[216:219], a[236:239], a[76:79], 0
    v_exp_f32 v151, v151
    v_mfma_f32_16x16x32_bf16 v[212:215], a[236:239], a[80:83], 0
    ds_read_b128 a[236:239], v239
    v_cvt_pk_bf16_f32 v178, v148, v149
    v_mfma_f32_16x16x16_bf16 v[144:147], v[28:29], v[142:143], v[144:147]
    v_cvt_pk_bf16_f32 v179, v150, v151
    v_fma_f32 v153, v153, s37, -v236
    v_mfma_f32_16x16x32_bf16 v[208:211], a[12:15], a[240:243], v[208:211]
    ds_read_b128 v[148:151], v250
    v_bfe_u32 v250, s76, v233, 4
    v_mfma_f32_16x16x32_bf16 v[196:199], a[216:219], v[176:179], 0
    v_mad_u32_u24 v250, v250, s40, v231
    v_fma_f32 v154, v154, s37, -v236
    v_mfma_f32_16x16x32_bf16 v[184:187], v[70:73], v[176:179], 0
    v_fma_f32 v155, v155, s37, -v236
    v_fma_f32 v156, v156, s37, -v236
    v_mfma_f32_16x16x32_bf16 v[188:191], v[92:95], v[176:179], 0
    v_exp_f32 v152, v152
    v_mfma_f32_16x16x32_bf16 v[192:195], v[114:117], v[176:179], 0
    v_exp_f32 v153, v153
    v_mfma_f32_16x16x32_bf16 v[204:207], a[16:19], a[240:243], v[204:207]
    v_exp_f32 v154, v154
    v_mfma_f32_16x16x32_bf16 v[200:203], a[20:23], a[240:243], v[200:203]
    v_exp_f32 v155, v155
    v_mfma_f32_16x16x32_bf16 v[220:223], a[240:243], a[84:87], v[220:223]
    v_cvt_pk_bf16_f32 v180, v152, v153
    v_cvt_pk_bf16_f32 v181, v154, v155
    v_mfma_f32_16x16x32_bf16 v[216:219], a[240:243], a[88:91], v[216:219]
    ds_read_b128 v[152:155], v230 offset:1280
    v_fma_f32 v157, v157, s37, -v236
    v_mfma_f32_16x16x32_bf16 v[212:215], a[240:243], a[92:95], v[212:215]
    s_waitcnt lgkmcnt(1)
    ds_read_b128 a[240:243], v240
    v_fma_f32 v158, v158, s37, -v236
    v_mfma_f32_16x16x32_bf16 v[148:151], v[30:33], v[138:141], v[148:151]
    v_fma_f32 v159, v159, s37, -v236
    v_fma_f32 v160, v160, s37, -v236
    v_mfma_f32_16x16x32_bf16 v[208:211], a[24:27], a[244:247], v[208:211]
    v_exp_f32 v156, v156
    v_mfma_f32_16x16x32_bf16 v[204:207], a[28:31], a[244:247], v[204:207]
    v_exp_f32 v157, v157
    v_mfma_f32_16x16x16_bf16 v[148:151], v[34:35], v[142:143], v[148:151]
    v_exp_f32 v158, v158
    v_mfma_f32_16x16x32_bf16 v[200:203], a[32:35], a[244:247], v[200:203]
    v_exp_f32 v159, v159
    v_mfma_f32_16x16x32_bf16 v[220:223], a[244:247], a[96:99], v[220:223]
    v_cvt_pk_bf16_f32 v182, v156, v157
    v_cvt_pk_bf16_f32 v183, v158, v159
    v_mfma_f32_16x16x32_bf16 v[216:219], a[244:247], a[100:103], v[216:219]
    ds_read_b128 v[156:159], v230 offset:1920
    v_fma_f32 v161, v161, s37, -v236
    v_mfma_f32_16x16x32_bf16 v[196:199], a[216:219], v[180:183], v[196:199]
    v_fma_f32 v162, v162, s37, -v236
    v_fma_f32 v163, v163, s37, -v236
    v_mfma_f32_16x16x32_bf16 v[184:187], v[74:77], v[180:183], v[184:187]
    v_exp_f32 v160, v160
    v_mfma_f32_16x16x32_bf16 v[188:191], v[96:99], v[180:183], v[188:191]
    v_exp_f32 v161, v161
    v_mfma_f32_16x16x32_bf16 v[192:195], v[118:121], v[180:183], v[192:195]
    s_waitcnt lgkmcnt(1)
    v_exp_f32 v162, v162
    v_mfma_f32_16x16x32_bf16 v[152:155], v[36:39], v[138:141], v[152:155]
    v_exp_f32 v163, v163
    v_mfma_f32_16x16x32_bf16 v[212:215], a[244:247], a[104:107], v[212:215]
    ds_read_b128 a[244:247], v239 offset:1024
    v_cvt_pk_bf16_f32 v176, v160, v161
    v_mfma_f32_16x16x32_bf16 v[208:211], a[36:39], v[252:255], v[208:211]
    v_cvt_pk_bf16_f32 v177, v162, v163
    v_fma_f32 v164, v164, s37, -v236
    v_mfma_f32_16x16x16_bf16 v[152:155], v[40:41], v[142:143], v[152:155]
    ds_read_b128 v[160:163], v234
    v_bfe_u32 v234, s73, v232, 4
    v_mfma_f32_16x16x32_bf16 v[204:207], a[40:43], v[252:255], v[204:207]
    s_waitcnt lgkmcnt(2)
    v_fma_f32 v165, v165, s37, -v236
    v_fma_f32 v166, v166, s37, -v236
    v_mfma_f32_16x16x32_bf16 v[156:159], v[42:45], v[138:141], v[156:159]
    v_fma_f32 v167, v167, s37, -v236
    v_fma_f32 v168, v168, s37, -v236
    v_mfma_f32_16x16x32_bf16 v[200:203], a[44:47], v[252:255], v[200:203]
    v_exp_f32 v164, v164
    v_mfma_f32_16x16x32_bf16 v[220:223], v[252:255], a[108:111], v[220:223]
    v_exp_f32 v165, v165
    v_mfma_f32_16x16x16_bf16 v[156:159], v[46:47], v[142:143], v[156:159]
    v_exp_f32 v166, v166
    v_mfma_f32_16x16x32_bf16 v[216:219], v[252:255], a[112:115], v[216:219]
    v_exp_f32 v167, v167
    v_mfma_f32_16x16x32_bf16 v[212:215], v[252:255], a[116:119], v[212:215]
    ds_read_b128 v[252:255], v240 offset:1024
    v_cvt_pk_bf16_f32 v178, v164, v165
    v_mfma_f32_16x16x32_bf16 v[208:211], a[48:51], a[248:251], v[208:211]
    v_cvt_pk_bf16_f32 v179, v166, v167
    v_fma_f32 v169, v169, s37, -v236
    v_mfma_f32_16x16x32_bf16 v[204:207], a[52:55], a[248:251], v[204:207]
    ds_read_b128 v[164:167], v235
    v_mad_u32_u24 v235, v234, s40, v228
    v_mfma_f32_16x16x32_bf16 v[196:199], a[216:219], v[176:179], v[196:199]
    v_mad_u32_u24 v234, v234, s40, v229
    v_fma_f32 v170, v170, s37, -v236
    v_mfma_f32_16x16x32_bf16 v[184:187], v[78:81], v[176:179], v[184:187]
    v_fma_f32 v171, v171, s37, -v236
    v_fma_f32 v172, v172, s37, -v236
    v_mfma_f32_16x16x32_bf16 v[188:191], v[100:103], v[176:179], v[188:191]
    v_exp_f32 v168, v168
    v_mfma_f32_16x16x32_bf16 v[192:195], v[122:125], v[176:179], v[192:195]
    s_waitcnt lgkmcnt(2)
    v_exp_f32 v169, v169
    v_mfma_f32_16x16x32_bf16 v[160:163], v[48:51], v[138:141], v[160:163]
    v_exp_f32 v170, v170
    v_mfma_f32_16x16x32_bf16 v[200:203], a[56:59], a[248:251], v[200:203]
    v_exp_f32 v171, v171
    v_mfma_f32_16x16x32_bf16 v[220:223], a[248:251], a[120:123], v[220:223]
    v_cvt_pk_bf16_f32 v180, v168, v169
    v_cvt_pk_bf16_f32 v181, v170, v171
    v_mfma_f32_16x16x16_bf16 v[160:163], v[52:53], v[142:143], v[160:163]
    ds_read_b128 v[168:171], v250
    v_bfe_u32 v250, s77, v232, 4
    v_mfma_f32_16x16x32_bf16 v[216:219], a[248:251], a[124:127], v[216:219]
    v_fma_f32 v173, v173, s37, -v236
    v_fma_f32 v174, v174, s37, -v236
    v_mfma_f32_16x16x32_bf16 v[212:215], a[248:251], a[128:131], v[212:215]
    ds_read_b64_tr_b16 a[248:249], v241 offset:12288
    ds_read_b64_tr_b16 a[250:251], v241 offset:26112
    v_mfma_f32_16x16x32_bf16 v[208:211], a[60:63], a[252:255], v[208:211]
    v_fma_f32 v175, v175, s37, -v236
    v_max3_f32 v248, v144, v145, v146
    v_mfma_f32_16x16x32_bf16 v[204:207], a[64:67], a[252:255], v[204:207]
    v_exp_f32 v172, v172
    v_mfma_f32_16x16x32_bf16 v[200:203], a[68:71], a[252:255], v[200:203]
    v_exp_f32 v173, v173
    v_mfma_f32_16x16x32_bf16 v[220:223], a[252:255], a[132:135], v[220:223]
    v_exp_f32 v174, v174
    v_mfma_f32_16x16x32_bf16 v[216:219], a[252:255], a[136:139], v[216:219]
    v_cvt_pk_bf16_f32 v54, v208, v209
    v_cvt_pk_bf16_f32 v55, v210, v211
    v_mfma_f32_16x16x32_bf16 v[212:215], a[252:255], a[140:143], v[212:215]
    v_cvt_pk_bf16_f32 v56, v204, v205
    v_cvt_pk_bf16_f32 v57, v206, v207
    v_mfma_f32_16x16x32_bf16 v[208:211], a[220:223], a[236:239], 0
    s_waitcnt lgkmcnt(3)
    v_cvt_pk_bf16_f32 v58, v200, v201
    v_cvt_pk_bf16_f32 v59, v202, v203
    v_mfma_f32_16x16x32_bf16 v[164:167], v[54:57], v[138:141], v[164:167]
    s_waitcnt lgkmcnt(2)
    v_cvt_pk_bf16_f32 v84, v220, v221
    v_cvt_pk_bf16_f32 v85, v222, v223
    v_mfma_f32_16x16x32_bf16 v[168:171], v[60:63], v[138:141], v[168:171]
    v_cvt_pk_bf16_f32 v106, v216, v217
    v_cvt_pk_bf16_f32 v107, v218, v219
    v_mfma_f32_16x16x32_bf16 v[200:203], a[220:223], a[240:243], 0
    v_cvt_pk_bf16_f32 v128, v212, v213
    v_cvt_pk_bf16_f32 v129, v214, v215
    v_mfma_f32_16x16x16_bf16 v[164:167], v[58:59], v[142:143], v[164:167]
    ds_read_b64_tr_b16 a[252:253], v241 offset:12296
    ds_read_b64_tr_b16 a[254:255], v241 offset:26120
    v_mfma_f32_16x16x16_bf16 v[168:171], v[64:65], v[142:143], v[168:171]
    v_exp_f32 v175, v175
    v_mfma_f32_16x16x32_bf16 v[204:207], a[224:227], a[236:239], 0
    v_cvt_pk_bf16_f32 v182, v172, v173
    v_cvt_pk_bf16_f32 v183, v174, v175
    v_mfma_f32_16x16x32_bf16 v[220:223], a[224:227], a[240:243], 0
    ds_read_b64_tr_b16 a[240:241], v242 offset:12296
    ds_read_b64_tr_b16 a[242:243], v242 offset:26120
    v_mfma_f32_16x16x32_bf16 v[196:199], a[216:219], v[180:183], v[196:199]
    ds_read_b128 v[172:175], v235
    v_bfe_u32 v235, s78, v232, 4
    v_mfma_f32_16x16x32_bf16 v[184:187], v[66:69], v[180:183], v[184:187]
    v_max3_f32 v249, v147, v148, v149
    v_max3_f32 v248, v248, v150, v151
    v_mfma_f32_16x16x32_bf16 v[188:191], v[88:91], v[180:183], v[188:191]
    v_max3_f32 v249, v249, v152, v153
    v_max3_f32 v248, v248, v154, v155
    v_mfma_f32_16x16x32_bf16 v[192:195], v[110:113], v[180:183], v[192:195]
    v_rcp_f32 v197, v196
    v_mfma_f32_16x16x32_bf16 v[216:219], a[228:231], a[236:239], 0
    v_mul_f32 v184, v184, v197
    v_mul_f32 v185, v185, v197
    v_mfma_f32_16x16x32_bf16 v[212:215], a[232:235], a[236:239], 0
    s_waitcnt lgkmcnt(5)
    ds_read_b64_tr_b16 a[236:237], v242 offset:12288
    ds_read_b64_tr_b16 a[238:239], v242 offset:26112
    v_mfma_f32_16x16x32_bf16 v[208:211], a[248:251], a[244:247], v[208:211]
    v_cvt_pk_bf16_f32 v184, v184, v185
    v_mul_f32 v186, v186, v197
    v_mfma_f32_16x16x32_bf16 v[200:203], a[248:251], v[252:255], v[200:203]
    s_waitcnt lgkmcnt(5)
    ds_read_b64_tr_b16 a[248:249], v241 offset:13824
    ds_read_b64_tr_b16 a[250:251], v241 offset:24576
    v_mfma_f32_16x16x32_bf16 v[204:207], a[252:255], a[244:247], v[204:207]
    v_mul_f32 v187, v187, v197
    v_cvt_pk_bf16_f32 v185, v186, v187
    v_mfma_f32_16x16x32_bf16 v[220:223], a[252:255], v[252:255], v[220:223]
    s_waitcnt lgkmcnt(5)
    ds_read_b128 v[252:255], v240 offset:2048
    ds_read_b64_tr_b16 a[252:253], v241 offset:13832
    v_mfma_f32_16x16x32_bf16 v[212:215], a[240:243], a[244:247], v[212:215]
    s_waitcnt lgkmcnt(6)
    ds_read_b64_tr_b16 a[254:255], v241 offset:24584
    ds_read_b64_tr_b16 a[240:241], v242 offset:13832
    v_mfma_f32_16x16x32_bf16 v[172:175], v[12:15], v[132:135], v[172:175]
    ds_read_b64_tr_b16 a[242:243], v242 offset:24584
    v_mul_f32 v188, v188, v197
    v_mul_f32 v189, v189, v197
    v_cvt_pk_bf16_f32 v186, v188, v189
    v_mul_f32 v190, v190, v197
    v_mul_f32 v191, v191, v197
    v_mfma_f32_16x16x16_bf16 v[172:175], v[16:17], v[136:137], v[172:175]
    s_waitcnt lgkmcnt(7)
    v_cvt_pk_bf16_f32 v187, v190, v191
    v_mul_f32 v192, v192, v197
    v_mul_f32 v193, v193, v197
    v_cvt_pk_bf16_f32 v188, v192, v193
    v_mfma_f32_16x16x32_bf16 v[216:219], a[236:239], a[244:247], v[216:219]
    s_waitcnt lgkmcnt(4)
    ds_read_b128 a[244:247], v239 offset:2048
    ds_read_b64_tr_b16 a[236:237], v242 offset:13824
    ds_read_b64_tr_b16 a[238:239], v242 offset:24576
    v_mul_f32 v194, v194, v197
    v_mul_f32 v195, v195, v197
    v_cvt_pk_bf16_f32 v189, v194, v195
    ds_write_b128 v237, v[184:187] offset:12288
    v_mfma_f32_16x16x32_bf16 v[200:203], a[248:251], v[252:255], v[200:203]
    s_waitcnt lgkmcnt(6)
    ds_write_b64 v238, v[188:189] offset:12288
    v_mfma_f32_16x16x32_bf16 v[220:223], a[252:255], v[252:255], v[220:223]
    s_waitcnt lgkmcnt(4)
    ds_read_b128 v[252:255], v240 offset:3072
    v_max3_f32 v249, v249, v156, v157
    v_max3_f32 v248, v248, v158, v159
    v_max3_f32 v249, v249, v160, v161
    v_max3_f32 v248, v248, v162, v163
    v_max3_f32 v249, v249, v164, v165
    v_max3_f32 v248, v248, v166, v167
    v_max3_f32 v249, v249, v168, v169
    v_max3_f32 v248, v248, v170, v171
    v_max_f32 v248, v248, v249
    v_mov_b32 v249, v248
    s_nop 1
    v_mfma_f32_16x16x32_bf16 v[208:211], a[248:251], a[244:247], v[208:211]
    ds_read_b64_tr_b16 a[248:249], v241 offset:36864
    ds_read_b64_tr_b16 a[250:251], v241 offset:38400
    v_mfma_f32_16x16x32_bf16 v[204:207], a[252:255], a[244:247], v[204:207]
    s_waitcnt lgkmcnt(5)
    ds_read_b64_tr_b16 a[252:253], v241 offset:36872
    ds_read_b64_tr_b16 a[254:255], v241 offset:38408
    v_mfma_f32_16x16x32_bf16 v[216:219], a[236:239], a[244:247], v[216:219]
    ds_read_b64_tr_b16 a[236:237], v242 offset:36864
    v_mfma_f32_16x16x32_bf16 v[212:215], a[240:243], a[244:247], v[212:215]
    s_waitcnt lgkmcnt(3)
    ds_read_b128 a[244:247], v239 offset:3072
    v_permlane16_swap_b32 v248, v249
    v_max_f32 v248, v248, v249
    ds_read_b64_tr_b16 a[238:239], v242 offset:38400
    v_mov_b32 v249, v248
    ds_read_b64_tr_b16 a[240:241], v242 offset:36872
    s_nop 0
    ds_read_b64_tr_b16 a[242:243], v242 offset:38408
    v_permlane32_swap_b32 v248, v249
    v_max_f32 v248, v248, v249
    v_mul_f32 v236, s37, v248
    v_fma_f32 v144, v144, s37, -v236
    v_fma_f32 v145, v145, s37, -v236
    v_fma_f32 v146, v146, s37, -v236
    v_fma_f32 v147, v147, s37, -v236
    v_exp_f32 v144, v144
    v_exp_f32 v145, v145
    v_mfma_f32_16x16x32_bf16 v[200:203], a[248:251], v[252:255], v[200:203]
    s_waitcnt lgkmcnt(5)
    v_exp_f32 v146, v146
    v_exp_f32 v147, v147
    v_cvt_pk_bf16_f32 v176, v144, v145
    v_mfma_f32_16x16x32_bf16 v[220:223], a[252:255], v[252:255], v[220:223]
    s_waitcnt lgkmcnt(3)
    ds_read_b128 v[252:255], v240 offset:4096
    v_cvt_pk_bf16_f32 v177, v146, v147
    ds_read_b128 v[144:147], v234
    v_mad_u32_u24 v234, v250, s40, v228
    v_mfma_f32_16x16x32_bf16 v[208:211], a[248:251], a[244:247], v[208:211]
    ds_read_b64_tr_b16 a[248:249], v241 offset:49152
    ds_read_b64_tr_b16 a[250:251], v241 offset:62976
    v_mfma_f32_16x16x32_bf16 v[204:207], a[252:255], a[244:247], v[204:207]
    s_waitcnt lgkmcnt(6)
    ds_read_b64_tr_b16 a[252:253], v241 offset:49160
    v_mad_u32_u24 v250, v250, s40, v229
    v_mfma_f32_16x16x32_bf16 v[216:219], a[236:239], a[244:247], v[216:219]
    s_waitcnt lgkmcnt(5)
    ds_read_b64_tr_b16 a[254:255], v241 offset:62984
    v_fma_f32 v148, v148, s37, -v236
    v_mfma_f32_16x16x32_bf16 v[212:215], a[240:243], a[244:247], v[212:215]
    s_waitcnt lgkmcnt(4)
    ds_read_b128 a[244:247], v239 offset:4096
    v_fma_f32 v149, v149, s37, -v236
    v_fma_f32 v150, v150, s37, -v236
    v_fma_f32 v151, v151, s37, -v236
    ds_read_b64_tr_b16 a[236:237], v242 offset:49152
    v_exp_f32 v148, v148
    ds_read_b64_tr_b16 a[238:239], v242 offset:62976
    ds_read_b64_tr_b16 a[240:241], v242 offset:49160
    v_exp_f32 v149, v149
    v_exp_f32 v150, v150
    ds_read_b64_tr_b16 a[242:243], v242 offset:62984
    v_mfma_f32_16x16x32_bf16 v[144:147], v[36:39], v[132:135], v[144:147]
    s_waitcnt lgkmcnt(7)
    v_exp_f32 v151, v151
    v_cvt_pk_bf16_f32 v178, v148, v149
    v_cvt_pk_bf16_f32 v179, v150, v151
    ds_read_b128 v[148:151], v229 offset:1280
    v_mfma_f32_16x16x32_bf16 v[200:203], a[248:251], v[252:255], v[200:203]
    v_fma_f32 v152, v152, s37, -v236
    v_fma_f32 v153, v153, s37, -v236
    v_mfma_f32_16x16x32_bf16 v[196:199], a[216:219], v[176:179], 0
    v_fma_f32 v154, v154, s37, -v236
    v_fma_f32 v155, v155, s37, -v236
    v_mfma_f32_16x16x32_bf16 v[184:187], v[68:71], v[176:179], 0
    v_exp_f32 v152, v152
    v_mfma_f32_16x16x32_bf16 v[188:191], v[90:93], v[176:179], 0
    v_exp_f32 v153, v153
    v_mfma_f32_16x16x32_bf16 v[192:195], v[112:115], v[176:179], 0
    v_exp_f32 v154, v154
    v_mfma_f32_16x16x16_bf16 v[144:147], v[40:41], v[136:137], v[144:147]
    s_waitcnt lgkmcnt(4)
    v_exp_f32 v155, v155
    v_mfma_f32_16x16x32_bf16 v[208:211], a[248:251], a[244:247], v[208:211]
    ds_read_b64_tr_b16 a[248:249], v241 offset:50688
    ds_read_b64_tr_b16 a[250:251], v241 offset:61440
    v_mfma_f32_16x16x32_bf16 v[204:207], a[252:255], a[244:247], v[204:207]
    v_cvt_pk_bf16_f32 v180, v152, v153
    v_cvt_pk_bf16_f32 v181, v154, v155
    v_mfma_f32_16x16x32_bf16 v[220:223], a[252:255], v[252:255], v[220:223]
    s_waitcnt lgkmcnt(2)
    ds_read_b128 v[252:255], v240 offset:5120
    ds_read_b64_tr_b16 a[252:253], v241 offset:50696
    v_mfma_f32_16x16x32_bf16 v[148:151], v[42:45], v[132:135], v[148:151]
    ds_read_b64_tr_b16 a[254:255], v241 offset:61448
    ds_read_b128 v[152:155], v228 offset:1280
    v_mfma_f32_16x16x32_bf16 v[216:219], a[236:239], a[244:247], v[216:219]
    v_fma_f32 v156, v156, s37, -v236
    v_fma_f32 v157, v157, s37, -v236
    v_mfma_f32_16x16x32_bf16 v[212:215], a[240:243], a[244:247], v[212:215]
    ds_read_b128 a[244:247], v239 offset:5120
    v_fma_f32 v158, v158, s37, -v236
    v_mfma_f32_16x16x16_bf16 v[148:151], v[46:47], v[136:137], v[148:151]
    s_waitcnt lgkmcnt(4)
    ds_read_b64_tr_b16 a[236:237], v242 offset:50688
    v_fma_f32 v159, v159, s37, -v236
    v_exp_f32 v156, v156
    ds_read_b64_tr_b16 a[238:239], v242 offset:61440
    v_exp_f32 v157, v157
    ds_read_b64_tr_b16 a[240:241], v242 offset:50696
    ds_read_b64_tr_b16 a[242:243], v242 offset:61448
    v_exp_f32 v158, v158
    v_exp_f32 v159, v159
    v_mfma_f32_16x16x32_bf16 v[200:203], a[248:251], v[252:255], v[200:203]
    s_waitcnt lgkmcnt(6)
    v_cvt_pk_bf16_f32 v182, v156, v157
    v_cvt_pk_bf16_f32 v183, v158, v159
    ds_read_b128 v[156:159], v234
    v_mfma_f32_16x16x32_bf16 v[220:223], a[252:255], v[252:255], v[220:223]
    ds_read_b128 v[252:255], v224 offset:15552
    v_bfe_u32 v234, s73, v232, 4
    v_mfma_f32_16x16x32_bf16 v[196:199], a[216:219], v[180:183], v[196:199]
    v_mad_u32_u24 v234, v234, s40, v230
    v_cvt_pk_bf16_f32 v200, v200, v201
    v_mfma_f32_16x16x32_bf16 v[184:187], v[76:79], v[180:183], v[184:187]
    v_cvt_pk_bf16_f32 v201, v202, v203
    v_fma_f32 v160, v160, s37, -v236
    v_mfma_f32_16x16x32_bf16 v[188:191], v[98:101], v[180:183], v[188:191]
    v_cvt_pk_bf16_f32 v202, v220, v221
    v_cvt_pk_bf16_f32 v203, v222, v223
    v_mfma_f32_16x16x32_bf16 v[192:195], v[120:123], v[180:183], v[192:195]
    s_waitcnt lgkmcnt(6)
    buffer_store_dwordx4 v[200:203], v245, s[20:23], s58 offen sc0 sc1
    v_mfma_f32_16x16x32_bf16 v[152:155], v[18:21], v[132:135], v[152:155]
    v_fma_f32 v161, v161, s37, -v236
    v_fma_f32 v162, v162, s37, -v236
    v_mfma_f32_16x16x32_bf16 v[208:211], a[248:251], a[244:247], v[208:211]
    ds_read_b128 a[248:251], v224 offset:15616
    v_fma_f32 v163, v163, s37, -v236
    v_mfma_f32_16x16x32_bf16 v[204:207], a[252:255], a[244:247], v[204:207]
    ds_read_b128 a[252:255], v224 offset:15680
    v_fma_f32 v164, v164, s37, -v236
    v_mfma_f32_16x16x16_bf16 v[152:155], v[22:23], v[136:137], v[152:155]
    s_waitcnt lgkmcnt(3)
    v_exp_f32 v160, v160
    v_mfma_f32_16x16x32_bf16 v[156:159], v[0:3], v[132:135], v[156:159]
    v_cvt_pk_bf16_f32 v208, v208, v209
    v_cvt_pk_bf16_f32 v209, v210, v211
    v_mfma_f32_16x16x32_bf16 v[216:219], a[236:239], a[244:247], v[216:219]
    ds_read_b128 a[236:239], v224 offset:15744
    v_cvt_pk_bf16_f32 v210, v204, v205
    v_mfma_f32_16x16x32_bf16 v[212:215], a[240:243], a[244:247], v[212:215]
    ds_read_b128 a[244:247], v224 offset:15488
    ds_read_b128 a[240:243], v224 offset:15808
    v_mfma_f32_16x16x16_bf16 v[156:159], v[4:5], v[136:137], v[156:159]
    v_cvt_pk_bf16_f32 v211, v206, v207
    v_exp_f32 v161, v161
    v_cvt_pk_bf16_f32 v216, v216, v217
    v_cvt_pk_bf16_f32 v217, v218, v219
    v_exp_f32 v162, v162
    v_cvt_pk_bf16_f32 v218, v212, v213
    v_cvt_pk_bf16_f32 v219, v214, v215
    v_exp_f32 v163, v163
    v_cvt_pk_bf16_f32 v176, v160, v161
    v_cvt_pk_bf16_f32 v177, v162, v163
    buffer_store_dwordx4 v[208:211], v243, s[20:23], s58 offen sc0 sc1
    ds_read_b128 v[160:163], v250
    v_mfma_f32_16x16x16_bf16 v[196:199], a[216:217], v[176:177], v[196:199]
    v_mad_u32_u24 v250, v235, s40, v229
    v_mad_u32_u24 v235, v235, s40, v228
    v_mfma_f32_16x16x16_bf16 v[184:187], v[82:83], v[176:177], v[184:187]
    v_fma_f32 v165, v165, s37, -v236
    v_fma_f32 v166, v166, s37, -v236
    v_mfma_f32_16x16x16_bf16 v[188:191], v[104:105], v[176:177], v[188:191]
    v_fma_f32 v167, v167, s37, -v236
    v_fma_f32 v168, v168, s37, -v236
    v_mfma_f32_16x16x16_bf16 v[192:195], v[126:127], v[176:177], v[192:195]
    s_waitcnt lgkmcnt(2)
    v_exp_f32 v164, v164
    v_mfma_f32_16x16x32_bf16 v[208:211], a[0:3], a[244:247], 0
    v_exp_f32 v165, v165
    v_mfma_f32_16x16x32_bf16 v[204:207], a[4:7], a[244:247], 0
    v_exp_f32 v166, v166
    v_mfma_f32_16x16x32_bf16 v[200:203], a[8:11], a[244:247], 0
    v_exp_f32 v167, v167
    v_mfma_f32_16x16x32_bf16 v[220:223], a[244:247], a[72:75], 0
    v_cvt_pk_bf16_f32 v180, v164, v165
    v_cvt_pk_bf16_f32 v181, v166, v167
    v_mfma_f32_16x16x32_bf16 v[212:215], a[244:247], a[80:83], 0
    s_waitcnt lgkmcnt(0)
    ds_read_b128 v[164:167], v250
    v_bfe_u32 v250, s78, v232, 4
    v_mfma_f32_16x16x32_bf16 v[160:163], v[24:27], v[132:135], v[160:163]
    v_mad_u32_u24 v250, v250, s40, v230
    v_fma_f32 v169, v169, s37, -v236
    v_mfma_f32_16x16x32_bf16 v[208:211], a[12:15], v[252:255], v[208:211]
    buffer_store_dwordx4 v[216:219], v244, s[20:23], s58 offen sc0 sc1
    v_mfma_f32_16x16x32_bf16 v[204:207], a[16:19], v[252:255], v[204:207]
    s_add_u32 s58, s51, 0x1a4000
    v_fma_f32 v170, v170, s37, -v236
    v_fma_f32 v171, v171, s37, -v236
    v_mfma_f32_16x16x16_bf16 v[160:163], v[28:29], v[136:137], v[160:163]
    v_exp_f32 v168, v168
    v_mfma_f32_16x16x32_bf16 v[216:219], a[244:247], a[76:79], 0
    ds_read_b128 a[244:247], v224 offset:18560
    v_max3_f32 v248, v172, v173, v174
    v_mfma_f32_16x16x32_bf16 v[200:203], a[20:23], v[252:255], v[200:203]
    v_exp_f32 v169, v169
    v_mfma_f32_16x16x32_bf16 v[220:223], v[252:255], a[84:87], v[220:223]
    v_exp_f32 v170, v170
    v_mfma_f32_16x16x32_bf16 v[216:219], v[252:255], a[88:91], v[216:219]
    v_exp_f32 v171, v171
    v_mfma_f32_16x16x32_bf16 v[212:215], v[252:255], a[92:95], v[212:215]
    ds_read_b128 v[252:255], v224 offset:18624
    v_cvt_pk_bf16_f32 v182, v168, v169
    v_mfma_f32_16x16x32_bf16 v[208:211], a[24:27], a[248:251], v[208:211]
    v_cvt_pk_bf16_f32 v183, v170, v171
    v_max3_f32 v249, v175, v144, v145
    v_mfma_f32_16x16x32_bf16 v[204:207], a[28:31], a[248:251], v[204:207]
    ds_read_b128 v[168:171], v235
    v_bfe_u32 v235, s77, v232, 4
    v_mfma_f32_16x16x32_bf16 v[196:199], a[216:219], v[180:183], v[196:199]
    v_mad_u32_u24 v235, v235, s40, v230
    v_max3_f32 v248, v248, v146, v147
    v_mfma_f32_16x16x32_bf16 v[184:187], v[84:87], v[180:183], v[184:187]
    v_max3_f32 v249, v249, v148, v149
    v_max3_f32 v248, v248, v150, v151
    v_mfma_f32_16x16x32_bf16 v[188:191], v[106:109], v[180:183], v[188:191]
    v_max3_f32 v249, v249, v152, v153
    v_max3_f32 v248, v248, v154, v155
    v_mfma_f32_16x16x32_bf16 v[192:195], v[128:131], v[180:183], v[192:195]
    v_rcp_f32 v197, v196
    v_mfma_f32_16x16x32_bf16 v[200:203], a[32:35], a[248:251], v[200:203]
    v_mul_f32 v184, v184, v197
    v_mul_f32 v185, v185, v197
    v_mfma_f32_16x16x32_bf16 v[220:223], a[248:251], a[96:99], v[220:223]
    v_cvt_pk_bf16_f32 v184, v184, v185
    v_mul_f32 v186, v186, v197
    v_mfma_f32_16x16x32_bf16 v[216:219], a[248:251], a[100:103], v[216:219]
    v_mul_f32 v187, v187, v197
    v_cvt_pk_bf16_f32 v185, v186, v187
    v_mfma_f32_16x16x32_bf16 v[212:215], a[248:251], a[104:107], v[212:215]
    ds_read_b128 a[248:251], v224 offset:18688
    v_mul_f32 v188, v188, v197
    v_mfma_f32_16x16x32_bf16 v[208:211], a[36:39], a[252:255], v[208:211]
    v_mul_f32 v189, v189, v197
    v_cvt_pk_bf16_f32 v186, v188, v189
    v_mfma_f32_16x16x32_bf16 v[204:207], a[40:43], a[252:255], v[204:207]
    v_mul_f32 v190, v190, v197
    v_mul_f32 v191, v191, v197
    v_mfma_f32_16x16x32_bf16 v[200:203], a[44:47], a[252:255], v[200:203]
    v_cvt_pk_bf16_f32 v187, v190, v191
    v_mul_f32 v192, v192, v197
    v_mfma_f32_16x16x32_bf16 v[220:223], a[252:255], a[108:111], v[220:223]
    v_mul_f32 v193, v193, v197
    v_cvt_pk_bf16_f32 v188, v192, v193
    v_mfma_f32_16x16x32_bf16 v[216:219], a[252:255], a[112:115], v[216:219]
    v_mul_f32 v194, v194, v197
    v_mul_f32 v195, v195, v197
    v_mfma_f32_16x16x32_bf16 v[212:215], a[252:255], a[116:119], v[212:215]
    ds_read_b128 a[252:255], v224 offset:18752
    v_cvt_pk_bf16_f32 v189, v194, v195
    v_mfma_f32_16x16x32_bf16 v[208:211], a[48:51], a[236:239], v[208:211]
    ds_write_b128 v237, v[184:187] offset:18432
    v_mfma_f32_16x16x32_bf16 v[204:207], a[52:55], a[236:239], v[204:207]
    ds_write_b64 v238, v[188:189] offset:18432
    v_mfma_f32_16x16x32_bf16 v[200:203], a[56:59], a[236:239], v[200:203]
    v_max3_f32 v249, v249, v156, v157
    v_max3_f32 v248, v248, v158, v159
    v_mfma_f32_16x16x32_bf16 v[220:223], a[236:239], a[120:123], v[220:223]
    v_max3_f32 v249, v249, v160, v161
    v_max3_f32 v248, v248, v162, v163
    v_mfma_f32_16x16x32_bf16 v[216:219], a[236:239], a[124:127], v[216:219]
    v_mfma_f32_16x16x32_bf16 v[212:215], a[236:239], a[128:131], v[212:215]
    ds_read_b128 a[236:239], v224 offset:18816
    v_mfma_f32_16x16x32_bf16 v[208:211], a[60:63], a[240:243], v[208:211]
    v_mfma_f32_16x16x32_bf16 v[204:207], a[64:67], a[240:243], v[204:207]
    v_mfma_f32_16x16x32_bf16 v[200:203], a[68:71], a[240:243], v[200:203]
    s_waitcnt lgkmcnt(1)
    v_mfma_f32_16x16x32_bf16 v[220:223], a[240:243], a[132:135], v[220:223]
    s_barrier
    v_mfma_f32_16x16x32_bf16 v[216:219], a[240:243], a[136:139], v[216:219]
    v_mfma_f32_16x16x32_bf16 v[212:215], a[240:243], a[140:143], v[212:215]
    ds_read_b128 a[240:243], v224 offset:18880
    v_cndmask_b32 v224, v239, v240, vcc
    v_cvt_pk_bf16_f32 v6, v208, v209
    v_cvt_pk_bf16_f32 v7, v210, v211
    v_mfma_f32_16x16x32_bf16 v[208:211], a[0:3], a[244:247], 0
    v_cvt_pk_bf16_f32 v8, v204, v205
    v_cvt_pk_bf16_f32 v9, v206, v207
    v_mfma_f32_16x16x32_bf16 v[204:207], a[4:7], a[244:247], 0
    v_cvt_pk_bf16_f32 v10, v200, v201
    v_cvt_pk_bf16_f32 v11, v202, v203
    v_mfma_f32_16x16x32_bf16 v[168:171], v[6:9], v[132:135], v[168:171]
    v_cvt_pk_bf16_f32 v72, v220, v221
    v_cvt_pk_bf16_f32 v73, v222, v223
    v_mfma_f32_16x16x32_bf16 v[200:203], a[8:11], a[244:247], 0
    v_cvt_pk_bf16_f32 v94, v216, v217
    v_cvt_pk_bf16_f32 v95, v218, v219
    v_mfma_f32_16x16x32_bf16 v[220:223], a[244:247], a[72:75], 0
    v_cvt_pk_bf16_f32 v116, v212, v213
    v_cvt_pk_bf16_f32 v117, v214, v215
    v_mfma_f32_16x16x16_bf16 v[168:171], v[10:11], v[136:137], v[168:171]
    ds_read_b64_tr_b16 a[0:1], v241 offset:12288
    ds_read_b64_tr_b16 a[2:3], v241 offset:26112
    v_mfma_f32_16x16x32_bf16 v[216:219], a[244:247], a[76:79], 0
    ds_read_b64_tr_b16 a[4:5], v241 offset:12296
    ds_read_b64_tr_b16 a[6:7], v241 offset:26120
    v_mfma_f32_16x16x32_bf16 v[212:215], a[244:247], a[80:83], 0
    ds_read_b128 a[244:247], v226 offset:4224
    v_mfma_f32_16x16x32_bf16 v[208:211], a[12:15], v[252:255], v[208:211]
    ds_read_b64_tr_b16 a[8:9], v242 offset:12288
    v_mfma_f32_16x16x32_bf16 v[204:207], a[16:19], v[252:255], v[204:207]
    ds_read_b64_tr_b16 a[10:11], v242 offset:26112
    v_mfma_f32_16x16x32_bf16 v[200:203], a[20:23], v[252:255], v[200:203]
    ds_read_b64_tr_b16 a[12:13], v242 offset:12296
    v_mfma_f32_16x16x32_bf16 v[220:223], v[252:255], a[84:87], v[220:223]
    ds_read_b64_tr_b16 a[14:15], v242 offset:26120
    v_mfma_f32_16x16x32_bf16 v[216:219], v[252:255], a[88:91], v[216:219]
    ds_read_b64_tr_b16 a[16:17], v241 offset:13824
    v_mfma_f32_16x16x32_bf16 v[212:215], v[252:255], a[92:95], v[212:215]
    ds_read_b128 v[252:255], v226 offset:4288
    v_mfma_f32_16x16x32_bf16 v[208:211], a[24:27], a[248:251], v[208:211]
    ds_read_b64_tr_b16 a[18:19], v241 offset:24576
    v_mfma_f32_16x16x32_bf16 v[204:207], a[28:31], a[248:251], v[204:207]
    ds_read_b64_tr_b16 a[20:21], v241 offset:13832
    v_mfma_f32_16x16x32_bf16 v[200:203], a[32:35], a[248:251], v[200:203]
    ds_read_b64_tr_b16 a[22:23], v241 offset:24584
    v_mfma_f32_16x16x32_bf16 v[220:223], a[248:251], a[96:99], v[220:223]
    ds_read_b64_tr_b16 a[24:25], v242 offset:13824
    v_mfma_f32_16x16x32_bf16 v[216:219], a[248:251], a[100:103], v[216:219]
    ds_read_b64_tr_b16 a[26:27], v242 offset:24576
    v_mfma_f32_16x16x32_bf16 v[212:215], a[248:251], a[104:107], v[212:215]
    ds_read_b128 a[248:251], v226 offset:4352
    v_mfma_f32_16x16x32_bf16 v[208:211], a[36:39], a[252:255], v[208:211]
    ds_read_b64_tr_b16 a[28:29], v242 offset:13832
    v_mfma_f32_16x16x32_bf16 v[204:207], a[40:43], a[252:255], v[204:207]
    ds_read_b64_tr_b16 a[30:31], v242 offset:24584
    v_mfma_f32_16x16x32_bf16 v[200:203], a[44:47], a[252:255], v[200:203]
    ds_read_b64_tr_b16 a[32:33], v241 offset:36864
    v_mfma_f32_16x16x32_bf16 v[220:223], a[252:255], a[108:111], v[220:223]
    ds_read_b64_tr_b16 a[34:35], v241 offset:38400
    v_mfma_f32_16x16x32_bf16 v[216:219], a[252:255], a[112:115], v[216:219]
    ds_read_b64_tr_b16 a[36:37], v241 offset:36872
    v_mfma_f32_16x16x32_bf16 v[212:215], a[252:255], a[116:119], v[212:215]
    s_waitcnt lgkmcnt(11)
    ds_read_b128 a[252:255], v226 offset:4416
    v_mfma_f32_16x16x32_bf16 v[208:211], a[48:51], a[236:239], v[208:211]
    ds_read_b64_tr_b16 a[38:39], v241 offset:38408
    v_mfma_f32_16x16x32_bf16 v[204:207], a[52:55], a[236:239], v[204:207]
    ds_read_b64_tr_b16 a[40:41], v242 offset:36864
    v_mfma_f32_16x16x32_bf16 v[200:203], a[56:59], a[236:239], v[200:203]
    ds_read_b64_tr_b16 a[42:43], v242 offset:38400
    v_mfma_f32_16x16x32_bf16 v[220:223], a[236:239], a[120:123], v[220:223]
    ds_read_b64_tr_b16 a[44:45], v242 offset:36872
    v_mfma_f32_16x16x32_bf16 v[216:219], a[236:239], a[124:127], v[216:219]
    ds_read_b64_tr_b16 a[46:47], v242 offset:38408
    v_mfma_f32_16x16x32_bf16 v[212:215], a[236:239], a[128:131], v[212:215]
    ds_read_b128 a[236:239], v226 offset:4480
    v_mfma_f32_16x16x32_bf16 v[208:211], a[60:63], a[240:243], v[208:211]
    ds_read_b64_tr_b16 a[48:49], v241 offset:49152
    v_mfma_f32_16x16x32_bf16 v[204:207], a[64:67], a[240:243], v[204:207]
    ds_read_b64_tr_b16 a[50:51], v241 offset:62976
    v_mfma_f32_16x16x32_bf16 v[200:203], a[68:71], a[240:243], v[200:203]
    ds_read_b64_tr_b16 a[52:53], v241 offset:49160
    v_mfma_f32_16x16x32_bf16 v[220:223], a[240:243], a[132:135], v[220:223]
    ds_read_b64_tr_b16 a[54:55], v241 offset:62984
    v_mfma_f32_16x16x32_bf16 v[216:219], a[240:243], a[136:139], v[216:219]
    v_cvt_pk_bf16_f32 v30, v208, v209
    v_cvt_pk_bf16_f32 v31, v210, v211
    v_mfma_f32_16x16x32_bf16 v[212:215], a[240:243], a[140:143], v[212:215]
    v_cvt_pk_bf16_f32 v32, v204, v205
    v_cvt_pk_bf16_f32 v33, v206, v207
    v_mfma_f32_16x16x32_bf16 v[208:211], a[144:147], a[244:247], 0
    v_cvt_pk_bf16_f32 v34, v200, v201
    v_cvt_pk_bf16_f32 v35, v202, v203
    v_mfma_f32_16x16x32_bf16 v[164:167], v[30:33], v[132:135], v[164:167]
    v_cvt_pk_bf16_f32 v70, v220, v221
    v_cvt_pk_bf16_f32 v71, v222, v223
    v_mfma_f32_16x16x32_bf16 v[204:207], a[148:151], a[244:247], 0
    v_cvt_pk_bf16_f32 v92, v216, v217
    v_cvt_pk_bf16_f32 v93, v218, v219
    v_mfma_f32_16x16x32_bf16 v[200:203], a[152:155], a[244:247], 0
    v_cvt_pk_bf16_f32 v114, v212, v213
    v_cvt_pk_bf16_f32 v115, v214, v215
    v_mfma_f32_16x16x16_bf16 v[164:167], v[34:35], v[136:137], v[164:167]
    ds_read_b128 a[240:243], v226 offset:4544
    ds_read_b64_tr_b16 a[56:57], v242 offset:49152
    v_mfma_f32_16x16x32_bf16 v[208:211], a[156:159], v[252:255], v[208:211]
    ds_read_b64_tr_b16 a[58:59], v242 offset:62976
    ds_read_b64_tr_b16 a[60:61], v242 offset:49160
    v_mfma_f32_16x16x32_bf16 v[204:207], a[160:163], v[252:255], v[204:207]
    ds_read_b64_tr_b16 a[62:63], v242 offset:62984
    v_cndmask_b32 v226, v244, v247, vcc
    v_mfma_f32_16x16x32_bf16 v[200:203], a[164:167], v[252:255], v[200:203]
    s_waitcnt lgkmcnt(7)
    ds_read_b64_tr_b16 a[64:65], v241 offset:50688
    v_cndmask_b32 v247, v247, v244, vcc
    v_mfma_f32_16x16x32_bf16 v[208:211], a[168:171], a[248:251], v[208:211]
    ds_read_b64_tr_b16 a[66:67], v241 offset:61440
    v_max3_f32 v249, v249, v164, v165
    v_mfma_f32_16x16x32_bf16 v[204:207], a[172:175], a[248:251], v[204:207]
    ds_read_b64_tr_b16 a[68:69], v241 offset:50696
    v_max3_f32 v248, v248, v166, v167
    v_mfma_f32_16x16x32_bf16 v[200:203], a[176:179], a[248:251], v[200:203]
    ds_read_b64_tr_b16 a[70:71], v241 offset:61448
    v_max3_f32 v249, v249, v168, v169
    v_mfma_f32_16x16x32_bf16 v[208:211], a[180:183], a[252:255], v[208:211]
    ds_read_b128 a[244:247], v239 offset:12288
    v_max3_f32 v248, v248, v170, v171
    v_mfma_f32_16x16x32_bf16 v[204:207], a[184:187], a[252:255], v[204:207]
    ds_read_b128 v[252:255], v240 offset:12288
    v_max_f32 v248, v248, v249
    v_mfma_f32_16x16x32_bf16 v[200:203], a[188:191], a[252:255], v[200:203]
    ds_read_b128 a[248:251], v239 offset:13312
    v_mov_b32 v249, v248
    v_mfma_f32_16x16x32_bf16 v[208:211], a[192:195], a[236:239], v[208:211]
    ds_read_b128 a[252:255], v240 offset:13312
    v_mfma_f32_16x16x32_bf16 v[204:207], a[196:199], a[236:239], v[204:207]
    v_permlane16_swap_b32 v248, v249
    v_mfma_f32_16x16x32_bf16 v[200:203], a[200:203], a[236:239], v[200:203]
    s_waitcnt lgkmcnt(10)
    ds_read_b128 a[236:239], v239 offset:14336
    v_max_f32 v248, v248, v249
    v_mfma_f32_16x16x32_bf16 v[208:211], a[204:207], a[240:243], v[208:211]
    v_mov_b32 v249, v248
    v_mfma_f32_16x16x32_bf16 v[204:207], a[208:211], a[240:243], v[204:207]
    v_mfma_f32_16x16x32_bf16 v[200:203], a[212:215], a[240:243], v[200:203]
    s_waitcnt lgkmcnt(4)
    ds_read_b128 a[240:243], v240 offset:14336
    v_permlane32_swap_b32 v248, v249
    v_max_f32 v248, v248, v249
    v_mul_f32 v236, s37, v248
    v_fma_f32 v172, v172, s37, -v236
    v_cvt_pk_bf16_f32 v138, v208, v209
    v_cvt_pk_bf16_f32 v139, v210, v211
    v_mfma_f32_16x16x32_bf16 v[220:223], a[220:223], a[244:247], 0
    s_waitcnt lgkmcnt(4)
    v_cvt_pk_bf16_f32 v140, v204, v205
    v_cvt_pk_bf16_f32 v141, v206, v207
    v_mfma_f32_16x16x32_bf16 v[212:215], a[220:223], v[252:255], 0
    v_cvt_pk_bf16_f32 v142, v200, v201
    v_cvt_pk_bf16_f32 v143, v202, v203
    v_mfma_f32_16x16x32_bf16 v[216:219], a[224:227], a[244:247], 0
    v_fma_f32 v173, v173, s37, -v236
    v_fma_f32 v174, v174, s37, -v236
    v_mfma_f32_16x16x32_bf16 v[208:211], a[224:227], v[252:255], 0
    ds_read_b128 v[252:255], v240 offset:15360
    v_fma_f32 v175, v175, s37, -v236
    v_mfma_f32_16x16x32_bf16 v[204:207], a[228:231], a[244:247], 0
    v_exp_f32 v172, v172
    v_mfma_f32_16x16x32_bf16 v[200:203], a[232:235], a[244:247], 0
    s_waitcnt lgkmcnt(2)
    ds_read_b128 a[244:247], v239 offset:15360
    v_fma_f32 v144, v144, s37, -v236
    v_mfma_f32_16x16x32_bf16 v[220:223], a[0:3], a[248:251], v[220:223]
    v_exp_f32 v173, v173
    v_mfma_f32_16x16x32_bf16 v[212:215], a[0:3], a[252:255], v[212:215]
    v_exp_f32 v174, v174
    v_mfma_f32_16x16x32_bf16 v[216:219], a[4:7], a[248:251], v[216:219]
    v_exp_f32 v175, v175
    v_mfma_f32_16x16x32_bf16 v[208:211], a[4:7], a[252:255], v[208:211]
    ds_read_b128 a[252:255], v240 offset:16384
    v_cvt_pk_bf16_f32 v176, v172, v173
    v_mfma_f32_16x16x32_bf16 v[204:207], a[8:11], a[248:251], v[204:207]
    v_cvt_pk_bf16_f32 v177, v174, v175
    v_fma_f32 v145, v145, s37, -v236
    v_mfma_f32_16x16x32_bf16 v[200:203], a[12:15], a[248:251], v[200:203]
    ds_read_b128 a[248:251], v239 offset:16384
    ds_read_b128 v[172:175], v234
    v_mfma_f32_16x16x32_bf16 v[220:223], a[16:19], a[236:239], v[220:223]
    s_waitcnt lgkmcnt(5)
    v_bfe_u32 v234, s79, v233, 4
    v_mad_u32_u24 v234, v234, s40, v231
    v_mfma_f32_16x16x32_bf16 v[212:215], a[16:19], a[240:243], v[212:215]
    v_fma_f32 v146, v146, s37, -v236
    v_fma_f32 v147, v147, s37, -v236
    v_mfma_f32_16x16x32_bf16 v[216:219], a[20:23], a[236:239], v[216:219]
    v_exp_f32 v144, v144
    v_mfma_f32_16x16x32_bf16 v[208:211], a[20:23], a[240:243], v[208:211]
    ds_read_b128 a[240:243], v240 offset:17408
    v_fma_f32 v148, v148, s37, -v236
    v_mfma_f32_16x16x32_bf16 v[204:207], a[24:27], a[236:239], v[204:207]
    v_exp_f32 v145, v145
    v_mfma_f32_16x16x32_bf16 v[200:203], a[28:31], a[236:239], v[200:203]
    s_waitcnt lgkmcnt(4)
    ds_read_b128 a[236:239], v239 offset:17408
    v_cvt_pk_bf16_f32 v178, v144, v145
    v_mfma_f32_16x16x32_bf16 v[220:223], a[32:35], a[244:247], v[220:223]
    v_exp_f32 v146, v146
    v_mfma_f32_16x16x32_bf16 v[212:215], a[32:35], v[252:255], v[212:215]
    v_exp_f32 v147, v147
    v_mfma_f32_16x16x32_bf16 v[216:219], a[36:39], a[244:247], v[216:219]
    v_cvt_pk_bf16_f32 v179, v146, v147
    v_fma_f32 v149, v149, s37, -v236
    v_mfma_f32_16x16x32_bf16 v[208:211], a[36:39], v[252:255], v[208:211]
    ds_read_b64_tr_b16 v[252:253], v242 offset:50696
    ds_read_b64_tr_b16 v[254:255], v242 offset:61448
    v_mfma_f32_16x16x32_bf16 v[196:199], a[216:219], v[176:179], 0
    ds_read_b128 v[144:147], v230 offset:1280
    v_fma_f32 v150, v150, s37, -v236
    v_mfma_f32_16x16x32_bf16 v[184:187], v[74:77], v[176:179], 0
    v_fma_f32 v151, v151, s37, -v236
    v_fma_f32 v152, v152, s37, -v236
    v_mfma_f32_16x16x32_bf16 v[188:191], v[96:99], v[176:179], 0
    v_exp_f32 v148, v148
    v_mfma_f32_16x16x32_bf16 v[192:195], v[118:121], v[176:179], 0
    s_waitcnt lgkmcnt(4)
    v_exp_f32 v149, v149
    v_mfma_f32_16x16x32_bf16 v[172:175], v[36:39], v[138:141], v[172:175]
    v_exp_f32 v150, v150
    v_mfma_f32_16x16x32_bf16 v[204:207], a[40:43], a[244:247], v[204:207]
    v_exp_f32 v151, v151
    v_mfma_f32_16x16x32_bf16 v[200:203], a[44:47], a[244:247], v[200:203]
    ds_read_b64_tr_b16 a[244:245], v242 offset:50688
    ds_read_b64_tr_b16 a[246:247], v242 offset:61440
    v_mfma_f32_16x16x16_bf16 v[172:175], v[40:41], v[142:143], v[172:175]
    v_cvt_pk_bf16_f32 v180, v148, v149
    v_cvt_pk_bf16_f32 v181, v150, v151
    v_mfma_f32_16x16x32_bf16 v[220:223], a[48:51], a[248:251], v[220:223]
    ds_read_b128 v[148:151], v235
    v_bfe_u32 v235, s80, v233, 4
    v_mfma_f32_16x16x32_bf16 v[212:215], a[48:51], a[252:255], v[212:215]
    v_mad_u32_u24 v235, v235, s40, v231
    v_fma_f32 v153, v153, s37, -v236
    v_mfma_f32_16x16x32_bf16 v[216:219], a[52:55], a[248:251], v[216:219]
    s_waitcnt lgkmcnt(3)
    v_fma_f32 v154, v154, s37, -v236
    v_fma_f32 v155, v155, s37, -v236
    v_mfma_f32_16x16x32_bf16 v[144:147], v[42:45], v[138:141], v[144:147]
    v_exp_f32 v152, v152
    v_mfma_f32_16x16x32_bf16 v[208:211], a[52:55], a[252:255], v[208:211]
    v_exp_f32 v153, v153
    v_mfma_f32_16x16x32_bf16 v[204:207], a[56:59], a[248:251], v[204:207]
    v_exp_f32 v154, v154
    v_mfma_f32_16x16x32_bf16 v[200:203], a[60:63], a[248:251], v[200:203]
    v_exp_f32 v155, v155
    v_mfma_f32_16x16x16_bf16 v[144:147], v[46:47], v[142:143], v[144:147]
    v_cvt_pk_bf16_f32 v182, v152, v153
    v_cvt_pk_bf16_f32 v183, v154, v155
    v_mfma_f32_16x16x32_bf16 v[220:223], a[64:67], a[236:239], v[220:223]
    ds_read_b128 v[152:155], v250
    v_fma_f32 v156, v156, s37, -v236
    v_mfma_f32_16x16x32_bf16 v[196:199], a[216:219], v[180:183], v[196:199]
    v_fma_f32 v157, v157, s37, -v236
    v_fma_f32 v158, v158, s37, -v236
    v_mfma_f32_16x16x32_bf16 v[184:187], v[78:81], v[180:183], v[184:187]
    v_fma_f32 v159, v159, s37, -v236
    v_fma_f32 v160, v160, s37, -v236
    v_mfma_f32_16x16x32_bf16 v[188:191], v[100:103], v[180:183], v[188:191]
    v_cvt_pk_bf16_f32 v220, v220, v221
    v_cvt_pk_bf16_f32 v221, v222, v223
    v_mfma_f32_16x16x32_bf16 v[192:195], v[122:125], v[180:183], v[192:195]
    s_waitcnt lgkmcnt(1)
    v_exp_f32 v156, v156
    v_mfma_f32_16x16x32_bf16 v[148:151], v[24:27], v[138:141], v[148:151]
    v_exp_f32 v157, v157
    v_mfma_f32_16x16x32_bf16 v[212:215], a[64:67], a[240:243], v[212:215]
    v_exp_f32 v158, v158
    v_mfma_f32_16x16x32_bf16 v[216:219], a[68:71], a[236:239], v[216:219]
    v_exp_f32 v159, v159
    v_mfma_f32_16x16x32_bf16 v[208:211], a[68:71], a[240:243], v[208:211]
    v_cvt_pk_bf16_f32 v176, v156, v157
    v_cvt_pk_bf16_f32 v177, v158, v159
    v_mfma_f32_16x16x16_bf16 v[148:151], v[28:29], v[142:143], v[148:151]
    s_waitcnt lgkmcnt(0)
    ds_read_b128 v[156:159], v234
    v_cvt_pk_bf16_f32 v212, v212, v213
    v_mfma_f32_16x16x32_bf16 v[152:155], v[30:33], v[138:141], v[152:155]
    v_cvt_pk_bf16_f32 v222, v216, v217
    v_cvt_pk_bf16_f32 v223, v218, v219
    v_mfma_f32_16x16x32_bf16 v[204:207], a[244:247], a[236:239], v[204:207]
    buffer_store_dwordx4 v[220:223], v243, s[20:23], s58 offen sc0 sc1
    v_mfma_f32_16x16x32_bf16 v[200:203], v[252:255], a[236:239], v[200:203]
    v_cvt_pk_bf16_f32 v213, v214, v215
    v_cvt_pk_bf16_f32 v214, v208, v209
    v_mfma_f32_16x16x16_bf16 v[152:155], v[34:35], v[142:143], v[152:155]
    s_waitcnt lgkmcnt(0)
    v_cvt_pk_bf16_f32 v215, v210, v211
    v_fma_f32 v161, v161, s37, -v236
    v_fma_f32 v162, v162, s37, -v236
    v_cvt_pk_bf16_f32 v204, v204, v205
    v_cvt_pk_bf16_f32 v205, v206, v207
    v_cvt_pk_bf16_f32 v206, v200, v201
    v_cvt_pk_bf16_f32 v207, v202, v203
    v_fma_f32 v163, v163, s37, -v236
    v_exp_f32 v160, v160
    v_exp_f32 v161, v161
    v_exp_f32 v162, v162
    v_exp_f32 v163, v163
    v_cvt_pk_bf16_f32 v178, v160, v161
    v_mfma_f32_16x16x32_bf16 v[156:159], v[48:51], v[138:141], v[156:159]
    v_cvt_pk_bf16_f32 v179, v162, v163
    v_fma_f32 v164, v164, s37, -v236
    ds_read_b128 v[160:163], v235
    v_mfma_f32_16x16x32_bf16 v[196:199], a[216:219], v[176:179], v[196:199]
    v_fma_f32 v165, v165, s37, -v236
    v_fma_f32 v166, v166, s37, -v236
    v_mfma_f32_16x16x32_bf16 v[184:187], v[66:69], v[176:179], v[184:187]
    v_fma_f32 v167, v167, s37, -v236
    v_fma_f32 v168, v168, s37, -v236
    v_mfma_f32_16x16x32_bf16 v[188:191], v[88:91], v[176:179], v[188:191]
    v_exp_f32 v164, v164
    v_mfma_f32_16x16x32_bf16 v[192:195], v[110:113], v[176:179], v[192:195]
    buffer_store_dwordx4 v[212:215], v245, s[20:23], s58 offen sc0 sc1
    v_mfma_f32_16x16x16_bf16 v[156:159], v[52:53], v[142:143], v[156:159]
    s_waitcnt lgkmcnt(0)
    v_exp_f32 v165, v165
    v_exp_f32 v166, v166
    v_exp_f32 v167, v167
    v_cvt_pk_bf16_f32 v180, v164, v165
    v_cvt_pk_bf16_f32 v181, v166, v167
    v_fma_f32 v169, v169, s37, -v236
    v_fma_f32 v170, v170, s37, -v236
    v_fma_f32 v171, v171, s37, -v236
    v_exp_f32 v168, v168
    v_exp_f32 v169, v169
    v_mfma_f32_16x16x32_bf16 v[160:163], v[54:57], v[138:141], v[160:163]
    v_exp_f32 v170, v170
    v_exp_f32 v171, v171
    v_cvt_pk_bf16_f32 v182, v168, v169
    v_cvt_pk_bf16_f32 v183, v170, v171
    v_max3_f32 v248, v172, v173, v174
    v_max3_f32 v249, v175, v144, v145
    v_mfma_f32_16x16x32_bf16 v[196:199], a[216:219], v[180:183], v[196:199]
    v_max3_f32 v248, v248, v146, v147
    v_max3_f32 v249, v249, v148, v149
    v_mfma_f32_16x16x32_bf16 v[184:187], v[70:73], v[180:183], v[184:187]
    v_max3_f32 v248, v248, v150, v151
    v_max3_f32 v249, v249, v152, v153
    v_mfma_f32_16x16x32_bf16 v[188:191], v[92:95], v[180:183], v[188:191]
    v_max3_f32 v248, v248, v154, v155
    v_max3_f32 v249, v249, v156, v157
    v_mfma_f32_16x16x32_bf16 v[192:195], v[114:117], v[180:183], v[192:195]
    v_rcp_f32 v197, v196
    v_mfma_f32_16x16x16_bf16 v[160:163], v[58:59], v[142:143], v[160:163]
    buffer_store_dwordx4 v[204:207], v244, s[20:23], s58 offen sc0 sc1
    v_mul_f32 v184, v184, v197
    v_mul_f32 v185, v185, v197
    v_cvt_pk_bf16_f32 v184, v184, v185
    v_mul_f32 v186, v186, v197
    v_mul_f32 v187, v187, v197
    v_cvt_pk_bf16_f32 v185, v186, v187
    v_mul_f32 v188, v188, v197
    v_mul_f32 v189, v189, v197
    v_cvt_pk_bf16_f32 v186, v188, v189
    v_mul_f32 v190, v190, v197
    v_mul_f32 v191, v191, v197
    v_cvt_pk_bf16_f32 v187, v190, v191
    v_mul_f32 v192, v192, v197
    v_mul_f32 v193, v193, v197
    v_cvt_pk_bf16_f32 v188, v192, v193
    v_mul_f32 v194, v194, v197
    v_mul_f32 v195, v195, v197
    v_cvt_pk_bf16_f32 v189, v194, v195
    ds_write_b128 v237, v[184:187]
    ds_write_b64 v238, v[188:189]
    s_add_u32 s58, s51, 0x1f8000
    v_max3_f32 v248, v248, v158, v159
    v_max3_f32 v249, v249, v160, v161
    v_max3_f32 v248, v248, v162, v163
    v_max_f32 v248, v248, v249
    v_mov_b32 v249, v248
    s_nop 1
    v_permlane16_swap_b32 v248, v249
    v_max_f32 v248, v248, v249
    v_mov_b32 v249, v248
    s_nop 1
    v_permlane32_swap_b32 v248, v249
    v_max_f32 v248, v248, v249
    v_mul_f32 v236, s37, v248
    v_fma_f32 v172, v172, s37, -v236
    v_fma_f32 v173, v173, s37, -v236
    v_fma_f32 v174, v174, s37, -v236
    v_fma_f32 v175, v175, s37, -v236
    v_exp_f32 v172, v172
    v_exp_f32 v173, v173
    v_exp_f32 v174, v174
    v_exp_f32 v175, v175
    v_cvt_pk_bf16_f32 v176, v172, v173
    v_cvt_pk_bf16_f32 v177, v174, v175
    s_waitcnt lgkmcnt(0)
    s_barrier
    ds_read_b128 a[248:251], v224
    ds_read_b128 a[252:255], v224 offset:1024
    ds_read_b128 a[236:239], v224 offset:2048
    v_fma_f32 v144, v144, s37, -v236
    ds_read_b128 a[240:243], v224 offset:3072
    v_fma_f32 v145, v145, s37, -v236
    ds_read_b128 a[244:247], v224 offset:4096
    v_fma_f32 v146, v146, s37, -v236
    ds_read_b128 v[252:255], v224 offset:5120
    v_fma_f32 v147, v147, s37, -v236
    v_exp_f32 v144, v144
    v_exp_f32 v145, v145
    v_exp_f32 v146, v146
    v_exp_f32 v147, v147
    v_cvt_pk_bf16_f32 v178, v144, v145
    v_cvt_pk_bf16_f32 v179, v146, v147
    v_fma_f32 v148, v148, s37, -v236
    v_fma_f32 v149, v149, s37, -v236
    v_mfma_f32_16x16x32_bf16 v[196:199], a[216:219], v[176:179], 0
    v_fma_f32 v150, v150, s37, -v236
    v_fma_f32 v151, v151, s37, -v236
    v_mfma_f32_16x16x32_bf16 v[184:187], v[76:79], v[176:179], 0
    v_exp_f32 v148, v148
    v_mfma_f32_16x16x32_bf16 v[188:191], v[98:101], v[176:179], 0
    v_exp_f32 v149, v149
    v_mfma_f32_16x16x32_bf16 v[192:195], v[120:123], v[176:179], 0
    s_waitcnt lgkmcnt(4)
    v_exp_f32 v150, v150
    v_mfma_f32_16x16x32_bf16 v[220:223], a[220:223], a[248:251], 0
    v_exp_f32 v151, v151
    v_mfma_f32_16x16x32_bf16 v[216:219], a[224:227], a[248:251], 0
    v_cvt_pk_bf16_f32 v180, v148, v149
    v_cvt_pk_bf16_f32 v181, v150, v151
    v_mfma_f32_16x16x32_bf16 v[212:215], a[228:231], a[248:251], 0
    v_fma_f32 v152, v152, s37, -v236
    v_fma_f32 v153, v153, s37, -v236
    v_mfma_f32_16x16x32_bf16 v[208:211], a[232:235], a[248:251], 0
    ds_read_b64_tr_b16 a[248:249], v242 offset:50688
    ds_read_b64_tr_b16 a[250:251], v242 offset:61440
    v_mfma_f32_16x16x32_bf16 v[220:223], a[0:3], a[252:255], v[220:223]
    v_fma_f32 v154, v154, s37, -v236
    v_fma_f32 v155, v155, s37, -v236
    v_mfma_f32_16x16x32_bf16 v[216:219], a[4:7], a[252:255], v[216:219]
    v_exp_f32 v152, v152
    v_mfma_f32_16x16x32_bf16 v[212:215], a[8:11], a[252:255], v[212:215]
    v_exp_f32 v153, v153
    v_mfma_f32_16x16x32_bf16 v[208:211], a[12:15], a[252:255], v[208:211]
    s_waitcnt lgkmcnt(2)
    ds_read_b64_tr_b16 a[252:253], v242 offset:50696
    ds_read_b64_tr_b16 a[254:255], v242 offset:61448
    v_mfma_f32_16x16x32_bf16 v[220:223], a[16:19], a[236:239], v[220:223]
    v_exp_f32 v154, v154
    v_mfma_f32_16x16x32_bf16 v[216:219], a[20:23], a[236:239], v[216:219]
    v_exp_f32 v155, v155
    v_mfma_f32_16x16x32_bf16 v[212:215], a[24:27], a[236:239], v[212:215]
    v_cvt_pk_bf16_f32 v182, v152, v153
    v_cvt_pk_bf16_f32 v183, v154, v155
    v_mfma_f32_16x16x32_bf16 v[208:211], a[28:31], a[236:239], v[208:211]
    v_fma_f32 v156, v156, s37, -v236
    v_fma_f32 v157, v157, s37, -v236
    v_mfma_f32_16x16x32_bf16 v[196:199], a[216:219], v[180:183], v[196:199]
    v_fma_f32 v158, v158, s37, -v236
    v_fma_f32 v159, v159, s37, -v236
    v_mfma_f32_16x16x32_bf16 v[184:187], v[68:71], v[180:183], v[184:187]
    v_exp_f32 v156, v156
    v_mfma_f32_16x16x32_bf16 v[188:191], v[90:93], v[180:183], v[188:191]
    v_exp_f32 v157, v157
    v_mfma_f32_16x16x32_bf16 v[192:195], v[112:115], v[180:183], v[192:195]
    v_exp_f32 v158, v158
    v_mfma_f32_16x16x32_bf16 v[220:223], a[32:35], a[240:243], v[220:223]
    v_exp_f32 v159, v159
    v_mfma_f32_16x16x32_bf16 v[216:219], a[36:39], a[240:243], v[216:219]
    v_cvt_pk_bf16_f32 v176, v156, v157
    v_cvt_pk_bf16_f32 v177, v158, v159
    v_mfma_f32_16x16x32_bf16 v[212:215], a[40:43], a[240:243], v[212:215]
    v_fma_f32 v160, v160, s37, -v236
    v_fma_f32 v161, v161, s37, -v236
    v_mfma_f32_16x16x32_bf16 v[208:211], a[44:47], a[240:243], v[208:211]
    v_fma_f32 v162, v162, s37, -v236
    v_fma_f32 v163, v163, s37, -v236
    v_mfma_f32_16x16x32_bf16 v[220:223], a[48:51], a[244:247], v[220:223]
    v_exp_f32 v160, v160
    v_mfma_f32_16x16x32_bf16 v[216:219], a[52:55], a[244:247], v[216:219]
    v_exp_f32 v161, v161
    v_mfma_f32_16x16x32_bf16 v[212:215], a[56:59], a[244:247], v[212:215]
    v_exp_f32 v162, v162
    v_mfma_f32_16x16x32_bf16 v[208:211], a[60:63], a[244:247], v[208:211]
    v_exp_f32 v163, v163
    v_mfma_f32_16x16x32_bf16 v[220:223], a[64:67], v[252:255], v[220:223]
    v_cvt_pk_bf16_f32 v178, v160, v161
    v_cvt_pk_bf16_f32 v179, v162, v163
    v_mfma_f32_16x16x32_bf16 v[216:219], a[68:71], v[252:255], v[216:219]
    s_waitcnt lgkmcnt(0)
    v_mfma_f32_16x16x32_bf16 v[212:215], a[248:251], v[252:255], v[212:215]
    v_mfma_f32_16x16x32_bf16 v[196:199], a[216:219], v[176:179], v[196:199]
    v_mfma_f32_16x16x32_bf16 v[184:187], v[82:85], v[176:179], v[184:187]
    v_mfma_f32_16x16x32_bf16 v[188:191], v[104:107], v[176:179], v[188:191]
    v_mfma_f32_16x16x32_bf16 v[192:195], v[126:129], v[176:179], v[192:195]
    v_cvt_pk_bf16_f32 v220, v220, v221
    v_cvt_pk_bf16_f32 v221, v222, v223
    v_mfma_f32_16x16x32_bf16 v[208:211], a[252:255], v[252:255], v[208:211]
    v_cvt_pk_bf16_f32 v222, v216, v217
    v_cvt_pk_bf16_f32 v223, v218, v219
    buffer_store_dwordx4 v[220:223], v225, s[20:23], s58 offen sc0 sc1
    v_cvt_pk_bf16_f32 v212, v212, v213
    v_cvt_pk_bf16_f32 v213, v214, v215
    v_rcp_f32 v197, v196
    s_nop 0
    v_mul_f32 v184, v184, v197
    v_cvt_pk_bf16_f32 v214, v208, v209
    v_cvt_pk_bf16_f32 v215, v210, v211
    v_mul_f32 v185, v185, v197
    v_cvt_pk_bf16_f32 v184, v184, v185
    v_mul_f32 v186, v186, v197
    v_mul_f32 v187, v187, v197
    v_cvt_pk_bf16_f32 v185, v186, v187
    v_mul_f32 v188, v188, v197
    v_mul_f32 v189, v189, v197
    v_cvt_pk_bf16_f32 v186, v188, v189
    v_mul_f32 v190, v190, v197
    v_mul_f32 v191, v191, v197
    v_cvt_pk_bf16_f32 v187, v190, v191
    v_mul_f32 v192, v192, v197
    v_mul_f32 v193, v193, v197
    v_cvt_pk_bf16_f32 v188, v192, v193
    v_mul_f32 v194, v194, v197
    v_mul_f32 v195, v195, v197
    v_cvt_pk_bf16_f32 v189, v194, v195
    ds_write_b128 v237, v[184:187] offset:6144
    ds_write_b64 v238, v[188:189] offset:6144
    buffer_store_dwordx4 v[212:215], v226, s[20:23], s58 offen sc0 sc1
    s_add_u32 s58, s51, 0x1f8000
    s_waitcnt lgkmcnt(0)
    s_barrier
    ds_read_b128 a[236:239], v227
    ds_read_b128 a[240:243], v227 offset:1024
    ds_read_b128 a[244:247], v227 offset:2048
    ds_read_b128 v[252:255], v227 offset:3072
    ds_read_b128 a[248:251], v227 offset:4096
    ds_read_b128 a[252:255], v227 offset:5120
    s_waitcnt lgkmcnt(5)
    v_mfma_f32_16x16x32_bf16 v[204:207], a[220:223], a[236:239], 0
    v_mfma_f32_16x16x32_bf16 v[200:203], a[224:227], a[236:239], 0
    v_mfma_f32_16x16x32_bf16 v[220:223], a[228:231], a[236:239], 0
    v_mfma_f32_16x16x32_bf16 v[216:219], a[232:235], a[236:239], 0
    s_waitcnt lgkmcnt(3)
    ds_read_b64_tr_b16 a[236:237], v242 offset:50688
    ds_read_b64_tr_b16 a[238:239], v242 offset:61440
    v_mfma_f32_16x16x32_bf16 v[204:207], a[0:3], a[240:243], v[204:207]
    v_mfma_f32_16x16x32_bf16 v[200:203], a[4:7], a[240:243], v[200:203]
    v_mfma_f32_16x16x32_bf16 v[220:223], a[8:11], a[240:243], v[220:223]
    v_mfma_f32_16x16x32_bf16 v[216:219], a[12:15], a[240:243], v[216:219]
    ds_read_b64_tr_b16 a[240:241], v242 offset:50696
    ds_read_b64_tr_b16 a[242:243], v242 offset:61448
    v_mfma_f32_16x16x32_bf16 v[204:207], a[16:19], a[244:247], v[204:207]
    v_mfma_f32_16x16x32_bf16 v[200:203], a[20:23], a[244:247], v[200:203]
    v_mfma_f32_16x16x32_bf16 v[220:223], a[24:27], a[244:247], v[220:223]
    v_mfma_f32_16x16x32_bf16 v[216:219], a[28:31], a[244:247], v[216:219]
    s_waitcnt lgkmcnt(4)
    v_mfma_f32_16x16x32_bf16 v[204:207], a[32:35], v[252:255], v[204:207]
    v_mfma_f32_16x16x32_bf16 v[200:203], a[36:39], v[252:255], v[200:203]
    v_mfma_f32_16x16x32_bf16 v[220:223], a[40:43], v[252:255], v[220:223]
    v_mfma_f32_16x16x32_bf16 v[216:219], a[44:47], v[252:255], v[216:219]
    v_mfma_f32_16x16x32_bf16 v[204:207], a[48:51], a[248:251], v[204:207]
    v_mfma_f32_16x16x32_bf16 v[200:203], a[52:55], a[248:251], v[200:203]
    v_mfma_f32_16x16x32_bf16 v[220:223], a[56:59], a[248:251], v[220:223]
    v_mfma_f32_16x16x32_bf16 v[216:219], a[60:63], a[248:251], v[216:219]
    v_mfma_f32_16x16x32_bf16 v[204:207], a[64:67], a[252:255], v[204:207]
    v_mfma_f32_16x16x32_bf16 v[200:203], a[68:71], a[252:255], v[200:203]
    s_waitcnt lgkmcnt(0)
    v_mfma_f32_16x16x32_bf16 v[220:223], a[236:239], a[252:255], v[220:223]
    v_mfma_f32_16x16x32_bf16 v[216:219], a[240:243], a[252:255], v[216:219]
    s_nop 4
    v_cvt_pk_bf16_f32 v204, v204, v205
    v_cvt_pk_bf16_f32 v205, v206, v207
    v_cvt_pk_bf16_f32 v206, v200, v201
    v_cvt_pk_bf16_f32 v207, v202, v203
    buffer_store_dwordx4 v[204:207], v246, s[20:23], s58 offen sc0 sc1
    v_cvt_pk_bf16_f32 v220, v220, v221
    v_cvt_pk_bf16_f32 v221, v222, v223
    v_cvt_pk_bf16_f32 v222, v216, v217
    v_cvt_pk_bf16_f32 v223, v218, v219
    buffer_store_dwordx4 v[220:223], v247, s[20:23], s58 offen sc0 sc1
    s_endpgm
.section .rodata,"a"
.p2align 6
.amdhsa_kernel standalone__neighborhood_dinat__vision_kernel
  .amdhsa_next_free_vgpr 512
  .amdhsa_next_free_sgpr 102
  .amdhsa_accum_offset 256
  .amdhsa_group_segment_fixed_size 0
  .amdhsa_kernarg_size 56
  .amdhsa_user_sgpr_count 2
  .amdhsa_user_sgpr_kernarg_segment_ptr 1
  .amdhsa_system_sgpr_workgroup_id_x 1
.end_amdhsa_kernel
```

```asm
; @launch grid=(256,1,1) block=(256,1,1) lds=163344
.amdgcn_target "amdgcn-amd-amdhsa--gfx950"
.text
.globl standalone__neighborhood_dinat__vision_kernel
.p2align 8
.type standalone__neighborhood_dinat__vision_kernel,@function
standalone__neighborhood_dinat__vision_kernel:
    s_cmp_ge_u32 s2, 256
    s_cbranch_scc1 L_exit
L_go:
    s_load_dwordx4 s[24:27], s[0:1], 0
    s_load_dwordx4 s[28:31], s[0:1], 16
    s_load_dwordx2 s[32:33], s[0:1], 32
    s_getpc_b64 s[12:13]
    s_and_b32 s13, s13, 0xffff
    s_mov_b32 s14, L_end-L_go-64
    s_mov_b32 s15, 0x20000
    s_lshl_b32 s52, s2, 10
    v_lshlrev_b32 v189, 5, v0
    s_and_b32 s53, s52, 0xe000
    buffer_load_dword v188, v189, s[12:15], s53 offen
    v_lshrrev_b32 v74, 6, v0
    v_and_b32 v184, 63, v0
    v_readfirstlane_b32 s36, v74
    v_mul_u32_u24 v76, 0x2aab, v184
    v_lshrrev_b32 v76, 16, v76
    v_mul_u32_u24 v74, 6, v76
    v_sub_u32 v77, v184, v74
    v_lshrrev_b32 v74, 1, v76
    v_and_b32 v74, 4, v74
    v_xor_b32 v76, v76, v74
    v_mul_u32_u24 v74, 0x480, v76
    v_lshl_add_u32 v251, v77, 4, v74
    v_add_u32 v79, 64, v184
    v_mul_u32_u24 v78, 0x2aab, v79
    v_lshrrev_b32 v78, 16, v78
    v_mul_u32_u24 v74, 6, v78
    v_sub_u32 v79, v79, v74
    v_lshrrev_b32 v74, 1, v78
    v_and_b32 v74, 4, v74
    v_xor_b32 v78, v78, v74
    v_mul_u32_u24 v74, 0x480, v78
    v_lshl_add_u32 v252, v79, 4, v74
    v_add_u32 v81, 0x80, v184
    v_mul_u32_u24 v80, 0x2aab, v81
    v_lshrrev_b32 v80, 16, v80
    v_mul_u32_u24 v74, 6, v80
    v_sub_u32 v81, v81, v74
    v_lshrrev_b32 v74, 1, v80
    v_and_b32 v74, 4, v74
    v_xor_b32 v80, v80, v74
    v_mul_u32_u24 v74, 0x480, v80
    v_lshl_add_u32 v253, v81, 4, v74
    s_mul_i32 s49, s36, 0x60
    s_mul_i32 s50, s36, 0xc00
    s_add_u32 s50, s50, 0x15e00
    s_mov_b32 s10, 0x36000
    s_mov_b32 s11, 0x20000
    s_and_b32 s53, s52, 0x3e000
    s_add_u32 s57, s49, 0x180
    s_add_u32 m0, s50, 0
    s_and_b32 s54, s2, 1
    s_lshl_b32 s54, s54, 2
    s_lshl_b32 s41, s36, 10
    s_add_u32 s42, s41, 0x1000
    s_min_u32 s42, s42, 0x1a00
    s_mov_b32 s6, 0x1260000
    s_mov_b32 s7, 0x20000
    s_mov_b32 s14, 0x12000
    s_mov_b32 s15, 0x20000
    s_mov_b32 s18, 0x548
    s_mov_b32 s19, 0x20000
    s_mov_b32 s22, 0x1260000
    s_mov_b32 s23, 0x20000
    s_and_b32 s52, s52, 0x1e000
    v_lshlrev_b32 v199, 1, v184
    v_lshrrev_b32 v185, 4, v184
    v_and_b32 v186, 7, v184
    v_bfe_u32 v187, v184, 3, 1
    v_and_b32 v103, 1, v185
    v_mul_u32_u24 v102, 0x1e40, v187
    v_mul_u32_u24 v100, 0x180, v186
    v_mul_u32_u24 v74, 0x180, v76
    v_lshl_add_u32 v192, v77, 4, v74
    s_waitcnt lgkmcnt(0)
    s_mov_b32 s8, s26
    s_and_b32 s9, s27, 0xffff
    buffer_load_dword v188, v189, s[8:11], s53 offen
    buffer_load_dwordx4 v251, s[8:11], s57 offen lds
    s_add_u32 m0, s50, 0x400
    s_lshr_b32 s53, s2, 3
    buffer_load_dwordx4 v252, s[8:11], s57 offen lds
    s_add_u32 m0, s50, 0x800
    s_lshr_b32 s55, s53, 3
    buffer_load_dwordx4 v253, s[8:11], s57 offen lds
    s_or_b32 s34, s54, s55
    s_and_b32 s35, s53, 7
    s_bfe_u32 s54, s2, 0x10002
    s_mul_i32 s54, s54, 0x15000
    s_bfe_u32 s55, s2, 0x10001
    s_mul_i32 s55, s55, 0x180
    s_add_u32 s38, s54, s55
    s_mul_i32 s54, s35, 14
    s_sub_u32 s54, s54, 3
    s_movk_i32 s53, 0x6f
    s_lshr_b32 s55, s41, 4
    v_add_u32 v96, s55, v184
    v_mul_u32_u24 v97, 0xaab, v96
    v_lshrrev_b32 v97, 16, v97
    v_mul_u32_u24 v98, 24, v97
    v_sub_u32 v96, v96, v98
    v_and_b32 v98, 2, v97
    v_xor_b32 v96, v96, v98
    v_add_u32 v97, s54, v97
    v_med3_i32 v97, v97, 0, s53
    v_mul_u32_u24 v97, 0x300, v97
    v_lshl_add_u32 v246, v96, 4, v97
    s_lshr_b32 s55, s42, 4
    v_add_u32 v96, s55, v184
    v_mul_u32_u24 v97, 0xaab, v96
    v_lshrrev_b32 v97, 16, v97
    v_mul_u32_u24 v98, 24, v97
    v_sub_u32 v96, v96, v98
    v_and_b32 v98, 2, v97
    v_xor_b32 v96, v96, v98
    v_add_u32 v97, s54, v97
    v_med3_i32 v97, v97, 0, s53
    v_mul_u32_u24 v97, 0x300, v97
    v_lshl_add_u32 v247, v96, 4, v97
    s_mul_i32 s51, s34, 0x24c000
    s_add_u32 s51, s51, s38
    s_sub_u32 s39, s51, 0x7e000
    s_cmp_eq_u32 s34, 0
    s_cselect_b32 s43, 8, 0
    s_cselect_b32 s44, 9, 1
    s_cselect_b32 s45, 3, 2
    s_mul_i32 s43, s43, 0x2a000
    s_add_u32 s43, s43, s39
    s_mul_i32 s44, s44, 0x2a000
    s_add_u32 s44, s44, s39
    s_mul_i32 s45, s45, 0x2a000
    s_add_u32 s45, s45, s39
    s_mov_b32 s4, s24
    s_and_b32 s5, s25, 0xffff
    s_mov_b32 s12, s28
    s_and_b32 s13, s29, 0xffff
    s_mov_b32 s16, s30
    s_and_b32 s17, s31, 0xffff
    s_mov_b32 s20, s32
    s_and_b32 s21, s33, 0xffff
    s_add_u32 m0, s41, 0
    s_add_u32 s56, s39, 0x7e000
    buffer_load_dwordx4 v246, s[4:7], s43 offen lds
    s_add_u32 m0, s42, 0
    s_add_u32 s57, s49, 0x9180
    buffer_load_dwordx4 v247, s[4:7], s43 offen lds
    s_add_u32 m0, s41, 0x1e40
    s_mul_i32 s55, s36, 0x152
    buffer_load_dwordx4 v246, s[4:7], s44 offen lds
    s_add_u32 m0, s42, 0x1e40
    v_bfe_u32 v96, v184, 2, 2
    buffer_load_dwordx4 v247, s[4:7], s44 offen lds
    s_add_u32 m0, s41, 0x3c80
    v_and_b32 v97, 3, v184
    buffer_load_dwordx4 v246, s[4:7], s45 offen lds
    s_add_u32 m0, s42, 0x3c80
    v_lshl_add_u32 v99, v185, 3, v96
    v_lshl_add_u32 v99, v103, 2, v99
    v_lshl_add_u32 v101, v97, 3, s50
    s_movk_i32 s27, 0x60
    v_mad_u32_u24 v254, v99, s27, v101
    v_xor_b32 v99, 4, v99
    v_mad_u32_u24 v255, v99, s27, v101
    buffer_load_dwordx4 v247, s[4:7], s45 offen lds
    s_add_u32 m0, s41, 0x5ac0
    v_and_b32 v98, 2, v184
    v_xor_b32 v98, v98, v185
    v_lshlrev_b32 v98, 4, v98
    v_add3_u32 v224, v98, v100, v102
    v_mul_u32_u24 v99, 0x1e40, v96
    v_mul_u32_u24 v227, 0x180, v97
    v_add3_u32 v227, v227, v98, v99
    v_and_b32 v74, 16, v76
    v_mul_u32_u24 v74, 0x300, v74
    v_add_u32 v86, v74, v192
    buffer_load_dwordx4 v246, s[4:7], s56 offen lds
    s_add_u32 m0, s42, 0x5ac0
    v_mul_u32_u24 v74, 0x180, v78
    v_lshl_add_u32 v193, v79, 4, v74
    v_and_b32 v74, 16, v78
    v_mul_u32_u24 v74, 0x300, v74
    v_add_u32 v87, v74, v193
    v_mul_u32_u24 v74, 0x180, v80
    v_lshl_add_u32 v194, v81, 4, v74
    v_and_b32 v74, 16, v80
    v_mul_u32_u24 v74, 0x300, v74
    buffer_load_dwordx4 v247, s[4:7], s56 offen lds
    s_add_u32 s56, s39, 0xa8000
    v_add_u32 v108, v74, v194
    v_add_u32 v98, 3, v186
    v_and_b32 v98, 2, v98
    v_xor_b32 v98, v98, v185
    v_lshl_add_u32 v98, v98, 4, v100
    v_add_u32 v225, v98, v102
    v_xor_b32 v99, 1, v187
    v_mul_u32_u24 v99, 0xd3c0, v99
    v_add_u32 v226, v98, v99
    v_lshl_add_u32 v99, v185, 2, v96
    v_and_b32 v98, 2, v185
    v_lshlrev_b32 v98, 1, v98
    v_xor_b32 v99, v99, v98
    v_mul_u32_u24 v99, 0x60, v99
    v_bfrev_b32 v98, v97
    v_lshrrev_b32 v98, 27, v98
    v_add3_u32 v109, v99, v98, s50
    v_lshlrev_b32 v99, 7, v185
    v_lshl_add_u32 v99, v186, 4, v99
    v_lshl_add_u32 v101, v187, 9, v99
    v_add_u32 v130, s50, v101
    v_lshl_add_u32 v99, v187, 10, v99
    s_and_b32 s24, s36, 1
    s_lshl_b32 s25, s24, 10
    s_add_u32 s26, s25, s50
    v_add_u32 v241, s26, v99
    s_lshr_b32 s27, s36, 1
    s_mul_i32 s26, s27, 0x1800
    s_add_u32 s26, s26, 0x16600
    v_add_u32 v242, s26, v99
    s_lshl_b32 s25, s24, 5
    v_mul_u32_u24 v99, 0x2a000, v187
    v_lshl_add_u32 v99, v100, 1, v99
    v_lshl_add_u32 v99, v185, 4, v99
    v_cmp_lt_u32 vcc, 5, v186
    v_add_u32 v98, 0x1800, v99
    v_bfrev_b32 v101, 1
    v_cndmask_b32 v98, v98, v101, vcc
    s_sub_u32 s59, 0, s24
    s_mov_b32 vcc_lo, s59
    s_mov_b32 vcc_hi, s59
    v_cndmask_b32 v101, v99, v98, vcc
    v_cndmask_b32 v102, v98, v99, vcc
    s_add_u32 s25, s25, s49
    v_add_u32 v243, s25, v101
    v_add_u32 v245, s25, v102
    s_mul_i32 s26, s27, 0xc0
    s_add_u32 s26, s26, 64
    v_add_u32 v244, s26, v101
    s_mul_i32 s25, s35, 0x2a00
    s_add_u32 s51, s51, s25
    s_add_u32 s58, s51, 0
    v_lshlrev_b32 v99, 4, v184
    v_add_u32 v99, 0x12e00, v99
    s_mul_i32 s25, s24, 0x1800
    v_add_u32 v239, s25, v99
    s_sub_u32 s25, 0x1800, s25
    v_add_u32 v240, s25, v99
    s_mul_i32 s25, s27, 0xc00
    s_lshl_b32 s26, s24, 11
    s_add_u32 s26, s26, s25
    v_add_u32 v237, s26, v99
    s_lshl_b32 s26, s24, 3
    s_add_u32 s26, s26, s25
    s_add_u32 s26, s26, 0x400
    v_add_u32 v238, s26, v99
    s_mov_b32 s37, 0x3e553b95
    s_mov_b32 s40, 0x140
    s_cmp_eq_u32 s34, 7
    s_cselect_b32 s46, 16, 17
    s_cselect_b32 s47, 10, 18
    s_cselect_b32 s48, 11, 19
    s_mul_i32 s46, s46, 0x2a000
    s_add_u32 s46, s46, s39
    s_mul_i32 s47, s47, 0x2a000
    s_add_u32 s47, s47, s39
    s_mul_i32 s48, s48, 0x2a000
    s_add_u32 s48, s48, s39
    v_mov_b32 v96, 0x3f803f80
    v_accvgpr_write_b32 a216, v96
    v_accvgpr_write_b32 a217, v96
    v_accvgpr_write_b32 a218, v96
    v_accvgpr_write_b32 a219, v96
    v_mov_b32 v236, 1.0
    s_cmp_eq_u32 s35, 0
    s_cselect_b32 s29, 3, 0
    s_cselect_b32 s30, -3, -2
    s_cmp_eq_u32 s35, 7
    s_cselect_b32 s33, 2, 64
    s_mul_i32 s32, s36, 0xf00
    s_add_u32 s32, s32, 0xf200
    v_lshrrev_b32 v60, 1, v185
    v_lshl_add_u32 v61, v187, 1, v60
    v_lshlrev_b32 v232, 2, v61
    v_lshl_add_u32 v61, v187, 2, v185
    v_lshlrev_b32 v233, 2, v61
    v_sub_u32 v60, v60, v187
    v_mul_i32_i24 v60, 0x140, v60
    s_sub_u32 s31, s32, 0x140
    v_add_u32 v60, s31, v60
    v_lshl_add_u32 v61, v103, 2, 3
    v_cmp_gt_u32 vcc, s29, v186
    v_sub_u32 v62, v61, v186
    s_mov_b64 exec, 0
    s_cmp_eq_u32 s36, 0
    s_cbranch_scc1 L_pg1
    s_cmp_eq_u32 s36, 1
    s_cbranch_scc1 L_pg2
    s_cmp_eq_u32 s36, 2
    s_cbranch_scc1 L_pg3
    s_branch L_pg4
    .p2align 12
L_back:
    s_mov_b64 exec, -1
    s_add_u32 m0, s50, 0x3000
    v_min_u32 v63, 10, v62
    buffer_load_dwordx4 v251, s[8:11], s57 offen lds
    s_add_u32 m0, s50, 0x3400
    v_mad_u32_u24 v64, v186, 3, v103
    v_add_u32 v65, 11, v64
    v_cndmask_b32 v63, v63, v65, vcc
    v_lshl_add_u32 v228, v63, 4, v60
    v_add_u32 v62, 8, v62
    v_min_u32 v63, 10, v62
    v_lshl_add_u32 v62, v103, 4, v186
    v_cmp_gt_u32 vcc, s29, v62
    v_add_u32 v65, 13, v64
    v_min_u32 v62, 5, v186
    v_cndmask_b32 v63, v63, v65, vcc
    v_lshl_add_u32 v229, v63, 4, v60
    v_cmp_lt_u32 vcc, s33, v62
    v_sub_u32 v63, v61, v62
    v_min_u32 v63, 10, v63
    v_mad_u32_u24 v64, v62, 3, 2
    v_add_u32 v65, v64, v103
    buffer_load_dwordx4 v252, s[8:11], s57 offen lds
    s_add_u32 m0, s50, 0x3800
    v_cndmask_b32 v63, v63, v65, vcc
    buffer_load_dwordx4 v253, s[8:11], s57 offen lds
    s_add_u32 s57, s49, 0x12180
    s_add_u32 m0, s50, 0x6000
    v_lshl_add_u32 v230, v63, 4, v60
    v_sub_u32 v63, 11, v62
    v_min_u32 v63, 10, v63
    v_add_u32 v65, 2, v64
    v_cndmask_b32 v63, v63, v65, vcc
    v_lshl_add_u32 v231, v63, 4, s32
    s_mov_b32 s60, 0x2222
    s_mov_b32 s61, 0x4444
    buffer_load_dwordx4 v251, s[8:11], s57 offen lds
    s_add_u32 m0, s50, 0x6400
    s_mov_b32 s62, 0x8808
    s_mov_b32 s63, 0x32104321
    s_mov_b32 s64, 0x76540765
    s_mov_b32 s65, 0x2222
    s_mov_b32 s66, 0x10002100
    s_mov_b32 s67, 0x54326543
    s_mov_b32 s68, 0x760007
    s_mov_b32 s69, 0x32104321
    s_mov_b32 s70, 0x76540765
    s_mov_b32 s71, 0x10002100
    s_mov_b32 s72, 0x760007
    s_mov_b32 s73, 0x2222
    s_mov_b32 s74, 0x8808
    buffer_load_dwordx4 v252, s[8:11], s57 offen lds
    s_add_u32 m0, s50, 0x6800
    s_mov_b32 s75, 0x760007
    s_mov_b32 s76, 0x10002100
    s_mov_b32 s77, 0x6666
    s_mov_b32 s78, 0x8808
    s_mov_b32 s79, 0x32104321
    s_mov_b32 s80, 0x76540765
    s_cmp_eq_u32 s34, 0
    s_cmov_b32 s60, 0xbbbb
    s_cmov_b32 s61, 0x4241
    v_bfe_u32 v234, s60, v232, 4
    v_mad_u32_u24 v235, v234, s40, v228
    v_mad_u32_u24 v234, v234, s40, v229
    s_cmp_eq_u32 s34, 0
    s_cmov_b32 s62, 0x8898
    s_cmov_b32 s63, 0x30a940ba
    buffer_load_dwordx4 v253, s[8:11], s57 offen lds
    s_add_u32 s57, s49, 0x1b180
    s_add_u32 m0, s50, 0x9000
    s_waitcnt vmcnt(14)
    ds_read_b64_tr_b16 a[0:1], v254
    ds_read_b64_tr_b16 a[2:3], v255
    ds_read_b64_tr_b16 a[4:5], v254 offset:32
    ds_read_b64_tr_b16 a[6:7], v255 offset:32
    ds_read_b64_tr_b16 a[8:9], v254 offset:64
    s_cmp_eq_u32 s34, 0
    s_cmov_b32 s64, 0x76549765
    s_cmov_b32 s65, 0x2221
    ds_read_b64_tr_b16 a[10:11], v255 offset:64
    s_cmp_eq_u32 s34, 0
    s_cmov_b32 s66, 0x10002000
    s_cmov_b32 s68, 0x760097
    buffer_load_dwordx4 v251, s[8:11], s57 offen lds
    s_add_u32 m0, s50, 0x9400
    s_cmp_eq_u32 s34, 7
    s_cmov_b32 s73, 0x2d22
    s_cmov_b32 s74, 0x1808
    s_cmp_eq_u32 s34, 7
    s_cmov_b32 s75, 0x60007
    s_cmov_b32 s76, 0x1b002100
    s_cmp_eq_u32 s34, 7
    s_cmov_b32 s77, 0x1606
    s_cmov_b32 s78, 0xbbbb
    s_cmp_eq_u32 s34, 7
    s_cmov_b32 s79, 0x321b4321
    s_cmov_b32 s80, 0xa904ba05
    buffer_load_dwordx4 v252, s[8:11], s57 offen lds
    s_add_u32 m0, s50, 0x9800
    s_lshl_b32 s31, s36, 10
    s_add_u32 s31, s31, 0x12e40
    v_and_b32 v118, 31, v184
    v_min_u32 v118, 19, v118
    v_lshrrev_b32 v119, 5, v184
    v_add_u32 v120, -11, v118
    v_max_i32 v120, 0, v120
    v_mul_u32_u24 v121, 11, v120
    v_lshrrev_b32 v121, 5, v121
    v_mul_u32_u24 v122, 3, v121
    v_sub_u32 v120, v120, v122
    v_lshlrev_b32 v120, 2, v120
    buffer_load_dwordx4 v253, s[8:11], s57 offen lds
    s_add_u32 s57, s49, 0x24180
    s_add_u32 m0, s50, 0xc000
    v_sub_u32 v121, v120, v121
    v_cmp_lt_u32 vcc, 10, v118
    v_add_u32 v121, s29, v121
    v_add_u32 v120, s30, v120
    v_add_u32 v122, -3, v118
    v_cndmask_b32 v121, v118, v121, vcc
    v_cndmask_b32 v120, v122, v120, vcc
    s_mov_b32 vcc_lo, s59
    s_mov_b32 vcc_hi, s59
    v_mad_u32_u24 v121, v119, 13, v121
    buffer_load_dword v188, v189, s[12:15], s52 offen
    v_lshl_add_u32 v121, v121, 2, s31
    s_cmp_eq_u32 s34, 0
    s_cselect_b32 s28, 0x208, 0
    v_add_u32 v122, s28, v121
    v_cmp_gt_u32 s[24:25], 7, v120
    v_add_u32 v120, 1, v120
    v_cmp_gt_u32 s[26:27], 7, v120
    v_add_u32 v120, 1, v120
    v_cmp_gt_u32 s[52:53], 7, v120
    v_add_u32 v120, 1, v120
    v_lshl_add_u32 v118, v118, 4, s32
    v_mad_u32_u24 v123, v119, s40, v118
    buffer_load_ushort v196, v199, s[16:19], s55 offen
    v_lshlrev_b32 v119, 3, v119
    v_mad_u32_u24 v124, v119, s40, v118
    v_lshl_add_u32 v125, v184, 2, s31
    s_mov_b32 s28, 0x3fb8aa3b
    v_mov_b32 v168, 0xf149f2ca
    v_mov_b32 v169, 0xf149f2ca
    v_mov_b32 v170, 0xf149f2ca
    v_mov_b32 v171, 0xf149f2ca
    buffer_load_ushort v197, v199, s[16:19], s55 offen offset:128
    buffer_load_ushort v198, v199, s[16:19], s55 offen offset:256
    v_cmp_gt_u32 s[54:55], 7, v120
    buffer_load_dwordx4 v251, s[8:11], s57 offen lds
    s_add_u32 m0, s50, 0xc400
    s_nop 0
    s_waitcnt vmcnt(14)
    s_barrier
    ds_read_b128 a[236:239], v224
    ds_read_b128 a[240:243], v224 offset:3072
    ds_read_b128 a[244:247], v224 offset:15488
    ds_read_b128 a[248:251], v224 offset:18560
    buffer_load_dwordx4 v252, s[8:11], s57 offen lds
    s_add_u32 m0, s50, 0xc800
    ds_read_b128 a[252:255], v227 offset:6144
    ds_read_b128 a[220:223], v224 offset:64
    ds_read_b128 a[224:227], v224 offset:3136
    ds_read_b128 a[228:231], v224 offset:15552
    buffer_load_dwordx4 v253, s[8:11], s57 offen lds
    s_add_u32 s57, s49, 0x2d180
    s_add_u32 m0, s50, 0xf000
    ds_read_b128 a[232:235], v224 offset:18624
    s_waitcnt lgkmcnt(8)
    v_mfma_f32_16x16x32_bf16 v[12:15], a[0:3], a[236:239], 0
    v_mfma_f32_16x16x32_bf16 v[16:19], a[4:7], a[236:239], 0
    v_mfma_f32_16x16x32_bf16 v[20:23], a[8:11], a[236:239], 0
    s_waitcnt lgkmcnt(7)
    ds_read_b128 a[236:239], v227 offset:6208
    v_mfma_f32_16x16x32_bf16 v[36:39], a[0:3], a[240:243], 0
    s_waitcnt vmcnt(13)
    buffer_load_dwordx4 v251, s[8:11], s57 offen lds
    v_mfma_f32_16x16x32_bf16 v[40:43], a[4:7], a[240:243], 0
    s_add_u32 m0, s50, 0xf400
    ds_read_b64_tr_b16 a[12:13], v254 offset:12288
    ds_read_b64_tr_b16 a[14:15], v255 offset:12288
    v_mfma_f32_16x16x32_bf16 v[44:47], a[8:11], a[240:243], 0
    s_waitcnt lgkmcnt(7)
    ds_read_b64_tr_b16 a[16:17], v254 offset:12320
    ds_read_b64_tr_b16 a[18:19], v255 offset:12320
    v_mfma_f32_16x16x32_bf16 v[132:135], a[0:3], a[244:247], 0
    ds_read_b64_tr_b16 a[20:21], v254 offset:12352
    ds_read_b64_tr_b16 a[22:23], v255 offset:12352
    v_mfma_f32_16x16x32_bf16 v[136:139], a[4:7], a[244:247], 0
    buffer_load_dwordx4 v252, s[8:11], s57 offen lds
    v_mfma_f32_16x16x32_bf16 v[140:143], a[8:11], a[244:247], 0
    s_add_u32 m0, s50, 0xf800
    ds_read_b128 a[240:243], v224 offset:128
    ds_read_b128 a[244:247], v224 offset:3200
    v_mfma_f32_16x16x32_bf16 v[220:223], a[0:3], a[248:251], 0
    v_mfma_f32_16x16x32_bf16 v[216:219], a[4:7], a[248:251], 0
    v_mfma_f32_16x16x32_bf16 v[212:215], a[8:11], a[248:251], 0
    buffer_load_dwordx4 v253, s[8:11], s57 offen lds
    v_mfma_f32_16x16x32_bf16 v[208:211], a[0:3], a[252:255], 0
    s_add_u32 m0, s41, 0x7900
    ds_read_b128 a[248:251], v224 offset:15616
    s_add_u32 s57, s49, 0x300
    v_mfma_f32_16x16x32_bf16 v[204:207], a[4:7], a[252:255], 0
    v_mfma_f32_16x16x32_bf16 v[200:203], a[8:11], a[252:255], 0
    s_waitcnt lgkmcnt(6)
    ds_read_b128 a[252:255], v224 offset:18688
    v_mfma_f32_16x16x32_bf16 v[12:15], a[12:15], a[220:223], v[12:15]
    s_waitcnt vmcnt(13) lgkmcnt(4)
    buffer_load_dwordx4 v246, s[4:7], s56 offen lds
    v_mfma_f32_16x16x32_bf16 v[16:19], a[16:19], a[220:223], v[16:19]
    s_add_u32 m0, s42, 0x7900
    ds_read_b64_tr_b16 a[24:25], v254 offset:24576
    ds_read_b64_tr_b16 a[26:27], v255 offset:24576
    v_mfma_f32_16x16x32_bf16 v[20:23], a[20:23], a[220:223], v[20:23]
    ds_read_b64_tr_b16 a[28:29], v254 offset:24608
    ds_read_b64_tr_b16 a[30:31], v255 offset:24608
    v_mfma_f32_16x16x32_bf16 v[36:39], a[12:15], a[224:227], v[36:39]
    ds_read_b64_tr_b16 a[32:33], v254 offset:24640
    ds_read_b64_tr_b16 a[34:35], v255 offset:24640
    v_mfma_f32_16x16x32_bf16 v[40:43], a[16:19], a[224:227], v[40:43]
    buffer_load_dwordx4 v247, s[4:7], s56 offen lds
    v_mfma_f32_16x16x32_bf16 v[44:47], a[20:23], a[224:227], v[44:47]
    s_add_u32 s56, s39, 0xd2000
    ds_read_b128 a[220:223], v227 offset:6272
    ds_read_b128 a[224:227], v224 offset:192
    v_mfma_f32_16x16x32_bf16 v[132:135], a[12:15], a[228:231], v[132:135]
    s_add_u32 m0, s41, 0x9740
    v_mfma_f32_16x16x32_bf16 v[136:139], a[16:19], a[228:231], v[136:139]
    v_mfma_f32_16x16x32_bf16 v[140:143], a[20:23], a[228:231], v[140:143]
    buffer_load_dwordx4 v246, s[4:7], s56 offen lds
    v_mfma_f32_16x16x32_bf16 v[220:223], a[12:15], a[232:235], v[220:223]
    s_add_u32 m0, s42, 0x9740
    ds_read_b128 a[228:231], v224 offset:3264
    v_mfma_f32_16x16x32_bf16 v[216:219], a[16:19], a[232:235], v[216:219]
    v_mfma_f32_16x16x32_bf16 v[212:215], a[20:23], a[232:235], v[212:215]
    ds_read_b128 a[232:235], v224 offset:15680
    v_mfma_f32_16x16x32_bf16 v[208:211], a[12:15], a[236:239], v[208:211]
    s_waitcnt vmcnt(13)
    buffer_load_dwordx4 v247, s[4:7], s56 offen lds
    v_mfma_f32_16x16x32_bf16 v[204:207], a[16:19], a[236:239], v[204:207]
    s_add_u32 s56, s39, 0xfc000
    ds_read_b64_tr_b16 a[36:37], v254 offset:36864
    ds_read_b64_tr_b16 a[38:39], v255 offset:36864
    v_mfma_f32_16x16x32_bf16 v[200:203], a[20:23], a[236:239], v[200:203]
    s_add_u32 m0, s41, 0xb580
    ds_read_b64_tr_b16 a[40:41], v254 offset:36896
    ds_read_b64_tr_b16 a[42:43], v255 offset:36896
    s_waitcnt lgkmcnt(7)
    v_mfma_f32_16x16x32_bf16 v[12:15], a[24:27], a[240:243], v[12:15]
    ds_read_b64_tr_b16 a[44:45], v254 offset:36928
    ds_read_b64_tr_b16 a[46:47], v255 offset:36928
    v_mfma_f32_16x16x32_bf16 v[16:19], a[28:31], a[240:243], v[16:19]
    buffer_load_dwordx4 v246, s[4:7], s56 offen lds
    v_mfma_f32_16x16x32_bf16 v[20:23], a[32:35], a[240:243], v[20:23]
    s_add_u32 m0, s42, 0xb580
    ds_read_b128 a[236:239], v224 offset:18752
    ds_read_b128 a[240:243], v227 offset:6336
    v_mfma_f32_16x16x32_bf16 v[36:39], a[24:27], a[244:247], v[36:39]
    s_waitcnt vmcnt(13)
    v_lshlrev_b32 v196, 16, v196
    v_mul_f32 v196, s28, v196
    v_mfma_f32_16x16x32_bf16 v[40:43], a[28:31], a[244:247], v[40:43]
    ds_write_b32 v125, v196
    v_mfma_f32_16x16x32_bf16 v[44:47], a[32:35], a[244:247], v[44:47]
    s_waitcnt vmcnt(12)
    ds_read_b128 a[244:247], v224 offset:256
    v_lshlrev_b32 v197, 16, v197
    v_mfma_f32_16x16x32_bf16 v[132:135], a[24:27], a[248:251], v[132:135]
    s_waitcnt vmcnt(11)
    buffer_load_dwordx4 v247, s[4:7], s56 offen lds
    v_mfma_f32_16x16x32_bf16 v[136:139], a[28:31], a[248:251], v[136:139]
    s_add_u32 s56, s39, 0x126000
    v_mul_f32 v197, s28, v197
    v_lshlrev_b32 v198, 16, v198
    v_mfma_f32_16x16x32_bf16 v[140:143], a[32:35], a[248:251], v[140:143]
    s_add_u32 m0, s41, 0xd3c0
    ds_read_b128 a[248:251], v224 offset:3328
    v_mul_f32 v198, s28, v198
    v_mfma_f32_16x16x32_bf16 v[220:223], a[24:27], a[252:255], v[220:223]
    ds_write_b32 v125, v197 offset:256
    v_mfma_f32_16x16x32_bf16 v[216:219], a[28:31], a[252:255], v[216:219]
    ds_write_b32 v125, v198 offset:512
    v_mfma_f32_16x16x32_bf16 v[212:215], a[32:35], a[252:255], v[212:215]
    ds_read_b128 a[252:255], v224 offset:15744
    ds_read2_b32 v[144:145], v121 offset0:39 offset1:40
    v_mfma_f32_16x16x32_bf16 v[208:211], a[24:27], a[220:223], v[208:211]
    buffer_load_dwordx4 v246, s[4:7], s56 offen lds
    v_mfma_f32_16x16x32_bf16 v[204:207], a[28:31], a[220:223], v[204:207]
    s_add_u32 m0, s42, 0xd3c0
    ds_read2_b32 v[146:147], v121 offset0:41 offset1:42
    ds_read2_b32 v[148:149], v121 offset0:65 offset1:66
    v_mfma_f32_16x16x32_bf16 v[200:203], a[32:35], a[220:223], v[200:203]
    s_waitcnt lgkmcnt(8)
    ds_read_b128 a[220:223], v224 offset:18816
    ds_read2_b32 v[150:151], v121 offset0:67 offset1:68
    v_mfma_f32_16x16x32_bf16 v[12:15], a[36:39], a[224:227], v[12:15]
    ds_read2_b32 v[152:153], v121 offset0:91 offset1:92
    ds_read2_b32 v[154:155], v121 offset0:93 offset1:94
    v_mfma_f32_16x16x32_bf16 v[16:19], a[40:43], a[224:227], v[16:19]
    ds_read2_b32 v[156:157], v121 offset0:117 offset1:118
    ds_read2_b32 v[158:159], v121 offset0:119 offset1:120
    v_mfma_f32_16x16x32_bf16 v[20:23], a[44:47], a[224:227], v[20:23]
    buffer_load_dwordx4 v247, s[4:7], s56 offen lds
    v_mfma_f32_16x16x32_bf16 v[36:39], a[36:39], a[228:231], v[36:39]
    s_add_u32 m0, s50, 0
    ds_read_b128 a[224:227], v227 offset:6400
    ds_read2_b32 v[160:161], v122 offset0:0 offset1:1
    v_mfma_f32_16x16x32_bf16 v[40:43], a[40:43], a[228:231], v[40:43]
    s_add_u32 s56, s39, 0x150000
    ds_read2_b32 v[162:163], v122 offset0:2 offset1:3
    s_waitcnt vmcnt(11)
    ds_read_b64_tr_b16 a[48:49], v254 offset:49152
    v_mfma_f32_16x16x32_bf16 v[44:47], a[44:47], a[228:231], v[44:47]
    ds_read_b64_tr_b16 a[50:51], v255 offset:49152
    ds_read_b64_tr_b16 a[52:53], v254 offset:49184
    v_mfma_f32_16x16x32_bf16 v[132:135], a[36:39], a[232:235], v[132:135]
    ds_read_b64_tr_b16 a[54:55], v255 offset:49184
    ds_read_b64_tr_b16 a[56:57], v254 offset:49216
    v_mfma_f32_16x16x32_bf16 v[136:139], a[40:43], a[232:235], v[136:139]
    ds_read_b64_tr_b16 a[58:59], v255 offset:49216
    ds_read_b128 a[228:231], v224 offset:320
    v_mfma_f32_16x16x32_bf16 v[140:143], a[44:47], a[232:235], v[140:143]
    buffer_load_dwordx4 v251, s[8:11], s57 offen lds
    v_mfma_f32_16x16x32_bf16 v[220:223], a[36:39], a[236:239], v[220:223]
    s_add_u32 m0, s50, 0x400
    ds_read_b128 a[232:235], v224 offset:3392
    ds_read2_b32 v[164:165], v122 offset0:13 offset1:14
    v_mfma_f32_16x16x32_bf16 v[216:219], a[40:43], a[236:239], v[216:219]
    s_waitcnt lgkmcnt(14)
    ds_read2_b32 v[166:167], v122 offset0:15 offset1:16
    v_cndmask_b32 v144, v168, v144, s[24:25]
    v_mfma_f32_16x16x32_bf16 v[212:215], a[44:47], a[236:239], v[212:215]
    ds_read_b128 a[236:239], v224 offset:15808
    v_cndmask_b32 v145, v168, v145, s[26:27]
    v_mfma_f32_16x16x32_bf16 v[208:211], a[36:39], a[240:243], v[208:211]
    v_cndmask_b32 v146, v168, v146, s[52:53]
    v_cndmask_b32 v147, v168, v147, s[54:55]
    v_mfma_f32_16x16x32_bf16 v[204:207], a[40:43], a[240:243], v[204:207]
    s_waitcnt lgkmcnt(9)
    buffer_load_dwordx4 v252, s[8:11], s57 offen lds
    v_mfma_f32_16x16x32_bf16 v[200:203], a[44:47], a[240:243], v[200:203]
    s_add_u32 m0, s50, 0x800
    ds_read_b128 a[240:243], v224 offset:18880
    v_cndmask_b32 v148, v168, v148, s[24:25]
    v_mfma_f32_16x16x32_bf16 v[12:15], a[48:51], a[244:247], v[12:15]
    s_waitcnt lgkmcnt(8)
    ds_write_b128 v123, v[144:147] offset:320
    v_mfma_f32_16x16x32_bf16 v[16:19], a[52:55], a[244:247], v[16:19]
    s_waitcnt lgkmcnt(7)
    v_cndmask_b32 v149, v168, v149, s[26:27]
    v_cndmask_b32 v150, v168, v150, s[52:53]
    v_mfma_f32_16x16x32_bf16 v[20:23], a[56:59], a[244:247], v[20:23]
    v_cndmask_b32 v151, v168, v151, s[54:55]
    v_cndmask_b32 v152, v168, v152, s[24:25]
    v_mfma_f32_16x16x32_bf16 v[36:39], a[48:51], a[248:251], v[36:39]
    s_waitcnt vmcnt(10)
    buffer_load_dwordx4 v253, s[8:11], s57 offen lds
    v_mfma_f32_16x16x32_bf16 v[40:43], a[52:55], a[248:251], v[40:43]
    s_add_u32 s57, s49, 0x9300
    ds_read_b64_tr_b16 a[60:61], v254 offset:61440
    ds_read_b64_tr_b16 a[62:63], v255 offset:61440
    v_mfma_f32_16x16x32_bf16 v[44:47], a[56:59], a[248:251], v[44:47]
    s_add_u32 m0, s50, 0x3000
    ds_read_b64_tr_b16 a[64:65], v254 offset:61472
    ds_read_b64_tr_b16 a[66:67], v255 offset:61472
    v_mfma_f32_16x16x32_bf16 v[132:135], a[48:51], a[252:255], v[132:135]
    ds_read_b64_tr_b16 a[68:69], v254 offset:61504
    ds_read_b64_tr_b16 a[70:71], v255 offset:61504
    v_mfma_f32_16x16x32_bf16 v[136:139], a[52:55], a[252:255], v[136:139]
    ds_read_b128 a[244:247], v227 offset:6464
    v_cndmask_b32 v153, v168, v153, s[26:27]
    v_mfma_f32_16x16x32_bf16 v[140:143], a[56:59], a[252:255], v[140:143]
    buffer_load_dwordx4 v251, s[8:11], s57 offen lds
    v_mfma_f32_16x16x32_bf16 v[220:223], a[48:51], a[220:223], v[220:223]
    s_add_u32 m0, s50, 0x3400
    ds_write_b128 v123, v[148:151] offset:960
    v_mfma_f32_16x16x32_bf16 v[216:219], a[52:55], a[220:223], v[216:219]
    v_cndmask_b32 v154, v168, v154, s[52:53]
    v_cndmask_b32 v155, v168, v155, s[54:55]
    v_mfma_f32_16x16x32_bf16 v[212:215], a[56:59], a[220:223], v[212:215]
    ds_write_b128 v123, v[152:155] offset:1600
    v_mfma_f32_16x16x32_bf16 v[208:211], a[48:51], a[224:227], v[208:211]
    buffer_load_dwordx4 v252, s[8:11], s57 offen lds
    v_mfma_f32_16x16x32_bf16 v[204:207], a[52:55], a[224:227], v[204:207]
    s_add_u32 m0, s50, 0x3800
    v_cndmask_b32 v156, v168, v156, s[24:25]
    v_cndmask_b32 v157, v168, v157, s[26:27]
    v_mfma_f32_16x16x32_bf16 v[200:203], a[56:59], a[224:227], v[200:203]
    s_waitcnt lgkmcnt(3)
    v_cndmask_b32 v158, v168, v158, s[52:53]
    v_cndmask_b32 v159, v168, v159, s[54:55]
    v_mfma_f32_16x16x32_bf16 v[12:15], a[60:63], a[228:231], v[12:15]
    s_waitcnt vmcnt(9)
    ds_write_b128 v123, v[156:159] offset:2240
    v_mfma_f32_16x16x32_bf16 v[16:19], a[64:67], a[228:231], v[16:19]
    s_barrier
    v_cndmask_b32 v160, v168, v160, s[24:25]
    v_cndmask_b32 v161, v168, v161, s[26:27]
    v_mfma_f32_16x16x32_bf16 v[20:23], a[68:71], a[228:231], v[20:23]
    buffer_load_dwordx4 v253, s[8:11], s57 offen lds
    v_mfma_f32_16x16x32_bf16 v[36:39], a[60:63], a[232:235], v[36:39]
    s_add_u32 s57, s49, 0x12300
    v_cvt_pk_bf16_f32 v0, v12, v13
    v_cvt_pk_bf16_f32 v1, v14, v15
    v_mfma_f32_16x16x32_bf16 v[40:43], a[64:67], a[232:235], v[40:43]
    s_add_u32 m0, s50, 0x6000
    ds_read_b128 a[248:251], v224 offset:30976
    ds_read_b128 a[252:255], v224 offset:31040
    v_mfma_f32_16x16x32_bf16 v[44:47], a[68:71], a[232:235], v[44:47]
    ds_read_b128 a[220:223], v224 offset:31104
    v_cvt_pk_bf16_f32 v2, v16, v17
    v_mfma_f32_16x16x32_bf16 v[132:135], a[60:63], a[236:239], v[132:135]
    ds_read_b128 a[224:227], v224 offset:31168
    v_cvt_pk_bf16_f32 v3, v18, v19
    v_mfma_f32_16x16x32_bf16 v[136:139], a[64:67], a[236:239], v[136:139]
    ds_read_b128 a[228:231], v224 offset:31232
    v_cvt_pk_bf16_f32 v4, v20, v21
    v_mfma_f32_16x16x32_bf16 v[140:143], a[68:71], a[236:239], v[140:143]
    ds_read_b128 a[232:235], v224 offset:31296
    v_cvt_pk_bf16_f32 v5, v22, v23
    v_mfma_f32_16x16x32_bf16 v[220:223], a[60:63], a[240:243], v[220:223]
    ds_read_b128 a[236:239], v224 offset:34048
    v_cvt_pk_bf16_f32 v24, v36, v37
    v_mfma_f32_16x16x32_bf16 v[216:219], a[64:67], a[240:243], v[216:219]
    s_waitcnt lgkmcnt(8)
    buffer_load_dwordx4 v251, s[8:11], s57 offen lds
    v_mfma_f32_16x16x32_bf16 v[212:215], a[68:71], a[240:243], v[212:215]
    s_add_u32 m0, s50, 0x6400
    ds_read_b128 a[240:243], v224 offset:34112
    v_cvt_pk_bf16_f32 v25, v38, v39
    v_mfma_f32_16x16x32_bf16 v[208:211], a[60:63], a[244:247], v[208:211]
    v_cvt_pk_bf16_f32 v26, v40, v41
    v_cvt_pk_bf16_f32 v27, v42, v43
    v_mfma_f32_16x16x32_bf16 v[204:207], a[64:67], a[244:247], v[204:207]
    s_waitcnt lgkmcnt(7)
    buffer_load_dwordx4 v252, s[8:11], s57 offen lds
    v_mfma_f32_16x16x32_bf16 v[200:203], a[68:71], a[244:247], v[200:203]
    s_add_u32 m0, s50, 0x6800
    ds_read_b128 a[244:247], v224 offset:34176
    v_cvt_pk_bf16_f32 v28, v44, v45
    v_mfma_f32_16x16x32_bf16 v[180:183], a[0:3], a[248:251], 0
    v_cvt_pk_bf16_f32 v29, v46, v47
    v_cvt_pk_bf16_f32 v6, v132, v133
    v_mfma_f32_16x16x32_bf16 v[176:179], a[4:7], a[248:251], 0
    v_cvt_pk_bf16_f32 v7, v134, v135
    v_cvt_pk_bf16_f32 v8, v136, v137
    v_mfma_f32_16x16x32_bf16 v[172:175], a[8:11], a[248:251], 0
    s_waitcnt lgkmcnt(5)
    ds_read_b128 a[248:251], v224 offset:34240
    v_cvt_pk_bf16_f32 v9, v138, v139
    v_mfma_f32_16x16x32_bf16 v[180:183], a[12:15], a[252:255], v[180:183]
    v_cvt_pk_bf16_f32 v10, v140, v141
    v_cvt_pk_bf16_f32 v11, v142, v143
    v_mfma_f32_16x16x32_bf16 v[176:179], a[16:19], a[252:255], v[176:179]
    buffer_load_dwordx4 v253, s[8:11], s57 offen lds
    v_mfma_f32_16x16x32_bf16 v[172:175], a[20:23], a[252:255], v[172:175]
    s_add_u32 s57, s49, 0x1b300
    ds_read_b128 a[252:255], v224 offset:34304
    v_cvt_pk_bf16_f32 v30, v220, v221
    v_mfma_f32_16x16x32_bf16 v[180:183], a[24:27], a[220:223], v[180:183]
    s_add_u32 m0, s50, 0x9000
    v_cvt_pk_bf16_f32 v31, v222, v223
    v_cvt_pk_bf16_f32 v32, v216, v217
    v_mfma_f32_16x16x32_bf16 v[176:179], a[28:31], a[220:223], v[176:179]
    s_waitcnt vmcnt(9)
    s_barrier
    v_cvt_pk_bf16_f32 v33, v218, v219
    v_cvt_pk_bf16_f32 v34, v212, v213
    v_mfma_f32_16x16x32_bf16 v[172:175], a[32:35], a[220:223], v[172:175]
    ds_read_b128 a[220:223], v224 offset:34368
    v_cvt_pk_bf16_f32 v35, v214, v215
    v_mfma_f32_16x16x32_bf16 v[180:183], a[36:39], a[224:227], v[180:183]
    buffer_load_dwordx4 v251, s[8:11], s57 offen lds
    v_mfma_f32_16x16x32_bf16 v[176:179], a[40:43], a[224:227], v[176:179]
    s_add_u32 m0, s50, 0x9400
    v_cvt_pk_bf16_f32 v48, v208, v209
    v_cvt_pk_bf16_f32 v49, v210, v211
    v_mfma_f32_16x16x32_bf16 v[172:175], a[44:47], a[224:227], v[172:175]
    s_waitcnt lgkmcnt(3)
    ds_read_b128 a[224:227], v224 offset:46464
    v_cvt_pk_bf16_f32 v50, v204, v205
    v_mfma_f32_16x16x32_bf16 v[180:183], a[48:51], a[228:231], v[180:183]
    v_cvt_pk_bf16_f32 v51, v206, v207
    v_cvt_pk_bf16_f32 v52, v200, v201
    v_mfma_f32_16x16x32_bf16 v[176:179], a[52:55], a[228:231], v[176:179]
    v_cvt_pk_bf16_f32 v53, v202, v203
    v_cndmask_b32 v162, v168, v162, s[52:53]
    v_mfma_f32_16x16x32_bf16 v[172:175], a[56:59], a[228:231], v[172:175]
    ds_read_b128 a[228:231], v224 offset:46528
    v_cndmask_b32 v163, v168, v163, s[54:55]
    v_mfma_f32_16x16x32_bf16 v[180:183], a[60:63], a[232:235], v[180:183]
    buffer_load_dwordx4 v252, s[8:11], s57 offen lds
    v_mfma_f32_16x16x32_bf16 v[176:179], a[64:67], a[232:235], v[176:179]
    s_add_u32 m0, s50, 0x9800
    ds_write_b128 v123, v[160:163] offset:2880
    v_mfma_f32_16x16x32_bf16 v[172:175], a[68:71], a[232:235], v[172:175]
    v_cndmask_b32 v164, v168, v164, s[24:25]
    v_cndmask_b32 v165, v168, v165, s[26:27]
    v_mfma_f32_16x16x32_bf16 v[220:223], a[0:3], a[236:239], 0
    s_lshl_b32 s25, s36, 2
    v_cvt_pk_bf16_f32 v12, v180, v181
    v_cvt_pk_bf16_f32 v13, v182, v183
    v_mfma_f32_16x16x32_bf16 v[216:219], a[4:7], a[236:239], 0
    s_add_u32 s25, s25, 0x27e00
    v_cvt_pk_bf16_f32 v14, v176, v177
    v_cvt_pk_bf16_f32 v15, v178, v179
    v_mfma_f32_16x16x32_bf16 v[212:215], a[8:11], a[236:239], 0
    v_cvt_pk_bf16_f32 v16, v172, v173
    v_cvt_pk_bf16_f32 v17, v174, v175
    v_mfma_f32_16x16x32_bf16 v[220:223], a[12:15], a[240:243], v[220:223]
    ds_read_b128 a[232:235], v224 offset:46592
    ds_read_b128 a[236:239], v224 offset:46656
    v_mfma_f32_16x16x32_bf16 v[216:219], a[16:19], a[240:243], v[216:219]
    s_waitcnt vmcnt(8)
    buffer_load_dwordx4 v253, s[8:11], s57 offen lds
    v_mfma_f32_16x16x32_bf16 v[212:215], a[20:23], a[240:243], v[212:215]
    s_add_u32 s57, s49, 0x24300
    ds_read_b128 a[240:243], v224 offset:46720
    ds_read_b64_tr_b16 a[72:73], v254
    v_mfma_f32_16x16x32_bf16 v[220:223], a[24:27], a[244:247], v[220:223]
    s_add_u32 m0, s50, 0xc000
    ds_read_b64_tr_b16 a[74:75], v255
    ds_read_b64_tr_b16 a[76:77], v254 offset:32
    v_mfma_f32_16x16x32_bf16 v[216:219], a[28:31], a[244:247], v[216:219]
    s_waitcnt lgkmcnt(7)
    buffer_load_dwordx4 v251, s[8:11], s57 offen lds
    v_mfma_f32_16x16x32_bf16 v[212:215], a[32:35], a[244:247], v[212:215]
    s_add_u32 m0, s50, 0xc400
    ds_read_b128 a[244:247], v224 offset:46784
    ds_read_b64_tr_b16 a[78:79], v255 offset:32
    v_mfma_f32_16x16x32_bf16 v[220:223], a[36:39], a[248:251], v[220:223]
    ds_read_b64_tr_b16 a[80:81], v254 offset:64
    ds_read_b64_tr_b16 a[82:83], v255 offset:64
    v_mfma_f32_16x16x32_bf16 v[216:219], a[40:43], a[248:251], v[216:219]
    v_cndmask_b32 v166, v168, v166, s[52:53]
    v_cndmask_b32 v167, v168, v167, s[54:55]
    v_mfma_f32_16x16x32_bf16 v[212:215], a[44:47], a[248:251], v[212:215]
    s_waitcnt vmcnt(7)
    ds_read_b128 a[248:251], v224 offset:49536
    ds_read_b64_tr_b16 a[84:85], v254 offset:12288
    v_mfma_f32_16x16x32_bf16 v[220:223], a[48:51], a[252:255], v[220:223]
    buffer_load_dwordx4 v252, s[8:11], s57 offen lds
    v_mfma_f32_16x16x32_bf16 v[216:219], a[52:55], a[252:255], v[216:219]
    s_add_u32 m0, s50, 0xc800
    ds_read_b64_tr_b16 a[86:87], v255 offset:12288
    ds_read_b64_tr_b16 a[88:89], v254 offset:12320
    v_mfma_f32_16x16x32_bf16 v[212:215], a[56:59], a[252:255], v[212:215]
    ds_read_b128 a[252:255], v224 offset:49600
    ds_read_b64_tr_b16 a[90:91], v255 offset:12320
    v_mfma_f32_16x16x32_bf16 v[220:223], a[60:63], a[220:223], v[220:223]
    ds_read_b64_tr_b16 a[92:93], v254 offset:12352
    ds_read_b64_tr_b16 a[94:95], v255 offset:12352
    v_mfma_f32_16x16x32_bf16 v[216:219], a[64:67], a[220:223], v[216:219]
    ds_write_b128 v123, v[164:167] offset:3200
    v_mfma_f32_16x16x32_bf16 v[212:215], a[68:71], a[220:223], v[212:215]
    buffer_load_dwordx4 v253, s[8:11], s57 offen lds
    v_mfma_f32_16x16x32_bf16 v[208:211], a[0:3], a[224:227], 0
    s_add_u32 s57, s49, 0x2d300
    v_cvt_pk_bf16_f32 v36, v220, v221
    v_cvt_pk_bf16_f32 v37, v222, v223
    v_mfma_f32_16x16x32_bf16 v[204:207], a[4:7], a[224:227], 0
    s_add_u32 m0, s50, 0xf000
    v_cvt_pk_bf16_f32 v38, v216, v217
    v_cvt_pk_bf16_f32 v39, v218, v219
    v_mfma_f32_16x16x32_bf16 v[200:203], a[8:11], a[224:227], 0
L_pg1:
    s_cbranch_execz L_pg5
    v_cvt_pk_bf16_f32 v40, v212, v213
    v_cvt_pk_bf16_f32 v41, v214, v215
    v_mfma_f32_16x16x32_bf16 v[208:211], a[12:15], a[228:231], v[208:211]
    ds_read_b128 a[220:223], v224 offset:49664
    ds_read_b128 a[224:227], v224 offset:49728
    v_mfma_f32_16x16x32_bf16 v[204:207], a[16:19], a[228:231], v[204:207]
    s_waitcnt vmcnt(6)
    ds_read_b64_tr_b16 a[96:97], v254 offset:24576
    v_mfma_f32_16x16x32_bf16 v[200:203], a[20:23], a[228:231], v[200:203]
    s_waitcnt lgkmcnt(7)
    ds_read_b128 a[228:231], v224 offset:49792
    v_mfma_f32_16x16x32_bf16 v[208:211], a[24:27], a[232:235], v[208:211]
    buffer_load_dwordx4 v251, s[8:11], s57 offen lds
    v_mfma_f32_16x16x32_bf16 v[204:207], a[28:31], a[232:235], v[204:207]
    s_add_u32 m0, s50, 0xf400
    ds_read_b64_tr_b16 a[98:99], v255 offset:24576
    ds_read_b64_tr_b16 a[100:101], v254 offset:24608
    v_mfma_f32_16x16x32_bf16 v[200:203], a[32:35], a[232:235], v[200:203]
    ds_read_b128 a[232:235], v224 offset:49856
    ds_read_b64_tr_b16 a[102:103], v255 offset:24608
    v_mfma_f32_16x16x32_bf16 v[208:211], a[36:39], a[236:239], v[208:211]
    ds_read_b64_tr_b16 a[104:105], v254 offset:24640
    ds_read_b64_tr_b16 a[106:107], v255 offset:24640
    v_mfma_f32_16x16x32_bf16 v[204:207], a[40:43], a[236:239], v[204:207]
    buffer_load_dwordx4 v252, s[8:11], s57 offen lds
    v_mfma_f32_16x16x32_bf16 v[200:203], a[44:47], a[236:239], v[200:203]
    s_add_u32 m0, s50, 0xf800
    ds_read_b128 a[236:239], v227 offset:37120
    v_mfma_f32_16x16x32_bf16 v[208:211], a[48:51], a[240:243], v[208:211]
    ds_write_b128 v124, v[168:171]
    v_mfma_f32_16x16x32_bf16 v[204:207], a[52:55], a[240:243], v[204:207]
    v_mfma_f32_16x16x32_bf16 v[200:203], a[56:59], a[240:243], v[200:203]
    v_mfma_f32_16x16x32_bf16 v[208:211], a[60:63], a[244:247], v[208:211]
    buffer_load_dwordx4 v253, s[8:11], s57 offen lds
    v_mfma_f32_16x16x32_bf16 v[204:207], a[64:67], a[244:247], v[204:207]
    s_add_u32 s57, s49, 0
    ds_read_b128 a[240:243], v227 offset:37184
    ds_read_b128 v[144:147], v235
    v_mfma_f32_16x16x32_bf16 v[200:203], a[68:71], a[244:247], v[200:203]
    s_add_u32 m0, s50, 0
    v_mfma_f32_16x16x32_bf16 v[180:183], a[0:3], a[248:251], 0
    v_cvt_pk_bf16_f32 v18, v208, v209
    v_cvt_pk_bf16_f32 v19, v210, v211
    v_mfma_f32_16x16x32_bf16 v[176:179], a[4:7], a[248:251], 0
    v_cvt_pk_bf16_f32 v20, v204, v205
    v_cvt_pk_bf16_f32 v21, v206, v207
    v_mfma_f32_16x16x32_bf16 v[172:175], a[8:11], a[248:251], 0
    v_cvt_pk_bf16_f32 v22, v200, v201
    v_cvt_pk_bf16_f32 v23, v202, v203
    v_mfma_f32_16x16x32_bf16 v[180:183], a[12:15], a[252:255], v[180:183]
    ds_read_b128 a[244:247], v227 offset:37248
    ds_read_b128 a[248:251], v227 offset:37312
    v_mfma_f32_16x16x32_bf16 v[176:179], a[16:19], a[252:255], v[176:179]
    s_waitcnt vmcnt(6) lgkmcnt(5)
    buffer_load_dwordx4 v251, s[8:11], s57 offen lds
    v_mfma_f32_16x16x32_bf16 v[172:175], a[20:23], a[252:255], v[172:175]
    s_add_u32 m0, s50, 0x400
    ds_read_b128 a[252:255], v227 offset:37376
    ds_read_b64_tr_b16 a[108:109], v254 offset:36864
    v_mfma_f32_16x16x32_bf16 v[180:183], a[24:27], a[220:223], v[180:183]
    ds_read_b64_tr_b16 a[110:111], v255 offset:36864
    ds_read_b64_tr_b16 a[112:113], v254 offset:36896
    v_mfma_f32_16x16x32_bf16 v[176:179], a[28:31], a[220:223], v[176:179]
    ds_read_b64_tr_b16 a[114:115], v255 offset:36896
    ds_read_b64_tr_b16 a[116:117], v254 offset:36928
    v_mfma_f32_16x16x32_bf16 v[172:175], a[32:35], a[220:223], v[172:175]
    ds_read_b128 a[220:223], v227 offset:37440
    v_mfma_f32_16x16x32_bf16 v[180:183], a[36:39], a[224:227], v[180:183]
    buffer_load_dwordx4 v252, s[8:11], s57 offen lds
    v_mfma_f32_16x16x32_bf16 v[176:179], a[40:43], a[224:227], v[176:179]
    s_add_u32 m0, s50, 0x800
    ds_read_b64_tr_b16 a[118:119], v255 offset:36928
    ds_read_b128 v[148:151], v234
    v_mfma_f32_16x16x32_bf16 v[172:175], a[44:47], a[224:227], v[172:175]
    ds_read_b128 a[224:227], v224
    v_bfe_u32 v234, s61, v232, 4
    v_mfma_f32_16x16x32_bf16 v[180:183], a[48:51], a[228:231], v[180:183]
    v_mad_u32_u24 v235, v234, s40, v229
    v_mad_u32_u24 v234, v234, s40, v228
    v_mfma_f32_16x16x32_bf16 v[176:179], a[52:55], a[228:231], v[176:179]
    s_waitcnt vmcnt(5)
    buffer_load_dwordx4 v253, s[8:11], s57 offen lds
    v_mfma_f32_16x16x32_bf16 v[172:175], a[56:59], a[228:231], v[172:175]
    s_add_u32 s57, s49, 0x9000
    ds_read_b128 a[228:231], v224 offset:64
    ds_read_b64_tr_b16 a[120:121], v254 offset:49152
    v_mfma_f32_16x16x32_bf16 v[180:183], a[60:63], a[232:235], v[180:183]
    s_add_u32 m0, s50, 0x3000
    ds_read_b64_tr_b16 a[122:123], v255 offset:49152
    ds_read_b64_tr_b16 a[124:125], v254 offset:49184
    v_mfma_f32_16x16x32_bf16 v[176:179], a[64:67], a[232:235], v[176:179]
    ds_read_b64_tr_b16 a[126:127], v255 offset:49184
    ds_read_b64_tr_b16 a[128:129], v254 offset:49216
    v_mfma_f32_16x16x32_bf16 v[172:175], a[68:71], a[232:235], v[172:175]
    ds_read_b128 a[232:235], v224 offset:128
    v_cvt_pk_bf16_f32 v42, v180, v181
    v_mfma_f32_16x16x32_bf16 v[220:223], a[0:3], a[236:239], 0
    ds_read_b64_tr_b16 a[130:131], v255 offset:49216
    v_cvt_pk_bf16_f32 v43, v182, v183
    v_mfma_f32_16x16x32_bf16 v[216:219], a[4:7], a[236:239], 0
    v_cvt_pk_bf16_f32 v44, v176, v177
    v_cvt_pk_bf16_f32 v45, v178, v179
    v_mfma_f32_16x16x32_bf16 v[212:215], a[8:11], a[236:239], 0
    s_waitcnt lgkmcnt(10)
    v_cvt_pk_bf16_f32 v46, v172, v173
    v_cvt_pk_bf16_f32 v47, v174, v175
    v_mfma_f32_16x16x32_bf16 v[220:223], a[12:15], a[240:243], v[220:223]
    ds_read_b128 a[236:239], v224 offset:192
    ds_read_b128 v[152:155], v235
    v_mfma_f32_16x16x32_bf16 v[216:219], a[16:19], a[240:243], v[216:219]
    buffer_load_dwordx4 v251, s[8:11], s57 offen lds
    v_mfma_f32_16x16x32_bf16 v[212:215], a[20:23], a[240:243], v[212:215]
    s_add_u32 m0, s50, 0x3400
    ds_read_b128 a[240:243], v224 offset:256
    v_mfma_f32_16x16x32_bf16 v[220:223], a[24:27], a[244:247], v[220:223]
    buffer_load_dwordx4 v252, s[8:11], s57 offen lds
    v_mfma_f32_16x16x32_bf16 v[216:219], a[28:31], a[244:247], v[216:219]
    s_add_u32 m0, s50, 0x3800
    ds_read_b128 v[156:159], v234
    v_bfe_u32 v234, s62, v232, 4
    v_mfma_f32_16x16x32_bf16 v[212:215], a[32:35], a[244:247], v[212:215]
    ds_read_b128 a[244:247], v224 offset:320
    v_mad_u32_u24 v235, v234, s40, v229
    v_mfma_f32_16x16x32_bf16 v[220:223], a[36:39], a[248:251], v[220:223]
    v_mad_u32_u24 v234, v234, s40, v228
    v_mfma_f32_16x16x32_bf16 v[216:219], a[40:43], a[248:251], v[216:219]
    v_mfma_f32_16x16x32_bf16 v[212:215], a[44:47], a[248:251], v[212:215]
    s_waitcnt vmcnt(5)
    ds_read_b128 a[248:251], v224 offset:3072
    ds_read_b64_tr_b16 a[132:133], v254 offset:61440
    v_mfma_f32_16x16x32_bf16 v[220:223], a[48:51], a[252:255], v[220:223]
    buffer_load_dwordx4 v253, s[8:11], s57 offen lds
    v_mfma_f32_16x16x32_bf16 v[216:219], a[52:55], a[252:255], v[216:219]
    s_add_u32 s57, s49, 0x12000
    ds_read_b64_tr_b16 a[134:135], v255 offset:61440
    ds_read_b64_tr_b16 a[136:137], v254 offset:61472
    v_mfma_f32_16x16x32_bf16 v[212:215], a[56:59], a[252:255], v[212:215]
    s_add_u32 m0, s50, 0x6000
    ds_read_b128 a[252:255], v224 offset:3136
    ds_read_b64_tr_b16 a[138:139], v255 offset:61472
    v_mfma_f32_16x16x32_bf16 v[220:223], a[60:63], a[220:223], v[220:223]
    ds_read_b64_tr_b16 a[140:141], v254 offset:61504
    ds_read_b64_tr_b16 a[142:143], v255 offset:61504
    v_mfma_f32_16x16x32_bf16 v[216:219], a[64:67], a[220:223], v[216:219]
    v_mfma_f32_16x16x32_bf16 v[212:215], a[68:71], a[220:223], v[212:215]
    s_waitcnt lgkmcnt(9)
    ds_read_b128 a[220:223], v224 offset:3200
    v_mfma_f32_16x16x32_bf16 v[208:211], a[224:227], a[72:75], 0
    buffer_load_dwordx4 v251, s[8:11], s57 offen lds
    v_mfma_f32_16x16x32_bf16 v[204:207], a[224:227], a[76:79], 0
    s_add_u32 m0, s50, 0x6400
    v_cvt_pk_bf16_f32 v54, v220, v221
    v_cvt_pk_bf16_f32 v55, v222, v223
    v_mfma_f32_16x16x32_bf16 v[200:203], a[224:227], a[80:83], 0
    v_cvt_pk_bf16_f32 v56, v216, v217
    v_cvt_pk_bf16_f32 v57, v218, v219
    v_mfma_f32_16x16x32_bf16 v[208:211], a[228:231], a[84:87], v[208:211]
    v_cvt_pk_bf16_f32 v58, v212, v213
    v_cvt_pk_bf16_f32 v59, v214, v215
    v_mfma_f32_16x16x32_bf16 v[204:207], a[228:231], a[88:91], v[204:207]
    ds_read_b128 a[224:227], v224 offset:3264
    v_mfma_f32_16x16x32_bf16 v[200:203], a[228:231], a[92:95], v[200:203]
    ds_read_b128 a[228:231], v224 offset:3328
    v_mfma_f32_16x16x32_bf16 v[208:211], a[232:235], a[96:99], v[208:211]
    buffer_load_dwordx4 v252, s[8:11], s57 offen lds
    v_mfma_f32_16x16x32_bf16 v[204:207], a[232:235], a[100:103], v[204:207]
    s_add_u32 m0, s50, 0x6800
    v_mfma_f32_16x16x32_bf16 v[200:203], a[232:235], a[104:107], v[200:203]
    ds_read_b128 a[232:235], v224 offset:3392
    v_mfma_f32_16x16x32_bf16 v[208:211], a[236:239], a[108:111], v[208:211]
    v_mfma_f32_16x16x32_bf16 v[204:207], a[236:239], a[112:115], v[204:207]
    s_waitcnt vmcnt(5)
    buffer_load_dwordx4 v253, s[8:11], s57 offen lds
    v_mfma_f32_16x16x32_bf16 v[200:203], a[236:239], a[116:119], v[200:203]
    s_add_u32 s57, s49, 0x1b000
    ds_read_b128 a[236:239], v224 offset:15488
    ds_read_b64_tr_b16 a[144:145], v254
    v_mfma_f32_16x16x32_bf16 v[208:211], a[240:243], a[120:123], v[208:211]
    s_add_u32 m0, s50, 0x9000
    ds_read_b64_tr_b16 a[146:147], v255
    ds_read_b64_tr_b16 a[148:149], v254 offset:32
    v_mfma_f32_16x16x32_bf16 v[204:207], a[240:243], a[124:127], v[204:207]
    ds_read_b64_tr_b16 a[150:151], v255 offset:32
    ds_read_b64_tr_b16 a[152:153], v254 offset:64
    v_mfma_f32_16x16x32_bf16 v[200:203], a[240:243], a[128:131], v[200:203]
    s_waitcnt lgkmcnt(8)
    ds_read_b128 a[240:243], v224 offset:15552
    v_mfma_f32_16x16x32_bf16 v[208:211], a[244:247], a[132:135], v[208:211]
    ds_read_b64_tr_b16 a[154:155], v255 offset:64
    v_mfma_f32_16x16x32_bf16 v[204:207], a[244:247], a[136:139], v[204:207]
    buffer_load_dwordx4 v251, s[8:11], s57 offen lds
    v_mfma_f32_16x16x32_bf16 v[200:203], a[244:247], a[140:143], v[200:203]
    s_add_u32 m0, s50, 0x9400
    ds_read_b128 a[244:247], v224 offset:15616
    v_mfma_f32_16x16x32_bf16 v[180:183], a[248:251], a[72:75], 0
    v_mfma_f32_16x16x32_bf16 v[176:179], a[248:251], a[76:79], 0
    v_cvt_pk_bf16_f32 v66, v208, v209
    v_cvt_pk_bf16_f32 v67, v210, v211
    v_mfma_f32_16x16x32_bf16 v[172:175], a[248:251], a[80:83], 0
    v_cvt_pk_bf16_f32 v88, v204, v205
    v_cvt_pk_bf16_f32 v89, v206, v207
    v_mfma_f32_16x16x32_bf16 v[180:183], a[252:255], a[84:87], v[180:183]
    v_cvt_pk_bf16_f32 v110, v200, v201
    v_cvt_pk_bf16_f32 v111, v202, v203
    v_mfma_f32_16x16x32_bf16 v[176:179], a[252:255], a[88:91], v[176:179]
    ds_read_b128 a[248:251], v224 offset:15680
    v_mfma_f32_16x16x32_bf16 v[172:175], a[252:255], a[92:95], v[172:175]
    ds_read_b128 a[252:255], v224 offset:15744
    v_mfma_f32_16x16x32_bf16 v[180:183], a[220:223], a[96:99], v[180:183]
    buffer_load_dwordx4 v252, s[8:11], s57 offen lds
    v_mfma_f32_16x16x32_bf16 v[176:179], a[220:223], a[100:103], v[176:179]
    s_add_u32 m0, s50, 0x9800
    v_mfma_f32_16x16x32_bf16 v[172:175], a[220:223], a[104:107], v[172:175]
    s_waitcnt vmcnt(5)
    ds_read_b128 a[220:223], v224 offset:15808
    ds_read_b64_tr_b16 a[156:157], v254 offset:12288
    v_mfma_f32_16x16x32_bf16 v[180:183], a[224:227], a[108:111], v[180:183]
    buffer_load_dwordx4 v253, s[8:11], s57 offen lds
    v_mfma_f32_16x16x32_bf16 v[176:179], a[224:227], a[112:115], v[176:179]
    s_add_u32 s57, s49, 0x24000
    ds_read_b64_tr_b16 a[158:159], v255 offset:12288
    ds_read_b64_tr_b16 a[160:161], v254 offset:12320
    v_mfma_f32_16x16x32_bf16 v[172:175], a[224:227], a[116:119], v[172:175]
    s_add_u32 m0, s50, 0xc000
    ds_read_b128 a[224:227], v224 offset:18560
    ds_read_b64_tr_b16 a[162:163], v255 offset:12320
    s_waitcnt lgkmcnt(8)
    v_mfma_f32_16x16x32_bf16 v[180:183], a[228:231], a[120:123], v[180:183]
    ds_read_b64_tr_b16 a[164:165], v254 offset:12352
    ds_read_b64_tr_b16 a[166:167], v255 offset:12352
    v_mfma_f32_16x16x32_bf16 v[176:179], a[228:231], a[124:127], v[176:179]
    v_mfma_f32_16x16x32_bf16 v[172:175], a[228:231], a[128:131], v[172:175]
    ds_read_b128 a[228:231], v224 offset:18624
    v_mfma_f32_16x16x32_bf16 v[180:183], a[232:235], a[132:135], v[180:183]
    buffer_load_dwordx4 v251, s[8:11], s57 offen lds
    v_mfma_f32_16x16x32_bf16 v[176:179], a[232:235], a[136:139], v[176:179]
    s_add_u32 m0, s50, 0xc400
    v_mfma_f32_16x16x32_bf16 v[172:175], a[232:235], a[140:143], v[172:175]
    ds_read_b128 a[232:235], v224 offset:18688
    v_mfma_f32_16x16x32_bf16 v[220:223], a[236:239], a[72:75], 0
    v_mfma_f32_16x16x32_bf16 v[216:219], a[236:239], a[76:79], 0
    v_mfma_f32_16x16x32_bf16 v[212:215], a[236:239], a[80:83], 0
    v_cvt_pk_bf16_f32 v68, v180, v181
    v_cvt_pk_bf16_f32 v69, v182, v183
    v_mfma_f32_16x16x32_bf16 v[220:223], a[240:243], a[84:87], v[220:223]
    v_cvt_pk_bf16_f32 v90, v176, v177
    v_cvt_pk_bf16_f32 v91, v178, v179
    v_mfma_f32_16x16x32_bf16 v[216:219], a[240:243], a[88:91], v[216:219]
    v_cvt_pk_bf16_f32 v112, v172, v173
    v_cvt_pk_bf16_f32 v113, v174, v175
    v_mfma_f32_16x16x32_bf16 v[212:215], a[240:243], a[92:95], v[212:215]
    ds_read_b128 a[236:239], v224 offset:18752
    ds_read_b128 a[240:243], v224 offset:18816
    v_mfma_f32_16x16x32_bf16 v[220:223], a[244:247], a[96:99], v[220:223]
    s_waitcnt vmcnt(4)
    buffer_load_dwordx4 v252, s[8:11], s57 offen lds
    v_mfma_f32_16x16x32_bf16 v[216:219], a[244:247], a[100:103], v[216:219]
    s_add_u32 m0, s50, 0xc800
    ds_read_b64_tr_b16 a[168:169], v254 offset:24576
    ds_read_b64_tr_b16 a[170:171], v255 offset:24576
    v_mfma_f32_16x16x32_bf16 v[212:215], a[244:247], a[104:107], v[212:215]
    s_waitcnt lgkmcnt(5)
    ds_read_b128 a[244:247], v224 offset:18880
    ds_read_b64_tr_b16 a[172:173], v254 offset:24608
    v_mfma_f32_16x16x32_bf16 v[220:223], a[248:251], a[108:111], v[220:223]
    buffer_load_dwordx4 v253, s[8:11], s57 offen lds
    v_mfma_f32_16x16x32_bf16 v[216:219], a[248:251], a[112:115], v[216:219]
    s_add_u32 s57, s49, 0x2d000
    ds_read_b64_tr_b16 a[174:175], v255 offset:24608
    ds_read_b64_tr_b16 a[176:177], v254 offset:24640
    v_mfma_f32_16x16x32_bf16 v[212:215], a[248:251], a[116:119], v[212:215]
    s_add_u32 m0, s50, 0xf000
    ds_read_b128 a[248:251], v227 offset:6144
    ds_read_b64_tr_b16 a[178:179], v255 offset:24640
    v_mfma_f32_16x16x32_bf16 v[220:223], a[252:255], a[120:123], v[220:223]
    v_mfma_f32_16x16x32_bf16 v[216:219], a[252:255], a[124:127], v[216:219]
    buffer_load_dwordx4 v251, s[8:11], s57 offen lds
    v_mfma_f32_16x16x32_bf16 v[212:215], a[252:255], a[128:131], v[212:215]
    s_add_u32 m0, s50, 0xf400
    ds_read_b128 a[252:255], v227 offset:6208
    v_mfma_f32_16x16x32_bf16 v[220:223], a[220:223], a[132:135], v[220:223]
    v_mfma_f32_16x16x32_bf16 v[216:219], a[220:223], a[136:139], v[216:219]
    v_mfma_f32_16x16x32_bf16 v[212:215], a[220:223], a[140:143], v[212:215]
    ds_read_b128 a[220:223], v227 offset:6272
    v_mfma_f32_16x16x32_bf16 v[208:211], a[224:227], a[72:75], 0
    buffer_load_dwordx4 v252, s[8:11], s57 offen lds
    v_mfma_f32_16x16x32_bf16 v[204:207], a[224:227], a[76:79], 0
    s_add_u32 m0, s50, 0xf800
    v_mfma_f32_16x16x32_bf16 v[200:203], a[224:227], a[80:83], 0
    v_cvt_pk_bf16_f32 v72, v220, v221
    v_cvt_pk_bf16_f32 v73, v222, v223
    v_mfma_f32_16x16x32_bf16 v[208:211], a[228:231], a[84:87], v[208:211]
    v_cvt_pk_bf16_f32 v94, v216, v217
    v_cvt_pk_bf16_f32 v95, v218, v219
    v_mfma_f32_16x16x32_bf16 v[204:207], a[228:231], a[88:91], v[204:207]
    v_cvt_pk_bf16_f32 v116, v212, v213
    v_cvt_pk_bf16_f32 v117, v214, v215
    v_mfma_f32_16x16x32_bf16 v[200:203], a[228:231], a[92:95], v[200:203]
    s_waitcnt lgkmcnt(2)
    ds_read_b128 a[224:227], v227 offset:6336
    ds_read_b128 a[228:231], v227 offset:6400
    v_mfma_f32_16x16x32_bf16 v[208:211], a[232:235], a[96:99], v[208:211]
    s_waitcnt vmcnt(5)
    buffer_load_dwordx4 v253, s[8:11], s57 offen lds
    v_mfma_f32_16x16x32_bf16 v[204:207], a[232:235], a[100:103], v[204:207]
    s_add_u32 s57, s49, 0
    ds_read_b64_tr_b16 a[180:181], v254 offset:36864
    ds_read_b64_tr_b16 a[182:183], v255 offset:36864
    v_mfma_f32_16x16x32_bf16 v[200:203], a[232:235], a[104:107], v[200:203]
    s_add_u32 m0, s50, 0
    ds_read_b128 a[232:235], v227 offset:6464
    ds_read_b64_tr_b16 a[184:185], v254 offset:36896
    v_mfma_f32_16x16x32_bf16 v[208:211], a[236:239], a[108:111], v[208:211]
    ds_read_b64_tr_b16 a[186:187], v255 offset:36896
    ds_read_b64_tr_b16 a[188:189], v254 offset:36928
    v_mfma_f32_16x16x32_bf16 v[204:207], a[236:239], a[112:115], v[204:207]
    ds_read_b64_tr_b16 a[190:191], v255 offset:36928
    v_mfma_f32_16x16x32_bf16 v[200:203], a[236:239], a[116:119], v[200:203]
    ds_read_b128 a[236:239], v225 offset:24384
    v_mfma_f32_16x16x32_bf16 v[208:211], a[240:243], a[120:123], v[208:211]
    buffer_load_dwordx4 v192, s[12:15], s57 offen lds
    v_mfma_f32_16x16x32_bf16 v[204:207], a[240:243], a[124:127], v[204:207]
    s_add_u32 m0, s50, 0x400
    v_mfma_f32_16x16x32_bf16 v[200:203], a[240:243], a[128:131], v[200:203]
    ds_read_b128 a[240:243], v225 offset:24448
    v_mfma_f32_16x16x32_bf16 v[208:211], a[244:247], a[132:135], v[208:211]
    v_mfma_f32_16x16x32_bf16 v[204:207], a[244:247], a[136:139], v[204:207]
    v_mfma_f32_16x16x32_bf16 v[200:203], a[244:247], a[140:143], v[200:203]
    ds_read_b128 a[244:247], v225 offset:24512
    v_mfma_f32_16x16x32_bf16 v[180:183], a[248:251], a[72:75], 0
    buffer_load_dwordx4 v193, s[12:15], s57 offen lds
    v_mfma_f32_16x16x32_bf16 v[176:179], a[248:251], a[76:79], 0
    s_add_u32 m0, s50, 0x800
    v_mfma_f32_16x16x32_bf16 v[172:175], a[248:251], a[80:83], 0
    s_waitcnt lgkmcnt(3)
    v_cvt_pk_bf16_f32 v70, v208, v209
    v_cvt_pk_bf16_f32 v71, v210, v211
    v_mfma_f32_16x16x32_bf16 v[180:183], a[252:255], a[84:87], v[180:183]
    v_cvt_pk_bf16_f32 v92, v204, v205
    v_cvt_pk_bf16_f32 v93, v206, v207
    v_mfma_f32_16x16x32_bf16 v[176:179], a[252:255], a[88:91], v[176:179]
    v_cvt_pk_bf16_f32 v114, v200, v201
    v_cvt_pk_bf16_f32 v115, v202, v203
    v_mfma_f32_16x16x32_bf16 v[172:175], a[252:255], a[92:95], v[172:175]
    ds_read_b128 a[248:251], v225 offset:24576
    ds_read_b128 a[252:255], v225 offset:24640
    v_mfma_f32_16x16x32_bf16 v[180:183], a[220:223], a[96:99], v[180:183]
    s_waitcnt vmcnt(5)
    buffer_load_dwordx4 v194, s[12:15], s57 offen lds
    v_mfma_f32_16x16x32_bf16 v[176:179], a[220:223], a[100:103], v[176:179]
    s_add_u32 s57, s49, 0x3000
    ds_read_b64_tr_b16 a[192:193], v254 offset:49152
    ds_read_b64_tr_b16 a[194:195], v255 offset:49152
    v_mfma_f32_16x16x32_bf16 v[172:175], a[220:223], a[104:107], v[172:175]
    s_add_u32 m0, s50, 0x3000
    ds_read_b128 a[220:223], v225 offset:24704
    ds_read_b64_tr_b16 a[196:197], v254 offset:49184
    v_mfma_f32_16x16x32_bf16 v[180:183], a[224:227], a[108:111], v[180:183]
    ds_read_b64_tr_b16 a[198:199], v255 offset:49184
    ds_read_b64_tr_b16 a[200:201], v254 offset:49216
    v_mfma_f32_16x16x32_bf16 v[176:179], a[224:227], a[112:115], v[176:179]
    buffer_load_dwordx4 v86, s[12:15], s57 offen lds
    v_mfma_f32_16x16x32_bf16 v[172:175], a[224:227], a[116:119], v[172:175]
    s_add_u32 m0, s50, 0x3400
    ds_read_b128 a[224:227], v225 offset:27456
    ds_read_b64_tr_b16 a[202:203], v255 offset:49216
    v_mfma_f32_16x16x32_bf16 v[180:183], a[228:231], a[120:123], v[180:183]
    v_mfma_f32_16x16x32_bf16 v[176:179], a[228:231], a[124:127], v[176:179]
    v_mfma_f32_16x16x32_bf16 v[172:175], a[228:231], a[128:131], v[172:175]
    ds_read_b128 a[228:231], v225 offset:27520
    v_mfma_f32_16x16x32_bf16 v[180:183], a[232:235], a[132:135], v[180:183]
    buffer_load_dwordx4 v87, s[12:15], s57 offen lds
    v_mfma_f32_16x16x32_bf16 v[176:179], a[232:235], a[136:139], v[176:179]
    s_add_u32 m0, s50, 0x3800
    v_mfma_f32_16x16x32_bf16 v[172:175], a[232:235], a[140:143], v[172:175]
    s_waitcnt lgkmcnt(7)
    ds_read_b128 a[232:235], v225 offset:27584
    v_mfma_f32_16x16x32_bf16 v[220:223], a[144:147], a[236:239], 0
    v_mfma_f32_16x16x32_bf16 v[216:219], a[148:151], a[236:239], 0
    v_mfma_f32_16x16x32_bf16 v[212:215], a[152:155], a[236:239], 0
    v_cvt_pk_bf16_f32 v82, v180, v181
    v_cvt_pk_bf16_f32 v83, v182, v183
    v_mfma_f32_16x16x32_bf16 v[220:223], a[156:159], a[240:243], v[220:223]
    v_cvt_pk_bf16_f32 v104, v176, v177
    v_cvt_pk_bf16_f32 v105, v178, v179
    v_mfma_f32_16x16x32_bf16 v[216:219], a[160:163], a[240:243], v[216:219]
    v_cvt_pk_bf16_f32 v126, v172, v173
    v_cvt_pk_bf16_f32 v127, v174, v175
    v_mfma_f32_16x16x32_bf16 v[212:215], a[164:167], a[240:243], v[212:215]
    ds_read_b128 a[236:239], v225 offset:27648
    ds_read_b128 a[240:243], v225 offset:27712
    v_mfma_f32_16x16x32_bf16 v[220:223], a[168:171], a[244:247], v[220:223]
    s_waitcnt vmcnt(5)
    buffer_load_dwordx4 v108, s[12:15], s57 offen lds
    v_mfma_f32_16x16x32_bf16 v[216:219], a[172:175], a[244:247], v[216:219]
    s_add_u32 s57, s49, 0x4800
    ds_read_b64_tr_b16 a[204:205], v254 offset:61440
    ds_read_b64_tr_b16 a[206:207], v255 offset:61440
    v_mfma_f32_16x16x32_bf16 v[212:215], a[176:179], a[244:247], v[212:215]
    s_add_u32 m0, s50, 0x6000
    ds_read_b128 a[244:247], v225 offset:27776
    ds_read_b64_tr_b16 a[208:209], v254 offset:61472
    v_mfma_f32_16x16x32_bf16 v[220:223], a[180:183], a[248:251], v[220:223]
    buffer_load_dwordx4 v192, s[12:15], s57 offen lds
    v_mfma_f32_16x16x32_bf16 v[216:219], a[184:187], a[248:251], v[216:219]
    s_add_u32 m0, s50, 0x6400
    ds_read_b64_tr_b16 a[210:211], v255 offset:61472
    ds_read_b64_tr_b16 a[212:213], v254 offset:61504
    v_mfma_f32_16x16x32_bf16 v[212:215], a[188:191], a[248:251], v[212:215]
    ds_read_b128 a[248:251], v224 offset:30976
    ds_read_b64_tr_b16 a[214:215], v255 offset:61504
    v_mfma_f32_16x16x32_bf16 v[220:223], a[192:195], a[252:255], v[220:223]
    s_waitcnt lgkmcnt(10)
    v_mfma_f32_16x16x32_bf16 v[216:219], a[196:199], a[252:255], v[216:219]
    v_mfma_f32_16x16x32_bf16 v[212:215], a[200:203], a[252:255], v[212:215]
    ds_read_b128 a[252:255], v224 offset:31040
    v_mfma_f32_16x16x32_bf16 v[208:211], a[144:147], a[224:227], 0
    s_waitcnt lgkmcnt(6)
    buffer_load_dwordx4 v193, s[12:15], s57 offen lds
    v_mfma_f32_16x16x32_bf16 v[220:223], a[204:207], a[220:223], v[220:223]
    s_add_u32 m0, s50, 0x6800
    s_barrier
    v_mfma_f32_16x16x32_bf16 v[204:207], a[148:151], a[224:227], 0
    s_waitcnt lgkmcnt(4)
    v_mfma_f32_16x16x32_bf16 v[216:219], a[208:211], a[220:223], v[216:219]
    v_mfma_f32_16x16x32_bf16 v[200:203], a[152:155], a[224:227], 0
    s_waitcnt lgkmcnt(1)
    ds_read_b128 a[224:227], v224 offset:31168
    v_mfma_f32_16x16x32_bf16 v[212:215], a[212:215], a[220:223], v[212:215]
    ds_read_b128 a[220:223], v224 offset:31104
    v_mul_f32 v220, s37, v220
    v_mfma_f32_16x16x32_bf16 v[208:211], a[156:159], a[228:231], v[208:211]
    v_mul_f32 v221, s37, v221
    v_mul_f32 v222, s37, v222
    v_mfma_f32_16x16x32_bf16 v[204:207], a[160:163], a[228:231], v[204:207]
    v_mul_f32 v223, s37, v223
    v_cvt_pk_bf16_f32 v132, v220, v221
    v_mfma_f32_16x16x32_bf16 v[200:203], a[164:167], a[228:231], v[200:203]
    v_cvt_pk_bf16_f32 v133, v222, v223
    v_mul_f32 v216, s37, v216
    v_mfma_f32_16x16x32_bf16 v[208:211], a[168:171], a[232:235], v[208:211]
    v_mul_f32 v217, s37, v217
    v_mul_f32 v218, s37, v218
    v_mfma_f32_16x16x32_bf16 v[204:207], a[172:175], a[232:235], v[204:207]
    v_mul_f32 v219, s37, v219
    v_cvt_pk_bf16_f32 v134, v216, v217
    v_mfma_f32_16x16x32_bf16 v[200:203], a[176:179], a[232:235], v[200:203]
    v_cvt_pk_bf16_f32 v135, v218, v219
    v_mul_f32 v212, s37, v212
    v_mfma_f32_16x16x32_bf16 v[208:211], a[180:183], a[236:239], v[208:211]
    v_mul_f32 v213, s37, v213
    v_mul_f32 v214, s37, v214
    v_mfma_f32_16x16x32_bf16 v[144:147], v[0:3], v[132:135], v[144:147]
    v_mul_f32 v215, s37, v215
    v_cvt_pk_bf16_f32 v136, v212, v213
    v_mfma_f32_16x16x32_bf16 v[148:151], v[24:27], v[132:135], v[148:151]
    ds_read_b128 a[228:231], v224 offset:31232
    v_cvt_pk_bf16_f32 v137, v214, v215
    v_mfma_f32_16x16x32_bf16 v[152:155], v[30:33], v[132:135], v[152:155]
    ds_read_b128 a[232:235], v224 offset:31296
    v_mfma_f32_16x16x16_bf16 v[144:147], v[4:5], v[136:137], v[144:147]
    buffer_load_dwordx4 v194, s[12:15], s57 offen lds
    v_mfma_f32_16x16x16_bf16 v[148:151], v[28:29], v[136:137], v[148:151]
    s_add_u32 s57, s49, 0x9000
    s_add_u32 m0, s50, 0x9000
    v_mfma_f32_16x16x16_bf16 v[152:155], v[34:35], v[136:137], v[152:155]
    buffer_load_dwordx4 v192, s[12:15], s57 offen lds
    v_mfma_f32_16x16x32_bf16 v[156:159], v[6:9], v[132:135], v[156:159]
    s_add_u32 m0, s50, 0x9400
    v_exp_f32 v144, v144
    v_mfma_f32_16x16x32_bf16 v[204:207], a[184:187], a[236:239], v[204:207]
    buffer_load_dwordx4 v193, s[12:15], s57 offen lds
    v_mfma_f32_16x16x32_bf16 v[200:203], a[188:191], a[236:239], v[200:203]
    s_add_u32 m0, s50, 0x9800
    ds_read_b128 a[236:239], v224 offset:34048
    v_mfma_f32_16x16x16_bf16 v[156:159], v[10:11], v[136:137], v[156:159]
    buffer_load_dwordx4 v194, s[12:15], s57 offen lds
    v_mfma_f32_16x16x32_bf16 v[208:211], a[192:195], a[240:243], v[208:211]
    s_add_u32 s57, s49, 0xc000
    v_exp_f32 v145, v145
    v_mfma_f32_16x16x32_bf16 v[204:207], a[196:199], a[240:243], v[204:207]
    s_add_u32 m0, s50, 0xc000
    v_exp_f32 v146, v146
    v_mfma_f32_16x16x32_bf16 v[200:203], a[200:203], a[240:243], v[200:203]
    ds_read_b128 a[240:243], v224 offset:34112
    v_cvt_pk_bf16_f32 v160, v144, v145
    v_mfma_f32_16x16x32_bf16 v[208:211], a[204:207], a[244:247], v[208:211]
    buffer_load_dwordx4 v86, s[12:15], s57 offen lds
    v_mfma_f32_16x16x32_bf16 v[204:207], a[208:211], a[244:247], v[204:207]
    s_add_u32 m0, s50, 0xc400
    v_exp_f32 v147, v147
    v_mfma_f32_16x16x32_bf16 v[200:203], a[212:215], a[244:247], v[200:203]
    ds_read_b128 a[244:247], v224 offset:34176
    v_cvt_pk_bf16_f32 v161, v146, v147
    v_mfma_f32_16x16x32_bf16 v[180:183], a[248:251], a[72:75], 0
    v_mul_f32 v208, s37, v208
    v_mul_f32 v209, s37, v209
    v_mfma_f32_16x16x32_bf16 v[176:179], a[248:251], a[76:79], 0
    v_mul_f32 v210, s37, v210
    v_mul_f32 v211, s37, v211
    v_mfma_f32_16x16x32_bf16 v[172:175], a[248:251], a[80:83], 0
    s_waitcnt lgkmcnt(2)
    v_cvt_pk_bf16_f32 v138, v208, v209
    v_cvt_pk_bf16_f32 v139, v210, v211
    v_mfma_f32_16x16x32_bf16 v[180:183], a[252:255], a[84:87], v[180:183]
    v_mul_f32 v204, s37, v204
    v_mul_f32 v205, s37, v205
    v_mfma_f32_16x16x32_bf16 v[176:179], a[252:255], a[88:91], v[176:179]
    v_mul_f32 v206, s37, v206
    v_mul_f32 v207, s37, v207
    v_mfma_f32_16x16x32_bf16 v[172:175], a[252:255], a[92:95], v[172:175]
    v_cvt_pk_bf16_f32 v140, v204, v205
    v_cvt_pk_bf16_f32 v141, v206, v207
    v_mfma_f32_16x16x32_bf16 v[180:183], a[220:223], a[96:99], v[180:183]
    v_mul_f32 v200, s37, v200
    v_mul_f32 v201, s37, v201
    v_mfma_f32_16x16x32_bf16 v[176:179], a[220:223], a[100:103], v[176:179]
    v_mul_f32 v202, s37, v202
    v_mul_f32 v203, s37, v203
    v_mfma_f32_16x16x32_bf16 v[172:175], a[220:223], a[104:107], v[172:175]
    v_cvt_pk_bf16_f32 v142, v200, v201
    v_cvt_pk_bf16_f32 v143, v202, v203
    v_mfma_f32_16x16x32_bf16 v[180:183], a[224:227], a[108:111], v[180:183]
    ds_read_b128 a[248:251], v224 offset:34240
    ds_read_b128 a[252:255], v224 offset:34304
    v_mfma_f32_16x16x32_bf16 v[176:179], a[224:227], a[112:115], v[176:179]
    ds_read_b128 a[220:223], v224 offset:34368
    v_mfma_f32_16x16x32_bf16 v[172:175], a[224:227], a[116:119], v[172:175]
    ds_read_b128 a[224:227], v224 offset:46464
    v_mfma_f32_16x16x32_bf16 v[180:183], a[228:231], a[120:123], v[180:183]
    buffer_load_dwordx4 v87, s[12:15], s57 offen lds
    v_mfma_f32_16x16x32_bf16 v[176:179], a[228:231], a[124:127], v[176:179]
    s_add_u32 m0, s50, 0xc800
    ds_read_b128 v[144:147], v228 offset:1920
    v_mfma_f32_16x16x32_bf16 v[172:175], a[228:231], a[128:131], v[172:175]
L_pg2:
    s_cbranch_execz L_pg6
    ds_read_b128 a[228:231], v224 offset:46528
    v_mfma_f32_16x16x32_bf16 v[180:183], a[232:235], a[132:135], v[180:183]
    buffer_load_dwordx4 v108, s[12:15], s57 offen lds
    v_mfma_f32_16x16x32_bf16 v[176:179], a[232:235], a[136:139], v[176:179]
    s_add_u32 s57, s49, 0xd800
    v_exp_f32 v148, v148
    v_mfma_f32_16x16x32_bf16 v[172:175], a[232:235], a[140:143], v[172:175]
    s_add_u32 m0, s50, 0xf000
    ds_read_b128 a[232:235], v224 offset:46592
    v_mfma_f32_16x16x32_bf16 v[220:223], a[236:239], a[72:75], 0
    v_cvt_pk_bf16_f32 v74, v180, v181
    v_cvt_pk_bf16_f32 v75, v182, v183
    v_mfma_f32_16x16x32_bf16 v[216:219], a[236:239], a[76:79], 0
    v_cvt_pk_bf16_f32 v96, v176, v177
    v_cvt_pk_bf16_f32 v97, v178, v179
    v_mfma_f32_16x16x32_bf16 v[212:215], a[236:239], a[80:83], 0
    s_waitcnt lgkmcnt(5)
    v_cvt_pk_bf16_f32 v118, v172, v173
    v_cvt_pk_bf16_f32 v119, v174, v175
    v_mfma_f32_16x16x32_bf16 v[220:223], a[240:243], a[84:87], v[220:223]
    s_waitcnt lgkmcnt(2)
    ds_read_b128 a[236:239], v224 offset:46656
    v_mfma_f32_16x16x32_bf16 v[144:147], v[12:15], v[132:135], v[144:147]
    buffer_load_dwordx4 v192, s[12:15], s57 offen lds
    v_mfma_f32_16x16x32_bf16 v[216:219], a[240:243], a[88:91], v[216:219]
    s_add_u32 m0, s50, 0xf400
    v_exp_f32 v149, v149
    v_mfma_f32_16x16x32_bf16 v[212:215], a[240:243], a[92:95], v[212:215]
    ds_read_b128 a[240:243], v224 offset:46720
    v_cvt_pk_bf16_f32 v162, v148, v149
    v_mfma_f32_16x16x16_bf16 v[144:147], v[16:17], v[136:137], v[144:147]
    buffer_load_dwordx4 v193, s[12:15], s57 offen lds
    v_mfma_f32_16x16x32_bf16 v[220:223], a[244:247], a[96:99], v[220:223]
    s_add_u32 m0, s50, 0xf800
    v_exp_f32 v150, v150
    v_mfma_f32_16x16x32_bf16 v[216:219], a[244:247], a[100:103], v[216:219]
    buffer_load_dwordx4 v194, s[12:15], s57 offen lds
    v_mfma_f32_16x16x32_bf16 v[212:215], a[244:247], a[104:107], v[212:215]
    s_add_u32 m0, s41, 0
    ds_read_b128 a[244:247], v224 offset:46784
    v_mfma_f32_16x16x32_bf16 v[220:223], a[248:251], a[108:111], v[220:223]
    v_exp_f32 v151, v151
    v_mfma_f32_16x16x32_bf16 v[216:219], a[248:251], a[112:115], v[216:219]
    s_waitcnt vmcnt(6)
    buffer_load_dwordx4 v246, s[4:7], s56 offen lds
    v_mfma_f32_16x16x32_bf16 v[212:215], a[248:251], a[116:119], v[212:215]
    s_add_u32 m0, s42, 0
    ds_read_b128 a[248:251], v224 offset:49536
    ds_read_b64_tr_b16 v[164:165], v109 offset:36864
    v_mfma_f32_16x16x32_bf16 v[220:223], a[252:255], a[120:123], v[220:223]
    ds_read_b64_tr_b16 v[166:167], v109 offset:38400
    ds_read_b64_tr_b16 v[168:169], v109 offset:36896
    v_mfma_f32_16x16x32_bf16 v[216:219], a[252:255], a[124:127], v[216:219]
    ds_read_b64_tr_b16 v[170:171], v109 offset:38432
    ds_read_b64_tr_b16 v[248:249], v109 offset:36928
    v_mfma_f32_16x16x32_bf16 v[212:215], a[252:255], a[128:131], v[212:215]
    ds_read_b128 a[252:255], v224 offset:49600
    v_cvt_pk_bf16_f32 v163, v150, v151
    v_mfma_f32_16x16x32_bf16 v[220:223], a[220:223], a[132:135], v[220:223]
    ds_read_b128 v[148:151], v229 offset:1920
    v_mfma_f32_16x16x32_bf16 v[196:199], a[216:219], v[160:163], 0
    buffer_load_dwordx4 v247, s[4:7], s56 offen lds
    v_mfma_f32_16x16x32_bf16 v[184:187], v[66:69], v[160:163], 0
    s_add_u32 s56, s39, 0x17a000
    ds_read_b64_tr_b16 v[250:251], v109 offset:38464
    s_add_u32 m0, s41, 0x1e40
    v_mfma_f32_16x16x32_bf16 v[188:191], v[88:91], v[160:163], 0
    v_cvt_pk_bf16_f32 v76, v220, v221
    v_cvt_pk_bf16_f32 v77, v222, v223
    v_mfma_f32_16x16x32_bf16 v[192:195], v[110:113], v[160:163], 0
    v_exp_f32 v152, v152
    v_mfma_f32_16x16x32_bf16 v[216:219], a[220:223], a[136:139], v[216:219]
    s_waitcnt lgkmcnt(6)
    ds_write_b128 v130, v[164:167] offset:36864
    v_mfma_f32_16x16x32_bf16 v[212:215], a[220:223], a[140:143], v[212:215]
    s_waitcnt lgkmcnt(2)
    buffer_load_dwordx4 v246, s[4:7], s56 offen lds
    v_mfma_f32_16x16x32_bf16 v[208:211], a[224:227], a[72:75], 0
    s_add_u32 m0, s42, 0x1e40
    ds_write_b128 v130, v[168:171] offset:37888
    v_mfma_f32_16x16x32_bf16 v[148:151], v[36:39], v[132:135], v[148:151]
    s_waitcnt lgkmcnt(2)
    ds_write_b128 v130, v[248:251] offset:38912
    v_mfma_f32_16x16x32_bf16 v[204:207], a[224:227], a[76:79], 0
    v_cvt_pk_bf16_f32 v98, v216, v217
    v_cvt_pk_bf16_f32 v99, v218, v219
    v_mfma_f32_16x16x32_bf16 v[200:203], a[224:227], a[80:83], 0
    v_cvt_pk_bf16_f32 v120, v212, v213
    v_cvt_pk_bf16_f32 v121, v214, v215
    v_mfma_f32_16x16x16_bf16 v[148:151], v[40:41], v[136:137], v[148:151]
    buffer_load_dwordx4 v247, s[4:7], s56 offen lds
    v_mfma_f32_16x16x32_bf16 v[208:211], a[228:231], a[84:87], v[208:211]
    s_add_u32 s56, s39, 0x1a4000
    v_exp_f32 v153, v153
    v_mfma_f32_16x16x32_bf16 v[204:207], a[228:231], a[88:91], v[204:207]
    s_add_u32 m0, s41, 0x3c80
    v_exp_f32 v154, v154
    v_mfma_f32_16x16x32_bf16 v[200:203], a[228:231], a[92:95], v[200:203]
    v_exp_f32 v155, v155
    v_mfma_f32_16x16x32_bf16 v[208:211], a[232:235], a[96:99], v[208:211]
    ds_read_b128 a[220:223], v224 offset:49664
    ds_read_b128 a[224:227], v224 offset:49728
    v_mfma_f32_16x16x32_bf16 v[204:207], a[232:235], a[100:103], v[204:207]
    ds_read_b128 a[228:231], v224 offset:49792
    v_cvt_pk_bf16_f32 v160, v152, v153
    v_mfma_f32_16x16x32_bf16 v[200:203], a[232:235], a[104:107], v[200:203]
    ds_read_b128 a[232:235], v224 offset:49856
    v_cvt_pk_bf16_f32 v161, v154, v155
    v_mfma_f32_16x16x32_bf16 v[208:211], a[236:239], a[108:111], v[208:211]
    buffer_load_dwordx4 v246, s[4:7], s56 offen lds
    v_mfma_f32_16x16x32_bf16 v[204:207], a[236:239], a[112:115], v[204:207]
    s_add_u32 m0, s42, 0x3c80
    ds_read_b128 v[152:155], v235
    v_bfe_u32 v235, s61, v232, 4
    v_mfma_f32_16x16x32_bf16 v[200:203], a[236:239], a[116:119], v[200:203]
    ds_read_b128 a[236:239], v227 offset:37120
    v_mad_u32_u24 v235, v235, s40, v230
    v_mfma_f32_16x16x32_bf16 v[208:211], a[240:243], a[120:123], v[208:211]
    buffer_load_dwordx4 v247, s[4:7], s56 offen lds
    v_mfma_f32_16x16x32_bf16 v[204:207], a[240:243], a[124:127], v[204:207]
    s_add_u32 s56, s39, 0x1ce000
    v_exp_f32 v156, v156
    v_mfma_f32_16x16x32_bf16 v[200:203], a[240:243], a[128:131], v[200:203]
    s_add_u32 m0, s41, 0x5ac0
    ds_read_b128 a[240:243], v227 offset:37184
    v_mfma_f32_16x16x32_bf16 v[208:211], a[244:247], a[132:135], v[208:211]
    v_exp_f32 v157, v157
    v_mfma_f32_16x16x32_bf16 v[204:207], a[244:247], a[136:139], v[204:207]
    v_exp_f32 v158, v158
    v_mfma_f32_16x16x32_bf16 v[200:203], a[244:247], a[140:143], v[200:203]
    ds_read_b128 a[244:247], v227 offset:37248
    v_cvt_pk_bf16_f32 v162, v156, v157
    v_mfma_f32_16x16x32_bf16 v[180:183], a[248:251], a[72:75], 0
    s_waitcnt lgkmcnt(3)
    buffer_load_dwordx4 v246, s[4:7], s56 offen lds
    v_mfma_f32_16x16x32_bf16 v[152:155], v[42:45], v[132:135], v[152:155]
    s_add_u32 m0, s42, 0x5ac0
    v_cvt_pk_bf16_f32 v80, v208, v209
    v_cvt_pk_bf16_f32 v81, v210, v211
    v_mfma_f32_16x16x32_bf16 v[176:179], a[248:251], a[76:79], 0
    v_cvt_pk_bf16_f32 v102, v204, v205
    v_cvt_pk_bf16_f32 v103, v206, v207
    v_mfma_f32_16x16x16_bf16 v[152:155], v[46:47], v[136:137], v[152:155]
    v_cvt_pk_bf16_f32 v124, v200, v201
    v_cvt_pk_bf16_f32 v125, v202, v203
    v_mfma_f32_16x16x32_bf16 v[172:175], a[248:251], a[80:83], 0
    ds_read_b128 a[248:251], v227 offset:37312
    v_mfma_f32_16x16x32_bf16 v[180:183], a[252:255], a[84:87], v[180:183]
    buffer_load_dwordx4 v247, s[4:7], s56 offen lds
    v_mfma_f32_16x16x32_bf16 v[176:179], a[252:255], a[88:91], v[176:179]
    s_add_u32 s56, s39, 0x1f8000
    v_exp_f32 v159, v159
    v_mfma_f32_16x16x32_bf16 v[172:175], a[252:255], a[92:95], v[172:175]
    s_add_u32 m0, s41, 0x7900
    ds_read_b128 a[252:255], v227 offset:37376
    v_cvt_pk_bf16_f32 v163, v158, v159
    v_mfma_f32_16x16x32_bf16 v[180:183], a[220:223], a[96:99], v[180:183]
    ds_read_b128 v[156:159], v234
    v_bfe_u32 v234, s60, v232, 4
    v_mfma_f32_16x16x32_bf16 v[196:199], a[216:219], v[160:163], v[196:199]
    v_mad_u32_u24 v234, v234, s40, v230
    v_mfma_f32_16x16x32_bf16 v[184:187], v[70:73], v[160:163], v[184:187]
    v_exp_f32 v144, v144
    v_mfma_f32_16x16x32_bf16 v[188:191], v[92:95], v[160:163], v[188:191]
    v_exp_f32 v145, v145
    v_mfma_f32_16x16x32_bf16 v[192:195], v[114:117], v[160:163], v[192:195]
    v_exp_f32 v146, v146
    v_mfma_f32_16x16x32_bf16 v[176:179], a[220:223], a[100:103], v[176:179]
    v_exp_f32 v147, v147
    v_mfma_f32_16x16x32_bf16 v[172:175], a[220:223], a[104:107], v[172:175]
    ds_read_b128 a[220:223], v227 offset:37440
    v_cvt_pk_bf16_f32 v160, v144, v145
    v_mfma_f32_16x16x32_bf16 v[180:183], a[224:227], a[108:111], v[180:183]
    v_cvt_pk_bf16_f32 v161, v146, v147
    v_mfma_f32_16x16x32_bf16 v[176:179], a[224:227], a[112:115], v[176:179]
    s_waitcnt lgkmcnt(1)
    ds_read_b128 v[144:147], v234
    v_bfe_u32 v234, s62, v232, 4
    v_mfma_f32_16x16x32_bf16 v[156:159], v[18:21], v[132:135], v[156:159]
    v_mad_u32_u24 v234, v234, s40, v230
    v_mfma_f32_16x16x32_bf16 v[172:175], a[224:227], a[116:119], v[172:175]
    ds_read_b64_tr_b16 a[224:225], v109
    ds_read_b64_tr_b16 a[226:227], v109 offset:1536
    v_mfma_f32_16x16x32_bf16 v[180:183], a[228:231], a[120:123], v[180:183]
    v_exp_f32 v148, v148
    v_mfma_f32_16x16x16_bf16 v[156:159], v[22:23], v[136:137], v[156:159]
    v_exp_f32 v149, v149
    v_mfma_f32_16x16x32_bf16 v[176:179], a[228:231], a[124:127], v[176:179]
    v_exp_f32 v150, v150
    v_mfma_f32_16x16x32_bf16 v[172:175], a[228:231], a[128:131], v[172:175]
    ds_read_b64_tr_b16 a[228:229], v109 offset:32
    ds_read_b64_tr_b16 a[230:231], v109 offset:1568
    v_mfma_f32_16x16x32_bf16 v[180:183], a[232:235], a[132:135], v[180:183]
    v_exp_f32 v151, v151
    v_mfma_f32_16x16x32_bf16 v[176:179], a[232:235], a[136:139], v[176:179]
    s_waitcnt lgkmcnt(4)
    v_cvt_pk_bf16_f32 v162, v148, v149
    v_cvt_pk_bf16_f32 v163, v150, v151
    v_mfma_f32_16x16x32_bf16 v[144:147], v[24:27], v[138:141], v[144:147]
    ds_read_b128 v[148:151], v235
    v_bfe_u32 v235, s63, v233, 4
    v_mfma_f32_16x16x32_bf16 v[196:199], a[216:219], v[160:163], v[196:199]
    v_cvt_pk_bf16_f32 v78, v180, v181
    v_cvt_pk_bf16_f32 v79, v182, v183
    v_mfma_f32_16x16x32_bf16 v[184:187], v[74:77], v[160:163], v[184:187]
    v_cvt_pk_bf16_f32 v100, v176, v177
    v_cvt_pk_bf16_f32 v101, v178, v179
    v_mfma_f32_16x16x32_bf16 v[188:191], v[96:99], v[160:163], v[188:191]
    v_mad_u32_u24 v235, v235, s40, v231
    v_mfma_f32_16x16x32_bf16 v[192:195], v[118:121], v[160:163], v[192:195]
    v_exp_f32 v152, v152
    v_mfma_f32_16x16x16_bf16 v[144:147], v[28:29], v[142:143], v[144:147]
    v_exp_f32 v153, v153
    v_mfma_f32_16x16x32_bf16 v[172:175], a[232:235], a[140:143], v[172:175]
    ds_read_b64_tr_b16 a[232:233], v109 offset:64
    ds_read_b64_tr_b16 a[234:235], v109 offset:1600
    v_mfma_f32_16x16x32_bf16 v[220:223], a[236:239], a[72:75], 0
    s_waitcnt lgkmcnt(3)
    ds_write_b128 v130, a[224:227]
    v_mfma_f32_16x16x32_bf16 v[216:219], a[236:239], a[76:79], 0
    s_waitcnt lgkmcnt(3)
    ds_write_b128 v130, a[228:231] offset:1024
    v_mfma_f32_16x16x32_bf16 v[148:151], v[30:33], v[138:141], v[148:151]
    v_exp_f32 v154, v154
    v_mfma_f32_16x16x32_bf16 v[212:215], a[236:239], a[80:83], 0
    v_cvt_pk_bf16_f32 v122, v172, v173
    v_cvt_pk_bf16_f32 v123, v174, v175
    v_mfma_f32_16x16x32_bf16 v[220:223], a[240:243], a[84:87], v[220:223]
    v_exp_f32 v155, v155
    v_mfma_f32_16x16x16_bf16 v[148:151], v[34:35], v[142:143], v[148:151]
    v_cvt_pk_bf16_f32 v160, v152, v153
    v_cvt_pk_bf16_f32 v161, v154, v155
    v_mfma_f32_16x16x32_bf16 v[216:219], a[240:243], a[88:91], v[216:219]
    s_waitcnt lgkmcnt(2)
    ds_write_b128 v130, a[232:235] offset:2048
    v_mfma_f32_16x16x32_bf16 v[212:215], a[240:243], a[92:95], v[212:215]
    v_exp_f32 v156, v156
    v_mfma_f32_16x16x32_bf16 v[220:223], a[244:247], a[96:99], v[220:223]
    v_exp_f32 v157, v157
    v_mfma_f32_16x16x32_bf16 v[216:219], a[244:247], a[100:103], v[216:219]
    v_exp_f32 v158, v158
    v_mfma_f32_16x16x32_bf16 v[212:215], a[244:247], a[104:107], v[212:215]
    ds_read_b128 a[236:239], v225 offset:39872
    ds_read_b128 a[240:243], v225 offset:39936
    v_mfma_f32_16x16x32_bf16 v[220:223], a[248:251], a[108:111], v[220:223]
    ds_read_b128 a[244:247], v225 offset:40000
    v_cvt_pk_bf16_f32 v162, v156, v157
    v_mfma_f32_16x16x32_bf16 v[216:219], a[248:251], a[112:115], v[216:219]
    ds_read_b128 v[152:155], v230 offset:1920
    v_mfma_f32_16x16x32_bf16 v[212:215], a[248:251], a[116:119], v[212:215]
    v_exp_f32 v159, v159
    v_mfma_f32_16x16x32_bf16 v[220:223], a[252:255], a[120:123], v[220:223]
    ds_read_b128 a[248:251], v225 offset:40064
    v_cvt_pk_bf16_f32 v163, v158, v159
    v_mfma_f32_16x16x32_bf16 v[216:219], a[252:255], a[124:127], v[216:219]
    ds_read_b128 v[156:159], v234
    v_bfe_u32 v234, s64, v233, 4
    v_mfma_f32_16x16x32_bf16 v[196:199], a[216:219], v[160:163], v[196:199]
    s_waitcnt vmcnt(4) lgkmcnt(6)
    ds_read_b64_tr_b16 a[224:225], v109 offset:12288
    v_mad_u32_u24 v234, v234, s40, v231
    v_mfma_f32_16x16x32_bf16 v[184:187], v[78:81], v[160:163], v[184:187]
    s_barrier
    ds_read_b128 v[252:255], v224 offset:320
    v_mfma_f32_16x16x32_bf16 v[188:191], v[100:103], v[160:163], v[188:191]
    ds_read_b128 v[164:167], v224 offset:3264
    v_mfma_f32_16x16x32_bf16 v[192:195], v[122:125], v[160:163], v[192:195]
    ds_read_b128 v[168:171], v224 offset:3328
    v_mfma_f32_16x16x32_bf16 v[212:215], a[252:255], a[128:131], v[212:215]
    ds_read_b128 a[252:255], v225 offset:40128
    v_mfma_f32_16x16x32_bf16 v[220:223], a[220:223], a[132:135], v[220:223]
    s_waitcnt lgkmcnt(7)
    ds_read_b128 v[248:251], v224 offset:3392
    v_mfma_f32_16x16x32_bf16 v[152:155], v[36:39], v[138:141], v[152:155]
    v_rcp_f32 v197, v196
    v_mfma_f32_16x16x32_bf16 v[216:219], a[220:223], a[136:139], v[216:219]
    v_mul_f32 v184, v184, v197
    v_mul_f32 v185, v185, v197
    v_mfma_f32_16x16x32_bf16 v[212:215], a[220:223], a[140:143], v[212:215]
    ds_read_b128 a[220:223], v225 offset:40192
    v_cvt_pk_bf16_f32 v84, v220, v221
    v_mfma_f32_16x16x16_bf16 v[152:155], v[40:41], v[142:143], v[152:155]
    s_waitcnt lgkmcnt(7)
    v_cvt_pk_bf16_f32 v85, v222, v223
    v_cvt_pk_bf16_f32 v184, v184, v185
    v_mfma_f32_16x16x32_bf16 v[156:159], v[42:45], v[138:141], v[156:159]
    v_cvt_pk_bf16_f32 v106, v216, v217
    v_cvt_pk_bf16_f32 v107, v218, v219
    v_mfma_f32_16x16x32_bf16 v[208:211], a[144:147], a[236:239], 0
    v_cvt_pk_bf16_f32 v128, v212, v213
    v_cvt_pk_bf16_f32 v129, v214, v215
    v_mfma_f32_16x16x32_bf16 v[204:207], a[148:151], a[236:239], 0
    v_mul_f32 v186, v186, v197
    v_mul_f32 v187, v187, v197
    v_mfma_f32_16x16x16_bf16 v[156:159], v[46:47], v[142:143], v[156:159]
    v_cvt_pk_bf16_f32 v185, v186, v187
    v_mul_f32 v188, v188, v197
    v_mfma_f32_16x16x32_bf16 v[200:203], a[152:155], a[236:239], 0
    v_mul_f32 v189, v189, v197
    v_cvt_pk_bf16_f32 v186, v188, v189
    v_mfma_f32_16x16x32_bf16 v[208:211], a[156:159], a[240:243], v[208:211]
    v_mul_f32 v190, v190, v197
    v_mul_f32 v191, v191, v197
    v_mfma_f32_16x16x32_bf16 v[204:207], a[160:163], a[240:243], v[204:207]
    v_cvt_pk_bf16_f32 v187, v190, v191
    v_mul_f32 v192, v192, v197
    v_mfma_f32_16x16x32_bf16 v[200:203], a[164:167], a[240:243], v[200:203]
    v_mul_f32 v193, v193, v197
    v_cvt_pk_bf16_f32 v188, v192, v193
    v_mfma_f32_16x16x32_bf16 v[208:211], a[168:171], a[244:247], v[208:211]
    v_mul_f32 v194, v194, v197
    v_mul_f32 v195, v195, v197
    v_mfma_f32_16x16x32_bf16 v[204:207], a[172:175], a[244:247], v[204:207]
    v_cvt_pk_bf16_f32 v189, v194, v195
    v_max3_f32 v236, v236, v196, v197
    v_mfma_f32_16x16x32_bf16 v[200:203], a[176:179], a[244:247], v[200:203]
    ds_write_b128 v237, v[184:187]
    v_mfma_f32_16x16x32_bf16 v[208:211], a[180:183], a[248:251], v[208:211]
    ds_write_b64 v238, v[188:189]
    v_mfma_f32_16x16x32_bf16 v[204:207], a[184:187], a[248:251], v[204:207]
    v_exp_f32 v144, v144
    v_mfma_f32_16x16x32_bf16 v[200:203], a[188:191], a[248:251], v[200:203]
    s_waitcnt lgkmcnt(2)
    v_exp_f32 v145, v145
    v_mfma_f32_16x16x32_bf16 v[208:211], a[192:195], a[252:255], v[208:211]
    v_exp_f32 v146, v146
    v_mfma_f32_16x16x32_bf16 v[204:207], a[196:199], a[252:255], v[204:207]
    ds_read_b128 a[248:251], v224
    ds_read_b64_tr_b16 a[226:227], v109 offset:13824
    v_mfma_f32_16x16x32_bf16 v[200:203], a[200:203], a[252:255], v[200:203]
    ds_read_b128 a[252:255], v224 offset:64
    v_cvt_pk_bf16_f32 v160, v144, v145
    v_mfma_f32_16x16x32_bf16 v[208:211], a[204:207], a[220:223], v[208:211]
    ds_read_b64_tr_b16 a[228:229], v109 offset:12320
    ds_read_b64_tr_b16 a[230:231], v109 offset:13856
    v_mfma_f32_16x16x32_bf16 v[204:207], a[208:211], a[220:223], v[204:207]
    ds_read_b64_tr_b16 a[232:233], v109 offset:12352
    ds_read_b64_tr_b16 a[234:235], v109 offset:13888
    v_mfma_f32_16x16x32_bf16 v[200:203], a[212:215], a[220:223], v[200:203]
    s_waitcnt lgkmcnt(6)
    ds_read_b128 a[220:223], v241
    v_exp_f32 v147, v147
    v_mul_f32 v208, s37, v208
    v_mul_f32 v209, s37, v209
    v_mul_f32 v210, s37, v210
    v_mul_f32 v211, s37, v211
    v_cvt_pk_bf16_f32 v132, v208, v209
    v_cvt_pk_bf16_f32 v133, v210, v211
    v_mul_f32 v204, s37, v204
    v_mul_f32 v205, s37, v205
    v_mul_f32 v206, s37, v206
    v_mul_f32 v207, s37, v207
    v_cvt_pk_bf16_f32 v134, v204, v205
    v_cvt_pk_bf16_f32 v135, v206, v207
    v_mul_f32 v200, s37, v200
    v_mfma_f32_16x16x32_bf16 v[180:183], a[0:3], a[248:251], 0
    v_mul_f32 v201, s37, v201
    v_mul_f32 v202, s37, v202
    v_mfma_f32_16x16x32_bf16 v[176:179], a[4:7], a[248:251], 0
    v_mul_f32 v203, s37, v203
    v_cvt_pk_bf16_f32 v136, v200, v201
    v_mfma_f32_16x16x32_bf16 v[172:175], a[8:11], a[248:251], 0
    ds_read_b64_tr_b16 a[236:237], v109 offset:24576
    v_cvt_pk_bf16_f32 v137, v202, v203
    v_mfma_f32_16x16x32_bf16 v[220:223], a[248:251], a[72:75], 0
    s_waitcnt lgkmcnt(5)
    ds_write_b128 v130, a[224:227] offset:12288
    v_mfma_f32_16x16x32_bf16 v[216:219], a[248:251], a[76:79], 0
    s_waitcnt lgkmcnt(3)
    ds_write_b128 v130, a[228:231] offset:13312
    v_mfma_f32_16x16x32_bf16 v[212:215], a[248:251], a[80:83], 0
    ds_write_b128 v130, a[232:235] offset:14336
    v_mfma_f32_16x16x32_bf16 v[180:183], a[12:15], a[252:255], v[180:183]
    v_cvt_pk_bf16_f32 v161, v146, v147
    v_mfma_f32_16x16x32_bf16 v[176:179], a[16:19], a[252:255], v[176:179]
    v_exp_f32 v148, v148
    v_mfma_f32_16x16x32_bf16 v[172:175], a[20:23], a[252:255], v[172:175]
    v_exp_f32 v149, v149
    v_mfma_f32_16x16x32_bf16 v[220:223], a[252:255], a[84:87], v[220:223]
    v_exp_f32 v150, v150
    v_mfma_f32_16x16x32_bf16 v[216:219], a[252:255], a[88:91], v[216:219]
    v_exp_f32 v151, v151
    v_mfma_f32_16x16x32_bf16 v[212:215], a[252:255], a[92:95], v[212:215]
    v_cvt_pk_bf16_f32 v162, v148, v149
    v_cvt_pk_bf16_f32 v163, v150, v151
    v_exp_f32 v152, v152
    v_exp_f32 v153, v153
    v_mfma_f32_16x16x32_bf16 v[196:199], a[216:219], v[160:163], 0
    ds_read_b128 v[144:147], v235
    v_bfe_u32 v235, s65, v232, 4
    v_mfma_f32_16x16x32_bf16 v[184:187], v[68:71], v[160:163], 0
    ds_read_b128 v[148:151], v234
    v_mad_u32_u24 v234, v235, s40, v229
    v_mfma_f32_16x16x32_bf16 v[188:191], v[90:93], v[160:163], 0
    ds_read_b128 a[224:227], v241 offset:512
    v_mad_u32_u24 v235, v235, s40, v228
    v_mfma_f32_16x16x32_bf16 v[192:195], v[112:115], v[160:163], 0
    s_waitcnt lgkmcnt(2)
    ds_read_b128 a[228:231], v242
    v_exp_f32 v154, v154
    v_exp_f32 v155, v155
    ds_read_b128 a[232:235], v242 offset:512
    ds_read_b64_tr_b16 a[238:239], v109 offset:26112
    v_cvt_pk_bf16_f32 v160, v152, v153
    ds_read_b64_tr_b16 a[240:241], v109 offset:24608
    ds_read_b64_tr_b16 a[242:243], v109 offset:26144
    ds_read_b64_tr_b16 a[244:245], v109 offset:24640
    v_cvt_pk_bf16_f32 v161, v154, v155
    ds_read_b128 v[152:155], v234
    v_exp_f32 v156, v156
    v_exp_f32 v157, v157
    v_mfma_f32_16x16x32_bf16 v[144:147], v[48:51], v[138:141], v[144:147]
    s_waitcnt lgkmcnt(8)
    ds_read_b64_tr_b16 a[246:247], v109 offset:26176
    ds_read_b64_tr_b16 a[248:249], v109 offset:49152
    ds_read_b64_tr_b16 a[250:251], v109 offset:50688
    v_mfma_f32_16x16x32_bf16 v[148:151], v[54:57], v[138:141], v[148:151]
    ds_read_b64_tr_b16 a[252:253], v109 offset:49184
    ds_read_b64_tr_b16 a[254:255], v109 offset:50720
    v_mfma_f32_16x16x16_bf16 v[144:147], v[52:53], v[142:143], v[144:147]
    v_exp_f32 v158, v158
    v_exp_f32 v159, v159
    v_cvt_pk_bf16_f32 v162, v156, v157
    v_mfma_f32_16x16x16_bf16 v[148:151], v[58:59], v[142:143], v[148:151]
    v_cvt_pk_bf16_f32 v163, v158, v159
    ds_read_b128 v[156:159], v235
    v_bfe_u32 v235, s62, v232, 4
    v_mfma_f32_16x16x32_bf16 v[196:199], a[216:219], v[160:163], v[196:199]
    v_mad_u32_u24 v234, v235, s40, v228
    v_mad_u32_u24 v235, v235, s40, v229
    v_mfma_f32_16x16x32_bf16 v[184:187], v[76:79], v[160:163], v[184:187]
    s_waitcnt lgkmcnt(9)
    ds_write_b128 v130, a[236:239] offset:24576
    v_mfma_f32_16x16x32_bf16 v[188:191], v[98:101], v[160:163], v[188:191]
    s_waitcnt lgkmcnt(8)
    ds_write_b128 v130, a[240:243] offset:25600
    v_mfma_f32_16x16x32_bf16 v[192:195], v[120:123], v[160:163], v[192:195]
    s_waitcnt lgkmcnt(6)
    ds_write_b128 v130, a[244:247] offset:26624
    v_mfma_f32_16x16x32_bf16 v[152:155], v[30:33], v[132:135], v[152:155]
    s_waitcnt lgkmcnt(3)
    v_exp_f32 v144, v144
    v_exp_f32 v145, v145
    v_exp_f32 v146, v146
    v_mfma_f32_16x16x32_bf16 v[156:159], v[6:9], v[132:135], v[156:159]
    v_exp_f32 v147, v147
    v_cvt_pk_bf16_f32 v160, v144, v145
    v_mfma_f32_16x16x16_bf16 v[152:155], v[34:35], v[136:137], v[152:155]
    v_cvt_pk_bf16_f32 v161, v146, v147
    v_exp_f32 v148, v148
    v_exp_f32 v149, v149
    v_mfma_f32_16x16x16_bf16 v[156:159], v[10:11], v[136:137], v[156:159]
    v_exp_f32 v150, v150
    v_exp_f32 v151, v151
    v_cvt_pk_bf16_f32 v162, v148, v149
    v_cvt_pk_bf16_f32 v163, v150, v151
    ds_read_b128 a[236:239], v224 offset:128
    ds_read_b128 a[240:243], v224 offset:192
    v_mfma_f32_16x16x32_bf16 v[196:199], a[216:219], v[160:163], v[196:199]
    ds_read_b128 a[244:247], v224 offset:256
    v_mfma_f32_16x16x32_bf16 v[184:187], v[82:85], v[160:163], v[184:187]
    ds_read_b128 v[144:147], v228 offset:1280
    v_mfma_f32_16x16x32_bf16 v[188:191], v[104:107], v[160:163], v[188:191]
    v_exp_f32 v152, v152
    v_mfma_f32_16x16x32_bf16 v[192:195], v[126:129], v[160:163], v[192:195]
    s_waitcnt lgkmcnt(3)
    ds_read_b128 v[148:151], v229 offset:1280
    v_exp_f32 v153, v153
    v_rcp_f32 v197, v196
    v_exp_f32 v154, v154
    v_mul_f32 v184, v184, v197
    v_mul_f32 v185, v185, v197
    v_cvt_pk_bf16_f32 v184, v184, v185
    v_mul_f32 v186, v186, v197
    v_mul_f32 v187, v187, v197
    v_cvt_pk_bf16_f32 v185, v186, v187
    v_mul_f32 v188, v188, v197
    v_mul_f32 v189, v189, v197
    v_cvt_pk_bf16_f32 v186, v188, v189
    v_mfma_f32_16x16x32_bf16 v[180:183], a[24:27], a[236:239], v[180:183]
    v_mul_f32 v190, v190, v197
    v_mul_f32 v191, v191, v197
    v_mfma_f32_16x16x32_bf16 v[176:179], a[28:31], a[236:239], v[176:179]
    v_cvt_pk_bf16_f32 v187, v190, v191
    v_mul_f32 v192, v192, v197
    v_mfma_f32_16x16x32_bf16 v[172:175], a[32:35], a[236:239], v[172:175]
    v_mul_f32 v193, v193, v197
    v_cvt_pk_bf16_f32 v188, v192, v193
    v_mfma_f32_16x16x32_bf16 v[220:223], a[236:239], a[96:99], v[220:223]
    s_waitcnt lgkmcnt(1)
    v_mul_f32 v194, v194, v197
    v_mul_f32 v195, v195, v197
    v_mfma_f32_16x16x32_bf16 v[144:147], v[12:15], v[132:135], v[144:147]
    s_waitcnt lgkmcnt(0)
    v_cvt_pk_bf16_f32 v189, v194, v195
    v_max3_f32 v236, v236, v196, v197
    v_mfma_f32_16x16x32_bf16 v[148:151], v[36:39], v[132:135], v[148:151]
    ds_write_b128 v237, v[184:187] offset:6144
    v_mfma_f32_16x16x32_bf16 v[216:219], a[236:239], a[100:103], v[216:219]
    ds_write_b64 v238, v[188:189] offset:6144
    v_mfma_f32_16x16x16_bf16 v[144:147], v[16:17], v[136:137], v[144:147]
    v_exp_f32 v155, v155
    v_mfma_f32_16x16x32_bf16 v[212:215], a[236:239], a[104:107], v[212:215]
    v_cvt_pk_bf16_f32 v160, v152, v153
    v_cvt_pk_bf16_f32 v161, v154, v155
    v_mfma_f32_16x16x16_bf16 v[148:151], v[40:41], v[136:137], v[148:151]
    v_exp_f32 v156, v156
    v_mfma_f32_16x16x32_bf16 v[180:183], a[36:39], a[240:243], v[180:183]
    ds_read_b128 v[152:155], v229 offset:1920
    v_mfma_f32_16x16x32_bf16 v[176:179], a[40:43], a[240:243], v[176:179]
    ds_read_b64_tr_b16 a[236:237], v109 offset:49216
    ds_read_b64_tr_b16 a[238:239], v109 offset:50752
    v_mfma_f32_16x16x32_bf16 v[172:175], a[44:47], a[240:243], v[172:175]
    ds_write_b128 v130, a[248:251] offset:49152
    v_mfma_f32_16x16x32_bf16 v[220:223], a[240:243], a[108:111], v[220:223]
    ds_write_b128 v130, a[252:255] offset:50176
    v_mfma_f32_16x16x32_bf16 v[216:219], a[240:243], a[112:115], v[216:219]
    v_exp_f32 v157, v157
    v_mfma_f32_16x16x32_bf16 v[212:215], a[240:243], a[116:119], v[212:215]
    v_exp_f32 v158, v158
    v_mfma_f32_16x16x32_bf16 v[180:183], a[48:51], a[244:247], v[180:183]
    v_exp_f32 v159, v159
    v_mfma_f32_16x16x32_bf16 v[176:179], a[52:55], a[244:247], v[176:179]
    s_waitcnt lgkmcnt(4)
    v_cvt_pk_bf16_f32 v162, v156, v157
    v_cvt_pk_bf16_f32 v163, v158, v159
    v_mfma_f32_16x16x32_bf16 v[152:155], v[42:45], v[132:135], v[152:155]
    s_waitcnt lgkmcnt(2)
    ds_write_b128 v130, a[236:239] offset:51200
    v_mfma_f32_16x16x32_bf16 v[196:199], a[216:219], v[160:163], 0
    v_exp_f32 v144, v144
    v_mfma_f32_16x16x32_bf16 v[184:187], v[70:73], v[160:163], 0
    v_exp_f32 v145, v145
    v_mfma_f32_16x16x32_bf16 v[188:191], v[92:95], v[160:163], 0
    v_exp_f32 v146, v146
    v_mfma_f32_16x16x32_bf16 v[192:195], v[114:117], v[160:163], 0
    ds_read_b128 a[240:243], v224 offset:3072
    ds_read_b128 v[156:159], v228 offset:1920
    v_mfma_f32_16x16x16_bf16 v[152:155], v[46:47], v[136:137], v[152:155]
    v_exp_f32 v147, v147
    v_mfma_f32_16x16x32_bf16 v[172:175], a[56:59], a[244:247], v[172:175]
    ds_read_b64_tr_b16 a[248:249], v109 offset:61440
    ds_read_b64_tr_b16 a[250:251], v109 offset:62976
    v_mfma_f32_16x16x32_bf16 v[220:223], a[244:247], a[120:123], v[220:223]
    ds_read_b64_tr_b16 a[252:253], v109 offset:61472
    ds_read_b64_tr_b16 a[254:255], v109 offset:63008
    v_mfma_f32_16x16x32_bf16 v[216:219], a[244:247], a[124:127], v[216:219]
    ds_read_b64_tr_b16 a[236:237], v109 offset:61504
    ds_read_b64_tr_b16 a[238:239], v109 offset:63040
    v_mfma_f32_16x16x32_bf16 v[212:215], a[244:247], a[128:131], v[212:215]
    ds_read_b128 a[244:247], v224 offset:3136
    v_cvt_pk_bf16_f32 v160, v144, v145
    v_mfma_f32_16x16x32_bf16 v[180:183], a[60:63], v[252:255], v[180:183]
    v_cvt_pk_bf16_f32 v161, v146, v147
    v_mfma_f32_16x16x32_bf16 v[176:179], a[64:67], v[252:255], v[176:179]
    ds_read_b128 v[144:147], v234
    v_bfe_u32 v234, s65, v232, 4
    v_mfma_f32_16x16x32_bf16 v[172:175], a[68:71], v[252:255], v[172:175]
    v_mad_u32_u24 v234, v234, s40, v230
    v_mfma_f32_16x16x32_bf16 v[220:223], v[252:255], a[132:135], v[220:223]
    s_waitcnt lgkmcnt(8)
    v_exp_f32 v148, v148
    v_mfma_f32_16x16x32_bf16 v[156:159], v[18:21], v[132:135], v[156:159]
    v_cvt_pk_bf16_f32 v0, v180, v181
    v_cvt_pk_bf16_f32 v1, v182, v183
    v_mfma_f32_16x16x32_bf16 v[216:219], v[252:255], a[136:139], v[216:219]
    v_cvt_pk_bf16_f32 v2, v176, v177
    v_cvt_pk_bf16_f32 v3, v178, v179
    v_mfma_f32_16x16x32_bf16 v[212:215], v[252:255], a[140:143], v[212:215]
    v_cvt_pk_bf16_f32 v4, v172, v173
    v_cvt_pk_bf16_f32 v5, v174, v175
    v_mfma_f32_16x16x16_bf16 v[156:159], v[22:23], v[136:137], v[156:159]
    v_cvt_pk_bf16_f32 v66, v220, v221
    v_cvt_pk_bf16_f32 v67, v222, v223
    v_mfma_f32_16x16x32_bf16 v[208:211], a[0:3], a[240:243], 0
    v_cvt_pk_bf16_f32 v88, v216, v217
    v_cvt_pk_bf16_f32 v89, v218, v219
    v_mfma_f32_16x16x32_bf16 v[204:207], a[4:7], a[240:243], 0
    s_waitcnt lgkmcnt(0)
    v_cvt_pk_bf16_f32 v110, v212, v213
    v_cvt_pk_bf16_f32 v111, v214, v215
    v_mfma_f32_16x16x32_bf16 v[144:147], v[0:3], v[132:135], v[144:147]
L_pg3:
    s_cbranch_execz L_pg7
    ds_read_b128 v[252:255], v224 offset:3200
    v_mfma_f32_16x16x32_bf16 v[200:203], a[8:11], a[240:243], 0
    ds_write_b128 v130, a[248:251] offset:61440
    v_mfma_f32_16x16x32_bf16 v[180:183], a[240:243], a[72:75], 0
    ds_write_b128 v130, a[252:255] offset:62464
    v_mfma_f32_16x16x32_bf16 v[176:179], a[240:243], a[76:79], 0
    ds_write_b128 v130, a[236:239] offset:63488
    v_mfma_f32_16x16x16_bf16 v[144:147], v[4:5], v[136:137], v[144:147]
    v_exp_f32 v149, v149
    v_mfma_f32_16x16x32_bf16 v[172:175], a[240:243], a[80:83], 0
    v_exp_f32 v150, v150
    v_mfma_f32_16x16x32_bf16 v[208:211], a[12:15], a[244:247], v[208:211]
    v_exp_f32 v151, v151
    v_mfma_f32_16x16x32_bf16 v[204:207], a[16:19], a[244:247], v[204:207]
    v_cvt_pk_bf16_f32 v162, v148, v149
    v_cvt_pk_bf16_f32 v163, v150, v151
    v_mfma_f32_16x16x32_bf16 v[200:203], a[20:23], a[244:247], v[200:203]
    v_exp_f32 v152, v152
    v_mfma_f32_16x16x32_bf16 v[196:199], a[216:219], v[160:163], v[196:199]
    v_exp_f32 v153, v153
    v_mfma_f32_16x16x32_bf16 v[184:187], v[74:77], v[160:163], v[184:187]
    v_exp_f32 v154, v154
    v_mfma_f32_16x16x32_bf16 v[188:191], v[96:99], v[160:163], v[188:191]
    ds_read_b128 a[240:243], v225 offset:42944
    ds_read_b128 v[148:151], v235
    v_mfma_f32_16x16x32_bf16 v[192:195], v[118:121], v[160:163], v[192:195]
    v_bfe_u32 v235, s62, v232, 4
    v_mad_u32_u24 v235, v235, s40, v230
    v_mfma_f32_16x16x32_bf16 v[180:183], a[244:247], a[84:87], v[180:183]
    v_exp_f32 v155, v155
    v_mfma_f32_16x16x32_bf16 v[176:179], a[244:247], a[88:91], v[176:179]
    v_cvt_pk_bf16_f32 v160, v152, v153
    v_cvt_pk_bf16_f32 v161, v154, v155
    v_mfma_f32_16x16x32_bf16 v[172:175], a[244:247], a[92:95], v[172:175]
    s_waitcnt lgkmcnt(4)
    ds_read_b128 a[244:247], v225 offset:43008
    ds_read_b128 v[152:155], v235
    v_mfma_f32_16x16x32_bf16 v[208:211], a[24:27], v[252:255], v[208:211]
    v_bfe_u32 v235, s66, v233, 4
    v_mad_u32_u24 v235, v235, s40, v231
    v_mfma_f32_16x16x32_bf16 v[204:207], a[28:31], v[252:255], v[204:207]
    v_exp_f32 v156, v156
    v_mfma_f32_16x16x32_bf16 v[200:203], a[32:35], v[252:255], v[200:203]
    v_exp_f32 v157, v157
    v_mfma_f32_16x16x32_bf16 v[180:183], v[252:255], a[96:99], v[180:183]
    v_exp_f32 v158, v158
    v_mfma_f32_16x16x32_bf16 v[176:179], v[252:255], a[100:103], v[176:179]
    v_exp_f32 v159, v159
    v_mfma_f32_16x16x32_bf16 v[172:175], v[252:255], a[104:107], v[172:175]
    ds_read_b128 v[252:255], v225 offset:43072
    v_cvt_pk_bf16_f32 v162, v156, v157
    v_mfma_f32_16x16x32_bf16 v[208:211], a[36:39], v[164:167], v[208:211]
    v_cvt_pk_bf16_f32 v163, v158, v159
    v_mfma_f32_16x16x32_bf16 v[204:207], a[40:43], v[164:167], v[204:207]
    ds_read_b128 v[156:159], v234
    v_bfe_u32 v234, s67, v233, 4
    v_mfma_f32_16x16x32_bf16 v[196:199], a[216:219], v[160:163], v[196:199]
    v_mad_u32_u24 v234, v234, s40, v231
    v_mfma_f32_16x16x32_bf16 v[184:187], v[78:81], v[160:163], v[184:187]
    v_exp_f32 v144, v144
    v_mfma_f32_16x16x32_bf16 v[188:191], v[100:103], v[160:163], v[188:191]
    v_exp_f32 v145, v145
    v_mfma_f32_16x16x32_bf16 v[192:195], v[122:125], v[160:163], v[192:195]
    v_exp_f32 v146, v146
    v_mfma_f32_16x16x32_bf16 v[200:203], a[44:47], v[164:167], v[200:203]
    v_exp_f32 v147, v147
    v_mfma_f32_16x16x32_bf16 v[180:183], v[164:167], a[108:111], v[180:183]
    v_cvt_pk_bf16_f32 v160, v144, v145
    v_cvt_pk_bf16_f32 v161, v146, v147
    v_mfma_f32_16x16x32_bf16 v[176:179], v[164:167], a[112:115], v[176:179]
    ds_read_b128 v[144:147], v230 offset:1280
    v_mfma_f32_16x16x32_bf16 v[172:175], v[164:167], a[116:119], v[172:175]
    ds_read_b128 v[164:167], v225 offset:43136
    v_mfma_f32_16x16x32_bf16 v[208:211], a[48:51], v[168:171], v[208:211]
    v_mfma_f32_16x16x32_bf16 v[204:207], a[52:55], v[168:171], v[204:207]
    v_mfma_f32_16x16x32_bf16 v[200:203], a[56:59], v[168:171], v[200:203]
    v_mfma_f32_16x16x32_bf16 v[180:183], v[168:171], a[120:123], v[180:183]
    v_mfma_f32_16x16x32_bf16 v[176:179], v[168:171], a[124:127], v[176:179]
    v_mfma_f32_16x16x32_bf16 v[172:175], v[168:171], a[128:131], v[172:175]
    ds_read_b128 v[168:171], v225 offset:43200
    v_mfma_f32_16x16x32_bf16 v[208:211], a[60:63], v[248:251], v[208:211]
    v_mfma_f32_16x16x32_bf16 v[204:207], a[64:67], v[248:251], v[204:207]
    v_mfma_f32_16x16x32_bf16 v[200:203], a[68:71], v[248:251], v[200:203]
    v_mfma_f32_16x16x32_bf16 v[180:183], v[248:251], a[132:135], v[180:183]
    v_mfma_f32_16x16x32_bf16 v[176:179], v[248:251], a[136:139], v[176:179]
    v_mfma_f32_16x16x32_bf16 v[172:175], v[248:251], a[140:143], v[172:175]
    s_waitcnt lgkmcnt(1)
    ds_read_b128 v[248:251], v225 offset:43264
    v_mfma_f32_16x16x32_bf16 v[220:223], a[144:147], a[240:243], 0
    v_mfma_f32_16x16x32_bf16 v[216:219], a[148:151], a[240:243], 0
    v_cvt_pk_bf16_f32 v24, v208, v209
    v_cvt_pk_bf16_f32 v25, v210, v211
    v_mfma_f32_16x16x32_bf16 v[212:215], a[152:155], a[240:243], 0
    v_cvt_pk_bf16_f32 v26, v204, v205
    v_cvt_pk_bf16_f32 v27, v206, v207
    v_mfma_f32_16x16x32_bf16 v[220:223], a[156:159], a[244:247], v[220:223]
    v_cvt_pk_bf16_f32 v28, v200, v201
    v_cvt_pk_bf16_f32 v29, v202, v203
    v_mfma_f32_16x16x32_bf16 v[148:151], v[24:27], v[132:135], v[148:151]
    v_cvt_pk_bf16_f32 v68, v180, v181
    v_cvt_pk_bf16_f32 v69, v182, v183
    v_mfma_f32_16x16x32_bf16 v[216:219], a[160:163], a[244:247], v[216:219]
    v_cvt_pk_bf16_f32 v90, v176, v177
    v_cvt_pk_bf16_f32 v91, v178, v179
    v_mfma_f32_16x16x32_bf16 v[212:215], a[164:167], a[244:247], v[212:215]
    s_waitcnt vmcnt(0) lgkmcnt(0)
    v_cvt_pk_bf16_f32 v112, v172, v173
    v_cvt_pk_bf16_f32 v113, v174, v175
    v_mfma_f32_16x16x16_bf16 v[148:151], v[28:29], v[136:137], v[148:151]
    s_barrier
    ds_read_b128 a[248:251], v227 offset:6144
    v_mfma_f32_16x16x32_bf16 v[220:223], a[168:171], v[252:255], v[220:223]
    ds_read_b128 a[252:255], v227 offset:6208
    ds_read_b128 a[236:239], v227 offset:6272
    v_mfma_f32_16x16x32_bf16 v[216:219], a[172:175], v[252:255], v[216:219]
    buffer_load_dwordx4 v246, s[4:7], s56 offen lds
    v_mfma_f32_16x16x32_bf16 v[212:215], a[176:179], v[252:255], v[212:215]
    s_add_u32 m0, s42, 0x7900
    ds_read_b128 a[240:243], v227 offset:6336
    ds_read_b128 a[244:247], v239
    v_mfma_f32_16x16x32_bf16 v[220:223], a[180:183], v[164:167], v[220:223]
    v_exp_f32 v148, v148
    v_mfma_f32_16x16x32_bf16 v[216:219], a[184:187], v[164:167], v[216:219]
    ds_read_b128 v[252:255], v240
    v_mfma_f32_16x16x32_bf16 v[212:215], a[188:191], v[164:167], v[212:215]
    ds_read_b128 v[164:167], v239 offset:1024
    v_mfma_f32_16x16x32_bf16 v[220:223], a[192:195], v[168:171], v[220:223]
    v_exp_f32 v149, v149
    v_mfma_f32_16x16x32_bf16 v[216:219], a[196:199], v[168:171], v[216:219]
    v_exp_f32 v150, v150
    v_mfma_f32_16x16x32_bf16 v[212:215], a[200:203], v[168:171], v[212:215]
    ds_read_b128 v[168:171], v241 offset:12288
    v_cvt_pk_bf16_f32 v162, v148, v149
    v_mfma_f32_16x16x32_bf16 v[220:223], a[204:207], v[248:251], v[220:223]
    buffer_load_dwordx4 v247, s[4:7], s56 offen lds
    v_mfma_f32_16x16x32_bf16 v[216:219], a[208:211], v[248:251], v[216:219]
    s_add_u32 s56, s39, 0x222000
    v_exp_f32 v151, v151
    v_mfma_f32_16x16x32_bf16 v[212:215], a[212:215], v[248:251], v[212:215]
    s_add_u32 m0, s41, 0x9740
    ds_read_b128 v[248:251], v241 offset:12800
    v_cvt_pk_bf16_f32 v163, v150, v151
    s_waitcnt lgkmcnt(4)
    v_mfma_f32_16x16x32_bf16 v[208:211], a[220:223], a[244:247], 0
    v_mul_f32 v220, s37, v220
    v_mul_f32 v221, s37, v221
    v_mfma_f32_16x16x32_bf16 v[196:199], a[216:219], v[160:163], v[196:199]
    v_mul_f32 v222, s37, v222
    v_mul_f32 v223, s37, v223
    v_mfma_f32_16x16x32_bf16 v[184:187], v[66:69], v[160:163], v[184:187]
    v_cvt_pk_bf16_f32 v138, v220, v221
    v_cvt_pk_bf16_f32 v139, v222, v223
    v_mfma_f32_16x16x32_bf16 v[188:191], v[88:91], v[160:163], v[188:191]
    v_mul_f32 v216, s37, v216
    v_mul_f32 v217, s37, v217
    v_mfma_f32_16x16x32_bf16 v[192:195], v[110:113], v[160:163], v[192:195]
    v_mul_f32 v218, s37, v218
    v_mul_f32 v219, s37, v219
    v_mfma_f32_16x16x32_bf16 v[220:223], a[0:3], a[248:251], 0
    v_cvt_pk_bf16_f32 v140, v216, v217
    v_cvt_pk_bf16_f32 v141, v218, v219
    v_mfma_f32_16x16x32_bf16 v[216:219], a[4:7], a[248:251], 0
    v_mul_f32 v212, s37, v212
    v_mul_f32 v213, s37, v213
    v_mfma_f32_16x16x32_bf16 v[152:155], v[24:27], v[138:141], v[152:155]
    v_mul_f32 v214, s37, v214
    v_mul_f32 v215, s37, v215
    v_mfma_f32_16x16x32_bf16 v[156:159], v[30:33], v[138:141], v[156:159]
    v_cvt_pk_bf16_f32 v142, v212, v213
    v_cvt_pk_bf16_f32 v143, v214, v215
    v_mfma_f32_16x16x32_bf16 v[144:147], v[36:39], v[138:141], v[144:147]
    buffer_load_dwordx4 v246, s[4:7], s56 offen lds
    v_mfma_f32_16x16x16_bf16 v[152:155], v[28:29], v[142:143], v[152:155]
    s_add_u32 m0, s42, 0x9740
    v_rcp_f32 v197, v196
    v_mfma_f32_16x16x16_bf16 v[156:159], v[34:35], v[142:143], v[156:159]
    v_mul_f32 v184, v184, v197
    v_mul_f32 v185, v185, v197
    v_mfma_f32_16x16x16_bf16 v[144:147], v[40:41], v[142:143], v[144:147]
    v_cvt_pk_bf16_f32 v184, v184, v185
    v_mul_f32 v186, v186, v197
    v_mfma_f32_16x16x32_bf16 v[212:215], a[8:11], a[248:251], 0
    ds_read_b128 a[248:251], v227 offset:6400
    v_mul_f32 v187, v187, v197
    v_mfma_f32_16x16x32_bf16 v[220:223], a[12:15], a[252:255], v[220:223]
    v_cvt_pk_bf16_f32 v185, v186, v187
    v_mul_f32 v188, v188, v197
    v_mfma_f32_16x16x32_bf16 v[216:219], a[16:19], a[252:255], v[216:219]
    v_mul_f32 v189, v189, v197
    v_cvt_pk_bf16_f32 v186, v188, v189
    v_mfma_f32_16x16x32_bf16 v[212:215], a[20:23], a[252:255], v[212:215]
    ds_read_b128 a[252:255], v227 offset:6464
    v_mul_f32 v190, v190, v197
    v_mfma_f32_16x16x32_bf16 v[220:223], a[24:27], a[236:239], v[220:223]
    buffer_load_dwordx4 v247, s[4:7], s56 offen lds
    v_mfma_f32_16x16x32_bf16 v[216:219], a[28:31], a[236:239], v[216:219]
    s_add_u32 s56, s39, 0x24c000
    v_mul_f32 v191, v191, v197
    v_cvt_pk_bf16_f32 v187, v190, v191
    v_mfma_f32_16x16x32_bf16 v[212:215], a[32:35], a[236:239], v[212:215]
    s_add_u32 m0, s41, 0xb580
    ds_read_b128 a[236:239], v227 offset:6144
    v_mul_f32 v192, v192, v197
    v_mfma_f32_16x16x32_bf16 v[220:223], a[36:39], a[240:243], v[220:223]
    v_mul_f32 v193, v193, v197
    v_cvt_pk_bf16_f32 v188, v192, v193
    v_mfma_f32_16x16x32_bf16 v[216:219], a[40:43], a[240:243], v[216:219]
    v_mul_f32 v194, v194, v197
    v_mul_f32 v195, v195, v197
    v_mfma_f32_16x16x32_bf16 v[212:215], a[44:47], a[240:243], v[212:215]
    s_waitcnt lgkmcnt(2)
    ds_read_b128 a[240:243], v227 offset:6208
    v_cvt_pk_bf16_f32 v189, v194, v195
    v_mfma_f32_16x16x32_bf16 v[220:223], a[48:51], a[248:251], v[220:223]
    ds_read_b128 v[148:151], v230 offset:1920
    v_max3_f32 v236, v236, v196, v197
    v_mfma_f32_16x16x32_bf16 v[216:219], a[52:55], a[248:251], v[216:219]
    ds_write_b128 v237, v[184:187] offset:12288
    v_mfma_f32_16x16x32_bf16 v[212:215], a[56:59], a[248:251], v[212:215]
    s_waitcnt lgkmcnt(4)
    ds_write_b64 v238, v[188:189] offset:12288
    v_mfma_f32_16x16x32_bf16 v[220:223], a[60:63], a[252:255], v[220:223]
    v_exp_f32 v152, v152
    v_mfma_f32_16x16x32_bf16 v[216:219], a[64:67], a[252:255], v[216:219]
    v_exp_f32 v153, v153
    v_mfma_f32_16x16x32_bf16 v[212:215], a[68:71], a[252:255], v[212:215]
    v_exp_f32 v154, v154
    v_mfma_f32_16x16x32_bf16 v[200:203], a[220:223], v[252:255], 0
    ds_read_b128 a[248:251], v227 offset:6272
    ds_read_b128 a[252:255], v227 offset:6336
    v_mfma_f32_16x16x32_bf16 v[204:207], a[224:227], a[244:247], 0
    s_waitcnt lgkmcnt(4)
    v_cvt_pk_bf16_f32 v60, v220, v221
    v_cvt_pk_bf16_f32 v61, v222, v223
    v_mfma_f32_16x16x32_bf16 v[148:151], v[42:45], v[138:141], v[148:151]
    v_cvt_pk_bf16_f32 v62, v216, v217
    v_cvt_pk_bf16_f32 v63, v218, v219
    v_mfma_f32_16x16x32_bf16 v[180:183], a[224:227], v[252:255], 0
    v_cvt_pk_bf16_f32 v64, v212, v213
    v_cvt_pk_bf16_f32 v65, v214, v215
    v_mfma_f32_16x16x32_bf16 v[176:179], a[228:231], a[244:247], 0
    ds_read_b128 v[252:255], v239 offset:2048
    v_cvt_pk_bf16_f32 v160, v152, v153
    v_mfma_f32_16x16x16_bf16 v[148:151], v[46:47], v[142:143], v[148:151]
    v_exp_f32 v155, v155
    v_mfma_f32_16x16x32_bf16 v[172:175], a[232:235], a[244:247], 0
    ds_read_b128 a[244:247], v240 offset:1024
    v_cvt_pk_bf16_f32 v161, v154, v155
    v_mfma_f32_16x16x32_bf16 v[220:223], a[236:239], a[72:75], 0
    ds_read_b128 v[152:155], v235
    v_bfe_u32 v235, s68, v233, 4
    v_mfma_f32_16x16x32_bf16 v[216:219], a[236:239], a[76:79], 0
    v_mad_u32_u24 v235, v235, s40, v231
    v_mfma_f32_16x16x32_bf16 v[212:215], a[236:239], a[80:83], 0
    ds_read_b128 a[236:239], v227 offset:6400
    v_mfma_f32_16x16x32_bf16 v[220:223], a[240:243], a[84:87], v[220:223]
    v_exp_f32 v156, v156
    v_mfma_f32_16x16x32_bf16 v[216:219], a[240:243], a[88:91], v[216:219]
    v_exp_f32 v157, v157
    v_mfma_f32_16x16x32_bf16 v[212:215], a[240:243], a[92:95], v[212:215]
    s_waitcnt lgkmcnt(4)
    ds_read_b128 a[240:243], v227 offset:6464
    v_cvt_pk_bf16_f32 v162, v156, v157
    v_mfma_f32_16x16x32_bf16 v[220:223], a[248:251], a[96:99], v[220:223]
    v_exp_f32 v158, v158
    v_mfma_f32_16x16x32_bf16 v[216:219], a[248:251], a[100:103], v[216:219]
    v_exp_f32 v159, v159
    v_mfma_f32_16x16x32_bf16 v[212:215], a[248:251], a[104:107], v[212:215]
    s_waitcnt lgkmcnt(2)
    ds_read_b128 a[248:251], v226 offset:1152
    v_cvt_pk_bf16_f32 v163, v158, v159
    v_mfma_f32_16x16x32_bf16 v[152:155], v[48:51], v[138:141], v[152:155]
    ds_read_b128 v[156:159], v234
    v_bfe_u32 v234, s69, v233, 4
    v_mfma_f32_16x16x32_bf16 v[196:199], a[216:219], v[160:163], 0
    v_mad_u32_u24 v234, v234, s40, v231
    v_mfma_f32_16x16x32_bf16 v[184:187], v[68:71], v[160:163], 0
    v_exp_f32 v144, v144
    v_mfma_f32_16x16x32_bf16 v[188:191], v[90:93], v[160:163], 0
    v_exp_f32 v145, v145
    v_mfma_f32_16x16x32_bf16 v[192:195], v[112:115], v[160:163], 0
    v_exp_f32 v146, v146
    v_mfma_f32_16x16x16_bf16 v[152:155], v[52:53], v[142:143], v[152:155]
    v_exp_f32 v147, v147
    v_mfma_f32_16x16x32_bf16 v[220:223], a[252:255], a[108:111], v[220:223]
    v_cvt_pk_bf16_f32 v160, v144, v145
    v_cvt_pk_bf16_f32 v161, v146, v147
    v_mfma_f32_16x16x32_bf16 v[216:219], a[252:255], a[112:115], v[216:219]
    ds_read_b128 v[144:147], v235
    v_bfe_u32 v235, s70, v233, 4
    v_mfma_f32_16x16x32_bf16 v[212:215], a[252:255], a[116:119], v[212:215]
    s_waitcnt lgkmcnt(1)
    ds_read_b128 a[252:255], v226 offset:1216
    v_mad_u32_u24 v235, v235, s40, v231
    v_mfma_f32_16x16x32_bf16 v[156:159], v[54:57], v[138:141], v[156:159]
    v_exp_f32 v148, v148
    v_mfma_f32_16x16x32_bf16 v[220:223], a[236:239], a[120:123], v[220:223]
    v_exp_f32 v149, v149
    v_mfma_f32_16x16x32_bf16 v[216:219], a[236:239], a[124:127], v[216:219]
    v_exp_f32 v150, v150
    v_mfma_f32_16x16x32_bf16 v[212:215], a[236:239], a[128:131], v[212:215]
    ds_read_b128 a[236:239], v226 offset:1280
    v_cvt_pk_bf16_f32 v162, v148, v149
    v_mfma_f32_16x16x16_bf16 v[156:159], v[58:59], v[142:143], v[156:159]
    v_exp_f32 v151, v151
    v_mfma_f32_16x16x32_bf16 v[220:223], a[240:243], a[132:135], v[220:223]
    v_cvt_pk_bf16_f32 v163, v150, v151
    v_mfma_f32_16x16x32_bf16 v[216:219], a[240:243], a[136:139], v[216:219]
    ds_read_b128 v[148:151], v228 offset:640
    v_mfma_f32_16x16x32_bf16 v[196:199], a[216:219], v[160:163], v[196:199]
    v_exp_f32 v152, v152
    v_mfma_f32_16x16x32_bf16 v[184:187], v[76:79], v[160:163], v[184:187]
    v_exp_f32 v153, v153
    v_mfma_f32_16x16x32_bf16 v[188:191], v[98:101], v[160:163], v[188:191]
    v_cvt_pk_bf16_f32 v86, v220, v221
    v_cvt_pk_bf16_f32 v87, v222, v223
    v_mfma_f32_16x16x32_bf16 v[192:195], v[120:123], v[160:163], v[192:195]
    s_waitcnt lgkmcnt(2)
    v_cvt_pk_bf16_f32 v108, v216, v217
    v_cvt_pk_bf16_f32 v109, v218, v219
    v_mfma_f32_16x16x32_bf16 v[144:147], v[60:63], v[138:141], v[144:147]
    v_exp_f32 v154, v154
    v_mfma_f32_16x16x32_bf16 v[212:215], a[240:243], a[140:143], v[212:215]
    ds_read_b128 a[240:243], v226 offset:1344
    v_cvt_pk_bf16_f32 v160, v152, v153
    v_mfma_f32_16x16x32_bf16 v[220:223], a[144:147], a[248:251], 0
    v_exp_f32 v155, v155
    v_mfma_f32_16x16x16_bf16 v[144:147], v[64:65], v[142:143], v[144:147]
    v_cvt_pk_bf16_f32 v161, v154, v155
    v_mfma_f32_16x16x32_bf16 v[216:219], a[148:151], a[248:251], 0
    ds_read_b128 v[152:155], v229 offset:640
    v_cvt_pk_bf16_f32 v130, v212, v213
    v_mfma_f32_16x16x32_bf16 v[220:223], a[156:159], a[252:255], v[220:223]
    v_cvt_pk_bf16_f32 v131, v214, v215
    v_mfma_f32_16x16x32_bf16 v[212:215], a[152:155], a[248:251], 0
    ds_read_b128 a[248:251], v226 offset:1408
    v_mfma_f32_16x16x32_bf16 v[216:219], a[160:163], a[252:255], v[216:219]
    v_exp_f32 v156, v156
    v_mfma_f32_16x16x32_bf16 v[212:215], a[164:167], a[252:255], v[212:215]
    s_waitcnt lgkmcnt(3)
    ds_read_b128 a[252:255], v226 offset:1472
    v_mfma_f32_16x16x32_bf16 v[220:223], a[168:171], a[236:239], v[220:223]
    v_exp_f32 v157, v157
    v_mfma_f32_16x16x32_bf16 v[216:219], a[172:175], a[236:239], v[216:219]
    v_exp_f32 v158, v158
    v_mfma_f32_16x16x32_bf16 v[212:215], a[176:179], a[236:239], v[212:215]
    s_waitcnt lgkmcnt(3)
    ds_read_b128 a[236:239], v224 offset:15488
    v_cvt_pk_bf16_f32 v162, v156, v157
    v_mfma_f32_16x16x32_bf16 v[220:223], a[180:183], a[240:243], v[220:223]
    v_exp_f32 v159, v159
    v_mfma_f32_16x16x32_bf16 v[216:219], a[184:187], a[240:243], v[216:219]
    v_cvt_pk_bf16_f32 v163, v158, v159
    v_mfma_f32_16x16x32_bf16 v[212:215], a[188:191], a[240:243], v[212:215]
    ds_read_b128 a[240:243], v224 offset:15552
    ds_read_b128 v[156:159], v229 offset:1280
    v_mfma_f32_16x16x32_bf16 v[196:199], a[216:219], v[160:163], v[196:199]
    v_exp_f32 v144, v144
    v_mfma_f32_16x16x32_bf16 v[184:187], v[82:85], v[160:163], v[184:187]
    v_exp_f32 v145, v145
    v_mfma_f32_16x16x32_bf16 v[188:191], v[104:107], v[160:163], v[188:191]
    v_exp_f32 v146, v146
    v_mfma_f32_16x16x32_bf16 v[192:195], v[126:129], v[160:163], v[192:195]
    s_waitcnt lgkmcnt(3)
    v_exp_f32 v147, v147
    v_mfma_f32_16x16x32_bf16 v[220:223], a[192:195], a[248:251], v[220:223]
    v_cvt_pk_bf16_f32 v160, v144, v145
    v_cvt_pk_bf16_f32 v161, v146, v147
    v_mfma_f32_16x16x32_bf16 v[216:219], a[196:199], a[248:251], v[216:219]
    ds_read_b128 v[144:147], v228 offset:1280
    v_mfma_f32_16x16x16_bf16 v[196:199], a[216:217], v[160:161], v[196:199]
    v_mfma_f32_16x16x16_bf16 v[184:187], v[86:87], v[160:161], v[184:187]
    v_mfma_f32_16x16x16_bf16 v[188:191], v[108:109], v[160:161], v[188:191]
    v_mfma_f32_16x16x16_bf16 v[192:195], v[130:131], v[160:161], v[192:195]
    v_mfma_f32_16x16x32_bf16 v[212:215], a[200:203], a[248:251], v[212:215]
    ds_read_b128 a[248:251], v224 offset:15616
    v_mfma_f32_16x16x32_bf16 v[220:223], a[204:207], a[252:255], v[220:223]
    v_mfma_f32_16x16x32_bf16 v[216:219], a[208:211], a[252:255], v[216:219]
    v_mfma_f32_16x16x32_bf16 v[212:215], a[212:215], a[252:255], v[212:215]
    ds_read_b128 a[252:255], v224 offset:15680
    v_mfma_f32_16x16x32_bf16 v[208:211], v[168:171], v[164:167], v[208:211]
    v_rcp_f32 v197, v196
    v_mfma_f32_16x16x32_bf16 v[200:203], v[168:171], a[244:247], v[200:203]
    v_mul_f32 v184, v184, v197
    v_mul_f32 v185, v185, v197
    v_mfma_f32_16x16x32_bf16 v[204:207], v[248:251], v[164:167], v[204:207]
    v_mul_f32 v220, s37, v220
    v_mul_f32 v221, s37, v221
    v_mfma_f32_16x16x32_bf16 v[180:183], v[248:251], a[244:247], v[180:183]
    s_waitcnt lgkmcnt(2)
    v_mul_f32 v222, s37, v222
    v_mul_f32 v223, s37, v223
    v_cvt_pk_bf16_f32 v132, v220, v221
    v_cvt_pk_bf16_f32 v133, v222, v223
    v_mfma_f32_16x16x32_bf16 v[220:223], a[0:3], a[236:239], 0
    v_mul_f32 v216, s37, v216
    v_mul_f32 v217, s37, v217
    v_mfma_f32_16x16x32_bf16 v[220:223], a[12:15], a[240:243], v[220:223]
    s_waitcnt lgkmcnt(1)
    v_mul_f32 v218, s37, v218
    v_mul_f32 v219, s37, v219
    v_mfma_f32_16x16x32_bf16 v[220:223], a[24:27], a[248:251], v[220:223]
    v_cvt_pk_bf16_f32 v134, v216, v217
    v_cvt_pk_bf16_f32 v135, v218, v219
    v_mfma_f32_16x16x32_bf16 v[216:219], a[4:7], a[236:239], 0
    v_mul_f32 v212, s37, v212
    v_mul_f32 v213, s37, v213
    v_mfma_f32_16x16x32_bf16 v[148:151], v[12:15], v[132:135], v[148:151]
    v_mul_f32 v214, s37, v214
    v_mul_f32 v215, s37, v215
    v_mfma_f32_16x16x32_bf16 v[152:155], v[36:39], v[132:135], v[152:155]
    v_cvt_pk_bf16_f32 v136, v212, v213
    v_cvt_pk_bf16_f32 v137, v214, v215
    v_mfma_f32_16x16x32_bf16 v[156:159], v[42:45], v[132:135], v[156:159]
    v_cvt_pk_bf16_f32 v184, v184, v185
    v_mul_f32 v186, v186, v197
    v_mfma_f32_16x16x16_bf16 v[148:151], v[16:17], v[136:137], v[148:151]
    v_mul_f32 v187, v187, v197
    v_cvt_pk_bf16_f32 v185, v186, v187
    v_mfma_f32_16x16x16_bf16 v[152:155], v[40:41], v[136:137], v[152:155]
    v_mul_f32 v188, v188, v197
    v_mul_f32 v189, v189, v197
    v_mfma_f32_16x16x16_bf16 v[156:159], v[46:47], v[136:137], v[156:159]
    v_cvt_pk_bf16_f32 v186, v188, v189
    v_mul_f32 v190, v190, v197
    v_mfma_f32_16x16x32_bf16 v[144:147], v[18:21], v[132:135], v[144:147]
    v_mul_f32 v191, v191, v197
    v_cvt_pk_bf16_f32 v187, v190, v191
    v_mfma_f32_16x16x32_bf16 v[212:215], a[8:11], a[236:239], 0
    ds_read_b128 a[236:239], v224 offset:15744
    v_mul_f32 v192, v192, v197
    v_mfma_f32_16x16x32_bf16 v[216:219], a[16:19], a[240:243], v[216:219]
    v_mul_f32 v193, v193, v197
    v_cvt_pk_bf16_f32 v188, v192, v193
    v_mfma_f32_16x16x16_bf16 v[144:147], v[22:23], v[136:137], v[144:147]
    v_mul_f32 v194, v194, v197
    v_mul_f32 v195, v195, v197
    v_mfma_f32_16x16x32_bf16 v[212:215], a[20:23], a[240:243], v[212:215]
    ds_read_b128 a[240:243], v224 offset:15808
    v_cvt_pk_bf16_f32 v189, v194, v195
    v_mfma_f32_16x16x32_bf16 v[216:219], a[28:31], a[248:251], v[216:219]
    ds_read_b128 v[168:171], v242 offset:12288
    v_max3_f32 v236, v236, v196, v197
    v_mfma_f32_16x16x32_bf16 v[212:215], a[32:35], a[248:251], v[212:215]
    s_waitcnt lgkmcnt(3)
    ds_read_b128 a[248:251], v224 offset:15488
    ds_read_b128 v[248:251], v242 offset:12800
    v_mfma_f32_16x16x32_bf16 v[220:223], a[36:39], a[252:255], v[220:223]
    ds_write_b128 v237, v[184:187] offset:18432
    v_mfma_f32_16x16x32_bf16 v[216:219], a[40:43], a[252:255], v[216:219]
    ds_write_b64 v238, v[188:189] offset:18432
    v_mfma_f32_16x16x32_bf16 v[212:215], a[44:47], a[252:255], v[212:215]
    s_waitcnt lgkmcnt(6)
    v_exp_f32 v148, v148
    v_mfma_f32_16x16x32_bf16 v[220:223], a[48:51], a[236:239], v[220:223]
    v_exp_f32 v149, v149
    v_mfma_f32_16x16x32_bf16 v[216:219], a[52:55], a[236:239], v[216:219]
    v_exp_f32 v150, v150
    v_mfma_f32_16x16x32_bf16 v[212:215], a[56:59], a[236:239], v[212:215]
    s_waitcnt lgkmcnt(4)
    ds_read_b128 a[252:255], v224 offset:15552
    ds_read_b128 a[236:239], v224 offset:15616
    v_mfma_f32_16x16x32_bf16 v[176:179], v[168:171], v[164:167], v[176:179]
    ds_read_b128 v[168:171], v241 offset:24576
    v_cvt_pk_bf16_f32 v160, v148, v149
    v_mfma_f32_16x16x32_bf16 v[220:223], a[60:63], a[240:243], v[220:223]
    s_waitcnt lgkmcnt(5)
    ds_read_b128 a[244:247], v239 offset:3072
    v_mfma_f32_16x16x32_bf16 v[172:175], v[248:251], v[164:167], v[172:175]
    ds_read_b128 v[164:167], v240 offset:2048
    v_mfma_f32_16x16x32_bf16 v[216:219], a[64:67], a[240:243], v[216:219]
    ds_read_b128 v[248:251], v241 offset:25088
    v_mfma_f32_16x16x32_bf16 v[212:215], a[68:71], a[240:243], v[212:215]
    ds_read_b128 a[240:243], v224 offset:15680
    v_exp_f32 v151, v151
    v_cvt_pk_bf16_f32 v6, v220, v221
    v_cvt_pk_bf16_f32 v7, v222, v223
    v_mfma_f32_16x16x32_bf16 v[220:223], a[248:251], a[72:75], 0
    v_cvt_pk_bf16_f32 v161, v150, v151
    v_cvt_pk_bf16_f32 v8, v216, v217
    v_cvt_pk_bf16_f32 v9, v218, v219
    v_mfma_f32_16x16x32_bf16 v[216:219], a[248:251], a[76:79], 0
    v_cvt_pk_bf16_f32 v10, v212, v213
    v_cvt_pk_bf16_f32 v11, v214, v215
    v_mfma_f32_16x16x32_bf16 v[212:215], a[248:251], a[80:83], 0
    s_waitcnt lgkmcnt(6)
    ds_read_b128 a[248:251], v224 offset:15744
    ds_read_b128 v[148:151], v228 offset:1920
    v_mfma_f32_16x16x32_bf16 v[220:223], a[252:255], a[84:87], v[220:223]
    s_waitcnt lgkmcnt(6)
    v_exp_f32 v152, v152
    v_mfma_f32_16x16x32_bf16 v[208:211], v[168:171], v[252:255], v[208:211]
    v_exp_f32 v153, v153
    v_mfma_f32_16x16x32_bf16 v[216:219], a[252:255], a[88:91], v[216:219]
    s_waitcnt lgkmcnt(4)
    v_exp_f32 v154, v154
    v_mfma_f32_16x16x32_bf16 v[200:203], v[168:171], v[164:167], v[200:203]
    s_waitcnt lgkmcnt(3)
    ds_read_b128 v[168:171], v242 offset:24576
    v_cvt_pk_bf16_f32 v162, v152, v153
    v_mfma_f32_16x16x32_bf16 v[204:207], v[248:251], v[252:255], v[204:207]
    v_exp_f32 v155, v155
    v_mfma_f32_16x16x32_bf16 v[180:183], v[248:251], v[164:167], v[180:183]
    ds_read_b128 v[248:251], v242 offset:25088
    ds_read_b128 v[164:167], v239 offset:4096
    v_mfma_f32_16x16x32_bf16 v[212:215], a[252:255], a[92:95], v[212:215]
    ds_read_b128 a[252:255], v224 offset:15808
    v_cvt_pk_bf16_f32 v163, v154, v155
    v_mfma_f32_16x16x32_bf16 v[220:223], a[236:239], a[96:99], v[220:223]
    ds_read_b128 v[152:155], v229 offset:1920
    v_mfma_f32_16x16x32_bf16 v[196:199], a[216:219], v[160:163], 0
    v_exp_f32 v156, v156
    v_mfma_f32_16x16x32_bf16 v[184:187], v[74:77], v[160:163], 0
    v_exp_f32 v157, v157
    v_mfma_f32_16x16x32_bf16 v[188:191], v[96:99], v[160:163], 0
    v_exp_f32 v158, v158
    v_mfma_f32_16x16x32_bf16 v[192:195], v[118:121], v[160:163], 0
    s_waitcnt lgkmcnt(5)
    v_exp_f32 v159, v159
    v_mfma_f32_16x16x32_bf16 v[148:151], v[0:3], v[132:135], v[148:151]
    s_waitcnt lgkmcnt(4)
    v_cvt_pk_bf16_f32 v160, v156, v157
    v_cvt_pk_bf16_f32 v161, v158, v159
    v_mfma_f32_16x16x32_bf16 v[176:179], v[168:171], v[252:255], v[176:179]
    s_waitcnt lgkmcnt(3)
    ds_read_b128 v[168:171], v241 offset:36864
    ds_read_b128 v[156:159], v229 offset:2560
    v_mfma_f32_16x16x32_bf16 v[172:175], v[248:251], v[252:255], v[172:175]
    v_exp_f32 v144, v144
    v_mfma_f32_16x16x16_bf16 v[148:151], v[4:5], v[136:137], v[148:151]
    ds_read_b128 v[252:255], v240 offset:3072
    v_mfma_f32_16x16x32_bf16 v[216:219], a[236:239], a[100:103], v[216:219]
    s_waitcnt lgkmcnt(3)
    ds_read_b128 v[248:251], v241 offset:37376
    v_mfma_f32_16x16x32_bf16 v[152:155], v[24:27], v[132:135], v[152:155]
    v_exp_f32 v145, v145
    v_mfma_f32_16x16x32_bf16 v[212:215], a[236:239], a[104:107], v[212:215]
    ds_read_b128 a[236:239], v224 offset:18560
    v_cvt_pk_bf16_f32 v162, v144, v145
    v_mfma_f32_16x16x32_bf16 v[220:223], a[240:243], a[108:111], v[220:223]
    v_exp_f32 v146, v146
    v_mfma_f32_16x16x16_bf16 v[152:155], v[28:29], v[136:137], v[152:155]
    v_exp_f32 v147, v147
    v_mfma_f32_16x16x32_bf16 v[216:219], a[240:243], a[112:115], v[216:219]
    v_cvt_pk_bf16_f32 v163, v146, v147
    v_mfma_f32_16x16x32_bf16 v[212:215], a[240:243], a[116:119], v[212:215]
    ds_read_b128 a[240:243], v224 offset:18624
    ds_read_b128 v[144:147], v228 offset:2560
    v_mfma_f32_16x16x32_bf16 v[196:199], a[216:219], v[160:163], v[196:199]
    v_exp_f32 v148, v148
    v_mfma_f32_16x16x32_bf16 v[184:187], v[78:81], v[160:163], v[184:187]
    v_exp_f32 v149, v149
    v_mfma_f32_16x16x32_bf16 v[188:191], v[100:103], v[160:163], v[188:191]
    v_exp_f32 v150, v150
    v_mfma_f32_16x16x32_bf16 v[192:195], v[122:125], v[160:163], v[192:195]
    v_exp_f32 v151, v151
    v_mfma_f32_16x16x32_bf16 v[220:223], a[248:251], a[120:123], v[220:223]
    v_cvt_pk_bf16_f32 v160, v148, v149
    v_cvt_pk_bf16_f32 v161, v150, v151
    v_mfma_f32_16x16x32_bf16 v[216:219], a[248:251], a[124:127], v[216:219]
    ds_read_b128 v[148:151], v230 offset:640
    v_mfma_f32_16x16x32_bf16 v[212:215], a[248:251], a[128:131], v[212:215]
    ds_read_b128 a[248:251], v224 offset:18688
    v_mfma_f32_16x16x32_bf16 v[220:223], a[252:255], a[132:135], v[220:223]
    v_exp_f32 v152, v152
    v_mfma_f32_16x16x32_bf16 v[216:219], a[252:255], a[136:139], v[216:219]
    s_waitcnt lgkmcnt(2)
    v_exp_f32 v153, v153
    v_mfma_f32_16x16x32_bf16 v[144:147], v[6:9], v[132:135], v[144:147]
    v_exp_f32 v154, v154
    v_mfma_f32_16x16x32_bf16 v[212:215], a[252:255], a[140:143], v[212:215]
    ds_read_b128 a[252:255], v224 offset:18752
    v_cvt_pk_bf16_f32 v162, v152, v153
    v_mfma_f32_16x16x32_bf16 v[208:211], v[168:171], a[244:247], v[208:211]
    v_cvt_pk_bf16_f32 v72, v220, v221
    v_cvt_pk_bf16_f32 v73, v222, v223
    v_mfma_f32_16x16x16_bf16 v[144:147], v[10:11], v[136:137], v[144:147]
    v_cvt_pk_bf16_f32 v94, v216, v217
    v_cvt_pk_bf16_f32 v95, v218, v219
    v_mfma_f32_16x16x32_bf16 v[200:203], v[168:171], v[252:255], v[200:203]
    v_cvt_pk_bf16_f32 v116, v212, v213
    v_cvt_pk_bf16_f32 v117, v214, v215
    v_mfma_f32_16x16x32_bf16 v[204:207], v[248:251], a[244:247], v[204:207]
    ds_read_b128 v[168:171], v242 offset:36864
    v_mfma_f32_16x16x32_bf16 v[180:183], v[248:251], v[252:255], v[180:183]
L_pg4:
    s_cbranch_execz L_pg8
    ds_read_b128 v[248:251], v242 offset:37376
    ds_read_b128 v[252:255], v239 offset:5120
    v_mfma_f32_16x16x32_bf16 v[220:223], a[0:3], a[236:239], 0
    v_exp_f32 v155, v155
    v_mfma_f32_16x16x32_bf16 v[216:219], a[4:7], a[236:239], 0
    v_cvt_pk_bf16_f32 v163, v154, v155
    v_mfma_f32_16x16x32_bf16 v[212:215], a[8:11], a[236:239], 0
    ds_read_b128 a[236:239], v224 offset:18816
    ds_read_b128 v[152:155], v230 offset:1280
    v_mfma_f32_16x16x32_bf16 v[196:199], a[216:219], v[160:163], v[196:199]
    v_exp_f32 v144, v144
    v_mfma_f32_16x16x32_bf16 v[184:187], v[66:69], v[160:163], v[184:187]
    v_exp_f32 v145, v145
    v_mfma_f32_16x16x32_bf16 v[188:191], v[88:91], v[160:163], v[188:191]
    v_exp_f32 v146, v146
    v_mfma_f32_16x16x32_bf16 v[192:195], v[110:113], v[160:163], v[192:195]
    s_waitcnt lgkmcnt(4)
    v_exp_f32 v147, v147
    v_mfma_f32_16x16x32_bf16 v[176:179], v[168:171], a[244:247], v[176:179]
    s_waitcnt lgkmcnt(3)
    ds_read_b128 v[168:171], v241 offset:49152
    v_cvt_pk_bf16_f32 v162, v144, v145
    v_mfma_f32_16x16x32_bf16 v[172:175], v[248:251], a[244:247], v[172:175]
    ds_read_b128 a[244:247], v240 offset:4096
    ds_read_b128 v[248:251], v241 offset:49664
    v_mfma_f32_16x16x32_bf16 v[220:223], a[12:15], a[240:243], v[220:223]
    v_cvt_pk_bf16_f32 v163, v146, v147
    v_mfma_f32_16x16x32_bf16 v[216:219], a[16:19], a[240:243], v[216:219]
    ds_read_b128 v[144:147], v230 offset:2560
    v_mfma_f32_16x16x32_bf16 v[212:215], a[20:23], a[240:243], v[212:215]
    ds_read_b128 a[240:243], v224 offset:18880
    v_mfma_f32_16x16x32_bf16 v[220:223], a[24:27], a[248:251], v[220:223]
    v_mfma_f32_16x16x32_bf16 v[216:219], a[28:31], a[248:251], v[216:219]
    v_mfma_f32_16x16x32_bf16 v[212:215], a[32:35], a[248:251], v[212:215]
    ds_read_b128 a[248:251], v224 offset:18560
    v_mfma_f32_16x16x32_bf16 v[220:223], a[36:39], a[252:255], v[220:223]
    v_mfma_f32_16x16x32_bf16 v[216:219], a[40:43], a[252:255], v[216:219]
    v_mfma_f32_16x16x32_bf16 v[212:215], a[44:47], a[252:255], v[212:215]
    s_waitcnt lgkmcnt(5)
    ds_read_b128 a[252:255], v224 offset:18624
    v_mfma_f32_16x16x32_bf16 v[220:223], a[48:51], a[236:239], v[220:223]
    v_mfma_f32_16x16x32_bf16 v[216:219], a[52:55], a[236:239], v[216:219]
    v_mfma_f32_16x16x32_bf16 v[212:215], a[56:59], a[236:239], v[212:215]
    s_waitcnt lgkmcnt(2)
    ds_read_b128 a[236:239], v224 offset:18688
    v_mfma_f32_16x16x32_bf16 v[220:223], a[60:63], a[240:243], v[220:223]
    v_mfma_f32_16x16x32_bf16 v[216:219], a[64:67], a[240:243], v[216:219]
    v_mfma_f32_16x16x32_bf16 v[212:215], a[68:71], a[240:243], v[212:215]
    ds_read_b128 a[240:243], v224 offset:18752
    v_mfma_f32_16x16x32_bf16 v[208:211], v[168:171], v[164:167], v[208:211]
    v_mfma_f32_16x16x32_bf16 v[200:203], v[168:171], a[244:247], v[200:203]
    ds_read_b128 v[168:171], v242 offset:49152
    v_mfma_f32_16x16x32_bf16 v[204:207], v[248:251], v[164:167], v[204:207]
    v_mfma_f32_16x16x32_bf16 v[180:183], v[248:251], a[244:247], v[180:183]
    s_waitcnt lgkmcnt(3)
    v_cvt_pk_bf16_f32 v30, v220, v221
    v_cvt_pk_bf16_f32 v31, v222, v223
    v_mfma_f32_16x16x32_bf16 v[220:223], a[248:251], a[72:75], 0
    v_cvt_pk_bf16_f32 v32, v216, v217
    v_cvt_pk_bf16_f32 v33, v218, v219
    v_mfma_f32_16x16x32_bf16 v[216:219], a[248:251], a[76:79], 0
    v_cvt_pk_bf16_f32 v34, v212, v213
    v_cvt_pk_bf16_f32 v35, v214, v215
    v_mfma_f32_16x16x32_bf16 v[156:159], v[30:33], v[132:135], v[156:159]
    ds_read_b128 v[248:251], v242 offset:49664
    v_mfma_f32_16x16x32_bf16 v[212:215], a[248:251], a[80:83], 0
    ds_read_b128 a[248:251], v224 offset:18816
    v_mfma_f32_16x16x32_bf16 v[220:223], a[252:255], a[84:87], v[220:223]
    v_mfma_f32_16x16x32_bf16 v[216:219], a[252:255], a[88:91], v[216:219]
    s_waitcnt lgkmcnt(2)
    v_mfma_f32_16x16x32_bf16 v[176:179], v[168:171], v[164:167], v[176:179]
    ds_read_b128 v[168:171], v241 offset:61440
    v_mfma_f32_16x16x16_bf16 v[156:159], v[34:35], v[136:137], v[156:159]
    v_mfma_f32_16x16x32_bf16 v[212:215], a[252:255], a[92:95], v[212:215]
    ds_read_b128 a[252:255], v224 offset:18880
    v_mfma_f32_16x16x32_bf16 v[220:223], a[236:239], a[96:99], v[220:223]
    v_mfma_f32_16x16x32_bf16 v[216:219], a[236:239], a[100:103], v[216:219]
    s_waitcnt lgkmcnt(3)
    v_mfma_f32_16x16x32_bf16 v[172:175], v[248:251], v[164:167], v[172:175]
    ds_read_b128 v[164:167], v240 offset:5120
    ds_read_b128 v[248:251], v241 offset:61952
    v_mfma_f32_16x16x32_bf16 v[212:215], a[236:239], a[104:107], v[212:215]
    ds_read_b128 a[236:239], v226 offset:4224
    v_mfma_f32_16x16x32_bf16 v[220:223], a[240:243], a[108:111], v[220:223]
    v_exp_f32 v156, v156
    v_mfma_f32_16x16x32_bf16 v[216:219], a[240:243], a[112:115], v[216:219]
    v_exp_f32 v157, v157
    v_mfma_f32_16x16x32_bf16 v[212:215], a[240:243], a[116:119], v[212:215]
    s_waitcnt lgkmcnt(5)
    ds_read_b128 a[240:243], v226 offset:4288
    v_cvt_pk_bf16_f32 v160, v156, v157
    v_mfma_f32_16x16x32_bf16 v[220:223], a[248:251], a[120:123], v[220:223]
    v_exp_f32 v158, v158
    v_mfma_f32_16x16x32_bf16 v[216:219], a[248:251], a[124:127], v[216:219]
    v_exp_f32 v159, v159
    v_mfma_f32_16x16x32_bf16 v[212:215], a[248:251], a[128:131], v[212:215]
    s_waitcnt lgkmcnt(4)
    ds_read_b128 a[248:251], v226 offset:4352
    v_cvt_pk_bf16_f32 v161, v158, v159
    v_mfma_f32_16x16x32_bf16 v[220:223], a[252:255], a[132:135], v[220:223]
    ds_read_b128 v[156:159], v230 offset:1920
    v_mfma_f32_16x16x32_bf16 v[196:199], a[216:219], v[160:163], v[196:199]
    v_mfma_f32_16x16x32_bf16 v[216:219], a[252:255], a[136:139], v[216:219]
    v_mfma_f32_16x16x32_bf16 v[212:215], a[252:255], a[140:143], v[212:215]
    ds_read_b128 a[252:255], v226 offset:4416
    v_mfma_f32_16x16x32_bf16 v[208:211], v[168:171], v[252:255], v[208:211]
    s_waitcnt lgkmcnt(4)
    v_mfma_f32_16x16x32_bf16 v[200:203], v[168:171], v[164:167], v[200:203]
    ds_read_b128 v[168:171], v242 offset:61440
    v_cvt_pk_bf16_f32 v70, v220, v221
    v_mfma_f32_16x16x32_bf16 v[204:207], v[248:251], v[252:255], v[204:207]
    v_cvt_pk_bf16_f32 v71, v222, v223
    v_cvt_pk_bf16_f32 v92, v216, v217
    v_mfma_f32_16x16x32_bf16 v[180:183], v[248:251], v[164:167], v[180:183]
    v_cvt_pk_bf16_f32 v93, v218, v219
    v_cvt_pk_bf16_f32 v114, v212, v213
    v_mfma_f32_16x16x32_bf16 v[184:187], v[70:73], v[160:163], v[184:187]
    ds_read_b128 v[248:251], v242 offset:61952
    v_cvt_pk_bf16_f32 v115, v214, v215
    v_mfma_f32_16x16x32_bf16 v[188:191], v[92:95], v[160:163], v[188:191]
    v_cvt_pk_bf16_f32 v208, v208, v209
    v_cvt_pk_bf16_f32 v209, v210, v211
    v_mfma_f32_16x16x32_bf16 v[192:195], v[114:117], v[160:163], v[192:195]
    v_cvt_pk_bf16_f32 v210, v204, v205
    v_cvt_pk_bf16_f32 v211, v206, v207
    v_mfma_f32_16x16x32_bf16 v[220:223], a[144:147], a[236:239], 0
    buffer_store_dwordx4 v[208:211], v243, s[20:23], s58 offen sc0 sc1
    v_mfma_f32_16x16x32_bf16 v[216:219], a[148:151], a[236:239], 0
    s_waitcnt lgkmcnt(1)
    v_cvt_pk_bf16_f32 v200, v200, v201
    v_cvt_pk_bf16_f32 v201, v202, v203
    v_mfma_f32_16x16x32_bf16 v[176:179], v[168:171], v[252:255], v[176:179]
    v_cvt_pk_bf16_f32 v202, v180, v181
    v_cvt_pk_bf16_f32 v203, v182, v183
    v_mfma_f32_16x16x32_bf16 v[212:215], a[152:155], a[236:239], 0
    ds_read_b128 a[236:239], v226 offset:4480
    ds_read_b128 v[168:171], v241 offset:12288
    v_mfma_f32_16x16x32_bf16 v[220:223], a[156:159], a[240:243], v[220:223]
    s_waitcnt lgkmcnt(2)
    v_rcp_f32 v197, v196
    v_mfma_f32_16x16x32_bf16 v[172:175], v[248:251], v[252:255], v[172:175]
    v_cvt_pk_bf16_f32 v176, v176, v177
    v_cvt_pk_bf16_f32 v177, v178, v179
    v_mfma_f32_16x16x32_bf16 v[216:219], a[160:163], a[240:243], v[216:219]
    v_mul_f32 v184, v184, v197
    v_mul_f32 v185, v185, v197
    v_mfma_f32_16x16x32_bf16 v[212:215], a[164:167], a[240:243], v[212:215]
    ds_read_b128 a[240:243], v226 offset:4544
    v_cvt_pk_bf16_f32 v184, v184, v185
    v_mfma_f32_16x16x32_bf16 v[220:223], a[168:171], a[248:251], v[220:223]
    v_cvt_pk_bf16_f32 v178, v172, v173
    v_cvt_pk_bf16_f32 v179, v174, v175
    v_mfma_f32_16x16x32_bf16 v[216:219], a[172:175], a[248:251], v[216:219]
    v_mul_f32 v186, v186, v197
    v_mul_f32 v187, v187, v197
    v_mfma_f32_16x16x32_bf16 v[212:215], a[176:179], a[248:251], v[212:215]
    ds_read_b128 a[248:251], v225 offset:8896
    v_cvt_pk_bf16_f32 v185, v186, v187
    v_mfma_f32_16x16x32_bf16 v[220:223], a[180:183], a[252:255], v[220:223]
    v_mul_f32 v188, v188, v197
    v_mul_f32 v189, v189, v197
    v_mfma_f32_16x16x32_bf16 v[216:219], a[184:187], a[252:255], v[216:219]
    buffer_store_dwordx4 v[200:203], v245, s[20:23], s58 offen sc0 sc1
    v_mfma_f32_16x16x32_bf16 v[212:215], a[188:191], a[252:255], v[212:215]
    s_waitcnt lgkmcnt(2)
    ds_read_b128 a[252:255], v225 offset:8960
    v_cvt_pk_bf16_f32 v186, v188, v189
    v_mfma_f32_16x16x32_bf16 v[220:223], a[192:195], a[236:239], v[220:223]
    s_waitcnt vmcnt(2) lgkmcnt(2)
    v_mul_f32 v190, v190, v197
    v_mul_f32 v191, v191, v197
    v_mfma_f32_16x16x32_bf16 v[216:219], a[196:199], a[236:239], v[216:219]
    s_barrier
    v_cvt_pk_bf16_f32 v187, v190, v191
    v_mul_f32 v192, v192, v197
    v_mfma_f32_16x16x32_bf16 v[212:215], a[200:203], a[236:239], v[212:215]
    ds_read_b128 a[236:239], v225 offset:9024
    v_mul_f32 v193, v193, v197
    v_mfma_f32_16x16x32_bf16 v[220:223], a[204:207], a[240:243], v[220:223]
    v_cvt_pk_bf16_f32 v188, v192, v193
    v_mul_f32 v194, v194, v197
    v_mfma_f32_16x16x32_bf16 v[216:219], a[208:211], a[240:243], v[216:219]
    v_mul_f32 v195, v195, v197
    v_cvt_pk_bf16_f32 v189, v194, v195
    v_mfma_f32_16x16x32_bf16 v[212:215], a[212:215], a[240:243], v[212:215]
    s_waitcnt lgkmcnt(2)
    ds_read_b128 a[240:243], v225 offset:9088
    v_max3_f32 v236, v236, v196, v197
    v_mul_f32 v220, s37, v220
    v_mul_f32 v221, s37, v221
    v_mul_f32 v222, s37, v222
    v_mul_f32 v223, s37, v223
    v_cvt_pk_bf16_f32 v138, v220, v221
    v_cvt_pk_bf16_f32 v139, v222, v223
    v_mfma_f32_16x16x32_bf16 v[220:223], a[144:147], a[248:251], 0
    s_waitcnt lgkmcnt(2)
    v_mul_f32 v216, s37, v216
    v_mul_f32 v217, s37, v217
    v_mfma_f32_16x16x32_bf16 v[220:223], a[156:159], a[252:255], v[220:223]
    v_mul_f32 v218, s37, v218
    v_mul_f32 v219, s37, v219
    v_cvt_pk_bf16_f32 v140, v216, v217
    v_cvt_pk_bf16_f32 v141, v218, v219
    v_mfma_f32_16x16x32_bf16 v[216:219], a[148:151], a[248:251], 0
    v_mul_f32 v212, s37, v212
    v_mul_f32 v213, s37, v213
    v_mfma_f32_16x16x32_bf16 v[148:151], v[36:39], v[138:141], v[148:151]
    v_mul_f32 v214, s37, v214
    v_mul_f32 v215, s37, v215
    v_mfma_f32_16x16x32_bf16 v[152:155], v[42:45], v[138:141], v[152:155]
    v_cvt_pk_bf16_f32 v142, v212, v213
    v_cvt_pk_bf16_f32 v143, v214, v215
    v_mfma_f32_16x16x32_bf16 v[156:159], v[24:27], v[138:141], v[156:159]
    buffer_store_dwordx4 v[176:179], v244, s[20:23], s58 offen sc0 sc1
    v_mfma_f32_16x16x16_bf16 v[148:151], v[40:41], v[142:143], v[148:151]
    s_add_u32 s58, s51, 0x54000
    ds_write_b128 v237, v[184:187]
    v_mfma_f32_16x16x16_bf16 v[152:155], v[46:47], v[142:143], v[152:155]
    ds_write_b64 v238, v[188:189]
    v_mfma_f32_16x16x16_bf16 v[156:159], v[28:29], v[142:143], v[156:159]
    v_mfma_f32_16x16x32_bf16 v[144:147], v[30:33], v[138:141], v[144:147]
    v_mfma_f32_16x16x32_bf16 v[212:215], a[152:155], a[248:251], 0
    v_mfma_f32_16x16x32_bf16 v[216:219], a[160:163], a[252:255], v[216:219]
    ds_read_b128 a[248:251], v225 offset:9152
    ds_read_b128 a[244:247], v239 offset:12288
    v_mfma_f32_16x16x32_bf16 v[212:215], a[164:167], a[252:255], v[212:215]
    ds_read_b128 a[252:255], v225 offset:9216
    v_mfma_f32_16x16x16_bf16 v[144:147], v[34:35], v[142:143], v[144:147]
    s_waitcnt lgkmcnt(5)
    ds_read_b128 v[252:255], v240 offset:12288
    v_mfma_f32_16x16x32_bf16 v[220:223], a[168:171], a[236:239], v[220:223]
    ds_read_b128 v[164:167], v239 offset:13312
    v_mfma_f32_16x16x32_bf16 v[216:219], a[172:175], a[236:239], v[216:219]
    ds_read_b128 v[248:251], v241 offset:12800
    v_mfma_f32_16x16x32_bf16 v[212:215], a[176:179], a[236:239], v[212:215]
    ds_read_b128 a[236:239], v224 offset:30976
    v_mfma_f32_16x16x32_bf16 v[220:223], a[180:183], a[240:243], v[220:223]
    buffer_load_dwordx4 v246, s[4:7], s56 offen lds
    v_mfma_f32_16x16x32_bf16 v[216:219], a[184:187], a[240:243], v[216:219]
    s_add_u32 m0, s42, 0xb580
    v_exp_f32 v148, v148
    v_mfma_f32_16x16x32_bf16 v[212:215], a[188:191], a[240:243], v[212:215]
    s_waitcnt lgkmcnt(6)
    ds_read_b128 a[240:243], v224 offset:31040
    v_mfma_f32_16x16x32_bf16 v[220:223], a[192:195], a[248:251], v[220:223]
    v_exp_f32 v149, v149
    v_mfma_f32_16x16x32_bf16 v[216:219], a[196:199], a[248:251], v[216:219]
    v_exp_f32 v150, v150
    v_mfma_f32_16x16x32_bf16 v[212:215], a[200:203], a[248:251], v[212:215]
    s_waitcnt lgkmcnt(5)
    ds_read_b128 a[248:251], v224 offset:31104
    v_cvt_pk_bf16_f32 v160, v148, v149
    v_mfma_f32_16x16x32_bf16 v[220:223], a[204:207], a[252:255], v[220:223]
    v_exp_f32 v151, v151
    v_mfma_f32_16x16x32_bf16 v[216:219], a[208:211], a[252:255], v[216:219]
    v_cvt_pk_bf16_f32 v161, v150, v151
    v_mfma_f32_16x16x32_bf16 v[212:215], a[212:215], a[252:255], v[212:215]
    ds_read_b128 a[252:255], v224 offset:31168
    ds_read_b128 v[148:151], v234
    v_mfma_f32_16x16x32_bf16 v[208:211], a[220:223], a[244:247], 0
    s_waitcnt lgkmcnt(5)
    buffer_load_dwordx4 v247, s[4:7], s56 offen lds
    v_mfma_f32_16x16x32_bf16 v[200:203], a[220:223], v[252:255], 0
    s_add_u32 s56, s39, 0x276000
    v_mul_f32 v220, s37, v220
    v_mul_f32 v221, s37, v221
    v_mfma_f32_16x16x32_bf16 v[204:207], a[224:227], a[244:247], 0
    s_add_u32 m0, s41, 0xd3c0
    v_mul_f32 v222, s37, v222
    v_mul_f32 v223, s37, v223
    v_mfma_f32_16x16x32_bf16 v[180:183], a[224:227], v[252:255], 0
    v_cvt_pk_bf16_f32 v132, v220, v221
    v_cvt_pk_bf16_f32 v133, v222, v223
    v_mfma_f32_16x16x32_bf16 v[176:179], a[228:231], a[244:247], 0
    v_mul_f32 v216, s37, v216
    v_mul_f32 v217, s37, v217
    v_mfma_f32_16x16x32_bf16 v[172:175], a[232:235], a[244:247], 0
    s_waitcnt lgkmcnt(3)
    v_mul_f32 v218, s37, v218
    v_mul_f32 v219, s37, v219
    v_mfma_f32_16x16x32_bf16 v[220:223], a[0:3], a[236:239], 0
    v_cvt_pk_bf16_f32 v134, v216, v217
    v_cvt_pk_bf16_f32 v135, v218, v219
    v_mfma_f32_16x16x32_bf16 v[216:219], a[4:7], a[236:239], 0
    v_mul_f32 v212, s37, v212
    v_mul_f32 v213, s37, v213
    v_mfma_f32_16x16x32_bf16 v[220:223], a[12:15], a[240:243], v[220:223]
    s_waitcnt lgkmcnt(0)
    v_mul_f32 v214, s37, v214
    v_mul_f32 v215, s37, v215
    v_mfma_f32_16x16x32_bf16 v[148:151], v[54:57], v[138:141], v[148:151]
    v_cvt_pk_bf16_f32 v136, v212, v213
    v_cvt_pk_bf16_f32 v137, v214, v215
    v_mfma_f32_16x16x32_bf16 v[212:215], a[8:11], a[236:239], 0
    ds_read_b128 a[236:239], v224 offset:31232
    ds_read_b128 a[244:247], v240 offset:13312
    v_mfma_f32_16x16x32_bf16 v[216:219], a[16:19], a[240:243], v[216:219]
    buffer_load_dwordx4 v246, s[4:7], s56 offen lds
    v_mfma_f32_16x16x16_bf16 v[148:151], v[58:59], v[142:143], v[148:151]
    s_add_u32 m0, s42, 0xd3c0
    ds_read_b128 v[252:255], v239 offset:14336
    v_bfe_u32 v234, s71, v233, 4
    v_mfma_f32_16x16x32_bf16 v[212:215], a[20:23], a[240:243], v[212:215]
    ds_read_b128 a[240:243], v224 offset:31296
    v_mad_u32_u24 v234, v234, s40, v231
    v_mfma_f32_16x16x32_bf16 v[220:223], a[24:27], a[248:251], v[220:223]
    v_exp_f32 v152, v152
    v_mfma_f32_16x16x32_bf16 v[216:219], a[28:31], a[248:251], v[216:219]
    v_exp_f32 v153, v153
    v_mfma_f32_16x16x32_bf16 v[212:215], a[32:35], a[248:251], v[212:215]
    ds_read_b128 a[248:251], v224 offset:30976
    v_cvt_pk_bf16_f32 v162, v152, v153
    v_mfma_f32_16x16x32_bf16 v[220:223], a[36:39], a[252:255], v[220:223]
    v_exp_f32 v154, v154
    v_mfma_f32_16x16x32_bf16 v[216:219], a[40:43], a[252:255], v[216:219]
    v_exp_f32 v155, v155
    v_mfma_f32_16x16x32_bf16 v[212:215], a[44:47], a[252:255], v[212:215]
    s_waitcnt lgkmcnt(4)
    ds_read_b128 a[252:255], v224 offset:31040
    v_cvt_pk_bf16_f32 v163, v154, v155
    v_mfma_f32_16x16x32_bf16 v[220:223], a[48:51], a[236:239], v[220:223]
    buffer_load_dwordx4 v247, s[4:7], s56 offen lds
    v_mfma_f32_16x16x32_bf16 v[196:199], a[216:219], v[160:163], 0
    s_add_u32 s56, s39, 0x2a0000
    ds_read_b128 v[152:155], v235
    v_bfe_u32 v235, s67, v233, 4
    v_mfma_f32_16x16x32_bf16 v[184:187], v[76:79], v[160:163], 0
    s_add_u32 m0, s41, 0
    v_mad_u32_u24 v235, v235, s40, v231
    v_mfma_f32_16x16x32_bf16 v[188:191], v[98:101], v[160:163], 0
    v_exp_f32 v156, v156
    v_mfma_f32_16x16x32_bf16 v[192:195], v[120:123], v[160:163], 0
    v_exp_f32 v157, v157
    v_mfma_f32_16x16x32_bf16 v[216:219], a[52:55], a[236:239], v[216:219]
    v_exp_f32 v158, v158
    v_mfma_f32_16x16x32_bf16 v[212:215], a[56:59], a[236:239], v[212:215]
    s_waitcnt lgkmcnt(2)
    ds_read_b128 a[236:239], v224 offset:31104
    v_cvt_pk_bf16_f32 v160, v156, v157
    v_mfma_f32_16x16x32_bf16 v[220:223], a[60:63], a[240:243], v[220:223]
    v_exp_f32 v159, v159
    v_mfma_f32_16x16x32_bf16 v[216:219], a[64:67], a[240:243], v[216:219]
    v_cvt_pk_bf16_f32 v161, v158, v159
    v_mfma_f32_16x16x32_bf16 v[212:215], a[68:71], a[240:243], v[212:215]
    s_waitcnt lgkmcnt(1)
    ds_read_b128 a[240:243], v224 offset:31168
    ds_read_b128 v[156:159], v229 offset:640
    v_mfma_f32_16x16x32_bf16 v[152:155], v[60:63], v[138:141], v[152:155]
    v_exp_f32 v144, v144
    v_mfma_f32_16x16x32_bf16 v[208:211], v[168:171], v[164:167], v[208:211]
    v_cvt_pk_bf16_f32 v12, v220, v221
    v_cvt_pk_bf16_f32 v13, v222, v223
    v_mfma_f32_16x16x32_bf16 v[200:203], v[168:171], a[244:247], v[200:203]
    v_cvt_pk_bf16_f32 v14, v216, v217
    v_cvt_pk_bf16_f32 v15, v218, v219
    v_mfma_f32_16x16x16_bf16 v[152:155], v[64:65], v[142:143], v[152:155]
    v_cvt_pk_bf16_f32 v16, v212, v213
    v_cvt_pk_bf16_f32 v17, v214, v215
    v_mfma_f32_16x16x32_bf16 v[204:207], v[248:251], v[164:167], v[204:207]
    ds_read_b128 v[168:171], v242 offset:12288
    v_mfma_f32_16x16x32_bf16 v[180:183], v[248:251], a[244:247], v[180:183]
    ds_read_b128 v[248:251], v242 offset:12800
    ds_read_b128 a[244:247], v239 offset:15360
    v_mfma_f32_16x16x32_bf16 v[220:223], a[248:251], a[72:75], 0
    v_exp_f32 v145, v145
    v_mfma_f32_16x16x32_bf16 v[216:219], a[248:251], a[76:79], 0
    v_exp_f32 v146, v146
    v_mfma_f32_16x16x32_bf16 v[212:215], a[248:251], a[80:83], 0
    s_waitcnt lgkmcnt(3)
    ds_read_b128 a[248:251], v224 offset:31232
    v_cvt_pk_bf16_f32 v162, v144, v145
    v_mfma_f32_16x16x32_bf16 v[156:159], v[42:45], v[132:135], v[156:159]
    v_exp_f32 v147, v147
    v_mfma_f32_16x16x32_bf16 v[220:223], a[252:255], a[84:87], v[220:223]
    v_cvt_pk_bf16_f32 v163, v146, v147
    v_mfma_f32_16x16x32_bf16 v[216:219], a[252:255], a[88:91], v[216:219]
    ds_read_b128 v[144:147], v228 offset:640
    v_mfma_f32_16x16x32_bf16 v[196:199], a[216:219], v[160:163], v[196:199]
    v_exp_f32 v148, v148
    v_mfma_f32_16x16x32_bf16 v[184:187], v[68:71], v[160:163], v[184:187]
    v_exp_f32 v149, v149
    v_mfma_f32_16x16x32_bf16 v[188:191], v[90:93], v[160:163], v[188:191]
    v_exp_f32 v150, v150
    v_mfma_f32_16x16x32_bf16 v[192:195], v[112:115], v[160:163], v[192:195]
    v_exp_f32 v151, v151
    v_mfma_f32_16x16x16_bf16 v[156:159], v[46:47], v[136:137], v[156:159]
    s_waitcnt lgkmcnt(2)
    v_cvt_pk_bf16_f32 v160, v148, v149
    v_cvt_pk_bf16_f32 v161, v150, v151
    v_mfma_f32_16x16x32_bf16 v[176:179], v[168:171], v[164:167], v[176:179]
    ds_read_b128 v[168:171], v241 offset:24576
    ds_read_b128 v[148:151], v228 offset:1280
    v_mfma_f32_16x16x32_bf16 v[172:175], v[248:251], v[164:167], v[172:175]
    v_exp_f32 v152, v152
    v_mfma_f32_16x16x32_bf16 v[212:215], a[252:255], a[92:95], v[212:215]
    s_waitcnt lgkmcnt(2)
    ds_read_b128 a[252:255], v224 offset:31296
    v_mfma_f32_16x16x32_bf16 v[144:147], v[18:21], v[132:135], v[144:147]
    ds_read_b128 v[164:167], v240 offset:14336
    v_mfma_f32_16x16x32_bf16 v[220:223], a[236:239], a[96:99], v[220:223]
    ds_read_b128 v[248:251], v241 offset:25088
    v_mfma_f32_16x16x32_bf16 v[216:219], a[236:239], a[100:103], v[216:219]
    v_exp_f32 v153, v153
    v_mfma_f32_16x16x32_bf16 v[212:215], a[236:239], a[104:107], v[212:215]
    ds_read_b128 a[236:239], v224 offset:34048
    v_cvt_pk_bf16_f32 v162, v152, v153
    v_mfma_f32_16x16x16_bf16 v[144:147], v[22:23], v[136:137], v[144:147]
    v_exp_f32 v154, v154
    v_mfma_f32_16x16x32_bf16 v[220:223], a[240:243], a[108:111], v[220:223]
    v_exp_f32 v155, v155
    v_mfma_f32_16x16x32_bf16 v[216:219], a[240:243], a[112:115], v[216:219]
    s_waitcnt lgkmcnt(4)
    v_cvt_pk_bf16_f32 v163, v154, v155
    v_mfma_f32_16x16x32_bf16 v[148:151], v[0:3], v[132:135], v[148:151]
    ds_read_b128 v[152:155], v229 offset:1280
    v_mfma_f32_16x16x32_bf16 v[196:199], a[216:219], v[160:163], v[196:199]
    v_exp_f32 v156, v156
    v_mfma_f32_16x16x32_bf16 v[184:187], v[84:87], v[160:163], v[184:187]
    v_exp_f32 v157, v157
    v_mfma_f32_16x16x32_bf16 v[188:191], v[106:109], v[160:163], v[188:191]
    v_exp_f32 v158, v158
    v_mfma_f32_16x16x32_bf16 v[192:195], v[128:131], v[160:163], v[192:195]
    v_exp_f32 v159, v159
    v_mfma_f32_16x16x16_bf16 v[148:151], v[4:5], v[136:137], v[148:151]
    v_rcp_f32 v197, v196
    v_mfma_f32_16x16x32_bf16 v[212:215], a[240:243], a[116:119], v[212:215]
    ds_read_b128 a[240:243], v224 offset:34112
    v_mul_f32 v184, v184, v197
    v_mfma_f32_16x16x32_bf16 v[220:223], a[248:251], a[120:123], v[220:223]
    v_mul_f32 v185, v185, v197
    v_cvt_pk_bf16_f32 v184, v184, v185
    v_mfma_f32_16x16x32_bf16 v[216:219], a[248:251], a[124:127], v[216:219]
    s_waitcnt lgkmcnt(1)
    v_mul_f32 v186, v186, v197
    v_mul_f32 v187, v187, v197
    v_mfma_f32_16x16x32_bf16 v[152:155], v[24:27], v[132:135], v[152:155]
    v_cvt_pk_bf16_f32 v185, v186, v187
    v_mul_f32 v188, v188, v197
    v_mfma_f32_16x16x32_bf16 v[212:215], a[248:251], a[128:131], v[212:215]
    ds_read_b128 a[248:251], v224 offset:34176
    v_mul_f32 v189, v189, v197
    v_mfma_f32_16x16x32_bf16 v[220:223], a[252:255], a[132:135], v[220:223]
    v_cvt_pk_bf16_f32 v186, v188, v189
    v_mul_f32 v190, v190, v197
    v_mfma_f32_16x16x16_bf16 v[152:155], v[28:29], v[136:137], v[152:155]
    v_mul_f32 v191, v191, v197
    v_cvt_pk_bf16_f32 v187, v190, v191
    v_mfma_f32_16x16x32_bf16 v[216:219], a[252:255], a[136:139], v[216:219]
    v_mul_f32 v192, v192, v197
    v_mul_f32 v193, v193, v197
    v_mfma_f32_16x16x32_bf16 v[212:215], a[252:255], a[140:143], v[212:215]
    v_cvt_pk_bf16_f32 v74, v220, v221
    v_cvt_pk_bf16_f32 v75, v222, v223
    v_mfma_f32_16x16x32_bf16 v[208:211], v[168:171], v[252:255], v[208:211]
    ds_read_b128 a[252:255], v224 offset:34240
    v_cvt_pk_bf16_f32 v188, v192, v193
    v_mfma_f32_16x16x32_bf16 v[200:203], v[168:171], v[164:167], v[200:203]
    v_cvt_pk_bf16_f32 v96, v216, v217
    v_cvt_pk_bf16_f32 v97, v218, v219
    v_mfma_f32_16x16x32_bf16 v[204:207], v[248:251], v[252:255], v[204:207]
    v_cvt_pk_bf16_f32 v118, v212, v213
    v_cvt_pk_bf16_f32 v119, v214, v215
    v_mfma_f32_16x16x32_bf16 v[180:183], v[248:251], v[164:167], v[180:183]
    v_mul_f32 v194, v194, v197
    v_mul_f32 v195, v195, v197
    v_mfma_f32_16x16x32_bf16 v[220:223], a[0:3], a[236:239], 0
    v_cvt_pk_bf16_f32 v189, v194, v195
    v_max3_f32 v236, v236, v196, v197
    v_mfma_f32_16x16x32_bf16 v[216:219], a[4:7], a[236:239], 0
    ds_write_b128 v237, v[184:187] offset:6144
    v_mfma_f32_16x16x32_bf16 v[212:215], a[8:11], a[236:239], 0
    s_waitcnt lgkmcnt(2)
    ds_write_b64 v238, v[188:189] offset:6144
    v_mfma_f32_16x16x32_bf16 v[220:223], a[12:15], a[240:243], v[220:223]
    v_cvt_pk_bf16_f32 v160, v156, v157
    v_cvt_pk_bf16_f32 v161, v158, v159
    v_mfma_f32_16x16x32_bf16 v[216:219], a[16:19], a[240:243], v[216:219]
    v_exp_f32 v144, v144
    v_mfma_f32_16x16x32_bf16 v[212:215], a[20:23], a[240:243], v[212:215]
    v_exp_f32 v145, v145
    v_mfma_f32_16x16x32_bf16 v[220:223], a[24:27], a[248:251], v[220:223]
    ds_read_b128 a[236:239], v224 offset:34304
    ds_read_b128 a[240:243], v224 offset:34368
    v_mfma_f32_16x16x32_bf16 v[216:219], a[28:31], a[248:251], v[216:219]
    ds_read_b128 v[168:171], v242 offset:24576
    v_cvt_pk_bf16_f32 v162, v144, v145
    v_mfma_f32_16x16x32_bf16 v[212:215], a[32:35], a[248:251], v[212:215]
    s_waitcnt lgkmcnt(5)
    ds_read_b128 a[248:251], v224 offset:34048
    v_mfma_f32_16x16x32_bf16 v[220:223], a[36:39], a[252:255], v[220:223]
    ds_read_b128 v[248:251], v242 offset:25088
    v_mfma_f32_16x16x32_bf16 v[216:219], a[40:43], a[252:255], v[216:219]
    ds_read_b128 v[164:167], v239 offset:16384
    v_mfma_f32_16x16x32_bf16 v[212:215], a[44:47], a[252:255], v[212:215]
    ds_read_b128 a[252:255], v224 offset:34112
    v_exp_f32 v146, v146
    v_exp_f32 v147, v147
    ds_read_b128 v[156:159], v229 offset:1920
    v_cvt_pk_bf16_f32 v163, v146, v147
    v_exp_f32 v148, v148
    ds_read_b128 v[144:147], v228 offset:1920
    v_mfma_f32_16x16x32_bf16 v[196:199], a[216:219], v[160:163], 0
    v_exp_f32 v149, v149
    v_mfma_f32_16x16x32_bf16 v[184:187], v[78:81], v[160:163], 0
    v_exp_f32 v150, v150
    v_mfma_f32_16x16x32_bf16 v[188:191], v[100:103], v[160:163], 0
    v_exp_f32 v151, v151
    v_mfma_f32_16x16x32_bf16 v[192:195], v[122:125], v[160:163], 0
    s_waitcnt lgkmcnt(6)
    v_cvt_pk_bf16_f32 v160, v148, v149
    v_cvt_pk_bf16_f32 v161, v150, v151
    v_mfma_f32_16x16x32_bf16 v[176:179], v[168:171], v[252:255], v[176:179]
    s_waitcnt lgkmcnt(4)
    ds_read_b128 v[168:171], v241 offset:36864
    ds_read_b128 v[148:151], v228 offset:2560
    v_mfma_f32_16x16x32_bf16 v[172:175], v[248:251], v[252:255], v[172:175]
    v_exp_f32 v152, v152
    v_mfma_f32_16x16x32_bf16 v[220:223], a[48:51], a[236:239], v[220:223]
    s_waitcnt lgkmcnt(3)
    ds_read_b128 v[252:255], v240 offset:15360
    v_mfma_f32_16x16x32_bf16 v[156:159], v[30:33], v[132:135], v[156:159]
    ds_read_b128 v[248:251], v241 offset:37376
    v_mfma_f32_16x16x32_bf16 v[216:219], a[52:55], a[236:239], v[216:219]
    s_waitcnt lgkmcnt(4)
    v_exp_f32 v153, v153
    v_mfma_f32_16x16x32_bf16 v[144:147], v[6:9], v[132:135], v[144:147]
    v_exp_f32 v154, v154
    v_mfma_f32_16x16x32_bf16 v[212:215], a[56:59], a[236:239], v[212:215]
    ds_read_b128 a[236:239], v224 offset:34176
    v_cvt_pk_bf16_f32 v162, v152, v153
    v_mfma_f32_16x16x16_bf16 v[156:159], v[34:35], v[136:137], v[156:159]
    v_exp_f32 v155, v155
    v_mfma_f32_16x16x16_bf16 v[144:147], v[10:11], v[136:137], v[144:147]
    v_cvt_pk_bf16_f32 v163, v154, v155
    v_mfma_f32_16x16x32_bf16 v[220:223], a[60:63], a[240:243], v[220:223]
    ds_read_b128 v[152:155], v229 offset:2560
    v_mfma_f32_16x16x32_bf16 v[196:199], a[216:219], v[160:163], v[196:199]
    v_mfma_f32_16x16x32_bf16 v[184:187], v[66:69], v[160:163], v[184:187]
    v_mfma_f32_16x16x32_bf16 v[188:191], v[88:91], v[160:163], v[188:191]
    v_exp_f32 v156, v156
    v_mfma_f32_16x16x32_bf16 v[192:195], v[110:113], v[160:163], v[192:195]
    s_waitcnt lgkmcnt(2)
    v_exp_f32 v157, v157
    v_mfma_f32_16x16x32_bf16 v[148:151], v[12:15], v[132:135], v[148:151]
    v_cvt_pk_bf16_f32 v36, v220, v221
    v_cvt_pk_bf16_f32 v37, v222, v223
    v_mfma_f32_16x16x32_bf16 v[216:219], a[64:67], a[240:243], v[216:219]
    v_exp_f32 v158, v158
    v_mfma_f32_16x16x32_bf16 v[212:215], a[68:71], a[240:243], v[212:215]
    ds_read_b128 a[240:243], v224 offset:34240
    v_cvt_pk_bf16_f32 v160, v156, v157
    v_mfma_f32_16x16x16_bf16 v[148:151], v[16:17], v[136:137], v[148:151]
    v_exp_f32 v159, v159
    v_mfma_f32_16x16x32_bf16 v[208:211], v[168:171], a[244:247], v[208:211]
    v_cvt_pk_bf16_f32 v161, v158, v159
    v_cvt_pk_bf16_f32 v38, v216, v217
    v_mfma_f32_16x16x32_bf16 v[200:203], v[168:171], v[252:255], v[200:203]
    v_cvt_pk_bf16_f32 v39, v218, v219
    v_cvt_pk_bf16_f32 v40, v212, v213
    v_mfma_f32_16x16x32_bf16 v[204:207], v[248:251], a[244:247], v[204:207]
    s_waitcnt lgkmcnt(1)
    ds_read_b128 v[168:171], v242 offset:36864
    v_cvt_pk_bf16_f32 v41, v214, v215
    v_mfma_f32_16x16x32_bf16 v[152:155], v[36:39], v[132:135], v[152:155]
    ds_read_b128 v[156:159], v230 offset:2560
    v_mfma_f32_16x16x32_bf16 v[180:183], v[248:251], v[252:255], v[180:183]
    ds_read_b128 v[248:251], v242 offset:37376
    v_mfma_f32_16x16x32_bf16 v[220:223], a[248:251], a[72:75], 0
    ds_read_b128 v[252:255], v239 offset:17408
    v_mfma_f32_16x16x32_bf16 v[216:219], a[248:251], a[76:79], 0
    v_exp_f32 v144, v144
    v_mfma_f32_16x16x16_bf16 v[152:155], v[40:41], v[136:137], v[152:155]
    v_exp_f32 v145, v145
    v_mfma_f32_16x16x32_bf16 v[212:215], a[248:251], a[80:83], 0
    ds_read_b128 a[248:251], v224 offset:34304
    v_cvt_pk_bf16_f32 v162, v144, v145
    v_mfma_f32_16x16x32_bf16 v[220:223], a[252:255], a[84:87], v[220:223]
    v_exp_f32 v146, v146
    v_mfma_f32_16x16x32_bf16 v[216:219], a[252:255], a[88:91], v[216:219]
    s_waitcnt lgkmcnt(4)
    v_exp_f32 v147, v147
    v_mfma_f32_16x16x32_bf16 v[176:179], v[168:171], a[244:247], v[176:179]
    ds_read_b128 v[168:171], v241 offset:49152
    v_cvt_pk_bf16_f32 v163, v146, v147
    v_mfma_f32_16x16x32_bf16 v[212:215], a[252:255], a[92:95], v[212:215]
L_pg5:
    s_cbranch_execz L_back
    ds_read_b128 a[252:255], v224 offset:34368
    ds_read_b128 v[144:147], v230 offset:640
    v_mfma_f32_16x16x32_bf16 v[196:199], a[216:219], v[160:163], v[196:199]
    v_exp_f32 v148, v148
    v_mfma_f32_16x16x32_bf16 v[184:187], v[70:73], v[160:163], v[184:187]
    v_exp_f32 v149, v149
    v_mfma_f32_16x16x32_bf16 v[188:191], v[92:95], v[160:163], v[188:191]
    v_exp_f32 v150, v150
    v_mfma_f32_16x16x32_bf16 v[192:195], v[114:117], v[160:163], v[192:195]
    s_waitcnt lgkmcnt(4)
    v_exp_f32 v151, v151
    v_mfma_f32_16x16x32_bf16 v[172:175], v[248:251], a[244:247], v[172:175]
    ds_read_b128 a[244:247], v240 offset:16384
    ds_read_b128 v[248:251], v241 offset:49664
    v_mfma_f32_16x16x32_bf16 v[220:223], a[236:239], a[96:99], v[220:223]
    v_cvt_pk_bf16_f32 v160, v148, v149
    v_cvt_pk_bf16_f32 v161, v150, v151
    v_mfma_f32_16x16x32_bf16 v[216:219], a[236:239], a[100:103], v[216:219]
    ds_read_b128 v[148:151], v230 offset:1280
    v_mfma_f32_16x16x32_bf16 v[212:215], a[236:239], a[104:107], v[212:215]
    ds_read_b128 a[236:239], v225 offset:11968
    v_mfma_f32_16x16x32_bf16 v[220:223], a[240:243], a[108:111], v[220:223]
    v_exp_f32 v152, v152
    v_mfma_f32_16x16x32_bf16 v[216:219], a[240:243], a[112:115], v[216:219]
    v_exp_f32 v153, v153
    v_mfma_f32_16x16x32_bf16 v[212:215], a[240:243], a[116:119], v[212:215]
    s_waitcnt lgkmcnt(4)
    ds_read_b128 a[240:243], v225 offset:12032
    v_cvt_pk_bf16_f32 v162, v152, v153
    v_mfma_f32_16x16x32_bf16 v[220:223], a[248:251], a[120:123], v[220:223]
    v_exp_f32 v154, v154
    v_mfma_f32_16x16x32_bf16 v[216:219], a[248:251], a[124:127], v[216:219]
    v_exp_f32 v155, v155
    v_mfma_f32_16x16x32_bf16 v[212:215], a[248:251], a[128:131], v[212:215]
    ds_read_b128 a[248:251], v225 offset:12096
    v_cvt_pk_bf16_f32 v163, v154, v155
    v_mfma_f32_16x16x32_bf16 v[220:223], a[252:255], a[132:135], v[220:223]
    ds_read_b128 v[152:155], v230 offset:1920
    v_mfma_f32_16x16x32_bf16 v[196:199], a[216:219], v[160:163], v[196:199]
    v_mfma_f32_16x16x32_bf16 v[216:219], a[252:255], a[136:139], v[216:219]
    v_mfma_f32_16x16x32_bf16 v[212:215], a[252:255], a[140:143], v[212:215]
    ds_read_b128 a[252:255], v225 offset:12160
    v_mfma_f32_16x16x32_bf16 v[208:211], v[168:171], v[164:167], v[208:211]
    s_waitcnt lgkmcnt(4)
    v_mfma_f32_16x16x32_bf16 v[200:203], v[168:171], a[244:247], v[200:203]
    ds_read_b128 v[168:171], v242 offset:49152
    v_cvt_pk_bf16_f32 v76, v220, v221
    v_mfma_f32_16x16x32_bf16 v[204:207], v[248:251], v[164:167], v[204:207]
    v_cvt_pk_bf16_f32 v77, v222, v223
    v_cvt_pk_bf16_f32 v98, v216, v217
    v_mfma_f32_16x16x32_bf16 v[180:183], v[248:251], a[244:247], v[180:183]
    v_cvt_pk_bf16_f32 v99, v218, v219
    v_cvt_pk_bf16_f32 v120, v212, v213
    v_mfma_f32_16x16x32_bf16 v[184:187], v[74:77], v[160:163], v[184:187]
    ds_read_b128 v[248:251], v242 offset:49664
    v_cvt_pk_bf16_f32 v121, v214, v215
    v_mfma_f32_16x16x32_bf16 v[188:191], v[96:99], v[160:163], v[188:191]
    v_rcp_f32 v197, v196
    v_mfma_f32_16x16x32_bf16 v[192:195], v[118:121], v[160:163], v[192:195]
    v_max3_f32 v236, v236, v196, v197
    v_mfma_f32_16x16x32_bf16 v[220:223], a[144:147], a[236:239], 0
    v_mfma_f32_16x16x32_bf16 v[216:219], a[148:151], a[236:239], 0
    v_mul_f32 v184, v184, v197
    v_mul_f32 v185, v185, v197
    v_mfma_f32_16x16x32_bf16 v[212:215], a[152:155], a[236:239], 0
    s_waitcnt lgkmcnt(1)
    ds_read_b128 a[236:239], v225 offset:12224
    v_cvt_pk_bf16_f32 v184, v184, v185
    v_mfma_f32_16x16x32_bf16 v[176:179], v[168:171], v[164:167], v[176:179]
    ds_read_b128 v[168:171], v241 offset:61440
    v_mul_f32 v186, v186, v197
    v_mfma_f32_16x16x32_bf16 v[220:223], a[156:159], a[240:243], v[220:223]
    v_mul_f32 v187, v187, v197
    v_cvt_pk_bf16_f32 v185, v186, v187
    v_mfma_f32_16x16x32_bf16 v[216:219], a[160:163], a[240:243], v[216:219]
    s_waitcnt lgkmcnt(2)
    v_mul_f32 v188, v188, v197
    v_mul_f32 v189, v189, v197
    v_mfma_f32_16x16x32_bf16 v[172:175], v[248:251], v[164:167], v[172:175]
    ds_read_b128 v[164:167], v240 offset:17408
    ds_read_b128 v[248:251], v241 offset:61952
    v_mfma_f32_16x16x32_bf16 v[212:215], a[164:167], a[240:243], v[212:215]
    ds_read_b128 a[240:243], v225 offset:12288
    v_cvt_pk_bf16_f32 v186, v188, v189
    v_mfma_f32_16x16x32_bf16 v[220:223], a[168:171], a[248:251], v[220:223]
    v_mul_f32 v190, v190, v197
    v_mul_f32 v191, v191, v197
    v_mfma_f32_16x16x32_bf16 v[216:219], a[172:175], a[248:251], v[216:219]
    v_cvt_pk_bf16_f32 v187, v190, v191
    v_mul_f32 v192, v192, v197
    v_mfma_f32_16x16x32_bf16 v[212:215], a[176:179], a[248:251], v[212:215]
    v_mul_f32 v193, v193, v197
    v_cvt_pk_bf16_f32 v188, v192, v193
    v_mfma_f32_16x16x32_bf16 v[220:223], a[180:183], a[252:255], v[220:223]
    v_mul_f32 v194, v194, v197
    v_mul_f32 v195, v195, v197
    v_mfma_f32_16x16x32_bf16 v[216:219], a[184:187], a[252:255], v[216:219]
    v_cvt_pk_bf16_f32 v189, v194, v195
    v_mfma_f32_16x16x32_bf16 v[212:215], a[188:191], a[252:255], v[212:215]
    s_waitcnt lgkmcnt(3)
    v_mfma_f32_16x16x32_bf16 v[220:223], a[192:195], a[236:239], v[220:223]
    v_mfma_f32_16x16x32_bf16 v[216:219], a[196:199], a[236:239], v[216:219]
    s_waitcnt vmcnt(0) lgkmcnt(0)
    v_mfma_f32_16x16x32_bf16 v[212:215], a[200:203], a[236:239], v[212:215]
    s_barrier
    ds_read_b128 a[248:251], v227 offset:37120
    v_mfma_f32_16x16x32_bf16 v[220:223], a[204:207], a[240:243], v[220:223]
    ds_read_b128 a[252:255], v227 offset:37184
    ds_read_b128 a[236:239], v227 offset:37248
    v_mfma_f32_16x16x32_bf16 v[216:219], a[208:211], a[240:243], v[216:219]
    buffer_load_dwordx4 v246, s[4:7], s56 offen lds
    v_mfma_f32_16x16x32_bf16 v[212:215], a[212:215], a[240:243], v[212:215]
    s_add_u32 m0, s42, 0
    ds_read_b128 a[240:243], v227 offset:37312
    ds_read_b128 a[244:247], v239
    v_mfma_f32_16x16x32_bf16 v[208:211], v[168:171], v[252:255], v[208:211]
    v_mul_f32 v220, s37, v220
    v_mul_f32 v221, s37, v221
    v_mfma_f32_16x16x32_bf16 v[200:203], v[168:171], v[164:167], v[200:203]
    v_mul_f32 v222, s37, v222
    v_mul_f32 v223, s37, v223
    v_mfma_f32_16x16x32_bf16 v[204:207], v[248:251], v[252:255], v[204:207]
    v_cvt_pk_bf16_f32 v138, v220, v221
    v_cvt_pk_bf16_f32 v139, v222, v223
    v_mfma_f32_16x16x32_bf16 v[180:183], v[248:251], v[164:167], v[180:183]
    s_waitcnt lgkmcnt(4)
    v_mul_f32 v216, s37, v216
    v_mul_f32 v217, s37, v217
    v_mul_f32 v218, s37, v218
    v_mul_f32 v219, s37, v219
    v_cvt_pk_bf16_f32 v140, v216, v217
    v_mfma_f32_16x16x32_bf16 v[220:223], a[0:3], a[248:251], 0
    v_cvt_pk_bf16_f32 v141, v218, v219
    v_mul_f32 v212, s37, v212
    v_mfma_f32_16x16x32_bf16 v[216:219], a[4:7], a[248:251], 0
    v_mul_f32 v213, s37, v213
    v_mul_f32 v214, s37, v214
    v_mfma_f32_16x16x32_bf16 v[156:159], v[36:39], v[138:141], v[156:159]
    v_mul_f32 v215, s37, v215
    v_cvt_pk_bf16_f32 v142, v212, v213
    v_mfma_f32_16x16x32_bf16 v[144:147], v[42:45], v[138:141], v[144:147]
    ds_read_b128 v[168:171], v242 offset:61440
    v_cvt_pk_bf16_f32 v143, v214, v215
    v_mfma_f32_16x16x32_bf16 v[148:151], v[24:27], v[138:141], v[148:151]
    ds_read_b128 v[248:251], v242 offset:61952
    v_cvt_pk_bf16_f32 v208, v208, v209
    v_mfma_f32_16x16x16_bf16 v[156:159], v[40:41], v[142:143], v[156:159]
    v_cvt_pk_bf16_f32 v209, v210, v211
    v_cvt_pk_bf16_f32 v210, v204, v205
    v_mfma_f32_16x16x16_bf16 v[144:147], v[46:47], v[142:143], v[144:147]
    v_cvt_pk_bf16_f32 v211, v206, v207
    v_cvt_pk_bf16_f32 v200, v200, v201
    v_mfma_f32_16x16x16_bf16 v[148:151], v[28:29], v[142:143], v[148:151]
    buffer_store_dwordx4 v[208:211], v243, s[20:23], s58 offen sc0 sc1
    v_mfma_f32_16x16x32_bf16 v[152:155], v[30:33], v[138:141], v[152:155]
    ds_read_b128 v[164:167], v239 offset:1024
    v_cvt_pk_bf16_f32 v201, v202, v203
    v_mfma_f32_16x16x32_bf16 v[212:215], a[8:11], a[248:251], 0
    s_waitcnt lgkmcnt(3)
    ds_read_b128 a[248:251], v227 offset:37376
    v_cvt_pk_bf16_f32 v202, v180, v181
    v_mfma_f32_16x16x32_bf16 v[220:223], a[12:15], a[252:255], v[220:223]
    v_cvt_pk_bf16_f32 v203, v182, v183
    v_mfma_f32_16x16x16_bf16 v[152:155], v[34:35], v[142:143], v[152:155]
    s_waitcnt lgkmcnt(3)
    ds_write_b128 v237, v[184:187] offset:12288
    v_mfma_f32_16x16x32_bf16 v[176:179], v[168:171], v[252:255], v[176:179]
    s_waitcnt lgkmcnt(3)
    ds_write_b64 v238, v[188:189] offset:12288
    v_mfma_f32_16x16x32_bf16 v[172:175], v[248:251], v[252:255], v[172:175]
    v_exp_f32 v156, v156
    v_mfma_f32_16x16x32_bf16 v[216:219], a[16:19], a[252:255], v[216:219]
    v_exp_f32 v157, v157
    v_mfma_f32_16x16x32_bf16 v[212:215], a[20:23], a[252:255], v[212:215]
    v_exp_f32 v158, v158
    v_mfma_f32_16x16x32_bf16 v[220:223], a[24:27], a[236:239], v[220:223]
    ds_read_b128 a[252:255], v227 offset:37440
    v_cvt_pk_bf16_f32 v176, v176, v177
    v_mfma_f32_16x16x32_bf16 v[216:219], a[28:31], a[236:239], v[216:219]
    ds_read_b128 v[252:255], v240
    v_cvt_pk_bf16_f32 v177, v178, v179
    v_mfma_f32_16x16x32_bf16 v[212:215], a[32:35], a[236:239], v[212:215]
    ds_read_b128 a[236:239], v227 offset:37120
    v_cvt_pk_bf16_f32 v178, v172, v173
    v_mfma_f32_16x16x32_bf16 v[220:223], a[36:39], a[240:243], v[220:223]
    buffer_store_dwordx4 v[200:203], v245, s[20:23], s58 offen sc0 sc1
    v_mfma_f32_16x16x32_bf16 v[216:219], a[40:43], a[240:243], v[216:219]
    ds_read_b128 v[168:171], v241 offset:12288
    v_cvt_pk_bf16_f32 v179, v174, v175
    v_mfma_f32_16x16x32_bf16 v[212:215], a[44:47], a[240:243], v[212:215]
    s_waitcnt lgkmcnt(6)
    ds_read_b128 a[240:243], v227 offset:37184
    ds_read_b128 v[248:251], v241 offset:12800
    v_mfma_f32_16x16x32_bf16 v[220:223], a[48:51], a[248:251], v[220:223]
    v_exp_f32 v159, v159
    v_mfma_f32_16x16x32_bf16 v[216:219], a[52:55], a[248:251], v[216:219]
    v_cvt_pk_bf16_f32 v160, v156, v157
    v_cvt_pk_bf16_f32 v161, v158, v159
    v_mfma_f32_16x16x32_bf16 v[212:215], a[56:59], a[248:251], v[212:215]
    s_waitcnt lgkmcnt(5)
    ds_read_b128 a[248:251], v227 offset:37248
    ds_read_b128 v[156:159], v234
    v_mfma_f32_16x16x32_bf16 v[220:223], a[60:63], a[252:255], v[220:223]
    v_bfe_u32 v234, s72, v233, 4
    v_mad_u32_u24 v234, v234, s40, v231
    v_mfma_f32_16x16x32_bf16 v[216:219], a[64:67], a[252:255], v[216:219]
    v_exp_f32 v144, v144
    v_mfma_f32_16x16x32_bf16 v[212:215], a[68:71], a[252:255], v[212:215]
    ds_read_b128 a[252:255], v227 offset:37312
    v_mfma_f32_16x16x32_bf16 v[208:211], a[220:223], a[244:247], 0
    s_waitcnt lgkmcnt(6)
    v_exp_f32 v145, v145
    v_mfma_f32_16x16x32_bf16 v[200:203], a[220:223], v[252:255], 0
    v_cvt_pk_bf16_f32 v48, v220, v221
    v_cvt_pk_bf16_f32 v49, v222, v223
    v_mfma_f32_16x16x32_bf16 v[204:207], a[224:227], a[244:247], 0
    v_cvt_pk_bf16_f32 v50, v216, v217
    v_cvt_pk_bf16_f32 v51, v218, v219
    v_mfma_f32_16x16x32_bf16 v[180:183], a[224:227], v[252:255], 0
    v_cvt_pk_bf16_f32 v52, v212, v213
    v_cvt_pk_bf16_f32 v53, v214, v215
    v_mfma_f32_16x16x32_bf16 v[172:175], a[232:235], a[244:247], 0
    s_waitcnt lgkmcnt(1)
    buffer_store_dwordx4 v[176:179], v244, s[20:23], s58 offen sc0 sc1
    v_mfma_f32_16x16x32_bf16 v[220:223], a[236:239], a[72:75], 0
    s_add_u32 s58, s51, 0xa8000
    ds_read_b128 v[252:255], v239 offset:2048
    v_cvt_pk_bf16_f32 v162, v144, v145
    v_mfma_f32_16x16x32_bf16 v[156:159], v[54:57], v[138:141], v[156:159]
    v_exp_f32 v146, v146
    v_mfma_f32_16x16x32_bf16 v[176:179], a[228:231], a[244:247], 0
    ds_read_b128 a[244:247], v240 offset:1024
    v_mfma_f32_16x16x32_bf16 v[216:219], a[236:239], a[76:79], 0
    v_exp_f32 v147, v147
    v_mfma_f32_16x16x32_bf16 v[212:215], a[236:239], a[80:83], 0
    ds_read_b128 a[236:239], v227 offset:37376
    v_cvt_pk_bf16_f32 v163, v146, v147
    v_mfma_f32_16x16x16_bf16 v[156:159], v[58:59], v[142:143], v[156:159]
    ds_read_b128 v[144:147], v235
    v_bfe_u32 v235, s69, v233, 4
    v_mfma_f32_16x16x32_bf16 v[196:199], a[216:219], v[160:163], 0
    v_mad_u32_u24 v235, v235, s40, v231
    v_mfma_f32_16x16x32_bf16 v[184:187], v[76:79], v[160:163], 0
    v_exp_f32 v148, v148
    v_mfma_f32_16x16x32_bf16 v[188:191], v[98:101], v[160:163], 0
    v_exp_f32 v149, v149
    v_mfma_f32_16x16x32_bf16 v[192:195], v[120:123], v[160:163], 0
    v_exp_f32 v150, v150
    v_mfma_f32_16x16x32_bf16 v[220:223], a[240:243], a[84:87], v[220:223]
    v_exp_f32 v151, v151
    v_mfma_f32_16x16x32_bf16 v[216:219], a[240:243], a[88:91], v[216:219]
    buffer_load_dwordx4 v247, s[4:7], s56 offen lds
    v_mfma_f32_16x16x32_bf16 v[212:215], a[240:243], a[92:95], v[212:215]
    s_add_u32 m0, s41, 0x1e40
    ds_read_b128 a[240:243], v227 offset:37440
    v_cvt_pk_bf16_f32 v160, v148, v149
    v_mfma_f32_16x16x32_bf16 v[220:223], a[248:251], a[96:99], v[220:223]
    s_waitcnt lgkmcnt(1)
    v_cvt_pk_bf16_f32 v161, v150, v151
    v_mfma_f32_16x16x32_bf16 v[144:147], v[60:63], v[138:141], v[144:147]
    ds_read_b128 v[148:151], v234
    v_bfe_u32 v234, s70, v233, 4
    v_mfma_f32_16x16x32_bf16 v[216:219], a[248:251], a[100:103], v[216:219]
    v_mad_u32_u24 v234, v234, s40, v231
    v_mfma_f32_16x16x32_bf16 v[212:215], a[248:251], a[104:107], v[212:215]
    ds_read_b128 a[248:251], v225 offset:24384
    v_mfma_f32_16x16x16_bf16 v[144:147], v[64:65], v[142:143], v[144:147]
    v_exp_f32 v152, v152
    v_mfma_f32_16x16x32_bf16 v[220:223], a[252:255], a[108:111], v[220:223]
    v_exp_f32 v153, v153
    v_mfma_f32_16x16x32_bf16 v[216:219], a[252:255], a[112:115], v[216:219]
    buffer_load_dwordx4 v246, s[4:7], s46 offen lds
    v_mfma_f32_16x16x32_bf16 v[212:215], a[252:255], a[116:119], v[212:215]
    s_add_u32 m0, s42, 0x1e40
    ds_read_b128 a[252:255], v225 offset:24448
    v_cvt_pk_bf16_f32 v162, v152, v153
    v_mfma_f32_16x16x32_bf16 v[220:223], a[236:239], a[120:123], v[220:223]
    v_exp_f32 v154, v154
    v_mfma_f32_16x16x32_bf16 v[216:219], a[236:239], a[124:127], v[216:219]
    s_waitcnt lgkmcnt(2)
    v_exp_f32 v155, v155
    v_mfma_f32_16x16x32_bf16 v[148:151], v[48:51], v[138:141], v[148:151]
    v_cvt_pk_bf16_f32 v163, v154, v155
    v_mfma_f32_16x16x32_bf16 v[212:215], a[236:239], a[128:131], v[212:215]
    ds_read_b128 a[236:239], v225 offset:24512
    ds_read_b128 v[152:155], v228 offset:640
    v_mfma_f32_16x16x32_bf16 v[196:199], a[216:219], v[160:163], v[196:199]
    v_exp_f32 v156, v156
    v_mfma_f32_16x16x32_bf16 v[184:187], v[68:71], v[160:163], v[184:187]
    v_exp_f32 v157, v157
    v_mfma_f32_16x16x32_bf16 v[188:191], v[90:93], v[160:163], v[188:191]
    buffer_load_dwordx4 v247, s[4:7], s46 offen lds
    v_mfma_f32_16x16x32_bf16 v[192:195], v[112:115], v[160:163], v[192:195]
    s_add_u32 m0, s41, 0x3c80
    v_exp_f32 v158, v158
    v_mfma_f32_16x16x16_bf16 v[148:151], v[52:53], v[142:143], v[148:151]
    v_exp_f32 v159, v159
    v_mfma_f32_16x16x32_bf16 v[220:223], a[240:243], a[132:135], v[220:223]
    v_cvt_pk_bf16_f32 v160, v156, v157
    v_cvt_pk_bf16_f32 v161, v158, v159
    v_mfma_f32_16x16x32_bf16 v[216:219], a[240:243], a[136:139], v[216:219]
    ds_read_b128 v[156:159], v229 offset:640
    v_mfma_f32_16x16x32_bf16 v[212:215], a[240:243], a[140:143], v[212:215]
    ds_read_b128 a[240:243], v225 offset:24576
    v_mfma_f32_16x16x32_bf16 v[208:211], v[168:171], v[164:167], v[208:211]
    v_exp_f32 v144, v144
    v_mfma_f32_16x16x32_bf16 v[200:203], v[168:171], a[244:247], v[200:203]
    s_waitcnt lgkmcnt(3)
    v_cvt_pk_bf16_f32 v82, v220, v221
    v_cvt_pk_bf16_f32 v83, v222, v223
    v_mfma_f32_16x16x32_bf16 v[220:223], a[144:147], a[248:251], 0
    v_cvt_pk_bf16_f32 v104, v216, v217
    v_cvt_pk_bf16_f32 v105, v218, v219
    v_mfma_f32_16x16x32_bf16 v[216:219], a[148:151], a[248:251], 0
    v_cvt_pk_bf16_f32 v126, v212, v213
    v_cvt_pk_bf16_f32 v127, v214, v215
    v_mfma_f32_16x16x32_bf16 v[212:215], a[152:155], a[248:251], 0
    ds_read_b128 a[248:251], v225 offset:24640
    ds_read_b128 v[168:171], v242 offset:12288
    v_mfma_f32_16x16x32_bf16 v[220:223], a[156:159], a[252:255], v[220:223]
    v_exp_f32 v145, v145
    v_mfma_f32_16x16x32_bf16 v[216:219], a[160:163], a[252:255], v[216:219]
    v_exp_f32 v146, v146
    v_mfma_f32_16x16x32_bf16 v[212:215], a[164:167], a[252:255], v[212:215]
    ds_read_b128 a[252:255], v225 offset:24704
    v_cvt_pk_bf16_f32 v162, v144, v145
    v_mfma_f32_16x16x32_bf16 v[220:223], a[168:171], a[236:239], v[220:223]
    v_exp_f32 v147, v147
    v_mfma_f32_16x16x32_bf16 v[216:219], a[172:175], a[236:239], v[216:219]
    v_cvt_pk_bf16_f32 v163, v146, v147
    v_mfma_f32_16x16x32_bf16 v[212:215], a[176:179], a[236:239], v[212:215]
    ds_read_b128 a[236:239], v224 offset:46464
    ds_read_b128 v[144:147], v229 offset:1280
    v_mfma_f32_16x16x32_bf16 v[196:199], a[216:219], v[160:163], v[196:199]
    v_exp_f32 v148, v148
    v_mfma_f32_16x16x32_bf16 v[184:187], v[84:87], v[160:163], v[184:187]
    v_exp_f32 v149, v149
    v_mfma_f32_16x16x32_bf16 v[188:191], v[106:109], v[160:163], v[188:191]
    v_exp_f32 v150, v150
    v_mfma_f32_16x16x32_bf16 v[192:195], v[128:131], v[160:163], v[192:195]
    s_waitcnt lgkmcnt(4)
    v_exp_f32 v151, v151
    v_mfma_f32_16x16x32_bf16 v[220:223], a[180:183], a[240:243], v[220:223]
    v_cvt_pk_bf16_f32 v160, v148, v149
    v_cvt_pk_bf16_f32 v161, v150, v151
    v_mfma_f32_16x16x32_bf16 v[216:219], a[184:187], a[240:243], v[216:219]
    ds_read_b128 v[148:151], v228 offset:1280
    v_mfma_f32_16x16x16_bf16 v[196:199], a[216:217], v[160:161], v[196:199]
    v_mfma_f32_16x16x16_bf16 v[184:187], v[82:83], v[160:161], v[184:187]
    v_mfma_f32_16x16x16_bf16 v[188:191], v[104:105], v[160:161], v[188:191]
    v_mfma_f32_16x16x16_bf16 v[192:195], v[126:127], v[160:161], v[192:195]
    v_mfma_f32_16x16x32_bf16 v[212:215], a[188:191], a[240:243], v[212:215]
    ds_read_b128 a[240:243], v224 offset:46528
    v_mfma_f32_16x16x32_bf16 v[220:223], a[192:195], a[248:251], v[220:223]
    v_mfma_f32_16x16x32_bf16 v[216:219], a[196:199], a[248:251], v[216:219]
    v_mfma_f32_16x16x32_bf16 v[212:215], a[200:203], a[248:251], v[212:215]
    s_waitcnt lgkmcnt(2)
    ds_read_b128 a[248:251], v224 offset:46592
    v_mfma_f32_16x16x32_bf16 v[220:223], a[204:207], a[252:255], v[220:223]
    v_rcp_f32 v197, v196
    v_mfma_f32_16x16x32_bf16 v[216:219], a[208:211], a[252:255], v[216:219]
    v_mul_f32 v184, v184, v197
    v_mul_f32 v185, v185, v197
    v_mfma_f32_16x16x32_bf16 v[212:215], a[212:215], a[252:255], v[212:215]
    ds_read_b128 a[252:255], v224 offset:46656
    v_cvt_pk_bf16_f32 v184, v184, v185
    v_mfma_f32_16x16x32_bf16 v[204:207], v[248:251], v[164:167], v[204:207]
    v_mul_f32 v220, s37, v220
    v_mul_f32 v221, s37, v221
    v_mfma_f32_16x16x32_bf16 v[180:183], v[248:251], a[244:247], v[180:183]
    v_mul_f32 v222, s37, v222
    v_mul_f32 v223, s37, v223
    v_mfma_f32_16x16x32_bf16 v[176:179], v[168:171], v[164:167], v[176:179]
    v_cvt_pk_bf16_f32 v132, v220, v221
    v_cvt_pk_bf16_f32 v133, v222, v223
    v_mfma_f32_16x16x32_bf16 v[220:223], a[0:3], a[236:239], 0
    s_waitcnt lgkmcnt(2)
    v_mul_f32 v216, s37, v216
    v_mul_f32 v217, s37, v217
    v_mfma_f32_16x16x32_bf16 v[220:223], a[12:15], a[240:243], v[220:223]
    s_waitcnt lgkmcnt(1)
    v_mul_f32 v218, s37, v218
    v_mul_f32 v219, s37, v219
    v_mfma_f32_16x16x32_bf16 v[220:223], a[24:27], a[248:251], v[220:223]
    v_cvt_pk_bf16_f32 v134, v216, v217
    v_cvt_pk_bf16_f32 v135, v218, v219
    v_mfma_f32_16x16x32_bf16 v[216:219], a[4:7], a[236:239], 0
    v_mul_f32 v212, s37, v212
    v_mul_f32 v213, s37, v213
    v_mfma_f32_16x16x32_bf16 v[152:155], v[0:3], v[132:135], v[152:155]
    v_mul_f32 v214, s37, v214
    v_mul_f32 v215, s37, v215
    v_mfma_f32_16x16x32_bf16 v[156:159], v[24:27], v[132:135], v[156:159]
    v_cvt_pk_bf16_f32 v136, v212, v213
    v_cvt_pk_bf16_f32 v137, v214, v215
    v_mfma_f32_16x16x32_bf16 v[144:147], v[30:33], v[132:135], v[144:147]
    v_mul_f32 v186, v186, v197
    v_mul_f32 v187, v187, v197
    v_mfma_f32_16x16x16_bf16 v[152:155], v[4:5], v[136:137], v[152:155]
    v_cvt_pk_bf16_f32 v185, v186, v187
    v_mul_f32 v188, v188, v197
    v_mfma_f32_16x16x16_bf16 v[156:159], v[28:29], v[136:137], v[156:159]
    v_mul_f32 v189, v189, v197
    v_cvt_pk_bf16_f32 v186, v188, v189
    v_mfma_f32_16x16x16_bf16 v[144:147], v[34:35], v[136:137], v[144:147]
    v_mul_f32 v190, v190, v197
    v_mul_f32 v191, v191, v197
    v_mfma_f32_16x16x32_bf16 v[148:151], v[6:9], v[132:135], v[148:151]
    v_cvt_pk_bf16_f32 v187, v190, v191
    v_mul_f32 v192, v192, v197
    v_mfma_f32_16x16x32_bf16 v[212:215], a[8:11], a[236:239], 0
    ds_read_b128 a[236:239], v224 offset:46720
    v_mul_f32 v193, v193, v197
    v_mfma_f32_16x16x32_bf16 v[216:219], a[16:19], a[240:243], v[216:219]
    v_cvt_pk_bf16_f32 v188, v192, v193
    v_mul_f32 v194, v194, v197
    v_mfma_f32_16x16x16_bf16 v[148:151], v[10:11], v[136:137], v[148:151]
    v_mul_f32 v195, v195, v197
    v_cvt_pk_bf16_f32 v189, v194, v195
    v_mfma_f32_16x16x32_bf16 v[212:215], a[20:23], a[240:243], v[212:215]
    ds_read_b128 a[240:243], v224 offset:46784
    v_max3_f32 v236, v236, v196, v197
    v_mfma_f32_16x16x32_bf16 v[216:219], a[28:31], a[248:251], v[216:219]
    ds_write_b128 v237, v[184:187] offset:18432
    v_mfma_f32_16x16x32_bf16 v[212:215], a[32:35], a[248:251], v[212:215]
    s_waitcnt lgkmcnt(3)
    ds_write_b64 v238, v[188:189] offset:18432
    v_mfma_f32_16x16x32_bf16 v[220:223], a[36:39], a[252:255], v[220:223]
    v_exp_f32 v152, v152
    v_mfma_f32_16x16x32_bf16 v[216:219], a[40:43], a[252:255], v[216:219]
    v_exp_f32 v153, v153
    v_mfma_f32_16x16x32_bf16 v[212:215], a[44:47], a[252:255], v[212:215]
    s_waitcnt lgkmcnt(3)
    v_exp_f32 v154, v154
    v_mfma_f32_16x16x32_bf16 v[220:223], a[48:51], a[236:239], v[220:223]
    ds_read_b128 a[248:251], v224 offset:46464
    ds_read_b128 a[252:255], v224 offset:46528
    v_mfma_f32_16x16x32_bf16 v[216:219], a[52:55], a[236:239], v[216:219]
    ds_read_b128 v[248:251], v242 offset:12800
    v_cvt_pk_bf16_f32 v160, v152, v153
    v_mfma_f32_16x16x32_bf16 v[212:215], a[56:59], a[236:239], v[212:215]
    s_waitcnt lgkmcnt(5)
    ds_read_b128 a[236:239], v224 offset:46592
    v_mfma_f32_16x16x32_bf16 v[220:223], a[60:63], a[240:243], v[220:223]
    ds_read_b128 v[168:171], v241 offset:24576
    v_mfma_f32_16x16x32_bf16 v[216:219], a[64:67], a[240:243], v[216:219]
    ds_read_b128 a[244:247], v239 offset:3072
    v_mfma_f32_16x16x32_bf16 v[212:215], a[68:71], a[240:243], v[212:215]
    s_waitcnt lgkmcnt(5)
    ds_read_b128 a[240:243], v224 offset:46656
    v_exp_f32 v155, v155
    v_exp_f32 v156, v156
    v_cvt_pk_bf16_f32 v161, v154, v155
    v_cvt_pk_bf16_f32 v18, v220, v221
    v_cvt_pk_bf16_f32 v19, v222, v223
    v_cvt_pk_bf16_f32 v20, v216, v217
    v_cvt_pk_bf16_f32 v21, v218, v219
    v_cvt_pk_bf16_f32 v22, v212, v213
    v_cvt_pk_bf16_f32 v23, v214, v215
    v_mfma_f32_16x16x32_bf16 v[220:223], a[248:251], a[72:75], 0
    ds_read_b128 v[152:155], v228 offset:1920
    v_mfma_f32_16x16x32_bf16 v[216:219], a[248:251], a[76:79], 0
    s_waitcnt lgkmcnt(5)
    v_exp_f32 v157, v157
    v_mfma_f32_16x16x32_bf16 v[172:175], v[248:251], v[164:167], v[172:175]
    ds_read_b128 v[164:167], v240 offset:2048
    ds_read_b128 v[248:251], v241 offset:25088
    v_mfma_f32_16x16x32_bf16 v[212:215], a[248:251], a[80:83], 0
    s_waitcnt lgkmcnt(5)
    ds_read_b128 a[248:251], v224 offset:46720
    v_cvt_pk_bf16_f32 v162, v156, v157
    v_mfma_f32_16x16x32_bf16 v[208:211], v[168:171], v[252:255], v[208:211]
    v_exp_f32 v158, v158
    v_mfma_f32_16x16x32_bf16 v[220:223], a[252:255], a[84:87], v[220:223]
    v_exp_f32 v159, v159
    v_mfma_f32_16x16x32_bf16 v[216:219], a[252:255], a[88:91], v[216:219]
    v_cvt_pk_bf16_f32 v163, v158, v159
    v_mfma_f32_16x16x32_bf16 v[212:215], a[252:255], a[92:95], v[212:215]
    ds_read_b128 a[252:255], v224 offset:46784
    ds_read_b128 v[156:159], v229 offset:1920
    v_mfma_f32_16x16x32_bf16 v[196:199], a[216:219], v[160:163], 0
    v_exp_f32 v144, v144
    v_mfma_f32_16x16x32_bf16 v[184:187], v[66:69], v[160:163], 0
    v_exp_f32 v145, v145
    v_mfma_f32_16x16x32_bf16 v[188:191], v[88:91], v[160:163], 0
    v_exp_f32 v146, v146
    v_mfma_f32_16x16x32_bf16 v[192:195], v[110:113], v[160:163], 0
    s_waitcnt lgkmcnt(5)
    v_exp_f32 v147, v147
    v_mfma_f32_16x16x32_bf16 v[152:155], v[12:15], v[132:135], v[152:155]
    s_waitcnt lgkmcnt(4)
    v_cvt_pk_bf16_f32 v160, v144, v145
    v_cvt_pk_bf16_f32 v161, v146, v147
    v_mfma_f32_16x16x32_bf16 v[200:203], v[168:171], v[164:167], v[200:203]
    s_waitcnt lgkmcnt(3)
    ds_read_b128 v[168:171], v242 offset:24576
    ds_read_b128 v[144:147], v229 offset:2560
    v_mfma_f32_16x16x32_bf16 v[204:207], v[248:251], v[252:255], v[204:207]
    v_exp_f32 v148, v148
    v_mfma_f32_16x16x16_bf16 v[152:155], v[16:17], v[136:137], v[152:155]
    v_exp_f32 v149, v149
    v_mfma_f32_16x16x32_bf16 v[180:183], v[248:251], v[164:167], v[180:183]
    s_waitcnt lgkmcnt(2)
    ds_read_b128 v[248:251], v242 offset:25088
    ds_read_b128 v[164:167], v239 offset:4096
    v_mfma_f32_16x16x32_bf16 v[156:159], v[36:39], v[132:135], v[156:159]
    v_exp_f32 v150, v150
    v_mfma_f32_16x16x32_bf16 v[220:223], a[236:239], a[96:99], v[220:223]
    v_exp_f32 v151, v151
    v_mfma_f32_16x16x32_bf16 v[216:219], a[236:239], a[100:103], v[216:219]
    v_cvt_pk_bf16_f32 v162, v148, v149
    v_cvt_pk_bf16_f32 v163, v150, v151
    v_mfma_f32_16x16x16_bf16 v[156:159], v[40:41], v[136:137], v[156:159]
    ds_read_b128 v[148:151], v228 offset:2560
    v_mfma_f32_16x16x32_bf16 v[196:199], a[216:219], v[160:163], v[196:199]
    v_exp_f32 v152, v152
    v_mfma_f32_16x16x32_bf16 v[184:187], v[70:73], v[160:163], v[184:187]
    v_exp_f32 v153, v153
    v_mfma_f32_16x16x32_bf16 v[188:191], v[92:95], v[160:163], v[188:191]
    v_exp_f32 v154, v154
    v_mfma_f32_16x16x32_bf16 v[192:195], v[114:117], v[160:163], v[192:195]
    s_waitcnt lgkmcnt(3)
    v_exp_f32 v155, v155
    v_mfma_f32_16x16x32_bf16 v[176:179], v[168:171], v[252:255], v[176:179]
    s_waitcnt lgkmcnt(2)
    ds_read_b128 v[168:171], v241 offset:36864
    v_cvt_pk_bf16_f32 v160, v152, v153
    v_mfma_f32_16x16x32_bf16 v[172:175], v[248:251], v[252:255], v[172:175]
    ds_read_b128 v[252:255], v240 offset:3072
    ds_read_b128 v[248:251], v241 offset:37376
    v_mfma_f32_16x16x32_bf16 v[212:215], a[236:239], a[104:107], v[212:215]
    ds_read_b128 a[236:239], v224 offset:49536
    v_cvt_pk_bf16_f32 v161, v154, v155
    v_mfma_f32_16x16x32_bf16 v[220:223], a[240:243], a[108:111], v[220:223]
    s_waitcnt lgkmcnt(4)
    ds_read_b128 v[152:155], v230 offset:640
    v_mfma_f32_16x16x32_bf16 v[148:151], v[18:21], v[132:135], v[148:151]
    v_exp_f32 v156, v156
    v_mfma_f32_16x16x32_bf16 v[216:219], a[240:243], a[112:115], v[216:219]
    v_exp_f32 v157, v157
    v_mfma_f32_16x16x32_bf16 v[212:215], a[240:243], a[116:119], v[212:215]
    ds_read_b128 a[240:243], v224 offset:49600
    v_cvt_pk_bf16_f32 v162, v156, v157
    v_mfma_f32_16x16x16_bf16 v[148:151], v[22:23], v[136:137], v[148:151]
    v_exp_f32 v158, v158
    v_mfma_f32_16x16x32_bf16 v[220:223], a[248:251], a[120:123], v[220:223]
    v_exp_f32 v159, v159
    v_mfma_f32_16x16x32_bf16 v[216:219], a[248:251], a[124:127], v[216:219]
    v_cvt_pk_bf16_f32 v163, v158, v159
    v_mfma_f32_16x16x32_bf16 v[212:215], a[248:251], a[128:131], v[212:215]
    ds_read_b128 a[248:251], v224 offset:49664
    ds_read_b128 v[156:159], v230 offset:1280
    v_mfma_f32_16x16x32_bf16 v[196:199], a[216:219], v[160:163], v[196:199]
    v_exp_f32 v148, v148
    v_mfma_f32_16x16x32_bf16 v[184:187], v[74:77], v[160:163], v[184:187]
    v_exp_f32 v149, v149
    v_mfma_f32_16x16x32_bf16 v[188:191], v[96:99], v[160:163], v[188:191]
    v_exp_f32 v150, v150
    v_mfma_f32_16x16x32_bf16 v[192:195], v[118:121], v[160:163], v[192:195]
    v_exp_f32 v151, v151
    v_mfma_f32_16x16x32_bf16 v[220:223], a[252:255], a[132:135], v[220:223]
    v_cvt_pk_bf16_f32 v162, v148, v149
    v_cvt_pk_bf16_f32 v163, v150, v151
    v_mfma_f32_16x16x32_bf16 v[216:219], a[252:255], a[136:139], v[216:219]
    ds_read_b128 v[148:151], v230 offset:2560
    v_mfma_f32_16x16x32_bf16 v[212:215], a[252:255], a[140:143], v[212:215]
    s_waitcnt lgkmcnt(3)
    ds_read_b128 a[252:255], v224 offset:49728
    v_mfma_f32_16x16x32_bf16 v[208:211], v[168:171], a[244:247], v[208:211]
    v_mfma_f32_16x16x32_bf16 v[200:203], v[168:171], v[252:255], v[200:203]
    v_cvt_pk_bf16_f32 v80, v220, v221
    v_cvt_pk_bf16_f32 v81, v222, v223
    v_mfma_f32_16x16x32_bf16 v[204:207], v[248:251], a[244:247], v[204:207]
    v_cvt_pk_bf16_f32 v102, v216, v217
    v_cvt_pk_bf16_f32 v103, v218, v219
    v_mfma_f32_16x16x32_bf16 v[180:183], v[248:251], v[252:255], v[180:183]
    v_cvt_pk_bf16_f32 v124, v212, v213
    v_cvt_pk_bf16_f32 v125, v214, v215
    v_mfma_f32_16x16x32_bf16 v[220:223], a[0:3], a[236:239], 0
    ds_read_b128 v[168:171], v242 offset:36864
    ds_read_b128 v[248:251], v242 offset:37376
    v_mfma_f32_16x16x32_bf16 v[216:219], a[4:7], a[236:239], 0
    ds_read_b128 v[252:255], v239 offset:5120
    v_mfma_f32_16x16x32_bf16 v[212:215], a[8:11], a[236:239], 0
    ds_read_b128 a[236:239], v224 offset:49792
    v_mfma_f32_16x16x32_bf16 v[220:223], a[12:15], a[240:243], v[220:223]
    v_mfma_f32_16x16x32_bf16 v[216:219], a[16:19], a[240:243], v[216:219]
L_pg6:
    s_cbranch_execz L_back
    v_mfma_f32_16x16x32_bf16 v[212:215], a[20:23], a[240:243], v[212:215]
    s_waitcnt lgkmcnt(4)
    ds_read_b128 a[240:243], v224 offset:49856
    v_mfma_f32_16x16x32_bf16 v[220:223], a[24:27], a[248:251], v[220:223]
    v_mfma_f32_16x16x32_bf16 v[216:219], a[28:31], a[248:251], v[216:219]
    v_mfma_f32_16x16x32_bf16 v[212:215], a[32:35], a[248:251], v[212:215]
    s_waitcnt lgkmcnt(4)
    ds_read_b128 a[248:251], v224 offset:49536
    v_mfma_f32_16x16x32_bf16 v[176:179], v[168:171], a[244:247], v[176:179]
    s_waitcnt lgkmcnt(4)
    ds_read_b128 v[168:171], v241 offset:49152
    v_mfma_f32_16x16x32_bf16 v[172:175], v[248:251], a[244:247], v[172:175]
    ds_read_b128 a[244:247], v240 offset:4096
    ds_read_b128 v[248:251], v241 offset:49664
    v_mfma_f32_16x16x32_bf16 v[220:223], a[36:39], a[252:255], v[220:223]
    v_mfma_f32_16x16x32_bf16 v[216:219], a[40:43], a[252:255], v[216:219]
    v_mfma_f32_16x16x32_bf16 v[212:215], a[44:47], a[252:255], v[212:215]
    s_waitcnt lgkmcnt(5)
    ds_read_b128 a[252:255], v224 offset:49600
    v_mfma_f32_16x16x32_bf16 v[220:223], a[48:51], a[236:239], v[220:223]
    v_mfma_f32_16x16x32_bf16 v[216:219], a[52:55], a[236:239], v[216:219]
    v_mfma_f32_16x16x32_bf16 v[212:215], a[56:59], a[236:239], v[212:215]
    s_waitcnt lgkmcnt(5)
    ds_read_b128 a[236:239], v224 offset:49664
    v_mfma_f32_16x16x32_bf16 v[220:223], a[60:63], a[240:243], v[220:223]
    v_mfma_f32_16x16x32_bf16 v[216:219], a[64:67], a[240:243], v[216:219]
    v_mfma_f32_16x16x32_bf16 v[212:215], a[68:71], a[240:243], v[212:215]
    s_waitcnt lgkmcnt(4)
    ds_read_b128 a[240:243], v224 offset:49728
    v_mfma_f32_16x16x32_bf16 v[208:211], v[168:171], v[164:167], v[208:211]
    s_waitcnt lgkmcnt(4)
    v_mfma_f32_16x16x32_bf16 v[200:203], v[168:171], a[244:247], v[200:203]
    s_waitcnt lgkmcnt(3)
    ds_read_b128 v[168:171], v242 offset:49152
    v_mfma_f32_16x16x32_bf16 v[204:207], v[248:251], v[164:167], v[204:207]
    v_mfma_f32_16x16x32_bf16 v[180:183], v[248:251], a[244:247], v[180:183]
    v_cvt_pk_bf16_f32 v42, v220, v221
    v_cvt_pk_bf16_f32 v43, v222, v223
    v_mfma_f32_16x16x32_bf16 v[220:223], a[248:251], a[72:75], 0
    v_cvt_pk_bf16_f32 v44, v216, v217
    v_cvt_pk_bf16_f32 v45, v218, v219
    v_mfma_f32_16x16x32_bf16 v[216:219], a[248:251], a[76:79], 0
    v_cvt_pk_bf16_f32 v46, v212, v213
    v_cvt_pk_bf16_f32 v47, v214, v215
    v_mfma_f32_16x16x32_bf16 v[144:147], v[42:45], v[132:135], v[144:147]
    ds_read_b128 v[248:251], v242 offset:49664
    v_mfma_f32_16x16x32_bf16 v[212:215], a[248:251], a[80:83], 0
    s_waitcnt lgkmcnt(3)
    ds_read_b128 a[248:251], v224 offset:49792
    v_mfma_f32_16x16x32_bf16 v[220:223], a[252:255], a[84:87], v[220:223]
    v_mfma_f32_16x16x32_bf16 v[216:219], a[252:255], a[88:91], v[216:219]
    s_waitcnt lgkmcnt(2)
    v_mfma_f32_16x16x32_bf16 v[176:179], v[168:171], v[164:167], v[176:179]
    ds_read_b128 v[168:171], v241 offset:61440
    v_mfma_f32_16x16x16_bf16 v[144:147], v[46:47], v[136:137], v[144:147]
    v_mfma_f32_16x16x32_bf16 v[212:215], a[252:255], a[92:95], v[212:215]
    ds_read_b128 a[252:255], v224 offset:49856
    v_mfma_f32_16x16x32_bf16 v[220:223], a[236:239], a[96:99], v[220:223]
    v_mfma_f32_16x16x32_bf16 v[216:219], a[236:239], a[100:103], v[216:219]
    s_waitcnt lgkmcnt(3)
    v_mfma_f32_16x16x32_bf16 v[172:175], v[248:251], v[164:167], v[172:175]
    ds_read_b128 v[164:167], v240 offset:5120
    ds_read_b128 v[248:251], v241 offset:61952
    v_mfma_f32_16x16x32_bf16 v[212:215], a[236:239], a[104:107], v[212:215]
    ds_read_b128 a[236:239], v225 offset:27456
    v_mfma_f32_16x16x32_bf16 v[220:223], a[240:243], a[108:111], v[220:223]
    v_exp_f32 v144, v144
    v_mfma_f32_16x16x32_bf16 v[216:219], a[240:243], a[112:115], v[216:219]
    v_exp_f32 v145, v145
    v_mfma_f32_16x16x32_bf16 v[212:215], a[240:243], a[116:119], v[212:215]
    s_waitcnt lgkmcnt(5)
    ds_read_b128 a[240:243], v225 offset:27520
    v_cvt_pk_bf16_f32 v160, v144, v145
    v_mfma_f32_16x16x32_bf16 v[220:223], a[248:251], a[120:123], v[220:223]
    v_exp_f32 v146, v146
    v_mfma_f32_16x16x32_bf16 v[216:219], a[248:251], a[124:127], v[216:219]
    v_exp_f32 v147, v147
    v_mfma_f32_16x16x32_bf16 v[212:215], a[248:251], a[128:131], v[212:215]
    s_waitcnt lgkmcnt(4)
    ds_read_b128 a[248:251], v225 offset:27584
    v_cvt_pk_bf16_f32 v161, v146, v147
    v_mfma_f32_16x16x32_bf16 v[220:223], a[252:255], a[132:135], v[220:223]
    ds_read_b128 v[144:147], v230 offset:1920
    v_mfma_f32_16x16x32_bf16 v[196:199], a[216:219], v[160:163], v[196:199]
    v_mfma_f32_16x16x32_bf16 v[216:219], a[252:255], a[136:139], v[216:219]
    v_mfma_f32_16x16x32_bf16 v[212:215], a[252:255], a[140:143], v[212:215]
    ds_read_b128 a[252:255], v225 offset:27648
    v_mfma_f32_16x16x32_bf16 v[208:211], v[168:171], v[252:255], v[208:211]
    s_waitcnt lgkmcnt(4)
    v_mfma_f32_16x16x32_bf16 v[200:203], v[168:171], v[164:167], v[200:203]
    ds_read_b128 v[168:171], v242 offset:61440
    v_cvt_pk_bf16_f32 v78, v220, v221
    v_mfma_f32_16x16x32_bf16 v[204:207], v[248:251], v[252:255], v[204:207]
    v_cvt_pk_bf16_f32 v79, v222, v223
    v_cvt_pk_bf16_f32 v100, v216, v217
    v_mfma_f32_16x16x32_bf16 v[180:183], v[248:251], v[164:167], v[180:183]
    v_cvt_pk_bf16_f32 v101, v218, v219
    v_cvt_pk_bf16_f32 v122, v212, v213
    v_mfma_f32_16x16x32_bf16 v[184:187], v[78:81], v[160:163], v[184:187]
    ds_read_b128 v[248:251], v242 offset:61952
    v_cvt_pk_bf16_f32 v123, v214, v215
    v_mfma_f32_16x16x32_bf16 v[188:191], v[100:103], v[160:163], v[188:191]
    v_cvt_pk_bf16_f32 v208, v208, v209
    v_cvt_pk_bf16_f32 v209, v210, v211
    v_mfma_f32_16x16x32_bf16 v[192:195], v[122:125], v[160:163], v[192:195]
    v_cvt_pk_bf16_f32 v210, v204, v205
    v_cvt_pk_bf16_f32 v211, v206, v207
    v_mfma_f32_16x16x32_bf16 v[220:223], a[144:147], a[236:239], 0
    buffer_store_dwordx4 v[208:211], v243, s[20:23], s58 offen sc0 sc1
    v_mfma_f32_16x16x32_bf16 v[216:219], a[148:151], a[236:239], 0
    s_waitcnt lgkmcnt(1)
    v_cvt_pk_bf16_f32 v200, v200, v201
    v_cvt_pk_bf16_f32 v201, v202, v203
    v_mfma_f32_16x16x32_bf16 v[176:179], v[168:171], v[252:255], v[176:179]
    v_cvt_pk_bf16_f32 v202, v180, v181
    v_cvt_pk_bf16_f32 v203, v182, v183
    v_mfma_f32_16x16x32_bf16 v[212:215], a[152:155], a[236:239], 0
    ds_read_b128 a[236:239], v225 offset:27712
    ds_read_b128 v[168:171], v241 offset:12288
    v_mfma_f32_16x16x32_bf16 v[220:223], a[156:159], a[240:243], v[220:223]
    s_waitcnt lgkmcnt(2)
    v_rcp_f32 v197, v196
    v_mfma_f32_16x16x32_bf16 v[172:175], v[248:251], v[252:255], v[172:175]
    v_cvt_pk_bf16_f32 v176, v176, v177
    v_cvt_pk_bf16_f32 v177, v178, v179
    v_mfma_f32_16x16x32_bf16 v[216:219], a[160:163], a[240:243], v[216:219]
    v_mul_f32 v184, v184, v197
    v_mul_f32 v185, v185, v197
    v_mfma_f32_16x16x32_bf16 v[212:215], a[164:167], a[240:243], v[212:215]
    ds_read_b128 a[240:243], v225 offset:27776
    v_cvt_pk_bf16_f32 v184, v184, v185
    v_mfma_f32_16x16x32_bf16 v[220:223], a[168:171], a[248:251], v[220:223]
    v_cvt_pk_bf16_f32 v178, v172, v173
    v_cvt_pk_bf16_f32 v179, v174, v175
    v_mfma_f32_16x16x32_bf16 v[216:219], a[172:175], a[248:251], v[216:219]
    v_mul_f32 v186, v186, v197
    v_mul_f32 v187, v187, v197
    v_mfma_f32_16x16x32_bf16 v[212:215], a[176:179], a[248:251], v[212:215]
    ds_read_b128 a[248:251], v225 offset:39872
    v_cvt_pk_bf16_f32 v185, v186, v187
    v_mfma_f32_16x16x32_bf16 v[220:223], a[180:183], a[252:255], v[220:223]
    v_mul_f32 v188, v188, v197
    v_mul_f32 v189, v189, v197
    v_mfma_f32_16x16x32_bf16 v[216:219], a[184:187], a[252:255], v[216:219]
    buffer_store_dwordx4 v[200:203], v245, s[20:23], s58 offen sc0 sc1
    v_mfma_f32_16x16x32_bf16 v[212:215], a[188:191], a[252:255], v[212:215]
    s_waitcnt lgkmcnt(2)
    ds_read_b128 a[252:255], v225 offset:39936
    v_cvt_pk_bf16_f32 v186, v188, v189
    v_mfma_f32_16x16x32_bf16 v[220:223], a[192:195], a[236:239], v[220:223]
    s_waitcnt vmcnt(2) lgkmcnt(2)
    v_mul_f32 v190, v190, v197
    v_mul_f32 v191, v191, v197
    v_mfma_f32_16x16x32_bf16 v[216:219], a[196:199], a[236:239], v[216:219]
    s_barrier
    v_cvt_pk_bf16_f32 v187, v190, v191
    v_mul_f32 v192, v192, v197
    v_mfma_f32_16x16x32_bf16 v[212:215], a[200:203], a[236:239], v[212:215]
    ds_read_b128 a[236:239], v225 offset:40000
    v_mul_f32 v193, v193, v197
    v_mfma_f32_16x16x32_bf16 v[220:223], a[204:207], a[240:243], v[220:223]
    v_cvt_pk_bf16_f32 v188, v192, v193
    v_mul_f32 v194, v194, v197
    v_mfma_f32_16x16x32_bf16 v[216:219], a[208:211], a[240:243], v[216:219]
    v_mul_f32 v195, v195, v197
    v_cvt_pk_bf16_f32 v189, v194, v195
    v_mfma_f32_16x16x32_bf16 v[212:215], a[212:215], a[240:243], v[212:215]
    s_waitcnt lgkmcnt(2)
    ds_read_b128 a[240:243], v225 offset:40064
    v_max3_f32 v236, v236, v196, v197
    v_mul_f32 v220, s37, v220
    v_mul_f32 v221, s37, v221
    v_mul_f32 v222, s37, v222
    v_mul_f32 v223, s37, v223
    v_cvt_pk_bf16_f32 v138, v220, v221
    v_cvt_pk_bf16_f32 v139, v222, v223
    v_mfma_f32_16x16x32_bf16 v[220:223], a[144:147], a[248:251], 0
    s_waitcnt lgkmcnt(2)
    v_mul_f32 v216, s37, v216
    v_mul_f32 v217, s37, v217
    v_mfma_f32_16x16x32_bf16 v[220:223], a[156:159], a[252:255], v[220:223]
    v_mul_f32 v218, s37, v218
    v_mul_f32 v219, s37, v219
    v_cvt_pk_bf16_f32 v140, v216, v217
    v_cvt_pk_bf16_f32 v141, v218, v219
    v_mfma_f32_16x16x32_bf16 v[216:219], a[148:151], a[248:251], 0
    v_mul_f32 v212, s37, v212
    v_mul_f32 v213, s37, v213
    v_mfma_f32_16x16x32_bf16 v[152:155], v[24:27], v[138:141], v[152:155]
    v_mul_f32 v214, s37, v214
    v_mul_f32 v215, s37, v215
    v_mfma_f32_16x16x32_bf16 v[156:159], v[30:33], v[138:141], v[156:159]
    v_cvt_pk_bf16_f32 v142, v212, v213
    v_cvt_pk_bf16_f32 v143, v214, v215
    v_mfma_f32_16x16x32_bf16 v[144:147], v[36:39], v[138:141], v[144:147]
    buffer_store_dwordx4 v[176:179], v244, s[20:23], s58 offen sc0 sc1
    v_mfma_f32_16x16x16_bf16 v[152:155], v[28:29], v[142:143], v[152:155]
    s_add_u32 s58, s51, 0xfc000
    ds_write_b128 v237, v[184:187]
    v_mfma_f32_16x16x16_bf16 v[156:159], v[34:35], v[142:143], v[156:159]
    ds_write_b64 v238, v[188:189]
    v_mfma_f32_16x16x16_bf16 v[144:147], v[40:41], v[142:143], v[144:147]
    v_mfma_f32_16x16x32_bf16 v[148:151], v[42:45], v[138:141], v[148:151]
    v_mfma_f32_16x16x32_bf16 v[212:215], a[152:155], a[248:251], 0
    v_mfma_f32_16x16x32_bf16 v[216:219], a[160:163], a[252:255], v[216:219]
    ds_read_b128 a[248:251], v225 offset:40128
    ds_read_b128 a[244:247], v239 offset:12288
    v_mfma_f32_16x16x32_bf16 v[212:215], a[164:167], a[252:255], v[212:215]
    ds_read_b128 a[252:255], v225 offset:40192
    v_mfma_f32_16x16x16_bf16 v[148:151], v[46:47], v[142:143], v[148:151]
    s_waitcnt lgkmcnt(5)
    ds_read_b128 v[252:255], v240 offset:12288
    v_mfma_f32_16x16x32_bf16 v[220:223], a[168:171], a[236:239], v[220:223]
    ds_read_b128 v[164:167], v239 offset:13312
    v_mfma_f32_16x16x32_bf16 v[216:219], a[172:175], a[236:239], v[216:219]
    ds_read_b128 v[248:251], v241 offset:12800
    v_mfma_f32_16x16x32_bf16 v[212:215], a[176:179], a[236:239], v[212:215]
    ds_read_b128 a[236:239], v224
    v_mfma_f32_16x16x32_bf16 v[220:223], a[180:183], a[240:243], v[220:223]
    buffer_load_dwordx4 v246, s[4:7], s47 offen lds
    v_mfma_f32_16x16x32_bf16 v[216:219], a[184:187], a[240:243], v[216:219]
    s_add_u32 m0, s42, 0x3c80
    v_exp_f32 v152, v152
    v_mfma_f32_16x16x32_bf16 v[212:215], a[188:191], a[240:243], v[212:215]
    s_waitcnt lgkmcnt(6)
    ds_read_b128 a[240:243], v224 offset:64
    v_mfma_f32_16x16x32_bf16 v[220:223], a[192:195], a[248:251], v[220:223]
    v_exp_f32 v153, v153
    v_mfma_f32_16x16x32_bf16 v[216:219], a[196:199], a[248:251], v[216:219]
    v_exp_f32 v154, v154
    v_mfma_f32_16x16x32_bf16 v[212:215], a[200:203], a[248:251], v[212:215]
    s_waitcnt lgkmcnt(5)
    ds_read_b128 a[248:251], v224 offset:128
    v_cvt_pk_bf16_f32 v160, v152, v153
    v_mfma_f32_16x16x32_bf16 v[220:223], a[204:207], a[252:255], v[220:223]
    v_exp_f32 v155, v155
    v_mfma_f32_16x16x32_bf16 v[216:219], a[208:211], a[252:255], v[216:219]
    v_cvt_pk_bf16_f32 v161, v154, v155
    v_mfma_f32_16x16x32_bf16 v[212:215], a[212:215], a[252:255], v[212:215]
    ds_read_b128 a[252:255], v224 offset:192
    ds_read_b128 v[152:155], v235
    v_mfma_f32_16x16x32_bf16 v[208:211], a[220:223], a[244:247], 0
    s_waitcnt lgkmcnt(5)
    buffer_load_dwordx4 v247, s[4:7], s47 offen lds
    v_mfma_f32_16x16x32_bf16 v[200:203], a[220:223], v[252:255], 0
    s_add_u32 m0, s41, 0x5ac0
    v_mul_f32 v220, s37, v220
    v_mul_f32 v221, s37, v221
    v_mfma_f32_16x16x32_bf16 v[204:207], a[224:227], a[244:247], 0
    v_mul_f32 v222, s37, v222
    v_mul_f32 v223, s37, v223
    v_mfma_f32_16x16x32_bf16 v[180:183], a[224:227], v[252:255], 0
    v_cvt_pk_bf16_f32 v132, v220, v221
    v_cvt_pk_bf16_f32 v133, v222, v223
    v_mfma_f32_16x16x32_bf16 v[176:179], a[228:231], a[244:247], 0
    v_mul_f32 v216, s37, v216
    v_mul_f32 v217, s37, v217
    v_mfma_f32_16x16x32_bf16 v[172:175], a[232:235], a[244:247], 0
    s_waitcnt lgkmcnt(3)
    v_mul_f32 v218, s37, v218
    v_mul_f32 v219, s37, v219
    v_mfma_f32_16x16x32_bf16 v[220:223], a[0:3], a[236:239], 0
    v_cvt_pk_bf16_f32 v134, v216, v217
    v_cvt_pk_bf16_f32 v135, v218, v219
    v_mfma_f32_16x16x32_bf16 v[216:219], a[4:7], a[236:239], 0
    v_mul_f32 v212, s37, v212
    v_mul_f32 v213, s37, v213
    v_mfma_f32_16x16x32_bf16 v[220:223], a[12:15], a[240:243], v[220:223]
    s_waitcnt lgkmcnt(0)
    v_mul_f32 v214, s37, v214
    v_mul_f32 v215, s37, v215
    v_mfma_f32_16x16x32_bf16 v[152:155], v[60:63], v[138:141], v[152:155]
    v_cvt_pk_bf16_f32 v136, v212, v213
    v_cvt_pk_bf16_f32 v137, v214, v215
    v_mfma_f32_16x16x32_bf16 v[212:215], a[8:11], a[236:239], 0
    ds_read_b128 a[236:239], v224 offset:256
    ds_read_b128 a[244:247], v240 offset:13312
    v_mfma_f32_16x16x32_bf16 v[216:219], a[16:19], a[240:243], v[216:219]
    buffer_load_dwordx4 v246, s[4:7], s48 offen lds
    v_mfma_f32_16x16x16_bf16 v[152:155], v[64:65], v[142:143], v[152:155]
    s_add_u32 m0, s42, 0x5ac0
    ds_read_b128 v[252:255], v239 offset:14336
    v_bfe_u32 v235, s73, v232, 4
    v_mfma_f32_16x16x32_bf16 v[212:215], a[20:23], a[240:243], v[212:215]
    ds_read_b128 a[240:243], v224 offset:320
    v_cndmask_b32 v246, v245, v243, vcc
    v_mfma_f32_16x16x32_bf16 v[220:223], a[24:27], a[248:251], v[220:223]
    v_exp_f32 v156, v156
    v_mfma_f32_16x16x32_bf16 v[216:219], a[28:31], a[248:251], v[216:219]
    v_exp_f32 v157, v157
    v_mfma_f32_16x16x32_bf16 v[212:215], a[32:35], a[248:251], v[212:215]
    ds_read_b128 a[248:251], v224
    v_cvt_pk_bf16_f32 v162, v156, v157
    v_mfma_f32_16x16x32_bf16 v[220:223], a[36:39], a[252:255], v[220:223]
    v_exp_f32 v158, v158
    v_mfma_f32_16x16x32_bf16 v[216:219], a[40:43], a[252:255], v[216:219]
    v_exp_f32 v159, v159
    v_mfma_f32_16x16x32_bf16 v[212:215], a[44:47], a[252:255], v[212:215]
    s_waitcnt lgkmcnt(4)
    ds_read_b128 a[252:255], v224 offset:64
    v_cvt_pk_bf16_f32 v163, v158, v159
    v_mfma_f32_16x16x32_bf16 v[220:223], a[48:51], a[236:239], v[220:223]
    buffer_load_dwordx4 v247, s[4:7], s48 offen lds
    v_mfma_f32_16x16x32_bf16 v[196:199], a[216:219], v[160:163], 0
    ds_read_b128 v[156:159], v234
    v_mad_u32_u24 v234, v235, s40, v229
    v_mfma_f32_16x16x32_bf16 v[184:187], v[68:71], v[160:163], 0
    v_mad_u32_u24 v235, v235, s40, v228
    v_bfrev_b32 v247, 1
    v_mfma_f32_16x16x32_bf16 v[188:191], v[90:93], v[160:163], 0
    v_exp_f32 v144, v144
    v_mfma_f32_16x16x32_bf16 v[192:195], v[112:115], v[160:163], 0
    v_exp_f32 v145, v145
    v_mfma_f32_16x16x32_bf16 v[216:219], a[52:55], a[236:239], v[216:219]
    v_exp_f32 v146, v146
    v_mfma_f32_16x16x32_bf16 v[212:215], a[56:59], a[236:239], v[212:215]
    s_waitcnt lgkmcnt(2)
    ds_read_b128 a[236:239], v224 offset:128
    v_cvt_pk_bf16_f32 v160, v144, v145
    v_mfma_f32_16x16x32_bf16 v[220:223], a[60:63], a[240:243], v[220:223]
    v_exp_f32 v147, v147
    v_mfma_f32_16x16x32_bf16 v[216:219], a[64:67], a[240:243], v[216:219]
    v_cvt_pk_bf16_f32 v161, v146, v147
    v_mfma_f32_16x16x32_bf16 v[212:215], a[68:71], a[240:243], v[212:215]
    s_waitcnt lgkmcnt(1)
    ds_read_b128 a[240:243], v224 offset:192
    ds_read_b128 v[144:147], v234
    v_mfma_f32_16x16x32_bf16 v[156:159], v[48:51], v[138:141], v[156:159]
    v_exp_f32 v148, v148
    v_mfma_f32_16x16x32_bf16 v[208:211], v[168:171], v[164:167], v[208:211]
    v_cvt_pk_bf16_f32 v0, v220, v221
    v_cvt_pk_bf16_f32 v1, v222, v223
    v_mfma_f32_16x16x32_bf16 v[200:203], v[168:171], a[244:247], v[200:203]
    v_cvt_pk_bf16_f32 v2, v216, v217
    v_cvt_pk_bf16_f32 v3, v218, v219
    v_mfma_f32_16x16x16_bf16 v[156:159], v[52:53], v[142:143], v[156:159]
    v_cvt_pk_bf16_f32 v4, v212, v213
    v_cvt_pk_bf16_f32 v5, v214, v215
    v_mfma_f32_16x16x32_bf16 v[204:207], v[248:251], v[164:167], v[204:207]
    ds_read_b128 v[168:171], v242 offset:12288
    v_mfma_f32_16x16x32_bf16 v[180:183], v[248:251], a[244:247], v[180:183]
    ds_read_b128 v[248:251], v242 offset:12800
    ds_read_b128 a[244:247], v239 offset:15360
    v_mfma_f32_16x16x32_bf16 v[220:223], a[248:251], a[72:75], 0
    v_exp_f32 v149, v149
    v_mfma_f32_16x16x32_bf16 v[216:219], a[248:251], a[76:79], 0
    v_exp_f32 v150, v150
    v_mfma_f32_16x16x32_bf16 v[212:215], a[248:251], a[80:83], 0
    s_waitcnt lgkmcnt(3)
    ds_read_b128 a[248:251], v224 offset:256
    v_cvt_pk_bf16_f32 v162, v148, v149
    v_mfma_f32_16x16x32_bf16 v[144:147], v[30:33], v[132:135], v[144:147]
    v_exp_f32 v151, v151
    v_mfma_f32_16x16x32_bf16 v[220:223], a[252:255], a[84:87], v[220:223]
    v_cvt_pk_bf16_f32 v163, v150, v151
    v_mfma_f32_16x16x32_bf16 v[216:219], a[252:255], a[88:91], v[216:219]
    ds_read_b128 v[148:151], v235
    v_bfe_u32 v235, s74, v232, 4
    v_mfma_f32_16x16x32_bf16 v[196:199], a[216:219], v[160:163], v[196:199]
    v_mad_u32_u24 v234, v235, s40, v228
    v_mad_u32_u24 v235, v235, s40, v229
    v_mfma_f32_16x16x32_bf16 v[184:187], v[76:79], v[160:163], v[184:187]
    v_exp_f32 v152, v152
    v_mfma_f32_16x16x32_bf16 v[188:191], v[98:101], v[160:163], v[188:191]
    v_exp_f32 v153, v153
    v_mfma_f32_16x16x32_bf16 v[192:195], v[120:123], v[160:163], v[192:195]
    v_exp_f32 v154, v154
    v_mfma_f32_16x16x16_bf16 v[144:147], v[34:35], v[136:137], v[144:147]
    s_waitcnt lgkmcnt(2)
    v_exp_f32 v155, v155
    v_mfma_f32_16x16x32_bf16 v[176:179], v[168:171], v[164:167], v[176:179]
    ds_read_b128 v[168:171], v241 offset:24576
    v_cvt_pk_bf16_f32 v160, v152, v153
    v_mfma_f32_16x16x32_bf16 v[172:175], v[248:251], v[164:167], v[172:175]
    ds_read_b128 v[164:167], v240 offset:14336
    ds_read_b128 v[248:251], v241 offset:25088
    v_mfma_f32_16x16x32_bf16 v[212:215], a[252:255], a[92:95], v[212:215]
    s_waitcnt lgkmcnt(3)
    ds_read_b128 a[252:255], v224 offset:320
    v_cvt_pk_bf16_f32 v161, v154, v155
    v_mfma_f32_16x16x32_bf16 v[148:151], v[6:9], v[132:135], v[148:151]
    ds_read_b128 v[152:155], v228 offset:1280
    v_mfma_f32_16x16x16_bf16 v[196:199], a[216:217], v[160:161], v[196:199]
    v_exp_f32 v156, v156
    v_mfma_f32_16x16x16_bf16 v[184:187], v[86:87], v[160:161], v[184:187]
    v_exp_f32 v157, v157
    v_mfma_f32_16x16x16_bf16 v[188:191], v[108:109], v[160:161], v[188:191]
    v_exp_f32 v158, v158
    v_mfma_f32_16x16x16_bf16 v[192:195], v[130:131], v[160:161], v[192:195]
    v_exp_f32 v159, v159
    v_mfma_f32_16x16x16_bf16 v[148:151], v[10:11], v[136:137], v[148:151]
    v_cvt_pk_bf16_f32 v160, v156, v157
    v_cvt_pk_bf16_f32 v161, v158, v159
    v_mfma_f32_16x16x32_bf16 v[220:223], a[236:239], a[96:99], v[220:223]
    ds_read_b128 v[156:159], v229 offset:1280
    v_mfma_f32_16x16x16_bf16 v[196:199], a[216:217], v[160:161], v[196:199]
    v_exp_f32 v144, v144
    v_mfma_f32_16x16x16_bf16 v[184:187], v[82:83], v[160:161], v[184:187]
    v_exp_f32 v145, v145
    v_mfma_f32_16x16x16_bf16 v[188:191], v[104:105], v[160:161], v[188:191]
    v_exp_f32 v146, v146
    v_mfma_f32_16x16x16_bf16 v[192:195], v[126:127], v[160:161], v[192:195]
    s_waitcnt lgkmcnt(1)
    v_exp_f32 v147, v147
    v_mfma_f32_16x16x32_bf16 v[152:155], v[12:15], v[132:135], v[152:155]
    v_rcp_f32 v197, v196
    v_mfma_f32_16x16x32_bf16 v[216:219], a[236:239], a[100:103], v[216:219]
    v_mul_f32 v184, v184, v197
    v_mul_f32 v185, v185, v197
    v_mfma_f32_16x16x32_bf16 v[212:215], a[236:239], a[104:107], v[212:215]
    ds_read_b128 a[236:239], v224 offset:3072
    v_cvt_pk_bf16_f32 v184, v184, v185
    v_mfma_f32_16x16x16_bf16 v[152:155], v[16:17], v[136:137], v[152:155]
    s_waitcnt lgkmcnt(1)
    v_mul_f32 v186, v186, v197
    v_mul_f32 v187, v187, v197
    v_mfma_f32_16x16x32_bf16 v[156:159], v[36:39], v[132:135], v[156:159]
    v_cvt_pk_bf16_f32 v185, v186, v187
    v_mul_f32 v188, v188, v197
    v_mfma_f32_16x16x32_bf16 v[220:223], a[240:243], a[108:111], v[220:223]
    v_mul_f32 v189, v189, v197
    v_cvt_pk_bf16_f32 v186, v188, v189
    v_mfma_f32_16x16x32_bf16 v[216:219], a[240:243], a[112:115], v[216:219]
    v_mul_f32 v190, v190, v197
    v_mul_f32 v191, v191, v197
    v_mfma_f32_16x16x16_bf16 v[156:159], v[40:41], v[136:137], v[156:159]
    v_cvt_pk_bf16_f32 v187, v190, v191
    v_mul_f32 v192, v192, v197
    v_mfma_f32_16x16x32_bf16 v[212:215], a[240:243], a[116:119], v[212:215]
    ds_read_b128 a[240:243], v224 offset:3136
    v_mul_f32 v193, v193, v197
    v_mfma_f32_16x16x32_bf16 v[220:223], a[248:251], a[120:123], v[220:223]
    v_cvt_pk_bf16_f32 v188, v192, v193
    v_mul_f32 v194, v194, v197
    v_mfma_f32_16x16x32_bf16 v[216:219], a[248:251], a[124:127], v[216:219]
    v_mul_f32 v195, v195, v197
    v_cvt_pk_bf16_f32 v189, v194, v195
    v_mfma_f32_16x16x32_bf16 v[212:215], a[248:251], a[128:131], v[212:215]
    ds_read_b128 a[248:251], v224 offset:3200
    v_max3_f32 v236, v236, v196, v197
    v_mfma_f32_16x16x32_bf16 v[220:223], a[252:255], a[132:135], v[220:223]
    ds_write_b128 v237, v[184:187] offset:6144
    v_mfma_f32_16x16x32_bf16 v[216:219], a[252:255], a[136:139], v[216:219]
    ds_write_b64 v238, v[188:189] offset:6144
    v_mfma_f32_16x16x32_bf16 v[212:215], a[252:255], a[140:143], v[212:215]
    v_cvt_pk_bf16_f32 v160, v144, v145
    v_cvt_pk_bf16_f32 v161, v146, v147
    v_mfma_f32_16x16x32_bf16 v[208:211], v[168:171], v[252:255], v[208:211]
    v_exp_f32 v148, v148
    v_mfma_f32_16x16x32_bf16 v[200:203], v[168:171], v[164:167], v[200:203]
    v_cvt_pk_bf16_f32 v66, v220, v221
    v_cvt_pk_bf16_f32 v67, v222, v223
    v_mfma_f32_16x16x32_bf16 v[204:207], v[248:251], v[252:255], v[204:207]
    v_cvt_pk_bf16_f32 v88, v216, v217
    v_cvt_pk_bf16_f32 v89, v218, v219
    v_mfma_f32_16x16x32_bf16 v[180:183], v[248:251], v[164:167], v[180:183]
    s_waitcnt lgkmcnt(3)
    v_cvt_pk_bf16_f32 v110, v212, v213
    v_cvt_pk_bf16_f32 v111, v214, v215
    v_mfma_f32_16x16x32_bf16 v[220:223], a[0:3], a[236:239], 0
    ds_read_b128 a[252:255], v224 offset:3264
    ds_read_b128 v[168:171], v242 offset:24576
    v_mfma_f32_16x16x32_bf16 v[216:219], a[4:7], a[236:239], 0
    ds_read_b128 v[248:251], v242 offset:25088
    v_mfma_f32_16x16x32_bf16 v[212:215], a[8:11], a[236:239], 0
    ds_read_b128 a[236:239], v224 offset:3328
    v_mfma_f32_16x16x32_bf16 v[220:223], a[12:15], a[240:243], v[220:223]
    ds_read_b128 v[164:167], v239 offset:16384
    v_mfma_f32_16x16x32_bf16 v[216:219], a[16:19], a[240:243], v[216:219]
    ds_read_b128 v[144:147], v229 offset:1920
    v_mfma_f32_16x16x32_bf16 v[212:215], a[20:23], a[240:243], v[212:215]
    s_waitcnt lgkmcnt(7)
    v_exp_f32 v149, v149
    v_mfma_f32_16x16x32_bf16 v[220:223], a[24:27], a[248:251], v[220:223]
    ds_read_b128 a[240:243], v224 offset:3392
    v_cvt_pk_bf16_f32 v162, v148, v149
    v_mfma_f32_16x16x32_bf16 v[216:219], a[28:31], a[248:251], v[216:219]
    v_exp_f32 v150, v150
    v_mfma_f32_16x16x32_bf16 v[212:215], a[32:35], a[248:251], v[212:215]
    s_waitcnt lgkmcnt(6)
    ds_read_b128 a[248:251], v224 offset:3072
    v_mfma_f32_16x16x32_bf16 v[220:223], a[36:39], a[252:255], v[220:223]
    s_waitcnt lgkmcnt(6)
    v_exp_f32 v151, v151
    v_mfma_f32_16x16x32_bf16 v[176:179], v[168:171], v[252:255], v[176:179]
    s_waitcnt lgkmcnt(5)
    ds_read_b128 v[168:171], v241 offset:36864
    v_cvt_pk_bf16_f32 v163, v150, v151
    v_mfma_f32_16x16x32_bf16 v[172:175], v[248:251], v[252:255], v[172:175]
    ds_read_b128 v[252:255], v240 offset:15360
    ds_read_b128 v[248:251], v241 offset:37376
    v_mfma_f32_16x16x32_bf16 v[196:199], a[216:219], v[160:163], 0
    ds_read_b128 v[148:151], v228 offset:1920
    v_mfma_f32_16x16x32_bf16 v[184:187], v[70:73], v[160:163], 0
    v_exp_f32 v152, v152
    v_mfma_f32_16x16x32_bf16 v[188:191], v[92:95], v[160:163], 0
    v_exp_f32 v153, v153
    v_mfma_f32_16x16x32_bf16 v[192:195], v[114:117], v[160:163], 0
    s_waitcnt lgkmcnt(6)
    v_exp_f32 v154, v154
    v_mfma_f32_16x16x32_bf16 v[144:147], v[42:45], v[132:135], v[144:147]
    v_exp_f32 v155, v155
    v_mfma_f32_16x16x32_bf16 v[216:219], a[40:43], a[252:255], v[216:219]
    v_cvt_pk_bf16_f32 v160, v152, v153
    v_cvt_pk_bf16_f32 v161, v154, v155
    v_mfma_f32_16x16x32_bf16 v[212:215], a[44:47], a[252:255], v[212:215]
    ds_read_b128 a[252:255], v224 offset:3136
    ds_read_b128 v[152:155], v234
    v_mfma_f32_16x16x16_bf16 v[144:147], v[46:47], v[136:137], v[144:147]
    v_bfe_u32 v234, s73, v232, 4
    v_mad_u32_u24 v234, v234, s40, v230
    v_mfma_f32_16x16x32_bf16 v[220:223], a[48:51], a[236:239], v[220:223]
    v_exp_f32 v156, v156
    v_mfma_f32_16x16x32_bf16 v[216:219], a[52:55], a[236:239], v[216:219]
    s_waitcnt lgkmcnt(2)
    v_exp_f32 v157, v157
    v_mfma_f32_16x16x32_bf16 v[148:151], v[18:21], v[132:135], v[148:151]
    v_exp_f32 v158, v158
    v_mfma_f32_16x16x32_bf16 v[212:215], a[56:59], a[236:239], v[212:215]
    ds_read_b128 a[236:239], v224 offset:3200
    v_cvt_pk_bf16_f32 v162, v156, v157
    v_mfma_f32_16x16x32_bf16 v[220:223], a[60:63], a[240:243], v[220:223]
    v_exp_f32 v159, v159
    v_mfma_f32_16x16x16_bf16 v[148:151], v[22:23], v[136:137], v[148:151]
    v_cvt_pk_bf16_f32 v163, v158, v159
    v_mfma_f32_16x16x32_bf16 v[216:219], a[64:67], a[240:243], v[216:219]
    ds_read_b128 v[156:159], v235
    v_bfe_u32 v235, s74, v232, 4
    v_mfma_f32_16x16x32_bf16 v[196:199], a[216:219], v[160:163], v[196:199]
    v_mad_u32_u24 v235, v235, s40, v230
    v_cvt_pk_bf16_f32 v24, v220, v221
    v_mfma_f32_16x16x32_bf16 v[184:187], v[74:77], v[160:163], v[184:187]
    v_cvt_pk_bf16_f32 v25, v222, v223
    v_mfma_f32_16x16x32_bf16 v[188:191], v[96:99], v[160:163], v[188:191]
    v_cvt_pk_bf16_f32 v26, v216, v217
    v_cvt_pk_bf16_f32 v27, v218, v219
    v_mfma_f32_16x16x32_bf16 v[192:195], v[118:121], v[160:163], v[192:195]
    s_waitcnt lgkmcnt(2)
    v_exp_f32 v144, v144
    v_mfma_f32_16x16x32_bf16 v[152:155], v[0:3], v[132:135], v[152:155]
    v_exp_f32 v145, v145
    v_mfma_f32_16x16x32_bf16 v[212:215], a[68:71], a[240:243], v[212:215]
    ds_read_b128 a[240:243], v224 offset:3264
    v_cvt_pk_bf16_f32 v160, v144, v145
    v_mfma_f32_16x16x32_bf16 v[208:211], v[168:171], a[244:247], v[208:211]
    v_exp_f32 v146, v146
    v_mfma_f32_16x16x16_bf16 v[152:155], v[4:5], v[136:137], v[152:155]
    s_waitcnt lgkmcnt(1)
    v_exp_f32 v147, v147
    v_mfma_f32_16x16x32_bf16 v[156:159], v[24:27], v[132:135], v[156:159]
    v_cvt_pk_bf16_f32 v161, v146, v147
    v_cvt_pk_bf16_f32 v28, v212, v213
    v_mfma_f32_16x16x32_bf16 v[200:203], v[168:171], v[252:255], v[200:203]
    ds_read_b128 v[168:171], v242 offset:36864
    v_cvt_pk_bf16_f32 v29, v214, v215
    v_mfma_f32_16x16x32_bf16 v[204:207], v[248:251], a[244:247], v[204:207]
    ds_read_b128 v[144:147], v235
    v_bfe_u32 v235, s67, v233, 4
    v_mfma_f32_16x16x16_bf16 v[156:159], v[28:29], v[136:137], v[156:159]
    v_mad_u32_u24 v235, v235, s40, v231
    v_mfma_f32_16x16x32_bf16 v[180:183], v[248:251], v[252:255], v[180:183]
    ds_read_b128 v[248:251], v242 offset:37376
    ds_read_b128 v[252:255], v239 offset:17408
    v_mfma_f32_16x16x32_bf16 v[220:223], a[248:251], a[72:75], 0
    v_exp_f32 v148, v148
    v_mfma_f32_16x16x32_bf16 v[216:219], a[248:251], a[76:79], 0
    v_exp_f32 v149, v149
    v_mfma_f32_16x16x32_bf16 v[212:215], a[248:251], a[80:83], 0
    ds_read_b128 a[248:251], v224 offset:3328
    v_cvt_pk_bf16_f32 v162, v148, v149
    v_mfma_f32_16x16x32_bf16 v[220:223], a[252:255], a[84:87], v[220:223]
    v_exp_f32 v150, v150
    v_mfma_f32_16x16x32_bf16 v[216:219], a[252:255], a[88:91], v[216:219]
    s_waitcnt lgkmcnt(4)
    v_exp_f32 v151, v151
    v_mfma_f32_16x16x32_bf16 v[176:179], v[168:171], a[244:247], v[176:179]
    ds_read_b128 v[168:171], v241 offset:49152
    v_cvt_pk_bf16_f32 v163, v150, v151
    v_mfma_f32_16x16x32_bf16 v[212:215], a[252:255], a[92:95], v[212:215]
    ds_read_b128 a[252:255], v224 offset:3392
    ds_read_b128 v[148:151], v234
    v_mfma_f32_16x16x32_bf16 v[196:199], a[216:219], v[160:163], v[196:199]
    v_bfe_u32 v234, s75, v233, 4
    v_mad_u32_u24 v234, v234, s40, v231
    v_mfma_f32_16x16x32_bf16 v[184:187], v[78:81], v[160:163], v[184:187]
    v_exp_f32 v152, v152
    v_mfma_f32_16x16x32_bf16 v[188:191], v[100:103], v[160:163], v[188:191]
L_pg7:
    s_cbranch_execz L_back
    v_exp_f32 v153, v153
    v_mfma_f32_16x16x32_bf16 v[192:195], v[122:125], v[160:163], v[192:195]
    s_waitcnt lgkmcnt(4)
    v_exp_f32 v154, v154
    v_mfma_f32_16x16x32_bf16 v[172:175], v[248:251], a[244:247], v[172:175]
    ds_read_b128 a[244:247], v240 offset:16384
    ds_read_b128 v[248:251], v241 offset:49664
    v_mfma_f32_16x16x32_bf16 v[220:223], a[236:239], a[96:99], v[220:223]
    v_exp_f32 v155, v155
    v_mfma_f32_16x16x32_bf16 v[216:219], a[236:239], a[100:103], v[216:219]
    v_cvt_pk_bf16_f32 v160, v152, v153
    v_cvt_pk_bf16_f32 v161, v154, v155
    v_mfma_f32_16x16x32_bf16 v[212:215], a[236:239], a[104:107], v[212:215]
    ds_read_b128 a[236:239], v225 offset:42944
    ds_read_b128 v[152:155], v230 offset:1280
    v_mfma_f32_16x16x32_bf16 v[220:223], a[240:243], a[108:111], v[220:223]
    v_exp_f32 v156, v156
    v_mfma_f32_16x16x32_bf16 v[216:219], a[240:243], a[112:115], v[216:219]
    v_exp_f32 v157, v157
    v_mfma_f32_16x16x32_bf16 v[212:215], a[240:243], a[116:119], v[212:215]
    s_waitcnt lgkmcnt(4)
    ds_read_b128 a[240:243], v225 offset:43008
    v_cvt_pk_bf16_f32 v162, v156, v157
    v_mfma_f32_16x16x32_bf16 v[220:223], a[248:251], a[120:123], v[220:223]
    v_exp_f32 v158, v158
    v_mfma_f32_16x16x32_bf16 v[216:219], a[248:251], a[124:127], v[216:219]
    v_exp_f32 v159, v159
    v_mfma_f32_16x16x32_bf16 v[212:215], a[248:251], a[128:131], v[212:215]
    ds_read_b128 a[248:251], v225 offset:43072
    v_cvt_pk_bf16_f32 v163, v158, v159
    v_mfma_f32_16x16x32_bf16 v[220:223], a[252:255], a[132:135], v[220:223]
    ds_read_b128 v[156:159], v230 offset:1920
    v_mfma_f32_16x16x32_bf16 v[196:199], a[216:219], v[160:163], v[196:199]
    v_mfma_f32_16x16x32_bf16 v[216:219], a[252:255], a[136:139], v[216:219]
    v_mfma_f32_16x16x32_bf16 v[212:215], a[252:255], a[140:143], v[212:215]
    ds_read_b128 a[252:255], v225 offset:43136
    v_mfma_f32_16x16x32_bf16 v[208:211], v[168:171], v[164:167], v[208:211]
    s_waitcnt lgkmcnt(4)
    v_mfma_f32_16x16x32_bf16 v[200:203], v[168:171], a[244:247], v[200:203]
    ds_read_b128 v[168:171], v242 offset:49152
    v_cvt_pk_bf16_f32 v68, v220, v221
    v_mfma_f32_16x16x32_bf16 v[204:207], v[248:251], v[164:167], v[204:207]
    v_cvt_pk_bf16_f32 v69, v222, v223
    v_cvt_pk_bf16_f32 v90, v216, v217
    v_mfma_f32_16x16x32_bf16 v[180:183], v[248:251], a[244:247], v[180:183]
    v_cvt_pk_bf16_f32 v91, v218, v219
    v_cvt_pk_bf16_f32 v112, v212, v213
    v_mfma_f32_16x16x32_bf16 v[184:187], v[66:69], v[160:163], v[184:187]
    ds_read_b128 v[248:251], v242 offset:49664
    v_cvt_pk_bf16_f32 v113, v214, v215
    v_mfma_f32_16x16x32_bf16 v[188:191], v[88:91], v[160:163], v[188:191]
    v_rcp_f32 v197, v196
    v_mfma_f32_16x16x32_bf16 v[192:195], v[110:113], v[160:163], v[192:195]
    v_max3_f32 v236, v236, v196, v197
    v_mfma_f32_16x16x32_bf16 v[220:223], a[144:147], a[236:239], 0
    v_mfma_f32_16x16x32_bf16 v[216:219], a[148:151], a[236:239], 0
    v_mul_f32 v184, v184, v197
    v_mul_f32 v185, v185, v197
    v_mfma_f32_16x16x32_bf16 v[212:215], a[152:155], a[236:239], 0
    s_waitcnt lgkmcnt(1)
    ds_read_b128 a[236:239], v225 offset:43200
    v_cvt_pk_bf16_f32 v184, v184, v185
    v_mfma_f32_16x16x32_bf16 v[176:179], v[168:171], v[164:167], v[176:179]
    ds_read_b128 v[168:171], v241 offset:61440
    v_mul_f32 v186, v186, v197
    v_mfma_f32_16x16x32_bf16 v[220:223], a[156:159], a[240:243], v[220:223]
    v_mul_f32 v187, v187, v197
    v_cvt_pk_bf16_f32 v185, v186, v187
    v_mfma_f32_16x16x32_bf16 v[216:219], a[160:163], a[240:243], v[216:219]
    s_waitcnt lgkmcnt(2)
    v_mul_f32 v188, v188, v197
    v_mul_f32 v189, v189, v197
    v_mfma_f32_16x16x32_bf16 v[172:175], v[248:251], v[164:167], v[172:175]
    ds_read_b128 v[164:167], v240 offset:17408
    ds_read_b128 v[248:251], v241 offset:61952
    v_mfma_f32_16x16x32_bf16 v[212:215], a[164:167], a[240:243], v[212:215]
    ds_read_b128 a[240:243], v225 offset:43264
    v_cvt_pk_bf16_f32 v186, v188, v189
    v_mfma_f32_16x16x32_bf16 v[220:223], a[168:171], a[248:251], v[220:223]
    v_mul_f32 v190, v190, v197
    v_mul_f32 v191, v191, v197
    v_mfma_f32_16x16x32_bf16 v[216:219], a[172:175], a[248:251], v[216:219]
    v_cvt_pk_bf16_f32 v187, v190, v191
    v_mul_f32 v192, v192, v197
    v_mfma_f32_16x16x32_bf16 v[212:215], a[176:179], a[248:251], v[212:215]
    v_mul_f32 v193, v193, v197
    v_cvt_pk_bf16_f32 v188, v192, v193
    v_mfma_f32_16x16x32_bf16 v[220:223], a[180:183], a[252:255], v[220:223]
    v_mul_f32 v194, v194, v197
    v_mul_f32 v195, v195, v197
    v_mfma_f32_16x16x32_bf16 v[216:219], a[184:187], a[252:255], v[216:219]
    v_cvt_pk_bf16_f32 v189, v194, v195
    v_cndmask_b32 v225, v243, v245, vcc
    v_mfma_f32_16x16x32_bf16 v[212:215], a[188:191], a[252:255], v[212:215]
    s_waitcnt vmcnt(0) lgkmcnt(2)
    v_mfma_f32_16x16x32_bf16 v[220:223], a[192:195], a[236:239], v[220:223]
    s_barrier
    ds_read_b128 a[248:251], v227 offset:6144
    v_mfma_f32_16x16x32_bf16 v[216:219], a[196:199], a[236:239], v[216:219]
    ds_read_b128 a[252:255], v227 offset:6208
    ds_read_b128 a[244:247], v239
    v_mfma_f32_16x16x32_bf16 v[212:215], a[200:203], a[236:239], v[212:215]
    s_waitcnt lgkmcnt(3)
    v_mfma_f32_16x16x32_bf16 v[220:223], a[204:207], a[240:243], v[220:223]
    ds_read_b128 a[236:239], v227 offset:6272
    v_mfma_f32_16x16x32_bf16 v[216:219], a[208:211], a[240:243], v[216:219]
    ds_write_b128 v237, v[184:187] offset:12288
    v_mfma_f32_16x16x32_bf16 v[212:215], a[212:215], a[240:243], v[212:215]
    ds_write_b64 v238, v[188:189] offset:12288
    v_mfma_f32_16x16x32_bf16 v[208:211], v[168:171], v[252:255], v[208:211]
    v_mfma_f32_16x16x32_bf16 v[200:203], v[168:171], v[164:167], v[200:203]
    v_mfma_f32_16x16x32_bf16 v[204:207], v[248:251], v[252:255], v[204:207]
    v_mul_f32 v220, s37, v220
    v_mul_f32 v221, s37, v221
    v_mfma_f32_16x16x32_bf16 v[180:183], v[248:251], v[164:167], v[180:183]
    s_waitcnt lgkmcnt(5)
    v_mul_f32 v222, s37, v222
    v_mul_f32 v223, s37, v223
    v_cvt_pk_bf16_f32 v138, v220, v221
    v_cvt_pk_bf16_f32 v139, v222, v223
    v_mfma_f32_16x16x32_bf16 v[220:223], a[0:3], a[248:251], 0
    s_waitcnt lgkmcnt(4)
    v_mul_f32 v216, s37, v216
    v_mul_f32 v217, s37, v217
    v_mfma_f32_16x16x32_bf16 v[220:223], a[12:15], a[252:255], v[220:223]
    s_waitcnt lgkmcnt(2)
    v_mul_f32 v218, s37, v218
    v_mul_f32 v219, s37, v219
    v_mfma_f32_16x16x32_bf16 v[220:223], a[24:27], a[236:239], v[220:223]
    v_cvt_pk_bf16_f32 v140, v216, v217
    v_cvt_pk_bf16_f32 v141, v218, v219
    v_mfma_f32_16x16x32_bf16 v[216:219], a[4:7], a[248:251], 0
    v_mul_f32 v212, s37, v212
    v_mul_f32 v213, s37, v213
    v_mfma_f32_16x16x32_bf16 v[144:147], v[24:27], v[138:141], v[144:147]
    v_mul_f32 v214, s37, v214
    v_mul_f32 v215, s37, v215
    v_mfma_f32_16x16x32_bf16 v[148:151], v[30:33], v[138:141], v[148:151]
    v_cvt_pk_bf16_f32 v142, v212, v213
    v_cvt_pk_bf16_f32 v143, v214, v215
    v_mfma_f32_16x16x32_bf16 v[152:155], v[36:39], v[138:141], v[152:155]
    ds_read_b128 a[240:243], v227 offset:6336
    ds_read_b128 v[168:171], v242 offset:61440
    v_mfma_f32_16x16x16_bf16 v[144:147], v[28:29], v[142:143], v[144:147]
    ds_read_b128 v[248:251], v242 offset:61952
    v_cvt_pk_bf16_f32 v208, v208, v209
    v_mfma_f32_16x16x16_bf16 v[148:151], v[34:35], v[142:143], v[148:151]
    v_cvt_pk_bf16_f32 v209, v210, v211
    v_cvt_pk_bf16_f32 v210, v204, v205
    v_mfma_f32_16x16x16_bf16 v[152:155], v[40:41], v[142:143], v[152:155]
    v_cvt_pk_bf16_f32 v211, v206, v207
    v_cvt_pk_bf16_f32 v200, v200, v201
    v_mfma_f32_16x16x32_bf16 v[156:159], v[42:45], v[138:141], v[156:159]
    buffer_store_dwordx4 v[208:211], v243, s[20:23], s58 offen sc0 sc1
    v_mfma_f32_16x16x32_bf16 v[212:215], a[8:11], a[248:251], 0
    ds_read_b128 a[248:251], v227 offset:6400
    v_cvt_pk_bf16_f32 v201, v202, v203
    v_mfma_f32_16x16x32_bf16 v[216:219], a[16:19], a[252:255], v[216:219]
    v_cvt_pk_bf16_f32 v202, v180, v181
    v_cvt_pk_bf16_f32 v203, v182, v183
    v_mfma_f32_16x16x16_bf16 v[156:159], v[46:47], v[142:143], v[156:159]
    ds_read_b128 v[164:167], v239 offset:1024
    v_mfma_f32_16x16x32_bf16 v[212:215], a[20:23], a[252:255], v[212:215]
    s_waitcnt lgkmcnt(3)
    ds_read_b128 a[252:255], v227 offset:6464
    v_mfma_f32_16x16x32_bf16 v[176:179], v[168:171], v[252:255], v[176:179]
    s_waitcnt lgkmcnt(3)
    ds_read_b128 v[168:171], v241 offset:12288
    v_mfma_f32_16x16x32_bf16 v[172:175], v[248:251], v[252:255], v[172:175]
    ds_read_b128 v[252:255], v240
    ds_read_b128 v[248:251], v241 offset:12800
    v_mfma_f32_16x16x32_bf16 v[216:219], a[28:31], a[236:239], v[216:219]
    v_exp_f32 v144, v144
    v_mfma_f32_16x16x32_bf16 v[212:215], a[32:35], a[236:239], v[212:215]
    ds_read_b128 a[236:239], v227 offset:6144
    v_cvt_pk_bf16_f32 v176, v176, v177
    v_mfma_f32_16x16x32_bf16 v[220:223], a[36:39], a[240:243], v[220:223]
    v_cvt_pk_bf16_f32 v177, v178, v179
    v_cvt_pk_bf16_f32 v178, v172, v173
    v_mfma_f32_16x16x32_bf16 v[216:219], a[40:43], a[240:243], v[216:219]
    v_cvt_pk_bf16_f32 v179, v174, v175
    v_mfma_f32_16x16x32_bf16 v[212:215], a[44:47], a[240:243], v[212:215]
    s_waitcnt lgkmcnt(6)
    ds_read_b128 a[240:243], v227 offset:6208
    v_mfma_f32_16x16x32_bf16 v[220:223], a[48:51], a[248:251], v[220:223]
    buffer_store_dwordx4 v[200:203], v245, s[20:23], s58 offen sc0 sc1
    v_mfma_f32_16x16x32_bf16 v[216:219], a[52:55], a[248:251], v[216:219]
    v_exp_f32 v145, v145
    v_mfma_f32_16x16x32_bf16 v[212:215], a[56:59], a[248:251], v[212:215]
    s_waitcnt lgkmcnt(4)
    ds_read_b128 a[248:251], v227 offset:6272
    v_cvt_pk_bf16_f32 v160, v144, v145
    v_mfma_f32_16x16x32_bf16 v[220:223], a[60:63], a[252:255], v[220:223]
    v_exp_f32 v146, v146
    v_mfma_f32_16x16x32_bf16 v[216:219], a[64:67], a[252:255], v[216:219]
    v_exp_f32 v147, v147
    v_mfma_f32_16x16x32_bf16 v[212:215], a[68:71], a[252:255], v[212:215]
    ds_read_b128 a[252:255], v227 offset:6336
    v_cvt_pk_bf16_f32 v161, v146, v147
    v_mfma_f32_16x16x32_bf16 v[208:211], a[220:223], a[244:247], 0
    s_waitcnt lgkmcnt(3)
    ds_read_b128 v[144:147], v235
    v_cvt_pk_bf16_f32 v54, v220, v221
    v_mfma_f32_16x16x32_bf16 v[200:203], a[220:223], v[252:255], 0
    v_cvt_pk_bf16_f32 v55, v222, v223
    v_cvt_pk_bf16_f32 v56, v216, v217
    v_mfma_f32_16x16x32_bf16 v[204:207], a[224:227], a[244:247], 0
    v_cvt_pk_bf16_f32 v57, v218, v219
    v_cvt_pk_bf16_f32 v58, v212, v213
    v_mfma_f32_16x16x32_bf16 v[180:183], a[224:227], v[252:255], 0
    v_cvt_pk_bf16_f32 v59, v214, v215
    v_bfe_u32 v235, s76, v233, 4
    v_mfma_f32_16x16x32_bf16 v[172:175], a[232:235], a[244:247], 0
    ds_read_b128 v[252:255], v239 offset:2048
    v_mad_u32_u24 v235, v235, s40, v231
    v_mfma_f32_16x16x32_bf16 v[220:223], a[236:239], a[72:75], 0
    v_exp_f32 v148, v148
    v_mfma_f32_16x16x32_bf16 v[216:219], a[236:239], a[76:79], 0
    buffer_store_dwordx4 v[176:179], v244, s[20:23], s58 offen sc0 sc1
    v_mfma_f32_16x16x32_bf16 v[212:215], a[236:239], a[80:83], 0
    s_add_u32 s58, s51, 0x150000
    ds_read_b128 a[236:239], v227 offset:6400
    v_mfma_f32_16x16x32_bf16 v[176:179], a[228:231], a[244:247], 0
    s_waitcnt lgkmcnt(2)
    ds_read_b128 a[244:247], v240 offset:1024
    v_mfma_f32_16x16x32_bf16 v[144:147], v[48:51], v[138:141], v[144:147]
    v_exp_f32 v149, v149
    v_mfma_f32_16x16x32_bf16 v[220:223], a[240:243], a[84:87], v[220:223]
    v_exp_f32 v150, v150
    v_mfma_f32_16x16x32_bf16 v[216:219], a[240:243], a[88:91], v[216:219]
    v_exp_f32 v151, v151
    v_mfma_f32_16x16x32_bf16 v[212:215], a[240:243], a[92:95], v[212:215]
    ds_read_b128 a[240:243], v227 offset:6464
    v_cndmask_b32 v227, v240, v239, vcc
    v_mfma_f32_16x16x16_bf16 v[144:147], v[52:53], v[142:143], v[144:147]
    v_cvt_pk_bf16_f32 v162, v148, v149
    v_cvt_pk_bf16_f32 v163, v150, v151
    v_mfma_f32_16x16x32_bf16 v[220:223], a[248:251], a[96:99], v[220:223]
    ds_read_b128 v[148:151], v234
    v_bfe_u32 v234, s73, v232, 4
    v_mfma_f32_16x16x32_bf16 v[196:199], a[216:219], v[160:163], 0
    v_exp_f32 v152, v152
    v_mfma_f32_16x16x32_bf16 v[184:187], v[68:71], v[160:163], 0
    v_exp_f32 v153, v153
    v_mfma_f32_16x16x32_bf16 v[188:191], v[90:93], v[160:163], 0
    v_exp_f32 v154, v154
    v_mfma_f32_16x16x32_bf16 v[192:195], v[112:115], v[160:163], 0
    v_exp_f32 v155, v155
    v_mfma_f32_16x16x32_bf16 v[216:219], a[248:251], a[100:103], v[216:219]
    v_cvt_pk_bf16_f32 v160, v152, v153
    v_cvt_pk_bf16_f32 v161, v154, v155
    v_mfma_f32_16x16x32_bf16 v[212:215], a[248:251], a[104:107], v[212:215]
    ds_read_b128 a[248:251], v226 offset:1152
    ds_read_b128 v[152:155], v235
    v_mfma_f32_16x16x32_bf16 v[220:223], a[252:255], a[108:111], v[220:223]
    v_mad_u32_u24 v235, v234, s40, v228
    v_mad_u32_u24 v234, v234, s40, v229
    v_mfma_f32_16x16x32_bf16 v[216:219], a[252:255], a[112:115], v[216:219]
    s_waitcnt lgkmcnt(2)
    v_exp_f32 v156, v156
    v_mfma_f32_16x16x32_bf16 v[148:151], v[54:57], v[138:141], v[148:151]
    v_exp_f32 v157, v157
    v_mfma_f32_16x16x32_bf16 v[212:215], a[252:255], a[116:119], v[212:215]
    ds_read_b128 a[252:255], v226 offset:1216
    v_cvt_pk_bf16_f32 v162, v156, v157
    v_mfma_f32_16x16x32_bf16 v[220:223], a[236:239], a[120:123], v[220:223]
    v_exp_f32 v158, v158
    v_mfma_f32_16x16x16_bf16 v[148:151], v[58:59], v[142:143], v[148:151]
    v_exp_f32 v159, v159
    v_mfma_f32_16x16x32_bf16 v[216:219], a[236:239], a[124:127], v[216:219]
    v_cvt_pk_bf16_f32 v163, v158, v159
    v_mfma_f32_16x16x32_bf16 v[212:215], a[236:239], a[128:131], v[212:215]
    ds_read_b128 a[236:239], v226 offset:1280
    ds_read_b128 v[156:159], v235
    v_mfma_f32_16x16x32_bf16 v[196:199], a[216:219], v[160:163], v[196:199]
    v_exp_f32 v144, v144
    v_mfma_f32_16x16x32_bf16 v[184:187], v[76:79], v[160:163], v[184:187]
    v_exp_f32 v145, v145
    v_mfma_f32_16x16x32_bf16 v[188:191], v[98:101], v[160:163], v[188:191]
    v_exp_f32 v146, v146
    v_mfma_f32_16x16x32_bf16 v[192:195], v[120:123], v[160:163], v[192:195]
    s_waitcnt lgkmcnt(3)
    v_exp_f32 v147, v147
    v_mfma_f32_16x16x32_bf16 v[152:155], v[60:63], v[138:141], v[152:155]
    v_cvt_pk_bf16_f32 v160, v144, v145
    v_cvt_pk_bf16_f32 v161, v146, v147
    v_mfma_f32_16x16x32_bf16 v[220:223], a[240:243], a[132:135], v[220:223]
    ds_read_b128 v[144:147], v234
    v_bfe_u32 v234, s77, v232, 4
    v_mfma_f32_16x16x16_bf16 v[196:199], a[216:217], v[160:161], v[196:199]
    v_mad_u32_u24 v235, v234, s40, v228
    v_mad_u32_u24 v234, v234, s40, v229
    v_mfma_f32_16x16x16_bf16 v[184:187], v[82:83], v[160:161], v[184:187]
    v_exp_f32 v148, v148
    v_mfma_f32_16x16x16_bf16 v[188:191], v[104:105], v[160:161], v[188:191]
    v_cvt_pk_bf16_f32 v84, v220, v221
    v_cvt_pk_bf16_f32 v85, v222, v223
    v_mfma_f32_16x16x16_bf16 v[192:195], v[126:127], v[160:161], v[192:195]
    v_exp_f32 v149, v149
    v_mfma_f32_16x16x16_bf16 v[152:155], v[64:65], v[142:143], v[152:155]
    v_exp_f32 v150, v150
    v_mfma_f32_16x16x32_bf16 v[216:219], a[240:243], a[136:139], v[216:219]
    v_exp_f32 v151, v151
    v_mfma_f32_16x16x32_bf16 v[212:215], a[240:243], a[140:143], v[212:215]
    ds_read_b128 a[240:243], v226 offset:1344
    v_cvt_pk_bf16_f32 v160, v148, v149
    v_mfma_f32_16x16x32_bf16 v[220:223], a[144:147], a[248:251], 0
    s_waitcnt lgkmcnt(2)
    v_cvt_pk_bf16_f32 v161, v150, v151
    v_mfma_f32_16x16x32_bf16 v[220:223], a[156:159], a[252:255], v[220:223]
    ds_read_b128 v[148:151], v229 offset:1280
    v_cvt_pk_bf16_f32 v106, v216, v217
    v_mfma_f32_16x16x32_bf16 v[220:223], a[168:171], a[236:239], v[220:223]
    v_cvt_pk_bf16_f32 v107, v218, v219
    v_cvt_pk_bf16_f32 v128, v212, v213
    v_mfma_f32_16x16x32_bf16 v[216:219], a[148:151], a[248:251], 0
    v_cvt_pk_bf16_f32 v129, v214, v215
    v_mfma_f32_16x16x32_bf16 v[212:215], a[152:155], a[248:251], 0
    ds_read_b128 a[248:251], v226 offset:1408
    v_mfma_f32_16x16x32_bf16 v[216:219], a[160:163], a[252:255], v[216:219]
    v_exp_f32 v152, v152
    v_mfma_f32_16x16x32_bf16 v[212:215], a[164:167], a[252:255], v[212:215]
    ds_read_b128 a[252:255], v226 offset:1472
    v_mfma_f32_16x16x32_bf16 v[216:219], a[172:175], a[236:239], v[216:219]
    v_exp_f32 v153, v153
    v_mfma_f32_16x16x32_bf16 v[212:215], a[176:179], a[236:239], v[212:215]
    s_waitcnt lgkmcnt(3)
    ds_read_b128 a[236:239], v224 offset:15488
    v_cvt_pk_bf16_f32 v162, v152, v153
    v_mfma_f32_16x16x32_bf16 v[220:223], a[180:183], a[240:243], v[220:223]
    v_exp_f32 v154, v154
    v_mfma_f32_16x16x32_bf16 v[216:219], a[184:187], a[240:243], v[216:219]
    v_exp_f32 v155, v155
    v_mfma_f32_16x16x32_bf16 v[212:215], a[188:191], a[240:243], v[212:215]
    ds_read_b128 a[240:243], v224 offset:15552
    v_cvt_pk_bf16_f32 v163, v154, v155
    v_mfma_f32_16x16x32_bf16 v[208:211], v[168:171], v[164:167], v[208:211]
    ds_read_b128 v[152:155], v228 offset:1280
    v_mfma_f32_16x16x32_bf16 v[196:199], a[216:219], v[160:163], v[196:199]
    v_mfma_f32_16x16x32_bf16 v[184:187], v[84:87], v[160:163], v[184:187]
    v_mfma_f32_16x16x32_bf16 v[188:191], v[106:109], v[160:163], v[188:191]
    v_mfma_f32_16x16x32_bf16 v[192:195], v[128:131], v[160:163], v[192:195]
    s_waitcnt lgkmcnt(3)
    v_mfma_f32_16x16x32_bf16 v[220:223], a[192:195], a[248:251], v[220:223]
    v_mfma_f32_16x16x32_bf16 v[216:219], a[196:199], a[248:251], v[216:219]
    v_mfma_f32_16x16x32_bf16 v[212:215], a[200:203], a[248:251], v[212:215]
    ds_read_b128 a[248:251], v224 offset:15616
    v_mfma_f32_16x16x32_bf16 v[220:223], a[204:207], a[252:255], v[220:223]
    v_rcp_f32 v197, v196
    v_mfma_f32_16x16x32_bf16 v[216:219], a[208:211], a[252:255], v[216:219]
    v_mul_f32 v184, v184, v197
    v_mul_f32 v185, v185, v197
    v_mfma_f32_16x16x32_bf16 v[212:215], a[212:215], a[252:255], v[212:215]
    ds_read_b128 a[252:255], v224 offset:15680
    v_cvt_pk_bf16_f32 v184, v184, v185
    v_mfma_f32_16x16x32_bf16 v[200:203], v[168:171], a[244:247], v[200:203]
    v_mul_f32 v220, s37, v220
    v_mul_f32 v221, s37, v221
    v_mfma_f32_16x16x32_bf16 v[204:207], v[248:251], v[164:167], v[204:207]
    v_mul_f32 v222, s37, v222
    v_mul_f32 v223, s37, v223
    v_mfma_f32_16x16x32_bf16 v[180:183], v[248:251], a[244:247], v[180:183]
    s_waitcnt lgkmcnt(2)
    v_cvt_pk_bf16_f32 v132, v220, v221
    v_cvt_pk_bf16_f32 v133, v222, v223
    v_mfma_f32_16x16x32_bf16 v[220:223], a[0:3], a[236:239], 0
    v_mul_f32 v216, s37, v216
    v_mul_f32 v217, s37, v217
    v_mfma_f32_16x16x32_bf16 v[220:223], a[12:15], a[240:243], v[220:223]
    s_waitcnt lgkmcnt(1)
    v_mul_f32 v218, s37, v218
    v_mul_f32 v219, s37, v219
    v_mfma_f32_16x16x32_bf16 v[220:223], a[24:27], a[248:251], v[220:223]
    v_cvt_pk_bf16_f32 v134, v216, v217
    v_cvt_pk_bf16_f32 v135, v218, v219
    v_mfma_f32_16x16x32_bf16 v[216:219], a[4:7], a[236:239], 0
    v_mul_f32 v212, s37, v212
    v_mul_f32 v213, s37, v213
    v_mfma_f32_16x16x32_bf16 v[156:159], v[12:15], v[132:135], v[156:159]
    v_mul_f32 v214, s37, v214
    v_mul_f32 v215, s37, v215
    v_mfma_f32_16x16x32_bf16 v[144:147], v[36:39], v[132:135], v[144:147]
    v_cvt_pk_bf16_f32 v136, v212, v213
    v_cvt_pk_bf16_f32 v137, v214, v215
    v_mfma_f32_16x16x32_bf16 v[148:151], v[42:45], v[132:135], v[148:151]
    v_mul_f32 v186, v186, v197
    v_mul_f32 v187, v187, v197
    v_mfma_f32_16x16x16_bf16 v[156:159], v[16:17], v[136:137], v[156:159]
    v_cvt_pk_bf16_f32 v185, v186, v187
    v_mul_f32 v188, v188, v197
    v_mfma_f32_16x16x16_bf16 v[144:147], v[40:41], v[136:137], v[144:147]
    v_mul_f32 v189, v189, v197
    v_cvt_pk_bf16_f32 v186, v188, v189
    v_mfma_f32_16x16x16_bf16 v[148:151], v[46:47], v[136:137], v[148:151]
    v_mul_f32 v190, v190, v197
    v_mul_f32 v191, v191, v197
    v_mfma_f32_16x16x32_bf16 v[152:155], v[18:21], v[132:135], v[152:155]
    v_cvt_pk_bf16_f32 v187, v190, v191
    v_mul_f32 v192, v192, v197
    v_mfma_f32_16x16x32_bf16 v[212:215], a[8:11], a[236:239], 0
    ds_read_b128 a[236:239], v224 offset:15744
    v_mul_f32 v193, v193, v197
    v_mfma_f32_16x16x32_bf16 v[216:219], a[16:19], a[240:243], v[216:219]
    v_cvt_pk_bf16_f32 v188, v192, v193
    v_mul_f32 v194, v194, v197
    v_mfma_f32_16x16x16_bf16 v[152:155], v[22:23], v[136:137], v[152:155]
    v_mul_f32 v195, v195, v197
    v_cvt_pk_bf16_f32 v189, v194, v195
    v_mfma_f32_16x16x32_bf16 v[212:215], a[20:23], a[240:243], v[212:215]
    ds_read_b128 a[240:243], v224 offset:15808
    v_max3_f32 v236, v236, v196, v197
    v_mfma_f32_16x16x32_bf16 v[216:219], a[28:31], a[248:251], v[216:219]
    ds_write_b128 v237, v[184:187] offset:18432
    v_mfma_f32_16x16x32_bf16 v[212:215], a[32:35], a[248:251], v[212:215]
    s_waitcnt lgkmcnt(3)
    ds_write_b64 v238, v[188:189] offset:18432
    v_mfma_f32_16x16x32_bf16 v[220:223], a[36:39], a[252:255], v[220:223]
    v_exp_f32 v156, v156
    v_mfma_f32_16x16x32_bf16 v[216:219], a[40:43], a[252:255], v[216:219]
    v_exp_f32 v157, v157
    v_mfma_f32_16x16x32_bf16 v[212:215], a[44:47], a[252:255], v[212:215]
    s_waitcnt lgkmcnt(3)
    v_exp_f32 v158, v158
    v_mfma_f32_16x16x32_bf16 v[220:223], a[48:51], a[236:239], v[220:223]
    ds_read_b128 a[248:251], v224 offset:15488
    ds_read_b128 a[252:255], v224 offset:15552
    v_mfma_f32_16x16x32_bf16 v[216:219], a[52:55], a[236:239], v[216:219]
    ds_read_b128 v[168:171], v242 offset:12288
    v_cvt_pk_bf16_f32 v160, v156, v157
    v_mfma_f32_16x16x32_bf16 v[212:215], a[56:59], a[236:239], v[212:215]
    s_waitcnt lgkmcnt(5)
    ds_read_b128 a[236:239], v224 offset:15616
    v_mfma_f32_16x16x32_bf16 v[220:223], a[60:63], a[240:243], v[220:223]
    ds_read_b128 v[248:251], v242 offset:12800
    v_mfma_f32_16x16x32_bf16 v[216:219], a[64:67], a[240:243], v[216:219]
    ds_read_b128 a[244:247], v239 offset:3072
    v_mfma_f32_16x16x32_bf16 v[212:215], a[68:71], a[240:243], v[212:215]
    s_waitcnt lgkmcnt(5)
    ds_read_b128 a[240:243], v224 offset:15680
    v_exp_f32 v159, v159
    v_exp_f32 v144, v144
    v_cvt_pk_bf16_f32 v161, v158, v159
    v_cvt_pk_bf16_f32 v6, v220, v221
    v_cvt_pk_bf16_f32 v7, v222, v223
    v_cvt_pk_bf16_f32 v8, v216, v217
    v_cvt_pk_bf16_f32 v9, v218, v219
    v_cvt_pk_bf16_f32 v10, v212, v213
    v_cvt_pk_bf16_f32 v11, v214, v215
    v_mfma_f32_16x16x32_bf16 v[220:223], a[248:251], a[72:75], 0
    ds_read_b128 v[156:159], v235
    v_mfma_f32_16x16x32_bf16 v[216:219], a[248:251], a[76:79], 0
    s_waitcnt lgkmcnt(5)
    v_exp_f32 v145, v145
    v_mfma_f32_16x16x32_bf16 v[176:179], v[168:171], v[164:167], v[176:179]
    ds_read_b128 v[168:171], v241 offset:24576
    v_cvt_pk_bf16_f32 v162, v144, v145
    v_mfma_f32_16x16x32_bf16 v[212:215], a[248:251], a[80:83], 0
    s_waitcnt lgkmcnt(4)
    ds_read_b128 a[248:251], v224 offset:15744
    v_mfma_f32_16x16x32_bf16 v[172:175], v[248:251], v[164:167], v[172:175]
    ds_read_b128 v[164:167], v240 offset:2048
    ds_read_b128 v[248:251], v241 offset:25088
    v_mfma_f32_16x16x32_bf16 v[220:223], a[252:255], a[84:87], v[220:223]
    v_exp_f32 v146, v146
    v_mfma_f32_16x16x32_bf16 v[216:219], a[252:255], a[88:91], v[216:219]
    v_exp_f32 v147, v147
    v_mfma_f32_16x16x32_bf16 v[212:215], a[252:255], a[92:95], v[212:215]
    ds_read_b128 a[252:255], v224 offset:15808
    v_cvt_pk_bf16_f32 v163, v146, v147
    v_mfma_f32_16x16x32_bf16 v[220:223], a[236:239], a[96:99], v[220:223]
    ds_read_b128 v[144:147], v234
    v_bfe_u32 v234, s78, v232, 4
    v_mfma_f32_16x16x32_bf16 v[196:199], a[216:219], v[160:163], 0
    v_mad_u32_u24 v235, v234, s40, v229
    v_mad_u32_u24 v234, v234, s40, v228
    v_mfma_f32_16x16x32_bf16 v[184:187], v[74:77], v[160:163], 0
    v_exp_f32 v148, v148
    v_mfma_f32_16x16x32_bf16 v[188:191], v[96:99], v[160:163], 0
    v_exp_f32 v149, v149
    v_mfma_f32_16x16x32_bf16 v[192:195], v[118:121], v[160:163], 0
    s_waitcnt lgkmcnt(5)
    v_exp_f32 v150, v150
    v_mfma_f32_16x16x32_bf16 v[156:159], v[0:3], v[132:135], v[156:159]
    v_exp_f32 v151, v151
    v_mfma_f32_16x16x32_bf16 v[208:211], v[168:171], v[252:255], v[208:211]
    s_waitcnt lgkmcnt(3)
    v_cvt_pk_bf16_f32 v160, v148, v149
    v_cvt_pk_bf16_f32 v161, v150, v151
    v_mfma_f32_16x16x32_bf16 v[200:203], v[168:171], v[164:167], v[200:203]
    ds_read_b128 v[168:171], v242 offset:24576
    ds_read_b128 v[148:151], v235
    v_mfma_f32_16x16x16_bf16 v[156:159], v[4:5], v[136:137], v[156:159]
    s_waitcnt lgkmcnt(2)
    v_bfe_u32 v235, s77, v232, 4
    v_mad_u32_u24 v235, v235, s40, v230
    v_mfma_f32_16x16x32_bf16 v[144:147], v[24:27], v[132:135], v[144:147]
    v_mov_b32 v5, s25
    v_mfma_f32_16x16x32_bf16 v[204:207], v[248:251], v[252:255], v[204:207]
    v_exp_f32 v152, v152
    v_mfma_f32_16x16x32_bf16 v[180:183], v[248:251], v[164:167], v[180:183]
    ds_read_b128 v[248:251], v242 offset:25088
    ds_read_b128 v[164:167], v239 offset:4096
    v_mfma_f32_16x16x16_bf16 v[144:147], v[28:29], v[136:137], v[144:147]
    v_exp_f32 v153, v153
    v_mfma_f32_16x16x32_bf16 v[216:219], a[236:239], a[100:103], v[216:219]
    v_exp_f32 v154, v154
    v_mfma_f32_16x16x32_bf16 v[212:215], a[236:239], a[104:107], v[212:215]
    ds_read_b128 a[236:239], v224 offset:18560
    v_cvt_pk_bf16_f32 v162, v152, v153
    v_mfma_f32_16x16x32_bf16 v[220:223], a[240:243], a[108:111], v[220:223]
    s_waitcnt lgkmcnt(4)
    v_exp_f32 v155, v155
    v_mfma_f32_16x16x32_bf16 v[176:179], v[168:171], v[252:255], v[176:179]
    ds_read_b128 v[168:171], v241 offset:36864
    v_cvt_pk_bf16_f32 v163, v154, v155
    v_mfma_f32_16x16x32_bf16 v[216:219], a[240:243], a[112:115], v[216:219]
    ds_read_b128 v[152:155], v234
    v_bfe_u32 v234, s73, v232, 4
    v_mfma_f32_16x16x32_bf16 v[196:199], a[216:219], v[160:163], v[196:199]
    v_mad_u32_u24 v234, v234, s40, v230
    v_mfma_f32_16x16x32_bf16 v[184:187], v[78:81], v[160:163], v[184:187]
    v_exp_f32 v156, v156
    v_mfma_f32_16x16x32_bf16 v[188:191], v[100:103], v[160:163], v[188:191]
    v_exp_f32 v157, v157
    v_mfma_f32_16x16x32_bf16 v[192:195], v[122:125], v[160:163], v[192:195]
    s_waitcnt lgkmcnt(4)
    v_exp_f32 v158, v158
    v_mfma_f32_16x16x32_bf16 v[172:175], v[248:251], v[252:255], v[172:175]
    ds_read_b128 v[252:255], v240 offset:3072
    ds_read_b128 v[248:251], v241 offset:37376
    v_mfma_f32_16x16x32_bf16 v[212:215], a[240:243], a[116:119], v[212:215]
    ds_read_b128 a[240:243], v224 offset:18624
    v_cvt_pk_bf16_f32 v160, v156, v157
    v_mfma_f32_16x16x32_bf16 v[220:223], a[248:251], a[120:123], v[220:223]
    v_exp_f32 v159, v159
    v_mfma_f32_16x16x32_bf16 v[216:219], a[248:251], a[124:127], v[216:219]
    s_waitcnt lgkmcnt(3)
    v_cvt_pk_bf16_f32 v161, v158, v159
    v_mfma_f32_16x16x32_bf16 v[152:155], v[6:9], v[132:135], v[152:155]
    ds_read_b128 v[156:159], v234
    v_bfe_u32 v234, s78, v232, 4
    v_mfma_f32_16x16x32_bf16 v[212:215], a[248:251], a[128:131], v[212:215]
    ds_read_b128 a[248:251], v224 offset:18688
    v_mad_u32_u24 v234, v234, s40, v230
    v_mfma_f32_16x16x32_bf16 v[220:223], a[252:255], a[132:135], v[220:223]
    v_exp_f32 v144, v144
    v_mfma_f32_16x16x16_bf16 v[152:155], v[10:11], v[136:137], v[152:155]
    v_exp_f32 v145, v145
    v_mfma_f32_16x16x32_bf16 v[216:219], a[252:255], a[136:139], v[216:219]
    v_exp_f32 v146, v146
    v_mfma_f32_16x16x32_bf16 v[212:215], a[252:255], a[140:143], v[212:215]
    ds_read_b128 a[252:255], v224 offset:18752
    v_cvt_pk_bf16_f32 v162, v144, v145
    v_mfma_f32_16x16x32_bf16 v[208:211], v[168:171], a[244:247], v[208:211]
    s_waitcnt lgkmcnt(5)
    v_cvt_pk_bf16_f32 v72, v220, v221
    v_cvt_pk_bf16_f32 v73, v222, v223
    v_mfma_f32_16x16x32_bf16 v[200:203], v[168:171], v[252:255], v[200:203]
    s_waitcnt lgkmcnt(4)
    v_cvt_pk_bf16_f32 v94, v216, v217
    v_cvt_pk_bf16_f32 v95, v218, v219
    v_mfma_f32_16x16x32_bf16 v[204:207], v[248:251], a[244:247], v[204:207]
    v_cvt_pk_bf16_f32 v116, v212, v213
    v_cvt_pk_bf16_f32 v117, v214, v215
    v_mfma_f32_16x16x32_bf16 v[180:183], v[248:251], v[252:255], v[180:183]
    ds_read_b128 v[168:171], v242 offset:36864
    ds_read_b128 v[248:251], v242 offset:37376
    v_mfma_f32_16x16x32_bf16 v[220:223], a[0:3], a[236:239], 0
    ds_read_b128 a[0:3], v241 offset:12288
    v_mov_b32 v6, 0x27e00
    v_mfma_f32_16x16x32_bf16 v[216:219], a[4:7], a[236:239], 0
    ds_read_b128 a[4:7], v241 offset:12800
    v_mfma_f32_16x16x32_bf16 v[212:215], a[8:11], a[236:239], 0
    s_waitcnt lgkmcnt(5)
    ds_read_b128 a[236:239], v224 offset:18816
    v_mfma_f32_16x16x32_bf16 v[220:223], a[12:15], a[240:243], v[220:223]
    ds_read_b128 a[8:11], v242 offset:12288
    v_mfma_f32_16x16x32_bf16 v[216:219], a[16:19], a[240:243], v[216:219]
    ds_read_b128 a[12:15], v242 offset:12800
    v_mfma_f32_16x16x32_bf16 v[212:215], a[20:23], a[240:243], v[212:215]
    ds_read_b128 a[240:243], v224 offset:18880
    v_mfma_f32_16x16x32_bf16 v[220:223], a[24:27], a[248:251], v[220:223]
    ds_read_b128 a[16:19], v241 offset:24576
    v_mfma_f32_16x16x32_bf16 v[216:219], a[28:31], a[248:251], v[216:219]
    s_waitcnt lgkmcnt(8)
    ds_read_b128 a[20:23], v241 offset:25088
    v_mfma_f32_16x16x32_bf16 v[176:179], v[168:171], a[244:247], v[176:179]
    s_waitcnt lgkmcnt(8)
    ds_read_b128 a[24:27], v242 offset:24576
    v_mfma_f32_16x16x32_bf16 v[172:175], v[248:251], a[244:247], v[172:175]
L_pg8:
    s_cbranch_execz L_back
    ds_read_b128 a[28:31], v242 offset:25088
    v_mfma_f32_16x16x32_bf16 v[212:215], a[32:35], a[248:251], v[212:215]
    ds_read_b128 a[248:251], v224 offset:18560
    v_mfma_f32_16x16x32_bf16 v[220:223], a[36:39], a[252:255], v[220:223]
    ds_read_b128 a[32:35], v241 offset:36864
    v_mfma_f32_16x16x32_bf16 v[216:219], a[40:43], a[252:255], v[216:219]
    ds_read_b128 a[36:39], v241 offset:37376
    v_mfma_f32_16x16x32_bf16 v[212:215], a[44:47], a[252:255], v[212:215]
    s_waitcnt lgkmcnt(10)
    ds_read_b128 a[252:255], v224 offset:18624
    v_mfma_f32_16x16x32_bf16 v[220:223], a[48:51], a[236:239], v[220:223]
    ds_read_b128 a[40:43], v242 offset:36864
    v_mfma_f32_16x16x32_bf16 v[216:219], a[52:55], a[236:239], v[216:219]
    ds_read_b128 a[44:47], v242 offset:37376
    v_mfma_f32_16x16x32_bf16 v[212:215], a[56:59], a[236:239], v[212:215]
    s_waitcnt lgkmcnt(10)
    ds_read_b128 a[236:239], v224 offset:18688
    v_mfma_f32_16x16x32_bf16 v[220:223], a[60:63], a[240:243], v[220:223]
    ds_read_b128 a[48:51], v241 offset:49152
    v_mfma_f32_16x16x32_bf16 v[216:219], a[64:67], a[240:243], v[216:219]
    ds_read_b128 a[52:55], v241 offset:49664
    v_mfma_f32_16x16x32_bf16 v[212:215], a[68:71], a[240:243], v[212:215]
    s_waitcnt lgkmcnt(8)
    ds_read_b128 a[240:243], v224 offset:18752
    v_exp_f32 v147, v147
    v_exp_f32 v152, v152
    ds_read_b128 a[56:59], v242 offset:49152
    v_cvt_pk_bf16_f32 v30, v220, v221
    v_cvt_pk_bf16_f32 v31, v222, v223
    v_mfma_f32_16x16x32_bf16 v[220:223], a[248:251], a[72:75], 0
    v_cvt_pk_bf16_f32 v32, v216, v217
    v_cvt_pk_bf16_f32 v33, v218, v219
    v_mfma_f32_16x16x32_bf16 v[216:219], a[248:251], a[76:79], 0
    v_cvt_pk_bf16_f32 v34, v212, v213
    v_cvt_pk_bf16_f32 v35, v214, v215
    v_mfma_f32_16x16x32_bf16 v[148:151], v[30:33], v[132:135], v[148:151]
    ds_read_b128 a[60:63], v242 offset:49664
    ds_read_b128 a[64:67], v241 offset:61440
    v_mfma_f32_16x16x32_bf16 v[212:215], a[248:251], a[80:83], 0
    s_waitcnt lgkmcnt(8)
    ds_read_b128 a[248:251], v224 offset:18816
    v_cvt_pk_bf16_f32 v163, v146, v147
    v_mfma_f32_16x16x32_bf16 v[220:223], a[252:255], a[84:87], v[220:223]
    ds_read_b128 a[68:71], v241 offset:61952
    v_mfma_f32_16x16x32_bf16 v[196:199], a[216:219], v[160:163], v[196:199]
    ds_read_b128 a[244:247], v240 offset:4096
    v_mfma_f32_16x16x32_bf16 v[184:187], v[66:69], v[160:163], v[184:187]
    ds_read_b128 v[252:255], v239 offset:5120
    v_mfma_f32_16x16x32_bf16 v[188:191], v[88:91], v[160:163], v[188:191]
    ds_read_b128 v[168:171], v242 offset:61440
    v_mfma_f32_16x16x32_bf16 v[192:195], v[110:113], v[160:163], v[192:195]
    ds_read_b128 v[248:251], v242 offset:61952
    v_mfma_f32_16x16x16_bf16 v[148:151], v[34:35], v[136:137], v[148:151]
    s_waitcnt lgkmcnt(8)
    ds_read_b128 v[144:147], v230 offset:1280
    v_mfma_f32_16x16x32_bf16 v[208:211], a[48:51], v[164:167], v[208:211]
    v_exp_f32 v153, v153
    v_mfma_f32_16x16x32_bf16 v[204:207], a[52:55], v[164:167], v[204:207]
    v_exp_f32 v154, v154
    v_mfma_f32_16x16x32_bf16 v[176:179], a[56:59], v[164:167], v[176:179]
    s_waitcnt lgkmcnt(8)
    v_exp_f32 v155, v155
    v_mfma_f32_16x16x32_bf16 v[172:175], a[60:63], v[164:167], v[172:175]
    ds_read_b128 v[164:167], v240 offset:5120
    v_cvt_pk_bf16_f32 v162, v152, v153
    v_mfma_f32_16x16x32_bf16 v[216:219], a[252:255], a[88:91], v[216:219]
    s_waitcnt lgkmcnt(5)
    v_exp_f32 v148, v148
    v_mfma_f32_16x16x32_bf16 v[200:203], a[48:51], a[244:247], v[200:203]
    v_exp_f32 v149, v149
    v_mfma_f32_16x16x32_bf16 v[180:183], a[52:55], a[244:247], v[180:183]
    v_exp_f32 v150, v150
    v_mfma_f32_16x16x32_bf16 v[212:215], a[252:255], a[92:95], v[212:215]
    ds_read_b128 a[252:255], v224 offset:18880
    v_cndmask_b32 v224, v239, v240, vcc
    v_mfma_f32_16x16x32_bf16 v[220:223], a[236:239], a[96:99], v[220:223]
    v_exp_f32 v151, v151
    v_mfma_f32_16x16x32_bf16 v[216:219], a[236:239], a[100:103], v[216:219]
    v_cvt_pk_bf16_f32 v160, v148, v149
    v_cvt_pk_bf16_f32 v161, v150, v151
    v_mfma_f32_16x16x32_bf16 v[212:215], a[236:239], a[104:107], v[212:215]
    ds_read_b128 a[236:239], v226 offset:4224
    ds_read_b128 v[148:151], v235
    v_mfma_f32_16x16x32_bf16 v[220:223], a[240:243], a[108:111], v[220:223]
    s_waitcnt lgkmcnt(3)
    v_bfe_u32 v235, s79, v233, 4
    v_mad_u32_u24 v235, v235, s40, v231
    v_mfma_f32_16x16x32_bf16 v[216:219], a[240:243], a[112:115], v[216:219]
    s_barrier
    ds_read_b128 a[244:247], v239 offset:12288
    v_cvt_pk_bf16_f32 v163, v154, v155
    v_mfma_f32_16x16x32_bf16 v[212:215], a[240:243], a[116:119], v[212:215]
    ds_read_b128 a[240:243], v226 offset:4288
    v_mfma_f32_16x16x32_bf16 v[196:199], a[216:219], v[160:163], v[196:199]
    ds_read_b128 v[152:155], v234
    v_bfe_u32 v234, s80, v233, 4
    v_mfma_f32_16x16x32_bf16 v[220:223], a[248:251], a[120:123], v[220:223]
    v_mad_u32_u24 v234, v234, s40, v231
    v_mfma_f32_16x16x32_bf16 v[216:219], a[248:251], a[124:127], v[216:219]
    v_mfma_f32_16x16x32_bf16 v[212:215], a[248:251], a[128:131], v[212:215]
    s_waitcnt lgkmcnt(5)
    ds_read_b128 a[248:251], v226 offset:4352
    v_mfma_f32_16x16x32_bf16 v[220:223], a[252:255], a[132:135], v[220:223]
    v_rcp_f32 v197, v196
    v_mfma_f32_16x16x32_bf16 v[216:219], a[252:255], a[136:139], v[216:219]
    v_max3_f32 v236, v236, v196, v197
    v_mfma_f32_16x16x32_bf16 v[212:215], a[252:255], a[140:143], v[212:215]
    ds_read_b128 a[252:255], v226 offset:4416
    v_mfma_f32_16x16x32_bf16 v[208:211], a[64:67], v[252:255], v[208:211]
    v_mfma_f32_16x16x32_bf16 v[200:203], a[64:67], v[164:167], v[200:203]
    v_mfma_f32_16x16x32_bf16 v[204:207], a[68:71], v[252:255], v[204:207]
    v_cvt_pk_bf16_f32 v70, v220, v221
    v_cvt_pk_bf16_f32 v71, v222, v223
    v_mfma_f32_16x16x32_bf16 v[180:183], a[68:71], v[164:167], v[180:183]
    v_cvt_pk_bf16_f32 v92, v216, v217
    v_cvt_pk_bf16_f32 v93, v218, v219
    v_mfma_f32_16x16x32_bf16 v[184:187], v[70:73], v[160:163], v[184:187]
    v_cvt_pk_bf16_f32 v114, v212, v213
    v_cvt_pk_bf16_f32 v115, v214, v215
    v_mfma_f32_16x16x32_bf16 v[188:191], v[92:95], v[160:163], v[188:191]
    v_cvt_pk_bf16_f32 v208, v208, v209
    v_cvt_pk_bf16_f32 v209, v210, v211
    v_mfma_f32_16x16x32_bf16 v[192:195], v[114:117], v[160:163], v[192:195]
    v_cvt_pk_bf16_f32 v210, v204, v205
    v_cvt_pk_bf16_f32 v211, v206, v207
    v_mfma_f32_16x16x32_bf16 v[176:179], v[168:171], v[252:255], v[176:179]
    buffer_store_dwordx4 v[208:211], v243, s[20:23], s58 offen sc0 sc1
    v_mfma_f32_16x16x32_bf16 v[172:175], v[248:251], v[252:255], v[172:175]
    s_waitcnt lgkmcnt(0)
    v_cvt_pk_bf16_f32 v200, v200, v201
    v_cvt_pk_bf16_f32 v201, v202, v203
    v_mfma_f32_16x16x32_bf16 v[220:223], a[144:147], a[236:239], 0
    v_cvt_pk_bf16_f32 v202, v180, v181
    v_cvt_pk_bf16_f32 v203, v182, v183
    v_mfma_f32_16x16x32_bf16 v[216:219], a[148:151], a[236:239], 0
    v_cvt_pk_bf16_f32 v176, v176, v177
    v_cvt_pk_bf16_f32 v177, v178, v179
    v_mfma_f32_16x16x32_bf16 v[212:215], a[152:155], a[236:239], 0
    ds_read_b128 a[236:239], v226 offset:4480
    v_cvt_pk_bf16_f32 v178, v172, v173
    v_mfma_f32_16x16x32_bf16 v[220:223], a[156:159], a[240:243], v[220:223]
    v_cvt_pk_bf16_f32 v179, v174, v175
    v_mul_f32 v184, v184, v197
    v_mfma_f32_16x16x32_bf16 v[216:219], a[160:163], a[240:243], v[216:219]
    v_mul_f32 v185, v185, v197
    v_cvt_pk_bf16_f32 v184, v184, v185
    v_mfma_f32_16x16x32_bf16 v[212:215], a[164:167], a[240:243], v[212:215]
    ds_read_b128 a[240:243], v226 offset:4544
    v_mul_f32 v186, v186, v197
    v_mfma_f32_16x16x32_bf16 v[220:223], a[168:171], a[248:251], v[220:223]
    v_mul_f32 v187, v187, v197
    v_cvt_pk_bf16_f32 v185, v186, v187
    v_mfma_f32_16x16x32_bf16 v[216:219], a[172:175], a[248:251], v[216:219]
    v_mul_f32 v188, v188, v197
    v_mul_f32 v189, v189, v197
    v_mfma_f32_16x16x32_bf16 v[212:215], a[176:179], a[248:251], v[212:215]
    v_cvt_pk_bf16_f32 v186, v188, v189
    v_mul_f32 v190, v190, v197
    v_mfma_f32_16x16x32_bf16 v[220:223], a[180:183], a[252:255], v[220:223]
    v_mul_f32 v191, v191, v197
    v_cvt_pk_bf16_f32 v187, v190, v191
    v_mfma_f32_16x16x32_bf16 v[216:219], a[184:187], a[252:255], v[216:219]
    buffer_store_dwordx4 v[200:203], v245, s[20:23], s58 offen sc0 sc1
    v_mfma_f32_16x16x32_bf16 v[212:215], a[188:191], a[252:255], v[212:215]
    s_waitcnt lgkmcnt(1)
    v_mul_f32 v192, v192, v197
    v_mul_f32 v193, v193, v197
    v_mfma_f32_16x16x32_bf16 v[220:223], a[192:195], a[236:239], v[220:223]
    v_cvt_pk_bf16_f32 v188, v192, v193
    v_mul_f32 v194, v194, v197
    v_mfma_f32_16x16x32_bf16 v[216:219], a[196:199], a[236:239], v[216:219]
    ds_read_b128 v[252:255], v240 offset:12288
    v_mul_f32 v195, v195, v197
    v_mfma_f32_16x16x32_bf16 v[212:215], a[200:203], a[236:239], v[212:215]
    s_waitcnt lgkmcnt(1)
    ds_read_b128 v[164:167], v239 offset:13312
    v_cvt_pk_bf16_f32 v189, v194, v195
    v_mfma_f32_16x16x32_bf16 v[220:223], a[204:207], a[240:243], v[220:223]
    ds_write_b128 v237, v[184:187]
    v_mfma_f32_16x16x32_bf16 v[216:219], a[208:211], a[240:243], v[216:219]
    ds_write_b64 v238, v[188:189]
    v_mfma_f32_16x16x32_bf16 v[212:215], a[212:215], a[240:243], v[212:215]
    v_cndmask_b32 v226, v244, v247, vcc
    v_cndmask_b32 v247, v247, v244, vcc
    v_mfma_f32_16x16x32_bf16 v[208:211], a[220:223], a[244:247], 0
    v_mfma_f32_16x16x32_bf16 v[204:207], a[224:227], a[244:247], 0
    v_mul_f32 v220, s37, v220
    v_mul_f32 v221, s37, v221
    v_mfma_f32_16x16x32_bf16 v[172:175], a[232:235], a[244:247], 0
    s_waitcnt lgkmcnt(3)
    v_mul_f32 v222, s37, v222
    v_mul_f32 v223, s37, v223
    v_mfma_f32_16x16x32_bf16 v[200:203], a[220:223], v[252:255], 0
    v_cvt_pk_bf16_f32 v138, v220, v221
    v_cvt_pk_bf16_f32 v139, v222, v223
    v_mfma_f32_16x16x32_bf16 v[180:183], a[224:227], v[252:255], 0
    s_waitcnt lgkmcnt(2)
    v_mul_f32 v216, s37, v216
    v_mul_f32 v217, s37, v217
    v_mfma_f32_16x16x32_bf16 v[208:211], a[0:3], v[164:167], v[208:211]
    v_mul_f32 v218, s37, v218
    v_mul_f32 v219, s37, v219
    v_mfma_f32_16x16x32_bf16 v[204:207], a[4:7], v[164:167], v[204:207]
    v_cvt_pk_bf16_f32 v140, v216, v217
    v_cvt_pk_bf16_f32 v141, v218, v219
    v_mfma_f32_16x16x32_bf16 v[172:175], a[12:15], v[164:167], v[172:175]
    v_mul_f32 v212, s37, v212
    v_mul_f32 v213, s37, v213
    v_mfma_f32_16x16x32_bf16 v[156:159], v[36:39], v[138:141], v[156:159]
    v_mul_f32 v214, s37, v214
    v_mul_f32 v215, s37, v215
    v_mfma_f32_16x16x32_bf16 v[144:147], v[42:45], v[138:141], v[144:147]
    s_waitcnt lgkmcnt(0)
    v_cvt_pk_bf16_f32 v142, v212, v213
    v_cvt_pk_bf16_f32 v143, v214, v215
    v_mfma_f32_16x16x32_bf16 v[148:151], v[24:27], v[138:141], v[148:151]
    s_barrier
    buffer_store_dwordx4 v[176:179], v244, s[20:23], s58 offen sc0 sc1
    v_mfma_f32_16x16x16_bf16 v[156:159], v[40:41], v[142:143], v[156:159]
    s_add_u32 s58, s51, 0x1a4000
    ds_read_b128 v[252:255], v239 offset:14336
    ds_read_b128 v[168:171], v242 offset:61440
    v_mfma_f32_16x16x16_bf16 v[144:147], v[46:47], v[142:143], v[144:147]
    ds_read_b128 v[248:251], v242 offset:61952
    v_mfma_f32_16x16x16_bf16 v[148:151], v[28:29], v[142:143], v[148:151]
    v_mfma_f32_16x16x32_bf16 v[152:155], v[30:33], v[138:141], v[152:155]
    v_mfma_f32_16x16x32_bf16 v[176:179], a[228:231], a[244:247], 0
    ds_read_b128 a[244:247], v240 offset:13312
    v_mfma_f32_16x16x32_bf16 v[176:179], a[8:11], v[164:167], v[176:179]
    ds_read_b128 v[164:167], v240 offset:14336
    v_exp_f32 v156, v156
    v_exp_f32 v157, v157
    v_mfma_f32_16x16x16_bf16 v[152:155], v[34:35], v[142:143], v[152:155]
    s_waitcnt lgkmcnt(4)
    v_exp_f32 v158, v158
    v_exp_f32 v159, v159
    v_mfma_f32_16x16x32_bf16 v[208:211], a[16:19], v[252:255], v[208:211]
    v_cvt_pk_bf16_f32 v160, v156, v157
    v_cvt_pk_bf16_f32 v161, v158, v159
    v_mfma_f32_16x16x32_bf16 v[204:207], a[20:23], v[252:255], v[204:207]
    ds_read_b128 v[156:159], v235
    v_mfma_f32_16x16x32_bf16 v[176:179], a[24:27], v[252:255], v[176:179]
    v_exp_f32 v144, v144
    v_mfma_f32_16x16x32_bf16 v[172:175], a[28:31], v[252:255], v[172:175]
    s_waitcnt lgkmcnt(2)
    ds_read_b128 v[252:255], v240 offset:15360
    v_mfma_f32_16x16x32_bf16 v[200:203], a[0:3], a[244:247], v[200:203]
    v_exp_f32 v145, v145
    v_mfma_f32_16x16x32_bf16 v[180:183], a[4:7], a[244:247], v[180:183]
    s_waitcnt lgkmcnt(2)
    ds_read_b128 a[244:247], v239 offset:15360
    v_cvt_pk_bf16_f32 v162, v144, v145
    v_mfma_f32_16x16x32_bf16 v[200:203], a[16:19], v[164:167], v[200:203]
    v_exp_f32 v146, v146
    v_mfma_f32_16x16x32_bf16 v[180:183], a[20:23], v[164:167], v[180:183]
    ds_read_b128 v[164:167], v239 offset:16384
    v_exp_f32 v147, v147
    v_exp_f32 v148, v148
    v_cvt_pk_bf16_f32 v163, v146, v147
    ds_read_b128 v[144:147], v234
    v_exp_f32 v149, v149
    v_mfma_f32_16x16x32_bf16 v[196:199], a[216:219], v[160:163], 0
    v_exp_f32 v150, v150
    v_mfma_f32_16x16x32_bf16 v[184:187], v[76:79], v[160:163], 0
    v_exp_f32 v151, v151
    v_mfma_f32_16x16x32_bf16 v[188:191], v[98:101], v[160:163], 0
    v_exp_f32 v152, v152
    v_mfma_f32_16x16x32_bf16 v[192:195], v[120:123], v[160:163], 0
    s_waitcnt lgkmcnt(3)
    v_cvt_pk_bf16_f32 v160, v148, v149
    v_cvt_pk_bf16_f32 v161, v150, v151
    v_mfma_f32_16x16x32_bf16 v[156:159], v[48:51], v[138:141], v[156:159]
    s_waitcnt lgkmcnt(2)
    v_exp_f32 v153, v153
    v_mfma_f32_16x16x32_bf16 v[208:211], a[32:35], a[244:247], v[208:211]
    v_exp_f32 v154, v154
    v_mfma_f32_16x16x32_bf16 v[200:203], a[32:35], v[252:255], v[200:203]
    v_exp_f32 v155, v155
    v_mfma_f32_16x16x32_bf16 v[204:207], a[36:39], a[244:247], v[204:207]
    v_cvt_pk_bf16_f32 v162, v152, v153
    v_cvt_pk_bf16_f32 v163, v154, v155
    v_mfma_f32_16x16x16_bf16 v[156:159], v[52:53], v[142:143], v[156:159]
    s_waitcnt lgkmcnt(0)
    v_mfma_f32_16x16x32_bf16 v[144:147], v[54:57], v[138:141], v[144:147]
    v_mfma_f32_16x16x32_bf16 v[196:199], a[216:219], v[160:163], v[196:199]
    v_mfma_f32_16x16x32_bf16 v[184:187], v[68:71], v[160:163], v[184:187]
    v_mfma_f32_16x16x32_bf16 v[188:191], v[90:93], v[160:163], v[188:191]
    v_mfma_f32_16x16x32_bf16 v[192:195], v[112:115], v[160:163], v[192:195]
    v_mfma_f32_16x16x32_bf16 v[180:183], a[36:39], v[252:255], v[180:183]
    ds_read_b128 v[252:255], v239 offset:17408
    v_mfma_f32_16x16x16_bf16 v[144:147], v[58:59], v[142:143], v[144:147]
    v_exp_f32 v156, v156
    v_mfma_f32_16x16x32_bf16 v[176:179], a[40:43], a[244:247], v[176:179]
    v_exp_f32 v157, v157
    v_mfma_f32_16x16x32_bf16 v[172:175], a[44:47], a[244:247], v[172:175]
    ds_read_b128 a[244:247], v240 offset:16384
    v_cvt_pk_bf16_f32 v160, v156, v157
    v_mfma_f32_16x16x32_bf16 v[208:211], a[48:51], v[164:167], v[208:211]
    v_exp_f32 v158, v158
    v_mfma_f32_16x16x32_bf16 v[204:207], a[52:55], v[164:167], v[204:207]
    v_exp_f32 v159, v159
    v_mfma_f32_16x16x32_bf16 v[176:179], a[56:59], v[164:167], v[176:179]
    v_cvt_pk_bf16_f32 v161, v158, v159
    v_mfma_f32_16x16x32_bf16 v[172:175], a[60:63], v[164:167], v[172:175]
    s_waitcnt lgkmcnt(1)
    ds_read_b128 v[164:167], v240 offset:17408
    v_exp_f32 v144, v144
    v_exp_f32 v145, v145
    v_mfma_f32_16x16x32_bf16 v[208:211], a[64:67], v[252:255], v[208:211]
    v_exp_f32 v146, v146
    v_mfma_f32_16x16x32_bf16 v[204:207], a[68:71], v[252:255], v[204:207]
    v_exp_f32 v147, v147
    v_mfma_f32_16x16x32_bf16 v[176:179], v[168:171], v[252:255], v[176:179]
    s_waitcnt lgkmcnt(1)
    ds_read_b128 v[168:171], v242 offset:61440
    v_cvt_pk_bf16_f32 v162, v144, v145
    v_mfma_f32_16x16x32_bf16 v[200:203], a[48:51], a[244:247], v[200:203]
    v_cvt_pk_bf16_f32 v163, v146, v147
    v_cvt_pk_bf16_f32 v208, v208, v209
    v_mfma_f32_16x16x32_bf16 v[180:183], a[52:55], a[244:247], v[180:183]
    ds_read_b128 a[244:247], v224
    v_cvt_pk_bf16_f32 v209, v210, v211
    v_mfma_f32_16x16x32_bf16 v[196:199], a[216:219], v[160:163], v[196:199]
    v_cvt_pk_bf16_f32 v210, v204, v205
    v_cvt_pk_bf16_f32 v211, v206, v207
    v_mfma_f32_16x16x32_bf16 v[184:187], v[82:85], v[160:163], v[184:187]
    buffer_store_dwordx4 v[208:211], v243, s[20:23], s58 offen sc0 sc1
    v_mfma_f32_16x16x32_bf16 v[188:191], v[104:107], v[160:163], v[188:191]
    v_cvt_pk_bf16_f32 v176, v176, v177
    v_cvt_pk_bf16_f32 v177, v178, v179
    v_mfma_f32_16x16x32_bf16 v[192:195], v[126:129], v[160:163], v[192:195]
    s_waitcnt lgkmcnt(2)
    v_rcp_f32 v197, v196
    v_mfma_f32_16x16x32_bf16 v[200:203], a[64:67], v[164:167], v[200:203]
    v_max3_f32 v236, v236, v196, v197
    v_mul_f32 v184, v184, v197
    v_mfma_f32_16x16x32_bf16 v[180:183], a[68:71], v[164:167], v[180:183]
    ds_read_b128 v[164:167], v224 offset:2048
    v_mul_f32 v185, v185, v197
    v_mfma_f32_16x16x32_bf16 v[172:175], v[248:251], v[252:255], v[172:175]
    s_waitcnt lgkmcnt(1)
    ds_read_b128 v[252:255], v224 offset:1024
    ds_read_b128 v[248:251], v242 offset:61952
    v_mfma_f32_16x16x32_bf16 v[208:211], a[220:223], a[244:247], 0
    v_cvt_pk_bf16_f32 v200, v200, v201
    v_cvt_pk_bf16_f32 v201, v202, v203
    v_mfma_f32_16x16x32_bf16 v[204:207], a[224:227], a[244:247], 0
    v_cvt_pk_bf16_f32 v202, v180, v181
    v_cvt_pk_bf16_f32 v203, v182, v183
    v_mfma_f32_16x16x32_bf16 v[180:183], a[232:235], a[244:247], 0
    s_waitcnt lgkmcnt(1)
    v_cvt_pk_bf16_f32 v178, v172, v173
    v_cvt_pk_bf16_f32 v179, v174, v175
    v_cvt_pk_bf16_f32 v184, v184, v185
    v_mul_f32 v186, v186, v197
    v_mul_f32 v187, v187, v197
    v_cvt_pk_bf16_f32 v185, v186, v187
    v_mul_f32 v188, v188, v197
    v_mul_f32 v189, v189, v197
    v_cvt_pk_bf16_f32 v186, v188, v189
    v_mul_f32 v190, v190, v197
    v_mul_f32 v191, v191, v197
    v_cvt_pk_bf16_f32 v187, v190, v191
    v_mul_f32 v192, v192, v197
    buffer_store_dwordx4 v[200:203], v245, s[20:23], s58 offen sc0 sc1
    v_mfma_f32_16x16x32_bf16 v[208:211], a[0:3], v[252:255], v[208:211]
    v_mul_f32 v193, v193, v197
    v_cvt_pk_bf16_f32 v188, v192, v193
    v_mfma_f32_16x16x32_bf16 v[200:203], a[228:231], a[244:247], 0
    ds_read_b128 a[244:247], v224 offset:3072
    v_mul_f32 v194, v194, v197
    v_mfma_f32_16x16x32_bf16 v[204:207], a[4:7], v[252:255], v[204:207]
    v_mul_f32 v195, v195, v197
    v_cvt_pk_bf16_f32 v189, v194, v195
    v_mfma_f32_16x16x32_bf16 v[200:203], a[8:11], v[252:255], v[200:203]
    ds_write_b128 v237, v[184:187] offset:6144
    v_mfma_f32_16x16x32_bf16 v[180:183], a[12:15], v[252:255], v[180:183]
    ds_write_b64 v238, v[188:189] offset:6144
    v_mfma_f32_16x16x32_bf16 v[208:211], a[16:19], v[164:167], v[208:211]
    v_cmp_lt_f32 vcc, 0x53800000, v236
    v_mfma_f32_16x16x32_bf16 v[204:207], a[20:23], v[164:167], v[204:207]
    v_mfma_f32_16x16x32_bf16 v[200:203], a[24:27], v[164:167], v[200:203]
    s_or_b32 s24, vcc_lo, vcc_hi
    v_mov_b32 v4, s24
    v_mfma_f32_16x16x32_bf16 v[180:183], a[28:31], v[164:167], v[180:183]
    s_waitcnt lgkmcnt(2)
    ds_read_b128 v[252:255], v224 offset:4096
    ds_read_b128 v[164:167], v224 offset:5120
    v_mfma_f32_16x16x32_bf16 v[208:211], a[32:35], a[244:247], v[208:211]
    ds_write_b32 v5, v4
    v_mfma_f32_16x16x32_bf16 v[204:207], a[36:39], a[244:247], v[204:207]
    buffer_store_dwordx4 v[176:179], v244, s[20:23], s58 offen sc0 sc1
    v_mfma_f32_16x16x32_bf16 v[200:203], a[40:43], a[244:247], v[200:203]
    s_add_u32 s58, s51, 0x1f8000
    v_mfma_f32_16x16x32_bf16 v[180:183], a[44:47], a[244:247], v[180:183]
    s_waitcnt lgkmcnt(2)
    v_mfma_f32_16x16x32_bf16 v[208:211], a[48:51], v[252:255], v[208:211]
    s_waitcnt lgkmcnt(0)
    v_mfma_f32_16x16x32_bf16 v[204:207], a[52:55], v[252:255], v[204:207]
    s_barrier
    ds_read_b128 a[244:247], v227
    ds_read_b128 v[0:3], v6
    v_mfma_f32_16x16x32_bf16 v[200:203], a[56:59], v[252:255], v[200:203]
    v_mfma_f32_16x16x32_bf16 v[180:183], a[60:63], v[252:255], v[180:183]
    ds_read_b128 v[252:255], v227 offset:1024
    v_mfma_f32_16x16x32_bf16 v[208:211], a[64:67], v[164:167], v[208:211]
    v_mfma_f32_16x16x32_bf16 v[204:207], a[68:71], v[164:167], v[204:207]
    v_mfma_f32_16x16x32_bf16 v[200:203], v[168:171], v[164:167], v[200:203]
    ds_read_b128 v[168:171], v242 offset:61440
    v_mfma_f32_16x16x32_bf16 v[180:183], v[248:251], v[164:167], v[180:183]
    s_waitcnt lgkmcnt(3)
    ds_read_b128 v[164:167], v227 offset:2048
    ds_read_b128 v[248:251], v242 offset:61952
    s_nop 1
    v_cvt_pk_bf16_f32 v208, v208, v209
    v_cvt_pk_bf16_f32 v209, v210, v211
    v_cvt_pk_bf16_f32 v210, v204, v205
    v_cvt_pk_bf16_f32 v211, v206, v207
    v_mfma_f32_16x16x32_bf16 v[176:179], a[220:223], a[244:247], 0
    buffer_store_dwordx4 v[208:211], v225, s[20:23], s58 offen sc0 sc1
    v_mfma_f32_16x16x32_bf16 v[172:175], a[224:227], a[244:247], 0
    v_cvt_pk_bf16_f32 v200, v200, v201
    v_cvt_pk_bf16_f32 v201, v202, v203
    v_mfma_f32_16x16x32_bf16 v[208:211], a[228:231], a[244:247], 0
    v_cvt_pk_bf16_f32 v202, v180, v181
    v_cvt_pk_bf16_f32 v203, v182, v183
    v_mfma_f32_16x16x32_bf16 v[204:207], a[232:235], a[244:247], 0
    s_waitcnt lgkmcnt(3)
    ds_read_b128 a[244:247], v227 offset:3072
    v_or3_b32 v0, v0, v1, v2
    v_mfma_f32_16x16x32_bf16 v[176:179], a[0:3], v[252:255], v[176:179]
    v_or_b32 v0, v0, v3
    v_mfma_f32_16x16x32_bf16 v[172:175], a[4:7], v[252:255], v[172:175]
    v_readfirstlane_b32 s24, v0
    v_mfma_f32_16x16x32_bf16 v[208:211], a[8:11], v[252:255], v[208:211]
    v_mfma_f32_16x16x32_bf16 v[204:207], a[12:15], v[252:255], v[204:207]
    s_waitcnt lgkmcnt(2)
    ds_read_b128 v[252:255], v227 offset:4096
    v_mfma_f32_16x16x32_bf16 v[176:179], a[16:19], v[164:167], v[176:179]
    v_mfma_f32_16x16x32_bf16 v[172:175], a[20:23], v[164:167], v[172:175]
    v_mfma_f32_16x16x32_bf16 v[208:211], a[24:27], v[164:167], v[208:211]
    v_mfma_f32_16x16x32_bf16 v[204:207], a[28:31], v[164:167], v[204:207]
    s_waitcnt lgkmcnt(1)
    ds_read_b128 v[164:167], v227 offset:5120
    v_mfma_f32_16x16x32_bf16 v[176:179], a[32:35], a[244:247], v[176:179]
    buffer_store_dwordx4 v[200:203], v226, s[20:23], s58 offen sc0 sc1
    v_mfma_f32_16x16x32_bf16 v[172:175], a[36:39], a[244:247], v[172:175]
    s_add_u32 s58, s51, 0x1f8000
    v_mfma_f32_16x16x32_bf16 v[208:211], a[40:43], a[244:247], v[208:211]
    v_mfma_f32_16x16x32_bf16 v[204:207], a[44:47], a[244:247], v[204:207]
    s_waitcnt lgkmcnt(1)
    v_mfma_f32_16x16x32_bf16 v[176:179], a[48:51], v[252:255], v[176:179]
    v_mfma_f32_16x16x32_bf16 v[172:175], a[52:55], v[252:255], v[172:175]
    v_mfma_f32_16x16x32_bf16 v[208:211], a[56:59], v[252:255], v[208:211]
    v_mfma_f32_16x16x32_bf16 v[204:207], a[60:63], v[252:255], v[204:207]
    s_waitcnt lgkmcnt(0)
    v_mfma_f32_16x16x32_bf16 v[176:179], a[64:67], v[164:167], v[176:179]
    v_mfma_f32_16x16x32_bf16 v[172:175], a[68:71], v[164:167], v[172:175]
    v_mfma_f32_16x16x32_bf16 v[208:211], v[168:171], v[164:167], v[208:211]
    v_mfma_f32_16x16x32_bf16 v[204:207], v[248:251], v[164:167], v[204:207]
    s_nop 4
    v_cvt_pk_bf16_f32 v176, v176, v177
    v_cvt_pk_bf16_f32 v177, v178, v179
    v_cvt_pk_bf16_f32 v178, v172, v173
    v_cvt_pk_bf16_f32 v179, v174, v175
    buffer_store_dwordx4 v[176:179], v246, s[20:23], s58 offen sc0 sc1
    v_cvt_pk_bf16_f32 v208, v208, v209
    v_cvt_pk_bf16_f32 v209, v210, v211
    v_cvt_pk_bf16_f32 v210, v204, v205
    v_cvt_pk_bf16_f32 v211, v206, v207
    buffer_store_dwordx4 v[208:211], v247, s[20:23], s58 offen sc0 sc1
    s_nop 1
    s_cmp_lg_u32 s24, 0
    s_cbranch_scc1 L_safe
L_exit:
    s_endpgm
L_end:
L_safe:
    s_waitcnt vmcnt(0) lgkmcnt(0)
    s_barrier
    v_mbcnt_lo_u32_b32 v0, -1, 0
    v_mbcnt_hi_u32_b32 v0, -1, v0
    s_lshl_b32 s24, s36, 6
    v_add_u32 v0, s24, v0
    s_load_dwordx4 s[24:27], s[0:1], 0
    s_load_dwordx4 s[28:31], s[0:1], 16
    s_load_dwordx2 s[32:33], s[0:1], 32
    v_lshrrev_b32 v74, 6, v0
    v_and_b32 v184, 63, v0
    v_readfirstlane_b32 s36, v74
    v_mul_u32_u24 v76, 0x2aab, v184
    v_lshrrev_b32 v76, 16, v76
    v_mul_u32_u24 v74, 6, v76
    v_sub_u32 v77, v184, v74
    v_lshrrev_b32 v74, 1, v76
    v_and_b32 v74, 4, v74
    v_xor_b32 v76, v76, v74
    v_mul_u32_u24 v74, 0x480, v76
    v_lshl_add_u32 v251, v77, 4, v74
    v_add_u32 v79, 64, v184
    v_mul_u32_u24 v78, 0x2aab, v79
    v_lshrrev_b32 v78, 16, v78
    v_mul_u32_u24 v74, 6, v78
    v_sub_u32 v79, v79, v74
    v_lshrrev_b32 v74, 1, v78
    v_and_b32 v74, 4, v74
    v_xor_b32 v78, v78, v74
    v_mul_u32_u24 v74, 0x480, v78
    v_lshl_add_u32 v252, v79, 4, v74
    v_add_u32 v81, 0x80, v184
    v_mul_u32_u24 v80, 0x2aab, v81
    v_lshrrev_b32 v80, 16, v80
    v_mul_u32_u24 v74, 6, v80
    v_sub_u32 v81, v81, v74
    v_lshrrev_b32 v74, 1, v80
    v_and_b32 v74, 4, v74
    v_xor_b32 v80, v80, v74
    v_mul_u32_u24 v74, 0x480, v80
    v_lshl_add_u32 v253, v81, 4, v74
    s_mul_i32 s49, s36, 0x60
    s_mul_i32 s50, s36, 0xc00
    s_add_u32 s50, s50, 0x15e00
    s_mov_b32 s10, 0x36000
    s_mov_b32 s11, 0x20000
    s_add_u32 s57, s49, 0x180
    s_add_u32 m0, s50, 0
    s_lshr_b32 s53, s2, 3
    s_and_b32 s54, s2, 1
    s_lshl_b32 s54, s54, 2
    s_lshr_b32 s55, s53, 3
    s_or_b32 s34, s54, s55
    s_and_b32 s35, s53, 7
    s_bfe_u32 s54, s2, 0x10002
    s_mul_i32 s54, s54, 0x15000
    s_bfe_u32 s55, s2, 0x10001
    s_mul_i32 s55, s55, 0x180
    s_add_u32 s38, s54, s55
    s_lshl_b32 s41, s36, 10
    s_add_u32 s42, s41, 0x1000
    s_min_u32 s42, s42, 0x1a00
    s_mul_i32 s54, s35, 14
    s_sub_u32 s54, s54, 3
    s_movk_i32 s53, 0x6f
    s_lshr_b32 s55, s41, 4
    v_add_u32 v96, s55, v184
    v_mul_u32_u24 v97, 0xaab, v96
    v_lshrrev_b32 v97, 16, v97
    v_mul_u32_u24 v98, 24, v97
    v_sub_u32 v96, v96, v98
    v_and_b32 v98, 2, v97
    v_xor_b32 v96, v96, v98
    v_add_u32 v97, s54, v97
    v_med3_i32 v97, v97, 0, s53
    v_mul_u32_u24 v97, 0x300, v97
    v_lshl_add_u32 v246, v96, 4, v97
    s_lshr_b32 s55, s42, 4
    v_add_u32 v96, s55, v184
    s_waitcnt lgkmcnt(0)
    s_mov_b32 s8, s26
    s_and_b32 s9, s27, 0xffff
    buffer_load_dwordx4 v251, s[8:11], s57 offen lds
    s_add_u32 m0, s50, 0x400
    v_mul_u32_u24 v97, 0xaab, v96
    buffer_load_dwordx4 v252, s[8:11], s57 offen lds
    s_add_u32 m0, s50, 0x800
    v_lshrrev_b32 v97, 16, v97
    buffer_load_dwordx4 v253, s[8:11], s57 offen lds
    v_mul_u32_u24 v98, 24, v97
    v_sub_u32 v96, v96, v98
    v_and_b32 v98, 2, v97
    v_xor_b32 v96, v96, v98
    v_add_u32 v97, s54, v97
    v_med3_i32 v97, v97, 0, s53
    v_mul_u32_u24 v97, 0x300, v97
    v_lshl_add_u32 v247, v96, 4, v97
    s_mul_i32 s51, s34, 0x24c000
    s_add_u32 s51, s51, s38
    s_sub_u32 s39, s51, 0x7e000
    s_cmp_eq_u32 s34, 0
    s_cselect_b32 s43, 8, 0
    s_cselect_b32 s44, 9, 1
    s_cselect_b32 s45, 3, 2
    s_mul_i32 s43, s43, 0x2a000
    s_add_u32 s43, s43, s39
    s_mul_i32 s44, s44, 0x2a000
    s_add_u32 s44, s44, s39
    s_mul_i32 s45, s45, 0x2a000
    s_add_u32 s45, s45, s39
    s_mov_b32 s4, s24
    s_and_b32 s5, s25, 0xffff
    s_mov_b32 s6, 0x1260000
    s_mov_b32 s7, 0x20000
    s_mov_b32 s12, s28
    s_and_b32 s13, s29, 0xffff
    s_mov_b32 s14, 0x12000
    s_mov_b32 s15, 0x20000
    s_mov_b32 s16, s30
    s_and_b32 s17, s31, 0xffff
    s_mov_b32 s18, 0x548
    s_mov_b32 s19, 0x20000
    s_mov_b32 s20, s32
    s_and_b32 s21, s33, 0xffff
    s_mov_b32 s22, 0x1260000
    s_mov_b32 s23, 0x20000
    s_add_u32 m0, s41, 0
    s_add_u32 s56, s39, 0x7e000
    buffer_load_dwordx4 v246, s[4:7], s43 offen lds
    s_add_u32 m0, s42, 0
    s_add_u32 s57, s49, 0x9180
    buffer_load_dwordx4 v247, s[4:7], s43 offen lds
    s_add_u32 m0, s41, 0x1e40
    s_mul_i32 s55, s36, 0x152
    buffer_load_dwordx4 v246, s[4:7], s44 offen lds
    s_add_u32 m0, s42, 0x1e40
    v_lshlrev_b32 v199, 1, v184
    buffer_load_dwordx4 v247, s[4:7], s44 offen lds
    s_add_u32 m0, s41, 0x3c80
    v_lshrrev_b32 v185, 4, v184
    buffer_load_dwordx4 v246, s[4:7], s45 offen lds
    s_add_u32 m0, s42, 0x3c80
    v_and_b32 v186, 7, v184
    v_bfe_u32 v187, v184, 3, 1
    v_bfe_u32 v96, v184, 2, 2
    v_and_b32 v97, 3, v184
    v_and_b32 v103, 1, v185
    v_lshl_add_u32 v99, v185, 3, v96
    v_lshl_add_u32 v99, v103, 2, v99
    v_lshl_add_u32 v101, v97, 3, s50
    s_movk_i32 s27, 0x60
    v_mad_u32_u24 v254, v99, s27, v101
    buffer_load_dwordx4 v247, s[4:7], s45 offen lds
    s_add_u32 m0, s41, 0x5ac0
    v_xor_b32 v99, 4, v99
    v_mad_u32_u24 v255, v99, s27, v101
    v_mul_u32_u24 v102, 0x1e40, v187
    v_and_b32 v98, 2, v184
    v_xor_b32 v98, v98, v185
    v_lshlrev_b32 v98, 4, v98
    v_mul_u32_u24 v100, 0x180, v186
    v_add3_u32 v224, v98, v100, v102
    v_mul_u32_u24 v99, 0x1e40, v96
    v_mul_u32_u24 v227, 0x180, v97
    buffer_load_dwordx4 v246, s[4:7], s56 offen lds
    s_add_u32 m0, s42, 0x5ac0
    v_add3_u32 v227, v227, v98, v99
    v_mul_u32_u24 v74, 0x180, v76
    v_lshl_add_u32 v192, v77, 4, v74
    v_and_b32 v74, 16, v76
    v_mul_u32_u24 v74, 0x300, v74
    v_add_u32 v86, v74, v192
    v_mul_u32_u24 v74, 0x180, v78
    v_lshl_add_u32 v193, v79, 4, v74
    v_and_b32 v74, 16, v78
    buffer_load_dwordx4 v247, s[4:7], s56 offen lds
    s_add_u32 m0, s50, 0x3000
    s_add_u32 s56, s39, 0xa8000
    v_mul_u32_u24 v74, 0x300, v74
    v_add_u32 v87, v74, v193
    v_mul_u32_u24 v74, 0x180, v80
    v_lshl_add_u32 v194, v81, 4, v74
    v_and_b32 v74, 16, v80
    v_mul_u32_u24 v74, 0x300, v74
    v_add_u32 v108, v74, v194
    v_add_u32 v98, 3, v186
    v_and_b32 v98, 2, v98
    v_xor_b32 v98, v98, v185
    buffer_load_dwordx4 v251, s[8:11], s57 offen lds
    s_add_u32 m0, s50, 0x3400
    v_lshl_add_u32 v98, v98, 4, v100
    v_add_u32 v225, v98, v102
    v_xor_b32 v99, 1, v187
    v_mul_u32_u24 v99, 0xd3c0, v99
    v_add_u32 v226, v98, v99
    v_lshl_add_u32 v99, v185, 2, v96
    v_and_b32 v98, 2, v185
    v_lshlrev_b32 v98, 1, v98
    v_xor_b32 v99, v99, v98
    buffer_load_dwordx4 v252, s[8:11], s57 offen lds
    s_add_u32 m0, s50, 0x3800
    v_mul_u32_u24 v99, 0x60, v99
    v_bfrev_b32 v98, v97
    v_lshrrev_b32 v98, 27, v98
    v_add3_u32 v109, v99, v98, s50
    v_lshlrev_b32 v99, 7, v185
    v_lshl_add_u32 v99, v186, 4, v99
    v_lshl_add_u32 v101, v187, 9, v99
    v_add_u32 v130, s50, v101
    v_lshl_add_u32 v99, v187, 10, v99
    s_and_b32 s24, s36, 1
    buffer_load_dwordx4 v253, s[8:11], s57 offen lds
    s_add_u32 s57, s49, 0x12180
    s_add_u32 m0, s50, 0x6000
    s_lshl_b32 s25, s24, 10
    s_add_u32 s26, s25, s50
    v_add_u32 v241, s26, v99
    s_lshr_b32 s27, s36, 1
    s_mul_i32 s26, s27, 0x1800
    s_add_u32 s26, s26, 0x16600
    v_add_u32 v242, s26, v99
    s_lshl_b32 s25, s24, 5
    v_mul_u32_u24 v99, 0x2a000, v187
    v_lshl_add_u32 v99, v100, 1, v99
    v_lshl_add_u32 v99, v185, 4, v99
    v_cmp_lt_u32 vcc, 5, v186
    v_add_u32 v98, 0x1800, v99
    v_bfrev_b32 v101, 1
    v_cndmask_b32 v98, v98, v101, vcc
    s_sub_u32 s59, 0, s24
    s_mov_b32 vcc_lo, s59
    s_mov_b32 vcc_hi, s59
    v_cndmask_b32 v101, v99, v98, vcc
    v_cndmask_b32 v102, v98, v99, vcc
    s_add_u32 s25, s25, s49
    v_add_u32 v243, s25, v101
    v_add_u32 v245, s25, v102
    s_mul_i32 s26, s27, 0xc0
    s_add_u32 s26, s26, 64
    v_add_u32 v244, s26, v101
    s_mul_i32 s25, s35, 0x2a00
    s_add_u32 s51, s51, s25
    s_add_u32 s58, s51, 0
    v_lshlrev_b32 v99, 4, v184
    v_add_u32 v99, 0x12e00, v99
    s_mul_i32 s25, s24, 0x1800
    v_add_u32 v239, s25, v99
    s_sub_u32 s25, 0x1800, s25
    v_add_u32 v240, s25, v99
    s_mul_i32 s25, s27, 0xc00
    s_lshl_b32 s26, s24, 11
    s_add_u32 s26, s26, s25
    v_add_u32 v237, s26, v99
    s_lshl_b32 s26, s24, 3
    s_add_u32 s26, s26, s25
    s_add_u32 s26, s26, 0x400
    v_add_u32 v238, s26, v99
    s_mov_b32 s37, 0x3e553b95
    s_mov_b32 s40, 0x140
    s_cmp_eq_u32 s34, 7
    s_cselect_b32 s46, 16, 17
    s_cselect_b32 s47, 10, 18
    s_cselect_b32 s48, 11, 19
    s_mul_i32 s46, s46, 0x2a000
    s_add_u32 s46, s46, s39
    s_mul_i32 s47, s47, 0x2a000
    s_add_u32 s47, s47, s39
    s_mul_i32 s48, s48, 0x2a000
    s_add_u32 s48, s48, s39
    v_mov_b32 v96, 0x3f803f80
    v_accvgpr_write_b32 a216, v96
    v_accvgpr_write_b32 a217, v96
    v_accvgpr_write_b32 a218, v96
    v_accvgpr_write_b32 a219, v96
    s_cmp_eq_u32 s35, 0
    s_cselect_b32 s29, 3, 0
    s_cselect_b32 s30, -3, -2
    s_cmp_eq_u32 s35, 7
    s_cselect_b32 s33, 2, 64
    s_mul_i32 s32, s36, 0xf00
    s_add_u32 s32, s32, 0xf200
    v_lshrrev_b32 v60, 1, v185
    v_lshl_add_u32 v61, v187, 1, v60
    v_lshlrev_b32 v232, 2, v61
    v_lshl_add_u32 v61, v187, 2, v185
    v_lshlrev_b32 v233, 2, v61
    v_sub_u32 v60, v60, v187
    v_mul_i32_i24 v60, 0x140, v60
    s_sub_u32 s31, s32, 0x140
    v_add_u32 v60, s31, v60
    v_lshl_add_u32 v61, v103, 2, 3
    v_cmp_gt_u32 vcc, s29, v186
    v_sub_u32 v62, v61, v186
    v_min_u32 v63, 10, v62
    v_mad_u32_u24 v64, v186, 3, v103
    v_add_u32 v65, 11, v64
    v_cndmask_b32 v63, v63, v65, vcc
    v_lshl_add_u32 v228, v63, 4, v60
    v_add_u32 v62, 8, v62
    v_min_u32 v63, 10, v62
    v_lshl_add_u32 v62, v103, 4, v186
    v_cmp_gt_u32 vcc, s29, v62
    v_add_u32 v65, 13, v64
    v_min_u32 v62, 5, v186
    v_cndmask_b32 v63, v63, v65, vcc
    v_lshl_add_u32 v229, v63, 4, v60
    v_cmp_lt_u32 vcc, s33, v62
    v_sub_u32 v63, v61, v62
    v_min_u32 v63, 10, v63
    v_mad_u32_u24 v64, v62, 3, 2
    v_add_u32 v65, v64, v103
    v_cndmask_b32 v63, v63, v65, vcc
    v_lshl_add_u32 v230, v63, 4, v60
    v_sub_u32 v63, 11, v62
    v_min_u32 v63, 10, v63
    v_add_u32 v65, 2, v64
    v_cndmask_b32 v63, v63, v65, vcc
    v_lshl_add_u32 v231, v63, 4, s32
    s_mov_b32 s60, 0x2222
    s_mov_b32 s61, 0x4444
    s_mov_b32 s62, 0x8808
    s_mov_b32 s63, 0x32104321
    s_mov_b32 s64, 0x76540765
    s_mov_b32 s65, 0x2222
    s_mov_b32 s66, 0x10002100
    s_mov_b32 s67, 0x54326543
    s_mov_b32 s68, 0x760007
    s_mov_b32 s69, 0x32104321
    s_mov_b32 s70, 0x76540765
    s_mov_b32 s71, 0x10002100
    s_mov_b32 s72, 0x760007
    s_mov_b32 s73, 0x2222
    s_mov_b32 s74, 0x8808
    s_mov_b32 s75, 0x760007
    s_mov_b32 s76, 0x10002100
    s_mov_b32 s77, 0x6666
    s_mov_b32 s78, 0x8808
    s_mov_b32 s79, 0x32104321
    s_mov_b32 s80, 0x76540765
    s_cmp_eq_u32 s34, 0
    s_cmov_b32 s60, 0xbbbb
    s_cmov_b32 s61, 0x4241
    v_bfe_u32 v234, s60, v232, 4
    v_mad_u32_u24 v235, v234, s40, v228
    v_mad_u32_u24 v234, v234, s40, v229
    v_bfe_u32 v250, s61, v232, 4
    s_cmp_eq_u32 s34, 0
    s_cmov_b32 s62, 0x8898
    s_cmov_b32 s63, 0x30a940ba
    s_cmp_eq_u32 s34, 0
    s_cmov_b32 s64, 0x76549765
    s_cmov_b32 s65, 0x2221
    s_cmp_eq_u32 s34, 0
    s_cmov_b32 s66, 0x10002000
    s_cmov_b32 s68, 0x760097
    s_cmp_eq_u32 s34, 7
    s_cmov_b32 s73, 0x2d22
    s_cmov_b32 s74, 0x1808
    s_cmp_eq_u32 s34, 7
    s_cmov_b32 s75, 0x60007
    s_cmov_b32 s76, 0x1b002100
    s_cmp_eq_u32 s34, 7
    s_cmov_b32 s77, 0x1606
    s_cmov_b32 s78, 0xbbbb
    s_cmp_eq_u32 s34, 7
    s_cmov_b32 s79, 0x321b4321
    s_cmov_b32 s80, 0xa904ba05
    s_lshl_b32 s31, s36, 10
    s_add_u32 s31, s31, 0x12e40
    v_and_b32 v118, 31, v184
    v_min_u32 v118, 19, v118
    v_lshrrev_b32 v119, 5, v184
    v_add_u32 v120, -11, v118
    v_max_i32 v120, 0, v120
    v_mul_u32_u24 v121, 11, v120
    v_lshrrev_b32 v121, 5, v121
    v_mul_u32_u24 v122, 3, v121
    v_sub_u32 v120, v120, v122
    v_lshlrev_b32 v120, 2, v120
    v_sub_u32 v121, v120, v121
    v_cmp_lt_u32 vcc, 10, v118
    v_add_u32 v121, s29, v121
    v_add_u32 v120, s30, v120
    v_add_u32 v122, -3, v118
    v_cndmask_b32 v121, v118, v121, vcc
    v_cndmask_b32 v120, v122, v120, vcc
    s_mov_b32 vcc_lo, s59
    s_mov_b32 vcc_hi, s59
    v_mad_u32_u24 v121, v119, 13, v121
    v_lshl_add_u32 v121, v121, 2, s31
    s_cmp_eq_u32 s34, 0
    s_cselect_b32 s28, 0x208, 0
    v_add_u32 v122, s28, v121
    buffer_load_dwordx4 v251, s[8:11], s57 offen lds
    s_add_u32 m0, s50, 0x6400
    v_cmp_gt_u32 s[24:25], 7, v120
    v_add_u32 v120, 1, v120
    v_cmp_gt_u32 s[26:27], 7, v120
    v_add_u32 v120, 1, v120
    v_cmp_gt_u32 s[52:53], 7, v120
    v_add_u32 v120, 1, v120
    v_lshl_add_u32 v118, v118, 4, s32
    v_mad_u32_u24 v123, v119, s40, v118
    v_lshlrev_b32 v119, 3, v119
    v_mad_u32_u24 v124, v119, s40, v118
    v_lshl_add_u32 v125, v184, 2, s31
    buffer_load_dwordx4 v252, s[8:11], s57 offen lds
    s_add_u32 m0, s50, 0x6800
    s_mov_b32 s28, 0x40ddb3d7
    v_mov_b32 v168, 0xf149f2ca
    v_mov_b32 v169, 0xf149f2ca
    v_mov_b32 v170, 0xf149f2ca
    v_mov_b32 v171, 0xf149f2ca
    buffer_load_dwordx4 v253, s[8:11], s57 offen lds
    s_add_u32 s57, s49, 0x1b180
    s_add_u32 m0, s50, 0x9000
    s_waitcnt vmcnt(14)
    ds_read_b64_tr_b16 a[0:1], v254
    ds_read_b64_tr_b16 a[2:3], v255
    ds_read_b64_tr_b16 a[4:5], v254 offset:32
    ds_read_b64_tr_b16 a[6:7], v255 offset:32
    ds_read_b64_tr_b16 a[8:9], v254 offset:64
    ds_read_b64_tr_b16 a[10:11], v255 offset:64
    buffer_load_dwordx4 v251, s[8:11], s57 offen lds
    s_add_u32 m0, s50, 0x9400
    s_nop 0
    buffer_load_dwordx4 v252, s[8:11], s57 offen lds
    s_add_u32 m0, s50, 0x9800
    s_nop 0
    buffer_load_dwordx4 v253, s[8:11], s57 offen lds
    s_add_u32 s57, s49, 0x24180
    s_add_u32 m0, s50, 0xc000
    s_nop 0
    buffer_load_ushort v196, v199, s[16:19], s55 offen
    s_waitcnt vmcnt(14)
    s_barrier
    ds_read_b128 a[236:239], v224
    ds_read_b128 a[240:243], v224 offset:64
    ds_read_b128 a[244:247], v224 offset:128
    ds_read_b128 a[248:251], v224 offset:192
    buffer_load_ushort v197, v199, s[16:19], s55 offen offset:128
    ds_read_b128 a[252:255], v224 offset:256
    ds_read_b128 a[220:223], v224 offset:320
    ds_read_b128 a[224:227], v224 offset:3072
    ds_read_b128 a[228:231], v224 offset:3136
    buffer_load_ushort v198, v199, s[16:19], s55 offen offset:256
    ds_read_b128 a[232:235], v224 offset:3200
    v_cmp_gt_u32 s[54:55], 7, v120
    s_waitcnt lgkmcnt(8)
    v_mfma_f32_16x16x32_bf16 v[220:223], a[0:3], a[236:239], 0
    v_mfma_f32_16x16x32_bf16 v[216:219], a[4:7], a[236:239], 0
    v_mfma_f32_16x16x32_bf16 v[212:215], a[8:11], a[236:239], 0
    s_waitcnt lgkmcnt(2)
    ds_read_b128 a[236:239], v224 offset:3264
    buffer_load_dwordx4 v251, s[8:11], s57 offen lds
    s_add_u32 m0, s50, 0xc400
    s_nop 0
    v_mfma_f32_16x16x32_bf16 v[208:211], a[0:3], a[224:227], 0
    v_mfma_f32_16x16x32_bf16 v[204:207], a[4:7], a[224:227], 0
    s_waitcnt vmcnt(10)
    buffer_load_dwordx4 v252, s[8:11], s57 offen lds
    v_mfma_f32_16x16x32_bf16 v[200:203], a[8:11], a[224:227], 0
    s_add_u32 m0, s50, 0xc800
    s_barrier
    ds_read_b128 a[224:227], v224 offset:15680
    buffer_load_dwordx4 v253, s[8:11], s57 offen lds
    s_add_u32 s57, s49, 0x2d180
    s_add_u32 m0, s50, 0xf000
    s_nop 0
    buffer_load_dwordx4 v251, s[8:11], s57 offen lds
    s_add_u32 m0, s50, 0xf400
    s_nop 0
    buffer_load_dwordx4 v252, s[8:11], s57 offen lds
    s_add_u32 m0, s50, 0xf800
    s_nop 0
    ds_read_b64_tr_b16 a[12:13], v254 offset:12288
    ds_read_b64_tr_b16 a[14:15], v255 offset:12288
    ds_read_b64_tr_b16 a[16:17], v254 offset:12320
    ds_read_b64_tr_b16 a[18:19], v255 offset:12320
    ds_read_b64_tr_b16 a[20:21], v254 offset:12352
    ds_read_b64_tr_b16 a[22:23], v255 offset:12352
    buffer_load_dwordx4 v253, s[8:11], s57 offen lds
    s_add_u32 m0, s41, 0x7900
    s_add_u32 s57, s49, 0x300
    buffer_load_dwordx4 v246, s[4:7], s56 offen lds
    s_add_u32 m0, s42, 0x7900
    s_nop 0
    s_waitcnt lgkmcnt(4)
    v_mfma_f32_16x16x32_bf16 v[220:223], a[12:15], a[240:243], v[220:223]
    s_waitcnt lgkmcnt(2)
    v_mfma_f32_16x16x32_bf16 v[216:219], a[16:19], a[240:243], v[216:219]
    s_waitcnt lgkmcnt(0)
    v_mfma_f32_16x16x32_bf16 v[212:215], a[20:23], a[240:243], v[212:215]
    ds_read_b128 a[240:243], v224 offset:3328
    v_mfma_f32_16x16x32_bf16 v[208:211], a[12:15], a[228:231], v[208:211]
    s_waitcnt vmcnt(13)
    buffer_load_dwordx4 v247, s[4:7], s56 offen lds
    v_mfma_f32_16x16x32_bf16 v[204:207], a[16:19], a[228:231], v[204:207]
    s_add_u32 s56, s39, 0xd2000
    ds_read_b64_tr_b16 a[24:25], v254 offset:24576
    ds_read_b64_tr_b16 a[26:27], v255 offset:24576
    v_mfma_f32_16x16x32_bf16 v[200:203], a[20:23], a[228:231], v[200:203]
    s_add_u32 m0, s41, 0x9740
    ds_read_b128 a[228:231], v224 offset:15744
    ds_read_b64_tr_b16 a[28:29], v254 offset:24608
    ds_read_b64_tr_b16 a[30:31], v255 offset:24608
    ds_read_b64_tr_b16 a[32:33], v254 offset:24640
    buffer_load_dwordx4 v246, s[4:7], s56 offen lds
    s_add_u32 m0, s42, 0x9740
    ds_read_b64_tr_b16 a[34:35], v255 offset:24640
    buffer_load_dwordx4 v247, s[4:7], s56 offen lds
    s_add_u32 s56, s39, 0xfc000
    s_add_u32 m0, s41, 0xb580
    s_nop 0
    s_waitcnt lgkmcnt(5)
    v_mfma_f32_16x16x32_bf16 v[220:223], a[24:27], a[244:247], v[220:223]
    v_mfma_f32_16x16x32_bf16 v[208:211], a[24:27], a[232:235], v[208:211]
    s_waitcnt lgkmcnt(2)
    v_mfma_f32_16x16x32_bf16 v[216:219], a[28:31], a[244:247], v[216:219]
    s_waitcnt vmcnt(13) lgkmcnt(0)
    buffer_load_dwordx4 v246, s[4:7], s56 offen lds
    v_mfma_f32_16x16x32_bf16 v[212:215], a[32:35], a[244:247], v[212:215]
    s_add_u32 m0, s42, 0xb580
    ds_read_b128 a[244:247], v224 offset:3392
    ds_read_b64_tr_b16 a[36:37], v254 offset:36864
    v_mfma_f32_16x16x32_bf16 v[204:207], a[28:31], a[232:235], v[204:207]
    ds_read_b64_tr_b16 a[38:39], v255 offset:36864
    ds_read_b64_tr_b16 a[40:41], v254 offset:36896
    v_mfma_f32_16x16x32_bf16 v[200:203], a[32:35], a[232:235], v[200:203]
    s_waitcnt vmcnt(11) lgkmcnt(1)
    buffer_load_dwordx4 v247, s[4:7], s56 offen lds
    s_add_u32 s56, s39, 0x126000
    s_add_u32 m0, s41, 0xd3c0
    ds_read_b128 a[232:235], v224 offset:15808
    ds_read_b64_tr_b16 a[42:43], v255 offset:36896
    ds_read_b64_tr_b16 a[44:45], v254 offset:36928
    v_lshlrev_b32 v196, 16, v196
    ds_read_b64_tr_b16 a[46:47], v255 offset:36928
    v_mul_f32 v196, s28, v196
    ds_write_b32 v125, v196
    v_lshlrev_b32 v197, 16, v197
    v_mul_f32 v197, s28, v197
    ds_write_b32 v125, v197 offset:256
    buffer_load_dwordx4 v246, s[4:7], s56 offen lds
    s_add_u32 m0, s42, 0xd3c0
    v_lshlrev_b32 v198, 16, v198
    v_mul_f32 v198, s28, v198
    ds_write_b32 v125, v198 offset:512
    v_mfma_f32_16x16x32_bf16 v[220:223], a[36:39], a[248:251], v[220:223]
    ds_read2_b32 v[144:145], v121 offset0:39 offset1:40
    ds_read2_b32 v[146:147], v121 offset0:41 offset1:42
    v_mfma_f32_16x16x32_bf16 v[208:211], a[36:39], a[236:239], v[208:211]
    s_waitcnt lgkmcnt(7)
    ds_read2_b32 v[148:149], v121 offset0:65 offset1:66
    ds_read2_b32 v[150:151], v121 offset0:67 offset1:68
    v_mfma_f32_16x16x32_bf16 v[216:219], a[40:43], a[248:251], v[216:219]
    s_waitcnt lgkmcnt(7)
    ds_read2_b32 v[152:153], v121 offset0:91 offset1:92
    ds_read2_b32 v[154:155], v121 offset0:93 offset1:94
    v_mfma_f32_16x16x32_bf16 v[212:215], a[44:47], a[248:251], v[212:215]
    buffer_load_dwordx4 v247, s[4:7], s56 offen lds
    v_mfma_f32_16x16x32_bf16 v[204:207], a[40:43], a[236:239], v[204:207]
    s_add_u32 m0, s50, 0
    ds_read_b128 a[248:251], v224 offset:15488
    ds_read2_b32 v[156:157], v121 offset0:117 offset1:118
    v_mfma_f32_16x16x32_bf16 v[200:203], a[44:47], a[236:239], v[200:203]
    s_add_u32 s56, s39, 0x150000
    ds_read_b128 a[236:239], v224 offset:18560
    ds_read2_b32 v[158:159], v121 offset0:119 offset1:120
    ds_read2_b32 v[160:161], v122 offset0:0 offset1:1
    ds_read2_b32 v[162:163], v122 offset0:2 offset1:3
    ds_read2_b32 v[164:165], v122 offset0:13 offset1:14
    ds_read2_b32 v[166:167], v122 offset0:15 offset1:16
    buffer_load_dwordx4 v251, s[8:11], s57 offen lds
    s_waitcnt vmcnt(12)
    ds_read_b64_tr_b16 a[48:49], v254 offset:49152
    ds_read_b64_tr_b16 a[50:51], v255 offset:49152
    s_add_u32 m0, s50, 0x400
    ds_read_b64_tr_b16 a[52:53], v254 offset:49184
    s_waitcnt lgkmcnt(15)
    v_cndmask_b32 v144, v168, v144, s[24:25]
    ds_read_b64_tr_b16 a[54:55], v255 offset:49184
    ds_read_b64_tr_b16 a[56:57], v254 offset:49216
    ds_read_b64_tr_b16 a[58:59], v255 offset:49216
    v_cndmask_b32 v145, v168, v145, s[26:27]
    v_cndmask_b32 v146, v168, v146, s[52:53]
    v_cndmask_b32 v147, v168, v147, s[54:55]
    ds_write_b128 v123, v[144:147] offset:320
    buffer_load_dwordx4 v252, s[8:11], s57 offen lds
    s_add_u32 m0, s50, 0x800
    s_waitcnt lgkmcnt(13)
    v_cndmask_b32 v148, v168, v148, s[24:25]
    v_cndmask_b32 v149, v168, v149, s[26:27]
    v_cndmask_b32 v150, v168, v150, s[52:53]
    v_cndmask_b32 v151, v168, v151, s[54:55]
    ds_write_b128 v123, v[148:151] offset:960
    v_cndmask_b32 v152, v168, v152, s[24:25]
    s_waitcnt lgkmcnt(6)
    v_mfma_f32_16x16x32_bf16 v[220:223], a[48:51], a[252:255], v[220:223]
    s_waitcnt lgkmcnt(4)
    v_cndmask_b32 v153, v168, v153, s[26:27]
    v_cndmask_b32 v154, v168, v154, s[52:53]
    v_mfma_f32_16x16x32_bf16 v[216:219], a[52:55], a[252:255], v[216:219]
    s_waitcnt lgkmcnt(2)
    v_cndmask_b32 v155, v168, v155, s[54:55]
    v_cndmask_b32 v156, v168, v156, s[24:25]
    v_mfma_f32_16x16x32_bf16 v[212:215], a[56:59], a[252:255], v[212:215]
    s_waitcnt vmcnt(10)
    buffer_load_dwordx4 v253, s[8:11], s57 offen lds
    v_mfma_f32_16x16x32_bf16 v[208:211], a[48:51], a[240:243], v[208:211]
    s_add_u32 s57, s49, 0x9300
    ds_read_b128 a[252:255], v224 offset:15552
    ds_read_b64_tr_b16 a[60:61], v254 offset:61440
    v_mfma_f32_16x16x32_bf16 v[204:207], a[52:55], a[240:243], v[204:207]
    s_add_u32 m0, s50, 0x3000
    ds_read_b64_tr_b16 a[62:63], v255 offset:61440
    ds_read_b64_tr_b16 a[64:65], v254 offset:61472
    v_mfma_f32_16x16x32_bf16 v[200:203], a[56:59], a[240:243], v[200:203]
    s_waitcnt lgkmcnt(1)
    ds_read_b128 a[240:243], v224 offset:18624
    v_cndmask_b32 v157, v168, v157, s[26:27]
    ds_read_b64_tr_b16 a[66:67], v255 offset:61472
    ds_read_b64_tr_b16 a[68:69], v254 offset:61504
    ds_read_b64_tr_b16 a[70:71], v255 offset:61504
    buffer_load_dwordx4 v251, s[8:11], s57 offen lds
    s_add_u32 m0, s50, 0x3400
    ds_write_b128 v123, v[152:155] offset:1600
    v_cndmask_b32 v158, v168, v158, s[52:53]
    v_cndmask_b32 v159, v168, v159, s[54:55]
    ds_write_b128 v123, v[156:159] offset:2240
    v_cndmask_b32 v160, v168, v160, s[24:25]
    v_cndmask_b32 v161, v168, v161, s[26:27]
    v_cndmask_b32 v162, v168, v162, s[52:53]
    v_cndmask_b32 v163, v168, v163, s[54:55]
    v_mfma_f32_16x16x32_bf16 v[220:223], a[60:63], a[220:223], v[220:223]
    s_waitcnt lgkmcnt(4)
    buffer_load_dwordx4 v252, s[8:11], s57 offen lds
    v_mfma_f32_16x16x32_bf16 v[208:211], a[60:63], a[244:247], v[208:211]
    s_add_u32 m0, s50, 0x3800
    ds_write_b128 v123, v[160:163] offset:2880
    v_mfma_f32_16x16x32_bf16 v[216:219], a[64:67], a[220:223], v[216:219]
    s_waitcnt lgkmcnt(3)
    v_cndmask_b32 v164, v168, v164, s[24:25]
    v_cndmask_b32 v165, v168, v165, s[26:27]
    v_mfma_f32_16x16x32_bf16 v[212:215], a[68:71], a[220:223], v[212:215]
    v_cvt_pk_bf16_f32 v0, v220, v221
    v_cvt_pk_bf16_f32 v1, v222, v223
    v_mfma_f32_16x16x32_bf16 v[204:207], a[64:67], a[244:247], v[204:207]
    v_cvt_pk_bf16_f32 v24, v208, v209
    v_cvt_pk_bf16_f32 v25, v210, v211
    v_mfma_f32_16x16x32_bf16 v[200:203], a[68:71], a[244:247], v[200:203]
    s_waitcnt vmcnt(9)
    v_cvt_pk_bf16_f32 v2, v216, v217
    v_cvt_pk_bf16_f32 v3, v218, v219
    v_mfma_f32_16x16x32_bf16 v[220:223], a[0:3], a[248:251], 0
    s_barrier
    v_cvt_pk_bf16_f32 v4, v212, v213
    v_cvt_pk_bf16_f32 v5, v214, v215
    v_mfma_f32_16x16x32_bf16 v[216:219], a[4:7], a[248:251], 0
    v_cvt_pk_bf16_f32 v26, v204, v205
    v_cvt_pk_bf16_f32 v27, v206, v207
    v_mfma_f32_16x16x32_bf16 v[212:215], a[8:11], a[248:251], 0
    v_cvt_pk_bf16_f32 v28, v200, v201
    v_cvt_pk_bf16_f32 v29, v202, v203
    v_mfma_f32_16x16x32_bf16 v[220:223], a[12:15], a[252:255], v[220:223]
    ds_read_b128 a[220:223], v224 offset:15616
    ds_read_b128 a[244:247], v224 offset:18688
    v_mfma_f32_16x16x32_bf16 v[216:219], a[16:19], a[252:255], v[216:219]
    ds_read_b128 a[248:251], v224 offset:18752
    v_cndmask_b32 v166, v168, v166, s[52:53]
    v_mfma_f32_16x16x32_bf16 v[212:215], a[20:23], a[252:255], v[212:215]
    ds_read_b128 a[252:255], v224 offset:18816
    v_cndmask_b32 v167, v168, v167, s[54:55]
    v_mfma_f32_16x16x32_bf16 v[208:211], a[0:3], a[236:239], 0
    buffer_load_dwordx4 v253, s[8:11], s57 offen lds
    v_mfma_f32_16x16x32_bf16 v[204:207], a[4:7], a[236:239], 0
    s_add_u32 s57, s49, 0x12300
    ds_write_b128 v123, v[164:167] offset:3200
    v_mfma_f32_16x16x32_bf16 v[200:203], a[8:11], a[236:239], 0
    s_add_u32 m0, s50, 0x6000
    ds_write_b128 v124, v[168:171]
    v_mfma_f32_16x16x32_bf16 v[208:211], a[12:15], a[240:243], v[208:211]
    s_waitcnt lgkmcnt(5)
    buffer_load_dwordx4 v251, s[8:11], s57 offen lds
    v_mfma_f32_16x16x32_bf16 v[220:223], a[24:27], a[220:223], v[220:223]
    s_add_u32 m0, s50, 0x6400
    v_mfma_f32_16x16x32_bf16 v[216:219], a[28:31], a[220:223], v[216:219]
    buffer_load_dwordx4 v252, s[8:11], s57 offen lds
    v_mfma_f32_16x16x32_bf16 v[212:215], a[32:35], a[220:223], v[212:215]
    s_add_u32 m0, s50, 0x6800
    v_mfma_f32_16x16x32_bf16 v[220:223], a[36:39], a[224:227], v[220:223]
    v_mfma_f32_16x16x32_bf16 v[216:219], a[40:43], a[224:227], v[216:219]
    ds_read_b128 a[220:223], v224 offset:18880
    ds_read_b128 a[236:239], v227 offset:6336
    v_mfma_f32_16x16x32_bf16 v[212:215], a[44:47], a[224:227], v[212:215]
    s_waitcnt vmcnt(8)
    ds_read_b128 a[224:227], v227 offset:6144
    v_mfma_f32_16x16x32_bf16 v[220:223], a[48:51], a[228:231], v[220:223]
    s_barrier
    buffer_load_dwordx4 v253, s[8:11], s57 offen lds
    v_mfma_f32_16x16x32_bf16 v[216:219], a[52:55], a[228:231], v[216:219]
    s_add_u32 s57, s49, 0x1b300
    ds_read_b128 v[144:147], v235
    v_bfe_u32 v235, s62, v232, 4
    v_mfma_f32_16x16x32_bf16 v[212:215], a[56:59], a[228:231], v[212:215]
    s_add_u32 m0, s50, 0x9000
    ds_read_b128 a[228:231], v227 offset:6208
    v_mfma_f32_16x16x32_bf16 v[220:223], a[60:63], a[232:235], v[220:223]
    buffer_load_dwordx4 v251, s[8:11], s57 offen lds
    v_mfma_f32_16x16x32_bf16 v[216:219], a[64:67], a[232:235], v[216:219]
    s_add_u32 m0, s50, 0x9400
    ds_read_b128 v[148:151], v234
    v_mad_u32_u24 v234, v250, s40, v229
    v_mfma_f32_16x16x32_bf16 v[212:215], a[68:71], a[232:235], v[212:215]
    ds_read_b128 a[232:235], v227 offset:6272
    v_mad_u32_u24 v250, v250, s40, v228
    v_mfma_f32_16x16x32_bf16 v[204:207], a[16:19], a[240:243], v[204:207]
    v_cvt_pk_bf16_f32 v6, v220, v221
    v_cvt_pk_bf16_f32 v7, v222, v223
    v_mfma_f32_16x16x32_bf16 v[200:203], a[20:23], a[240:243], v[200:203]
    s_waitcnt lgkmcnt(7)
    v_cvt_pk_bf16_f32 v8, v216, v217
    v_cvt_pk_bf16_f32 v9, v218, v219
    v_mfma_f32_16x16x32_bf16 v[208:211], a[24:27], a[244:247], v[208:211]
    v_cvt_pk_bf16_f32 v10, v212, v213
    v_cvt_pk_bf16_f32 v11, v214, v215
    v_mfma_f32_16x16x32_bf16 v[204:207], a[28:31], a[244:247], v[204:207]
    ds_read_b128 a[240:243], v227 offset:6400
    ds_read_b128 v[152:155], v234
    v_mfma_f32_16x16x32_bf16 v[200:203], a[32:35], a[244:247], v[200:203]
    buffer_load_dwordx4 v252, s[8:11], s57 offen lds
    v_mfma_f32_16x16x32_bf16 v[208:211], a[36:39], a[248:251], v[208:211]
    s_add_u32 m0, s50, 0x9800
    ds_read_b128 a[244:247], v227 offset:6464
    v_bfe_u32 v234, s60, v232, 4
    v_mfma_f32_16x16x32_bf16 v[204:207], a[40:43], a[248:251], v[204:207]
    s_waitcnt vmcnt(8)
    ds_read_b64_tr_b16 a[72:73], v254
    ds_read_b64_tr_b16 a[74:75], v255
    v_mfma_f32_16x16x32_bf16 v[200:203], a[44:47], a[248:251], v[200:203]
    ds_read_b128 a[248:251], v224 offset:30976
    v_mad_u32_u24 v234, v234, s40, v230
    v_mfma_f32_16x16x32_bf16 v[208:211], a[48:51], a[252:255], v[208:211]
    buffer_load_dwordx4 v253, s[8:11], s57 offen lds
    v_mfma_f32_16x16x32_bf16 v[204:207], a[52:55], a[252:255], v[204:207]
    s_add_u32 s57, s49, 0x24300
    ds_read_b64_tr_b16 a[76:77], v254 offset:32
    ds_read_b64_tr_b16 a[78:79], v255 offset:32
    v_mfma_f32_16x16x32_bf16 v[200:203], a[56:59], a[252:255], v[200:203]
    s_add_u32 m0, s50, 0xc000
    ds_read_b128 a[252:255], v224 offset:31040
    ds_read_b64_tr_b16 a[80:81], v254 offset:64
    s_waitcnt lgkmcnt(10)
    v_mfma_f32_16x16x32_bf16 v[208:211], a[60:63], a[220:223], v[208:211]
    ds_read_b64_tr_b16 a[82:83], v255 offset:64
    ds_read_b128 v[156:159], v250
    v_mfma_f32_16x16x32_bf16 v[204:207], a[64:67], a[220:223], v[204:207]
    v_mad_u32_u24 v250, v235, s40, v229
    v_mad_u32_u24 v235, v235, s40, v228
    v_mfma_f32_16x16x32_bf16 v[200:203], a[68:71], a[220:223], v[200:203]
    ds_read_b128 a[220:223], v224 offset:31104
    v_mfma_f32_16x16x32_bf16 v[220:223], a[0:3], a[224:227], 0
    v_cvt_pk_bf16_f32 v30, v208, v209
    v_cvt_pk_bf16_f32 v31, v210, v211
    v_mfma_f32_16x16x32_bf16 v[216:219], a[4:7], a[224:227], 0
    v_cvt_pk_bf16_f32 v32, v204, v205
    v_cvt_pk_bf16_f32 v33, v206, v207
    v_mfma_f32_16x16x32_bf16 v[212:215], a[8:11], a[224:227], 0
    v_cvt_pk_bf16_f32 v34, v200, v201
    v_cvt_pk_bf16_f32 v35, v202, v203
    v_mfma_f32_16x16x32_bf16 v[220:223], a[12:15], a[228:231], v[220:223]
    ds_read_b128 a[224:227], v224 offset:31168
    ds_read_b128 v[160:163], v228 offset:1920
    v_mfma_f32_16x16x32_bf16 v[216:219], a[16:19], a[228:231], v[216:219]
    buffer_load_dwordx4 v251, s[8:11], s57 offen lds
    v_mfma_f32_16x16x32_bf16 v[212:215], a[20:23], a[228:231], v[212:215]
    s_add_u32 m0, s50, 0xc400
    ds_read_b128 a[228:231], v224 offset:31232
    v_mfma_f32_16x16x32_bf16 v[220:223], a[24:27], a[232:235], v[220:223]
    s_waitcnt vmcnt(7)
    buffer_load_dwordx4 v252, s[8:11], s57 offen lds
    v_mfma_f32_16x16x32_bf16 v[216:219], a[28:31], a[232:235], v[216:219]
    s_add_u32 m0, s50, 0xc800
    ds_read_b64_tr_b16 a[84:85], v254 offset:12288
    ds_read_b64_tr_b16 a[86:87], v255 offset:12288
    v_mfma_f32_16x16x32_bf16 v[212:215], a[32:35], a[232:235], v[212:215]
    ds_read_b128 a[232:235], v224 offset:31296
    ds_read_b64_tr_b16 a[88:89], v254 offset:12320
    v_mfma_f32_16x16x32_bf16 v[220:223], a[36:39], a[236:239], v[220:223]
    ds_read_b64_tr_b16 a[90:91], v255 offset:12320
    ds_read_b64_tr_b16 a[92:93], v254 offset:12352
    v_mfma_f32_16x16x32_bf16 v[216:219], a[40:43], a[236:239], v[216:219]
    ds_read_b64_tr_b16 a[94:95], v255 offset:12352
    ds_read_b128 v[164:167], v229 offset:1920
    v_mfma_f32_16x16x32_bf16 v[212:215], a[44:47], a[236:239], v[212:215]
    s_waitcnt lgkmcnt(11)
    buffer_load_dwordx4 v253, s[8:11], s57 offen lds
    v_mfma_f32_16x16x32_bf16 v[220:223], a[48:51], a[240:243], v[220:223]
    s_add_u32 s57, s49, 0x2d300
    ds_read_b128 a[236:239], v224 offset:34048
    s_add_u32 m0, s50, 0xf000
    v_mfma_f32_16x16x32_bf16 v[216:219], a[52:55], a[240:243], v[216:219]
    ds_read_b128 v[168:171], v250
    v_bfe_u32 v250, s62, v232, 4
    v_mfma_f32_16x16x32_bf16 v[212:215], a[56:59], a[240:243], v[212:215]
    ds_read_b128 a[240:243], v224 offset:34112
    v_mad_u32_u24 v250, v250, s40, v230
    v_mfma_f32_16x16x32_bf16 v[220:223], a[60:63], a[244:247], v[220:223]
    ds_read_b128 v[172:175], v235
    v_bfe_u32 v235, s61, v232, 4
    v_mfma_f32_16x16x32_bf16 v[216:219], a[64:67], a[244:247], v[216:219]
    buffer_load_dwordx4 v251, s[8:11], s57 offen lds
    v_mfma_f32_16x16x32_bf16 v[212:215], a[68:71], a[244:247], v[212:215]
    s_add_u32 m0, s50, 0xf400
    ds_read_b128 a[244:247], v224 offset:34176
    v_mad_u32_u24 v235, v235, s40, v230
    v_mfma_f32_16x16x32_bf16 v[208:211], a[0:3], a[248:251], 0
    v_cvt_pk_bf16_f32 v48, v220, v221
    v_cvt_pk_bf16_f32 v49, v222, v223
    v_mfma_f32_16x16x32_bf16 v[204:207], a[4:7], a[248:251], 0
    v_cvt_pk_bf16_f32 v50, v216, v217
    v_cvt_pk_bf16_f32 v51, v218, v219
    v_mfma_f32_16x16x32_bf16 v[200:203], a[8:11], a[248:251], 0
    v_cvt_pk_bf16_f32 v52, v212, v213
    v_cvt_pk_bf16_f32 v53, v214, v215
    v_mfma_f32_16x16x32_bf16 v[208:211], a[12:15], a[252:255], v[208:211]
    s_waitcnt vmcnt(7)
    ds_read_b128 a[248:251], v224 offset:34240
    ds_read_b64_tr_b16 a[96:97], v254 offset:24576
    v_mfma_f32_16x16x32_bf16 v[204:207], a[16:19], a[252:255], v[204:207]
    buffer_load_dwordx4 v252, s[8:11], s57 offen lds
    v_mfma_f32_16x16x32_bf16 v[200:203], a[20:23], a[252:255], v[200:203]
    s_add_u32 m0, s50, 0xf800
    ds_read_b128 a[252:255], v224 offset:34304
    ds_read_b64_tr_b16 a[98:99], v255 offset:24576
    v_mfma_f32_16x16x32_bf16 v[208:211], a[24:27], a[220:223], v[208:211]
    ds_read_b64_tr_b16 a[100:101], v254 offset:24608
    ds_read_b64_tr_b16 a[102:103], v255 offset:24608
    v_mfma_f32_16x16x32_bf16 v[204:207], a[28:31], a[220:223], v[204:207]
    ds_read_b64_tr_b16 a[104:105], v254 offset:24640
    ds_read_b64_tr_b16 a[106:107], v255 offset:24640
    v_mfma_f32_16x16x32_bf16 v[200:203], a[32:35], a[220:223], v[200:203]
    s_waitcnt lgkmcnt(9)
    ds_read_b128 a[220:223], v224 offset:34368
    v_mfma_f32_16x16x32_bf16 v[208:211], a[36:39], a[224:227], v[208:211]
    s_waitcnt vmcnt(5)
    buffer_load_dwordx4 v253, s[8:11], s57 offen lds
    v_mfma_f32_16x16x32_bf16 v[204:207], a[40:43], a[224:227], v[204:207]
    s_add_u32 s57, s49, 0
    ds_read_b64_tr_b16 a[108:109], v254 offset:36864
    ds_read_b64_tr_b16 a[110:111], v255 offset:36864
    v_mfma_f32_16x16x32_bf16 v[200:203], a[44:47], a[224:227], v[200:203]
    s_add_u32 m0, s50, 0
    ds_read_b128 a[224:227], v224 offset:46464
    ds_read_b64_tr_b16 a[112:113], v254 offset:36896
    v_mfma_f32_16x16x32_bf16 v[208:211], a[48:51], a[228:231], v[208:211]
    ds_read_b64_tr_b16 a[114:115], v255 offset:36896
    ds_read_b64_tr_b16 a[116:117], v254 offset:36928
    v_mfma_f32_16x16x32_bf16 v[204:207], a[52:55], a[228:231], v[204:207]
    ds_read_b64_tr_b16 a[118:119], v255 offset:36928
    v_mfma_f32_16x16x32_bf16 v[200:203], a[56:59], a[228:231], v[200:203]
    ds_read_b128 a[228:231], v224 offset:46528
    v_mfma_f32_16x16x32_bf16 v[208:211], a[60:63], a[232:235], v[208:211]
    buffer_load_dwordx4 v251, s[8:11], s57 offen lds
    v_mfma_f32_16x16x32_bf16 v[204:207], a[64:67], a[232:235], v[204:207]
    s_add_u32 m0, s50, 0x400
    v_mfma_f32_16x16x32_bf16 v[200:203], a[68:71], a[232:235], v[200:203]
    ds_read_b128 a[232:235], v224 offset:46592
    v_mfma_f32_16x16x32_bf16 v[220:223], a[0:3], a[236:239], 0
    v_mfma_f32_16x16x32_bf16 v[216:219], a[4:7], a[236:239], 0
    v_mfma_f32_16x16x32_bf16 v[212:215], a[8:11], a[236:239], 0
    v_cvt_pk_bf16_f32 v12, v208, v209
    v_cvt_pk_bf16_f32 v13, v210, v211
    v_mfma_f32_16x16x32_bf16 v[220:223], a[12:15], a[240:243], v[220:223]
    v_cvt_pk_bf16_f32 v14, v204, v205
    v_cvt_pk_bf16_f32 v15, v206, v207
    v_mfma_f32_16x16x32_bf16 v[216:219], a[16:19], a[240:243], v[216:219]
    v_cvt_pk_bf16_f32 v16, v200, v201
    v_cvt_pk_bf16_f32 v17, v202, v203
    v_mfma_f32_16x16x32_bf16 v[212:215], a[20:23], a[240:243], v[212:215]
    s_waitcnt lgkmcnt(2)
    ds_read_b128 a[236:239], v224 offset:46656
    ds_read_b128 a[240:243], v224 offset:46720
    v_mfma_f32_16x16x32_bf16 v[220:223], a[24:27], a[244:247], v[220:223]
    buffer_load_dwordx4 v252, s[8:11], s57 offen lds
    v_mfma_f32_16x16x32_bf16 v[216:219], a[28:31], a[244:247], v[216:219]
    s_add_u32 m0, s50, 0x800
    v_mfma_f32_16x16x32_bf16 v[212:215], a[32:35], a[244:247], v[212:215]
    s_waitcnt vmcnt(5)
    ds_read_b128 a[244:247], v224 offset:46784
    ds_read_b64_tr_b16 a[120:121], v254 offset:49152
    v_mfma_f32_16x16x32_bf16 v[220:223], a[36:39], a[248:251], v[220:223]
    buffer_load_dwordx4 v253, s[8:11], s57 offen lds
    v_mfma_f32_16x16x32_bf16 v[216:219], a[40:43], a[248:251], v[216:219]
    s_add_u32 s57, s49, 0x9000
    ds_read_b64_tr_b16 a[122:123], v255 offset:49152
    ds_read_b64_tr_b16 a[124:125], v254 offset:49184
    v_mfma_f32_16x16x32_bf16 v[212:215], a[44:47], a[248:251], v[212:215]
    s_add_u32 m0, s50, 0x3000
    ds_read_b128 a[248:251], v224 offset:49536
    ds_read_b64_tr_b16 a[126:127], v255 offset:49184
    v_mfma_f32_16x16x32_bf16 v[220:223], a[48:51], a[252:255], v[220:223]
    ds_read_b64_tr_b16 a[128:129], v254 offset:49216
    ds_read_b64_tr_b16 a[130:131], v255 offset:49216
    v_mfma_f32_16x16x32_bf16 v[216:219], a[52:55], a[252:255], v[216:219]
    buffer_load_dwordx4 v251, s[8:11], s57 offen lds
    v_mfma_f32_16x16x32_bf16 v[212:215], a[56:59], a[252:255], v[212:215]
    s_add_u32 m0, s50, 0x3400
    ds_read_b128 a[252:255], v224 offset:49600
    v_mfma_f32_16x16x32_bf16 v[220:223], a[60:63], a[220:223], v[220:223]
    v_mfma_f32_16x16x32_bf16 v[216:219], a[64:67], a[220:223], v[216:219]
    v_mfma_f32_16x16x32_bf16 v[212:215], a[68:71], a[220:223], v[212:215]
    ds_read_b128 a[220:223], v224 offset:49664
    v_mfma_f32_16x16x32_bf16 v[208:211], a[0:3], a[224:227], 0
    v_mfma_f32_16x16x32_bf16 v[204:207], a[4:7], a[224:227], 0
    s_waitcnt lgkmcnt(7)
    buffer_load_dwordx4 v252, s[8:11], s57 offen lds
    v_mfma_f32_16x16x32_bf16 v[200:203], a[8:11], a[224:227], 0
    s_add_u32 m0, s50, 0x3800
    v_cvt_pk_bf16_f32 v36, v220, v221
    v_cvt_pk_bf16_f32 v37, v222, v223
    v_mfma_f32_16x16x32_bf16 v[208:211], a[12:15], a[228:231], v[208:211]
    v_cvt_pk_bf16_f32 v38, v216, v217
    v_cvt_pk_bf16_f32 v39, v218, v219
    v_mfma_f32_16x16x32_bf16 v[204:207], a[16:19], a[228:231], v[204:207]
    v_cvt_pk_bf16_f32 v40, v212, v213
    v_cvt_pk_bf16_f32 v41, v214, v215
    v_mfma_f32_16x16x32_bf16 v[200:203], a[20:23], a[228:231], v[200:203]
    ds_read_b128 a[224:227], v224 offset:49728
    ds_read_b128 a[228:231], v224 offset:49792
    v_mfma_f32_16x16x32_bf16 v[208:211], a[24:27], a[232:235], v[208:211]
    s_waitcnt vmcnt(5)
    buffer_load_dwordx4 v253, s[8:11], s57 offen lds
    v_mfma_f32_16x16x32_bf16 v[204:207], a[28:31], a[232:235], v[204:207]
    s_add_u32 s57, s49, 0x12000
    ds_read_b64_tr_b16 a[132:133], v254 offset:61440
    ds_read_b64_tr_b16 a[134:135], v255 offset:61440
    v_mfma_f32_16x16x32_bf16 v[200:203], a[32:35], a[232:235], v[200:203]
    s_add_u32 m0, s50, 0x6000
    ds_read_b128 a[232:235], v224 offset:49856
    ds_read_b64_tr_b16 a[136:137], v254 offset:61472
    v_mfma_f32_16x16x32_bf16 v[208:211], a[36:39], a[236:239], v[208:211]
    ds_read_b64_tr_b16 a[138:139], v255 offset:61472
    ds_read_b64_tr_b16 a[140:141], v254 offset:61504
    v_mfma_f32_16x16x32_bf16 v[204:207], a[40:43], a[236:239], v[204:207]
    ds_read_b64_tr_b16 a[142:143], v255 offset:61504
    v_mfma_f32_16x16x32_bf16 v[200:203], a[44:47], a[236:239], v[200:203]
    ds_read_b128 a[236:239], v227 offset:37120
    v_mfma_f32_16x16x32_bf16 v[208:211], a[48:51], a[240:243], v[208:211]
    buffer_load_dwordx4 v251, s[8:11], s57 offen lds
    v_mfma_f32_16x16x32_bf16 v[204:207], a[52:55], a[240:243], v[204:207]
    s_add_u32 m0, s50, 0x6400
    v_mfma_f32_16x16x32_bf16 v[200:203], a[56:59], a[240:243], v[200:203]
    ds_read_b128 a[240:243], v227 offset:37184
    v_mfma_f32_16x16x32_bf16 v[208:211], a[60:63], a[244:247], v[208:211]
    v_mfma_f32_16x16x32_bf16 v[204:207], a[64:67], a[244:247], v[204:207]
    v_mfma_f32_16x16x32_bf16 v[200:203], a[68:71], a[244:247], v[200:203]
    s_waitcnt lgkmcnt(7)
    ds_read_b128 a[244:247], v227 offset:37248
    v_mfma_f32_16x16x32_bf16 v[220:223], a[0:3], a[248:251], 0
    buffer_load_dwordx4 v252, s[8:11], s57 offen lds
    v_mfma_f32_16x16x32_bf16 v[216:219], a[4:7], a[248:251], 0
    s_add_u32 m0, s50, 0x6800
    v_mfma_f32_16x16x32_bf16 v[212:215], a[8:11], a[248:251], 0
    v_cvt_pk_bf16_f32 v18, v208, v209
    v_cvt_pk_bf16_f32 v19, v210, v211
    v_mfma_f32_16x16x32_bf16 v[220:223], a[12:15], a[252:255], v[220:223]
    v_cvt_pk_bf16_f32 v20, v204, v205
    v_cvt_pk_bf16_f32 v21, v206, v207
    v_mfma_f32_16x16x32_bf16 v[216:219], a[16:19], a[252:255], v[216:219]
    v_cvt_pk_bf16_f32 v22, v200, v201
    v_cvt_pk_bf16_f32 v23, v202, v203
    v_mfma_f32_16x16x32_bf16 v[212:215], a[20:23], a[252:255], v[212:215]
    ds_read_b128 a[248:251], v227 offset:37312
    ds_read_b128 a[252:255], v227 offset:37376
    v_mfma_f32_16x16x32_bf16 v[220:223], a[24:27], a[220:223], v[220:223]
    s_waitcnt vmcnt(5)
    buffer_load_dwordx4 v253, s[8:11], s57 offen lds
    v_mfma_f32_16x16x32_bf16 v[216:219], a[28:31], a[220:223], v[216:219]
    s_add_u32 s57, s49, 0x1b000
    ds_read_b64_tr_b16 a[144:145], v254
    ds_read_b64_tr_b16 a[146:147], v255
    v_mfma_f32_16x16x32_bf16 v[212:215], a[32:35], a[220:223], v[212:215]
    s_add_u32 m0, s50, 0x9000
    ds_read_b128 a[220:223], v227 offset:37440
    ds_read_b64_tr_b16 a[148:149], v254 offset:32
    v_mfma_f32_16x16x32_bf16 v[220:223], a[36:39], a[224:227], v[220:223]
    ds_read_b64_tr_b16 a[150:151], v255 offset:32
    ds_read_b64_tr_b16 a[152:153], v254 offset:64
    v_mfma_f32_16x16x32_bf16 v[216:219], a[40:43], a[224:227], v[216:219]
    buffer_load_dwordx4 v251, s[8:11], s57 offen lds
    v_mfma_f32_16x16x32_bf16 v[212:215], a[44:47], a[224:227], v[212:215]
    s_add_u32 m0, s50, 0x9400
    ds_read_b128 a[224:227], v224
    ds_read_b64_tr_b16 a[154:155], v255 offset:64
    v_mfma_f32_16x16x32_bf16 v[220:223], a[48:51], a[228:231], v[220:223]
    v_mfma_f32_16x16x32_bf16 v[216:219], a[52:55], a[228:231], v[216:219]
    v_mfma_f32_16x16x32_bf16 v[212:215], a[56:59], a[228:231], v[212:215]
    s_waitcnt lgkmcnt(10)
    ds_read_b128 a[228:231], v224 offset:64
    v_mfma_f32_16x16x32_bf16 v[220:223], a[60:63], a[232:235], v[220:223]
    v_mfma_f32_16x16x32_bf16 v[216:219], a[64:67], a[232:235], v[216:219]
    buffer_load_dwordx4 v252, s[8:11], s57 offen lds
    v_mfma_f32_16x16x32_bf16 v[212:215], a[68:71], a[232:235], v[212:215]
    s_add_u32 m0, s50, 0x9800
    ds_read_b128 a[232:235], v224 offset:128
    v_mfma_f32_16x16x32_bf16 v[208:211], a[0:3], a[236:239], 0
    v_mfma_f32_16x16x32_bf16 v[204:207], a[4:7], a[236:239], 0
    v_mfma_f32_16x16x32_bf16 v[200:203], a[8:11], a[236:239], 0
    v_cvt_pk_bf16_f32 v42, v220, v221
    v_cvt_pk_bf16_f32 v43, v222, v223
    v_mfma_f32_16x16x32_bf16 v[208:211], a[12:15], a[240:243], v[208:211]
    v_cvt_pk_bf16_f32 v44, v216, v217
    v_cvt_pk_bf16_f32 v45, v218, v219
    v_mfma_f32_16x16x32_bf16 v[204:207], a[16:19], a[240:243], v[204:207]
    v_cvt_pk_bf16_f32 v46, v212, v213
    v_cvt_pk_bf16_f32 v47, v214, v215
    v_mfma_f32_16x16x32_bf16 v[200:203], a[20:23], a[240:243], v[200:203]
    ds_read_b128 a[236:239], v224 offset:192
    ds_read_b128 a[240:243], v224 offset:256
    v_mfma_f32_16x16x32_bf16 v[208:211], a[24:27], a[244:247], v[208:211]
    s_waitcnt vmcnt(5)
    buffer_load_dwordx4 v253, s[8:11], s57 offen lds
    v_mfma_f32_16x16x32_bf16 v[204:207], a[28:31], a[244:247], v[204:207]
    s_add_u32 s57, s49, 0x24000
    ds_read_b64_tr_b16 a[156:157], v254 offset:12288
    ds_read_b64_tr_b16 a[158:159], v255 offset:12288
    v_mfma_f32_16x16x32_bf16 v[200:203], a[32:35], a[244:247], v[200:203]
    s_add_u32 m0, s50, 0xc000
    ds_read_b128 a[244:247], v224 offset:320
    ds_read_b64_tr_b16 a[160:161], v254 offset:12320
    s_waitcnt lgkmcnt(6)
    v_mfma_f32_16x16x32_bf16 v[208:211], a[36:39], a[248:251], v[208:211]
    buffer_load_dwordx4 v251, s[8:11], s57 offen lds
    v_mfma_f32_16x16x32_bf16 v[204:207], a[40:43], a[248:251], v[204:207]
    s_add_u32 m0, s50, 0xc400
    ds_read_b64_tr_b16 a[162:163], v255 offset:12320
    ds_read_b64_tr_b16 a[164:165], v254 offset:12352
    v_mfma_f32_16x16x32_bf16 v[200:203], a[44:47], a[248:251], v[200:203]
    ds_read_b128 a[248:251], v224 offset:3072
    ds_read_b64_tr_b16 a[166:167], v255 offset:12352
    v_mfma_f32_16x16x32_bf16 v[208:211], a[48:51], a[252:255], v[208:211]
    v_mfma_f32_16x16x32_bf16 v[204:207], a[52:55], a[252:255], v[204:207]
    v_mfma_f32_16x16x32_bf16 v[200:203], a[56:59], a[252:255], v[200:203]
    ds_read_b128 a[252:255], v224 offset:3136
    v_mfma_f32_16x16x32_bf16 v[208:211], a[60:63], a[220:223], v[208:211]
    buffer_load_dwordx4 v252, s[8:11], s57 offen lds
    v_mfma_f32_16x16x32_bf16 v[204:207], a[64:67], a[220:223], v[204:207]
    s_add_u32 m0, s50, 0xc800
    v_mfma_f32_16x16x32_bf16 v[200:203], a[68:71], a[220:223], v[200:203]
    ds_read_b128 a[220:223], v224 offset:3200
    v_mfma_f32_16x16x32_bf16 v[220:223], a[224:227], a[72:75], 0
    v_mfma_f32_16x16x32_bf16 v[216:219], a[224:227], a[76:79], 0
    v_mfma_f32_16x16x32_bf16 v[212:215], a[224:227], a[80:83], 0
    v_cvt_pk_bf16_f32 v54, v208, v209
    v_cvt_pk_bf16_f32 v55, v210, v211
    v_mfma_f32_16x16x32_bf16 v[220:223], a[228:231], a[84:87], v[220:223]
    v_cvt_pk_bf16_f32 v56, v204, v205
    v_cvt_pk_bf16_f32 v57, v206, v207
    v_mfma_f32_16x16x32_bf16 v[216:219], a[228:231], a[88:91], v[216:219]
    v_cvt_pk_bf16_f32 v58, v200, v201
    v_cvt_pk_bf16_f32 v59, v202, v203
    v_mfma_f32_16x16x32_bf16 v[212:215], a[228:231], a[92:95], v[212:215]
    ds_read_b128 a[224:227], v224 offset:3264
    ds_read_b128 a[228:231], v224 offset:3328
    v_mfma_f32_16x16x32_bf16 v[220:223], a[232:235], a[96:99], v[220:223]
    s_waitcnt vmcnt(5)
    buffer_load_dwordx4 v253, s[8:11], s57 offen lds
    v_mfma_f32_16x16x32_bf16 v[216:219], a[232:235], a[100:103], v[216:219]
    s_add_u32 s57, s49, 0x2d000
    ds_read_b64_tr_b16 a[168:169], v254 offset:24576
    ds_read_b64_tr_b16 a[170:171], v255 offset:24576
    v_mfma_f32_16x16x32_bf16 v[212:215], a[232:235], a[104:107], v[212:215]
    s_add_u32 m0, s50, 0xf000
    ds_read_b128 a[232:235], v224 offset:3392
    ds_read_b64_tr_b16 a[172:173], v254 offset:24608
    s_waitcnt lgkmcnt(6)
    v_mfma_f32_16x16x32_bf16 v[220:223], a[236:239], a[108:111], v[220:223]
    buffer_load_dwordx4 v251, s[8:11], s57 offen lds
    v_mfma_f32_16x16x32_bf16 v[216:219], a[236:239], a[112:115], v[216:219]
    s_add_u32 m0, s50, 0xf400
    ds_read_b64_tr_b16 a[174:175], v255 offset:24608
    ds_read_b64_tr_b16 a[176:177], v254 offset:24640
    v_mfma_f32_16x16x32_bf16 v[212:215], a[236:239], a[116:119], v[212:215]
    ds_read_b128 a[236:239], v224 offset:15488
    ds_read_b64_tr_b16 a[178:179], v255 offset:24640
    v_mfma_f32_16x16x32_bf16 v[220:223], a[240:243], a[120:123], v[220:223]
    v_mfma_f32_16x16x32_bf16 v[216:219], a[240:243], a[124:127], v[216:219]
    buffer_load_dwordx4 v252, s[8:11], s57 offen lds
    v_mfma_f32_16x16x32_bf16 v[212:215], a[240:243], a[128:131], v[212:215]
    s_add_u32 m0, s50, 0xf800
    ds_read_b128 a[240:243], v224 offset:15552
    v_mfma_f32_16x16x32_bf16 v[220:223], a[244:247], a[132:135], v[220:223]
    v_mfma_f32_16x16x32_bf16 v[216:219], a[244:247], a[136:139], v[216:219]
    v_mfma_f32_16x16x32_bf16 v[212:215], a[244:247], a[140:143], v[212:215]
    ds_read_b128 a[244:247], v224 offset:15616
    v_mfma_f32_16x16x32_bf16 v[208:211], a[248:251], a[72:75], 0
    buffer_load_dwordx4 v253, s[8:11], s57 offen lds
    v_mfma_f32_16x16x32_bf16 v[204:207], a[248:251], a[76:79], 0
    s_add_u32 s57, s49, 0
    s_add_u32 m0, s50, 0
    v_cvt_pk_bf16_f32 v66, v220, v221
    v_mfma_f32_16x16x32_bf16 v[200:203], a[248:251], a[80:83], 0
    v_cvt_pk_bf16_f32 v67, v222, v223
    v_cvt_pk_bf16_f32 v88, v216, v217
    v_mfma_f32_16x16x32_bf16 v[208:211], a[252:255], a[84:87], v[208:211]
    v_cvt_pk_bf16_f32 v89, v218, v219
    v_cvt_pk_bf16_f32 v110, v212, v213
    v_mfma_f32_16x16x32_bf16 v[204:207], a[252:255], a[88:91], v[204:207]
    ds_read_b128 a[248:251], v224 offset:15680
    v_cvt_pk_bf16_f32 v111, v214, v215
    v_mfma_f32_16x16x32_bf16 v[200:203], a[252:255], a[92:95], v[200:203]
    s_waitcnt vmcnt(6)
    ds_read_b128 a[252:255], v224 offset:15744
    ds_read_b64_tr_b16 a[180:181], v254 offset:36864
    v_mfma_f32_16x16x32_bf16 v[208:211], a[220:223], a[96:99], v[208:211]
    buffer_load_dwordx4 v192, s[12:15], s57 offen lds
    v_mfma_f32_16x16x32_bf16 v[204:207], a[220:223], a[100:103], v[204:207]
    s_add_u32 m0, s50, 0x400
    ds_read_b64_tr_b16 a[182:183], v255 offset:36864
    ds_read_b64_tr_b16 a[184:185], v254 offset:36896
    v_mfma_f32_16x16x32_bf16 v[200:203], a[220:223], a[104:107], v[200:203]
    s_waitcnt lgkmcnt(6)
    ds_read_b128 a[220:223], v224 offset:15808
    ds_read_b64_tr_b16 a[186:187], v255 offset:36896
    v_mfma_f32_16x16x32_bf16 v[208:211], a[224:227], a[108:111], v[208:211]
    ds_read_b64_tr_b16 a[188:189], v254 offset:36928
    ds_read_b64_tr_b16 a[190:191], v255 offset:36928
    v_mfma_f32_16x16x32_bf16 v[204:207], a[224:227], a[112:115], v[204:207]
    v_mfma_f32_16x16x32_bf16 v[200:203], a[224:227], a[116:119], v[200:203]
    ds_read_b128 a[224:227], v224 offset:18560
    v_mfma_f32_16x16x32_bf16 v[208:211], a[228:231], a[120:123], v[208:211]
    buffer_load_dwordx4 v193, s[12:15], s57 offen lds
    v_mfma_f32_16x16x32_bf16 v[204:207], a[228:231], a[124:127], v[204:207]
    s_add_u32 m0, s50, 0x800
    v_mfma_f32_16x16x32_bf16 v[200:203], a[228:231], a[128:131], v[200:203]
    ds_read_b128 a[228:231], v224 offset:18624
    v_mfma_f32_16x16x32_bf16 v[208:211], a[232:235], a[132:135], v[208:211]
    v_mfma_f32_16x16x32_bf16 v[204:207], a[232:235], a[136:139], v[204:207]
    v_mfma_f32_16x16x32_bf16 v[200:203], a[232:235], a[140:143], v[200:203]
    ds_read_b128 a[232:235], v224 offset:18688
    v_mfma_f32_16x16x32_bf16 v[220:223], a[236:239], a[72:75], 0
    buffer_load_dwordx4 v194, s[12:15], s57 offen lds
    v_mfma_f32_16x16x32_bf16 v[216:219], a[236:239], a[76:79], 0
    s_add_u32 s57, s49, 0x3000
    s_add_u32 m0, s50, 0x3000
    v_cvt_pk_bf16_f32 v68, v208, v209
    v_mfma_f32_16x16x32_bf16 v[212:215], a[236:239], a[80:83], 0
    v_cvt_pk_bf16_f32 v69, v210, v211
    v_cvt_pk_bf16_f32 v90, v204, v205
    v_mfma_f32_16x16x32_bf16 v[220:223], a[240:243], a[84:87], v[220:223]
    v_cvt_pk_bf16_f32 v91, v206, v207
    v_cvt_pk_bf16_f32 v112, v200, v201
    v_mfma_f32_16x16x32_bf16 v[216:219], a[240:243], a[88:91], v[216:219]
    ds_read_b128 a[236:239], v224 offset:18752
    v_cvt_pk_bf16_f32 v113, v202, v203
    v_mfma_f32_16x16x32_bf16 v[212:215], a[240:243], a[92:95], v[212:215]
    s_waitcnt vmcnt(6) lgkmcnt(3)
    ds_read_b128 a[240:243], v224 offset:18816
    ds_read_b64_tr_b16 a[192:193], v254 offset:49152
    v_mfma_f32_16x16x32_bf16 v[220:223], a[244:247], a[96:99], v[220:223]
    buffer_load_dwordx4 v86, s[12:15], s57 offen lds
    v_mfma_f32_16x16x32_bf16 v[216:219], a[244:247], a[100:103], v[216:219]
    s_add_u32 m0, s50, 0x3400
    ds_read_b64_tr_b16 a[194:195], v255 offset:49152
    ds_read_b64_tr_b16 a[196:197], v254 offset:49184
    v_mfma_f32_16x16x32_bf16 v[212:215], a[244:247], a[104:107], v[212:215]
    ds_read_b128 a[244:247], v224 offset:18880
    ds_read_b64_tr_b16 a[198:199], v255 offset:49184
    v_mfma_f32_16x16x32_bf16 v[220:223], a[248:251], a[108:111], v[220:223]
    ds_read_b64_tr_b16 a[200:201], v254 offset:49216
    ds_read_b64_tr_b16 a[202:203], v255 offset:49216
    v_mfma_f32_16x16x32_bf16 v[216:219], a[248:251], a[112:115], v[216:219]
    buffer_load_dwordx4 v87, s[12:15], s57 offen lds
    v_mfma_f32_16x16x32_bf16 v[212:215], a[248:251], a[116:119], v[212:215]
    s_add_u32 m0, s50, 0x3800
    ds_read_b128 a[248:251], v227 offset:6144
    v_mfma_f32_16x16x32_bf16 v[220:223], a[252:255], a[120:123], v[220:223]
    v_mfma_f32_16x16x32_bf16 v[216:219], a[252:255], a[124:127], v[216:219]
    v_mfma_f32_16x16x32_bf16 v[212:215], a[252:255], a[128:131], v[212:215]
    s_waitcnt vmcnt(5)
    ds_read_b128 a[252:255], v227 offset:6208
    ds_read_b64_tr_b16 a[204:205], v254 offset:61440
    v_mfma_f32_16x16x32_bf16 v[220:223], a[220:223], a[132:135], v[220:223]
    buffer_load_dwordx4 v108, s[12:15], s57 offen lds
    v_mfma_f32_16x16x32_bf16 v[216:219], a[220:223], a[136:139], v[216:219]
    s_add_u32 s57, s49, 0x4800
    ds_read_b64_tr_b16 a[206:207], v255 offset:61440
    ds_read_b64_tr_b16 a[208:209], v254 offset:61472
    v_mfma_f32_16x16x32_bf16 v[212:215], a[220:223], a[140:143], v[212:215]
    s_add_u32 m0, s50, 0x6000
    ds_read_b128 a[220:223], v227 offset:6272
    v_cvt_pk_bf16_f32 v72, v220, v221
    v_mfma_f32_16x16x32_bf16 v[208:211], a[224:227], a[72:75], 0
    v_cvt_pk_bf16_f32 v73, v222, v223
    v_cvt_pk_bf16_f32 v94, v216, v217
    v_mfma_f32_16x16x32_bf16 v[204:207], a[224:227], a[76:79], 0
    ds_read_b64_tr_b16 a[210:211], v255 offset:61472
    v_cvt_pk_bf16_f32 v95, v218, v219
    v_mfma_f32_16x16x32_bf16 v[200:203], a[224:227], a[80:83], 0
    s_waitcnt lgkmcnt(7)
    v_cvt_pk_bf16_f32 v116, v212, v213
    v_cvt_pk_bf16_f32 v117, v214, v215
    v_mfma_f32_16x16x32_bf16 v[208:211], a[228:231], a[84:87], v[208:211]
    ds_read_b128 a[224:227], v227 offset:6336
    ds_read_b64_tr_b16 a[212:213], v254 offset:61504
    v_mfma_f32_16x16x32_bf16 v[204:207], a[228:231], a[88:91], v[204:207]
    buffer_load_dwordx4 v192, s[12:15], s57 offen lds
    v_mfma_f32_16x16x32_bf16 v[200:203], a[228:231], a[92:95], v[200:203]
    s_add_u32 m0, s50, 0x6400
    ds_read_b128 a[228:231], v227 offset:6400
    ds_read_b64_tr_b16 a[214:215], v255 offset:61504
    v_mfma_f32_16x16x32_bf16 v[208:211], a[232:235], a[96:99], v[208:211]
    v_mfma_f32_16x16x32_bf16 v[204:207], a[232:235], a[100:103], v[204:207]
    v_mfma_f32_16x16x32_bf16 v[200:203], a[232:235], a[104:107], v[200:203]
    ds_read_b128 a[232:235], v227 offset:6464
    v_mfma_f32_16x16x32_bf16 v[208:211], a[236:239], a[108:111], v[208:211]
    buffer_load_dwordx4 v193, s[12:15], s57 offen lds
    v_mfma_f32_16x16x32_bf16 v[204:207], a[236:239], a[112:115], v[204:207]
    s_add_u32 m0, s50, 0x6800
    v_mfma_f32_16x16x32_bf16 v[200:203], a[236:239], a[116:119], v[200:203]
    ds_read_b128 a[236:239], v225 offset:24384
    v_mfma_f32_16x16x32_bf16 v[208:211], a[240:243], a[120:123], v[208:211]
    v_mfma_f32_16x16x32_bf16 v[204:207], a[240:243], a[124:127], v[204:207]
    v_mfma_f32_16x16x32_bf16 v[200:203], a[240:243], a[128:131], v[200:203]
    ds_read_b128 a[240:243], v225 offset:24448
    v_mfma_f32_16x16x32_bf16 v[208:211], a[244:247], a[132:135], v[208:211]
    buffer_load_dwordx4 v194, s[12:15], s57 offen lds
    v_mfma_f32_16x16x32_bf16 v[204:207], a[244:247], a[136:139], v[204:207]
    s_add_u32 s57, s49, 0x9000
    s_add_u32 m0, s50, 0x9000
    v_mfma_f32_16x16x32_bf16 v[200:203], a[244:247], a[140:143], v[200:203]
    s_waitcnt lgkmcnt(3)
    ds_read_b128 a[244:247], v225 offset:24512
    v_mfma_f32_16x16x32_bf16 v[220:223], a[248:251], a[72:75], 0
    v_mfma_f32_16x16x32_bf16 v[216:219], a[248:251], a[76:79], 0
    v_cvt_pk_bf16_f32 v70, v208, v209
    v_cvt_pk_bf16_f32 v71, v210, v211
    v_mfma_f32_16x16x32_bf16 v[212:215], a[248:251], a[80:83], 0
    v_cvt_pk_bf16_f32 v92, v204, v205
    v_cvt_pk_bf16_f32 v93, v206, v207
    v_mfma_f32_16x16x32_bf16 v[220:223], a[252:255], a[84:87], v[220:223]
    v_cvt_pk_bf16_f32 v114, v200, v201
    v_cvt_pk_bf16_f32 v115, v202, v203
    v_mfma_f32_16x16x32_bf16 v[216:219], a[252:255], a[88:91], v[216:219]
    ds_read_b128 a[248:251], v225 offset:24576
    v_mfma_f32_16x16x32_bf16 v[212:215], a[252:255], a[92:95], v[212:215]
    ds_read_b128 a[252:255], v225 offset:24640
    v_mfma_f32_16x16x32_bf16 v[220:223], a[220:223], a[96:99], v[220:223]
    buffer_load_dwordx4 v192, s[12:15], s57 offen lds
    v_mfma_f32_16x16x32_bf16 v[216:219], a[220:223], a[100:103], v[216:219]
    s_add_u32 m0, s50, 0x9400
    v_mfma_f32_16x16x32_bf16 v[212:215], a[220:223], a[104:107], v[212:215]
    ds_read_b128 a[220:223], v225 offset:24704
    v_mfma_f32_16x16x32_bf16 v[220:223], a[224:227], a[108:111], v[220:223]
    buffer_load_dwordx4 v193, s[12:15], s57 offen lds
    v_mfma_f32_16x16x32_bf16 v[216:219], a[224:227], a[112:115], v[216:219]
    s_add_u32 m0, s50, 0x9800
    v_mfma_f32_16x16x32_bf16 v[212:215], a[224:227], a[116:119], v[212:215]
    ds_read_b128 a[224:227], v225 offset:27456
    v_mfma_f32_16x16x32_bf16 v[220:223], a[228:231], a[120:123], v[220:223]
    buffer_load_dwordx4 v194, s[12:15], s57 offen lds
    v_mfma_f32_16x16x32_bf16 v[216:219], a[228:231], a[124:127], v[216:219]
    s_add_u32 s57, s49, 0xc000
    s_add_u32 m0, s50, 0xc000
    v_mfma_f32_16x16x32_bf16 v[212:215], a[228:231], a[128:131], v[212:215]
    s_waitcnt lgkmcnt(3)
    ds_read_b128 a[228:231], v225 offset:27520
    v_mfma_f32_16x16x32_bf16 v[220:223], a[232:235], a[132:135], v[220:223]
    v_mfma_f32_16x16x32_bf16 v[216:219], a[232:235], a[136:139], v[216:219]
    v_mfma_f32_16x16x32_bf16 v[212:215], a[232:235], a[140:143], v[212:215]
    ds_read_b128 a[232:235], v225 offset:27584
    v_mfma_f32_16x16x32_bf16 v[208:211], a[144:147], a[236:239], 0
    buffer_load_dwordx4 v86, s[12:15], s57 offen lds
    v_mfma_f32_16x16x32_bf16 v[204:207], a[148:151], a[236:239], 0
    s_add_u32 m0, s50, 0xc400
    v_mfma_f32_16x16x32_bf16 v[200:203], a[152:155], a[236:239], 0
    v_cvt_pk_bf16_f32 v82, v220, v221
    v_cvt_pk_bf16_f32 v83, v222, v223
    v_mfma_f32_16x16x32_bf16 v[208:211], a[156:159], a[240:243], v[208:211]
    v_cvt_pk_bf16_f32 v104, v216, v217
    v_cvt_pk_bf16_f32 v105, v218, v219
    v_mfma_f32_16x16x32_bf16 v[204:207], a[160:163], a[240:243], v[204:207]
    v_cvt_pk_bf16_f32 v126, v212, v213
    v_cvt_pk_bf16_f32 v127, v214, v215
    v_mfma_f32_16x16x32_bf16 v[200:203], a[164:167], a[240:243], v[200:203]
    ds_read_b128 a[236:239], v225 offset:27648
    ds_read_b128 a[240:243], v225 offset:27712
    v_mfma_f32_16x16x32_bf16 v[208:211], a[168:171], a[244:247], v[208:211]
    buffer_load_dwordx4 v87, s[12:15], s57 offen lds
    v_mfma_f32_16x16x32_bf16 v[204:207], a[172:175], a[244:247], v[204:207]
    s_add_u32 m0, s50, 0xc800
    v_mfma_f32_16x16x32_bf16 v[200:203], a[176:179], a[244:247], v[200:203]
    ds_read_b128 a[244:247], v225 offset:27776
    v_mfma_f32_16x16x32_bf16 v[208:211], a[180:183], a[248:251], v[208:211]
    v_mfma_f32_16x16x32_bf16 v[204:207], a[184:187], a[248:251], v[204:207]
    v_mfma_f32_16x16x32_bf16 v[200:203], a[188:191], a[248:251], v[200:203]
    s_waitcnt lgkmcnt(3)
    ds_read_b128 a[248:251], v224 offset:30976
    v_mfma_f32_16x16x32_bf16 v[208:211], a[192:195], a[252:255], v[208:211]
    buffer_load_dwordx4 v108, s[12:15], s57 offen lds
    v_mfma_f32_16x16x32_bf16 v[204:207], a[196:199], a[252:255], v[204:207]
    s_add_u32 s57, s49, 0xd800
    s_add_u32 m0, s50, 0xf000
    v_mfma_f32_16x16x32_bf16 v[200:203], a[200:203], a[252:255], v[200:203]
    ds_read_b128 a[252:255], v224 offset:31040
    v_mfma_f32_16x16x32_bf16 v[208:211], a[204:207], a[220:223], v[208:211]
    v_mfma_f32_16x16x32_bf16 v[204:207], a[208:211], a[220:223], v[204:207]
    s_waitcnt lgkmcnt(2)
    buffer_load_dwordx4 v192, s[12:15], s57 offen lds
    v_mfma_f32_16x16x32_bf16 v[200:203], a[212:215], a[220:223], v[200:203]
    s_add_u32 m0, s50, 0xf400
    ds_read_b128 a[220:223], v224 offset:31104
    s_barrier
    v_mfma_f32_16x16x32_bf16 v[220:223], a[144:147], a[224:227], 0
    v_mfma_f32_16x16x32_bf16 v[216:219], a[148:151], a[224:227], 0
    v_cvt_pk_bf16_f32 v132, v208, v209
    v_cvt_pk_bf16_f32 v133, v210, v211
    v_mfma_f32_16x16x32_bf16 v[212:215], a[152:155], a[224:227], 0
    v_cvt_pk_bf16_f32 v134, v204, v205
    v_cvt_pk_bf16_f32 v135, v206, v207
    v_mfma_f32_16x16x32_bf16 v[220:223], a[156:159], a[228:231], v[220:223]
    v_cvt_pk_bf16_f32 v136, v200, v201
    v_cvt_pk_bf16_f32 v137, v202, v203
    v_mfma_f32_16x16x32_bf16 v[144:147], v[0:3], v[132:135], v[144:147]
    ds_read_b128 a[224:227], v224 offset:31168
    v_mfma_f32_16x16x32_bf16 v[148:151], v[24:27], v[132:135], v[148:151]
    buffer_load_dwordx4 v193, s[12:15], s57 offen lds
    v_mfma_f32_16x16x32_bf16 v[152:155], v[30:33], v[132:135], v[152:155]
    s_add_u32 m0, s50, 0xf800
    v_mfma_f32_16x16x32_bf16 v[156:159], v[6:9], v[132:135], v[156:159]
    v_mfma_f32_16x16x16_bf16 v[144:147], v[4:5], v[136:137], v[144:147]
    v_mfma_f32_16x16x32_bf16 v[160:163], v[12:15], v[132:135], v[160:163]
    buffer_load_dwordx4 v194, s[12:15], s57 offen lds
    v_mfma_f32_16x16x16_bf16 v[148:151], v[28:29], v[136:137], v[148:151]
    s_add_u32 m0, s41, 0
    v_mfma_f32_16x16x16_bf16 v[152:155], v[34:35], v[136:137], v[152:155]
    v_mfma_f32_16x16x16_bf16 v[156:159], v[10:11], v[136:137], v[156:159]
    v_mfma_f32_16x16x32_bf16 v[164:167], v[36:39], v[132:135], v[164:167]
    v_mfma_f32_16x16x16_bf16 v[160:163], v[16:17], v[136:137], v[160:163]
    v_max3_f32 v248, v144, v145, v146
    v_mfma_f32_16x16x32_bf16 v[168:171], v[42:45], v[132:135], v[168:171]
    buffer_load_dwordx4 v246, s[4:7], s56 offen lds
    v_mfma_f32_16x16x32_bf16 v[172:175], v[18:21], v[132:135], v[172:175]
    s_add_u32 m0, s42, 0
    v_max3_f32 v249, v147, v148, v149
    v_max3_f32 v248, v248, v150, v151
    v_mfma_f32_16x16x16_bf16 v[164:167], v[40:41], v[136:137], v[164:167]
    v_max3_f32 v249, v249, v152, v153
    v_max3_f32 v248, v248, v154, v155
    v_mfma_f32_16x16x16_bf16 v[168:171], v[46:47], v[136:137], v[168:171]
    v_max3_f32 v249, v249, v156, v157
    v_max3_f32 v248, v248, v158, v159
    v_mfma_f32_16x16x16_bf16 v[172:175], v[22:23], v[136:137], v[172:175]
    v_max3_f32 v249, v249, v160, v161
    v_max3_f32 v248, v248, v162, v163
    v_mfma_f32_16x16x32_bf16 v[216:219], a[160:163], a[228:231], v[216:219]
    buffer_load_dwordx4 v247, s[4:7], s56 offen lds
    v_mfma_f32_16x16x32_bf16 v[212:215], a[164:167], a[228:231], v[212:215]
    s_add_u32 s56, s39, 0x17a000
    ds_read_b128 a[228:231], v224 offset:31232
    v_max3_f32 v249, v249, v164, v165
    v_mfma_f32_16x16x32_bf16 v[220:223], a[168:171], a[232:235], v[220:223]
    s_add_u32 m0, s41, 0x1e40
    v_max3_f32 v248, v248, v166, v167
    v_max3_f32 v249, v249, v168, v169
    v_mfma_f32_16x16x32_bf16 v[216:219], a[172:175], a[232:235], v[216:219]
    v_max3_f32 v248, v248, v170, v171
    v_max3_f32 v249, v249, v172, v173
    v_mfma_f32_16x16x32_bf16 v[212:215], a[176:179], a[232:235], v[212:215]
    ds_read_b128 a[232:235], v224 offset:31296
    v_max3_f32 v248, v248, v174, v175
    v_mfma_f32_16x16x32_bf16 v[220:223], a[180:183], a[236:239], v[220:223]
    v_max_f32 v248, v248, v249
    v_mov_b32 v249, v248
    v_mfma_f32_16x16x32_bf16 v[216:219], a[184:187], a[236:239], v[216:219]
    buffer_load_dwordx4 v246, s[4:7], s56 offen lds
    v_mfma_f32_16x16x32_bf16 v[212:215], a[188:191], a[236:239], v[212:215]
    s_add_u32 m0, s42, 0x1e40
    ds_read_b128 a[236:239], v224 offset:34048
    v_mfma_f32_16x16x32_bf16 v[220:223], a[192:195], a[240:243], v[220:223]
    v_permlane16_swap_b32 v248, v249
    v_mfma_f32_16x16x32_bf16 v[216:219], a[196:199], a[240:243], v[216:219]
    v_max_f32 v248, v248, v249
    v_mov_b32 v249, v248
    v_mfma_f32_16x16x32_bf16 v[212:215], a[200:203], a[240:243], v[212:215]
    ds_read_b128 a[240:243], v224 offset:34112
    v_mfma_f32_16x16x32_bf16 v[220:223], a[204:207], a[244:247], v[220:223]
    buffer_load_dwordx4 v247, s[4:7], s56 offen lds
    v_mfma_f32_16x16x32_bf16 v[216:219], a[208:211], a[244:247], v[216:219]
    s_add_u32 s56, s39, 0x1a4000
    v_permlane32_swap_b32 v248, v249
    v_mfma_f32_16x16x32_bf16 v[212:215], a[212:215], a[244:247], v[212:215]
    s_add_u32 m0, s41, 0x3c80
    ds_read_b128 a[244:247], v224 offset:34176
    v_max_f32 v248, v248, v249
    s_waitcnt lgkmcnt(3)
    v_mfma_f32_16x16x32_bf16 v[208:211], a[248:251], a[72:75], 0
    v_cvt_pk_bf16_f32 v138, v220, v221
    v_cvt_pk_bf16_f32 v139, v222, v223
    v_mfma_f32_16x16x32_bf16 v[204:207], a[248:251], a[76:79], 0
    v_cvt_pk_bf16_f32 v140, v216, v217
    v_cvt_pk_bf16_f32 v141, v218, v219
    v_mfma_f32_16x16x32_bf16 v[200:203], a[248:251], a[80:83], 0
    v_cvt_pk_bf16_f32 v142, v212, v213
    v_cvt_pk_bf16_f32 v143, v214, v215
    v_mfma_f32_16x16x32_bf16 v[208:211], a[252:255], a[84:87], v[208:211]
    ds_read_b128 a[248:251], v224 offset:34240
    v_mul_f32 v236, s37, v248
    v_mfma_f32_16x16x32_bf16 v[204:207], a[252:255], a[88:91], v[204:207]
    buffer_load_dwordx4 v246, s[4:7], s56 offen lds
    v_mfma_f32_16x16x32_bf16 v[200:203], a[252:255], a[92:95], v[200:203]
    s_add_u32 m0, s42, 0x3c80
    ds_read_b128 a[252:255], v224 offset:34304
    v_fma_f32 v144, v144, s37, -v236
    v_mfma_f32_16x16x32_bf16 v[208:211], a[220:223], a[96:99], v[208:211]
    v_fma_f32 v145, v145, s37, -v236
    v_fma_f32 v146, v146, s37, -v236
    v_mfma_f32_16x16x32_bf16 v[204:207], a[220:223], a[100:103], v[204:207]
    v_fma_f32 v147, v147, s37, -v236
    v_fma_f32 v148, v148, s37, -v236
    v_mfma_f32_16x16x32_bf16 v[200:203], a[220:223], a[104:107], v[200:203]
    ds_read_b128 a[220:223], v224 offset:34368
    v_fma_f32 v149, v149, s37, -v236
    v_mfma_f32_16x16x32_bf16 v[208:211], a[224:227], a[108:111], v[208:211]
    buffer_load_dwordx4 v247, s[4:7], s56 offen lds
    v_mfma_f32_16x16x32_bf16 v[204:207], a[224:227], a[112:115], v[204:207]
    s_add_u32 s56, s39, 0x1ce000
    v_exp_f32 v144, v144
    v_mfma_f32_16x16x32_bf16 v[200:203], a[224:227], a[116:119], v[200:203]
    s_add_u32 m0, s41, 0x5ac0
    s_waitcnt vmcnt(21)
    ds_read_b64_tr_b16 a[224:225], v109
    ds_read_b64_tr_b16 a[226:227], v109 offset:1536
    v_mfma_f32_16x16x32_bf16 v[208:211], a[228:231], a[120:123], v[208:211]
    v_exp_f32 v145, v145
    v_mfma_f32_16x16x32_bf16 v[204:207], a[228:231], a[124:127], v[204:207]
    v_exp_f32 v146, v146
    v_mfma_f32_16x16x32_bf16 v[200:203], a[228:231], a[128:131], v[200:203]
    buffer_load_dwordx4 v246, s[4:7], s56 offen lds
    v_mfma_f32_16x16x32_bf16 v[208:211], a[232:235], a[132:135], v[208:211]
    s_add_u32 m0, s42, 0x5ac0
    ds_read_b64_tr_b16 a[228:229], v109 offset:32
    ds_read_b64_tr_b16 a[230:231], v109 offset:1568
    v_mfma_f32_16x16x32_bf16 v[204:207], a[232:235], a[136:139], v[204:207]
    v_exp_f32 v147, v147
    v_mfma_f32_16x16x32_bf16 v[200:203], a[232:235], a[140:143], v[200:203]
    s_waitcnt lgkmcnt(5)
    ds_read_b64_tr_b16 a[232:233], v109 offset:64
    ds_read_b64_tr_b16 a[234:235], v109 offset:1600
    v_mfma_f32_16x16x32_bf16 v[220:223], a[236:239], a[72:75], 0
    v_cvt_pk_bf16_f32 v74, v208, v209
    v_cvt_pk_bf16_f32 v75, v210, v211
    v_mfma_f32_16x16x32_bf16 v[216:219], a[236:239], a[76:79], 0
    v_cvt_pk_bf16_f32 v96, v204, v205
    v_cvt_pk_bf16_f32 v97, v206, v207
    v_mfma_f32_16x16x32_bf16 v[212:215], a[236:239], a[80:83], 0
    v_cvt_pk_bf16_f32 v118, v200, v201
    v_cvt_pk_bf16_f32 v119, v202, v203
    v_mfma_f32_16x16x32_bf16 v[220:223], a[240:243], a[84:87], v[220:223]
    ds_read_b128 a[236:239], v224 offset:46464
    v_cvt_pk_bf16_f32 v176, v144, v145
    v_mfma_f32_16x16x32_bf16 v[216:219], a[240:243], a[88:91], v[216:219]
    buffer_load_dwordx4 v247, s[4:7], s56 offen lds
    v_mfma_f32_16x16x32_bf16 v[212:215], a[240:243], a[92:95], v[212:215]
    s_add_u32 s56, s39, 0x1f8000
    ds_read_b128 a[240:243], v224 offset:46528
    v_cvt_pk_bf16_f32 v177, v146, v147
    v_mfma_f32_16x16x32_bf16 v[220:223], a[244:247], a[96:99], v[220:223]
    s_add_u32 m0, s41, 0x7900
    ds_read_b128 v[144:147], v234
    v_bfe_u32 v234, s63, v233, 4
    v_mfma_f32_16x16x32_bf16 v[216:219], a[244:247], a[100:103], v[216:219]
    v_mad_u32_u24 v234, v234, s40, v231
    v_fma_f32 v150, v150, s37, -v236
    v_mfma_f32_16x16x32_bf16 v[212:215], a[244:247], a[104:107], v[212:215]
    ds_read_b128 a[244:247], v224 offset:46592
    v_fma_f32 v151, v151, s37, -v236
    v_mfma_f32_16x16x32_bf16 v[220:223], a[248:251], a[108:111], v[220:223]
    s_waitcnt lgkmcnt(4)
    ds_write_b128 v130, a[224:227]
    v_mfma_f32_16x16x32_bf16 v[216:219], a[248:251], a[112:115], v[216:219]
    ds_write_b128 v130, a[228:231] offset:1024
    v_mfma_f32_16x16x32_bf16 v[212:215], a[248:251], a[116:119], v[212:215]
    ds_write_b128 v130, a[232:235] offset:2048
    v_mfma_f32_16x16x32_bf16 v[220:223], a[252:255], a[120:123], v[220:223]
    s_waitcnt lgkmcnt(4)
    v_exp_f32 v148, v148
    v_mfma_f32_16x16x32_bf16 v[144:147], v[24:27], v[138:141], v[144:147]
    v_exp_f32 v149, v149
    v_mfma_f32_16x16x32_bf16 v[216:219], a[252:255], a[124:127], v[216:219]
    v_exp_f32 v150, v150
    v_mfma_f32_16x16x32_bf16 v[212:215], a[252:255], a[128:131], v[212:215]
    v_exp_f32 v151, v151
    v_mfma_f32_16x16x32_bf16 v[220:223], a[220:223], a[132:135], v[220:223]
    v_cvt_pk_bf16_f32 v178, v148, v149
    v_cvt_pk_bf16_f32 v179, v150, v151
    v_mfma_f32_16x16x16_bf16 v[144:147], v[28:29], v[142:143], v[144:147]
    v_fma_f32 v152, v152, s37, -v236
    v_fma_f32 v153, v153, s37, -v236
    v_mfma_f32_16x16x32_bf16 v[196:199], a[216:219], v[176:179], 0
    v_fma_f32 v154, v154, s37, -v236
    v_fma_f32 v155, v155, s37, -v236
    v_mfma_f32_16x16x32_bf16 v[184:187], v[66:69], v[176:179], 0
    v_cvt_pk_bf16_f32 v76, v220, v221
    v_cvt_pk_bf16_f32 v77, v222, v223
    v_mfma_f32_16x16x32_bf16 v[188:191], v[88:91], v[176:179], 0
    ds_read_b128 a[248:251], v224 offset:46656
    ds_read_b128 a[252:255], v224 offset:46720
    v_mfma_f32_16x16x32_bf16 v[192:195], v[110:113], v[176:179], 0
    ds_read_b128 v[148:151], v235
    v_bfe_u32 v235, s64, v233, 4
    v_mfma_f32_16x16x32_bf16 v[216:219], a[220:223], a[136:139], v[216:219]
    v_mad_u32_u24 v235, v235, s40, v231
    v_fma_f32 v156, v156, s37, -v236
    v_mfma_f32_16x16x32_bf16 v[212:215], a[220:223], a[140:143], v[212:215]
    ds_read_b128 a[220:223], v224 offset:46784
    v_fma_f32 v157, v157, s37, -v236
    v_mfma_f32_16x16x32_bf16 v[208:211], a[236:239], a[72:75], 0
    s_waitcnt vmcnt(20)
    ds_read_b64_tr_b16 a[224:225], v109 offset:12288
    ds_read_b64_tr_b16 a[226:227], v109 offset:13824
    v_mfma_f32_16x16x32_bf16 v[204:207], a[236:239], a[76:79], 0
    v_cvt_pk_bf16_f32 v98, v216, v217
    v_cvt_pk_bf16_f32 v99, v218, v219
    v_mfma_f32_16x16x32_bf16 v[200:203], a[236:239], a[80:83], 0
    v_cvt_pk_bf16_f32 v120, v212, v213
    v_cvt_pk_bf16_f32 v121, v214, v215
    v_mfma_f32_16x16x32_bf16 v[208:211], a[240:243], a[84:87], v[208:211]
    s_waitcnt vmcnt(4) lgkmcnt(6)
    ds_read_b128 a[236:239], v224 offset:49536
    ds_read_b64_tr_b16 a[228:229], v109 offset:12320
    v_mfma_f32_16x16x32_bf16 v[204:207], a[240:243], a[88:91], v[204:207]
    s_barrier
    ds_read_b128 v[252:255], v224 offset:320
    v_fma_f32 v158, v158, s37, -v236
    v_mfma_f32_16x16x32_bf16 v[200:203], a[240:243], a[92:95], v[200:203]
    ds_read_b128 a[240:243], v224 offset:49600
    v_fma_f32 v159, v159, s37, -v236
    v_mfma_f32_16x16x32_bf16 v[208:211], a[244:247], a[96:99], v[208:211]
    s_waitcnt lgkmcnt(7)
    ds_read_b64_tr_b16 a[230:231], v109 offset:13856
    ds_read_b64_tr_b16 a[232:233], v109 offset:12352
    v_mfma_f32_16x16x32_bf16 v[148:151], v[30:33], v[138:141], v[148:151]
    ds_read_b64_tr_b16 a[234:235], v109 offset:13888
    v_fma_f32 v160, v160, s37, -v236
    v_mfma_f32_16x16x32_bf16 v[204:207], a[244:247], a[100:103], v[204:207]
    v_exp_f32 v152, v152
    v_mfma_f32_16x16x32_bf16 v[200:203], a[244:247], a[104:107], v[200:203]
    ds_read_b128 a[244:247], v224 offset:49664
    v_fma_f32 v161, v161, s37, -v236
    v_mfma_f32_16x16x16_bf16 v[148:151], v[34:35], v[142:143], v[148:151]
    s_waitcnt lgkmcnt(8)
    ds_write_b128 v130, a[224:227] offset:12288
    v_mfma_f32_16x16x32_bf16 v[208:211], a[248:251], a[108:111], v[208:211]
    v_exp_f32 v153, v153
    v_mfma_f32_16x16x32_bf16 v[204:207], a[248:251], a[112:115], v[204:207]
    v_exp_f32 v154, v154
    v_mfma_f32_16x16x32_bf16 v[200:203], a[248:251], a[116:119], v[200:203]
    v_exp_f32 v155, v155
    v_mfma_f32_16x16x32_bf16 v[208:211], a[252:255], a[120:123], v[208:211]
    ds_read_b128 a[248:251], v224 offset:49728
    ds_read_b64_tr_b16 a[224:225], v109 offset:24576
    v_mfma_f32_16x16x32_bf16 v[204:207], a[252:255], a[124:127], v[204:207]
    s_waitcnt lgkmcnt(6)
    ds_write_b128 v130, a[228:231] offset:13312
    v_mfma_f32_16x16x32_bf16 v[200:203], a[252:255], a[128:131], v[200:203]
    s_waitcnt lgkmcnt(5)
    ds_write_b128 v130, a[232:235] offset:14336
    v_mfma_f32_16x16x32_bf16 v[208:211], a[220:223], a[132:135], v[208:211]
    v_cvt_pk_bf16_f32 v180, v152, v153
    v_cvt_pk_bf16_f32 v181, v154, v155
    v_mfma_f32_16x16x32_bf16 v[204:207], a[220:223], a[136:139], v[204:207]
    v_exp_f32 v156, v156
    v_mfma_f32_16x16x32_bf16 v[200:203], a[220:223], a[140:143], v[200:203]
    v_exp_f32 v157, v157
    v_mfma_f32_16x16x32_bf16 v[220:223], a[236:239], a[72:75], 0
    v_exp_f32 v158, v158
    v_mfma_f32_16x16x32_bf16 v[216:219], a[236:239], a[76:79], 0
    v_cvt_pk_bf16_f32 v80, v208, v209
    v_cvt_pk_bf16_f32 v81, v210, v211
    v_mfma_f32_16x16x32_bf16 v[212:215], a[236:239], a[80:83], 0
    v_cvt_pk_bf16_f32 v102, v204, v205
    v_cvt_pk_bf16_f32 v103, v206, v207
    v_mfma_f32_16x16x32_bf16 v[220:223], a[240:243], a[84:87], v[220:223]
    v_cvt_pk_bf16_f32 v124, v200, v201
    v_cvt_pk_bf16_f32 v125, v202, v203
    v_mfma_f32_16x16x32_bf16 v[216:219], a[240:243], a[88:91], v[216:219]
    ds_read_b128 a[252:255], v224 offset:49792
    ds_read_b128 a[220:223], v224 offset:49856
    v_mfma_f32_16x16x32_bf16 v[212:215], a[240:243], a[92:95], v[212:215]
    s_waitcnt lgkmcnt(4)
    ds_read_b128 a[236:239], v225 offset:39872
    v_cvt_pk_bf16_f32 v182, v156, v157
    v_mfma_f32_16x16x32_bf16 v[220:223], a[244:247], a[96:99], v[220:223]
    ds_read_b128 a[240:243], v225 offset:39936
    v_fma_f32 v162, v162, s37, -v236
    v_mfma_f32_16x16x32_bf16 v[216:219], a[244:247], a[100:103], v[216:219]
    ds_read_b128 v[152:155], v230 offset:1920
    v_fma_f32 v163, v163, s37, -v236
    v_mfma_f32_16x16x32_bf16 v[212:215], a[244:247], a[104:107], v[212:215]
    v_exp_f32 v159, v159
    v_mfma_f32_16x16x32_bf16 v[220:223], a[248:251], a[108:111], v[220:223]
    ds_read_b128 a[244:247], v225 offset:40000
    v_cvt_pk_bf16_f32 v183, v158, v159
    v_mfma_f32_16x16x32_bf16 v[216:219], a[248:251], a[112:115], v[216:219]
    ds_read_b128 v[156:159], v250
    v_bfe_u32 v250, s65, v232, 4
    v_mfma_f32_16x16x32_bf16 v[196:199], a[216:219], v[180:183], v[196:199]
    ds_read_b64_tr_b16 a[226:227], v109 offset:26112
    v_fma_f32 v164, v164, s37, -v236
    v_mfma_f32_16x16x32_bf16 v[184:187], v[70:73], v[180:183], v[184:187]
    ds_read_b64_tr_b16 a[228:229], v109 offset:24608
    ds_read_b64_tr_b16 a[230:231], v109 offset:26144
    v_mfma_f32_16x16x32_bf16 v[188:191], v[92:95], v[180:183], v[188:191]
    ds_read_b64_tr_b16 a[232:233], v109 offset:24640
    ds_read_b64_tr_b16 a[234:235], v109 offset:26176
    v_mfma_f32_16x16x32_bf16 v[192:195], v[114:117], v[180:183], v[192:195]
    v_exp_f32 v160, v160
    v_mfma_f32_16x16x32_bf16 v[212:215], a[248:251], a[116:119], v[212:215]
    s_waitcnt lgkmcnt(10)
    ds_read_b128 a[248:251], v225 offset:40064
    v_fma_f32 v165, v165, s37, -v236
    v_mfma_f32_16x16x32_bf16 v[220:223], a[252:255], a[120:123], v[220:223]
    s_waitcnt lgkmcnt(8)
    v_exp_f32 v161, v161
    v_mfma_f32_16x16x32_bf16 v[152:155], v[36:39], v[138:141], v[152:155]
    v_exp_f32 v162, v162
    v_mfma_f32_16x16x32_bf16 v[216:219], a[252:255], a[124:127], v[216:219]
    v_exp_f32 v163, v163
    v_mfma_f32_16x16x32_bf16 v[212:215], a[252:255], a[128:131], v[212:215]
    ds_read_b128 a[252:255], v225 offset:40128
    v_cvt_pk_bf16_f32 v176, v160, v161
    v_mfma_f32_16x16x16_bf16 v[152:155], v[40:41], v[142:143], v[152:155]
    s_waitcnt lgkmcnt(6)
    ds_write_b128 v130, a[224:227] offset:24576
    v_mfma_f32_16x16x32_bf16 v[156:159], v[42:45], v[138:141], v[156:159]
    s_waitcnt lgkmcnt(5)
    ds_write_b128 v130, a[228:231] offset:25600
    v_mfma_f32_16x16x32_bf16 v[220:223], a[220:223], a[132:135], v[220:223]
    s_waitcnt lgkmcnt(4)
    ds_write_b128 v130, a[232:235] offset:26624
    v_mfma_f32_16x16x32_bf16 v[216:219], a[220:223], a[136:139], v[216:219]
    v_cvt_pk_bf16_f32 v177, v162, v163
    v_fma_f32 v166, v166, s37, -v236
    v_mfma_f32_16x16x16_bf16 v[156:159], v[46:47], v[142:143], v[156:159]
    v_fma_f32 v167, v167, s37, -v236
    v_fma_f32 v168, v168, s37, -v236
    v_mfma_f32_16x16x32_bf16 v[212:215], a[220:223], a[140:143], v[212:215]
    v_cvt_pk_bf16_f32 v78, v220, v221
    v_cvt_pk_bf16_f32 v79, v222, v223
    v_mfma_f32_16x16x32_bf16 v[208:211], a[144:147], a[236:239], 0
    v_cvt_pk_bf16_f32 v100, v216, v217
    v_cvt_pk_bf16_f32 v101, v218, v219
    v_mfma_f32_16x16x32_bf16 v[204:207], a[148:151], a[236:239], 0
    v_exp_f32 v164, v164
    v_mfma_f32_16x16x32_bf16 v[200:203], a[152:155], a[236:239], 0
    v_cvt_pk_bf16_f32 v122, v212, v213
    v_cvt_pk_bf16_f32 v123, v214, v215
    v_mfma_f32_16x16x32_bf16 v[208:211], a[156:159], a[240:243], v[208:211]
    v_exp_f32 v165, v165
    v_mfma_f32_16x16x32_bf16 v[204:207], a[160:163], a[240:243], v[204:207]
    ds_read_b128 a[220:223], v225 offset:40192
    ds_read_b128 a[224:227], v227 offset:37120
    v_mfma_f32_16x16x32_bf16 v[200:203], a[164:167], a[240:243], v[200:203]
    ds_read_b128 a[228:231], v227 offset:37184
    v_cvt_pk_bf16_f32 v178, v164, v165
    v_mfma_f32_16x16x32_bf16 v[208:211], a[168:171], a[244:247], v[208:211]
    ds_read_b128 a[232:235], v227 offset:37248
    v_fma_f32 v169, v169, s37, -v236
    v_mfma_f32_16x16x32_bf16 v[204:207], a[172:175], a[244:247], v[204:207]
    ds_read_b128 a[236:239], v227 offset:37312
    v_fma_f32 v170, v170, s37, -v236
    v_mfma_f32_16x16x32_bf16 v[200:203], a[176:179], a[244:247], v[200:203]
    s_waitcnt lgkmcnt(7)
    ds_read_b128 a[240:243], v227 offset:37376
    v_fma_f32 v171, v171, s37, -v236
    v_mfma_f32_16x16x32_bf16 v[208:211], a[180:183], a[248:251], v[208:211]
    ds_read_b128 a[244:247], v227 offset:37440
    v_fma_f32 v172, v172, s37, -v236
    v_mfma_f32_16x16x32_bf16 v[204:207], a[184:187], a[248:251], v[204:207]
    ds_read_b128 v[160:163], v234
    v_mad_u32_u24 v234, v250, s40, v229
    v_mfma_f32_16x16x32_bf16 v[200:203], a[188:191], a[248:251], v[200:203]
    v_mad_u32_u24 v250, v250, s40, v228
    v_fma_f32 v173, v173, s37, -v236
    v_mfma_f32_16x16x32_bf16 v[208:211], a[192:195], a[252:255], v[208:211]
    ds_read_b64_tr_b16 a[248:249], v109 offset:36864
    ds_read_b64_tr_b16 a[250:251], v109 offset:38400
    v_mfma_f32_16x16x32_bf16 v[204:207], a[196:199], a[252:255], v[204:207]
    v_exp_f32 v166, v166
    v_mfma_f32_16x16x32_bf16 v[200:203], a[200:203], a[252:255], v[200:203]
    s_waitcnt lgkmcnt(9)
    ds_read_b64_tr_b16 a[252:253], v109 offset:36896
    ds_read_b64_tr_b16 a[254:255], v109 offset:38432
    v_mfma_f32_16x16x32_bf16 v[208:211], a[204:207], a[220:223], v[208:211]
    v_exp_f32 v167, v167
    v_mfma_f32_16x16x32_bf16 v[204:207], a[208:211], a[220:223], v[204:207]
    v_cvt_pk_bf16_f32 v179, v166, v167
    v_fma_f32 v174, v174, s37, -v236
    v_mfma_f32_16x16x32_bf16 v[200:203], a[212:215], a[220:223], v[200:203]
    ds_read_b128 v[164:167], v235
    v_bfe_u32 v235, s62, v232, 4
    v_mfma_f32_16x16x32_bf16 v[196:199], a[216:219], v[176:179], v[196:199]
    v_cvt_pk_bf16_f32 v132, v208, v209
    v_cvt_pk_bf16_f32 v133, v210, v211
    v_mfma_f32_16x16x32_bf16 v[184:187], v[74:77], v[176:179], v[184:187]
    v_cvt_pk_bf16_f32 v134, v204, v205
    v_cvt_pk_bf16_f32 v135, v206, v207
    v_mfma_f32_16x16x32_bf16 v[188:191], v[96:99], v[176:179], v[188:191]
    v_cvt_pk_bf16_f32 v136, v200, v201
    v_cvt_pk_bf16_f32 v137, v202, v203
    v_mfma_f32_16x16x32_bf16 v[192:195], v[118:121], v[176:179], v[192:195]
    s_waitcnt lgkmcnt(5)
    ds_read_b64_tr_b16 a[220:221], v109 offset:36928
    ds_read_b64_tr_b16 a[222:223], v109 offset:38464
    v_mfma_f32_16x16x32_bf16 v[160:163], v[48:51], v[138:141], v[160:163]
    s_waitcnt lgkmcnt(5)
    ds_write_b128 v130, a[248:251] offset:36864
    v_mfma_f32_16x16x32_bf16 v[220:223], a[224:227], a[72:75], 0
    s_waitcnt lgkmcnt(4)
    ds_write_b128 v130, a[252:255] offset:37888
    v_mfma_f32_16x16x32_bf16 v[216:219], a[224:227], a[76:79], 0
    s_waitcnt lgkmcnt(4)
    v_exp_f32 v168, v168
    v_mfma_f32_16x16x32_bf16 v[164:167], v[54:57], v[138:141], v[164:167]
    v_exp_f32 v169, v169
    v_mfma_f32_16x16x16_bf16 v[160:163], v[52:53], v[142:143], v[160:163]
    v_exp_f32 v170, v170
    v_mfma_f32_16x16x32_bf16 v[212:215], a[224:227], a[80:83], 0
    v_exp_f32 v171, v171
    v_mfma_f32_16x16x32_bf16 v[220:223], a[228:231], a[84:87], v[220:223]
    s_waitcnt lgkmcnt(2)
    ds_write_b128 v130, a[220:223] offset:38912
    v_mfma_f32_16x16x16_bf16 v[164:167], v[58:59], v[142:143], v[164:167]
    v_cvt_pk_bf16_f32 v180, v168, v169
    v_cvt_pk_bf16_f32 v181, v170, v171
    v_mfma_f32_16x16x32_bf16 v[216:219], a[228:231], a[88:91], v[216:219]
    v_fma_f32 v175, v175, s37, -v236
    v_max3_f32 v248, v144, v145, v146
    v_mfma_f32_16x16x32_bf16 v[212:215], a[228:231], a[92:95], v[212:215]
    v_exp_f32 v172, v172
    v_mfma_f32_16x16x32_bf16 v[220:223], a[232:235], a[96:99], v[220:223]
    ds_read_b128 a[248:251], v224
    ds_read_b128 a[252:255], v224 offset:64
    v_mfma_f32_16x16x32_bf16 v[216:219], a[232:235], a[100:103], v[216:219]
    ds_read_b128 a[220:223], v241
    v_max3_f32 v249, v147, v148, v149
    v_mfma_f32_16x16x32_bf16 v[212:215], a[232:235], a[104:107], v[212:215]
    ds_read_b128 v[168:171], v234
    v_bfe_u32 v234, s62, v232, 4
    v_mfma_f32_16x16x32_bf16 v[220:223], a[236:239], a[108:111], v[220:223]
    v_mad_u32_u24 v234, v234, s40, v230
    v_max3_f32 v248, v248, v150, v151
    v_mfma_f32_16x16x32_bf16 v[216:219], a[236:239], a[112:115], v[216:219]
    ds_read_b64_tr_b16 a[224:225], v109 offset:49152
    ds_read_b64_tr_b16 a[226:227], v109 offset:50688
    v_mfma_f32_16x16x32_bf16 v[212:215], a[236:239], a[116:119], v[212:215]
    ds_read_b64_tr_b16 a[228:229], v109 offset:49184
    ds_read_b64_tr_b16 a[230:231], v109 offset:50720
    v_mfma_f32_16x16x32_bf16 v[220:223], a[240:243], a[120:123], v[220:223]
    ds_read_b64_tr_b16 a[232:233], v109 offset:49216
    ds_read_b64_tr_b16 a[234:235], v109 offset:50752
    v_mfma_f32_16x16x32_bf16 v[216:219], a[240:243], a[124:127], v[216:219]
    ds_read_b64_tr_b16 a[236:237], v109 offset:61440
    ds_read_b64_tr_b16 a[238:239], v109 offset:62976
    v_mfma_f32_16x16x32_bf16 v[212:215], a[240:243], a[128:131], v[212:215]
    ds_read_b64_tr_b16 a[240:241], v109 offset:61472
    ds_read_b64_tr_b16 a[242:243], v109 offset:63008
    v_mfma_f32_16x16x32_bf16 v[220:223], a[244:247], a[132:135], v[220:223]
    v_exp_f32 v173, v173
    v_mfma_f32_16x16x32_bf16 v[216:219], a[244:247], a[136:139], v[216:219]
    v_exp_f32 v174, v174
    v_mfma_f32_16x16x32_bf16 v[212:215], a[244:247], a[140:143], v[212:215]
    s_waitcnt lgkmcnt(10)
    ds_read_b64_tr_b16 a[244:245], v109 offset:61504
    ds_read_b64_tr_b16 a[246:247], v109 offset:63040
    v_mfma_f32_16x16x32_bf16 v[168:171], v[30:33], v[132:135], v[168:171]
    v_exp_f32 v175, v175
    v_mfma_f32_16x16x32_bf16 v[208:211], a[0:3], a[248:251], 0
    v_cvt_pk_bf16_f32 v84, v220, v221
    v_cvt_pk_bf16_f32 v85, v222, v223
    v_mfma_f32_16x16x32_bf16 v[204:207], a[4:7], a[248:251], 0
    v_cvt_pk_bf16_f32 v106, v216, v217
    v_cvt_pk_bf16_f32 v107, v218, v219
    v_mfma_f32_16x16x16_bf16 v[168:171], v[34:35], v[136:137], v[168:171]
    v_cvt_pk_bf16_f32 v128, v212, v213
    v_cvt_pk_bf16_f32 v129, v214, v215
    v_mfma_f32_16x16x32_bf16 v[200:203], a[8:11], a[248:251], 0
    s_waitcnt lgkmcnt(6)
    ds_write_b128 v130, a[224:227] offset:49152
    v_mfma_f32_16x16x32_bf16 v[220:223], a[248:251], a[72:75], 0
    ds_write_b128 v130, a[228:231] offset:50176
    v_mfma_f32_16x16x32_bf16 v[216:219], a[248:251], a[76:79], 0
    ds_write_b128 v130, a[232:235] offset:51200
    v_mfma_f32_16x16x32_bf16 v[212:215], a[248:251], a[80:83], 0
    s_waitcnt lgkmcnt(3)
    ds_write_b128 v130, a[236:239] offset:61440
    v_mfma_f32_16x16x32_bf16 v[208:211], a[12:15], a[252:255], v[208:211]
    ds_write_b128 v130, a[240:243] offset:62464
    v_mfma_f32_16x16x32_bf16 v[204:207], a[16:19], a[252:255], v[204:207]
    ds_write_b128 v130, a[244:247] offset:63488
    v_mfma_f32_16x16x32_bf16 v[200:203], a[20:23], a[252:255], v[200:203]
    v_cvt_pk_bf16_f32 v182, v172, v173
    v_cvt_pk_bf16_f32 v183, v174, v175
    v_mfma_f32_16x16x32_bf16 v[220:223], a[252:255], a[84:87], v[220:223]
    v_max3_f32 v249, v249, v152, v153
    v_max3_f32 v248, v248, v154, v155
    v_mfma_f32_16x16x32_bf16 v[196:199], a[216:219], v[180:183], v[196:199]
    v_max3_f32 v249, v249, v156, v157
    v_max3_f32 v248, v248, v158, v159
    v_mfma_f32_16x16x32_bf16 v[184:187], v[78:81], v[180:183], v[184:187]
    v_max3_f32 v249, v249, v160, v161
    v_max3_f32 v248, v248, v162, v163
    v_mfma_f32_16x16x32_bf16 v[188:191], v[100:103], v[180:183], v[188:191]
    v_max3_f32 v249, v249, v164, v165
    v_max3_f32 v248, v248, v166, v167
    v_mfma_f32_16x16x32_bf16 v[192:195], v[122:125], v[180:183], v[192:195]
    v_rcp_f32 v197, v196
    v_mfma_f32_16x16x32_bf16 v[216:219], a[252:255], a[88:91], v[216:219]
    v_mul_f32 v184, v184, v197
    v_mul_f32 v185, v185, v197
    v_mfma_f32_16x16x32_bf16 v[212:215], a[252:255], a[92:95], v[212:215]
    v_cvt_pk_bf16_f32 v184, v184, v185
    v_mul_f32 v186, v186, v197
    v_mul_f32 v187, v187, v197
    v_cvt_pk_bf16_f32 v185, v186, v187
    v_mul_f32 v188, v188, v197
    v_mul_f32 v189, v189, v197
    v_cvt_pk_bf16_f32 v186, v188, v189
    v_mul_f32 v190, v190, v197
    v_mul_f32 v191, v191, v197
    v_cvt_pk_bf16_f32 v187, v190, v191
    v_mul_f32 v192, v192, v197
    v_mul_f32 v193, v193, v197
    v_cvt_pk_bf16_f32 v188, v192, v193
    v_mul_f32 v194, v194, v197
    v_mul_f32 v195, v195, v197
    v_cvt_pk_bf16_f32 v189, v194, v195
    ds_write_b128 v237, v[184:187]
    ds_write_b64 v238, v[188:189]
    v_max_f32 v248, v248, v249
    v_mov_b32 v249, v248
    s_nop 1
    v_permlane16_swap_b32 v248, v249
    v_max_f32 v248, v248, v249
    v_mov_b32 v249, v248
    s_nop 1
    v_permlane32_swap_b32 v248, v249
    v_max_f32 v248, v248, v249
    v_mul_f32 v236, s37, v248
    v_fma_f32 v144, v144, s37, -v236
    v_fma_f32 v145, v145, s37, -v236
    v_fma_f32 v146, v146, s37, -v236
    v_fma_f32 v147, v147, s37, -v236
    v_exp_f32 v144, v144
    v_exp_f32 v145, v145
    v_exp_f32 v146, v146
    ds_read_b128 a[236:239], v224 offset:128
    ds_read_b128 a[240:243], v224 offset:192
    v_exp_f32 v147, v147
    ds_read_b128 a[244:247], v224 offset:256
    v_cvt_pk_bf16_f32 v176, v144, v145
    ds_read_b128 a[248:251], v224 offset:3072
    v_cvt_pk_bf16_f32 v177, v146, v147
    ds_read_b128 a[252:255], v224 offset:3136
    v_fma_f32 v148, v148, s37, -v236
    ds_read_b128 a[224:227], v241 offset:512
    v_fma_f32 v149, v149, s37, -v236
    ds_read_b128 a[228:231], v242
    v_fma_f32 v150, v150, s37, -v236
    ds_read_b128 a[232:235], v242 offset:512
    v_fma_f32 v151, v151, s37, -v236
    ds_read_b128 v[172:175], v250
    v_mad_u32_u24 v250, v235, s40, v228
    s_waitcnt lgkmcnt(8)
    v_mfma_f32_16x16x32_bf16 v[208:211], a[24:27], a[236:239], v[208:211]
    ds_read_b128 v[144:147], v228 offset:1280
    v_mad_u32_u24 v235, v235, s40, v229
    v_mfma_f32_16x16x32_bf16 v[204:207], a[28:31], a[236:239], v[204:207]
    v_exp_f32 v148, v148
    v_mfma_f32_16x16x32_bf16 v[200:203], a[32:35], a[236:239], v[200:203]
    v_exp_f32 v149, v149
    v_mfma_f32_16x16x32_bf16 v[220:223], a[236:239], a[96:99], v[220:223]
    v_exp_f32 v150, v150
    v_mfma_f32_16x16x32_bf16 v[216:219], a[236:239], a[100:103], v[216:219]
    v_exp_f32 v151, v151
    v_mfma_f32_16x16x32_bf16 v[212:215], a[236:239], a[104:107], v[212:215]
    s_waitcnt lgkmcnt(5)
    ds_read_b128 a[236:239], v224 offset:3200
    v_cvt_pk_bf16_f32 v178, v148, v149
    v_mfma_f32_16x16x32_bf16 v[208:211], a[36:39], a[240:243], v[208:211]
    v_cvt_pk_bf16_f32 v179, v150, v151
    v_fma_f32 v152, v152, s37, -v236
    v_mfma_f32_16x16x32_bf16 v[204:207], a[40:43], a[240:243], v[204:207]
    ds_read_b128 v[148:151], v229 offset:1280
    v_fma_f32 v153, v153, s37, -v236
    v_mfma_f32_16x16x32_bf16 v[196:199], a[216:219], v[176:179], 0
    v_fma_f32 v154, v154, s37, -v236
    v_fma_f32 v155, v155, s37, -v236
    v_mfma_f32_16x16x32_bf16 v[184:187], v[68:71], v[176:179], 0
    v_exp_f32 v152, v152
    v_mfma_f32_16x16x32_bf16 v[188:191], v[90:93], v[176:179], 0
    v_exp_f32 v153, v153
    v_mfma_f32_16x16x32_bf16 v[192:195], v[112:115], v[176:179], 0
    s_waitcnt lgkmcnt(2)
    v_exp_f32 v154, v154
    v_mfma_f32_16x16x32_bf16 v[172:175], v[6:9], v[132:135], v[172:175]
    v_exp_f32 v155, v155
    v_mfma_f32_16x16x32_bf16 v[144:147], v[12:15], v[132:135], v[144:147]
    v_cvt_pk_bf16_f32 v180, v152, v153
    v_cvt_pk_bf16_f32 v181, v154, v155
    v_mfma_f32_16x16x32_bf16 v[200:203], a[44:47], a[240:243], v[200:203]
    ds_read_b128 v[152:155], v229 offset:1920
    v_fma_f32 v156, v156, s37, -v236
    v_mfma_f32_16x16x16_bf16 v[172:175], v[10:11], v[136:137], v[172:175]
    v_fma_f32 v157, v157, s37, -v236
    v_fma_f32 v158, v158, s37, -v236
    v_mfma_f32_16x16x16_bf16 v[144:147], v[16:17], v[136:137], v[144:147]
    s_waitcnt lgkmcnt(1)
    v_fma_f32 v159, v159, s37, -v236
    v_fma_f32 v160, v160, s37, -v236
    v_mfma_f32_16x16x32_bf16 v[148:151], v[36:39], v[132:135], v[148:151]
    v_exp_f32 v156, v156
    v_mfma_f32_16x16x32_bf16 v[220:223], a[240:243], a[108:111], v[220:223]
    v_exp_f32 v157, v157
    v_mfma_f32_16x16x32_bf16 v[216:219], a[240:243], a[112:115], v[216:219]
    v_exp_f32 v158, v158
    v_mfma_f32_16x16x32_bf16 v[212:215], a[240:243], a[116:119], v[212:215]
    ds_read_b128 a[240:243], v224 offset:3264
    v_cvt_pk_bf16_f32 v182, v156, v157
    v_mfma_f32_16x16x16_bf16 v[148:151], v[40:41], v[136:137], v[148:151]
    v_exp_f32 v159, v159
    v_mfma_f32_16x16x32_bf16 v[208:211], a[48:51], a[244:247], v[208:211]
    s_waitcnt lgkmcnt(1)
    v_cvt_pk_bf16_f32 v183, v158, v159
    v_fma_f32 v161, v161, s37, -v236
    v_mfma_f32_16x16x32_bf16 v[152:155], v[42:45], v[132:135], v[152:155]
    ds_read_b128 v[156:159], v228 offset:1920
    v_fma_f32 v162, v162, s37, -v236
    v_mfma_f32_16x16x32_bf16 v[196:199], a[216:219], v[180:183], v[196:199]
    v_fma_f32 v163, v163, s37, -v236
    v_fma_f32 v164, v164, s37, -v236
    v_mfma_f32_16x16x32_bf16 v[184:187], v[76:79], v[180:183], v[184:187]
    v_exp_f32 v160, v160
    v_mfma_f32_16x16x32_bf16 v[188:191], v[98:101], v[180:183], v[188:191]
    v_exp_f32 v161, v161
    v_mfma_f32_16x16x32_bf16 v[192:195], v[120:123], v[180:183], v[192:195]
    v_exp_f32 v162, v162
    v_mfma_f32_16x16x16_bf16 v[152:155], v[46:47], v[136:137], v[152:155]
    v_exp_f32 v163, v163
    v_mfma_f32_16x16x32_bf16 v[204:207], a[52:55], a[244:247], v[204:207]
    v_cvt_pk_bf16_f32 v176, v160, v161
    v_cvt_pk_bf16_f32 v177, v162, v163
    v_mfma_f32_16x16x32_bf16 v[200:203], a[56:59], a[244:247], v[200:203]
    ds_read_b128 v[160:163], v250
    v_bfe_u32 v250, s66, v233, 4
    v_mfma_f32_16x16x32_bf16 v[220:223], a[244:247], a[120:123], v[220:223]
    s_waitcnt lgkmcnt(1)
    v_mad_u32_u24 v250, v250, s40, v231
    v_fma_f32 v165, v165, s37, -v236
    v_mfma_f32_16x16x32_bf16 v[156:159], v[18:21], v[132:135], v[156:159]
    v_fma_f32 v166, v166, s37, -v236
    v_fma_f32 v167, v167, s37, -v236
    v_mfma_f32_16x16x32_bf16 v[216:219], a[244:247], a[124:127], v[216:219]
    v_exp_f32 v164, v164
    v_mfma_f32_16x16x32_bf16 v[212:215], a[244:247], a[128:131], v[212:215]
    ds_read_b128 a[244:247], v224 offset:3328
    v_max3_f32 v248, v168, v169, v170
    v_mfma_f32_16x16x16_bf16 v[156:159], v[22:23], v[136:137], v[156:159]
    v_exp_f32 v165, v165
    v_mfma_f32_16x16x32_bf16 v[208:211], a[60:63], v[252:255], v[208:211]
    v_exp_f32 v166, v166
    v_mfma_f32_16x16x32_bf16 v[204:207], a[64:67], v[252:255], v[204:207]
    v_exp_f32 v167, v167
    v_mfma_f32_16x16x32_bf16 v[200:203], a[68:71], v[252:255], v[200:203]
    v_cvt_pk_bf16_f32 v178, v164, v165
    v_cvt_pk_bf16_f32 v179, v166, v167
    v_mfma_f32_16x16x32_bf16 v[220:223], v[252:255], a[132:135], v[220:223]
    ds_read_b128 v[164:167], v235
    v_cvt_pk_bf16_f32 v0, v208, v209
    v_mfma_f32_16x16x32_bf16 v[196:199], a[216:219], v[176:179], v[196:199]
    v_cvt_pk_bf16_f32 v1, v210, v211
    v_cvt_pk_bf16_f32 v2, v204, v205
    v_mfma_f32_16x16x32_bf16 v[184:187], v[82:85], v[176:179], v[184:187]
    v_cvt_pk_bf16_f32 v3, v206, v207
    v_cvt_pk_bf16_f32 v4, v200, v201
    v_mfma_f32_16x16x32_bf16 v[188:191], v[104:107], v[176:179], v[188:191]
    v_cvt_pk_bf16_f32 v5, v202, v203
    v_cvt_pk_bf16_f32 v66, v220, v221
    v_mfma_f32_16x16x32_bf16 v[192:195], v[126:129], v[176:179], v[192:195]
    s_waitcnt lgkmcnt(2)
    v_cvt_pk_bf16_f32 v67, v222, v223
    v_bfe_u32 v235, s65, v232, 4
    v_mfma_f32_16x16x32_bf16 v[160:163], v[0:3], v[132:135], v[160:163]
    v_rcp_f32 v197, v196
    v_mfma_f32_16x16x32_bf16 v[216:219], v[252:255], a[136:139], v[216:219]
    v_mul_f32 v184, v184, v197
    v_mul_f32 v185, v185, v197
    v_mfma_f32_16x16x32_bf16 v[212:215], v[252:255], a[140:143], v[212:215]
    ds_read_b128 v[252:255], v224 offset:3392
    v_cvt_pk_bf16_f32 v184, v184, v185
    v_mfma_f32_16x16x16_bf16 v[160:163], v[4:5], v[136:137], v[160:163]
    v_mul_f32 v186, v186, v197
    v_mul_f32 v187, v187, v197
    v_mfma_f32_16x16x32_bf16 v[208:211], a[0:3], a[248:251], 0
    v_cvt_pk_bf16_f32 v88, v216, v217
    v_cvt_pk_bf16_f32 v89, v218, v219
    v_mfma_f32_16x16x32_bf16 v[204:207], a[4:7], a[248:251], 0
    v_cvt_pk_bf16_f32 v110, v212, v213
    v_cvt_pk_bf16_f32 v111, v214, v215
    v_mfma_f32_16x16x32_bf16 v[200:203], a[8:11], a[248:251], 0
    v_cvt_pk_bf16_f32 v185, v186, v187
    v_mul_f32 v188, v188, v197
    v_mfma_f32_16x16x32_bf16 v[220:223], a[248:251], a[72:75], 0
    v_mul_f32 v189, v189, v197
    v_cvt_pk_bf16_f32 v186, v188, v189
    v_mfma_f32_16x16x32_bf16 v[216:219], a[248:251], a[76:79], 0
    v_mul_f32 v190, v190, v197
    v_mul_f32 v191, v191, v197
    v_mfma_f32_16x16x32_bf16 v[212:215], a[248:251], a[80:83], 0
    ds_read_b128 a[248:251], v225 offset:42944
    v_cvt_pk_bf16_f32 v187, v190, v191
    v_mfma_f32_16x16x32_bf16 v[208:211], a[12:15], a[252:255], v[208:211]
    v_mul_f32 v192, v192, v197
    v_mul_f32 v193, v193, v197
    v_mfma_f32_16x16x32_bf16 v[204:207], a[16:19], a[252:255], v[204:207]
    v_cvt_pk_bf16_f32 v188, v192, v193
    v_mul_f32 v194, v194, v197
    v_mfma_f32_16x16x32_bf16 v[200:203], a[20:23], a[252:255], v[200:203]
    v_mul_f32 v195, v195, v197
    v_cvt_pk_bf16_f32 v189, v194, v195
    v_mfma_f32_16x16x32_bf16 v[220:223], a[252:255], a[84:87], v[220:223]
    ds_write_b128 v237, v[184:187] offset:6144
    v_mfma_f32_16x16x32_bf16 v[216:219], a[252:255], a[88:91], v[216:219]
    ds_write_b64 v238, v[188:189] offset:6144
    v_mfma_f32_16x16x32_bf16 v[212:215], a[252:255], a[92:95], v[212:215]
    v_mad_u32_u24 v235, v235, s40, v230
    v_max3_f32 v249, v171, v172, v173
    v_mfma_f32_16x16x32_bf16 v[208:211], a[24:27], a[236:239], v[208:211]
    v_max3_f32 v248, v248, v174, v175
    v_max3_f32 v249, v249, v144, v145
    v_mfma_f32_16x16x32_bf16 v[204:207], a[28:31], a[236:239], v[204:207]
    v_max3_f32 v248, v248, v146, v147
    v_max3_f32 v249, v249, v148, v149
    v_mfma_f32_16x16x32_bf16 v[200:203], a[32:35], a[236:239], v[200:203]
    ds_read_b128 a[252:255], v225 offset:43008
    v_max3_f32 v248, v248, v150, v151
    v_mfma_f32_16x16x32_bf16 v[220:223], a[236:239], a[96:99], v[220:223]
    v_max3_f32 v249, v249, v152, v153
    v_max3_f32 v248, v248, v154, v155
    v_mfma_f32_16x16x32_bf16 v[216:219], a[236:239], a[100:103], v[216:219]
    v_max3_f32 v249, v249, v156, v157
    v_max3_f32 v248, v248, v158, v159
    v_mfma_f32_16x16x32_bf16 v[212:215], a[236:239], a[104:107], v[212:215]
    ds_read_b128 a[236:239], v225 offset:43072
    v_max3_f32 v249, v249, v160, v161
    v_mfma_f32_16x16x32_bf16 v[208:211], a[36:39], a[240:243], v[208:211]
    v_max3_f32 v248, v248, v162, v163
    v_mfma_f32_16x16x32_bf16 v[204:207], a[40:43], a[240:243], v[204:207]
    v_mfma_f32_16x16x32_bf16 v[200:203], a[44:47], a[240:243], v[200:203]
    v_mfma_f32_16x16x32_bf16 v[220:223], a[240:243], a[108:111], v[220:223]
    v_mfma_f32_16x16x32_bf16 v[216:219], a[240:243], a[112:115], v[216:219]
    v_mfma_f32_16x16x32_bf16 v[212:215], a[240:243], a[116:119], v[212:215]
    s_waitcnt lgkmcnt(2)
    ds_read_b128 a[240:243], v225 offset:43136
    v_mfma_f32_16x16x32_bf16 v[208:211], a[48:51], a[244:247], v[208:211]
    v_mfma_f32_16x16x32_bf16 v[204:207], a[52:55], a[244:247], v[204:207]
    v_mfma_f32_16x16x32_bf16 v[200:203], a[56:59], a[244:247], v[200:203]
    v_mfma_f32_16x16x32_bf16 v[220:223], a[244:247], a[120:123], v[220:223]
    v_mfma_f32_16x16x32_bf16 v[216:219], a[244:247], a[124:127], v[216:219]
    v_mfma_f32_16x16x32_bf16 v[212:215], a[244:247], a[128:131], v[212:215]
    ds_read_b128 a[244:247], v225 offset:43200
    v_mfma_f32_16x16x32_bf16 v[208:211], a[60:63], v[252:255], v[208:211]
    v_mfma_f32_16x16x32_bf16 v[204:207], a[64:67], v[252:255], v[204:207]
    v_mfma_f32_16x16x32_bf16 v[200:203], a[68:71], v[252:255], v[200:203]
    v_mfma_f32_16x16x32_bf16 v[220:223], v[252:255], a[132:135], v[220:223]
    v_mfma_f32_16x16x32_bf16 v[216:219], v[252:255], a[136:139], v[216:219]
    v_mfma_f32_16x16x32_bf16 v[212:215], v[252:255], a[140:143], v[212:215]
    ds_read_b128 v[252:255], v225 offset:43264
    s_nop 1
    v_cvt_pk_bf16_f32 v24, v208, v209
    v_cvt_pk_bf16_f32 v25, v210, v211
    v_mfma_f32_16x16x32_bf16 v[208:211], a[144:147], a[248:251], 0
    v_cvt_pk_bf16_f32 v26, v204, v205
    v_cvt_pk_bf16_f32 v27, v206, v207
    v_mfma_f32_16x16x32_bf16 v[204:207], a[148:151], a[248:251], 0
    v_cvt_pk_bf16_f32 v28, v200, v201
    v_cvt_pk_bf16_f32 v29, v202, v203
    v_mfma_f32_16x16x32_bf16 v[164:167], v[24:27], v[132:135], v[164:167]
    v_cvt_pk_bf16_f32 v68, v220, v221
    v_cvt_pk_bf16_f32 v69, v222, v223
    v_mfma_f32_16x16x32_bf16 v[200:203], a[152:155], a[248:251], 0
    s_waitcnt lgkmcnt(1)
    v_cvt_pk_bf16_f32 v90, v216, v217
    v_cvt_pk_bf16_f32 v91, v218, v219
    v_mfma_f32_16x16x32_bf16 v[208:211], a[156:159], a[252:255], v[208:211]
    v_cvt_pk_bf16_f32 v112, v212, v213
    v_cvt_pk_bf16_f32 v113, v214, v215
    v_mfma_f32_16x16x16_bf16 v[164:167], v[28:29], v[136:137], v[164:167]
    s_waitcnt vmcnt(0) lgkmcnt(0)
    ds_read_b128 a[248:251], v226 offset:1152
    v_mfma_f32_16x16x32_bf16 v[204:207], a[160:163], a[252:255], v[204:207]
    s_barrier
    v_mfma_f32_16x16x32_bf16 v[200:203], a[164:167], a[252:255], v[200:203]
    ds_read_b128 a[252:255], v226 offset:1216
    v_mfma_f32_16x16x32_bf16 v[208:211], a[168:171], a[236:239], v[208:211]
    buffer_load_dwordx4 v246, s[4:7], s56 offen lds
    v_mfma_f32_16x16x32_bf16 v[204:207], a[172:175], a[236:239], v[204:207]
    s_add_u32 m0, s42, 0x7900
    v_max3_f32 v249, v249, v164, v165
    v_max3_f32 v248, v248, v166, v167
    v_mfma_f32_16x16x32_bf16 v[200:203], a[176:179], a[236:239], v[200:203]
    ds_read_b128 a[236:239], v226 offset:1280
    v_max_f32 v248, v248, v249
    v_mfma_f32_16x16x32_bf16 v[208:211], a[180:183], a[240:243], v[208:211]
    v_mov_b32 v249, v248
    v_mfma_f32_16x16x32_bf16 v[204:207], a[184:187], a[240:243], v[204:207]
    v_mfma_f32_16x16x32_bf16 v[200:203], a[188:191], a[240:243], v[200:203]
    ds_read_b128 a[240:243], v226 offset:1344
    v_mfma_f32_16x16x32_bf16 v[208:211], a[192:195], a[244:247], v[208:211]
    v_permlane16_swap_b32 v248, v249
    v_mfma_f32_16x16x32_bf16 v[204:207], a[196:199], a[244:247], v[204:207]
    v_max_f32 v248, v248, v249
    v_mov_b32 v249, v248
    v_mfma_f32_16x16x32_bf16 v[200:203], a[200:203], a[244:247], v[200:203]
    ds_read_b128 a[244:247], v226 offset:1408
    v_mfma_f32_16x16x32_bf16 v[208:211], a[204:207], v[252:255], v[208:211]
    buffer_load_dwordx4 v247, s[4:7], s56 offen lds
    v_mfma_f32_16x16x32_bf16 v[204:207], a[208:211], v[252:255], v[204:207]
    s_add_u32 s56, s39, 0x222000
    v_permlane32_swap_b32 v248, v249
    v_mfma_f32_16x16x32_bf16 v[200:203], a[212:215], v[252:255], v[200:203]
    s_add_u32 m0, s41, 0x9740
    ds_read_b128 v[252:255], v226 offset:1472
    v_max_f32 v248, v248, v249
    s_waitcnt lgkmcnt(3)
    v_mfma_f32_16x16x32_bf16 v[220:223], a[144:147], a[248:251], 0
    v_cvt_pk_bf16_f32 v138, v208, v209
    v_cvt_pk_bf16_f32 v139, v210, v211
    v_mfma_f32_16x16x32_bf16 v[216:219], a[148:151], a[248:251], 0
    v_cvt_pk_bf16_f32 v140, v204, v205
    v_cvt_pk_bf16_f32 v141, v206, v207
    v_mfma_f32_16x16x32_bf16 v[212:215], a[152:155], a[248:251], 0
    v_cvt_pk_bf16_f32 v142, v200, v201
    v_cvt_pk_bf16_f32 v143, v202, v203
    v_mfma_f32_16x16x32_bf16 v[220:223], a[156:159], a[252:255], v[220:223]
    ds_read_b128 a[248:251], v227 offset:6144
    v_mul_f32 v236, s37, v248
    v_mfma_f32_16x16x32_bf16 v[216:219], a[160:163], a[252:255], v[216:219]
    v_fma_f32 v168, v168, s37, -v236
    v_fma_f32 v169, v169, s37, -v236
    v_mfma_f32_16x16x32_bf16 v[212:215], a[164:167], a[252:255], v[212:215]
    ds_read_b128 a[252:255], v227 offset:6208
    v_fma_f32 v170, v170, s37, -v236
    v_mfma_f32_16x16x32_bf16 v[220:223], a[168:171], a[236:239], v[220:223]
    buffer_load_dwordx4 v246, s[4:7], s56 offen lds
    v_mfma_f32_16x16x32_bf16 v[216:219], a[172:175], a[236:239], v[216:219]
    s_add_u32 m0, s42, 0x9740
    v_fma_f32 v171, v171, s37, -v236
    v_fma_f32 v172, v172, s37, -v236
    v_mfma_f32_16x16x32_bf16 v[212:215], a[176:179], a[236:239], v[212:215]
    s_waitcnt lgkmcnt(3)
    ds_read_b128 a[236:239], v227 offset:6272
    v_fma_f32 v173, v173, s37, -v236
    v_mfma_f32_16x16x32_bf16 v[220:223], a[180:183], a[240:243], v[220:223]
    v_exp_f32 v168, v168
    v_mfma_f32_16x16x32_bf16 v[216:219], a[184:187], a[240:243], v[216:219]
    v_exp_f32 v169, v169
    v_mfma_f32_16x16x32_bf16 v[212:215], a[188:191], a[240:243], v[212:215]
    ds_read_b128 a[240:243], v227 offset:6336
    v_cvt_pk_bf16_f32 v180, v168, v169
    v_mfma_f32_16x16x32_bf16 v[220:223], a[192:195], a[244:247], v[220:223]
    v_exp_f32 v170, v170
    v_mfma_f32_16x16x32_bf16 v[216:219], a[196:199], a[244:247], v[216:219]
    v_exp_f32 v171, v171
    v_mfma_f32_16x16x32_bf16 v[212:215], a[200:203], a[244:247], v[212:215]
    s_waitcnt lgkmcnt(3)
    ds_read_b128 a[244:247], v227 offset:6400
    v_cvt_pk_bf16_f32 v181, v170, v171
    v_mfma_f32_16x16x32_bf16 v[220:223], a[204:207], v[252:255], v[220:223]
    buffer_load_dwordx4 v247, s[4:7], s56 offen lds
    v_mfma_f32_16x16x32_bf16 v[216:219], a[208:211], v[252:255], v[216:219]
    s_add_u32 s56, s39, 0x24c000
    ds_read_b128 v[168:171], v234
    v_bfe_u32 v234, s67, v233, 4
    v_mfma_f32_16x16x32_bf16 v[212:215], a[212:215], v[252:255], v[212:215]
    s_add_u32 m0, s41, 0xb580
    ds_read_b128 v[252:255], v227 offset:6464
    v_cvt_pk_bf16_f32 v132, v220, v221
    v_mfma_f32_16x16x32_bf16 v[208:211], a[0:3], a[248:251], 0
    v_cvt_pk_bf16_f32 v133, v222, v223
    v_cvt_pk_bf16_f32 v134, v216, v217
    v_mfma_f32_16x16x32_bf16 v[204:207], a[4:7], a[248:251], 0
    v_cvt_pk_bf16_f32 v135, v218, v219
    v_cvt_pk_bf16_f32 v136, v212, v213
    v_mfma_f32_16x16x32_bf16 v[200:203], a[8:11], a[248:251], 0
    v_cvt_pk_bf16_f32 v137, v214, v215
    v_mad_u32_u24 v234, v234, s40, v231
    v_mfma_f32_16x16x32_bf16 v[220:223], a[248:251], a[72:75], 0
    v_fma_f32 v174, v174, s37, -v236
    v_fma_f32 v175, v175, s37, -v236
    v_mfma_f32_16x16x32_bf16 v[216:219], a[248:251], a[76:79], 0
    v_exp_f32 v172, v172
    v_mfma_f32_16x16x32_bf16 v[212:215], a[248:251], a[80:83], 0
    s_waitcnt lgkmcnt(3)
    ds_read_b128 a[248:251], v239
    v_fma_f32 v144, v144, s37, -v236
    v_mfma_f32_16x16x32_bf16 v[208:211], a[12:15], a[252:255], v[208:211]
    s_waitcnt lgkmcnt(2)
    v_exp_f32 v173, v173
    v_mfma_f32_16x16x32_bf16 v[168:171], v[24:27], v[138:141], v[168:171]
    v_exp_f32 v174, v174
    v_mfma_f32_16x16x32_bf16 v[204:207], a[16:19], a[252:255], v[204:207]
    v_exp_f32 v175, v175
    v_mfma_f32_16x16x32_bf16 v[200:203], a[20:23], a[252:255], v[200:203]
    v_cvt_pk_bf16_f32 v182, v172, v173
    v_cvt_pk_bf16_f32 v183, v174, v175
    v_mfma_f32_16x16x16_bf16 v[168:171], v[28:29], v[142:143], v[168:171]
    ds_read_b128 v[172:175], v235
    v_bfe_u32 v235, s68, v233, 4
    v_mfma_f32_16x16x32_bf16 v[196:199], a[216:219], v[180:183], 0
    v_mad_u32_u24 v235, v235, s40, v231
    v_fma_f32 v145, v145, s37, -v236
    v_mfma_f32_16x16x32_bf16 v[184:187], v[70:73], v[180:183], 0
    v_fma_f32 v146, v146, s37, -v236
    v_fma_f32 v147, v147, s37, -v236
    v_mfma_f32_16x16x32_bf16 v[188:191], v[92:95], v[180:183], 0
    v_exp_f32 v144, v144
    v_mfma_f32_16x16x32_bf16 v[192:195], v[114:117], v[180:183], 0
    v_exp_f32 v145, v145
    v_mfma_f32_16x16x32_bf16 v[220:223], a[252:255], a[84:87], v[220:223]
    v_exp_f32 v146, v146
    v_mfma_f32_16x16x32_bf16 v[216:219], a[252:255], a[88:91], v[216:219]
    v_exp_f32 v147, v147
    v_mfma_f32_16x16x32_bf16 v[212:215], a[252:255], a[92:95], v[212:215]
    ds_read_b128 a[252:255], v240
    v_cvt_pk_bf16_f32 v176, v144, v145
    v_mfma_f32_16x16x32_bf16 v[208:211], a[24:27], a[236:239], v[208:211]
    s_waitcnt lgkmcnt(1)
    v_cvt_pk_bf16_f32 v177, v146, v147
    v_fma_f32 v148, v148, s37, -v236
    v_mfma_f32_16x16x32_bf16 v[172:175], v[30:33], v[138:141], v[172:175]
    ds_read_b128 v[144:147], v230 offset:1280
    v_fma_f32 v149, v149, s37, -v236
    v_mfma_f32_16x16x32_bf16 v[204:207], a[28:31], a[236:239], v[204:207]
    v_fma_f32 v150, v150, s37, -v236
    v_fma_f32 v151, v151, s37, -v236
    v_mfma_f32_16x16x32_bf16 v[200:203], a[32:35], a[236:239], v[200:203]
    v_exp_f32 v148, v148
    v_mfma_f32_16x16x16_bf16 v[172:175], v[34:35], v[142:143], v[172:175]
    v_exp_f32 v149, v149
    v_mfma_f32_16x16x32_bf16 v[220:223], a[236:239], a[96:99], v[220:223]
    v_exp_f32 v150, v150
    v_mfma_f32_16x16x32_bf16 v[216:219], a[236:239], a[100:103], v[216:219]
    v_exp_f32 v151, v151
    v_mfma_f32_16x16x32_bf16 v[212:215], a[236:239], a[104:107], v[212:215]
    ds_read_b128 a[236:239], v239 offset:1024
    v_cvt_pk_bf16_f32 v178, v148, v149
    v_mfma_f32_16x16x32_bf16 v[208:211], a[36:39], a[240:243], v[208:211]
    v_cvt_pk_bf16_f32 v179, v150, v151
    v_fma_f32 v152, v152, s37, -v236
    v_mfma_f32_16x16x32_bf16 v[204:207], a[40:43], a[240:243], v[204:207]
    ds_read_b128 v[148:151], v230 offset:1920
    v_fma_f32 v153, v153, s37, -v236
    v_mfma_f32_16x16x32_bf16 v[196:199], a[216:219], v[176:179], v[196:199]
    v_fma_f32 v154, v154, s37, -v236
    v_fma_f32 v155, v155, s37, -v236
    v_mfma_f32_16x16x32_bf16 v[184:187], v[74:77], v[176:179], v[184:187]
    v_exp_f32 v152, v152
    v_mfma_f32_16x16x32_bf16 v[188:191], v[96:99], v[176:179], v[188:191]
    v_exp_f32 v153, v153
    v_mfma_f32_16x16x32_bf16 v[192:195], v[118:121], v[176:179], v[192:195]
    s_waitcnt lgkmcnt(2)
    v_exp_f32 v154, v154
    v_mfma_f32_16x16x32_bf16 v[144:147], v[36:39], v[138:141], v[144:147]
    v_exp_f32 v155, v155
    v_mfma_f32_16x16x32_bf16 v[200:203], a[44:47], a[240:243], v[200:203]
    v_cvt_pk_bf16_f32 v180, v152, v153
    v_cvt_pk_bf16_f32 v181, v154, v155
    v_mfma_f32_16x16x32_bf16 v[220:223], a[240:243], a[108:111], v[220:223]
    ds_read_b128 v[152:155], v250
    v_bfe_u32 v250, s69, v233, 4
    v_mfma_f32_16x16x16_bf16 v[144:147], v[40:41], v[142:143], v[144:147]
    s_waitcnt lgkmcnt(1)
    v_mad_u32_u24 v250, v250, s40, v231
    v_fma_f32 v156, v156, s37, -v236
    v_mfma_f32_16x16x32_bf16 v[148:151], v[42:45], v[138:141], v[148:151]
    v_fma_f32 v157, v157, s37, -v236
    v_fma_f32 v158, v158, s37, -v236
    v_mfma_f32_16x16x32_bf16 v[216:219], a[240:243], a[112:115], v[216:219]
    v_fma_f32 v159, v159, s37, -v236
    v_fma_f32 v160, v160, s37, -v236
    v_mfma_f32_16x16x32_bf16 v[212:215], a[240:243], a[116:119], v[212:215]
    ds_read_b128 a[240:243], v240 offset:1024
    v_fma_f32 v161, v161, s37, -v236
    v_mfma_f32_16x16x16_bf16 v[148:151], v[46:47], v[142:143], v[148:151]
    v_exp_f32 v156, v156
    v_mfma_f32_16x16x32_bf16 v[208:211], a[48:51], a[244:247], v[208:211]
    v_exp_f32 v157, v157
    v_mfma_f32_16x16x32_bf16 v[204:207], a[52:55], a[244:247], v[204:207]
    v_exp_f32 v158, v158
    v_mfma_f32_16x16x32_bf16 v[200:203], a[56:59], a[244:247], v[200:203]
    s_waitcnt lgkmcnt(1)
    v_exp_f32 v159, v159
    v_mfma_f32_16x16x32_bf16 v[152:155], v[48:51], v[138:141], v[152:155]
    v_cvt_pk_bf16_f32 v182, v156, v157
    v_cvt_pk_bf16_f32 v183, v158, v159
    v_mfma_f32_16x16x32_bf16 v[220:223], a[244:247], a[120:123], v[220:223]
    ds_read_b128 v[156:159], v234
    v_bfe_u32 v234, s70, v233, 4
    v_mfma_f32_16x16x32_bf16 v[196:199], a[216:219], v[180:183], v[196:199]
    v_mad_u32_u24 v234, v234, s40, v231
    v_fma_f32 v162, v162, s37, -v236
    v_mfma_f32_16x16x32_bf16 v[184:187], v[78:81], v[180:183], v[184:187]
    v_fma_f32 v163, v163, s37, -v236
    v_fma_f32 v164, v164, s37, -v236
    v_mfma_f32_16x16x32_bf16 v[188:191], v[100:103], v[180:183], v[188:191]
    v_exp_f32 v160, v160
    v_mfma_f32_16x16x32_bf16 v[192:195], v[122:125], v[180:183], v[192:195]
    v_exp_f32 v161, v161
    v_mfma_f32_16x16x16_bf16 v[152:155], v[52:53], v[142:143], v[152:155]
    v_exp_f32 v162, v162
    v_mfma_f32_16x16x32_bf16 v[216:219], a[244:247], a[124:127], v[216:219]
    v_exp_f32 v163, v163
    v_mfma_f32_16x16x32_bf16 v[212:215], a[244:247], a[128:131], v[212:215]
    ds_read_b128 a[244:247], v241 offset:12288
    v_cvt_pk_bf16_f32 v176, v160, v161
    v_mfma_f32_16x16x32_bf16 v[208:211], a[60:63], v[252:255], v[208:211]
    s_waitcnt lgkmcnt(1)
    v_cvt_pk_bf16_f32 v177, v162, v163
    v_fma_f32 v165, v165, s37, -v236
    v_mfma_f32_16x16x32_bf16 v[156:159], v[54:57], v[138:141], v[156:159]
    ds_read_b128 v[160:163], v235
    v_bfe_u32 v235, s71, v233, 4
    v_mfma_f32_16x16x32_bf16 v[204:207], a[64:67], v[252:255], v[204:207]
    v_mad_u32_u24 v235, v235, s40, v231
    v_fma_f32 v166, v166, s37, -v236
    v_mfma_f32_16x16x32_bf16 v[200:203], a[68:71], v[252:255], v[200:203]
    v_cvt_pk_bf16_f32 v60, v208, v209
    v_cvt_pk_bf16_f32 v61, v210, v211
    v_mfma_f32_16x16x16_bf16 v[156:159], v[58:59], v[142:143], v[156:159]
    v_fma_f32 v167, v167, s37, -v236
    v_max3_f32 v248, v168, v169, v170
    v_mfma_f32_16x16x32_bf16 v[220:223], v[252:255], a[132:135], v[220:223]
    v_cvt_pk_bf16_f32 v62, v204, v205
    v_cvt_pk_bf16_f32 v63, v206, v207
    v_mfma_f32_16x16x32_bf16 v[216:219], v[252:255], a[136:139], v[216:219]
    v_cvt_pk_bf16_f32 v64, v200, v201
    v_cvt_pk_bf16_f32 v65, v202, v203
    v_mfma_f32_16x16x32_bf16 v[212:215], v[252:255], a[140:143], v[212:215]
    ds_read_b128 v[252:255], v241 offset:12800
    v_max3_f32 v249, v171, v172, v173
    v_mfma_f32_16x16x32_bf16 v[208:211], a[220:223], a[248:251], 0
    v_cvt_pk_bf16_f32 v86, v220, v221
    v_cvt_pk_bf16_f32 v87, v222, v223
    v_mfma_f32_16x16x32_bf16 v[200:203], a[220:223], a[252:255], 0
    s_waitcnt lgkmcnt(1)
    v_cvt_pk_bf16_f32 v108, v216, v217
    v_cvt_pk_bf16_f32 v109, v218, v219
    v_mfma_f32_16x16x32_bf16 v[160:163], v[60:63], v[138:141], v[160:163]
    v_cvt_pk_bf16_f32 v130, v212, v213
    v_cvt_pk_bf16_f32 v131, v214, v215
    v_mfma_f32_16x16x32_bf16 v[204:207], a[224:227], a[248:251], 0
    v_exp_f32 v164, v164
    v_mfma_f32_16x16x32_bf16 v[220:223], a[224:227], a[252:255], 0
    ds_read_b128 a[252:255], v242 offset:12800
    v_max3_f32 v248, v248, v174, v175
    v_mfma_f32_16x16x16_bf16 v[160:163], v[64:65], v[142:143], v[160:163]
    v_exp_f32 v165, v165
    v_mfma_f32_16x16x32_bf16 v[216:219], a[228:231], a[248:251], 0
    v_exp_f32 v166, v166
    v_mfma_f32_16x16x32_bf16 v[212:215], a[232:235], a[248:251], 0
    ds_read_b128 a[248:251], v242 offset:12288
    v_cvt_pk_bf16_f32 v178, v164, v165
    v_mfma_f32_16x16x32_bf16 v[208:211], a[244:247], a[236:239], v[208:211]
    v_exp_f32 v167, v167
    v_mfma_f32_16x16x32_bf16 v[200:203], a[244:247], a[240:243], v[200:203]
    s_waitcnt lgkmcnt(2)
    ds_read_b128 a[244:247], v241 offset:24576
    v_cvt_pk_bf16_f32 v179, v166, v167
    v_mfma_f32_16x16x32_bf16 v[204:207], v[252:255], a[236:239], v[204:207]
    ds_read_b128 v[164:167], v228 offset:640
    v_max3_f32 v249, v249, v144, v145
    v_mfma_f32_16x16x32_bf16 v[196:199], a[216:219], v[176:179], v[196:199]
    v_max3_f32 v248, v248, v146, v147
    v_max3_f32 v249, v249, v148, v149
    v_mfma_f32_16x16x32_bf16 v[184:187], v[66:69], v[176:179], v[184:187]
    v_max3_f32 v248, v248, v150, v151
    v_max3_f32 v249, v249, v152, v153
    v_mfma_f32_16x16x32_bf16 v[188:191], v[88:91], v[176:179], v[188:191]
    v_max3_f32 v248, v248, v154, v155
    v_max3_f32 v249, v249, v156, v157
    v_mfma_f32_16x16x32_bf16 v[192:195], v[110:113], v[176:179], v[192:195]
    v_rcp_f32 v197, v196
    v_mfma_f32_16x16x32_bf16 v[220:223], v[252:255], a[240:243], v[220:223]
    s_waitcnt lgkmcnt(2)
    ds_read_b128 a[240:243], v240 offset:2048
    ds_read_b128 v[252:255], v241 offset:25088
    v_mfma_f32_16x16x32_bf16 v[216:219], a[248:251], a[236:239], v[216:219]
    ds_read_b128 a[248:251], v242 offset:24576
    v_mul_f32 v184, v184, v197
    v_mfma_f32_16x16x32_bf16 v[212:215], a[252:255], a[236:239], v[212:215]
    s_waitcnt lgkmcnt(3)
    ds_read_b128 a[236:239], v239 offset:2048
    v_mul_f32 v185, v185, v197
    v_cvt_pk_bf16_f32 v184, v184, v185
    v_mul_f32 v186, v186, v197
    ds_read_b128 a[252:255], v242 offset:25088
    v_mfma_f32_16x16x32_bf16 v[164:167], v[12:15], v[132:135], v[164:167]
    v_mul_f32 v187, v187, v197
    v_cvt_pk_bf16_f32 v185, v186, v187
    v_mul_f32 v188, v188, v197
    v_mul_f32 v189, v189, v197
    v_cvt_pk_bf16_f32 v186, v188, v189
    v_mul_f32 v190, v190, v197
    v_mfma_f32_16x16x16_bf16 v[164:167], v[16:17], v[136:137], v[164:167]
    s_waitcnt lgkmcnt(4)
    v_mul_f32 v191, v191, v197
    v_cvt_pk_bf16_f32 v187, v190, v191
    v_mul_f32 v192, v192, v197
    v_mul_f32 v193, v193, v197
    v_cvt_pk_bf16_f32 v188, v192, v193
    v_mul_f32 v194, v194, v197
    v_mul_f32 v195, v195, v197
    v_mfma_f32_16x16x32_bf16 v[200:203], a[244:247], a[240:243], v[200:203]
    s_waitcnt lgkmcnt(3)
    v_cvt_pk_bf16_f32 v189, v194, v195
    v_max3_f32 v248, v248, v158, v159
    v_mfma_f32_16x16x32_bf16 v[220:223], v[252:255], a[240:243], v[220:223]
    s_waitcnt lgkmcnt(1)
    ds_read_b128 a[240:243], v240 offset:3072
    ds_write_b128 v237, v[184:187] offset:12288
    v_mfma_f32_16x16x32_bf16 v[208:211], a[244:247], a[236:239], v[208:211]
    ds_write_b64 v238, v[188:189] offset:12288
    v_mfma_f32_16x16x32_bf16 v[204:207], v[252:255], a[236:239], v[204:207]
    v_max3_f32 v249, v249, v160, v161
    v_max3_f32 v248, v248, v162, v163
    v_mfma_f32_16x16x32_bf16 v[216:219], a[248:251], a[236:239], v[216:219]
    s_waitcnt lgkmcnt(3)
    v_max_f32 v248, v248, v249
    v_mov_b32 v249, v248
    v_mfma_f32_16x16x32_bf16 v[212:215], a[252:255], a[236:239], v[212:215]
    s_nop 0
    v_permlane16_swap_b32 v248, v249
    ds_read_b128 a[236:239], v239 offset:3072
    ds_read_b128 a[244:247], v241 offset:36864
    v_max_f32 v248, v248, v249
    v_mov_b32 v249, v248
    ds_read_b128 v[252:255], v241 offset:37376
    s_nop 0
    ds_read_b128 a[248:251], v242 offset:36864
    v_permlane32_swap_b32 v248, v249
    v_max_f32 v248, v248, v249
    ds_read_b128 a[252:255], v242 offset:37376
    v_mul_f32 v236, s37, v248
    v_fma_f32 v168, v168, s37, -v236
    v_fma_f32 v169, v169, s37, -v236
    v_fma_f32 v170, v170, s37, -v236
    v_fma_f32 v171, v171, s37, -v236
    v_exp_f32 v168, v168
    v_exp_f32 v169, v169
    v_exp_f32 v170, v170
    v_exp_f32 v171, v171
    v_cvt_pk_bf16_f32 v180, v168, v169
    v_cvt_pk_bf16_f32 v181, v170, v171
    ds_read_b128 v[168:171], v229 offset:640
    v_fma_f32 v172, v172, s37, -v236
    v_fma_f32 v173, v173, s37, -v236
    v_fma_f32 v174, v174, s37, -v236
    s_waitcnt lgkmcnt(4)
    v_mfma_f32_16x16x32_bf16 v[208:211], a[244:247], a[236:239], v[208:211]
    v_fma_f32 v175, v175, s37, -v236
    v_fma_f32 v144, v144, s37, -v236
    v_mfma_f32_16x16x32_bf16 v[200:203], a[244:247], a[240:243], v[200:203]
    s_waitcnt lgkmcnt(3)
    ds_read_b128 a[244:247], v241 offset:49152
    v_fma_f32 v145, v145, s37, -v236
    v_mfma_f32_16x16x32_bf16 v[204:207], v[252:255], a[236:239], v[204:207]
    v_exp_f32 v172, v172
    v_mfma_f32_16x16x32_bf16 v[220:223], v[252:255], a[240:243], v[220:223]
    s_waitcnt lgkmcnt(3)
    ds_read_b128 a[240:243], v240 offset:4096
    ds_read_b128 v[252:255], v241 offset:49664
    v_mfma_f32_16x16x32_bf16 v[216:219], a[248:251], a[236:239], v[216:219]
    s_waitcnt lgkmcnt(4)
    ds_read_b128 a[248:251], v242 offset:49152
    v_fma_f32 v146, v146, s37, -v236
    v_mfma_f32_16x16x32_bf16 v[212:215], a[252:255], a[236:239], v[212:215]
    s_waitcnt lgkmcnt(4)
    ds_read_b128 a[236:239], v239 offset:4096
    v_exp_f32 v173, v173
    v_exp_f32 v174, v174
    ds_read_b128 a[252:255], v242 offset:49664
    v_mfma_f32_16x16x32_bf16 v[168:171], v[36:39], v[132:135], v[168:171]
    v_exp_f32 v175, v175
    v_cvt_pk_bf16_f32 v182, v172, v173
    v_cvt_pk_bf16_f32 v183, v174, v175
    ds_read_b128 v[172:175], v229 offset:1280
    v_fma_f32 v147, v147, s37, -v236
    v_mfma_f32_16x16x32_bf16 v[196:199], a[216:219], v[180:183], 0
    v_exp_f32 v144, v144
    v_mfma_f32_16x16x32_bf16 v[184:187], v[68:71], v[180:183], 0
    v_exp_f32 v145, v145
    v_mfma_f32_16x16x32_bf16 v[188:191], v[90:93], v[180:183], 0
    v_exp_f32 v146, v146
    v_mfma_f32_16x16x32_bf16 v[192:195], v[112:115], v[180:183], 0
    v_exp_f32 v147, v147
    v_mfma_f32_16x16x16_bf16 v[168:171], v[40:41], v[136:137], v[168:171]
    s_waitcnt lgkmcnt(2)
    v_cvt_pk_bf16_f32 v176, v144, v145
    v_cvt_pk_bf16_f32 v177, v146, v147
    v_mfma_f32_16x16x32_bf16 v[208:211], a[244:247], a[236:239], v[208:211]
    ds_read_b128 v[144:147], v228 offset:1280
    v_fma_f32 v148, v148, s37, -v236
    v_mfma_f32_16x16x32_bf16 v[200:203], a[244:247], a[240:243], v[200:203]
    ds_read_b128 a[244:247], v241 offset:61440
    v_fma_f32 v149, v149, s37, -v236
    v_mfma_f32_16x16x32_bf16 v[204:207], v[252:255], a[236:239], v[204:207]
    s_waitcnt lgkmcnt(2)
    v_fma_f32 v150, v150, s37, -v236
    v_fma_f32 v151, v151, s37, -v236
    v_mfma_f32_16x16x32_bf16 v[172:175], v[42:45], v[132:135], v[172:175]
    v_exp_f32 v148, v148
    v_mfma_f32_16x16x32_bf16 v[220:223], v[252:255], a[240:243], v[220:223]
    ds_read_b128 a[240:243], v240 offset:5120
    ds_read_b128 v[252:255], v241 offset:61952
    v_mfma_f32_16x16x32_bf16 v[216:219], a[248:251], a[236:239], v[216:219]
    ds_read_b128 a[248:251], v242 offset:61440
    v_fma_f32 v152, v152, s37, -v236
    v_mfma_f32_16x16x16_bf16 v[172:175], v[46:47], v[136:137], v[172:175]
    v_exp_f32 v149, v149
    v_mfma_f32_16x16x32_bf16 v[212:215], a[252:255], a[236:239], v[212:215]
    s_waitcnt lgkmcnt(4)
    ds_read_b128 a[236:239], v239 offset:5120
    ds_read_b128 a[252:255], v242 offset:61952
    v_exp_f32 v150, v150
    v_exp_f32 v151, v151
    v_mfma_f32_16x16x32_bf16 v[144:147], v[18:21], v[132:135], v[144:147]
    v_cvt_pk_bf16_f32 v178, v148, v149
    v_cvt_pk_bf16_f32 v179, v150, v151
    ds_read_b128 v[148:151], v228 offset:1920
    v_fma_f32 v153, v153, s37, -v236
    v_mfma_f32_16x16x32_bf16 v[196:199], a[216:219], v[176:179], v[196:199]
    v_fma_f32 v154, v154, s37, -v236
    v_fma_f32 v155, v155, s37, -v236
    v_mfma_f32_16x16x32_bf16 v[184:187], v[76:79], v[176:179], v[184:187]
    v_exp_f32 v152, v152
    v_mfma_f32_16x16x32_bf16 v[188:191], v[98:101], v[176:179], v[188:191]
    v_exp_f32 v153, v153
    v_mfma_f32_16x16x32_bf16 v[192:195], v[120:123], v[176:179], v[192:195]
    v_exp_f32 v154, v154
    v_mfma_f32_16x16x16_bf16 v[144:147], v[22:23], v[136:137], v[144:147]
    s_waitcnt lgkmcnt(2)
    v_exp_f32 v155, v155
    v_mfma_f32_16x16x32_bf16 v[208:211], a[244:247], a[236:239], v[208:211]
    v_cvt_pk_bf16_f32 v180, v152, v153
    v_cvt_pk_bf16_f32 v181, v154, v155
    v_mfma_f32_16x16x32_bf16 v[200:203], a[244:247], a[240:243], v[200:203]
    ds_read_b128 a[244:247], v224 offset:15616
    ds_read_b128 v[152:155], v229 offset:1920
    v_mfma_f32_16x16x32_bf16 v[204:207], v[252:255], a[236:239], v[204:207]
    s_waitcnt lgkmcnt(2)
    v_fma_f32 v156, v156, s37, -v236
    v_fma_f32 v157, v157, s37, -v236
    v_mfma_f32_16x16x32_bf16 v[148:151], v[0:3], v[132:135], v[148:151]
    v_cvt_pk_bf16_f32 v208, v208, v209
    v_cvt_pk_bf16_f32 v209, v210, v211
    v_mfma_f32_16x16x32_bf16 v[220:223], v[252:255], a[240:243], v[220:223]
    ds_read_b128 a[240:243], v224 offset:15552
    ds_read_b128 v[252:255], v224 offset:15680
    v_mfma_f32_16x16x32_bf16 v[216:219], a[248:251], a[236:239], v[216:219]
    ds_read_b128 a[248:251], v224 offset:15744
    v_cvt_pk_bf16_f32 v210, v204, v205
    v_mfma_f32_16x16x16_bf16 v[148:151], v[4:5], v[136:137], v[148:151]
    v_cvt_pk_bf16_f32 v211, v206, v207
    v_cvt_pk_bf16_f32 v200, v200, v201
    v_mfma_f32_16x16x32_bf16 v[212:215], a[252:255], a[236:239], v[212:215]
    s_waitcnt lgkmcnt(3)
    ds_read_b128 a[236:239], v224 offset:15488
    ds_read_b128 a[252:255], v224 offset:15808
    buffer_store_dwordx4 v[208:211], v243, s[20:23], s58 offen sc0 sc1
    v_cvt_pk_bf16_f32 v201, v202, v203
    v_cvt_pk_bf16_f32 v202, v220, v221
    v_cvt_pk_bf16_f32 v203, v222, v223
    v_cvt_pk_bf16_f32 v216, v216, v217
    v_cvt_pk_bf16_f32 v217, v218, v219
    v_cvt_pk_bf16_f32 v218, v212, v213
    v_cvt_pk_bf16_f32 v219, v214, v215
    v_mfma_f32_16x16x32_bf16 v[152:155], v[24:27], v[132:135], v[152:155]
    v_fma_f32 v158, v158, s37, -v236
    v_fma_f32 v159, v159, s37, -v236
    v_exp_f32 v156, v156
    v_exp_f32 v157, v157
    v_exp_f32 v158, v158
    v_exp_f32 v159, v159
    v_mfma_f32_16x16x16_bf16 v[152:155], v[28:29], v[136:137], v[152:155]
    s_waitcnt lgkmcnt(1)
    v_cvt_pk_bf16_f32 v182, v156, v157
    v_cvt_pk_bf16_f32 v183, v158, v159
    ds_read_b128 v[156:159], v229 offset:2560
    v_mfma_f32_16x16x32_bf16 v[208:211], a[0:3], a[236:239], 0
    v_fma_f32 v160, v160, s37, -v236
    v_fma_f32 v161, v161, s37, -v236
    v_mfma_f32_16x16x32_bf16 v[196:199], a[216:219], v[180:183], v[196:199]
    v_fma_f32 v162, v162, s37, -v236
    v_fma_f32 v163, v163, s37, -v236
    v_mfma_f32_16x16x32_bf16 v[184:187], v[82:85], v[180:183], v[184:187]
    v_exp_f32 v160, v160
    v_mfma_f32_16x16x32_bf16 v[188:191], v[104:107], v[180:183], v[188:191]
    v_exp_f32 v161, v161
    v_mfma_f32_16x16x32_bf16 v[192:195], v[126:129], v[180:183], v[192:195]
    buffer_store_dwordx4 v[200:203], v245, s[20:23], s58 offen sc0 sc1
    v_mfma_f32_16x16x32_bf16 v[204:207], a[4:7], a[236:239], 0
    v_exp_f32 v162, v162
    v_mfma_f32_16x16x32_bf16 v[200:203], a[8:11], a[236:239], 0
    v_exp_f32 v163, v163
    v_mfma_f32_16x16x32_bf16 v[220:223], a[236:239], a[72:75], 0
    v_cvt_pk_bf16_f32 v176, v160, v161
    v_cvt_pk_bf16_f32 v177, v162, v163
    v_mfma_f32_16x16x32_bf16 v[212:215], a[236:239], a[80:83], 0
    ds_read_b128 v[160:163], v228 offset:2560
    v_max3_f32 v248, v164, v165, v166
    v_mfma_f32_16x16x16_bf16 v[196:199], a[216:217], v[176:177], v[196:199]
    v_max3_f32 v249, v167, v168, v169
    v_max3_f32 v248, v248, v170, v171
    v_mfma_f32_16x16x16_bf16 v[184:187], v[86:87], v[176:177], v[184:187]
    v_max3_f32 v249, v249, v172, v173
    v_max3_f32 v248, v248, v174, v175
    v_mfma_f32_16x16x16_bf16 v[188:191], v[108:109], v[176:177], v[188:191]
    v_max3_f32 v249, v249, v144, v145
    v_max3_f32 v248, v248, v146, v147
    v_mfma_f32_16x16x16_bf16 v[192:195], v[130:131], v[176:177], v[192:195]
    v_rcp_f32 v197, v196
    v_mfma_f32_16x16x32_bf16 v[208:211], a[12:15], a[240:243], v[208:211]
    v_mul_f32 v184, v184, v197
    v_mul_f32 v185, v185, v197
    v_mfma_f32_16x16x32_bf16 v[204:207], a[16:19], a[240:243], v[204:207]
    v_cvt_pk_bf16_f32 v184, v184, v185
    v_mul_f32 v186, v186, v197
    v_mfma_f32_16x16x32_bf16 v[200:203], a[20:23], a[240:243], v[200:203]
    v_mul_f32 v187, v187, v197
    v_cvt_pk_bf16_f32 v185, v186, v187
    v_mfma_f32_16x16x32_bf16 v[220:223], a[240:243], a[84:87], v[220:223]
    buffer_store_dwordx4 v[216:219], v244, s[20:23], s58 offen sc0 sc1
    v_mfma_f32_16x16x32_bf16 v[212:215], a[240:243], a[92:95], v[212:215]
    s_add_u32 s58, s51, 0x54000
    v_mul_f32 v188, v188, v197
    v_mul_f32 v189, v189, v197
    v_mfma_f32_16x16x32_bf16 v[216:219], a[236:239], a[76:79], 0
    ds_read_b128 a[236:239], v224 offset:18560
    v_cvt_pk_bf16_f32 v186, v188, v189
    v_mfma_f32_16x16x32_bf16 v[216:219], a[240:243], a[88:91], v[216:219]
    ds_read_b128 a[240:243], v224 offset:18624
    v_mul_f32 v190, v190, v197
    v_mfma_f32_16x16x32_bf16 v[208:211], a[24:27], a[244:247], v[208:211]
    v_mul_f32 v191, v191, v197
    v_cvt_pk_bf16_f32 v187, v190, v191
    v_mfma_f32_16x16x32_bf16 v[204:207], a[28:31], a[244:247], v[204:207]
    v_mul_f32 v192, v192, v197
    v_mul_f32 v193, v193, v197
    v_mfma_f32_16x16x32_bf16 v[200:203], a[32:35], a[244:247], v[200:203]
    v_cvt_pk_bf16_f32 v188, v192, v193
    v_mul_f32 v194, v194, v197
    v_mfma_f32_16x16x32_bf16 v[220:223], a[244:247], a[96:99], v[220:223]
    v_mul_f32 v195, v195, v197
    v_cvt_pk_bf16_f32 v189, v194, v195
    v_mfma_f32_16x16x32_bf16 v[216:219], a[244:247], a[100:103], v[216:219]
    ds_write_b128 v237, v[184:187] offset:18432
    v_mfma_f32_16x16x32_bf16 v[212:215], a[244:247], a[104:107], v[212:215]
    ds_write_b64 v238, v[188:189] offset:18432
    v_mfma_f32_16x16x32_bf16 v[208:211], a[36:39], v[252:255], v[208:211]
    v_max3_f32 v249, v249, v148, v149
    v_max3_f32 v248, v248, v150, v151
    v_mfma_f32_16x16x32_bf16 v[204:207], a[40:43], v[252:255], v[204:207]
    v_max3_f32 v249, v249, v152, v153
    v_max3_f32 v248, v248, v154, v155
    v_mfma_f32_16x16x32_bf16 v[200:203], a[44:47], v[252:255], v[200:203]
    v_mfma_f32_16x16x32_bf16 v[220:223], v[252:255], a[108:111], v[220:223]
    ds_read_b128 a[244:247], v224 offset:18688
    v_mfma_f32_16x16x32_bf16 v[216:219], v[252:255], a[112:115], v[216:219]
    v_mfma_f32_16x16x32_bf16 v[212:215], v[252:255], a[116:119], v[212:215]
    ds_read_b128 v[252:255], v224 offset:18752
    v_mfma_f32_16x16x32_bf16 v[208:211], a[48:51], a[248:251], v[208:211]
    v_mfma_f32_16x16x32_bf16 v[204:207], a[52:55], a[248:251], v[204:207]
    v_mfma_f32_16x16x32_bf16 v[200:203], a[56:59], a[248:251], v[200:203]
    v_mfma_f32_16x16x32_bf16 v[220:223], a[248:251], a[120:123], v[220:223]
    v_mfma_f32_16x16x32_bf16 v[216:219], a[248:251], a[124:127], v[216:219]
    v_mfma_f32_16x16x32_bf16 v[212:215], a[248:251], a[128:131], v[212:215]
    s_waitcnt lgkmcnt(3)
    ds_read_b128 a[248:251], v224 offset:18816
    v_mfma_f32_16x16x32_bf16 v[208:211], a[60:63], a[252:255], v[208:211]
    v_mfma_f32_16x16x32_bf16 v[204:207], a[64:67], a[252:255], v[204:207]
    v_mfma_f32_16x16x32_bf16 v[200:203], a[68:71], a[252:255], v[200:203]
    v_mfma_f32_16x16x32_bf16 v[220:223], a[252:255], a[132:135], v[220:223]
    v_mfma_f32_16x16x32_bf16 v[216:219], a[252:255], a[136:139], v[216:219]
    v_mfma_f32_16x16x32_bf16 v[212:215], a[252:255], a[140:143], v[212:215]
    ds_read_b128 a[252:255], v224 offset:18880
    s_nop 1
    v_cvt_pk_bf16_f32 v6, v208, v209
    v_cvt_pk_bf16_f32 v7, v210, v211
    v_mfma_f32_16x16x32_bf16 v[208:211], a[0:3], a[236:239], 0
    v_cvt_pk_bf16_f32 v8, v204, v205
    v_cvt_pk_bf16_f32 v9, v206, v207
    v_mfma_f32_16x16x32_bf16 v[204:207], a[4:7], a[236:239], 0
    v_cvt_pk_bf16_f32 v10, v200, v201
    v_cvt_pk_bf16_f32 v11, v202, v203
    v_mfma_f32_16x16x32_bf16 v[160:163], v[6:9], v[132:135], v[160:163]
    v_cvt_pk_bf16_f32 v72, v220, v221
    v_cvt_pk_bf16_f32 v73, v222, v223
    v_mfma_f32_16x16x32_bf16 v[200:203], a[8:11], a[236:239], 0
    v_cvt_pk_bf16_f32 v94, v216, v217
    v_cvt_pk_bf16_f32 v95, v218, v219
    v_mfma_f32_16x16x32_bf16 v[220:223], a[236:239], a[72:75], 0
    v_cvt_pk_bf16_f32 v116, v212, v213
    v_cvt_pk_bf16_f32 v117, v214, v215
    v_mfma_f32_16x16x16_bf16 v[160:163], v[10:11], v[136:137], v[160:163]
    v_mfma_f32_16x16x32_bf16 v[216:219], a[236:239], a[76:79], 0
    v_mfma_f32_16x16x32_bf16 v[212:215], a[236:239], a[80:83], 0
    ds_read_b128 a[236:239], v226 offset:4224
    v_mfma_f32_16x16x32_bf16 v[208:211], a[12:15], a[240:243], v[208:211]
    v_mfma_f32_16x16x32_bf16 v[204:207], a[16:19], a[240:243], v[204:207]
    v_mfma_f32_16x16x32_bf16 v[200:203], a[20:23], a[240:243], v[200:203]
    v_mfma_f32_16x16x32_bf16 v[220:223], a[240:243], a[84:87], v[220:223]
    v_mfma_f32_16x16x32_bf16 v[216:219], a[240:243], a[88:91], v[216:219]
    v_mfma_f32_16x16x32_bf16 v[212:215], a[240:243], a[92:95], v[212:215]
    s_waitcnt lgkmcnt(1)
    ds_read_b128 a[240:243], v226 offset:4288
    v_mfma_f32_16x16x32_bf16 v[208:211], a[24:27], a[244:247], v[208:211]
    v_mfma_f32_16x16x32_bf16 v[204:207], a[28:31], a[244:247], v[204:207]
    v_mfma_f32_16x16x32_bf16 v[200:203], a[32:35], a[244:247], v[200:203]
    v_mfma_f32_16x16x32_bf16 v[220:223], a[244:247], a[96:99], v[220:223]
    v_mfma_f32_16x16x32_bf16 v[216:219], a[244:247], a[100:103], v[216:219]
    v_mfma_f32_16x16x32_bf16 v[212:215], a[244:247], a[104:107], v[212:215]
    ds_read_b128 a[244:247], v226 offset:4352
    v_mfma_f32_16x16x32_bf16 v[208:211], a[36:39], v[252:255], v[208:211]
    v_mfma_f32_16x16x32_bf16 v[204:207], a[40:43], v[252:255], v[204:207]
    v_mfma_f32_16x16x32_bf16 v[200:203], a[44:47], v[252:255], v[200:203]
    v_mfma_f32_16x16x32_bf16 v[220:223], v[252:255], a[108:111], v[220:223]
    v_mfma_f32_16x16x32_bf16 v[216:219], v[252:255], a[112:115], v[216:219]
    v_mfma_f32_16x16x32_bf16 v[212:215], v[252:255], a[116:119], v[212:215]
    ds_read_b128 v[252:255], v226 offset:4416
    v_mfma_f32_16x16x32_bf16 v[208:211], a[48:51], a[248:251], v[208:211]
    v_mfma_f32_16x16x32_bf16 v[204:207], a[52:55], a[248:251], v[204:207]
    v_mfma_f32_16x16x32_bf16 v[200:203], a[56:59], a[248:251], v[200:203]
    v_mfma_f32_16x16x32_bf16 v[220:223], a[248:251], a[120:123], v[220:223]
    v_mfma_f32_16x16x32_bf16 v[216:219], a[248:251], a[124:127], v[216:219]
    v_mfma_f32_16x16x32_bf16 v[212:215], a[248:251], a[128:131], v[212:215]
    ds_read_b128 a[248:251], v226 offset:4480
    v_mfma_f32_16x16x32_bf16 v[208:211], a[60:63], a[252:255], v[208:211]
    v_mfma_f32_16x16x32_bf16 v[204:207], a[64:67], a[252:255], v[204:207]
    v_mfma_f32_16x16x32_bf16 v[200:203], a[68:71], a[252:255], v[200:203]
    v_mfma_f32_16x16x32_bf16 v[220:223], a[252:255], a[132:135], v[220:223]
    v_mfma_f32_16x16x32_bf16 v[216:219], a[252:255], a[136:139], v[216:219]
    v_mfma_f32_16x16x32_bf16 v[212:215], a[252:255], a[140:143], v[212:215]
    s_waitcnt lgkmcnt(1)
    ds_read_b128 a[252:255], v226 offset:4544
    s_nop 1
    v_cvt_pk_bf16_f32 v30, v208, v209
    v_cvt_pk_bf16_f32 v31, v210, v211
    v_mfma_f32_16x16x32_bf16 v[208:211], a[144:147], a[236:239], 0
    v_cvt_pk_bf16_f32 v32, v204, v205
    v_cvt_pk_bf16_f32 v33, v206, v207
    v_mfma_f32_16x16x32_bf16 v[204:207], a[148:151], a[236:239], 0
    v_cvt_pk_bf16_f32 v34, v200, v201
    v_cvt_pk_bf16_f32 v35, v202, v203
    v_mfma_f32_16x16x32_bf16 v[156:159], v[30:33], v[132:135], v[156:159]
    v_cvt_pk_bf16_f32 v70, v220, v221
    v_cvt_pk_bf16_f32 v71, v222, v223
    v_mfma_f32_16x16x32_bf16 v[200:203], a[152:155], a[236:239], 0
    v_cvt_pk_bf16_f32 v92, v216, v217
    v_cvt_pk_bf16_f32 v93, v218, v219
    v_mfma_f32_16x16x32_bf16 v[208:211], a[156:159], a[240:243], v[208:211]
    v_cvt_pk_bf16_f32 v114, v212, v213
    v_cvt_pk_bf16_f32 v115, v214, v215
    v_mfma_f32_16x16x16_bf16 v[156:159], v[34:35], v[136:137], v[156:159]
    s_waitcnt vmcnt(3) lgkmcnt(0)
    ds_read_b128 a[236:239], v225 offset:8896
    v_mfma_f32_16x16x32_bf16 v[204:207], a[160:163], a[240:243], v[204:207]
    s_barrier
    v_mfma_f32_16x16x32_bf16 v[200:203], a[164:167], a[240:243], v[200:203]
    ds_read_b128 a[240:243], v225 offset:8960
    v_mfma_f32_16x16x32_bf16 v[208:211], a[168:171], a[244:247], v[208:211]
    buffer_load_dwordx4 v246, s[4:7], s56 offen lds
    v_mfma_f32_16x16x32_bf16 v[204:207], a[172:175], a[244:247], v[204:207]
    s_add_u32 m0, s42, 0xb580
    v_max3_f32 v249, v249, v156, v157
    v_max3_f32 v248, v248, v158, v159
    v_mfma_f32_16x16x32_bf16 v[200:203], a[176:179], a[244:247], v[200:203]
    ds_read_b128 a[244:247], v225 offset:9024
    v_max3_f32 v249, v249, v160, v161
    v_mfma_f32_16x16x32_bf16 v[208:211], a[180:183], v[252:255], v[208:211]
    v_max3_f32 v248, v248, v162, v163
    v_max_f32 v248, v248, v249
    v_mfma_f32_16x16x32_bf16 v[204:207], a[184:187], v[252:255], v[204:207]
    v_mov_b32 v249, v248
    v_mfma_f32_16x16x32_bf16 v[200:203], a[188:191], v[252:255], v[200:203]
    ds_read_b128 v[252:255], v225 offset:9088
    v_mfma_f32_16x16x32_bf16 v[208:211], a[192:195], a[248:251], v[208:211]
    v_permlane16_swap_b32 v248, v249
    v_mfma_f32_16x16x32_bf16 v[204:207], a[196:199], a[248:251], v[204:207]
    v_max_f32 v248, v248, v249
    v_mov_b32 v249, v248
    v_mfma_f32_16x16x32_bf16 v[200:203], a[200:203], a[248:251], v[200:203]
    ds_read_b128 a[248:251], v225 offset:9152
    v_mfma_f32_16x16x32_bf16 v[208:211], a[204:207], a[252:255], v[208:211]
    buffer_load_dwordx4 v247, s[4:7], s56 offen lds
    v_mfma_f32_16x16x32_bf16 v[204:207], a[208:211], a[252:255], v[204:207]
    s_add_u32 s56, s39, 0x276000
    v_permlane32_swap_b32 v248, v249
    v_mfma_f32_16x16x32_bf16 v[200:203], a[212:215], a[252:255], v[200:203]
    s_add_u32 m0, s41, 0xd3c0
    ds_read_b128 a[252:255], v225 offset:9216
    v_max_f32 v248, v248, v249
    s_waitcnt lgkmcnt(3)
    v_mfma_f32_16x16x32_bf16 v[220:223], a[144:147], a[236:239], 0
    v_cvt_pk_bf16_f32 v138, v208, v209
    v_cvt_pk_bf16_f32 v139, v210, v211
    v_mfma_f32_16x16x32_bf16 v[216:219], a[148:151], a[236:239], 0
    v_cvt_pk_bf16_f32 v140, v204, v205
    v_cvt_pk_bf16_f32 v141, v206, v207
    v_mfma_f32_16x16x32_bf16 v[212:215], a[152:155], a[236:239], 0
    v_cvt_pk_bf16_f32 v142, v200, v201
    v_cvt_pk_bf16_f32 v143, v202, v203
    v_mfma_f32_16x16x32_bf16 v[220:223], a[156:159], a[240:243], v[220:223]
    ds_read_b128 a[236:239], v239 offset:12288
    v_mul_f32 v236, s37, v248
    v_mfma_f32_16x16x32_bf16 v[216:219], a[160:163], a[240:243], v[216:219]
    v_fma_f32 v164, v164, s37, -v236
    v_fma_f32 v165, v165, s37, -v236
    v_mfma_f32_16x16x32_bf16 v[212:215], a[164:167], a[240:243], v[212:215]
    buffer_load_dwordx4 v246, s[4:7], s56 offen lds
    v_mfma_f32_16x16x32_bf16 v[220:223], a[168:171], a[244:247], v[220:223]
    s_add_u32 m0, s42, 0xd3c0
    ds_read_b128 a[240:243], v240 offset:12288
    v_fma_f32 v166, v166, s37, -v236
    v_mfma_f32_16x16x32_bf16 v[216:219], a[172:175], a[244:247], v[216:219]
    v_fma_f32 v167, v167, s37, -v236
    v_fma_f32 v168, v168, s37, -v236
    v_mfma_f32_16x16x32_bf16 v[212:215], a[176:179], a[244:247], v[212:215]
    s_waitcnt lgkmcnt(3)
    ds_read_b128 a[244:247], v239 offset:13312
    v_fma_f32 v169, v169, s37, -v236
    v_mfma_f32_16x16x32_bf16 v[220:223], a[180:183], v[252:255], v[220:223]
    v_exp_f32 v164, v164
    v_mfma_f32_16x16x32_bf16 v[216:219], a[184:187], v[252:255], v[216:219]
    v_exp_f32 v165, v165
    v_mfma_f32_16x16x32_bf16 v[212:215], a[188:191], v[252:255], v[212:215]
    ds_read_b128 v[252:255], v240 offset:13312
    v_cvt_pk_bf16_f32 v180, v164, v165
    v_mfma_f32_16x16x32_bf16 v[220:223], a[192:195], a[248:251], v[220:223]
    v_exp_f32 v166, v166
    v_mfma_f32_16x16x32_bf16 v[216:219], a[196:199], a[248:251], v[216:219]
    s_waitcnt lgkmcnt(3)
    buffer_load_dwordx4 v247, s[4:7], s56 offen lds
    v_mfma_f32_16x16x32_bf16 v[212:215], a[200:203], a[248:251], v[212:215]
    s_add_u32 s56, s39, 0x2a0000
    ds_read_b128 a[248:251], v241 offset:12288
    v_fma_f32 v170, v170, s37, -v236
    v_mfma_f32_16x16x32_bf16 v[220:223], a[204:207], a[252:255], v[220:223]
    s_add_u32 m0, s41, 0
    v_exp_f32 v167, v167
    v_mfma_f32_16x16x32_bf16 v[216:219], a[208:211], a[252:255], v[216:219]
    v_cvt_pk_bf16_f32 v181, v166, v167
    v_fma_f32 v171, v171, s37, -v236
    v_mfma_f32_16x16x32_bf16 v[212:215], a[212:215], a[252:255], v[212:215]
    ds_read_b128 a[252:255], v241 offset:12800
    ds_read_b128 v[164:167], v230 offset:640
    v_mfma_f32_16x16x32_bf16 v[208:211], a[220:223], a[236:239], 0
    s_waitcnt lgkmcnt(4)
    v_cvt_pk_bf16_f32 v132, v220, v221
    v_cvt_pk_bf16_f32 v133, v222, v223
    v_mfma_f32_16x16x32_bf16 v[200:203], a[220:223], a[240:243], 0
    v_cvt_pk_bf16_f32 v134, v216, v217
    v_cvt_pk_bf16_f32 v135, v218, v219
    v_mfma_f32_16x16x32_bf16 v[204:207], a[224:227], a[236:239], 0
    v_cvt_pk_bf16_f32 v136, v212, v213
    v_cvt_pk_bf16_f32 v137, v214, v215
    v_mfma_f32_16x16x32_bf16 v[220:223], a[224:227], a[240:243], 0
    ds_read_b128 a[240:243], v242 offset:12800
    v_fma_f32 v172, v172, s37, -v236
    v_mfma_f32_16x16x32_bf16 v[216:219], a[228:231], a[236:239], 0
    v_exp_f32 v168, v168
    v_mfma_f32_16x16x32_bf16 v[212:215], a[232:235], a[236:239], 0
    s_waitcnt lgkmcnt(3)
    ds_read_b128 a[236:239], v242 offset:12288
    v_fma_f32 v173, v173, s37, -v236
    v_mfma_f32_16x16x32_bf16 v[208:211], a[248:251], a[244:247], v[208:211]
    v_exp_f32 v169, v169
    v_mfma_f32_16x16x32_bf16 v[200:203], a[248:251], v[252:255], v[200:203]
    s_waitcnt lgkmcnt(3)
    ds_read_b128 a[248:251], v241 offset:24576
    v_cvt_pk_bf16_f32 v182, v168, v169
    v_mfma_f32_16x16x32_bf16 v[204:207], a[252:255], a[244:247], v[204:207]
    s_waitcnt lgkmcnt(3)
    v_exp_f32 v170, v170
    v_mfma_f32_16x16x32_bf16 v[164:167], v[36:39], v[138:141], v[164:167]
    v_exp_f32 v171, v171
    v_mfma_f32_16x16x32_bf16 v[220:223], a[252:255], v[252:255], v[220:223]
    ds_read_b128 v[252:255], v240 offset:14336
    ds_read_b128 a[252:255], v241 offset:25088
    v_cvt_pk_bf16_f32 v183, v170, v171
    v_fma_f32 v174, v174, s37, -v236
    v_mfma_f32_16x16x16_bf16 v[164:167], v[40:41], v[142:143], v[164:167]
    ds_read_b128 v[168:171], v230 offset:1280
    v_fma_f32 v175, v175, s37, -v236
    v_mfma_f32_16x16x32_bf16 v[196:199], a[216:219], v[180:183], 0
    v_exp_f32 v172, v172
    v_mfma_f32_16x16x32_bf16 v[184:187], v[74:77], v[180:183], 0
    v_exp_f32 v173, v173
    v_mfma_f32_16x16x32_bf16 v[188:191], v[96:99], v[180:183], 0
    v_exp_f32 v174, v174
    v_mfma_f32_16x16x32_bf16 v[192:195], v[118:121], v[180:183], 0
    s_waitcnt lgkmcnt(4)
    v_exp_f32 v175, v175
    v_mfma_f32_16x16x32_bf16 v[216:219], a[236:239], a[244:247], v[216:219]
    ds_read_b128 a[236:239], v242 offset:24576
    v_cvt_pk_bf16_f32 v176, v172, v173
    v_mfma_f32_16x16x32_bf16 v[212:215], a[240:243], a[244:247], v[212:215]
    s_waitcnt lgkmcnt(3)
    ds_read_b128 a[244:247], v239 offset:14336
    ds_read_b128 a[240:243], v242 offset:25088
    v_mfma_f32_16x16x32_bf16 v[200:203], a[248:251], v[252:255], v[200:203]
    s_waitcnt lgkmcnt(4)
    v_cvt_pk_bf16_f32 v177, v174, v175
    v_fma_f32 v144, v144, s37, -v236
    v_mfma_f32_16x16x32_bf16 v[220:223], a[252:255], v[252:255], v[220:223]
    s_waitcnt lgkmcnt(3)
    ds_read_b128 v[252:255], v240 offset:15360
    ds_read_b128 v[172:175], v230 offset:1920
    v_fma_f32 v145, v145, s37, -v236
    v_fma_f32 v146, v146, s37, -v236
    v_mfma_f32_16x16x32_bf16 v[168:171], v[42:45], v[138:141], v[168:171]
    v_fma_f32 v147, v147, s37, -v236
    v_fma_f32 v148, v148, s37, -v236
    v_exp_f32 v144, v144
    v_exp_f32 v145, v145
    v_exp_f32 v146, v146
    v_exp_f32 v147, v147
    v_mfma_f32_16x16x16_bf16 v[168:171], v[46:47], v[142:143], v[168:171]
    v_cvt_pk_bf16_f32 v178, v144, v145
    v_cvt_pk_bf16_f32 v179, v146, v147
    ds_read_b128 v[144:147], v230 offset:2560
    v_fma_f32 v149, v149, s37, -v236
    v_mfma_f32_16x16x32_bf16 v[196:199], a[216:219], v[176:179], v[196:199]
    v_fma_f32 v150, v150, s37, -v236
    v_fma_f32 v151, v151, s37, -v236
    v_mfma_f32_16x16x32_bf16 v[184:187], v[78:81], v[176:179], v[184:187]
    v_exp_f32 v148, v148
    v_mfma_f32_16x16x32_bf16 v[188:191], v[100:103], v[176:179], v[188:191]
    v_exp_f32 v149, v149
    v_mfma_f32_16x16x32_bf16 v[192:195], v[122:125], v[176:179], v[192:195]
    s_waitcnt lgkmcnt(1)
    v_exp_f32 v150, v150
    v_mfma_f32_16x16x32_bf16 v[172:175], v[24:27], v[138:141], v[172:175]
    v_exp_f32 v151, v151
    v_mfma_f32_16x16x32_bf16 v[208:211], a[248:251], a[244:247], v[208:211]
    ds_read_b128 a[248:251], v241 offset:36864
    v_cvt_pk_bf16_f32 v180, v148, v149
    v_mfma_f32_16x16x32_bf16 v[204:207], a[252:255], a[244:247], v[204:207]
    ds_read_b128 a[252:255], v241 offset:37376
    v_cvt_pk_bf16_f32 v181, v150, v151
    v_mfma_f32_16x16x16_bf16 v[172:175], v[28:29], v[142:143], v[172:175]
    s_waitcnt lgkmcnt(2)
    ds_read_b128 v[148:151], v250
    v_bfe_u32 v250, s67, v233, 4
    v_mfma_f32_16x16x32_bf16 v[144:147], v[30:33], v[138:141], v[144:147]
    v_mad_u32_u24 v250, v250, s40, v231
    v_fma_f32 v152, v152, s37, -v236
    v_mfma_f32_16x16x32_bf16 v[216:219], a[236:239], a[244:247], v[216:219]
    ds_read_b128 a[236:239], v242 offset:36864
    v_fma_f32 v153, v153, s37, -v236
    v_mfma_f32_16x16x32_bf16 v[212:215], a[240:243], a[244:247], v[212:215]
    ds_read_b128 a[244:247], v239 offset:15360
    ds_read_b128 a[240:243], v242 offset:37376
    v_mfma_f32_16x16x16_bf16 v[144:147], v[34:35], v[142:143], v[144:147]
    s_waitcnt lgkmcnt(5)
    v_fma_f32 v154, v154, s37, -v236
    v_fma_f32 v155, v155, s37, -v236
    v_exp_f32 v152, v152
    v_exp_f32 v153, v153
    v_exp_f32 v154, v154
    v_mfma_f32_16x16x32_bf16 v[200:203], a[248:251], v[252:255], v[200:203]
    s_waitcnt lgkmcnt(4)
    v_exp_f32 v155, v155
    v_mfma_f32_16x16x32_bf16 v[220:223], a[252:255], v[252:255], v[220:223]
    s_waitcnt lgkmcnt(3)
    ds_read_b128 v[252:255], v240 offset:16384
    v_cvt_pk_bf16_f32 v182, v152, v153
    v_cvt_pk_bf16_f32 v183, v154, v155
    ds_read_b128 v[152:155], v234
    v_mfma_f32_16x16x32_bf16 v[148:151], v[54:57], v[138:141], v[148:151]
    v_bfe_u32 v234, s72, v233, 4
    v_mad_u32_u24 v234, v234, s40, v231
    v_mfma_f32_16x16x32_bf16 v[196:199], a[216:219], v[180:183], v[196:199]
    v_fma_f32 v156, v156, s37, -v236
    v_fma_f32 v157, v157, s37, -v236
    v_mfma_f32_16x16x32_bf16 v[184:187], v[66:69], v[180:183], v[184:187]
    v_fma_f32 v158, v158, s37, -v236
    v_fma_f32 v159, v159, s37, -v236
    v_mfma_f32_16x16x32_bf16 v[188:191], v[88:91], v[180:183], v[188:191]
    v_exp_f32 v156, v156
    v_mfma_f32_16x16x32_bf16 v[192:195], v[110:113], v[180:183], v[192:195]
    v_exp_f32 v157, v157
    v_mfma_f32_16x16x16_bf16 v[148:151], v[58:59], v[142:143], v[148:151]
    s_waitcnt lgkmcnt(2)
    v_exp_f32 v158, v158
    v_mfma_f32_16x16x32_bf16 v[208:211], a[248:251], a[244:247], v[208:211]
    ds_read_b128 a[248:251], v241 offset:49152
    v_cvt_pk_bf16_f32 v176, v156, v157
    v_mfma_f32_16x16x32_bf16 v[204:207], a[252:255], a[244:247], v[204:207]
    ds_read_b128 a[252:255], v241 offset:49664
    v_fma_f32 v160, v160, s37, -v236
    v_mfma_f32_16x16x32_bf16 v[216:219], a[236:239], a[244:247], v[216:219]
    s_waitcnt lgkmcnt(2)
    ds_read_b128 a[236:239], v242 offset:49152
    v_fma_f32 v161, v161, s37, -v236
    v_mfma_f32_16x16x32_bf16 v[152:155], v[60:63], v[138:141], v[152:155]
    v_exp_f32 v159, v159
    v_mfma_f32_16x16x32_bf16 v[212:215], a[240:243], a[244:247], v[212:215]
    ds_read_b128 a[244:247], v239 offset:16384
    ds_read_b128 a[240:243], v242 offset:49664
    v_cvt_pk_bf16_f32 v177, v158, v159
    v_fma_f32 v162, v162, s37, -v236
    v_mfma_f32_16x16x16_bf16 v[152:155], v[64:65], v[142:143], v[152:155]
    s_waitcnt lgkmcnt(4)
    ds_read_b128 v[156:159], v229 offset:640
    v_fma_f32 v163, v163, s37, -v236
    v_exp_f32 v160, v160
    v_exp_f32 v161, v161
    v_exp_f32 v162, v162
    v_exp_f32 v163, v163
    v_mfma_f32_16x16x32_bf16 v[200:203], a[248:251], v[252:255], v[200:203]
    s_waitcnt lgkmcnt(4)
    v_cvt_pk_bf16_f32 v178, v160, v161
    v_cvt_pk_bf16_f32 v179, v162, v163
    v_mfma_f32_16x16x32_bf16 v[220:223], a[252:255], v[252:255], v[220:223]
    ds_read_b128 v[252:255], v240 offset:17408
    ds_read_b128 v[160:163], v228 offset:640
    v_mfma_f32_16x16x32_bf16 v[196:199], a[216:219], v[176:179], v[196:199]
    v_max3_f32 v248, v164, v165, v166
    v_max3_f32 v249, v167, v168, v169
    v_mfma_f32_16x16x32_bf16 v[184:187], v[70:73], v[176:179], v[184:187]
    v_max3_f32 v248, v248, v170, v171
    v_max3_f32 v249, v249, v172, v173
    v_mfma_f32_16x16x32_bf16 v[188:191], v[92:95], v[176:179], v[188:191]
    v_max3_f32 v248, v248, v174, v175
    v_max3_f32 v249, v249, v144, v145
    v_mfma_f32_16x16x32_bf16 v[192:195], v[114:117], v[176:179], v[192:195]
    s_waitcnt lgkmcnt(4)
    v_rcp_f32 v197, v196
    v_mfma_f32_16x16x32_bf16 v[208:211], a[248:251], a[244:247], v[208:211]
    s_waitcnt lgkmcnt(2)
    ds_read_b128 a[248:251], v241 offset:61440
    v_mul_f32 v184, v184, v197
    v_mfma_f32_16x16x32_bf16 v[156:159], v[42:45], v[132:135], v[156:159]
    v_mul_f32 v185, v185, v197
    v_cvt_pk_bf16_f32 v184, v184, v185
    v_mfma_f32_16x16x32_bf16 v[204:207], a[252:255], a[244:247], v[204:207]
    ds_read_b128 a[252:255], v241 offset:61952
    v_mul_f32 v186, v186, v197
    v_mfma_f32_16x16x32_bf16 v[216:219], a[236:239], a[244:247], v[216:219]
    ds_read_b128 a[236:239], v242 offset:61440
    v_mul_f32 v187, v187, v197
    v_mfma_f32_16x16x16_bf16 v[156:159], v[46:47], v[136:137], v[156:159]
    s_waitcnt lgkmcnt(3)
    v_cvt_pk_bf16_f32 v185, v186, v187
    v_mul_f32 v188, v188, v197
    v_mfma_f32_16x16x32_bf16 v[160:163], v[18:21], v[132:135], v[160:163]
    v_mul_f32 v189, v189, v197
    v_cvt_pk_bf16_f32 v186, v188, v189
    v_mfma_f32_16x16x32_bf16 v[212:215], a[240:243], a[244:247], v[212:215]
    ds_read_b128 a[244:247], v239 offset:17408
    ds_read_b128 a[240:243], v242 offset:61952
    v_mul_f32 v190, v190, v197
    v_mfma_f32_16x16x16_bf16 v[160:163], v[22:23], v[136:137], v[160:163]
    s_waitcnt lgkmcnt(4)
    v_mul_f32 v191, v191, v197
    v_cvt_pk_bf16_f32 v187, v190, v191
    v_mul_f32 v192, v192, v197
    v_mfma_f32_16x16x32_bf16 v[200:203], a[248:251], v[252:255], v[200:203]
    s_waitcnt lgkmcnt(3)
    v_mul_f32 v193, v193, v197
    v_cvt_pk_bf16_f32 v188, v192, v193
    v_mul_f32 v194, v194, v197
    v_mul_f32 v195, v195, v197
    v_cvt_pk_bf16_f32 v189, v194, v195
    ds_write_b128 v237, v[184:187]
    v_mfma_f32_16x16x32_bf16 v[220:223], a[252:255], v[252:255], v[220:223]
    s_waitcnt lgkmcnt(2)
    ds_write_b64 v238, v[188:189]
    v_cvt_pk_bf16_f32 v200, v200, v201
    v_cvt_pk_bf16_f32 v201, v202, v203
    v_max3_f32 v248, v248, v146, v147
    v_max3_f32 v249, v249, v148, v149
    v_max3_f32 v248, v248, v150, v151
    v_mfma_f32_16x16x32_bf16 v[208:211], a[248:251], a[244:247], v[208:211]
    v_max3_f32 v249, v249, v152, v153
    v_cvt_pk_bf16_f32 v202, v220, v221
    v_mfma_f32_16x16x32_bf16 v[204:207], a[252:255], a[244:247], v[204:207]
    v_cvt_pk_bf16_f32 v203, v222, v223
    v_max3_f32 v248, v248, v154, v155
    v_mfma_f32_16x16x32_bf16 v[216:219], a[236:239], a[244:247], v[216:219]
    s_waitcnt lgkmcnt(2)
    ds_read_b128 v[252:255], v224 offset:31040
    ds_read_b128 a[248:251], v224 offset:31104
    v_mfma_f32_16x16x32_bf16 v[212:215], a[240:243], a[244:247], v[212:215]
    ds_read_b128 a[244:247], v224 offset:30976
    v_cvt_pk_bf16_f32 v208, v208, v209
    v_cvt_pk_bf16_f32 v209, v210, v211
    v_cvt_pk_bf16_f32 v210, v204, v205
    ds_read_b128 a[252:255], v224 offset:31168
    v_cvt_pk_bf16_f32 v211, v206, v207
    ds_read_b128 a[236:239], v224 offset:31232
    buffer_store_dwordx4 v[208:211], v243, s[20:23], s58 offen sc0 sc1
    ds_read_b128 a[240:243], v224 offset:31296
    v_cvt_pk_bf16_f32 v216, v216, v217
    v_cvt_pk_bf16_f32 v217, v218, v219
    v_cvt_pk_bf16_f32 v218, v212, v213
    v_cvt_pk_bf16_f32 v219, v214, v215
    v_max_f32 v248, v248, v249
    v_mov_b32 v249, v248
    s_nop 1
    v_permlane16_swap_b32 v248, v249
    v_max_f32 v248, v248, v249
    v_mov_b32 v249, v248
    s_nop 1
    v_permlane32_swap_b32 v248, v249
    v_max_f32 v248, v248, v249
    v_mul_f32 v236, s37, v248
    v_fma_f32 v164, v164, s37, -v236
    s_waitcnt lgkmcnt(3)
    v_mfma_f32_16x16x32_bf16 v[208:211], a[0:3], a[244:247], 0
    v_fma_f32 v165, v165, s37, -v236
    v_fma_f32 v166, v166, s37, -v236
    v_mfma_f32_16x16x32_bf16 v[204:207], a[4:7], a[244:247], 0
    v_fma_f32 v167, v167, s37, -v236
    v_fma_f32 v168, v168, s37, -v236
    v_mfma_f32_16x16x32_bf16 v[220:223], a[244:247], a[72:75], 0
    v_exp_f32 v164, v164
    v_mfma_f32_16x16x32_bf16 v[212:215], a[244:247], a[80:83], 0
    v_exp_f32 v165, v165
    v_mfma_f32_16x16x32_bf16 v[208:211], a[12:15], v[252:255], v[208:211]
    v_exp_f32 v166, v166
    v_mfma_f32_16x16x32_bf16 v[204:207], a[16:19], v[252:255], v[204:207]
    v_exp_f32 v167, v167
    v_mfma_f32_16x16x32_bf16 v[220:223], v[252:255], a[84:87], v[220:223]
    buffer_store_dwordx4 v[200:203], v245, s[20:23], s58 offen sc0 sc1
    v_mfma_f32_16x16x32_bf16 v[212:215], v[252:255], a[92:95], v[212:215]
    v_cvt_pk_bf16_f32 v180, v164, v165
    v_cvt_pk_bf16_f32 v181, v166, v167
    v_mfma_f32_16x16x32_bf16 v[200:203], a[8:11], a[244:247], 0
    ds_read_b128 v[164:167], v228 offset:1280
    v_fma_f32 v169, v169, s37, -v236
    v_mfma_f32_16x16x32_bf16 v[200:203], a[20:23], v[252:255], v[200:203]
    v_fma_f32 v170, v170, s37, -v236
    v_fma_f32 v171, v171, s37, -v236
    v_mfma_f32_16x16x32_bf16 v[208:211], a[24:27], a[248:251], v[208:211]
    v_exp_f32 v168, v168
    v_mfma_f32_16x16x32_bf16 v[204:207], a[28:31], a[248:251], v[204:207]
    v_exp_f32 v169, v169
    v_mfma_f32_16x16x32_bf16 v[200:203], a[32:35], a[248:251], v[200:203]
    v_exp_f32 v170, v170
    v_mfma_f32_16x16x32_bf16 v[220:223], a[248:251], a[96:99], v[220:223]
    v_exp_f32 v171, v171
    v_mfma_f32_16x16x32_bf16 v[212:215], a[248:251], a[104:107], v[212:215]
    s_waitcnt lgkmcnt(1)
    v_cvt_pk_bf16_f32 v182, v168, v169
    v_cvt_pk_bf16_f32 v183, v170, v171
    v_mfma_f32_16x16x32_bf16 v[208:211], a[36:39], a[252:255], v[208:211]
    ds_read_b128 v[168:171], v229 offset:1280
    v_fma_f32 v172, v172, s37, -v236
    v_mfma_f32_16x16x32_bf16 v[196:199], a[216:219], v[180:183], 0
    v_fma_f32 v173, v173, s37, -v236
    v_fma_f32 v174, v174, s37, -v236
    v_mfma_f32_16x16x32_bf16 v[184:187], v[76:79], v[180:183], 0
    v_fma_f32 v175, v175, s37, -v236
    v_fma_f32 v144, v144, s37, -v236
    v_mfma_f32_16x16x32_bf16 v[188:191], v[98:101], v[180:183], 0
    s_waitcnt lgkmcnt(1)
    buffer_store_dwordx4 v[216:219], v244, s[20:23], s58 offen sc0 sc1
    v_mfma_f32_16x16x32_bf16 v[192:195], v[120:123], v[180:183], 0
    s_add_u32 s58, s51, 0xa8000
    v_exp_f32 v172, v172
    v_mfma_f32_16x16x32_bf16 v[164:167], v[0:3], v[132:135], v[164:167]
    v_exp_f32 v173, v173
    v_mfma_f32_16x16x32_bf16 v[216:219], a[244:247], a[76:79], 0
    ds_read_b128 a[244:247], v224 offset:34048
    v_cvt_pk_bf16_f32 v176, v172, v173
    v_mfma_f32_16x16x32_bf16 v[216:219], v[252:255], a[88:91], v[216:219]
    ds_read_b128 v[252:255], v224 offset:34112
    v_fma_f32 v145, v145, s37, -v236
    v_mfma_f32_16x16x16_bf16 v[164:167], v[4:5], v[136:137], v[164:167]
    s_waitcnt lgkmcnt(2)
    v_exp_f32 v174, v174
    v_mfma_f32_16x16x32_bf16 v[168:171], v[24:27], v[132:135], v[168:171]
    v_exp_f32 v175, v175
    v_mfma_f32_16x16x32_bf16 v[216:219], a[248:251], a[100:103], v[216:219]
    ds_read_b128 a[248:251], v224 offset:34176
    v_cvt_pk_bf16_f32 v177, v174, v175
    v_mfma_f32_16x16x32_bf16 v[204:207], a[40:43], a[252:255], v[204:207]
    ds_read_b128 v[172:175], v229 offset:1920
    v_fma_f32 v146, v146, s37, -v236
    v_mfma_f32_16x16x16_bf16 v[168:171], v[28:29], v[136:137], v[168:171]
    v_fma_f32 v147, v147, s37, -v236
    v_fma_f32 v148, v148, s37, -v236
    v_mfma_f32_16x16x32_bf16 v[200:203], a[44:47], a[252:255], v[200:203]
    v_exp_f32 v144, v144
    v_mfma_f32_16x16x32_bf16 v[220:223], a[252:255], a[108:111], v[220:223]
    v_exp_f32 v145, v145
    v_mfma_f32_16x16x32_bf16 v[216:219], a[252:255], a[112:115], v[216:219]
    v_exp_f32 v146, v146
    v_mfma_f32_16x16x32_bf16 v[212:215], a[252:255], a[116:119], v[212:215]
    ds_read_b128 a[252:255], v224 offset:34240
    v_cvt_pk_bf16_f32 v178, v144, v145
    v_mfma_f32_16x16x32_bf16 v[208:211], a[48:51], a[236:239], v[208:211]
    v_exp_f32 v147, v147
    v_mfma_f32_16x16x32_bf16 v[204:207], a[52:55], a[236:239], v[204:207]
    v_cvt_pk_bf16_f32 v179, v146, v147
    v_fma_f32 v149, v149, s37, -v236
    v_mfma_f32_16x16x32_bf16 v[200:203], a[56:59], a[236:239], v[200:203]
    ds_read_b128 v[144:147], v228 offset:1920
    v_fma_f32 v150, v150, s37, -v236
    v_mfma_f32_16x16x32_bf16 v[196:199], a[216:219], v[176:179], v[196:199]
    v_fma_f32 v151, v151, s37, -v236
    v_fma_f32 v152, v152, s37, -v236
    v_mfma_f32_16x16x32_bf16 v[184:187], v[68:71], v[176:179], v[184:187]
    v_exp_f32 v148, v148
    v_mfma_f32_16x16x32_bf16 v[188:191], v[90:93], v[176:179], v[188:191]
    v_exp_f32 v149, v149
    v_mfma_f32_16x16x32_bf16 v[192:195], v[112:115], v[176:179], v[192:195]
    s_waitcnt lgkmcnt(2)
    v_exp_f32 v150, v150
    v_mfma_f32_16x16x32_bf16 v[172:175], v[30:33], v[132:135], v[172:175]
    v_exp_f32 v151, v151
    v_mfma_f32_16x16x32_bf16 v[220:223], a[236:239], a[120:123], v[220:223]
    v_cvt_pk_bf16_f32 v180, v148, v149
    v_cvt_pk_bf16_f32 v181, v150, v151
    v_mfma_f32_16x16x32_bf16 v[216:219], a[236:239], a[124:127], v[216:219]
    ds_read_b128 v[148:151], v228 offset:2560
    v_fma_f32 v153, v153, s37, -v236
    v_mfma_f32_16x16x16_bf16 v[172:175], v[34:35], v[136:137], v[172:175]
    s_waitcnt lgkmcnt(1)
    v_fma_f32 v154, v154, s37, -v236
    v_fma_f32 v155, v155, s37, -v236
    v_mfma_f32_16x16x32_bf16 v[144:147], v[6:9], v[132:135], v[144:147]
    v_exp_f32 v152, v152
    v_mfma_f32_16x16x32_bf16 v[212:215], a[236:239], a[128:131], v[212:215]
    ds_read_b128 a[236:239], v224 offset:34304
    v_max3_f32 v248, v156, v157, v158
    v_mfma_f32_16x16x32_bf16 v[208:211], a[60:63], a[240:243], v[208:211]
    v_exp_f32 v153, v153
    v_mfma_f32_16x16x16_bf16 v[144:147], v[10:11], v[136:137], v[144:147]
    v_exp_f32 v154, v154
    v_mfma_f32_16x16x32_bf16 v[204:207], a[64:67], a[240:243], v[204:207]
    v_exp_f32 v155, v155
    v_mfma_f32_16x16x32_bf16 v[200:203], a[68:71], a[240:243], v[200:203]
    v_cvt_pk_bf16_f32 v182, v152, v153
    v_cvt_pk_bf16_f32 v183, v154, v155
    v_mfma_f32_16x16x32_bf16 v[220:223], a[240:243], a[132:135], v[220:223]
    v_cvt_pk_bf16_f32 v12, v208, v209
    v_cvt_pk_bf16_f32 v13, v210, v211
    v_mfma_f32_16x16x32_bf16 v[196:199], a[216:219], v[180:183], v[196:199]
    v_cvt_pk_bf16_f32 v14, v204, v205
    v_cvt_pk_bf16_f32 v15, v206, v207
    v_mfma_f32_16x16x32_bf16 v[184:187], v[84:87], v[180:183], v[184:187]
    v_cvt_pk_bf16_f32 v16, v200, v201
    v_cvt_pk_bf16_f32 v17, v202, v203
    v_mfma_f32_16x16x32_bf16 v[188:191], v[106:109], v[180:183], v[188:191]
    v_cvt_pk_bf16_f32 v74, v220, v221
    v_cvt_pk_bf16_f32 v75, v222, v223
    v_mfma_f32_16x16x32_bf16 v[192:195], v[128:131], v[180:183], v[192:195]
    s_waitcnt lgkmcnt(1)
    ds_read_b128 v[152:155], v229 offset:2560
    v_max3_f32 v249, v159, v160, v161
    v_mfma_f32_16x16x32_bf16 v[148:151], v[12:15], v[132:135], v[148:151]
    v_rcp_f32 v197, v196
    v_mfma_f32_16x16x32_bf16 v[216:219], a[240:243], a[136:139], v[216:219]
    v_mul_f32 v184, v184, v197
    v_mul_f32 v185, v185, v197
    v_mfma_f32_16x16x32_bf16 v[212:215], a[240:243], a[140:143], v[212:215]
    ds_read_b128 a[240:243], v224 offset:34368
    v_cvt_pk_bf16_f32 v184, v184, v185
    v_mfma_f32_16x16x16_bf16 v[148:151], v[16:17], v[136:137], v[148:151]
    v_mul_f32 v186, v186, v197
    v_mul_f32 v187, v187, v197
    v_mfma_f32_16x16x32_bf16 v[208:211], a[0:3], a[244:247], 0
    v_cvt_pk_bf16_f32 v96, v216, v217
    v_cvt_pk_bf16_f32 v97, v218, v219
    v_mfma_f32_16x16x32_bf16 v[204:207], a[4:7], a[244:247], 0
    v_cvt_pk_bf16_f32 v118, v212, v213
    v_cvt_pk_bf16_f32 v119, v214, v215
    v_mfma_f32_16x16x32_bf16 v[200:203], a[8:11], a[244:247], 0
    v_cvt_pk_bf16_f32 v185, v186, v187
    v_mul_f32 v188, v188, v197
    v_mfma_f32_16x16x32_bf16 v[220:223], a[244:247], a[72:75], 0
    v_mul_f32 v189, v189, v197
    v_cvt_pk_bf16_f32 v186, v188, v189
    v_mfma_f32_16x16x32_bf16 v[216:219], a[244:247], a[76:79], 0
    v_mul_f32 v190, v190, v197
    v_mul_f32 v191, v191, v197
    v_mfma_f32_16x16x32_bf16 v[212:215], a[244:247], a[80:83], 0
    ds_read_b128 a[244:247], v225 offset:11968
    v_cvt_pk_bf16_f32 v187, v190, v191
    v_mfma_f32_16x16x32_bf16 v[208:211], a[12:15], v[252:255], v[208:211]
    v_mul_f32 v192, v192, v197
    v_mul_f32 v193, v193, v197
    v_mfma_f32_16x16x32_bf16 v[204:207], a[16:19], v[252:255], v[204:207]
    v_cvt_pk_bf16_f32 v188, v192, v193
    v_mul_f32 v194, v194, v197
    v_mfma_f32_16x16x32_bf16 v[200:203], a[20:23], v[252:255], v[200:203]
    v_mul_f32 v195, v195, v197
    v_cvt_pk_bf16_f32 v189, v194, v195
    v_mfma_f32_16x16x32_bf16 v[220:223], v[252:255], a[84:87], v[220:223]
    ds_write_b128 v237, v[184:187] offset:6144
    v_mfma_f32_16x16x32_bf16 v[216:219], v[252:255], a[88:91], v[216:219]
    ds_write_b64 v238, v[188:189] offset:6144
    v_mfma_f32_16x16x32_bf16 v[212:215], v[252:255], a[92:95], v[212:215]
    v_max3_f32 v248, v248, v162, v163
    v_max3_f32 v249, v249, v164, v165
    v_mfma_f32_16x16x32_bf16 v[208:211], a[24:27], a[248:251], v[208:211]
    v_max3_f32 v248, v248, v166, v167
    v_max3_f32 v249, v249, v168, v169
    v_mfma_f32_16x16x32_bf16 v[204:207], a[28:31], a[248:251], v[204:207]
    v_max3_f32 v248, v248, v170, v171
    v_max3_f32 v249, v249, v172, v173
    v_mfma_f32_16x16x32_bf16 v[200:203], a[32:35], a[248:251], v[200:203]
    ds_read_b128 v[252:255], v225 offset:12032
    v_max3_f32 v248, v248, v174, v175
    v_mfma_f32_16x16x32_bf16 v[220:223], a[248:251], a[96:99], v[220:223]
    v_max3_f32 v249, v249, v144, v145
    v_max3_f32 v248, v248, v146, v147
    v_mfma_f32_16x16x32_bf16 v[216:219], a[248:251], a[100:103], v[216:219]
    v_max3_f32 v249, v249, v148, v149
    v_max3_f32 v248, v248, v150, v151
    v_mfma_f32_16x16x32_bf16 v[212:215], a[248:251], a[104:107], v[212:215]
    ds_read_b128 a[248:251], v225 offset:12096
    v_mfma_f32_16x16x32_bf16 v[208:211], a[36:39], a[252:255], v[208:211]
    v_mfma_f32_16x16x32_bf16 v[204:207], a[40:43], a[252:255], v[204:207]
    v_mfma_f32_16x16x32_bf16 v[200:203], a[44:47], a[252:255], v[200:203]
    v_mfma_f32_16x16x32_bf16 v[220:223], a[252:255], a[108:111], v[220:223]
    v_mfma_f32_16x16x32_bf16 v[216:219], a[252:255], a[112:115], v[216:219]
    v_mfma_f32_16x16x32_bf16 v[212:215], a[252:255], a[116:119], v[212:215]
    s_waitcnt lgkmcnt(2)
    ds_read_b128 a[252:255], v225 offset:12160
    v_mfma_f32_16x16x32_bf16 v[208:211], a[48:51], a[236:239], v[208:211]
    v_mfma_f32_16x16x32_bf16 v[204:207], a[52:55], a[236:239], v[204:207]
    v_mfma_f32_16x16x32_bf16 v[200:203], a[56:59], a[236:239], v[200:203]
    v_mfma_f32_16x16x32_bf16 v[220:223], a[236:239], a[120:123], v[220:223]
    v_mfma_f32_16x16x32_bf16 v[216:219], a[236:239], a[124:127], v[216:219]
    v_mfma_f32_16x16x32_bf16 v[212:215], a[236:239], a[128:131], v[212:215]
    ds_read_b128 a[236:239], v225 offset:12224
    v_mfma_f32_16x16x32_bf16 v[208:211], a[60:63], a[240:243], v[208:211]
    v_mfma_f32_16x16x32_bf16 v[204:207], a[64:67], a[240:243], v[204:207]
    v_mfma_f32_16x16x32_bf16 v[200:203], a[68:71], a[240:243], v[200:203]
    v_mfma_f32_16x16x32_bf16 v[220:223], a[240:243], a[132:135], v[220:223]
    v_mfma_f32_16x16x32_bf16 v[216:219], a[240:243], a[136:139], v[216:219]
    v_mfma_f32_16x16x32_bf16 v[212:215], a[240:243], a[140:143], v[212:215]
    ds_read_b128 a[240:243], v225 offset:12288
    s_nop 1
    v_cvt_pk_bf16_f32 v36, v208, v209
    v_cvt_pk_bf16_f32 v37, v210, v211
    v_mfma_f32_16x16x32_bf16 v[208:211], a[144:147], a[244:247], 0
    v_cvt_pk_bf16_f32 v38, v204, v205
    v_cvt_pk_bf16_f32 v39, v206, v207
    v_mfma_f32_16x16x32_bf16 v[204:207], a[148:151], a[244:247], 0
    v_cvt_pk_bf16_f32 v40, v200, v201
    v_cvt_pk_bf16_f32 v41, v202, v203
    v_mfma_f32_16x16x32_bf16 v[152:155], v[36:39], v[132:135], v[152:155]
    v_cvt_pk_bf16_f32 v76, v220, v221
    v_cvt_pk_bf16_f32 v77, v222, v223
    v_mfma_f32_16x16x32_bf16 v[200:203], a[152:155], a[244:247], 0
    s_waitcnt lgkmcnt(1)
    v_cvt_pk_bf16_f32 v98, v216, v217
    v_cvt_pk_bf16_f32 v99, v218, v219
    v_mfma_f32_16x16x32_bf16 v[208:211], a[156:159], v[252:255], v[208:211]
    v_cvt_pk_bf16_f32 v120, v212, v213
    v_cvt_pk_bf16_f32 v121, v214, v215
    v_mfma_f32_16x16x16_bf16 v[152:155], v[40:41], v[136:137], v[152:155]
    s_waitcnt vmcnt(3) lgkmcnt(0)
    ds_read_b128 a[244:247], v225 offset:24384
    v_mfma_f32_16x16x32_bf16 v[204:207], a[160:163], v[252:255], v[204:207]
    s_barrier
    v_mfma_f32_16x16x32_bf16 v[200:203], a[164:167], v[252:255], v[200:203]
    ds_read_b128 v[252:255], v225 offset:24448
    v_mfma_f32_16x16x32_bf16 v[208:211], a[168:171], a[248:251], v[208:211]
    buffer_load_dwordx4 v246, s[4:7], s56 offen lds
    v_mfma_f32_16x16x32_bf16 v[204:207], a[172:175], a[248:251], v[204:207]
    s_add_u32 m0, s42, 0
    v_max3_f32 v249, v249, v152, v153
    v_max3_f32 v248, v248, v154, v155
    v_mfma_f32_16x16x32_bf16 v[200:203], a[176:179], a[248:251], v[200:203]
    ds_read_b128 a[248:251], v225 offset:24512
    v_max_f32 v248, v248, v249
    v_mfma_f32_16x16x32_bf16 v[208:211], a[180:183], a[252:255], v[208:211]
    v_mov_b32 v249, v248
    v_mfma_f32_16x16x32_bf16 v[204:207], a[184:187], a[252:255], v[204:207]
    v_mfma_f32_16x16x32_bf16 v[200:203], a[188:191], a[252:255], v[200:203]
    ds_read_b128 a[252:255], v225 offset:24576
    v_mfma_f32_16x16x32_bf16 v[208:211], a[192:195], a[236:239], v[208:211]
    v_permlane16_swap_b32 v248, v249
    v_mfma_f32_16x16x32_bf16 v[204:207], a[196:199], a[236:239], v[204:207]
    v_max_f32 v248, v248, v249
    v_mov_b32 v249, v248
    v_mfma_f32_16x16x32_bf16 v[200:203], a[200:203], a[236:239], v[200:203]
    ds_read_b128 a[236:239], v225 offset:24640
    v_mfma_f32_16x16x32_bf16 v[208:211], a[204:207], a[240:243], v[208:211]
    buffer_load_dwordx4 v247, s[4:7], s56 offen lds
    v_mfma_f32_16x16x32_bf16 v[204:207], a[208:211], a[240:243], v[204:207]
    s_add_u32 m0, s41, 0x1e40
    v_permlane32_swap_b32 v248, v249
    v_mfma_f32_16x16x32_bf16 v[200:203], a[212:215], a[240:243], v[200:203]
    s_waitcnt lgkmcnt(3)
    ds_read_b128 a[240:243], v225 offset:24704
    v_max_f32 v248, v248, v249
    v_mfma_f32_16x16x32_bf16 v[220:223], a[144:147], a[244:247], 0
    v_cvt_pk_bf16_f32 v138, v208, v209
    v_cvt_pk_bf16_f32 v139, v210, v211
    v_mfma_f32_16x16x32_bf16 v[216:219], a[148:151], a[244:247], 0
    v_cvt_pk_bf16_f32 v140, v204, v205
    v_cvt_pk_bf16_f32 v141, v206, v207
    v_mfma_f32_16x16x32_bf16 v[212:215], a[152:155], a[244:247], 0
    v_cvt_pk_bf16_f32 v142, v200, v201
    v_cvt_pk_bf16_f32 v143, v202, v203
    v_mfma_f32_16x16x32_bf16 v[220:223], a[156:159], v[252:255], v[220:223]
    ds_read_b128 a[244:247], v227 offset:37120
    v_mul_f32 v236, s37, v248
    v_mfma_f32_16x16x32_bf16 v[216:219], a[160:163], v[252:255], v[216:219]
    v_fma_f32 v156, v156, s37, -v236
    v_fma_f32 v157, v157, s37, -v236
    v_mfma_f32_16x16x32_bf16 v[212:215], a[164:167], v[252:255], v[212:215]
    s_waitcnt lgkmcnt(3)
    ds_read_b128 v[252:255], v227 offset:37184
    v_fma_f32 v158, v158, s37, -v236
    v_mfma_f32_16x16x32_bf16 v[220:223], a[168:171], a[248:251], v[220:223]
    buffer_load_dwordx4 v246, s[4:7], s46 offen lds
    v_mfma_f32_16x16x32_bf16 v[216:219], a[172:175], a[248:251], v[216:219]
    s_add_u32 m0, s42, 0x1e40
    v_fma_f32 v159, v159, s37, -v236
    v_fma_f32 v160, v160, s37, -v236
    v_mfma_f32_16x16x32_bf16 v[212:215], a[176:179], a[248:251], v[212:215]
    ds_read_b128 a[248:251], v227 offset:37248
    v_fma_f32 v161, v161, s37, -v236
    v_mfma_f32_16x16x32_bf16 v[220:223], a[180:183], a[252:255], v[220:223]
    v_exp_f32 v156, v156
    v_mfma_f32_16x16x32_bf16 v[216:219], a[184:187], a[252:255], v[216:219]
    v_exp_f32 v157, v157
    v_mfma_f32_16x16x32_bf16 v[212:215], a[188:191], a[252:255], v[212:215]
    s_waitcnt lgkmcnt(3)
    ds_read_b128 a[252:255], v227 offset:37312
    v_cvt_pk_bf16_f32 v176, v156, v157
    v_mfma_f32_16x16x32_bf16 v[220:223], a[192:195], a[236:239], v[220:223]
    v_exp_f32 v158, v158
    v_mfma_f32_16x16x32_bf16 v[216:219], a[196:199], a[236:239], v[216:219]
    v_exp_f32 v159, v159
    v_mfma_f32_16x16x32_bf16 v[212:215], a[200:203], a[236:239], v[212:215]
    ds_read_b128 a[236:239], v227 offset:37376
    v_cvt_pk_bf16_f32 v177, v158, v159
    v_mfma_f32_16x16x32_bf16 v[220:223], a[204:207], a[240:243], v[220:223]
    buffer_load_dwordx4 v247, s[4:7], s46 offen lds
    v_mfma_f32_16x16x32_bf16 v[216:219], a[208:211], a[240:243], v[216:219]
    s_add_u32 m0, s41, 0x3c80
    ds_read_b128 v[156:159], v230 offset:2560
    v_fma_f32 v162, v162, s37, -v236
    v_mfma_f32_16x16x32_bf16 v[212:215], a[212:215], a[240:243], v[212:215]
    s_waitcnt lgkmcnt(4)
    ds_read_b128 a[240:243], v227 offset:37440
    v_fma_f32 v163, v163, s37, -v236
    v_mfma_f32_16x16x32_bf16 v[208:211], a[0:3], a[244:247], 0
    v_cvt_pk_bf16_f32 v132, v220, v221
    v_cvt_pk_bf16_f32 v133, v222, v223
    v_mfma_f32_16x16x32_bf16 v[204:207], a[4:7], a[244:247], 0
    v_cvt_pk_bf16_f32 v134, v216, v217
    v_cvt_pk_bf16_f32 v135, v218, v219
    v_mfma_f32_16x16x32_bf16 v[200:203], a[8:11], a[244:247], 0
    v_cvt_pk_bf16_f32 v136, v212, v213
    v_cvt_pk_bf16_f32 v137, v214, v215
    v_mfma_f32_16x16x32_bf16 v[220:223], a[244:247], a[72:75], 0
    v_exp_f32 v160, v160
    v_mfma_f32_16x16x32_bf16 v[216:219], a[244:247], a[76:79], 0
    v_exp_f32 v161, v161
    v_mfma_f32_16x16x32_bf16 v[212:215], a[244:247], a[80:83], 0
    ds_read_b128 a[244:247], v239
    v_cvt_pk_bf16_f32 v178, v160, v161
    v_mfma_f32_16x16x32_bf16 v[208:211], a[12:15], v[252:255], v[208:211]
    s_waitcnt lgkmcnt(2)
    v_exp_f32 v162, v162
    v_mfma_f32_16x16x32_bf16 v[156:159], v[36:39], v[138:141], v[156:159]
    v_exp_f32 v163, v163
    v_mfma_f32_16x16x32_bf16 v[204:207], a[16:19], v[252:255], v[204:207]
    v_cvt_pk_bf16_f32 v179, v162, v163
    v_fma_f32 v164, v164, s37, -v236
    v_mfma_f32_16x16x32_bf16 v[200:203], a[20:23], v[252:255], v[200:203]
    ds_read_b128 v[160:163], v230 offset:640
    v_fma_f32 v165, v165, s37, -v236
    v_mfma_f32_16x16x32_bf16 v[196:199], a[216:219], v[176:179], 0
    v_fma_f32 v166, v166, s37, -v236
    v_fma_f32 v167, v167, s37, -v236
    v_mfma_f32_16x16x32_bf16 v[184:187], v[78:81], v[176:179], 0
    v_exp_f32 v164, v164
    v_mfma_f32_16x16x32_bf16 v[188:191], v[100:103], v[176:179], 0
    v_exp_f32 v165, v165
    v_mfma_f32_16x16x32_bf16 v[192:195], v[122:125], v[176:179], 0
    v_exp_f32 v166, v166
    v_mfma_f32_16x16x16_bf16 v[156:159], v[40:41], v[142:143], v[156:159]
    v_exp_f32 v167, v167
    v_mfma_f32_16x16x32_bf16 v[220:223], v[252:255], a[84:87], v[220:223]
    v_cvt_pk_bf16_f32 v180, v164, v165
    v_cvt_pk_bf16_f32 v181, v166, v167
    v_mfma_f32_16x16x32_bf16 v[216:219], v[252:255], a[88:91], v[216:219]
    ds_read_b128 v[164:167], v230 offset:1280
    v_fma_f32 v168, v168, s37, -v236
    v_mfma_f32_16x16x32_bf16 v[212:215], v[252:255], a[92:95], v[212:215]
    s_waitcnt lgkmcnt(1)
    ds_read_b128 v[252:255], v240
    v_fma_f32 v169, v169, s37, -v236
    v_mfma_f32_16x16x32_bf16 v[160:163], v[42:45], v[138:141], v[160:163]
    v_fma_f32 v170, v170, s37, -v236
    v_fma_f32 v171, v171, s37, -v236
    v_mfma_f32_16x16x32_bf16 v[208:211], a[24:27], a[248:251], v[208:211]
    v_exp_f32 v168, v168
    v_mfma_f32_16x16x32_bf16 v[204:207], a[28:31], a[248:251], v[204:207]
    v_exp_f32 v169, v169
    v_mfma_f32_16x16x16_bf16 v[160:163], v[46:47], v[142:143], v[160:163]
    v_exp_f32 v170, v170
    v_mfma_f32_16x16x32_bf16 v[200:203], a[32:35], a[248:251], v[200:203]
    v_exp_f32 v171, v171
    v_mfma_f32_16x16x32_bf16 v[220:223], a[248:251], a[96:99], v[220:223]
    v_cvt_pk_bf16_f32 v182, v168, v169
    v_cvt_pk_bf16_f32 v183, v170, v171
    v_mfma_f32_16x16x32_bf16 v[216:219], a[248:251], a[100:103], v[216:219]
    ds_read_b128 v[168:171], v230 offset:1920
    v_fma_f32 v172, v172, s37, -v236
    v_mfma_f32_16x16x32_bf16 v[196:199], a[216:219], v[180:183], v[196:199]
    v_fma_f32 v173, v173, s37, -v236
    v_fma_f32 v174, v174, s37, -v236
    v_mfma_f32_16x16x32_bf16 v[184:187], v[66:69], v[180:183], v[184:187]
    v_fma_f32 v175, v175, s37, -v236
    v_fma_f32 v144, v144, s37, -v236
    v_mfma_f32_16x16x32_bf16 v[188:191], v[88:91], v[180:183], v[188:191]
    v_exp_f32 v172, v172
    v_mfma_f32_16x16x32_bf16 v[192:195], v[110:113], v[180:183], v[192:195]
    s_waitcnt lgkmcnt(1)
    v_exp_f32 v173, v173
    v_mfma_f32_16x16x32_bf16 v[164:167], v[24:27], v[138:141], v[164:167]
    v_exp_f32 v174, v174
    v_mfma_f32_16x16x32_bf16 v[212:215], a[248:251], a[104:107], v[212:215]
    ds_read_b128 a[248:251], v239 offset:1024
    v_cvt_pk_bf16_f32 v176, v172, v173
    v_mfma_f32_16x16x32_bf16 v[208:211], a[36:39], a[252:255], v[208:211]
    v_exp_f32 v175, v175
    v_mfma_f32_16x16x16_bf16 v[164:167], v[28:29], v[142:143], v[164:167]
    s_waitcnt lgkmcnt(1)
    v_cvt_pk_bf16_f32 v177, v174, v175
    v_fma_f32 v145, v145, s37, -v236
    v_mfma_f32_16x16x32_bf16 v[168:171], v[30:33], v[138:141], v[168:171]
    ds_read_b128 v[172:175], v235
    v_bfe_u32 v235, s69, v233, 4
    v_mfma_f32_16x16x32_bf16 v[204:207], a[40:43], a[252:255], v[204:207]
    v_mad_u32_u24 v235, v235, s40, v231
    v_fma_f32 v146, v146, s37, -v236
    v_mfma_f32_16x16x32_bf16 v[200:203], a[44:47], a[252:255], v[200:203]
    v_fma_f32 v147, v147, s37, -v236
    v_fma_f32 v148, v148, s37, -v236
    v_mfma_f32_16x16x16_bf16 v[168:171], v[34:35], v[142:143], v[168:171]
    v_exp_f32 v144, v144
    v_mfma_f32_16x16x32_bf16 v[220:223], a[252:255], a[108:111], v[220:223]
    v_exp_f32 v145, v145
    v_mfma_f32_16x16x32_bf16 v[216:219], a[252:255], a[112:115], v[216:219]
    v_exp_f32 v146, v146
    v_mfma_f32_16x16x32_bf16 v[212:215], a[252:255], a[116:119], v[212:215]
    ds_read_b128 a[252:255], v240 offset:1024
    v_cvt_pk_bf16_f32 v178, v144, v145
    v_mfma_f32_16x16x32_bf16 v[208:211], a[48:51], a[236:239], v[208:211]
    v_exp_f32 v147, v147
    v_mfma_f32_16x16x32_bf16 v[204:207], a[52:55], a[236:239], v[204:207]
    s_waitcnt lgkmcnt(1)
    v_cvt_pk_bf16_f32 v179, v146, v147
    v_fma_f32 v149, v149, s37, -v236
    v_mfma_f32_16x16x32_bf16 v[172:175], v[54:57], v[138:141], v[172:175]
    ds_read_b128 v[144:147], v250
    v_bfe_u32 v250, s70, v233, 4
    v_mfma_f32_16x16x32_bf16 v[196:199], a[216:219], v[176:179], v[196:199]
    v_mad_u32_u24 v250, v250, s40, v231
    v_fma_f32 v150, v150, s37, -v236
    v_mfma_f32_16x16x32_bf16 v[184:187], v[70:73], v[176:179], v[184:187]
    v_fma_f32 v151, v151, s37, -v236
    v_fma_f32 v152, v152, s37, -v236
    v_mfma_f32_16x16x32_bf16 v[188:191], v[92:95], v[176:179], v[188:191]
    v_exp_f32 v148, v148
    v_mfma_f32_16x16x32_bf16 v[192:195], v[114:117], v[176:179], v[192:195]
    v_exp_f32 v149, v149
    v_mfma_f32_16x16x16_bf16 v[172:175], v[58:59], v[142:143], v[172:175]
    v_exp_f32 v150, v150
    v_mfma_f32_16x16x32_bf16 v[200:203], a[56:59], a[236:239], v[200:203]
    v_exp_f32 v151, v151
    v_mfma_f32_16x16x32_bf16 v[220:223], a[236:239], a[120:123], v[220:223]
    v_cvt_pk_bf16_f32 v180, v148, v149
    v_cvt_pk_bf16_f32 v181, v150, v151
    v_mfma_f32_16x16x32_bf16 v[216:219], a[236:239], a[124:127], v[216:219]
    s_waitcnt lgkmcnt(0)
    ds_read_b128 v[148:151], v234
    v_bfe_u32 v234, s73, v232, 4
    v_mfma_f32_16x16x32_bf16 v[144:147], v[60:63], v[138:141], v[144:147]
    v_fma_f32 v153, v153, s37, -v236
    v_fma_f32 v154, v154, s37, -v236
    v_mfma_f32_16x16x32_bf16 v[212:215], a[236:239], a[128:131], v[212:215]
    ds_read_b128 a[236:239], v241 offset:12288
    v_fma_f32 v155, v155, s37, -v236
    v_mfma_f32_16x16x32_bf16 v[208:211], a[60:63], a[240:243], v[208:211]
    v_exp_f32 v152, v152
    v_mfma_f32_16x16x16_bf16 v[144:147], v[64:65], v[142:143], v[144:147]
    v_exp_f32 v153, v153
    v_mfma_f32_16x16x32_bf16 v[204:207], a[64:67], a[240:243], v[204:207]
    v_exp_f32 v154, v154
    v_mfma_f32_16x16x32_bf16 v[200:203], a[68:71], a[240:243], v[200:203]
    v_exp_f32 v155, v155
    v_mfma_f32_16x16x32_bf16 v[220:223], a[240:243], a[132:135], v[220:223]
    v_cvt_pk_bf16_f32 v48, v208, v209
    v_cvt_pk_bf16_f32 v49, v210, v211
    v_mfma_f32_16x16x32_bf16 v[216:219], a[240:243], a[136:139], v[216:219]
    v_cvt_pk_bf16_f32 v182, v152, v153
    v_cvt_pk_bf16_f32 v50, v204, v205
    v_mfma_f32_16x16x32_bf16 v[212:215], a[240:243], a[140:143], v[212:215]
    v_cvt_pk_bf16_f32 v51, v206, v207
    v_cvt_pk_bf16_f32 v52, v200, v201
    v_mfma_f32_16x16x32_bf16 v[208:211], a[220:223], a[244:247], 0
    s_waitcnt lgkmcnt(1)
    v_cvt_pk_bf16_f32 v53, v202, v203
    v_cvt_pk_bf16_f32 v82, v220, v221
    v_mfma_f32_16x16x32_bf16 v[148:151], v[48:51], v[138:141], v[148:151]
    v_cvt_pk_bf16_f32 v83, v222, v223
    v_cvt_pk_bf16_f32 v104, v216, v217
    v_mfma_f32_16x16x32_bf16 v[200:203], a[220:223], v[252:255], 0
    v_cvt_pk_bf16_f32 v105, v218, v219
    v_cvt_pk_bf16_f32 v126, v212, v213
    v_mfma_f32_16x16x32_bf16 v[204:207], a[224:227], a[244:247], 0
    ds_read_b128 a[240:243], v241 offset:12800
    v_cvt_pk_bf16_f32 v127, v214, v215
    v_mfma_f32_16x16x16_bf16 v[148:151], v[52:53], v[142:143], v[148:151]
    v_cvt_pk_bf16_f32 v183, v154, v155
    v_max3_f32 v248, v156, v157, v158
    v_mfma_f32_16x16x32_bf16 v[220:223], a[224:227], v[252:255], 0
    ds_read_b128 v[252:255], v242 offset:12800
    ds_read_b128 v[152:155], v228 offset:640
    v_mfma_f32_16x16x32_bf16 v[196:199], a[216:219], v[180:183], v[196:199]
    v_max3_f32 v249, v159, v160, v161
    v_max3_f32 v248, v248, v162, v163
    v_mfma_f32_16x16x32_bf16 v[184:187], v[74:77], v[180:183], v[184:187]
    v_max3_f32 v249, v249, v164, v165
    v_max3_f32 v248, v248, v166, v167
    v_mfma_f32_16x16x32_bf16 v[188:191], v[96:99], v[180:183], v[188:191]
    v_max3_f32 v249, v249, v168, v169
    v_max3_f32 v248, v248, v170, v171
    v_mfma_f32_16x16x32_bf16 v[192:195], v[118:121], v[180:183], v[192:195]
    v_rcp_f32 v197, v196
    v_mfma_f32_16x16x32_bf16 v[216:219], a[228:231], a[244:247], 0
    v_mul_f32 v184, v184, v197
    v_mul_f32 v185, v185, v197
    v_mfma_f32_16x16x32_bf16 v[212:215], a[232:235], a[244:247], 0
    s_waitcnt lgkmcnt(3)
    ds_read_b128 a[244:247], v242 offset:12288
    v_cvt_pk_bf16_f32 v184, v184, v185
    v_mfma_f32_16x16x32_bf16 v[208:211], a[236:239], a[248:251], v[208:211]
    v_mul_f32 v186, v186, v197
    v_mul_f32 v187, v187, v197
    v_mfma_f32_16x16x32_bf16 v[200:203], a[236:239], a[252:255], v[200:203]
    s_waitcnt lgkmcnt(3)
    ds_read_b128 a[236:239], v241 offset:24576
    v_cvt_pk_bf16_f32 v185, v186, v187
    v_mfma_f32_16x16x32_bf16 v[204:207], a[240:243], a[248:251], v[204:207]
    s_waitcnt lgkmcnt(2)
    v_mul_f32 v188, v188, v197
    v_mul_f32 v189, v189, v197
    v_mfma_f32_16x16x32_bf16 v[152:155], v[0:3], v[132:135], v[152:155]
    v_cvt_pk_bf16_f32 v186, v188, v189
    v_mul_f32 v190, v190, v197
    v_mfma_f32_16x16x32_bf16 v[220:223], a[240:243], a[252:255], v[220:223]
    ds_read_b128 a[252:255], v240 offset:2048
    ds_read_b128 a[240:243], v241 offset:25088
    v_mfma_f32_16x16x32_bf16 v[212:215], v[252:255], a[248:251], v[212:215]
    ds_read_b128 v[252:255], v242 offset:25088
    v_mul_f32 v191, v191, v197
    v_mfma_f32_16x16x16_bf16 v[152:155], v[4:5], v[136:137], v[152:155]
    s_waitcnt lgkmcnt(4)
    v_cvt_pk_bf16_f32 v187, v190, v191
    v_mul_f32 v192, v192, v197
    v_mul_f32 v193, v193, v197
    v_cvt_pk_bf16_f32 v188, v192, v193
    v_mfma_f32_16x16x32_bf16 v[216:219], a[244:247], a[248:251], v[216:219]
    s_waitcnt lgkmcnt(2)
    ds_read_b128 a[248:251], v239 offset:2048
    ds_read_b128 a[244:247], v242 offset:24576
    v_mul_f32 v194, v194, v197
    v_mul_f32 v195, v195, v197
    v_cvt_pk_bf16_f32 v189, v194, v195
    ds_write_b128 v237, v[184:187] offset:12288
    ds_write_b64 v238, v[188:189] offset:12288
    v_max3_f32 v249, v249, v172, v173
    v_max3_f32 v248, v248, v174, v175
    v_max3_f32 v249, v249, v144, v145
    v_mfma_f32_16x16x32_bf16 v[200:203], a[236:239], a[252:255], v[200:203]
    s_waitcnt lgkmcnt(5)
    v_max3_f32 v248, v248, v146, v147
    v_max3_f32 v249, v249, v148, v149
    v_mfma_f32_16x16x32_bf16 v[220:223], a[240:243], a[252:255], v[220:223]
    s_waitcnt lgkmcnt(3)
    v_max3_f32 v248, v248, v150, v151
    v_max_f32 v248, v248, v249
    v_mov_b32 v249, v248
    s_nop 1
    v_permlane16_swap_b32 v248, v249
    ds_read_b128 a[252:255], v240 offset:3072
    v_mfma_f32_16x16x32_bf16 v[208:211], a[236:239], a[248:251], v[208:211]
    ds_read_b128 a[236:239], v241 offset:36864
    v_max_f32 v248, v248, v249
    v_mfma_f32_16x16x32_bf16 v[204:207], a[240:243], a[248:251], v[204:207]
    s_waitcnt lgkmcnt(4)
    ds_read_b128 a[240:243], v241 offset:37376
    v_mov_b32 v249, v248
    v_mfma_f32_16x16x32_bf16 v[216:219], a[244:247], a[248:251], v[216:219]
    ds_read_b128 a[244:247], v242 offset:36864
    v_mfma_f32_16x16x32_bf16 v[212:215], v[252:255], a[248:251], v[212:215]
    s_waitcnt lgkmcnt(2)
    ds_read_b128 a[248:251], v239 offset:3072
    ds_read_b128 v[252:255], v242 offset:37376
    v_permlane32_swap_b32 v248, v249
    v_max_f32 v248, v248, v249
    v_mul_f32 v236, s37, v248
    v_fma_f32 v156, v156, s37, -v236
    v_fma_f32 v157, v157, s37, -v236
    v_fma_f32 v158, v158, s37, -v236
    v_fma_f32 v159, v159, s37, -v236
    v_exp_f32 v156, v156
    v_exp_f32 v157, v157
    v_exp_f32 v158, v158
    v_exp_f32 v159, v159
    v_cvt_pk_bf16_f32 v176, v156, v157
    v_cvt_pk_bf16_f32 v177, v158, v159
    ds_read_b128 v[156:159], v229 offset:640
    v_mfma_f32_16x16x32_bf16 v[200:203], a[236:239], a[252:255], v[200:203]
    s_waitcnt lgkmcnt(4)
    v_fma_f32 v160, v160, s37, -v236
    v_fma_f32 v161, v161, s37, -v236
    v_mfma_f32_16x16x32_bf16 v[220:223], a[240:243], a[252:255], v[220:223]
    s_waitcnt lgkmcnt(2)
    ds_read_b128 a[252:255], v240 offset:4096
    v_fma_f32 v162, v162, s37, -v236
    v_fma_f32 v163, v163, s37, -v236
    v_exp_f32 v160, v160
    v_mfma_f32_16x16x32_bf16 v[208:211], a[236:239], a[248:251], v[208:211]
    ds_read_b128 a[236:239], v241 offset:49152
    v_fma_f32 v164, v164, s37, -v236
    v_mfma_f32_16x16x32_bf16 v[204:207], a[240:243], a[248:251], v[204:207]
    ds_read_b128 a[240:243], v241 offset:49664
    v_fma_f32 v165, v165, s37, -v236
    v_mfma_f32_16x16x32_bf16 v[216:219], a[244:247], a[248:251], v[216:219]
    s_waitcnt lgkmcnt(4)
    ds_read_b128 a[244:247], v242 offset:49152
    v_fma_f32 v166, v166, s37, -v236
    v_mfma_f32_16x16x32_bf16 v[212:215], v[252:255], a[248:251], v[212:215]
    s_waitcnt lgkmcnt(4)
    ds_read_b128 a[248:251], v239 offset:4096
    ds_read_b128 v[252:255], v242 offset:49664
    v_exp_f32 v161, v161
    v_exp_f32 v162, v162
    v_exp_f32 v163, v163
    v_mfma_f32_16x16x32_bf16 v[156:159], v[24:27], v[132:135], v[156:159]
    v_cvt_pk_bf16_f32 v178, v160, v161
    v_cvt_pk_bf16_f32 v179, v162, v163
    ds_read_b128 v[160:163], v229 offset:1280
    v_fma_f32 v167, v167, s37, -v236
    v_mfma_f32_16x16x32_bf16 v[196:199], a[216:219], v[176:179], 0
    v_exp_f32 v164, v164
    v_mfma_f32_16x16x32_bf16 v[184:187], v[76:79], v[176:179], 0
    v_exp_f32 v165, v165
    v_mfma_f32_16x16x32_bf16 v[188:191], v[98:101], v[176:179], 0
    v_exp_f32 v166, v166
    v_mfma_f32_16x16x32_bf16 v[192:195], v[120:123], v[176:179], 0
    v_exp_f32 v167, v167
    v_mfma_f32_16x16x16_bf16 v[156:159], v[28:29], v[136:137], v[156:159]
    s_waitcnt lgkmcnt(2)
    v_cvt_pk_bf16_f32 v180, v164, v165
    v_cvt_pk_bf16_f32 v181, v166, v167
    v_mfma_f32_16x16x32_bf16 v[208:211], a[236:239], a[248:251], v[208:211]
    ds_read_b128 v[164:167], v228 offset:1280
    v_fma_f32 v168, v168, s37, -v236
    v_mfma_f32_16x16x32_bf16 v[200:203], a[236:239], a[252:255], v[200:203]
    ds_read_b128 a[236:239], v241 offset:61440
    v_fma_f32 v169, v169, s37, -v236
    v_mfma_f32_16x16x32_bf16 v[204:207], a[240:243], a[248:251], v[204:207]
    s_waitcnt lgkmcnt(2)
    v_fma_f32 v170, v170, s37, -v236
    v_fma_f32 v171, v171, s37, -v236
    v_mfma_f32_16x16x32_bf16 v[160:163], v[30:33], v[132:135], v[160:163]
    v_exp_f32 v168, v168
    v_mfma_f32_16x16x32_bf16 v[220:223], a[240:243], a[252:255], v[220:223]
    ds_read_b128 a[252:255], v240 offset:5120
    ds_read_b128 a[240:243], v241 offset:61952
    v_mfma_f32_16x16x32_bf16 v[216:219], a[244:247], a[248:251], v[216:219]
    ds_read_b128 a[244:247], v242 offset:61440
    v_fma_f32 v172, v172, s37, -v236
    v_mfma_f32_16x16x16_bf16 v[160:163], v[34:35], v[136:137], v[160:163]
    v_exp_f32 v169, v169
    v_mfma_f32_16x16x32_bf16 v[212:215], v[252:255], a[248:251], v[212:215]
    s_waitcnt lgkmcnt(4)
    ds_read_b128 a[248:251], v239 offset:5120
    ds_read_b128 v[252:255], v242 offset:61952
    v_exp_f32 v170, v170
    v_exp_f32 v171, v171
    v_mfma_f32_16x16x32_bf16 v[164:167], v[6:9], v[132:135], v[164:167]
    v_cvt_pk_bf16_f32 v182, v168, v169
    v_cvt_pk_bf16_f32 v183, v170, v171
    ds_read_b128 v[168:171], v228 offset:1920
    v_fma_f32 v173, v173, s37, -v236
    v_mfma_f32_16x16x32_bf16 v[196:199], a[216:219], v[180:183], v[196:199]
    v_fma_f32 v174, v174, s37, -v236
    v_fma_f32 v175, v175, s37, -v236
    v_mfma_f32_16x16x32_bf16 v[184:187], v[68:71], v[180:183], v[184:187]
    v_exp_f32 v172, v172
    v_mfma_f32_16x16x32_bf16 v[188:191], v[90:93], v[180:183], v[188:191]
    v_exp_f32 v173, v173
    v_mfma_f32_16x16x32_bf16 v[192:195], v[112:115], v[180:183], v[192:195]
    v_exp_f32 v174, v174
    v_mfma_f32_16x16x16_bf16 v[164:167], v[10:11], v[136:137], v[164:167]
    s_waitcnt lgkmcnt(2)
    v_exp_f32 v175, v175
    v_mfma_f32_16x16x32_bf16 v[208:211], a[236:239], a[248:251], v[208:211]
    v_cvt_pk_bf16_f32 v176, v172, v173
    v_cvt_pk_bf16_f32 v177, v174, v175
    v_mfma_f32_16x16x32_bf16 v[200:203], a[236:239], a[252:255], v[200:203]
    ds_read_b128 a[236:239], v224 offset:46592
    ds_read_b128 v[172:175], v229 offset:1920
    v_mfma_f32_16x16x32_bf16 v[204:207], a[240:243], a[248:251], v[204:207]
    s_waitcnt lgkmcnt(2)
    v_fma_f32 v144, v144, s37, -v236
    v_fma_f32 v145, v145, s37, -v236
    v_mfma_f32_16x16x32_bf16 v[168:171], v[12:15], v[132:135], v[168:171]
    v_cvt_pk_bf16_f32 v208, v208, v209
    v_cvt_pk_bf16_f32 v209, v210, v211
    v_mfma_f32_16x16x32_bf16 v[220:223], a[240:243], a[252:255], v[220:223]
    ds_read_b128 a[252:255], v224 offset:46528
    ds_read_b128 a[240:243], v224 offset:46656
    v_mfma_f32_16x16x32_bf16 v[216:219], a[244:247], a[248:251], v[216:219]
    ds_read_b128 a[244:247], v224 offset:46720
    v_cvt_pk_bf16_f32 v210, v204, v205
    v_mfma_f32_16x16x16_bf16 v[168:171], v[16:17], v[136:137], v[168:171]
    v_cvt_pk_bf16_f32 v211, v206, v207
    v_cvt_pk_bf16_f32 v200, v200, v201
    v_mfma_f32_16x16x32_bf16 v[212:215], v[252:255], a[248:251], v[212:215]
    s_waitcnt lgkmcnt(3)
    ds_read_b128 a[248:251], v224 offset:46464
    ds_read_b128 v[252:255], v224 offset:46784
    buffer_store_dwordx4 v[208:211], v243, s[20:23], s58 offen sc0 sc1
    v_cvt_pk_bf16_f32 v201, v202, v203
    v_cvt_pk_bf16_f32 v202, v220, v221
    v_cvt_pk_bf16_f32 v203, v222, v223
    v_cvt_pk_bf16_f32 v216, v216, v217
    v_cvt_pk_bf16_f32 v217, v218, v219
    v_cvt_pk_bf16_f32 v218, v212, v213
    v_cvt_pk_bf16_f32 v219, v214, v215
    v_mfma_f32_16x16x32_bf16 v[172:175], v[36:39], v[132:135], v[172:175]
    v_fma_f32 v146, v146, s37, -v236
    v_fma_f32 v147, v147, s37, -v236
    v_exp_f32 v144, v144
    v_exp_f32 v145, v145
    v_exp_f32 v146, v146
    v_exp_f32 v147, v147
    v_mfma_f32_16x16x16_bf16 v[172:175], v[40:41], v[136:137], v[172:175]
    s_waitcnt lgkmcnt(1)
    v_cvt_pk_bf16_f32 v178, v144, v145
    v_cvt_pk_bf16_f32 v179, v146, v147
    ds_read_b128 v[144:147], v229 offset:2560
    v_mfma_f32_16x16x32_bf16 v[208:211], a[0:3], a[248:251], 0
    v_fma_f32 v148, v148, s37, -v236
    v_fma_f32 v149, v149, s37, -v236
    v_mfma_f32_16x16x32_bf16 v[196:199], a[216:219], v[176:179], v[196:199]
    v_fma_f32 v150, v150, s37, -v236
    v_fma_f32 v151, v151, s37, -v236
    v_mfma_f32_16x16x32_bf16 v[184:187], v[84:87], v[176:179], v[184:187]
    v_exp_f32 v148, v148
    v_mfma_f32_16x16x32_bf16 v[188:191], v[106:109], v[176:179], v[188:191]
    v_exp_f32 v149, v149
    v_mfma_f32_16x16x32_bf16 v[192:195], v[128:131], v[176:179], v[192:195]
    buffer_store_dwordx4 v[200:203], v245, s[20:23], s58 offen sc0 sc1
    v_mfma_f32_16x16x32_bf16 v[204:207], a[4:7], a[248:251], 0
    v_exp_f32 v150, v150
    v_mfma_f32_16x16x32_bf16 v[200:203], a[8:11], a[248:251], 0
    v_exp_f32 v151, v151
    v_mfma_f32_16x16x32_bf16 v[220:223], a[248:251], a[72:75], 0
    v_cvt_pk_bf16_f32 v180, v148, v149
    v_cvt_pk_bf16_f32 v181, v150, v151
    v_mfma_f32_16x16x32_bf16 v[212:215], a[248:251], a[80:83], 0
    ds_read_b128 v[148:151], v228 offset:2560
    v_max3_f32 v248, v152, v153, v154
    v_mfma_f32_16x16x16_bf16 v[196:199], a[216:217], v[180:181], v[196:199]
    v_max3_f32 v249, v155, v156, v157
    v_max3_f32 v248, v248, v158, v159
    v_mfma_f32_16x16x16_bf16 v[184:187], v[82:83], v[180:181], v[184:187]
    v_max3_f32 v249, v249, v160, v161
    v_max3_f32 v248, v248, v162, v163
    v_mfma_f32_16x16x16_bf16 v[188:191], v[104:105], v[180:181], v[188:191]
    v_max3_f32 v249, v249, v164, v165
    v_max3_f32 v248, v248, v166, v167
    v_mfma_f32_16x16x16_bf16 v[192:195], v[126:127], v[180:181], v[192:195]
    v_rcp_f32 v197, v196
    v_mfma_f32_16x16x32_bf16 v[208:211], a[12:15], a[252:255], v[208:211]
    v_mul_f32 v184, v184, v197
    v_mul_f32 v185, v185, v197
    v_mfma_f32_16x16x32_bf16 v[204:207], a[16:19], a[252:255], v[204:207]
    v_cvt_pk_bf16_f32 v184, v184, v185
    v_mul_f32 v186, v186, v197
    v_mfma_f32_16x16x32_bf16 v[200:203], a[20:23], a[252:255], v[200:203]
    v_mul_f32 v187, v187, v197
    v_cvt_pk_bf16_f32 v185, v186, v187
    v_mfma_f32_16x16x32_bf16 v[220:223], a[252:255], a[84:87], v[220:223]
    buffer_store_dwordx4 v[216:219], v244, s[20:23], s58 offen sc0 sc1
    v_mfma_f32_16x16x32_bf16 v[212:215], a[252:255], a[92:95], v[212:215]
    s_add_u32 s58, s51, 0xfc000
    v_mul_f32 v188, v188, v197
    v_mul_f32 v189, v189, v197
    v_mfma_f32_16x16x32_bf16 v[216:219], a[248:251], a[76:79], 0
    ds_read_b128 a[248:251], v224 offset:49536
    v_cvt_pk_bf16_f32 v186, v188, v189
    v_mfma_f32_16x16x32_bf16 v[216:219], a[252:255], a[88:91], v[216:219]
    ds_read_b128 a[252:255], v224 offset:49600
    v_mul_f32 v190, v190, v197
    v_mfma_f32_16x16x32_bf16 v[208:211], a[24:27], a[236:239], v[208:211]
    v_mul_f32 v191, v191, v197
    v_cvt_pk_bf16_f32 v187, v190, v191
    v_mfma_f32_16x16x32_bf16 v[204:207], a[28:31], a[236:239], v[204:207]
    v_mul_f32 v192, v192, v197
    v_mul_f32 v193, v193, v197
    v_mfma_f32_16x16x32_bf16 v[200:203], a[32:35], a[236:239], v[200:203]
    v_cvt_pk_bf16_f32 v188, v192, v193
    v_mul_f32 v194, v194, v197
    v_mfma_f32_16x16x32_bf16 v[220:223], a[236:239], a[96:99], v[220:223]
    v_mul_f32 v195, v195, v197
    v_cvt_pk_bf16_f32 v189, v194, v195
    v_mfma_f32_16x16x32_bf16 v[216:219], a[236:239], a[100:103], v[216:219]
    ds_write_b128 v237, v[184:187] offset:18432
    v_mfma_f32_16x16x32_bf16 v[212:215], a[236:239], a[104:107], v[212:215]
    ds_write_b64 v238, v[188:189] offset:18432
    v_mfma_f32_16x16x32_bf16 v[208:211], a[36:39], a[240:243], v[208:211]
    v_max3_f32 v249, v249, v168, v169
    v_max3_f32 v248, v248, v170, v171
    v_mfma_f32_16x16x32_bf16 v[204:207], a[40:43], a[240:243], v[204:207]
    v_max3_f32 v249, v249, v172, v173
    v_max3_f32 v248, v248, v174, v175
    v_mfma_f32_16x16x32_bf16 v[200:203], a[44:47], a[240:243], v[200:203]
    v_mfma_f32_16x16x32_bf16 v[220:223], a[240:243], a[108:111], v[220:223]
    ds_read_b128 a[236:239], v224 offset:49664
    v_mfma_f32_16x16x32_bf16 v[216:219], a[240:243], a[112:115], v[216:219]
    v_mfma_f32_16x16x32_bf16 v[212:215], a[240:243], a[116:119], v[212:215]
    ds_read_b128 a[240:243], v224 offset:49728
    v_mfma_f32_16x16x32_bf16 v[208:211], a[48:51], a[244:247], v[208:211]
    v_mfma_f32_16x16x32_bf16 v[204:207], a[52:55], a[244:247], v[204:207]
    v_mfma_f32_16x16x32_bf16 v[200:203], a[56:59], a[244:247], v[200:203]
    v_mfma_f32_16x16x32_bf16 v[220:223], a[244:247], a[120:123], v[220:223]
    v_mfma_f32_16x16x32_bf16 v[216:219], a[244:247], a[124:127], v[216:219]
    v_mfma_f32_16x16x32_bf16 v[212:215], a[244:247], a[128:131], v[212:215]
    s_waitcnt lgkmcnt(3)
    ds_read_b128 a[244:247], v224 offset:49792
    v_mfma_f32_16x16x32_bf16 v[208:211], a[60:63], v[252:255], v[208:211]
    v_mfma_f32_16x16x32_bf16 v[204:207], a[64:67], v[252:255], v[204:207]
    v_mfma_f32_16x16x32_bf16 v[200:203], a[68:71], v[252:255], v[200:203]
    v_mfma_f32_16x16x32_bf16 v[220:223], v[252:255], a[132:135], v[220:223]
    v_mfma_f32_16x16x32_bf16 v[216:219], v[252:255], a[136:139], v[216:219]
    v_mfma_f32_16x16x32_bf16 v[212:215], v[252:255], a[140:143], v[212:215]
    ds_read_b128 v[252:255], v224 offset:49856
    s_nop 1
    v_cvt_pk_bf16_f32 v18, v208, v209
    v_cvt_pk_bf16_f32 v19, v210, v211
    v_mfma_f32_16x16x32_bf16 v[208:211], a[0:3], a[248:251], 0
    v_cvt_pk_bf16_f32 v20, v204, v205
    v_cvt_pk_bf16_f32 v21, v206, v207
    v_mfma_f32_16x16x32_bf16 v[204:207], a[4:7], a[248:251], 0
    v_cvt_pk_bf16_f32 v22, v200, v201
    v_cvt_pk_bf16_f32 v23, v202, v203
    v_mfma_f32_16x16x32_bf16 v[148:151], v[18:21], v[132:135], v[148:151]
    v_cvt_pk_bf16_f32 v80, v220, v221
    v_cvt_pk_bf16_f32 v81, v222, v223
    v_mfma_f32_16x16x32_bf16 v[200:203], a[8:11], a[248:251], 0
    v_cvt_pk_bf16_f32 v102, v216, v217
    v_cvt_pk_bf16_f32 v103, v218, v219
    v_mfma_f32_16x16x32_bf16 v[220:223], a[248:251], a[72:75], 0
    v_cvt_pk_bf16_f32 v124, v212, v213
    v_cvt_pk_bf16_f32 v125, v214, v215
    v_mfma_f32_16x16x16_bf16 v[148:151], v[22:23], v[136:137], v[148:151]
    v_mfma_f32_16x16x32_bf16 v[216:219], a[248:251], a[76:79], 0
    v_mfma_f32_16x16x32_bf16 v[212:215], a[248:251], a[80:83], 0
    ds_read_b128 a[248:251], v225 offset:27456
    v_mfma_f32_16x16x32_bf16 v[208:211], a[12:15], a[252:255], v[208:211]
    v_mfma_f32_16x16x32_bf16 v[204:207], a[16:19], a[252:255], v[204:207]
    v_mfma_f32_16x16x32_bf16 v[200:203], a[20:23], a[252:255], v[200:203]
    v_mfma_f32_16x16x32_bf16 v[220:223], a[252:255], a[84:87], v[220:223]
    v_mfma_f32_16x16x32_bf16 v[216:219], a[252:255], a[88:91], v[216:219]
    v_mfma_f32_16x16x32_bf16 v[212:215], a[252:255], a[92:95], v[212:215]
    s_waitcnt lgkmcnt(1)
    ds_read_b128 a[252:255], v225 offset:27520
    v_mfma_f32_16x16x32_bf16 v[208:211], a[24:27], a[236:239], v[208:211]
    v_mfma_f32_16x16x32_bf16 v[204:207], a[28:31], a[236:239], v[204:207]
    v_mfma_f32_16x16x32_bf16 v[200:203], a[32:35], a[236:239], v[200:203]
    v_mfma_f32_16x16x32_bf16 v[220:223], a[236:239], a[96:99], v[220:223]
    v_mfma_f32_16x16x32_bf16 v[216:219], a[236:239], a[100:103], v[216:219]
    v_mfma_f32_16x16x32_bf16 v[212:215], a[236:239], a[104:107], v[212:215]
    ds_read_b128 a[236:239], v225 offset:27584
    v_mfma_f32_16x16x32_bf16 v[208:211], a[36:39], a[240:243], v[208:211]
    v_mfma_f32_16x16x32_bf16 v[204:207], a[40:43], a[240:243], v[204:207]
    v_mfma_f32_16x16x32_bf16 v[200:203], a[44:47], a[240:243], v[200:203]
    v_mfma_f32_16x16x32_bf16 v[220:223], a[240:243], a[108:111], v[220:223]
    v_mfma_f32_16x16x32_bf16 v[216:219], a[240:243], a[112:115], v[216:219]
    v_mfma_f32_16x16x32_bf16 v[212:215], a[240:243], a[116:119], v[212:215]
    ds_read_b128 a[240:243], v225 offset:27648
    v_mfma_f32_16x16x32_bf16 v[208:211], a[48:51], a[244:247], v[208:211]
    v_mfma_f32_16x16x32_bf16 v[204:207], a[52:55], a[244:247], v[204:207]
    v_mfma_f32_16x16x32_bf16 v[200:203], a[56:59], a[244:247], v[200:203]
    v_mfma_f32_16x16x32_bf16 v[220:223], a[244:247], a[120:123], v[220:223]
    v_mfma_f32_16x16x32_bf16 v[216:219], a[244:247], a[124:127], v[216:219]
    v_mfma_f32_16x16x32_bf16 v[212:215], a[244:247], a[128:131], v[212:215]
    ds_read_b128 a[244:247], v225 offset:27712
    v_mfma_f32_16x16x32_bf16 v[208:211], a[60:63], v[252:255], v[208:211]
    v_mfma_f32_16x16x32_bf16 v[204:207], a[64:67], v[252:255], v[204:207]
    v_mfma_f32_16x16x32_bf16 v[200:203], a[68:71], v[252:255], v[200:203]
    v_mfma_f32_16x16x32_bf16 v[220:223], v[252:255], a[132:135], v[220:223]
    v_mfma_f32_16x16x32_bf16 v[216:219], v[252:255], a[136:139], v[216:219]
    v_mfma_f32_16x16x32_bf16 v[212:215], v[252:255], a[140:143], v[212:215]
    s_waitcnt lgkmcnt(1)
    ds_read_b128 v[252:255], v225 offset:27776
    s_nop 1
    v_cvt_pk_bf16_f32 v42, v208, v209
    v_cvt_pk_bf16_f32 v43, v210, v211
    v_mfma_f32_16x16x32_bf16 v[208:211], a[144:147], a[248:251], 0
    v_cvt_pk_bf16_f32 v44, v204, v205
    v_cvt_pk_bf16_f32 v45, v206, v207
    v_mfma_f32_16x16x32_bf16 v[204:207], a[148:151], a[248:251], 0
    v_cvt_pk_bf16_f32 v46, v200, v201
    v_cvt_pk_bf16_f32 v47, v202, v203
    v_mfma_f32_16x16x32_bf16 v[144:147], v[42:45], v[132:135], v[144:147]
    v_cvt_pk_bf16_f32 v78, v220, v221
    v_cvt_pk_bf16_f32 v79, v222, v223
    v_mfma_f32_16x16x32_bf16 v[200:203], a[152:155], a[248:251], 0
    v_cvt_pk_bf16_f32 v100, v216, v217
    v_cvt_pk_bf16_f32 v101, v218, v219
    v_mfma_f32_16x16x32_bf16 v[208:211], a[156:159], a[252:255], v[208:211]
    v_cvt_pk_bf16_f32 v122, v212, v213
    v_cvt_pk_bf16_f32 v123, v214, v215
    v_mfma_f32_16x16x16_bf16 v[144:147], v[46:47], v[136:137], v[144:147]
    s_waitcnt vmcnt(3) lgkmcnt(0)
    ds_read_b128 a[248:251], v225 offset:39872
    v_mfma_f32_16x16x32_bf16 v[204:207], a[160:163], a[252:255], v[204:207]
    s_barrier
    v_mfma_f32_16x16x32_bf16 v[200:203], a[164:167], a[252:255], v[200:203]
    ds_read_b128 a[252:255], v225 offset:39936
    v_mfma_f32_16x16x32_bf16 v[208:211], a[168:171], a[236:239], v[208:211]
    buffer_load_dwordx4 v246, s[4:7], s47 offen lds
    v_mfma_f32_16x16x32_bf16 v[204:207], a[172:175], a[236:239], v[204:207]
    s_add_u32 m0, s42, 0x3c80
    v_max3_f32 v249, v249, v144, v145
    v_max3_f32 v248, v248, v146, v147
    v_mfma_f32_16x16x32_bf16 v[200:203], a[176:179], a[236:239], v[200:203]
    ds_read_b128 a[236:239], v225 offset:40000
    v_max3_f32 v249, v249, v148, v149
    v_mfma_f32_16x16x32_bf16 v[208:211], a[180:183], a[240:243], v[208:211]
    v_max3_f32 v248, v248, v150, v151
    v_max_f32 v248, v248, v249
    v_mfma_f32_16x16x32_bf16 v[204:207], a[184:187], a[240:243], v[204:207]
    v_mov_b32 v249, v248
    v_mfma_f32_16x16x32_bf16 v[200:203], a[188:191], a[240:243], v[200:203]
    ds_read_b128 a[240:243], v225 offset:40064
    v_mfma_f32_16x16x32_bf16 v[208:211], a[192:195], a[244:247], v[208:211]
    v_permlane16_swap_b32 v248, v249
    v_mfma_f32_16x16x32_bf16 v[204:207], a[196:199], a[244:247], v[204:207]
    v_max_f32 v248, v248, v249
    v_mov_b32 v249, v248
    v_mfma_f32_16x16x32_bf16 v[200:203], a[200:203], a[244:247], v[200:203]
    ds_read_b128 a[244:247], v225 offset:40128
    v_mfma_f32_16x16x32_bf16 v[208:211], a[204:207], v[252:255], v[208:211]
    buffer_load_dwordx4 v247, s[4:7], s47 offen lds
    v_mfma_f32_16x16x32_bf16 v[204:207], a[208:211], v[252:255], v[204:207]
    s_add_u32 m0, s41, 0x5ac0
    v_permlane32_swap_b32 v248, v249
    v_mfma_f32_16x16x32_bf16 v[200:203], a[212:215], v[252:255], v[200:203]
    s_waitcnt lgkmcnt(3)
    ds_read_b128 v[252:255], v225 offset:40192
    v_max_f32 v248, v248, v249
    v_mfma_f32_16x16x32_bf16 v[220:223], a[144:147], a[248:251], 0
    v_cvt_pk_bf16_f32 v138, v208, v209
    v_cvt_pk_bf16_f32 v139, v210, v211
    v_mfma_f32_16x16x32_bf16 v[216:219], a[148:151], a[248:251], 0
    v_cvt_pk_bf16_f32 v140, v204, v205
    v_cvt_pk_bf16_f32 v141, v206, v207
    v_mfma_f32_16x16x32_bf16 v[212:215], a[152:155], a[248:251], 0
    v_cvt_pk_bf16_f32 v142, v200, v201
    v_cvt_pk_bf16_f32 v143, v202, v203
    v_mfma_f32_16x16x32_bf16 v[220:223], a[156:159], a[252:255], v[220:223]
    ds_read_b128 a[248:251], v239 offset:12288
    v_mul_f32 v236, s37, v248
    v_mfma_f32_16x16x32_bf16 v[216:219], a[160:163], a[252:255], v[216:219]
    v_fma_f32 v152, v152, s37, -v236
    v_fma_f32 v153, v153, s37, -v236
    v_mfma_f32_16x16x32_bf16 v[212:215], a[164:167], a[252:255], v[212:215]
    s_waitcnt lgkmcnt(3)
    buffer_load_dwordx4 v246, s[4:7], s48 offen lds
    v_mfma_f32_16x16x32_bf16 v[220:223], a[168:171], a[236:239], v[220:223]
    s_add_u32 m0, s42, 0x5ac0
    ds_read_b128 a[252:255], v240 offset:12288
    v_cndmask_b32 v246, v245, v243, vcc
    v_mfma_f32_16x16x32_bf16 v[216:219], a[172:175], a[236:239], v[216:219]
    v_fma_f32 v154, v154, s37, -v236
    v_fma_f32 v155, v155, s37, -v236
    v_mfma_f32_16x16x32_bf16 v[212:215], a[176:179], a[236:239], v[212:215]
    ds_read_b128 a[236:239], v239 offset:13312
    v_fma_f32 v156, v156, s37, -v236
    v_mfma_f32_16x16x32_bf16 v[220:223], a[180:183], a[240:243], v[220:223]
    v_exp_f32 v152, v152
    v_mfma_f32_16x16x32_bf16 v[216:219], a[184:187], a[240:243], v[216:219]
    v_exp_f32 v153, v153
    v_mfma_f32_16x16x32_bf16 v[212:215], a[188:191], a[240:243], v[212:215]
    s_waitcnt lgkmcnt(3)
    ds_read_b128 a[240:243], v240 offset:13312
    v_cvt_pk_bf16_f32 v176, v152, v153
    v_mfma_f32_16x16x32_bf16 v[220:223], a[192:195], a[244:247], v[220:223]
    v_exp_f32 v154, v154
    v_mfma_f32_16x16x32_bf16 v[216:219], a[196:199], a[244:247], v[216:219]
    buffer_load_dwordx4 v247, s[4:7], s48 offen lds
    v_mfma_f32_16x16x32_bf16 v[212:215], a[200:203], a[244:247], v[212:215]
    ds_read_b128 a[244:247], v241 offset:12288
    v_bfrev_b32 v247, 1
    v_mfma_f32_16x16x32_bf16 v[220:223], a[204:207], v[252:255], v[220:223]
    v_exp_f32 v155, v155
    v_mfma_f32_16x16x32_bf16 v[216:219], a[208:211], v[252:255], v[216:219]
    v_cvt_pk_bf16_f32 v177, v154, v155
    v_fma_f32 v157, v157, s37, -v236
    v_mfma_f32_16x16x32_bf16 v[212:215], a[212:215], v[252:255], v[212:215]
    s_waitcnt lgkmcnt(3)
    ds_read_b128 v[252:255], v241 offset:12800
    ds_read_b128 v[152:155], v230 offset:640
    v_mfma_f32_16x16x32_bf16 v[208:211], a[220:223], a[248:251], 0
    v_cvt_pk_bf16_f32 v132, v220, v221
    v_cvt_pk_bf16_f32 v133, v222, v223
    v_mfma_f32_16x16x32_bf16 v[200:203], a[220:223], a[252:255], 0
    v_cvt_pk_bf16_f32 v134, v216, v217
    v_cvt_pk_bf16_f32 v135, v218, v219
    v_mfma_f32_16x16x32_bf16 v[204:207], a[224:227], a[248:251], 0
    v_cvt_pk_bf16_f32 v136, v212, v213
    v_cvt_pk_bf16_f32 v137, v214, v215
    v_mfma_f32_16x16x32_bf16 v[220:223], a[224:227], a[252:255], 0
    ds_read_b128 a[252:255], v242 offset:12800
    v_fma_f32 v158, v158, s37, -v236
    v_mfma_f32_16x16x32_bf16 v[216:219], a[228:231], a[248:251], 0
    v_fma_f32 v159, v159, s37, -v236
    v_fma_f32 v160, v160, s37, -v236
    v_mfma_f32_16x16x32_bf16 v[212:215], a[232:235], a[248:251], 0
    s_waitcnt lgkmcnt(3)
    ds_read_b128 a[248:251], v242 offset:12288
    v_fma_f32 v161, v161, s37, -v236
    v_mfma_f32_16x16x32_bf16 v[208:211], a[244:247], a[236:239], v[208:211]
    v_exp_f32 v156, v156
    v_mfma_f32_16x16x32_bf16 v[200:203], a[244:247], a[240:243], v[200:203]
    s_waitcnt lgkmcnt(3)
    ds_read_b128 a[244:247], v241 offset:24576
    v_fma_f32 v162, v162, s37, -v236
    v_mfma_f32_16x16x32_bf16 v[204:207], v[252:255], a[236:239], v[204:207]
    s_waitcnt lgkmcnt(3)
    v_exp_f32 v157, v157
    v_mfma_f32_16x16x32_bf16 v[152:155], v[24:27], v[138:141], v[152:155]
    v_exp_f32 v158, v158
    v_mfma_f32_16x16x32_bf16 v[220:223], v[252:255], a[240:243], v[220:223]
    s_waitcnt lgkmcnt(2)
    ds_read_b128 a[240:243], v240 offset:14336
    ds_read_b128 v[252:255], v241 offset:25088
    v_exp_f32 v159, v159
    v_mfma_f32_16x16x32_bf16 v[212:215], a[252:255], a[236:239], v[212:215]
    ds_read_b128 a[252:255], v242 offset:25088
    v_cvt_pk_bf16_f32 v178, v156, v157
    v_mfma_f32_16x16x16_bf16 v[152:155], v[28:29], v[142:143], v[152:155]
    s_waitcnt lgkmcnt(4)
    v_cvt_pk_bf16_f32 v179, v158, v159
    v_fma_f32 v163, v163, s37, -v236
    v_mfma_f32_16x16x32_bf16 v[216:219], a[248:251], a[236:239], v[216:219]
    ds_read_b128 a[236:239], v239 offset:14336
    ds_read_b128 a[248:251], v242 offset:24576
    v_mfma_f32_16x16x32_bf16 v[196:199], a[216:219], v[176:179], 0
    ds_read_b128 v[156:159], v230 offset:1280
    v_fma_f32 v164, v164, s37, -v236
    v_mfma_f32_16x16x32_bf16 v[184:187], v[66:69], v[176:179], 0
    v_exp_f32 v160, v160
    v_mfma_f32_16x16x32_bf16 v[188:191], v[88:91], v[176:179], 0
    v_exp_f32 v161, v161
    v_mfma_f32_16x16x32_bf16 v[192:195], v[110:113], v[176:179], 0
    s_waitcnt lgkmcnt(5)
    v_exp_f32 v162, v162
    v_mfma_f32_16x16x32_bf16 v[200:203], a[244:247], a[240:243], v[200:203]
    s_waitcnt lgkmcnt(4)
    v_exp_f32 v163, v163
    v_mfma_f32_16x16x32_bf16 v[220:223], v[252:255], a[240:243], v[220:223]
    s_waitcnt lgkmcnt(2)
    ds_read_b128 a[240:243], v240 offset:15360
    v_cvt_pk_bf16_f32 v180, v160, v161
    v_cvt_pk_bf16_f32 v181, v162, v163
    ds_read_b128 v[160:163], v230 offset:1920
    v_fma_f32 v165, v165, s37, -v236
    v_fma_f32 v166, v166, s37, -v236
    v_mfma_f32_16x16x32_bf16 v[208:211], a[244:247], a[236:239], v[208:211]
    ds_read_b128 a[244:247], v241 offset:36864
    v_fma_f32 v167, v167, s37, -v236
    v_mfma_f32_16x16x32_bf16 v[204:207], v[252:255], a[236:239], v[204:207]
    s_waitcnt lgkmcnt(4)
    ds_read_b128 v[252:255], v241 offset:37376
    v_fma_f32 v168, v168, s37, -v236
    v_mfma_f32_16x16x32_bf16 v[216:219], a[248:251], a[236:239], v[216:219]
    s_waitcnt lgkmcnt(4)
    ds_read_b128 a[248:251], v242 offset:36864
    v_fma_f32 v169, v169, s37, -v236
    v_mfma_f32_16x16x32_bf16 v[156:159], v[30:33], v[138:141], v[156:159]
    v_exp_f32 v164, v164
    v_mfma_f32_16x16x32_bf16 v[212:215], a[252:255], a[236:239], v[212:215]
    ds_read_b128 a[236:239], v239 offset:15360
    ds_read_b128 a[252:255], v242 offset:37376
    v_exp_f32 v165, v165
    v_exp_f32 v166, v166
    v_mfma_f32_16x16x16_bf16 v[156:159], v[34:35], v[142:143], v[156:159]
    s_waitcnt lgkmcnt(5)
    v_exp_f32 v167, v167
    v_cvt_pk_bf16_f32 v182, v164, v165
    v_cvt_pk_bf16_f32 v183, v166, v167
    ds_read_b128 v[164:167], v230 offset:2560
    v_mfma_f32_16x16x32_bf16 v[160:163], v[36:39], v[138:141], v[160:163]
    v_fma_f32 v170, v170, s37, -v236
    v_fma_f32 v171, v171, s37, -v236
    v_mfma_f32_16x16x32_bf16 v[196:199], a[216:219], v[180:183], v[196:199]
    v_exp_f32 v168, v168
    v_mfma_f32_16x16x32_bf16 v[184:187], v[70:73], v[180:183], v[184:187]
    v_exp_f32 v169, v169
    v_mfma_f32_16x16x32_bf16 v[188:191], v[92:95], v[180:183], v[188:191]
    v_exp_f32 v170, v170
    v_mfma_f32_16x16x32_bf16 v[192:195], v[114:117], v[180:183], v[192:195]
    v_exp_f32 v171, v171
    v_mfma_f32_16x16x16_bf16 v[160:163], v[40:41], v[142:143], v[160:163]
    s_waitcnt lgkmcnt(2)
    v_cvt_pk_bf16_f32 v176, v168, v169
    v_cvt_pk_bf16_f32 v177, v170, v171
    v_mfma_f32_16x16x32_bf16 v[208:211], a[244:247], a[236:239], v[208:211]
    ds_read_b128 v[168:171], v235
    v_mad_u32_u24 v235, v234, s40, v229
    v_mfma_f32_16x16x32_bf16 v[200:203], a[244:247], a[240:243], v[200:203]
    ds_read_b128 a[244:247], v241 offset:49152
    v_mad_u32_u24 v234, v234, s40, v228
    v_mfma_f32_16x16x32_bf16 v[204:207], v[252:255], a[236:239], v[204:207]
    s_waitcnt lgkmcnt(2)
    v_fma_f32 v172, v172, s37, -v236
    v_fma_f32 v173, v173, s37, -v236
    v_mfma_f32_16x16x32_bf16 v[164:167], v[42:45], v[138:141], v[164:167]
    v_fma_f32 v174, v174, s37, -v236
    v_fma_f32 v175, v175, s37, -v236
    v_mfma_f32_16x16x32_bf16 v[220:223], v[252:255], a[240:243], v[220:223]
    ds_read_b128 a[240:243], v240 offset:16384
    ds_read_b128 v[252:255], v241 offset:49664
    v_mfma_f32_16x16x32_bf16 v[216:219], a[248:251], a[236:239], v[216:219]
    ds_read_b128 a[248:251], v242 offset:49152
    v_fma_f32 v144, v144, s37, -v236
    v_mfma_f32_16x16x16_bf16 v[164:167], v[46:47], v[142:143], v[164:167]
    v_exp_f32 v172, v172
    v_mfma_f32_16x16x32_bf16 v[212:215], a[252:255], a[236:239], v[212:215]
    s_waitcnt lgkmcnt(4)
    ds_read_b128 a[236:239], v239 offset:16384
    ds_read_b128 a[252:255], v242 offset:49664
    v_exp_f32 v173, v173
    v_exp_f32 v174, v174
    v_mfma_f32_16x16x32_bf16 v[168:171], v[60:63], v[138:141], v[168:171]
    v_exp_f32 v175, v175
    v_cvt_pk_bf16_f32 v178, v172, v173
    v_cvt_pk_bf16_f32 v179, v174, v175
    ds_read_b128 v[172:175], v250
    v_bfe_u32 v250, s74, v232, 4
    v_mfma_f32_16x16x32_bf16 v[196:199], a[216:219], v[176:179], v[196:199]
    v_fma_f32 v145, v145, s37, -v236
    v_fma_f32 v146, v146, s37, -v236
    v_mfma_f32_16x16x32_bf16 v[184:187], v[74:77], v[176:179], v[184:187]
    v_fma_f32 v147, v147, s37, -v236
    v_fma_f32 v148, v148, s37, -v236
    v_mfma_f32_16x16x32_bf16 v[188:191], v[96:99], v[176:179], v[188:191]
    v_exp_f32 v144, v144
    v_mfma_f32_16x16x32_bf16 v[192:195], v[118:121], v[176:179], v[192:195]
    v_exp_f32 v145, v145
    v_mfma_f32_16x16x16_bf16 v[168:171], v[64:65], v[142:143], v[168:171]
    s_waitcnt lgkmcnt(2)
    v_exp_f32 v146, v146
    v_mfma_f32_16x16x32_bf16 v[208:211], a[244:247], a[236:239], v[208:211]
    v_exp_f32 v147, v147
    v_mfma_f32_16x16x32_bf16 v[200:203], a[244:247], a[240:243], v[200:203]
    ds_read_b128 a[244:247], v241 offset:61440
    v_cvt_pk_bf16_f32 v180, v144, v145
    v_mfma_f32_16x16x32_bf16 v[204:207], v[252:255], a[236:239], v[204:207]
    s_waitcnt lgkmcnt(1)
    v_cvt_pk_bf16_f32 v181, v146, v147
    v_fma_f32 v149, v149, s37, -v236
    v_mfma_f32_16x16x32_bf16 v[172:175], v[48:51], v[138:141], v[172:175]
    ds_read_b128 v[144:147], v235
    v_bfe_u32 v235, s74, v232, 4
    v_mfma_f32_16x16x32_bf16 v[220:223], v[252:255], a[240:243], v[220:223]
    ds_read_b128 a[240:243], v240 offset:17408
    v_mad_u32_u24 v235, v235, s40, v230
    v_mfma_f32_16x16x32_bf16 v[216:219], a[248:251], a[236:239], v[216:219]
    ds_read_b128 v[252:255], v241 offset:61952
    v_fma_f32 v150, v150, s37, -v236
    v_mfma_f32_16x16x16_bf16 v[172:175], v[52:53], v[142:143], v[172:175]
    ds_read_b128 a[248:251], v242 offset:61440
    v_fma_f32 v151, v151, s37, -v236
    v_mfma_f32_16x16x32_bf16 v[212:215], a[252:255], a[236:239], v[212:215]
    ds_read_b128 a[236:239], v239 offset:17408
    v_exp_f32 v148, v148
    ds_read_b128 a[252:255], v242 offset:61952
    v_exp_f32 v149, v149
    v_exp_f32 v150, v150
    v_exp_f32 v151, v151
    v_cvt_pk_bf16_f32 v182, v148, v149
    v_cvt_pk_bf16_f32 v183, v150, v151
    ds_read_b128 v[148:151], v234
    v_mad_u32_u24 v234, v250, s40, v228
    v_mfma_f32_16x16x32_bf16 v[196:199], a[216:219], v[180:183], v[196:199]
    v_mad_u32_u24 v250, v250, s40, v229
    v_max3_f32 v248, v152, v153, v154
    v_mfma_f32_16x16x32_bf16 v[184:187], v[78:81], v[180:183], v[184:187]
    v_max3_f32 v249, v155, v156, v157
    v_max3_f32 v248, v248, v158, v159
    v_mfma_f32_16x16x32_bf16 v[188:191], v[100:103], v[180:183], v[188:191]
    v_max3_f32 v249, v249, v160, v161
    v_max3_f32 v248, v248, v162, v163
    v_mfma_f32_16x16x32_bf16 v[192:195], v[122:125], v[180:183], v[192:195]
    s_waitcnt lgkmcnt(4)
    v_rcp_f32 v197, v196
    v_mfma_f32_16x16x32_bf16 v[144:147], v[30:33], v[132:135], v[144:147]
    s_waitcnt lgkmcnt(2)
    v_mul_f32 v184, v184, v197
    v_mul_f32 v185, v185, v197
    v_mfma_f32_16x16x32_bf16 v[208:211], a[244:247], a[236:239], v[208:211]
    v_cvt_pk_bf16_f32 v184, v184, v185
    v_mul_f32 v186, v186, v197
    v_mfma_f32_16x16x32_bf16 v[200:203], a[244:247], a[240:243], v[200:203]
    ds_read_b128 a[244:247], v224 offset:128
    v_mul_f32 v187, v187, v197
    v_mfma_f32_16x16x16_bf16 v[144:147], v[34:35], v[136:137], v[144:147]
    s_waitcnt lgkmcnt(1)
    v_cvt_pk_bf16_f32 v185, v186, v187
    v_mul_f32 v188, v188, v197
    v_mfma_f32_16x16x32_bf16 v[148:151], v[6:9], v[132:135], v[148:151]
    v_cvt_pk_bf16_f32 v208, v208, v209
    v_cvt_pk_bf16_f32 v209, v210, v211
    v_mfma_f32_16x16x32_bf16 v[204:207], v[252:255], a[236:239], v[204:207]
    v_cvt_pk_bf16_f32 v200, v200, v201
    v_cvt_pk_bf16_f32 v201, v202, v203
    v_mfma_f32_16x16x32_bf16 v[220:223], v[252:255], a[240:243], v[220:223]
    ds_read_b128 a[240:243], v224 offset:64
    ds_read_b128 v[252:255], v224 offset:192
    v_mfma_f32_16x16x16_bf16 v[148:151], v[10:11], v[136:137], v[148:151]
    v_mul_f32 v189, v189, v197
    v_cvt_pk_bf16_f32 v186, v188, v189
    v_mfma_f32_16x16x32_bf16 v[216:219], a[248:251], a[236:239], v[216:219]
    ds_read_b128 a[248:251], v224 offset:256
    v_cvt_pk_bf16_f32 v210, v204, v205
    v_mfma_f32_16x16x32_bf16 v[212:215], a[252:255], a[236:239], v[212:215]
    ds_read_b128 a[236:239], v224
    ds_read_b128 a[252:255], v224 offset:320
    v_cvt_pk_bf16_f32 v211, v206, v207
    buffer_store_dwordx4 v[208:211], v243, s[20:23], s58 offen sc0 sc1
    v_cvt_pk_bf16_f32 v202, v220, v221
    v_cvt_pk_bf16_f32 v203, v222, v223
    v_cvt_pk_bf16_f32 v216, v216, v217
    v_cvt_pk_bf16_f32 v217, v218, v219
    v_cvt_pk_bf16_f32 v218, v212, v213
    v_cvt_pk_bf16_f32 v219, v214, v215
    v_mul_f32 v190, v190, v197
    v_mul_f32 v191, v191, v197
    v_cvt_pk_bf16_f32 v187, v190, v191
    v_mul_f32 v192, v192, v197
    v_mul_f32 v193, v193, v197
    v_cvt_pk_bf16_f32 v188, v192, v193
    v_mul_f32 v194, v194, v197
    v_mul_f32 v195, v195, v197
    v_cvt_pk_bf16_f32 v189, v194, v195
    ds_write_b128 v237, v[184:187]
    s_waitcnt lgkmcnt(2)
    v_mfma_f32_16x16x32_bf16 v[208:211], a[0:3], a[236:239], 0
    ds_write_b64 v238, v[188:189]
    v_mfma_f32_16x16x32_bf16 v[204:207], a[4:7], a[236:239], 0
    v_max3_f32 v249, v249, v164, v165
    v_max3_f32 v248, v248, v166, v167
    v_mfma_f32_16x16x32_bf16 v[220:223], a[236:239], a[72:75], 0
    v_max3_f32 v249, v249, v168, v169
    v_max3_f32 v248, v248, v170, v171
    v_mfma_f32_16x16x32_bf16 v[212:215], a[236:239], a[80:83], 0
    v_max3_f32 v249, v249, v172, v173
    v_max3_f32 v248, v248, v174, v175
    v_mfma_f32_16x16x32_bf16 v[208:211], a[12:15], a[240:243], v[208:211]
    v_max_f32 v248, v248, v249
    v_mov_b32 v249, v248
    v_mfma_f32_16x16x32_bf16 v[204:207], a[16:19], a[240:243], v[204:207]
    buffer_store_dwordx4 v[200:203], v245, s[20:23], s58 offen sc0 sc1
    v_mfma_f32_16x16x32_bf16 v[220:223], a[240:243], a[84:87], v[220:223]
    v_permlane16_swap_b32 v248, v249
    v_mfma_f32_16x16x32_bf16 v[200:203], a[8:11], a[236:239], 0
    v_max_f32 v248, v248, v249
    v_mov_b32 v249, v248
    v_mfma_f32_16x16x32_bf16 v[200:203], a[20:23], a[240:243], v[200:203]
    v_mfma_f32_16x16x32_bf16 v[212:215], a[240:243], a[92:95], v[212:215]
    v_permlane32_swap_b32 v248, v249
    v_mfma_f32_16x16x32_bf16 v[208:211], a[24:27], a[244:247], v[208:211]
    v_max_f32 v248, v248, v249
    v_mul_f32 v236, s37, v248
    v_mfma_f32_16x16x32_bf16 v[204:207], a[28:31], a[244:247], v[204:207]
    v_fma_f32 v152, v152, s37, -v236
    v_fma_f32 v153, v153, s37, -v236
    v_mfma_f32_16x16x32_bf16 v[200:203], a[32:35], a[244:247], v[200:203]
    v_fma_f32 v154, v154, s37, -v236
    v_fma_f32 v155, v155, s37, -v236
    v_mfma_f32_16x16x32_bf16 v[220:223], a[244:247], a[96:99], v[220:223]
    v_exp_f32 v152, v152
    v_mfma_f32_16x16x32_bf16 v[212:215], a[244:247], a[104:107], v[212:215]
    v_exp_f32 v153, v153
    v_mfma_f32_16x16x32_bf16 v[208:211], a[36:39], v[252:255], v[208:211]
    v_exp_f32 v154, v154
    v_mfma_f32_16x16x32_bf16 v[204:207], a[40:43], v[252:255], v[204:207]
    v_exp_f32 v155, v155
    v_mfma_f32_16x16x32_bf16 v[200:203], a[44:47], v[252:255], v[200:203]
    buffer_store_dwordx4 v[216:219], v244, s[20:23], s58 offen sc0 sc1
    v_mfma_f32_16x16x32_bf16 v[220:223], v[252:255], a[108:111], v[220:223]
    s_add_u32 s58, s51, 0x150000
    v_cvt_pk_bf16_f32 v176, v152, v153
    v_cvt_pk_bf16_f32 v177, v154, v155
    v_mfma_f32_16x16x32_bf16 v[216:219], a[236:239], a[76:79], 0
    ds_read_b128 a[236:239], v224 offset:3072
    ds_read_b128 v[152:155], v228 offset:1280
    v_mfma_f32_16x16x32_bf16 v[216:219], a[240:243], a[88:91], v[216:219]
    v_fma_f32 v156, v156, s37, -v236
    v_fma_f32 v157, v157, s37, -v236
    v_mfma_f32_16x16x32_bf16 v[216:219], a[244:247], a[100:103], v[216:219]
    ds_read_b128 a[240:243], v224 offset:3136
    v_fma_f32 v158, v158, s37, -v236
    v_mfma_f32_16x16x32_bf16 v[216:219], v[252:255], a[112:115], v[216:219]
    ds_read_b128 a[244:247], v224 offset:3200
    v_fma_f32 v159, v159, s37, -v236
    v_mfma_f32_16x16x32_bf16 v[212:215], v[252:255], a[116:119], v[212:215]
    ds_read_b128 v[252:255], v224 offset:3264
    v_fma_f32 v160, v160, s37, -v236
    v_mfma_f32_16x16x32_bf16 v[208:211], a[48:51], a[248:251], v[208:211]
    v_exp_f32 v156, v156
    v_mfma_f32_16x16x32_bf16 v[204:207], a[52:55], a[248:251], v[204:207]
    v_exp_f32 v157, v157
    v_mfma_f32_16x16x32_bf16 v[200:203], a[56:59], a[248:251], v[200:203]
    v_exp_f32 v158, v158
    v_mfma_f32_16x16x32_bf16 v[220:223], a[248:251], a[120:123], v[220:223]
    v_exp_f32 v159, v159
    v_mfma_f32_16x16x32_bf16 v[216:219], a[248:251], a[124:127], v[216:219]
    s_waitcnt lgkmcnt(3)
    v_cvt_pk_bf16_f32 v178, v156, v157
    v_cvt_pk_bf16_f32 v179, v158, v159
    v_mfma_f32_16x16x32_bf16 v[152:155], v[12:15], v[132:135], v[152:155]
    ds_read_b128 v[156:159], v229 offset:1280
    v_fma_f32 v161, v161, s37, -v236
    v_mfma_f32_16x16x32_bf16 v[196:199], a[216:219], v[176:179], 0
    v_fma_f32 v162, v162, s37, -v236
    v_fma_f32 v163, v163, s37, -v236
    v_mfma_f32_16x16x32_bf16 v[184:187], v[68:71], v[176:179], 0
    v_exp_f32 v160, v160
    v_mfma_f32_16x16x32_bf16 v[188:191], v[90:93], v[176:179], 0
    v_exp_f32 v161, v161
    v_mfma_f32_16x16x32_bf16 v[192:195], v[112:115], v[176:179], 0
    v_exp_f32 v162, v162
    v_mfma_f32_16x16x16_bf16 v[152:155], v[16:17], v[136:137], v[152:155]
    v_exp_f32 v163, v163
    v_mfma_f32_16x16x32_bf16 v[212:215], a[248:251], a[128:131], v[212:215]
    ds_read_b128 a[248:251], v224 offset:3328
    v_cvt_pk_bf16_f32 v180, v160, v161
    v_mfma_f32_16x16x32_bf16 v[208:211], a[60:63], a[252:255], v[208:211]
    v_cvt_pk_bf16_f32 v181, v162, v163
    v_fma_f32 v164, v164, s37, -v236
    v_mfma_f32_16x16x32_bf16 v[204:207], a[64:67], a[252:255], v[204:207]
    s_waitcnt lgkmcnt(1)
    ds_read_b128 v[160:163], v229 offset:1920
    v_fma_f32 v165, v165, s37, -v236
    v_mfma_f32_16x16x32_bf16 v[156:159], v[36:39], v[132:135], v[156:159]
    v_fma_f32 v166, v166, s37, -v236
    v_fma_f32 v167, v167, s37, -v236
    v_mfma_f32_16x16x32_bf16 v[200:203], a[68:71], a[252:255], v[200:203]
    v_cvt_pk_bf16_f32 v0, v208, v209
    v_cvt_pk_bf16_f32 v1, v210, v211
    v_mfma_f32_16x16x32_bf16 v[220:223], a[252:255], a[132:135], v[220:223]
    v_cvt_pk_bf16_f32 v2, v204, v205
    v_cvt_pk_bf16_f32 v3, v206, v207
    v_mfma_f32_16x16x16_bf16 v[156:159], v[40:41], v[136:137], v[156:159]
    v_exp_f32 v164, v164
    v_mfma_f32_16x16x32_bf16 v[216:219], a[252:255], a[136:139], v[216:219]
    v_cvt_pk_bf16_f32 v4, v200, v201
    v_cvt_pk_bf16_f32 v5, v202, v203
    v_mfma_f32_16x16x32_bf16 v[212:215], a[252:255], a[140:143], v[212:215]
    v_cvt_pk_bf16_f32 v66, v220, v221
    v_cvt_pk_bf16_f32 v67, v222, v223
    v_mfma_f32_16x16x32_bf16 v[208:211], a[0:3], a[236:239], 0
    ds_read_b128 a[252:255], v224 offset:3392
    v_fma_f32 v168, v168, s37, -v236
    v_mfma_f32_16x16x32_bf16 v[204:207], a[4:7], a[236:239], 0
    s_waitcnt lgkmcnt(1)
    v_cvt_pk_bf16_f32 v88, v216, v217
    v_cvt_pk_bf16_f32 v89, v218, v219
    v_mfma_f32_16x16x32_bf16 v[160:163], v[42:45], v[132:135], v[160:163]
    v_cvt_pk_bf16_f32 v110, v212, v213
    v_cvt_pk_bf16_f32 v111, v214, v215
    v_mfma_f32_16x16x32_bf16 v[200:203], a[8:11], a[236:239], 0
    v_exp_f32 v165, v165
    v_mfma_f32_16x16x32_bf16 v[220:223], a[236:239], a[72:75], 0
    v_exp_f32 v166, v166
    v_mfma_f32_16x16x16_bf16 v[160:163], v[46:47], v[136:137], v[160:163]
    v_exp_f32 v167, v167
    v_mfma_f32_16x16x32_bf16 v[216:219], a[236:239], a[76:79], 0
    v_cvt_pk_bf16_f32 v182, v164, v165
    v_cvt_pk_bf16_f32 v183, v166, v167
    v_mfma_f32_16x16x32_bf16 v[212:215], a[236:239], a[80:83], 0
    ds_read_b128 a[236:239], v225 offset:42944
    ds_read_b128 v[164:167], v228 offset:1920
    v_mfma_f32_16x16x32_bf16 v[196:199], a[216:219], v[180:183], v[196:199]
    v_fma_f32 v169, v169, s37, -v236
    v_fma_f32 v170, v170, s37, -v236
    v_mfma_f32_16x16x32_bf16 v[184:187], v[76:79], v[180:183], v[184:187]
    v_fma_f32 v171, v171, s37, -v236
    v_fma_f32 v172, v172, s37, -v236
    v_mfma_f32_16x16x32_bf16 v[188:191], v[98:101], v[180:183], v[188:191]
    v_exp_f32 v168, v168
    v_mfma_f32_16x16x32_bf16 v[192:195], v[120:123], v[180:183], v[192:195]
    v_exp_f32 v169, v169
    v_mfma_f32_16x16x32_bf16 v[208:211], a[12:15], a[240:243], v[208:211]
    v_exp_f32 v170, v170
    v_mfma_f32_16x16x32_bf16 v[204:207], a[16:19], a[240:243], v[204:207]
    v_exp_f32 v171, v171
    v_mfma_f32_16x16x32_bf16 v[200:203], a[20:23], a[240:243], v[200:203]
    v_cvt_pk_bf16_f32 v176, v168, v169
    v_cvt_pk_bf16_f32 v177, v170, v171
    v_mfma_f32_16x16x32_bf16 v[220:223], a[240:243], a[84:87], v[220:223]
    ds_read_b128 v[168:171], v234
    v_bfe_u32 v234, s67, v233, 4
    v_mfma_f32_16x16x16_bf16 v[196:199], a[216:217], v[176:177], v[196:199]
    v_mad_u32_u24 v234, v234, s40, v231
    v_fma_f32 v173, v173, s37, -v236
    v_mfma_f32_16x16x16_bf16 v[184:187], v[86:87], v[176:177], v[184:187]
    v_fma_f32 v174, v174, s37, -v236
    v_fma_f32 v175, v175, s37, -v236
    v_mfma_f32_16x16x16_bf16 v[188:191], v[108:109], v[176:177], v[188:191]
    v_exp_f32 v172, v172
    v_mfma_f32_16x16x16_bf16 v[192:195], v[130:131], v[176:177], v[192:195]
    s_waitcnt lgkmcnt(1)
    v_exp_f32 v173, v173
    v_mfma_f32_16x16x32_bf16 v[164:167], v[18:21], v[132:135], v[164:167]
    v_exp_f32 v174, v174
    v_mfma_f32_16x16x32_bf16 v[216:219], a[240:243], a[88:91], v[216:219]
    v_exp_f32 v175, v175
    v_mfma_f32_16x16x32_bf16 v[212:215], a[240:243], a[92:95], v[212:215]
    ds_read_b128 a[240:243], v225 offset:43008
    v_cvt_pk_bf16_f32 v180, v172, v173
    v_mfma_f32_16x16x16_bf16 v[164:167], v[22:23], v[136:137], v[164:167]
    s_waitcnt lgkmcnt(1)
    v_cvt_pk_bf16_f32 v181, v174, v175
    v_max3_f32 v248, v144, v145, v146
    v_mfma_f32_16x16x32_bf16 v[168:171], v[0:3], v[132:135], v[168:171]
    ds_read_b128 v[172:175], v250
    v_bfe_u32 v250, s73, v232, 4
    v_mfma_f32_16x16x16_bf16 v[196:199], a[216:217], v[180:181], v[196:199]
    v_mad_u32_u24 v250, v250, s40, v230
    v_max3_f32 v249, v147, v148, v149
    v_mfma_f32_16x16x16_bf16 v[184:187], v[82:83], v[180:181], v[184:187]
    v_max3_f32 v248, v248, v150, v151
    v_max3_f32 v249, v249, v152, v153
    v_mfma_f32_16x16x16_bf16 v[188:191], v[104:105], v[180:181], v[188:191]
    v_max3_f32 v248, v248, v154, v155
    v_max3_f32 v249, v249, v156, v157
    v_mfma_f32_16x16x16_bf16 v[192:195], v[126:127], v[180:181], v[192:195]
    v_rcp_f32 v197, v196
    v_mfma_f32_16x16x16_bf16 v[168:171], v[4:5], v[136:137], v[168:171]
    v_mul_f32 v184, v184, v197
    v_mul_f32 v185, v185, v197
    v_mfma_f32_16x16x32_bf16 v[208:211], a[24:27], a[244:247], v[208:211]
    v_cvt_pk_bf16_f32 v184, v184, v185
    v_mul_f32 v186, v186, v197
    v_mfma_f32_16x16x32_bf16 v[204:207], a[28:31], a[244:247], v[204:207]
    v_mul_f32 v187, v187, v197
    v_cvt_pk_bf16_f32 v185, v186, v187
    v_mfma_f32_16x16x32_bf16 v[200:203], a[32:35], a[244:247], v[200:203]
    v_mul_f32 v188, v188, v197
    v_mul_f32 v189, v189, v197
    v_mfma_f32_16x16x32_bf16 v[220:223], a[244:247], a[96:99], v[220:223]
    v_cvt_pk_bf16_f32 v186, v188, v189
    v_mul_f32 v190, v190, v197
    v_mfma_f32_16x16x32_bf16 v[216:219], a[244:247], a[100:103], v[216:219]
    v_mul_f32 v191, v191, v197
    v_cvt_pk_bf16_f32 v187, v190, v191
    v_mfma_f32_16x16x32_bf16 v[212:215], a[244:247], a[104:107], v[212:215]
    ds_read_b128 a[244:247], v225 offset:43072
    v_mul_f32 v192, v192, v197
    v_mfma_f32_16x16x32_bf16 v[208:211], a[36:39], v[252:255], v[208:211]
    v_mul_f32 v193, v193, v197
    v_cvt_pk_bf16_f32 v188, v192, v193
    v_mfma_f32_16x16x32_bf16 v[204:207], a[40:43], v[252:255], v[204:207]
    v_mul_f32 v194, v194, v197
    v_mul_f32 v195, v195, v197
    v_mfma_f32_16x16x32_bf16 v[200:203], a[44:47], v[252:255], v[200:203]
    v_cvt_pk_bf16_f32 v189, v194, v195
    v_max3_f32 v248, v248, v158, v159
    v_mfma_f32_16x16x32_bf16 v[220:223], v[252:255], a[108:111], v[220:223]
    ds_write_b128 v237, v[184:187] offset:6144
    v_mfma_f32_16x16x32_bf16 v[216:219], v[252:255], a[112:115], v[216:219]
    ds_write_b64 v238, v[188:189] offset:6144
    v_mfma_f32_16x16x32_bf16 v[212:215], v[252:255], a[116:119], v[212:215]
    v_max3_f32 v249, v249, v160, v161
    v_max3_f32 v248, v248, v162, v163
    v_mfma_f32_16x16x32_bf16 v[208:211], a[48:51], a[248:251], v[208:211]
    v_max3_f32 v249, v249, v164, v165
    v_max3_f32 v248, v248, v166, v167
    v_mfma_f32_16x16x32_bf16 v[204:207], a[52:55], a[248:251], v[204:207]
    v_max3_f32 v249, v249, v168, v169
    v_max3_f32 v248, v248, v170, v171
    v_mfma_f32_16x16x32_bf16 v[200:203], a[56:59], a[248:251], v[200:203]
    ds_read_b128 v[252:255], v225 offset:43136
    v_mfma_f32_16x16x32_bf16 v[220:223], a[248:251], a[120:123], v[220:223]
    v_mfma_f32_16x16x32_bf16 v[216:219], a[248:251], a[124:127], v[216:219]
    v_mfma_f32_16x16x32_bf16 v[212:215], a[248:251], a[128:131], v[212:215]
    ds_read_b128 a[248:251], v225 offset:43200
    v_mfma_f32_16x16x32_bf16 v[208:211], a[60:63], a[252:255], v[208:211]
    v_mfma_f32_16x16x32_bf16 v[204:207], a[64:67], a[252:255], v[204:207]
    v_mfma_f32_16x16x32_bf16 v[200:203], a[68:71], a[252:255], v[200:203]
    s_waitcnt vmcnt(3) lgkmcnt(2)
    v_mfma_f32_16x16x32_bf16 v[220:223], a[252:255], a[132:135], v[220:223]
    s_barrier
    v_mfma_f32_16x16x32_bf16 v[216:219], a[252:255], a[136:139], v[216:219]
    v_mfma_f32_16x16x32_bf16 v[212:215], a[252:255], a[140:143], v[212:215]
    ds_read_b128 a[252:255], v225 offset:43264
    v_cndmask_b32 v225, v243, v245, vcc
    v_cvt_pk_bf16_f32 v24, v208, v209
    v_cvt_pk_bf16_f32 v25, v210, v211
    v_mfma_f32_16x16x32_bf16 v[208:211], a[144:147], a[236:239], 0
    v_cvt_pk_bf16_f32 v26, v204, v205
    v_cvt_pk_bf16_f32 v27, v206, v207
    v_mfma_f32_16x16x32_bf16 v[204:207], a[148:151], a[236:239], 0
    v_cvt_pk_bf16_f32 v28, v200, v201
    v_cvt_pk_bf16_f32 v29, v202, v203
    v_mfma_f32_16x16x32_bf16 v[172:175], v[24:27], v[132:135], v[172:175]
    v_cvt_pk_bf16_f32 v68, v220, v221
    v_cvt_pk_bf16_f32 v69, v222, v223
    v_mfma_f32_16x16x32_bf16 v[200:203], a[152:155], a[236:239], 0
    v_cvt_pk_bf16_f32 v90, v216, v217
    v_cvt_pk_bf16_f32 v91, v218, v219
    v_mfma_f32_16x16x32_bf16 v[208:211], a[156:159], a[240:243], v[208:211]
    v_cvt_pk_bf16_f32 v112, v212, v213
    v_cvt_pk_bf16_f32 v113, v214, v215
    v_mfma_f32_16x16x16_bf16 v[172:175], v[28:29], v[136:137], v[172:175]
    ds_read_b128 a[236:239], v226 offset:1152
    v_mfma_f32_16x16x32_bf16 v[204:207], a[160:163], a[240:243], v[204:207]
    v_mfma_f32_16x16x32_bf16 v[200:203], a[164:167], a[240:243], v[200:203]
    ds_read_b128 a[240:243], v226 offset:1216
    v_mfma_f32_16x16x32_bf16 v[208:211], a[168:171], a[244:247], v[208:211]
    v_mfma_f32_16x16x32_bf16 v[204:207], a[172:175], a[244:247], v[204:207]
    v_mfma_f32_16x16x32_bf16 v[200:203], a[176:179], a[244:247], v[200:203]
    s_waitcnt lgkmcnt(2)
    ds_read_b128 a[244:247], v226 offset:1280
    v_max3_f32 v249, v249, v172, v173
    v_mfma_f32_16x16x32_bf16 v[208:211], a[180:183], v[252:255], v[208:211]
    v_max3_f32 v248, v248, v174, v175
    v_max_f32 v248, v248, v249
    v_mfma_f32_16x16x32_bf16 v[204:207], a[184:187], v[252:255], v[204:207]
    v_mov_b32 v249, v248
    v_mfma_f32_16x16x32_bf16 v[200:203], a[188:191], v[252:255], v[200:203]
    ds_read_b128 v[252:255], v226 offset:1344
    v_mfma_f32_16x16x32_bf16 v[208:211], a[192:195], a[248:251], v[208:211]
    v_permlane16_swap_b32 v248, v249
    v_mfma_f32_16x16x32_bf16 v[204:207], a[196:199], a[248:251], v[204:207]
    v_max_f32 v248, v248, v249
    v_mov_b32 v249, v248
    v_mfma_f32_16x16x32_bf16 v[200:203], a[200:203], a[248:251], v[200:203]
    ds_read_b128 a[248:251], v226 offset:1408
    v_mfma_f32_16x16x32_bf16 v[208:211], a[204:207], a[252:255], v[208:211]
    v_permlane32_swap_b32 v248, v249
    v_mfma_f32_16x16x32_bf16 v[204:207], a[208:211], a[252:255], v[204:207]
    v_max_f32 v248, v248, v249
    v_mul_f32 v236, s37, v248
    v_mfma_f32_16x16x32_bf16 v[200:203], a[212:215], a[252:255], v[200:203]
    s_waitcnt lgkmcnt(3)
    ds_read_b128 a[252:255], v226 offset:1472
    v_fma_f32 v144, v144, s37, -v236
    v_mfma_f32_16x16x32_bf16 v[220:223], a[144:147], a[236:239], 0
    v_cvt_pk_bf16_f32 v138, v208, v209
    v_cvt_pk_bf16_f32 v139, v210, v211
    v_mfma_f32_16x16x32_bf16 v[216:219], a[148:151], a[236:239], 0
    v_cvt_pk_bf16_f32 v140, v204, v205
    v_cvt_pk_bf16_f32 v141, v206, v207
    v_mfma_f32_16x16x32_bf16 v[212:215], a[152:155], a[236:239], 0
    v_cvt_pk_bf16_f32 v142, v200, v201
    v_cvt_pk_bf16_f32 v143, v202, v203
    v_mfma_f32_16x16x32_bf16 v[220:223], a[156:159], a[240:243], v[220:223]
    ds_read_b128 a[236:239], v227 offset:6144
    v_fma_f32 v145, v145, s37, -v236
    v_mfma_f32_16x16x32_bf16 v[216:219], a[160:163], a[240:243], v[216:219]
    v_fma_f32 v146, v146, s37, -v236
    v_fma_f32 v147, v147, s37, -v236
    v_mfma_f32_16x16x32_bf16 v[212:215], a[164:167], a[240:243], v[212:215]
    s_waitcnt lgkmcnt(3)
    ds_read_b128 a[240:243], v227 offset:6208
    v_fma_f32 v148, v148, s37, -v236
    v_mfma_f32_16x16x32_bf16 v[220:223], a[168:171], a[244:247], v[220:223]
    v_exp_f32 v144, v144
    v_mfma_f32_16x16x32_bf16 v[216:219], a[172:175], a[244:247], v[216:219]
    v_exp_f32 v145, v145
    v_mfma_f32_16x16x32_bf16 v[212:215], a[176:179], a[244:247], v[212:215]
    ds_read_b128 a[244:247], v227 offset:6272
    v_cvt_pk_bf16_f32 v176, v144, v145
    v_mfma_f32_16x16x32_bf16 v[220:223], a[180:183], v[252:255], v[220:223]
    v_exp_f32 v146, v146
    v_mfma_f32_16x16x32_bf16 v[216:219], a[184:187], v[252:255], v[216:219]
    v_exp_f32 v147, v147
    v_mfma_f32_16x16x32_bf16 v[212:215], a[188:191], v[252:255], v[212:215]
    s_waitcnt lgkmcnt(3)
    ds_read_b128 v[252:255], v227 offset:6336
    v_cvt_pk_bf16_f32 v177, v146, v147
    v_mfma_f32_16x16x32_bf16 v[220:223], a[192:195], a[248:251], v[220:223]
    ds_read_b128 v[144:147], v235
    v_bfe_u32 v235, s75, v233, 4
    v_mfma_f32_16x16x32_bf16 v[216:219], a[196:199], a[248:251], v[216:219]
    v_mad_u32_u24 v235, v235, s40, v231
    v_fma_f32 v149, v149, s37, -v236
    v_mfma_f32_16x16x32_bf16 v[212:215], a[200:203], a[248:251], v[212:215]
    ds_read_b128 a[248:251], v227 offset:6400
    v_fma_f32 v150, v150, s37, -v236
    v_mfma_f32_16x16x32_bf16 v[220:223], a[204:207], a[252:255], v[220:223]
    v_fma_f32 v151, v151, s37, -v236
    v_fma_f32 v152, v152, s37, -v236
    v_mfma_f32_16x16x32_bf16 v[216:219], a[208:211], a[252:255], v[216:219]
    v_exp_f32 v148, v148
    v_mfma_f32_16x16x32_bf16 v[212:215], a[212:215], a[252:255], v[212:215]
    s_waitcnt lgkmcnt(4)
    ds_read_b128 a[252:255], v227 offset:6464
    v_cndmask_b32 v227, v240, v239, vcc
    v_mfma_f32_16x16x32_bf16 v[208:211], a[0:3], a[236:239], 0
    v_cvt_pk_bf16_f32 v132, v220, v221
    v_cvt_pk_bf16_f32 v133, v222, v223
    v_mfma_f32_16x16x32_bf16 v[204:207], a[4:7], a[236:239], 0
    v_cvt_pk_bf16_f32 v134, v216, v217
    v_cvt_pk_bf16_f32 v135, v218, v219
    v_mfma_f32_16x16x32_bf16 v[200:203], a[8:11], a[236:239], 0
    s_waitcnt lgkmcnt(2)
    v_cvt_pk_bf16_f32 v136, v212, v213
    v_cvt_pk_bf16_f32 v137, v214, v215
    v_mfma_f32_16x16x32_bf16 v[144:147], v[24:27], v[138:141], v[144:147]
    v_exp_f32 v149, v149
    v_mfma_f32_16x16x32_bf16 v[220:223], a[236:239], a[72:75], 0
    v_exp_f32 v150, v150
    v_mfma_f32_16x16x32_bf16 v[216:219], a[236:239], a[76:79], 0
    v_exp_f32 v151, v151
    v_mfma_f32_16x16x32_bf16 v[212:215], a[236:239], a[80:83], 0
    ds_read_b128 a[236:239], v239
    v_cvt_pk_bf16_f32 v178, v148, v149
    v_mfma_f32_16x16x16_bf16 v[144:147], v[28:29], v[142:143], v[144:147]
    v_cvt_pk_bf16_f32 v179, v150, v151
    v_fma_f32 v153, v153, s37, -v236
    v_mfma_f32_16x16x32_bf16 v[208:211], a[12:15], a[240:243], v[208:211]
    ds_read_b128 v[148:151], v250
    v_bfe_u32 v250, s76, v233, 4
    v_mfma_f32_16x16x32_bf16 v[196:199], a[216:219], v[176:179], 0
    v_mad_u32_u24 v250, v250, s40, v231
    v_fma_f32 v154, v154, s37, -v236
    v_mfma_f32_16x16x32_bf16 v[184:187], v[70:73], v[176:179], 0
    v_fma_f32 v155, v155, s37, -v236
    v_fma_f32 v156, v156, s37, -v236
    v_mfma_f32_16x16x32_bf16 v[188:191], v[92:95], v[176:179], 0
    v_exp_f32 v152, v152
    v_mfma_f32_16x16x32_bf16 v[192:195], v[114:117], v[176:179], 0
    v_exp_f32 v153, v153
    v_mfma_f32_16x16x32_bf16 v[204:207], a[16:19], a[240:243], v[204:207]
    v_exp_f32 v154, v154
    v_mfma_f32_16x16x32_bf16 v[200:203], a[20:23], a[240:243], v[200:203]
    v_exp_f32 v155, v155
    v_mfma_f32_16x16x32_bf16 v[220:223], a[240:243], a[84:87], v[220:223]
    v_cvt_pk_bf16_f32 v180, v152, v153
    v_cvt_pk_bf16_f32 v181, v154, v155
    v_mfma_f32_16x16x32_bf16 v[216:219], a[240:243], a[88:91], v[216:219]
    s_waitcnt lgkmcnt(0)
    ds_read_b128 v[152:155], v230 offset:1280
    v_fma_f32 v157, v157, s37, -v236
    v_mfma_f32_16x16x32_bf16 v[148:151], v[30:33], v[138:141], v[148:151]
    v_fma_f32 v158, v158, s37, -v236
    v_fma_f32 v159, v159, s37, -v236
    v_mfma_f32_16x16x32_bf16 v[212:215], a[240:243], a[92:95], v[212:215]
    ds_read_b128 a[240:243], v240
    v_fma_f32 v160, v160, s37, -v236
    v_mfma_f32_16x16x32_bf16 v[208:211], a[24:27], a[244:247], v[208:211]
    v_exp_f32 v156, v156
    v_mfma_f32_16x16x16_bf16 v[148:151], v[34:35], v[142:143], v[148:151]
    v_exp_f32 v157, v157
    v_mfma_f32_16x16x32_bf16 v[204:207], a[28:31], a[244:247], v[204:207]
    v_exp_f32 v158, v158
    v_mfma_f32_16x16x32_bf16 v[200:203], a[32:35], a[244:247], v[200:203]
    v_exp_f32 v159, v159
    v_mfma_f32_16x16x32_bf16 v[220:223], a[244:247], a[96:99], v[220:223]
    v_cvt_pk_bf16_f32 v182, v156, v157
    v_cvt_pk_bf16_f32 v183, v158, v159
    v_mfma_f32_16x16x32_bf16 v[216:219], a[244:247], a[100:103], v[216:219]
    ds_read_b128 v[156:159], v230 offset:1920
    v_fma_f32 v161, v161, s37, -v236
    v_mfma_f32_16x16x32_bf16 v[196:199], a[216:219], v[180:183], v[196:199]
    v_fma_f32 v162, v162, s37, -v236
    v_fma_f32 v163, v163, s37, -v236
    v_mfma_f32_16x16x32_bf16 v[184:187], v[74:77], v[180:183], v[184:187]
    v_exp_f32 v160, v160
    v_mfma_f32_16x16x32_bf16 v[188:191], v[96:99], v[180:183], v[188:191]
    v_exp_f32 v161, v161
    v_mfma_f32_16x16x32_bf16 v[192:195], v[118:121], v[180:183], v[192:195]
    s_waitcnt lgkmcnt(1)
    v_exp_f32 v162, v162
    v_mfma_f32_16x16x32_bf16 v[152:155], v[36:39], v[138:141], v[152:155]
    v_exp_f32 v163, v163
    v_mfma_f32_16x16x32_bf16 v[212:215], a[244:247], a[104:107], v[212:215]
    ds_read_b128 a[244:247], v239 offset:1024
    v_cvt_pk_bf16_f32 v176, v160, v161
    v_mfma_f32_16x16x32_bf16 v[208:211], a[36:39], v[252:255], v[208:211]
    v_cvt_pk_bf16_f32 v177, v162, v163
    v_fma_f32 v164, v164, s37, -v236
    v_mfma_f32_16x16x16_bf16 v[152:155], v[40:41], v[142:143], v[152:155]
    s_waitcnt lgkmcnt(1)
    ds_read_b128 v[160:163], v234
    v_bfe_u32 v234, s73, v232, 4
    v_mfma_f32_16x16x32_bf16 v[156:159], v[42:45], v[138:141], v[156:159]
    v_fma_f32 v165, v165, s37, -v236
    v_fma_f32 v166, v166, s37, -v236
    v_mfma_f32_16x16x32_bf16 v[204:207], a[40:43], v[252:255], v[204:207]
    v_fma_f32 v167, v167, s37, -v236
    v_fma_f32 v168, v168, s37, -v236
    v_mfma_f32_16x16x32_bf16 v[200:203], a[44:47], v[252:255], v[200:203]
    v_exp_f32 v164, v164
    v_mfma_f32_16x16x16_bf16 v[156:159], v[46:47], v[142:143], v[156:159]
    v_exp_f32 v165, v165
    v_mfma_f32_16x16x32_bf16 v[220:223], v[252:255], a[108:111], v[220:223]
    v_exp_f32 v166, v166
    v_mfma_f32_16x16x32_bf16 v[216:219], v[252:255], a[112:115], v[216:219]
    v_exp_f32 v167, v167
    v_mfma_f32_16x16x32_bf16 v[212:215], v[252:255], a[116:119], v[212:215]
    ds_read_b128 v[252:255], v240 offset:1024
    v_cvt_pk_bf16_f32 v178, v164, v165
    v_mfma_f32_16x16x32_bf16 v[208:211], a[48:51], a[248:251], v[208:211]
    s_waitcnt lgkmcnt(1)
    v_cvt_pk_bf16_f32 v179, v166, v167
    v_fma_f32 v169, v169, s37, -v236
    v_mfma_f32_16x16x32_bf16 v[160:163], v[48:51], v[138:141], v[160:163]
    ds_read_b128 v[164:167], v235
    v_mad_u32_u24 v235, v234, s40, v228
    v_mfma_f32_16x16x32_bf16 v[196:199], a[216:219], v[176:179], v[196:199]
    v_mad_u32_u24 v234, v234, s40, v229
    v_fma_f32 v170, v170, s37, -v236
    v_mfma_f32_16x16x32_bf16 v[184:187], v[78:81], v[176:179], v[184:187]
    v_fma_f32 v171, v171, s37, -v236
    v_fma_f32 v172, v172, s37, -v236
    v_mfma_f32_16x16x32_bf16 v[188:191], v[100:103], v[176:179], v[188:191]
    v_exp_f32 v168, v168
    v_mfma_f32_16x16x32_bf16 v[192:195], v[122:125], v[176:179], v[192:195]
    v_exp_f32 v169, v169
    v_mfma_f32_16x16x16_bf16 v[160:163], v[52:53], v[142:143], v[160:163]
    v_exp_f32 v170, v170
    v_mfma_f32_16x16x32_bf16 v[204:207], a[52:55], a[248:251], v[204:207]
    v_exp_f32 v171, v171
    v_mfma_f32_16x16x32_bf16 v[200:203], a[56:59], a[248:251], v[200:203]
    v_cvt_pk_bf16_f32 v180, v168, v169
    v_cvt_pk_bf16_f32 v181, v170, v171
    v_mfma_f32_16x16x32_bf16 v[220:223], a[248:251], a[120:123], v[220:223]
    ds_read_b128 v[168:171], v250
    v_bfe_u32 v250, s77, v232, 4
    v_mfma_f32_16x16x32_bf16 v[216:219], a[248:251], a[124:127], v[216:219]
    v_fma_f32 v173, v173, s37, -v236
    v_fma_f32 v174, v174, s37, -v236
    v_mfma_f32_16x16x32_bf16 v[212:215], a[248:251], a[128:131], v[212:215]
    ds_read_b128 a[248:251], v241 offset:12288
    v_fma_f32 v175, v175, s37, -v236
    v_mfma_f32_16x16x32_bf16 v[208:211], a[60:63], a[252:255], v[208:211]
    v_exp_f32 v172, v172
    v_mfma_f32_16x16x32_bf16 v[204:207], a[64:67], a[252:255], v[204:207]
    v_exp_f32 v173, v173
    v_mfma_f32_16x16x32_bf16 v[200:203], a[68:71], a[252:255], v[200:203]
    v_exp_f32 v174, v174
    v_mfma_f32_16x16x32_bf16 v[220:223], a[252:255], a[132:135], v[220:223]
    v_exp_f32 v175, v175
    v_mfma_f32_16x16x32_bf16 v[216:219], a[252:255], a[136:139], v[216:219]
    v_cvt_pk_bf16_f32 v54, v208, v209
    v_cvt_pk_bf16_f32 v55, v210, v211
    v_mfma_f32_16x16x32_bf16 v[212:215], a[252:255], a[140:143], v[212:215]
    s_waitcnt lgkmcnt(1)
    v_cvt_pk_bf16_f32 v56, v204, v205
    v_cvt_pk_bf16_f32 v57, v206, v207
    v_mfma_f32_16x16x32_bf16 v[168:171], v[60:63], v[138:141], v[168:171]
    v_cvt_pk_bf16_f32 v58, v200, v201
    v_cvt_pk_bf16_f32 v59, v202, v203
    v_mfma_f32_16x16x32_bf16 v[164:167], v[54:57], v[138:141], v[164:167]
    v_cvt_pk_bf16_f32 v84, v220, v221
    v_cvt_pk_bf16_f32 v85, v222, v223
    v_mfma_f32_16x16x32_bf16 v[208:211], a[220:223], a[236:239], 0
    v_cvt_pk_bf16_f32 v106, v216, v217
    v_cvt_pk_bf16_f32 v107, v218, v219
    v_mfma_f32_16x16x16_bf16 v[168:171], v[64:65], v[142:143], v[168:171]
    v_cvt_pk_bf16_f32 v128, v212, v213
    v_cvt_pk_bf16_f32 v129, v214, v215
    v_mfma_f32_16x16x16_bf16 v[164:167], v[58:59], v[142:143], v[164:167]
    ds_read_b128 a[252:255], v241 offset:12800
    v_cvt_pk_bf16_f32 v182, v172, v173
    v_mfma_f32_16x16x32_bf16 v[200:203], a[220:223], a[240:243], 0
    v_cvt_pk_bf16_f32 v183, v174, v175
    v_max3_f32 v248, v144, v145, v146
    v_mfma_f32_16x16x32_bf16 v[204:207], a[224:227], a[236:239], 0
    ds_read_b128 v[172:175], v235
    v_bfe_u32 v235, s78, v232, 4
    v_mfma_f32_16x16x32_bf16 v[196:199], a[216:219], v[180:183], v[196:199]
    v_max3_f32 v249, v147, v148, v149
    v_max3_f32 v248, v248, v150, v151
    v_mfma_f32_16x16x32_bf16 v[184:187], v[66:69], v[180:183], v[184:187]
    v_max3_f32 v249, v249, v152, v153
    v_max3_f32 v248, v248, v154, v155
    v_mfma_f32_16x16x32_bf16 v[188:191], v[88:91], v[180:183], v[188:191]
    v_max3_f32 v249, v249, v156, v157
    v_max3_f32 v248, v248, v158, v159
    v_mfma_f32_16x16x32_bf16 v[192:195], v[110:113], v[180:183], v[192:195]
    v_rcp_f32 v197, v196
    v_mfma_f32_16x16x32_bf16 v[220:223], a[224:227], a[240:243], 0
    ds_read_b128 a[240:243], v242 offset:12800
    v_mul_f32 v184, v184, v197
    v_mfma_f32_16x16x32_bf16 v[216:219], a[228:231], a[236:239], 0
    v_mul_f32 v185, v185, v197
    v_cvt_pk_bf16_f32 v184, v184, v185
    v_mfma_f32_16x16x32_bf16 v[212:215], a[232:235], a[236:239], 0
    s_waitcnt lgkmcnt(3)
    ds_read_b128 a[236:239], v242 offset:12288
    v_mul_f32 v186, v186, v197
    v_mfma_f32_16x16x32_bf16 v[208:211], a[248:251], a[244:247], v[208:211]
    s_waitcnt lgkmcnt(2)
    v_mul_f32 v187, v187, v197
    v_cvt_pk_bf16_f32 v185, v186, v187
    v_mfma_f32_16x16x32_bf16 v[172:175], v[12:15], v[132:135], v[172:175]
    v_mul_f32 v188, v188, v197
    v_mul_f32 v189, v189, v197
    v_mfma_f32_16x16x32_bf16 v[200:203], a[248:251], v[252:255], v[200:203]
    ds_read_b128 a[248:251], v241 offset:24576
    v_cvt_pk_bf16_f32 v186, v188, v189
    v_mfma_f32_16x16x32_bf16 v[204:207], a[252:255], a[244:247], v[204:207]
    v_mul_f32 v190, v190, v197
    v_mul_f32 v191, v191, v197
    v_mfma_f32_16x16x16_bf16 v[172:175], v[16:17], v[136:137], v[172:175]
    v_cvt_pk_bf16_f32 v187, v190, v191
    v_mul_f32 v192, v192, v197
    v_mfma_f32_16x16x32_bf16 v[220:223], a[252:255], v[252:255], v[220:223]
    s_waitcnt lgkmcnt(2)
    ds_read_b128 v[252:255], v240 offset:2048
    ds_read_b128 a[252:255], v241 offset:25088
    v_mfma_f32_16x16x32_bf16 v[212:215], a[240:243], a[244:247], v[212:215]
    s_waitcnt lgkmcnt(3)
    ds_read_b128 a[240:243], v242 offset:25088
    v_mul_f32 v193, v193, v197
    v_cvt_pk_bf16_f32 v188, v192, v193
    v_mul_f32 v194, v194, v197
    v_mfma_f32_16x16x32_bf16 v[216:219], a[236:239], a[244:247], v[216:219]
    s_waitcnt lgkmcnt(2)
    ds_read_b128 a[244:247], v239 offset:2048
    v_mul_f32 v195, v195, v197
    ds_read_b128 a[236:239], v242 offset:24576
    v_cvt_pk_bf16_f32 v189, v194, v195
    ds_write_b128 v237, v[184:187] offset:12288
    ds_write_b64 v238, v[188:189] offset:12288
    v_max3_f32 v249, v249, v160, v161
    v_max3_f32 v248, v248, v162, v163
    v_max3_f32 v249, v249, v164, v165
    v_max3_f32 v248, v248, v166, v167
    v_max3_f32 v249, v249, v168, v169
    v_max3_f32 v248, v248, v170, v171
    v_mfma_f32_16x16x32_bf16 v[200:203], a[248:251], v[252:255], v[200:203]
    s_waitcnt lgkmcnt(3)
    v_max_f32 v248, v248, v249
    v_mov_b32 v249, v248
    v_mfma_f32_16x16x32_bf16 v[220:223], a[252:255], v[252:255], v[220:223]
    s_nop 0
    v_permlane16_swap_b32 v248, v249
    ds_read_b128 v[252:255], v240 offset:3072
    v_mfma_f32_16x16x32_bf16 v[208:211], a[248:251], a[244:247], v[208:211]
    ds_read_b128 a[248:251], v241 offset:36864
    v_max_f32 v248, v248, v249
    v_mfma_f32_16x16x32_bf16 v[204:207], a[252:255], a[244:247], v[204:207]
    s_waitcnt lgkmcnt(4)
    ds_read_b128 a[252:255], v241 offset:37376
    v_mov_b32 v249, v248
    v_mfma_f32_16x16x32_bf16 v[216:219], a[236:239], a[244:247], v[216:219]
    ds_read_b128 a[236:239], v242 offset:36864
    v_mfma_f32_16x16x32_bf16 v[212:215], a[240:243], a[244:247], v[212:215]
    s_waitcnt lgkmcnt(2)
    ds_read_b128 a[244:247], v239 offset:3072
    ds_read_b128 a[240:243], v242 offset:37376
    v_permlane32_swap_b32 v248, v249
    v_max_f32 v248, v248, v249
    v_mul_f32 v236, s37, v248
    v_fma_f32 v144, v144, s37, -v236
    v_fma_f32 v145, v145, s37, -v236
    v_fma_f32 v146, v146, s37, -v236
    v_fma_f32 v147, v147, s37, -v236
    v_exp_f32 v144, v144
    v_exp_f32 v145, v145
    v_exp_f32 v146, v146
    v_exp_f32 v147, v147
    v_cvt_pk_bf16_f32 v176, v144, v145
    v_cvt_pk_bf16_f32 v177, v146, v147
    ds_read_b128 v[144:147], v234
    v_mfma_f32_16x16x32_bf16 v[200:203], a[248:251], v[252:255], v[200:203]
    s_waitcnt lgkmcnt(4)
    v_mad_u32_u24 v234, v250, s40, v228
    v_mad_u32_u24 v250, v250, s40, v229
    v_mfma_f32_16x16x32_bf16 v[220:223], a[252:255], v[252:255], v[220:223]
    s_waitcnt lgkmcnt(2)
    ds_read_b128 v[252:255], v240 offset:4096
    v_fma_f32 v148, v148, s37, -v236
    v_fma_f32 v149, v149, s37, -v236
    v_fma_f32 v150, v150, s37, -v236
    v_mfma_f32_16x16x32_bf16 v[208:211], a[248:251], a[244:247], v[208:211]
    ds_read_b128 a[248:251], v241 offset:49152
    v_fma_f32 v151, v151, s37, -v236
    v_mfma_f32_16x16x32_bf16 v[204:207], a[252:255], a[244:247], v[204:207]
    ds_read_b128 a[252:255], v241 offset:49664
    v_fma_f32 v152, v152, s37, -v236
    v_mfma_f32_16x16x32_bf16 v[216:219], a[236:239], a[244:247], v[216:219]
    s_waitcnt lgkmcnt(4)
    ds_read_b128 a[236:239], v242 offset:49152
    v_fma_f32 v153, v153, s37, -v236
    v_mfma_f32_16x16x32_bf16 v[212:215], a[240:243], a[244:247], v[212:215]
    s_waitcnt lgkmcnt(4)
    ds_read_b128 a[244:247], v239 offset:4096
    ds_read_b128 a[240:243], v242 offset:49664
    v_exp_f32 v148, v148
    v_exp_f32 v149, v149
    v_exp_f32 v150, v150
    v_exp_f32 v151, v151
    v_mfma_f32_16x16x32_bf16 v[144:147], v[36:39], v[132:135], v[144:147]
    v_cvt_pk_bf16_f32 v178, v148, v149
    v_cvt_pk_bf16_f32 v179, v150, v151
    ds_read_b128 v[148:151], v229 offset:1280
    v_fma_f32 v154, v154, s37, -v236
    v_mfma_f32_16x16x32_bf16 v[196:199], a[216:219], v[176:179], 0
    v_fma_f32 v155, v155, s37, -v236
    v_fma_f32 v156, v156, s37, -v236
    v_mfma_f32_16x16x32_bf16 v[184:187], v[68:71], v[176:179], 0
    v_exp_f32 v152, v152
    v_mfma_f32_16x16x32_bf16 v[188:191], v[90:93], v[176:179], 0
    v_exp_f32 v153, v153
    v_mfma_f32_16x16x32_bf16 v[192:195], v[112:115], v[176:179], 0
    v_exp_f32 v154, v154
    v_mfma_f32_16x16x16_bf16 v[144:147], v[40:41], v[136:137], v[144:147]
    s_waitcnt lgkmcnt(2)
    v_exp_f32 v155, v155
    v_mfma_f32_16x16x32_bf16 v[208:211], a[248:251], a[244:247], v[208:211]
    v_cvt_pk_bf16_f32 v180, v152, v153
    v_cvt_pk_bf16_f32 v181, v154, v155
    v_mfma_f32_16x16x32_bf16 v[200:203], a[248:251], v[252:255], v[200:203]
    ds_read_b128 a[248:251], v241 offset:61440
    ds_read_b128 v[152:155], v228 offset:1280
    v_mfma_f32_16x16x32_bf16 v[204:207], a[252:255], a[244:247], v[204:207]
    s_waitcnt lgkmcnt(2)
    v_fma_f32 v157, v157, s37, -v236
    v_fma_f32 v158, v158, s37, -v236
    v_mfma_f32_16x16x32_bf16 v[148:151], v[42:45], v[132:135], v[148:151]
    v_fma_f32 v159, v159, s37, -v236
    v_fma_f32 v160, v160, s37, -v236
    v_mfma_f32_16x16x32_bf16 v[220:223], a[252:255], v[252:255], v[220:223]
    ds_read_b128 v[252:255], v240 offset:5120
    ds_read_b128 a[252:255], v241 offset:61952
    v_mfma_f32_16x16x32_bf16 v[216:219], a[236:239], a[244:247], v[216:219]
    ds_read_b128 a[236:239], v242 offset:61440
    v_fma_f32 v161, v161, s37, -v236
    v_mfma_f32_16x16x16_bf16 v[148:151], v[46:47], v[136:137], v[148:151]
    v_exp_f32 v156, v156
    v_mfma_f32_16x16x32_bf16 v[212:215], a[240:243], a[244:247], v[212:215]
    ds_read_b128 a[244:247], v239 offset:5120
    ds_read_b128 a[240:243], v242 offset:61952
    v_exp_f32 v157, v157
    v_exp_f32 v158, v158
    v_exp_f32 v159, v159
    v_cvt_pk_bf16_f32 v182, v156, v157
    v_cvt_pk_bf16_f32 v183, v158, v159
    ds_read_b128 v[156:159], v234
    v_bfe_u32 v234, s73, v232, 4
    v_mfma_f32_16x16x32_bf16 v[196:199], a[216:219], v[180:183], v[196:199]
    v_mad_u32_u24 v234, v234, s40, v230
    v_fma_f32 v162, v162, s37, -v236
    v_mfma_f32_16x16x32_bf16 v[184:187], v[76:79], v[180:183], v[184:187]
    v_fma_f32 v163, v163, s37, -v236
    v_fma_f32 v164, v164, s37, -v236
    v_mfma_f32_16x16x32_bf16 v[188:191], v[98:101], v[180:183], v[188:191]
    v_exp_f32 v160, v160
    v_mfma_f32_16x16x32_bf16 v[192:195], v[120:123], v[180:183], v[192:195]
    s_waitcnt lgkmcnt(5)
    v_exp_f32 v161, v161
    v_mfma_f32_16x16x32_bf16 v[152:155], v[18:21], v[132:135], v[152:155]
    s_waitcnt lgkmcnt(2)
    v_exp_f32 v162, v162
    v_mfma_f32_16x16x32_bf16 v[208:211], a[248:251], a[244:247], v[208:211]
    v_exp_f32 v163, v163
    v_mfma_f32_16x16x32_bf16 v[200:203], a[248:251], v[252:255], v[200:203]
    ds_read_b128 a[248:251], v224 offset:15616
    v_cvt_pk_bf16_f32 v176, v160, v161
    v_mfma_f32_16x16x16_bf16 v[152:155], v[22:23], v[136:137], v[152:155]
    s_waitcnt lgkmcnt(1)
    v_cvt_pk_bf16_f32 v177, v162, v163
    v_fma_f32 v165, v165, s37, -v236
    v_mfma_f32_16x16x32_bf16 v[156:159], v[0:3], v[132:135], v[156:159]
    ds_read_b128 v[160:163], v250
    v_cvt_pk_bf16_f32 v208, v208, v209
    v_mfma_f32_16x16x16_bf16 v[196:199], a[216:217], v[176:177], v[196:199]
    v_cvt_pk_bf16_f32 v209, v210, v211
    v_cvt_pk_bf16_f32 v200, v200, v201
    v_mfma_f32_16x16x16_bf16 v[184:187], v[82:83], v[176:177], v[184:187]
    v_cvt_pk_bf16_f32 v201, v202, v203
    v_mad_u32_u24 v250, v235, s40, v229
    v_mfma_f32_16x16x16_bf16 v[188:191], v[104:105], v[176:177], v[188:191]
    v_mad_u32_u24 v235, v235, s40, v228
    v_fma_f32 v166, v166, s37, -v236
    v_mfma_f32_16x16x16_bf16 v[192:195], v[126:127], v[176:177], v[192:195]
    v_fma_f32 v167, v167, s37, -v236
    v_fma_f32 v168, v168, s37, -v236
    v_mfma_f32_16x16x16_bf16 v[156:159], v[4:5], v[136:137], v[156:159]
    v_exp_f32 v164, v164
    v_mfma_f32_16x16x32_bf16 v[204:207], a[252:255], a[244:247], v[204:207]
    v_exp_f32 v165, v165
    v_mfma_f32_16x16x32_bf16 v[220:223], a[252:255], v[252:255], v[220:223]
    ds_read_b128 v[252:255], v224 offset:15552
    ds_read_b128 a[252:255], v224 offset:15680
    v_mfma_f32_16x16x32_bf16 v[216:219], a[236:239], a[244:247], v[216:219]
    s_waitcnt lgkmcnt(2)
    ds_read_b128 a[236:239], v224 offset:15744
    v_cvt_pk_bf16_f32 v180, v164, v165
    v_mfma_f32_16x16x32_bf16 v[160:163], v[24:27], v[132:135], v[160:163]
    v_cvt_pk_bf16_f32 v210, v204, v205
    v_cvt_pk_bf16_f32 v211, v206, v207
    v_mfma_f32_16x16x32_bf16 v[212:215], a[240:243], a[244:247], v[212:215]
    ds_read_b128 a[244:247], v224 offset:15488
    ds_read_b128 a[240:243], v224 offset:15808
    buffer_store_dwordx4 v[208:211], v243, s[20:23], s58 offen sc0 sc1
    v_mfma_f32_16x16x16_bf16 v[160:163], v[28:29], v[136:137], v[160:163]
    s_waitcnt lgkmcnt(1)
    v_cvt_pk_bf16_f32 v202, v220, v221
    v_cvt_pk_bf16_f32 v203, v222, v223
    v_cvt_pk_bf16_f32 v216, v216, v217
    v_cvt_pk_bf16_f32 v217, v218, v219
    v_cvt_pk_bf16_f32 v218, v212, v213
    v_cvt_pk_bf16_f32 v219, v214, v215
    v_exp_f32 v166, v166
    v_exp_f32 v167, v167
    v_fma_f32 v169, v169, s37, -v236
    v_cvt_pk_bf16_f32 v181, v166, v167
    ds_read_b128 v[164:167], v250
    v_bfe_u32 v250, s78, v232, 4
    v_mad_u32_u24 v250, v250, s40, v230
    v_fma_f32 v170, v170, s37, -v236
    v_fma_f32 v171, v171, s37, -v236
    v_exp_f32 v168, v168
    v_exp_f32 v169, v169
    v_mfma_f32_16x16x32_bf16 v[208:211], a[0:3], a[244:247], 0
    v_exp_f32 v170, v170
    v_mfma_f32_16x16x32_bf16 v[204:207], a[4:7], a[244:247], 0
    v_exp_f32 v171, v171
    v_mfma_f32_16x16x32_bf16 v[220:223], a[244:247], a[72:75], 0
    v_cvt_pk_bf16_f32 v182, v168, v169
    v_cvt_pk_bf16_f32 v183, v170, v171
    v_mfma_f32_16x16x32_bf16 v[212:215], a[244:247], a[80:83], 0
    ds_read_b128 v[168:171], v235
    v_bfe_u32 v235, s77, v232, 4
    v_mfma_f32_16x16x32_bf16 v[196:199], a[216:219], v[180:183], v[196:199]
    buffer_store_dwordx4 v[200:203], v245, s[20:23], s58 offen sc0 sc1
    v_mfma_f32_16x16x32_bf16 v[184:187], v[84:87], v[180:183], v[184:187]
    v_mad_u32_u24 v235, v235, s40, v230
    v_max3_f32 v248, v172, v173, v174
    v_mfma_f32_16x16x32_bf16 v[188:191], v[106:109], v[180:183], v[188:191]
    v_max3_f32 v249, v175, v144, v145
    v_max3_f32 v248, v248, v146, v147
    v_mfma_f32_16x16x32_bf16 v[192:195], v[128:131], v[180:183], v[192:195]
    v_rcp_f32 v197, v196
    v_mfma_f32_16x16x32_bf16 v[200:203], a[8:11], a[244:247], 0
    v_mul_f32 v184, v184, v197
    v_mul_f32 v185, v185, v197
    v_mfma_f32_16x16x32_bf16 v[208:211], a[12:15], v[252:255], v[208:211]
    v_cvt_pk_bf16_f32 v184, v184, v185
    v_mul_f32 v186, v186, v197
    v_mfma_f32_16x16x32_bf16 v[204:207], a[16:19], v[252:255], v[204:207]
    v_mul_f32 v187, v187, v197
    v_cvt_pk_bf16_f32 v185, v186, v187
    v_mfma_f32_16x16x32_bf16 v[200:203], a[20:23], v[252:255], v[200:203]
    v_mul_f32 v188, v188, v197
    v_mul_f32 v189, v189, v197
    v_mfma_f32_16x16x32_bf16 v[220:223], v[252:255], a[84:87], v[220:223]
    v_cvt_pk_bf16_f32 v186, v188, v189
    v_mul_f32 v190, v190, v197
    v_mfma_f32_16x16x32_bf16 v[212:215], v[252:255], a[92:95], v[212:215]
    v_mul_f32 v191, v191, v197
    v_cvt_pk_bf16_f32 v187, v190, v191
    v_mfma_f32_16x16x32_bf16 v[208:211], a[24:27], a[248:251], v[208:211]
    v_mul_f32 v192, v192, v197
    v_mul_f32 v193, v193, v197
    v_mfma_f32_16x16x32_bf16 v[204:207], a[28:31], a[248:251], v[204:207]
    v_cvt_pk_bf16_f32 v188, v192, v193
    v_mul_f32 v194, v194, v197
    v_mfma_f32_16x16x32_bf16 v[200:203], a[32:35], a[248:251], v[200:203]
    buffer_store_dwordx4 v[216:219], v244, s[20:23], s58 offen sc0 sc1
    v_mfma_f32_16x16x32_bf16 v[220:223], a[248:251], a[96:99], v[220:223]
    s_add_u32 s58, s51, 0x1a4000
    v_mul_f32 v195, v195, v197
    v_cvt_pk_bf16_f32 v189, v194, v195
    v_mfma_f32_16x16x32_bf16 v[216:219], a[244:247], a[76:79], 0
    ds_read_b128 a[244:247], v224 offset:18560
    v_max3_f32 v249, v249, v148, v149
    v_mfma_f32_16x16x32_bf16 v[216:219], v[252:255], a[88:91], v[216:219]
    ds_read_b128 v[252:255], v224 offset:18624
    v_max3_f32 v248, v248, v150, v151
    v_mfma_f32_16x16x32_bf16 v[216:219], a[248:251], a[100:103], v[216:219]
    ds_write_b128 v237, v[184:187] offset:18432
    v_mfma_f32_16x16x32_bf16 v[212:215], a[248:251], a[104:107], v[212:215]
    ds_write_b64 v238, v[188:189] offset:18432
    v_mfma_f32_16x16x32_bf16 v[208:211], a[36:39], a[252:255], v[208:211]
    v_max3_f32 v249, v249, v152, v153
    v_max3_f32 v248, v248, v154, v155
    v_mfma_f32_16x16x32_bf16 v[204:207], a[40:43], a[252:255], v[204:207]
    v_max3_f32 v249, v249, v156, v157
    v_max3_f32 v248, v248, v158, v159
    v_mfma_f32_16x16x32_bf16 v[200:203], a[44:47], a[252:255], v[200:203]
    v_max3_f32 v249, v249, v160, v161
    v_max3_f32 v248, v248, v162, v163
    v_mfma_f32_16x16x32_bf16 v[220:223], a[252:255], a[108:111], v[220:223]
    ds_read_b128 a[248:251], v224 offset:18688
    v_mfma_f32_16x16x32_bf16 v[216:219], a[252:255], a[112:115], v[216:219]
    v_mfma_f32_16x16x32_bf16 v[212:215], a[252:255], a[116:119], v[212:215]
    ds_read_b128 a[252:255], v224 offset:18752
    v_mfma_f32_16x16x32_bf16 v[208:211], a[48:51], a[236:239], v[208:211]
    v_mfma_f32_16x16x32_bf16 v[204:207], a[52:55], a[236:239], v[204:207]
    v_mfma_f32_16x16x32_bf16 v[200:203], a[56:59], a[236:239], v[200:203]
    v_mfma_f32_16x16x32_bf16 v[220:223], a[236:239], a[120:123], v[220:223]
    s_waitcnt lgkmcnt(2)
    v_mfma_f32_16x16x32_bf16 v[216:219], a[236:239], a[124:127], v[216:219]
    s_barrier
    v_mfma_f32_16x16x32_bf16 v[212:215], a[236:239], a[128:131], v[212:215]
    ds_read_b128 a[236:239], v224 offset:18816
    v_mfma_f32_16x16x32_bf16 v[208:211], a[60:63], a[240:243], v[208:211]
    v_mfma_f32_16x16x32_bf16 v[204:207], a[64:67], a[240:243], v[204:207]
    v_mfma_f32_16x16x32_bf16 v[200:203], a[68:71], a[240:243], v[200:203]
    v_mfma_f32_16x16x32_bf16 v[220:223], a[240:243], a[132:135], v[220:223]
    v_mfma_f32_16x16x32_bf16 v[216:219], a[240:243], a[136:139], v[216:219]
    v_mfma_f32_16x16x32_bf16 v[212:215], a[240:243], a[140:143], v[212:215]
    ds_read_b128 a[240:243], v224 offset:18880
    v_cndmask_b32 v224, v239, v240, vcc
    s_nop 0
    v_cvt_pk_bf16_f32 v6, v208, v209
    v_cvt_pk_bf16_f32 v7, v210, v211
    v_mfma_f32_16x16x32_bf16 v[208:211], a[0:3], a[244:247], 0
    v_cvt_pk_bf16_f32 v8, v204, v205
    v_cvt_pk_bf16_f32 v9, v206, v207
    v_mfma_f32_16x16x32_bf16 v[204:207], a[4:7], a[244:247], 0
    v_cvt_pk_bf16_f32 v10, v200, v201
    v_cvt_pk_bf16_f32 v11, v202, v203
    v_mfma_f32_16x16x32_bf16 v[168:171], v[6:9], v[132:135], v[168:171]
    v_cvt_pk_bf16_f32 v72, v220, v221
    v_cvt_pk_bf16_f32 v73, v222, v223
    v_mfma_f32_16x16x32_bf16 v[200:203], a[8:11], a[244:247], 0
    v_cvt_pk_bf16_f32 v94, v216, v217
    v_cvt_pk_bf16_f32 v95, v218, v219
    v_mfma_f32_16x16x32_bf16 v[220:223], a[244:247], a[72:75], 0
    v_cvt_pk_bf16_f32 v116, v212, v213
    v_cvt_pk_bf16_f32 v117, v214, v215
    v_mfma_f32_16x16x16_bf16 v[168:171], v[10:11], v[136:137], v[168:171]
    ds_read_b128 a[0:3], v241 offset:12288
    ds_read_b128 a[4:7], v241 offset:12800
    v_mfma_f32_16x16x32_bf16 v[216:219], a[244:247], a[76:79], 0
    ds_read_b128 a[8:11], v242 offset:12288
    v_mfma_f32_16x16x32_bf16 v[212:215], a[244:247], a[80:83], 0
    ds_read_b128 a[244:247], v226 offset:4224
    v_mfma_f32_16x16x32_bf16 v[208:211], a[12:15], v[252:255], v[208:211]
    ds_read_b128 a[12:15], v242 offset:12800
    v_mfma_f32_16x16x32_bf16 v[204:207], a[16:19], v[252:255], v[204:207]
    ds_read_b128 a[16:19], v241 offset:24576
    v_mfma_f32_16x16x32_bf16 v[200:203], a[20:23], v[252:255], v[200:203]
    ds_read_b128 a[20:23], v241 offset:25088
    v_mfma_f32_16x16x32_bf16 v[220:223], v[252:255], a[84:87], v[220:223]
    v_mfma_f32_16x16x32_bf16 v[216:219], v[252:255], a[88:91], v[216:219]
    v_mfma_f32_16x16x32_bf16 v[212:215], v[252:255], a[92:95], v[212:215]
    s_waitcnt lgkmcnt(7)
    ds_read_b128 v[252:255], v226 offset:4288
    v_mfma_f32_16x16x32_bf16 v[208:211], a[24:27], a[248:251], v[208:211]
    ds_read_b128 a[24:27], v242 offset:24576
    v_mfma_f32_16x16x32_bf16 v[204:207], a[28:31], a[248:251], v[204:207]
    ds_read_b128 a[28:31], v242 offset:25088
    v_mfma_f32_16x16x32_bf16 v[200:203], a[32:35], a[248:251], v[200:203]
    ds_read_b128 a[32:35], v241 offset:36864
    v_mfma_f32_16x16x32_bf16 v[220:223], a[248:251], a[96:99], v[220:223]
    v_mfma_f32_16x16x32_bf16 v[216:219], a[248:251], a[100:103], v[216:219]
    v_mfma_f32_16x16x32_bf16 v[212:215], a[248:251], a[104:107], v[212:215]
    ds_read_b128 a[248:251], v226 offset:4352
    v_mfma_f32_16x16x32_bf16 v[208:211], a[36:39], a[252:255], v[208:211]
    ds_read_b128 a[36:39], v241 offset:37376
    v_mfma_f32_16x16x32_bf16 v[204:207], a[40:43], a[252:255], v[204:207]
    ds_read_b128 a[40:43], v242 offset:36864
    v_mfma_f32_16x16x32_bf16 v[200:203], a[44:47], a[252:255], v[200:203]
    ds_read_b128 a[44:47], v242 offset:37376
    v_mfma_f32_16x16x32_bf16 v[220:223], a[252:255], a[108:111], v[220:223]
    v_mfma_f32_16x16x32_bf16 v[216:219], a[252:255], a[112:115], v[216:219]
    v_mfma_f32_16x16x32_bf16 v[212:215], a[252:255], a[116:119], v[212:215]
    ds_read_b128 a[252:255], v226 offset:4416
    v_mfma_f32_16x16x32_bf16 v[208:211], a[48:51], a[236:239], v[208:211]
    ds_read_b128 a[48:51], v241 offset:49152
    v_mfma_f32_16x16x32_bf16 v[204:207], a[52:55], a[236:239], v[204:207]
    ds_read_b128 a[52:55], v241 offset:49664
    v_mfma_f32_16x16x32_bf16 v[200:203], a[56:59], a[236:239], v[200:203]
    ds_read_b128 a[56:59], v242 offset:49152
    v_mfma_f32_16x16x32_bf16 v[220:223], a[236:239], a[120:123], v[220:223]
    v_mfma_f32_16x16x32_bf16 v[216:219], a[236:239], a[124:127], v[216:219]
    v_mfma_f32_16x16x32_bf16 v[212:215], a[236:239], a[128:131], v[212:215]
    ds_read_b128 a[236:239], v226 offset:4480
    v_mfma_f32_16x16x32_bf16 v[208:211], a[60:63], a[240:243], v[208:211]
    ds_read_b128 a[60:63], v242 offset:49664
    v_mfma_f32_16x16x32_bf16 v[204:207], a[64:67], a[240:243], v[204:207]
    ds_read_b128 a[64:67], v241 offset:61440
    v_mfma_f32_16x16x32_bf16 v[200:203], a[68:71], a[240:243], v[200:203]
    ds_read_b128 a[68:71], v241 offset:61952
    v_mfma_f32_16x16x32_bf16 v[220:223], a[240:243], a[132:135], v[220:223]
    v_mfma_f32_16x16x32_bf16 v[216:219], a[240:243], a[136:139], v[216:219]
    v_mfma_f32_16x16x32_bf16 v[212:215], a[240:243], a[140:143], v[212:215]
    s_waitcnt lgkmcnt(5)
    v_cvt_pk_bf16_f32 v30, v208, v209
    v_cvt_pk_bf16_f32 v31, v210, v211
    v_mfma_f32_16x16x32_bf16 v[208:211], a[144:147], a[244:247], 0
    v_cvt_pk_bf16_f32 v32, v204, v205
    v_cvt_pk_bf16_f32 v33, v206, v207
    v_mfma_f32_16x16x32_bf16 v[204:207], a[148:151], a[244:247], 0
    v_cvt_pk_bf16_f32 v34, v200, v201
    v_cvt_pk_bf16_f32 v35, v202, v203
    v_mfma_f32_16x16x32_bf16 v[164:167], v[30:33], v[132:135], v[164:167]
    v_cvt_pk_bf16_f32 v70, v220, v221
    v_cvt_pk_bf16_f32 v71, v222, v223
    v_mfma_f32_16x16x32_bf16 v[200:203], a[152:155], a[244:247], 0
    v_cvt_pk_bf16_f32 v92, v216, v217
    v_cvt_pk_bf16_f32 v93, v218, v219
    v_mfma_f32_16x16x32_bf16 v[208:211], a[156:159], v[252:255], v[208:211]
    v_cvt_pk_bf16_f32 v114, v212, v213
    v_cvt_pk_bf16_f32 v115, v214, v215
    v_mfma_f32_16x16x16_bf16 v[164:167], v[34:35], v[136:137], v[164:167]
    ds_read_b128 a[240:243], v226 offset:4544
    ds_read_b128 a[244:247], v239 offset:12288
    v_mfma_f32_16x16x32_bf16 v[204:207], a[160:163], v[252:255], v[204:207]
    v_cndmask_b32 v226, v244, v247, vcc
    v_cndmask_b32 v247, v247, v244, vcc
    v_mfma_f32_16x16x32_bf16 v[200:203], a[164:167], v[252:255], v[200:203]
    ds_read_b128 v[252:255], v240 offset:12288
    v_mfma_f32_16x16x32_bf16 v[208:211], a[168:171], a[248:251], v[208:211]
    v_max3_f32 v249, v249, v164, v165
    v_max3_f32 v248, v248, v166, v167
    v_mfma_f32_16x16x32_bf16 v[204:207], a[172:175], a[248:251], v[204:207]
    v_max3_f32 v249, v249, v168, v169
    v_max3_f32 v248, v248, v170, v171
    v_mfma_f32_16x16x32_bf16 v[200:203], a[176:179], a[248:251], v[200:203]
    ds_read_b128 a[248:251], v239 offset:13312
    v_max_f32 v248, v248, v249
    v_mfma_f32_16x16x32_bf16 v[208:211], a[180:183], a[252:255], v[208:211]
    v_mov_b32 v249, v248
    v_mfma_f32_16x16x32_bf16 v[204:207], a[184:187], a[252:255], v[204:207]
    v_mfma_f32_16x16x32_bf16 v[200:203], a[188:191], a[252:255], v[200:203]
    s_waitcnt lgkmcnt(4)
    ds_read_b128 a[252:255], v240 offset:13312
    v_mfma_f32_16x16x32_bf16 v[208:211], a[192:195], a[236:239], v[208:211]
    v_permlane16_swap_b32 v248, v249
    v_mfma_f32_16x16x32_bf16 v[204:207], a[196:199], a[236:239], v[204:207]
    v_max_f32 v248, v248, v249
    v_mov_b32 v249, v248
    v_mfma_f32_16x16x32_bf16 v[200:203], a[200:203], a[236:239], v[200:203]
    s_waitcnt lgkmcnt(3)
    ds_read_b128 a[236:239], v239 offset:14336
    v_mfma_f32_16x16x32_bf16 v[208:211], a[204:207], a[240:243], v[208:211]
    v_permlane32_swap_b32 v248, v249
    v_mfma_f32_16x16x32_bf16 v[204:207], a[208:211], a[240:243], v[204:207]
    v_max_f32 v248, v248, v249
    v_mul_f32 v236, s37, v248
    v_mfma_f32_16x16x32_bf16 v[200:203], a[212:215], a[240:243], v[200:203]
    ds_read_b128 a[240:243], v240 offset:14336
    v_fma_f32 v172, v172, s37, -v236
    v_mfma_f32_16x16x32_bf16 v[220:223], a[220:223], a[244:247], 0
    s_waitcnt lgkmcnt(3)
    v_cvt_pk_bf16_f32 v138, v208, v209
    v_cvt_pk_bf16_f32 v139, v210, v211
    v_mfma_f32_16x16x32_bf16 v[212:215], a[220:223], v[252:255], 0
    v_cvt_pk_bf16_f32 v140, v204, v205
    v_cvt_pk_bf16_f32 v141, v206, v207
    v_mfma_f32_16x16x32_bf16 v[216:219], a[224:227], a[244:247], 0
    v_cvt_pk_bf16_f32 v142, v200, v201
    v_cvt_pk_bf16_f32 v143, v202, v203
    v_mfma_f32_16x16x32_bf16 v[208:211], a[224:227], v[252:255], 0
    ds_read_b128 v[252:255], v240 offset:15360
    v_fma_f32 v173, v173, s37, -v236
    v_mfma_f32_16x16x32_bf16 v[204:207], a[228:231], a[244:247], 0
    v_fma_f32 v174, v174, s37, -v236
    v_fma_f32 v175, v175, s37, -v236
    v_mfma_f32_16x16x32_bf16 v[200:203], a[232:235], a[244:247], 0
    ds_read_b128 a[244:247], v239 offset:15360
    v_fma_f32 v144, v144, s37, -v236
    v_mfma_f32_16x16x32_bf16 v[220:223], a[0:3], a[248:251], v[220:223]
    s_waitcnt lgkmcnt(3)
    v_exp_f32 v172, v172
    v_mfma_f32_16x16x32_bf16 v[212:215], a[0:3], a[252:255], v[212:215]
    v_exp_f32 v173, v173
    v_mfma_f32_16x16x32_bf16 v[216:219], a[4:7], a[248:251], v[216:219]
    v_exp_f32 v174, v174
    v_mfma_f32_16x16x32_bf16 v[208:211], a[4:7], a[252:255], v[208:211]
    ds_read_b128 a[252:255], v240 offset:16384
    v_cvt_pk_bf16_f32 v176, v172, v173
    v_mfma_f32_16x16x32_bf16 v[204:207], a[8:11], a[248:251], v[204:207]
    v_exp_f32 v175, v175
    v_mfma_f32_16x16x32_bf16 v[200:203], a[12:15], a[248:251], v[200:203]
    ds_read_b128 a[248:251], v239 offset:16384
    v_cvt_pk_bf16_f32 v177, v174, v175
    v_mfma_f32_16x16x32_bf16 v[220:223], a[16:19], a[236:239], v[220:223]
    s_waitcnt lgkmcnt(4)
    ds_read_b128 v[172:175], v234
    v_bfe_u32 v234, s79, v233, 4
    v_mfma_f32_16x16x32_bf16 v[212:215], a[16:19], a[240:243], v[212:215]
    v_mad_u32_u24 v234, v234, s40, v231
    v_fma_f32 v145, v145, s37, -v236
    v_mfma_f32_16x16x32_bf16 v[216:219], a[20:23], a[236:239], v[216:219]
    v_fma_f32 v146, v146, s37, -v236
    v_fma_f32 v147, v147, s37, -v236
    v_mfma_f32_16x16x32_bf16 v[208:211], a[20:23], a[240:243], v[208:211]
    ds_read_b128 a[240:243], v240 offset:17408
    v_fma_f32 v148, v148, s37, -v236
    v_mfma_f32_16x16x32_bf16 v[204:207], a[24:27], a[236:239], v[204:207]
    v_exp_f32 v144, v144
    v_mfma_f32_16x16x32_bf16 v[200:203], a[28:31], a[236:239], v[200:203]
    s_waitcnt lgkmcnt(4)
    ds_read_b128 a[236:239], v239 offset:17408
    v_fma_f32 v149, v149, s37, -v236
    v_mfma_f32_16x16x32_bf16 v[220:223], a[32:35], a[244:247], v[220:223]
    v_exp_f32 v145, v145
    v_mfma_f32_16x16x32_bf16 v[212:215], a[32:35], v[252:255], v[212:215]
    v_exp_f32 v146, v146
    v_mfma_f32_16x16x32_bf16 v[216:219], a[36:39], a[244:247], v[216:219]
    s_waitcnt lgkmcnt(2)
    v_exp_f32 v147, v147
    v_mfma_f32_16x16x32_bf16 v[172:175], v[36:39], v[138:141], v[172:175]
    v_cvt_pk_bf16_f32 v178, v144, v145
    v_cvt_pk_bf16_f32 v179, v146, v147
    v_mfma_f32_16x16x32_bf16 v[208:211], a[36:39], v[252:255], v[208:211]
    ds_read_b128 v[252:255], v242 offset:61952
    ds_read_b128 v[144:147], v230 offset:1280
    v_mfma_f32_16x16x32_bf16 v[196:199], a[216:219], v[176:179], 0
    v_fma_f32 v150, v150, s37, -v236
    v_fma_f32 v151, v151, s37, -v236
    v_mfma_f32_16x16x32_bf16 v[184:187], v[74:77], v[176:179], 0
    v_exp_f32 v148, v148
    v_mfma_f32_16x16x32_bf16 v[188:191], v[96:99], v[176:179], 0
    v_exp_f32 v149, v149
    v_mfma_f32_16x16x32_bf16 v[192:195], v[118:121], v[176:179], 0
    v_exp_f32 v150, v150
    v_mfma_f32_16x16x16_bf16 v[172:175], v[40:41], v[142:143], v[172:175]
    v_exp_f32 v151, v151
    v_mfma_f32_16x16x32_bf16 v[204:207], a[40:43], a[244:247], v[204:207]
    v_cvt_pk_bf16_f32 v180, v148, v149
    v_cvt_pk_bf16_f32 v181, v150, v151
    v_mfma_f32_16x16x32_bf16 v[200:203], a[44:47], a[244:247], v[200:203]
    ds_read_b128 a[244:247], v242 offset:61440
    ds_read_b128 v[148:151], v235
    v_mfma_f32_16x16x32_bf16 v[220:223], a[48:51], a[248:251], v[220:223]
    v_bfe_u32 v235, s80, v233, 4
    v_mad_u32_u24 v235, v235, s40, v231
    v_mfma_f32_16x16x32_bf16 v[212:215], a[48:51], a[252:255], v[212:215]
    s_waitcnt lgkmcnt(2)
    v_fma_f32 v152, v152, s37, -v236
    v_fma_f32 v153, v153, s37, -v236
    v_mfma_f32_16x16x32_bf16 v[144:147], v[42:45], v[138:141], v[144:147]
    v_fma_f32 v154, v154, s37, -v236
    v_fma_f32 v155, v155, s37, -v236
    v_mfma_f32_16x16x32_bf16 v[216:219], a[52:55], a[248:251], v[216:219]
    v_exp_f32 v152, v152
    v_mfma_f32_16x16x32_bf16 v[208:211], a[52:55], a[252:255], v[208:211]
    v_exp_f32 v153, v153
    v_mfma_f32_16x16x16_bf16 v[144:147], v[46:47], v[142:143], v[144:147]
    v_exp_f32 v154, v154
    v_mfma_f32_16x16x32_bf16 v[204:207], a[56:59], a[248:251], v[204:207]
    v_exp_f32 v155, v155
    v_mfma_f32_16x16x32_bf16 v[200:203], a[60:63], a[248:251], v[200:203]
    v_cvt_pk_bf16_f32 v182, v152, v153
    v_cvt_pk_bf16_f32 v183, v154, v155
    v_mfma_f32_16x16x32_bf16 v[220:223], a[64:67], a[236:239], v[220:223]
    ds_read_b128 v[152:155], v250
    v_fma_f32 v156, v156, s37, -v236
    v_mfma_f32_16x16x32_bf16 v[196:199], a[216:219], v[180:183], v[196:199]
    v_fma_f32 v157, v157, s37, -v236
    v_fma_f32 v158, v158, s37, -v236
    v_mfma_f32_16x16x32_bf16 v[184:187], v[78:81], v[180:183], v[184:187]
    v_fma_f32 v159, v159, s37, -v236
    v_fma_f32 v160, v160, s37, -v236
    v_mfma_f32_16x16x32_bf16 v[188:191], v[100:103], v[180:183], v[188:191]
    v_cvt_pk_bf16_f32 v220, v220, v221
    v_cvt_pk_bf16_f32 v221, v222, v223
    v_mfma_f32_16x16x32_bf16 v[192:195], v[122:125], v[180:183], v[192:195]
    s_waitcnt lgkmcnt(1)
    v_exp_f32 v156, v156
    v_mfma_f32_16x16x32_bf16 v[148:151], v[24:27], v[138:141], v[148:151]
    v_exp_f32 v157, v157
    v_mfma_f32_16x16x32_bf16 v[212:215], a[64:67], a[240:243], v[212:215]
    v_exp_f32 v158, v158
    v_mfma_f32_16x16x32_bf16 v[216:219], a[68:71], a[236:239], v[216:219]
    v_exp_f32 v159, v159
    v_mfma_f32_16x16x32_bf16 v[208:211], a[68:71], a[240:243], v[208:211]
    v_cvt_pk_bf16_f32 v176, v156, v157
    v_cvt_pk_bf16_f32 v177, v158, v159
    v_mfma_f32_16x16x16_bf16 v[148:151], v[28:29], v[142:143], v[148:151]
    s_waitcnt lgkmcnt(0)
    ds_read_b128 v[156:159], v234
    v_cvt_pk_bf16_f32 v212, v212, v213
    v_mfma_f32_16x16x32_bf16 v[152:155], v[30:33], v[138:141], v[152:155]
    v_cvt_pk_bf16_f32 v222, v216, v217
    v_cvt_pk_bf16_f32 v223, v218, v219
    v_mfma_f32_16x16x32_bf16 v[204:207], a[244:247], a[236:239], v[204:207]
    buffer_store_dwordx4 v[220:223], v243, s[20:23], s58 offen sc0 sc1
    v_mfma_f32_16x16x32_bf16 v[200:203], v[252:255], a[236:239], v[200:203]
    v_cvt_pk_bf16_f32 v213, v214, v215
    v_cvt_pk_bf16_f32 v214, v208, v209
    v_mfma_f32_16x16x16_bf16 v[152:155], v[34:35], v[142:143], v[152:155]
    s_waitcnt lgkmcnt(0)
    v_cvt_pk_bf16_f32 v215, v210, v211
    v_fma_f32 v161, v161, s37, -v236
    v_fma_f32 v162, v162, s37, -v236
    v_cvt_pk_bf16_f32 v204, v204, v205
    v_cvt_pk_bf16_f32 v205, v206, v207
    v_cvt_pk_bf16_f32 v206, v200, v201
    v_cvt_pk_bf16_f32 v207, v202, v203
    v_fma_f32 v163, v163, s37, -v236
    v_exp_f32 v160, v160
    v_exp_f32 v161, v161
    v_exp_f32 v162, v162
    v_exp_f32 v163, v163
    v_mfma_f32_16x16x32_bf16 v[156:159], v[48:51], v[138:141], v[156:159]
    v_cvt_pk_bf16_f32 v178, v160, v161
    v_cvt_pk_bf16_f32 v179, v162, v163
    ds_read_b128 v[160:163], v235
    v_fma_f32 v164, v164, s37, -v236
    v_mfma_f32_16x16x32_bf16 v[196:199], a[216:219], v[176:179], v[196:199]
    v_fma_f32 v165, v165, s37, -v236
    v_fma_f32 v166, v166, s37, -v236
    v_mfma_f32_16x16x32_bf16 v[184:187], v[66:69], v[176:179], v[184:187]
    v_fma_f32 v167, v167, s37, -v236
    v_fma_f32 v168, v168, s37, -v236
    v_mfma_f32_16x16x32_bf16 v[188:191], v[88:91], v[176:179], v[188:191]
    v_exp_f32 v164, v164
    v_mfma_f32_16x16x32_bf16 v[192:195], v[110:113], v[176:179], v[192:195]
    buffer_store_dwordx4 v[212:215], v245, s[20:23], s58 offen sc0 sc1
    v_mfma_f32_16x16x16_bf16 v[156:159], v[52:53], v[142:143], v[156:159]
    s_waitcnt lgkmcnt(0)
    v_exp_f32 v165, v165
    v_exp_f32 v166, v166
    v_exp_f32 v167, v167
    v_cvt_pk_bf16_f32 v180, v164, v165
    v_cvt_pk_bf16_f32 v181, v166, v167
    v_fma_f32 v169, v169, s37, -v236
    v_fma_f32 v170, v170, s37, -v236
    v_fma_f32 v171, v171, s37, -v236
    v_mfma_f32_16x16x32_bf16 v[160:163], v[54:57], v[138:141], v[160:163]
    v_exp_f32 v168, v168
    v_exp_f32 v169, v169
    v_exp_f32 v170, v170
    v_exp_f32 v171, v171
    v_cvt_pk_bf16_f32 v182, v168, v169
    v_cvt_pk_bf16_f32 v183, v170, v171
    v_mfma_f32_16x16x16_bf16 v[160:163], v[58:59], v[142:143], v[160:163]
    v_max3_f32 v248, v172, v173, v174
    v_max3_f32 v249, v175, v144, v145
    v_mfma_f32_16x16x32_bf16 v[196:199], a[216:219], v[180:183], v[196:199]
    v_max3_f32 v248, v248, v146, v147
    v_max3_f32 v249, v249, v148, v149
    v_mfma_f32_16x16x32_bf16 v[184:187], v[70:73], v[180:183], v[184:187]
    v_max3_f32 v248, v248, v150, v151
    v_max3_f32 v249, v249, v152, v153
    v_mfma_f32_16x16x32_bf16 v[188:191], v[92:95], v[180:183], v[188:191]
    v_max3_f32 v248, v248, v154, v155
    v_max3_f32 v249, v249, v156, v157
    v_mfma_f32_16x16x32_bf16 v[192:195], v[114:117], v[180:183], v[192:195]
    buffer_store_dwordx4 v[204:207], v244, s[20:23], s58 offen sc0 sc1
    v_rcp_f32 v197, v196
    s_add_u32 s58, s51, 0x1f8000
    v_mul_f32 v184, v184, v197
    v_mul_f32 v185, v185, v197
    v_cvt_pk_bf16_f32 v184, v184, v185
    v_mul_f32 v186, v186, v197
    v_mul_f32 v187, v187, v197
    v_cvt_pk_bf16_f32 v185, v186, v187
    v_mul_f32 v188, v188, v197
    v_mul_f32 v189, v189, v197
    v_cvt_pk_bf16_f32 v186, v188, v189
    v_mul_f32 v190, v190, v197
    v_mul_f32 v191, v191, v197
    v_cvt_pk_bf16_f32 v187, v190, v191
    v_mul_f32 v192, v192, v197
    v_mul_f32 v193, v193, v197
    v_cvt_pk_bf16_f32 v188, v192, v193
    v_mul_f32 v194, v194, v197
    v_mul_f32 v195, v195, v197
    v_cvt_pk_bf16_f32 v189, v194, v195
    ds_write_b128 v237, v[184:187]
    ds_write_b64 v238, v[188:189]
    v_max3_f32 v248, v248, v158, v159
    v_max3_f32 v249, v249, v160, v161
    v_max3_f32 v248, v248, v162, v163
    v_max_f32 v248, v248, v249
    v_mov_b32 v249, v248
    s_nop 1
    v_permlane16_swap_b32 v248, v249
    v_max_f32 v248, v248, v249
    v_mov_b32 v249, v248
    s_nop 1
    v_permlane32_swap_b32 v248, v249
    v_max_f32 v248, v248, v249
    v_mul_f32 v236, s37, v248
    v_fma_f32 v172, v172, s37, -v236
    v_fma_f32 v173, v173, s37, -v236
    v_fma_f32 v174, v174, s37, -v236
    v_fma_f32 v175, v175, s37, -v236
    v_exp_f32 v172, v172
    v_exp_f32 v173, v173
    v_exp_f32 v174, v174
    v_exp_f32 v175, v175
    v_cvt_pk_bf16_f32 v176, v172, v173
    v_cvt_pk_bf16_f32 v177, v174, v175
    v_fma_f32 v144, v144, s37, -v236
    v_fma_f32 v145, v145, s37, -v236
    v_fma_f32 v146, v146, s37, -v236
    v_fma_f32 v147, v147, s37, -v236
    v_exp_f32 v144, v144
    v_exp_f32 v145, v145
    v_exp_f32 v146, v146
    v_exp_f32 v147, v147
    v_cvt_pk_bf16_f32 v178, v144, v145
    s_waitcnt lgkmcnt(0)
    s_barrier
    ds_read_b128 a[248:251], v224
    ds_read_b128 a[252:255], v224 offset:1024
    v_cvt_pk_bf16_f32 v179, v146, v147
    v_fma_f32 v148, v148, s37, -v236
    ds_read_b128 a[236:239], v224 offset:2048
    v_mfma_f32_16x16x32_bf16 v[196:199], a[216:219], v[176:179], 0
    ds_read_b128 a[240:243], v224 offset:3072
    v_fma_f32 v149, v149, s37, -v236
    v_mfma_f32_16x16x32_bf16 v[184:187], v[76:79], v[176:179], 0
    ds_read_b128 a[244:247], v224 offset:4096
    v_fma_f32 v150, v150, s37, -v236
    v_mfma_f32_16x16x32_bf16 v[188:191], v[98:101], v[176:179], 0
    ds_read_b128 v[252:255], v224 offset:5120
    v_fma_f32 v151, v151, s37, -v236
    v_mfma_f32_16x16x32_bf16 v[192:195], v[120:123], v[176:179], 0
    s_waitcnt lgkmcnt(5)
    v_exp_f32 v148, v148
    v_exp_f32 v149, v149
    v_exp_f32 v150, v150
    v_exp_f32 v151, v151
    v_cvt_pk_bf16_f32 v180, v148, v149
    v_cvt_pk_bf16_f32 v181, v150, v151
    v_fma_f32 v152, v152, s37, -v236
    v_mfma_f32_16x16x32_bf16 v[220:223], a[220:223], a[248:251], 0
    v_fma_f32 v153, v153, s37, -v236
    v_fma_f32 v154, v154, s37, -v236
    v_mfma_f32_16x16x32_bf16 v[216:219], a[224:227], a[248:251], 0
    v_fma_f32 v155, v155, s37, -v236
    v_fma_f32 v156, v156, s37, -v236
    v_mfma_f32_16x16x32_bf16 v[212:215], a[228:231], a[248:251], 0
    v_exp_f32 v152, v152
    v_mfma_f32_16x16x32_bf16 v[208:211], a[232:235], a[248:251], 0
    s_waitcnt lgkmcnt(3)
    ds_read_b128 a[248:251], v242 offset:61440
    v_fma_f32 v157, v157, s37, -v236
    v_mfma_f32_16x16x32_bf16 v[220:223], a[0:3], a[252:255], v[220:223]
    v_exp_f32 v153, v153
    v_mfma_f32_16x16x32_bf16 v[216:219], a[4:7], a[252:255], v[216:219]
    v_exp_f32 v154, v154
    v_mfma_f32_16x16x32_bf16 v[212:215], a[8:11], a[252:255], v[212:215]
    v_exp_f32 v155, v155
    v_mfma_f32_16x16x32_bf16 v[208:211], a[12:15], a[252:255], v[208:211]
    ds_read_b128 a[252:255], v242 offset:61952
    v_cvt_pk_bf16_f32 v182, v152, v153
    v_mfma_f32_16x16x32_bf16 v[220:223], a[16:19], a[236:239], v[220:223]
    v_cvt_pk_bf16_f32 v183, v154, v155
    v_fma_f32 v158, v158, s37, -v236
    v_mfma_f32_16x16x32_bf16 v[216:219], a[20:23], a[236:239], v[216:219]
    v_fma_f32 v159, v159, s37, -v236
    v_fma_f32 v160, v160, s37, -v236
    v_mfma_f32_16x16x32_bf16 v[196:199], a[216:219], v[180:183], v[196:199]
    v_exp_f32 v156, v156
    v_mfma_f32_16x16x32_bf16 v[184:187], v[68:71], v[180:183], v[184:187]
    v_exp_f32 v157, v157
    v_mfma_f32_16x16x32_bf16 v[188:191], v[90:93], v[180:183], v[188:191]
    v_exp_f32 v158, v158
    v_mfma_f32_16x16x32_bf16 v[192:195], v[112:115], v[180:183], v[192:195]
    v_exp_f32 v159, v159
    v_mfma_f32_16x16x32_bf16 v[212:215], a[24:27], a[236:239], v[212:215]
    v_cvt_pk_bf16_f32 v176, v156, v157
    v_cvt_pk_bf16_f32 v177, v158, v159
    v_mfma_f32_16x16x32_bf16 v[208:211], a[28:31], a[236:239], v[208:211]
    s_waitcnt lgkmcnt(1)
    v_fma_f32 v161, v161, s37, -v236
    v_fma_f32 v162, v162, s37, -v236
    v_mfma_f32_16x16x32_bf16 v[220:223], a[32:35], a[240:243], v[220:223]
    v_fma_f32 v163, v163, s37, -v236
    v_mfma_f32_16x16x32_bf16 v[216:219], a[36:39], a[240:243], v[216:219]
    v_exp_f32 v160, v160
    v_mfma_f32_16x16x32_bf16 v[212:215], a[40:43], a[240:243], v[212:215]
    v_exp_f32 v161, v161
    v_mfma_f32_16x16x32_bf16 v[208:211], a[44:47], a[240:243], v[208:211]
    v_exp_f32 v162, v162
    v_mfma_f32_16x16x32_bf16 v[220:223], a[48:51], a[244:247], v[220:223]
    v_exp_f32 v163, v163
    v_mfma_f32_16x16x32_bf16 v[216:219], a[52:55], a[244:247], v[216:219]
    v_cvt_pk_bf16_f32 v178, v160, v161
    v_cvt_pk_bf16_f32 v179, v162, v163
    v_mfma_f32_16x16x32_bf16 v[212:215], a[56:59], a[244:247], v[212:215]
    v_mfma_f32_16x16x32_bf16 v[208:211], a[60:63], a[244:247], v[208:211]
    v_mfma_f32_16x16x32_bf16 v[196:199], a[216:219], v[176:179], v[196:199]
    v_mfma_f32_16x16x32_bf16 v[184:187], v[82:85], v[176:179], v[184:187]
    v_mfma_f32_16x16x32_bf16 v[188:191], v[104:107], v[176:179], v[188:191]
    v_mfma_f32_16x16x32_bf16 v[192:195], v[126:129], v[176:179], v[192:195]
    v_mfma_f32_16x16x32_bf16 v[220:223], a[64:67], v[252:255], v[220:223]
    v_mfma_f32_16x16x32_bf16 v[216:219], a[68:71], v[252:255], v[216:219]
    v_mfma_f32_16x16x32_bf16 v[212:215], a[248:251], v[252:255], v[212:215]
    s_waitcnt lgkmcnt(0)
    v_mfma_f32_16x16x32_bf16 v[208:211], a[252:255], v[252:255], v[208:211]
    s_nop 0
    v_rcp_f32 v197, v196
    s_nop 0
    v_mul_f32 v184, v184, v197
    v_mul_f32 v185, v185, v197
    v_cvt_pk_bf16_f32 v220, v220, v221
    v_cvt_pk_bf16_f32 v221, v222, v223
    v_cvt_pk_bf16_f32 v222, v216, v217
    v_cvt_pk_bf16_f32 v223, v218, v219
    buffer_store_dwordx4 v[220:223], v225, s[20:23], s58 offen sc0 sc1
    v_cvt_pk_bf16_f32 v212, v212, v213
    v_cvt_pk_bf16_f32 v213, v214, v215
    v_cvt_pk_bf16_f32 v214, v208, v209
    v_cvt_pk_bf16_f32 v215, v210, v211
    v_cvt_pk_bf16_f32 v184, v184, v185
    v_mul_f32 v186, v186, v197
    v_mul_f32 v187, v187, v197
    v_cvt_pk_bf16_f32 v185, v186, v187
    v_mul_f32 v188, v188, v197
    v_mul_f32 v189, v189, v197
    v_cvt_pk_bf16_f32 v186, v188, v189
    v_mul_f32 v190, v190, v197
    v_mul_f32 v191, v191, v197
    v_cvt_pk_bf16_f32 v187, v190, v191
    v_mul_f32 v192, v192, v197
    v_mul_f32 v193, v193, v197
    v_cvt_pk_bf16_f32 v188, v192, v193
    v_mul_f32 v194, v194, v197
    v_mul_f32 v195, v195, v197
    v_cvt_pk_bf16_f32 v189, v194, v195
    ds_write_b128 v237, v[184:187] offset:6144
    ds_write_b64 v238, v[188:189] offset:6144
    buffer_store_dwordx4 v[212:215], v226, s[20:23], s58 offen sc0 sc1
    s_add_u32 s58, s51, 0x1f8000
    s_waitcnt lgkmcnt(0)
    s_barrier
    ds_read_b128 a[236:239], v227
    ds_read_b128 a[240:243], v227 offset:1024
    ds_read_b128 a[244:247], v227 offset:2048
    ds_read_b128 v[252:255], v227 offset:3072
    ds_read_b128 a[248:251], v227 offset:4096
    ds_read_b128 a[252:255], v227 offset:5120
    s_waitcnt lgkmcnt(5)
    v_mfma_f32_16x16x32_bf16 v[204:207], a[220:223], a[236:239], 0
    v_mfma_f32_16x16x32_bf16 v[200:203], a[224:227], a[236:239], 0
    v_mfma_f32_16x16x32_bf16 v[220:223], a[228:231], a[236:239], 0
    v_mfma_f32_16x16x32_bf16 v[216:219], a[232:235], a[236:239], 0
    s_waitcnt lgkmcnt(3)
    ds_read_b128 a[236:239], v242 offset:61440
    v_mfma_f32_16x16x32_bf16 v[204:207], a[0:3], a[240:243], v[204:207]
    v_mfma_f32_16x16x32_bf16 v[200:203], a[4:7], a[240:243], v[200:203]
    v_mfma_f32_16x16x32_bf16 v[220:223], a[8:11], a[240:243], v[220:223]
    v_mfma_f32_16x16x32_bf16 v[216:219], a[12:15], a[240:243], v[216:219]
    ds_read_b128 a[240:243], v242 offset:61952
    v_mfma_f32_16x16x32_bf16 v[204:207], a[16:19], a[244:247], v[204:207]
    v_mfma_f32_16x16x32_bf16 v[200:203], a[20:23], a[244:247], v[200:203]
    v_mfma_f32_16x16x32_bf16 v[220:223], a[24:27], a[244:247], v[220:223]
    v_mfma_f32_16x16x32_bf16 v[216:219], a[28:31], a[244:247], v[216:219]
    s_waitcnt lgkmcnt(2)
    v_mfma_f32_16x16x32_bf16 v[204:207], a[32:35], v[252:255], v[204:207]
    v_mfma_f32_16x16x32_bf16 v[200:203], a[36:39], v[252:255], v[200:203]
    v_mfma_f32_16x16x32_bf16 v[220:223], a[40:43], v[252:255], v[220:223]
    v_mfma_f32_16x16x32_bf16 v[216:219], a[44:47], v[252:255], v[216:219]
    v_mfma_f32_16x16x32_bf16 v[204:207], a[48:51], a[248:251], v[204:207]
    v_mfma_f32_16x16x32_bf16 v[200:203], a[52:55], a[248:251], v[200:203]
    v_mfma_f32_16x16x32_bf16 v[220:223], a[56:59], a[248:251], v[220:223]
    v_mfma_f32_16x16x32_bf16 v[216:219], a[60:63], a[248:251], v[216:219]
    v_mfma_f32_16x16x32_bf16 v[204:207], a[64:67], a[252:255], v[204:207]
    v_mfma_f32_16x16x32_bf16 v[200:203], a[68:71], a[252:255], v[200:203]
    s_waitcnt lgkmcnt(0)
    v_mfma_f32_16x16x32_bf16 v[220:223], a[236:239], a[252:255], v[220:223]
    v_mfma_f32_16x16x32_bf16 v[216:219], a[240:243], a[252:255], v[216:219]
    s_nop 4
    v_cvt_pk_bf16_f32 v204, v204, v205
    v_cvt_pk_bf16_f32 v205, v206, v207
    v_cvt_pk_bf16_f32 v206, v200, v201
    v_cvt_pk_bf16_f32 v207, v202, v203
    buffer_store_dwordx4 v[204:207], v246, s[20:23], s58 offen sc0 sc1
    v_cvt_pk_bf16_f32 v220, v220, v221
    v_cvt_pk_bf16_f32 v221, v222, v223
    v_cvt_pk_bf16_f32 v222, v216, v217
    v_cvt_pk_bf16_f32 v223, v218, v219
    buffer_store_dwordx4 v[220:223], v247, s[20:23], s58 offen sc0 sc1
    s_endpgm
.section .rodata,"a"
.p2align 6
.amdhsa_kernel standalone__neighborhood_dinat__vision_kernel
  .amdhsa_next_free_vgpr 512
  .amdhsa_next_free_sgpr 102
  .amdhsa_accum_offset 256
  .amdhsa_group_segment_fixed_size 0
  .amdhsa_kernarg_size 56
  .amdhsa_user_sgpr_count 2
  .amdhsa_user_sgpr_kernarg_segment_ptr 1
  .amdhsa_system_sgpr_workgroup_id_x 1
.end_amdhsa_kernel
```

```asm
; @launch grid=(256,1,1) block=(256,1,1) lds=163344
.amdgcn_target "amdgcn-amd-amdhsa--gfx950"
.text
.globl standalone__neighborhood_dinat__vision_kernel
.p2align 8
.type standalone__neighborhood_dinat__vision_kernel,@function
standalone__neighborhood_dinat__vision_kernel:
    s_cmp_ge_u32 s2, 256
    s_cbranch_scc1 L_exit
L_go:
    s_load_dwordx4 s[24:27], s[0:1], 0
    s_load_dwordx4 s[28:31], s[0:1], 16
    s_load_dwordx2 s[32:33], s[0:1], 32
    s_getpc_b64 s[12:13]
    s_and_b32 s13, s13, 0xffff
    s_mov_b32 s14, L_end-L_go-64
    s_mov_b32 s15, 0x20000
    s_lshl_b32 s52, s2, 10
    v_lshlrev_b32 v189, 5, v0
    s_and_b32 s53, s52, 0xe000
    buffer_load_dword v188, v189, s[12:15], s53 offen
    v_lshrrev_b32 v74, 6, v0
    v_and_b32 v184, 63, v0
    v_readfirstlane_b32 s36, v74
    v_mul_u32_u24 v76, 0x2aab, v184
    v_lshrrev_b32 v76, 16, v76
    v_mul_u32_u24 v74, 6, v76
    v_sub_u32 v77, v184, v74
    v_lshrrev_b32 v74, 1, v76
    v_and_b32 v74, 4, v74
    v_xor_b32 v76, v76, v74
    v_mul_u32_u24 v74, 0x480, v76
    v_lshl_add_u32 v251, v77, 4, v74
    v_add_u32 v79, 64, v184
    v_mul_u32_u24 v78, 0x2aab, v79
    v_lshrrev_b32 v78, 16, v78
    v_mul_u32_u24 v74, 6, v78
    v_sub_u32 v79, v79, v74
    v_lshrrev_b32 v74, 1, v78
    v_and_b32 v74, 4, v74
    v_xor_b32 v78, v78, v74
    v_mul_u32_u24 v74, 0x480, v78
    v_lshl_add_u32 v252, v79, 4, v74
    v_add_u32 v81, 0x80, v184
    v_mul_u32_u24 v80, 0x2aab, v81
    v_lshrrev_b32 v80, 16, v80
    v_mul_u32_u24 v74, 6, v80
    v_sub_u32 v81, v81, v74
    v_lshrrev_b32 v74, 1, v80
    v_and_b32 v74, 4, v74
    v_xor_b32 v80, v80, v74
    v_mul_u32_u24 v74, 0x480, v80
    v_lshl_add_u32 v253, v81, 4, v74
    s_mul_i32 s49, s36, 0x60
    s_mul_i32 s50, s36, 0xc00
    s_add_u32 s50, s50, 0x15e00
    s_mov_b32 s10, 0x36000
    s_mov_b32 s11, 0x20000
    s_and_b32 s53, s52, 0x3e000
    s_mov_b32 s18, 0x548
    s_mov_b32 s19, 0x20000
    s_mul_i32 s58, s36, 0x152
    v_lshlrev_b32 v199, 1, v184
    s_add_u32 s57, s49, 0x180
    s_add_u32 m0, s50, 0
    s_and_b32 s54, s2, 1
    s_lshl_b32 s54, s54, 2
    s_lshl_b32 s41, s36, 10
    s_add_u32 s42, s41, 0x1000
    s_min_u32 s42, s42, 0x1a00
    s_mov_b32 s6, 0x1260000
    s_mov_b32 s7, 0x20000
    s_mov_b32 s14, 0x12000
    s_mov_b32 s15, 0x20000
    s_mov_b32 s22, 0x1260000
    s_mov_b32 s23, 0x20000
    s_and_b32 s52, s52, 0x1e000
    v_lshrrev_b32 v185, 4, v184
    v_and_b32 v186, 7, v184
    v_bfe_u32 v187, v184, 3, 1
    v_and_b32 v103, 1, v185
    v_mul_u32_u24 v102, 0x1e40, v187
    v_mul_u32_u24 v100, 0x180, v186
    s_mov_b32 s40, 0x140
    v_mul_u32_u24 v119, 13, v184
    v_lshrrev_b32 v119, 8, v119
    v_mul_u32_u24 v118, 20, v119
    v_sub_u32 v118, v184, v118
    v_add_u32 v120, -11, v118
    v_max_i32 v120, 0, v120
    v_mul_u32_u24 v121, 11, v120
    v_lshrrev_b32 v121, 5, v121
    v_mul_u32_u24 v122, 3, v121
    v_sub_u32 v120, v120, v122
    v_lshlrev_b32 v120, 2, v120
    v_sub_u32 v121, v120, v121
    v_cmp_lt_u32 vcc, 10, v118
    v_add_u32 v122, -3, v118
    s_mov_b32 s68, 0x3fb8aa3b
    v_mov_b32 v124, 0xf149f2ca
    v_mul_u32_u24 v74, 0x180, v76
    v_lshl_add_u32 v192, v77, 4, v74
    v_and_b32 v74, 16, v76
    v_mul_u32_u24 v74, 0x300, v74
    v_add_u32 v86, v74, v192
    v_mul_u32_u24 v74, 0x180, v78
    v_lshl_add_u32 v193, v79, 4, v74
    v_and_b32 v74, 16, v78
    v_mul_u32_u24 v74, 0x300, v74
    v_add_u32 v87, v74, v193
    v_mul_u32_u24 v74, 0x180, v80
    v_lshl_add_u32 v194, v81, 4, v74
    v_and_b32 v74, 16, v80
    v_mul_u32_u24 v74, 0x300, v74
    v_add_u32 v108, v74, v194
    s_mov_b32 s37, 0x3e553b95
    v_mov_b32 v236, 1.0
    v_lshrrev_b32 v60, 1, v185
    s_waitcnt lgkmcnt(0)
    s_mov_b32 s8, s26
    s_and_b32 s9, s27, 0xffff
    buffer_load_dword v188, v189, s[8:11], s53 offen
    s_mov_b32 s16, s30
    s_and_b32 s17, s31, 0xffff
    buffer_load_ushort v196, v199, s[16:19], s58 offen
    buffer_load_ushort v197, v199, s[16:19], s58 offen offset:128
    buffer_load_ushort v198, v199, s[16:19], s58 offen offset:256
    buffer_load_dwordx4 v251, s[8:11], s57 offen lds
    s_add_u32 m0, s50, 0x400
    s_lshr_b32 s53, s2, 3
    s_lshr_b32 s55, s53, 3
    s_or_b32 s34, s54, s55
    s_and_b32 s35, s53, 7
    buffer_load_dwordx4 v252, s[8:11], s57 offen lds
    s_add_u32 m0, s50, 0x800
    s_bfe_u32 s54, s2, 0x10002
    s_mul_i32 s54, s54, 0x15000
    s_bfe_u32 s55, s2, 0x10001
    s_mul_i32 s55, s55, 0x180
    s_add_u32 s38, s54, s55
    s_mul_i32 s54, s35, 14
    s_sub_u32 s54, s54, 3
    s_movk_i32 s53, 0x6f
    s_lshr_b32 s55, s41, 4
    v_add_u32 v96, s55, v184
    v_mul_u32_u24 v97, 0xaab, v96
    v_lshrrev_b32 v97, 16, v97
    buffer_load_dwordx4 v253, s[8:11], s57 offen lds
    v_mul_u32_u24 v98, 24, v97
    v_sub_u32 v96, v96, v98
    v_and_b32 v98, 2, v97
    v_xor_b32 v96, v96, v98
    v_add_u32 v97, s54, v97
    v_med3_i32 v97, v97, 0, s53
    v_mul_u32_u24 v97, 0x300, v97
    v_lshl_add_u32 v246, v96, 4, v97
    s_lshr_b32 s55, s42, 4
    v_add_u32 v96, s55, v184
    v_mul_u32_u24 v97, 0xaab, v96
    v_lshrrev_b32 v97, 16, v97
    v_mul_u32_u24 v98, 24, v97
    v_sub_u32 v96, v96, v98
    v_and_b32 v98, 2, v97
    v_xor_b32 v96, v96, v98
    v_add_u32 v97, s54, v97
    v_med3_i32 v97, v97, 0, s53
    v_mul_u32_u24 v97, 0x300, v97
    v_lshl_add_u32 v247, v96, 4, v97
    s_mul_i32 s51, s34, 0x24c000
    s_add_u32 s51, s51, s38
    s_sub_u32 s39, s51, 0x7e000
    s_cmp_eq_u32 s34, 0
    s_cselect_b32 s43, 8, 0
    s_cselect_b32 s44, 9, 1
    s_cselect_b32 s45, 3, 2
    s_mul_i32 s43, s43, 0x2a000
    s_add_u32 s43, s43, s39
    s_mul_i32 s44, s44, 0x2a000
    s_add_u32 s44, s44, s39
    s_mul_i32 s45, s45, 0x2a000
    s_add_u32 s45, s45, s39
    s_mov_b32 s4, s24
    s_and_b32 s5, s25, 0xffff
    s_mov_b32 s12, s28
    s_and_b32 s13, s29, 0xffff
    s_mov_b32 s20, s32
    s_and_b32 s21, s33, 0xffff
    s_add_u32 m0, s41, 0
    s_add_u32 s56, s39, 0x7e000
    buffer_load_dwordx4 v246, s[4:7], s43 offen lds
    s_add_u32 m0, s42, 0
    s_add_u32 s57, s49, 0x9180
    buffer_load_dwordx4 v247, s[4:7], s43 offen lds
    s_add_u32 m0, s41, 0x1e40
    v_bfe_u32 v96, v184, 2, 2
    v_and_b32 v97, 3, v184
    v_lshl_add_u32 v99, v185, 3, v96
    v_lshl_add_u32 v99, v103, 2, v99
    v_lshl_add_u32 v101, v97, 3, s50
    s_movk_i32 s27, 0x60
    v_mad_u32_u24 v254, v99, s27, v101
    buffer_load_dwordx4 v246, s[4:7], s44 offen lds
    s_add_u32 m0, s42, 0x1e40
    v_xor_b32 v99, 4, v99
    v_mad_u32_u24 v255, v99, s27, v101
    v_and_b32 v98, 2, v184
    v_xor_b32 v98, v98, v185
    v_lshlrev_b32 v98, 4, v98
    v_add3_u32 v224, v98, v100, v102
    v_mul_u32_u24 v99, 0x1e40, v96
    buffer_load_dwordx4 v247, s[4:7], s44 offen lds
    s_add_u32 m0, s41, 0x3c80
    v_mul_u32_u24 v227, 0x180, v97
    v_add3_u32 v227, v227, v98, v99
    s_cmp_eq_u32 s35, 0
    s_cselect_b32 s29, 3, 0
    s_cselect_b32 s30, -3, -2
    s_mul_i32 s32, s36, 0xf00
    s_add_u32 s32, s32, 0xf200
    s_lshl_b32 s31, s36, 10
    s_add_u32 s31, s31, 0x12e40
    v_add_u32 v121, s29, v121
    buffer_load_dwordx4 v246, s[4:7], s45 offen lds
    s_add_u32 m0, s42, 0x3c80
    v_add_u32 v120, s30, v120
    v_cndmask_b32 v121, v118, v121, vcc
    v_cndmask_b32 v120, v122, v120, vcc
    v_mad_u32_u24 v121, v119, 13, v121
    v_lshl_add_u32 v121, v121, 2, s31
    s_cmp_eq_u32 s34, 0
    s_cselect_b32 s28, 0x208, 0
    v_add_u32 v122, s28, v121
    buffer_load_dwordx4 v247, s[4:7], s45 offen lds
    s_add_u32 m0, s41, 0x5ac0
    v_cmp_gt_u32 s[60:61], 7, v120
    v_add_u32 v120, 1, v120
    v_cmp_gt_u32 s[62:63], 7, v120
    v_add_u32 v120, 1, v120
    v_cmp_gt_u32 s[64:65], 7, v120
    v_add_u32 v120, 1, v120
    buffer_load_dwordx4 v246, s[4:7], s56 offen lds
    s_add_u32 m0, s42, 0x5ac0
    v_cmp_gt_u32 s[66:67], 7, v120
    v_lshl_add_u32 v123, v184, 4, s32
    v_lshl_add_u32 v125, v184, 2, s31
    s_and_b32 s72, s60, 0xfff00000
    s_and_b32 s70, s62, 0xfff00000
    v_add_u32 v98, 3, v186
    v_and_b32 v98, 2, v98
    v_xor_b32 v98, v98, v185
    buffer_load_dwordx4 v247, s[4:7], s56 offen lds
    s_add_u32 m0, s50, 0x3000
    s_add_u32 s56, s39, 0xa8000
    v_lshl_add_u32 v98, v98, 4, v100
    v_add_u32 v225, v98, v102
    v_xor_b32 v99, 1, v187
    v_mul_u32_u24 v99, 0xd3c0, v99
    v_add_u32 v226, v98, v99
    v_lshl_add_u32 v99, v185, 2, v96
    buffer_load_dwordx4 v251, s[8:11], s57 offen lds
    s_add_u32 m0, s50, 0x3400
    v_and_b32 v98, 2, v185
    v_lshlrev_b32 v98, 1, v98
    v_xor_b32 v99, v99, v98
    v_mul_u32_u24 v99, 0x60, v99
    v_lshl_add_u32 v131, v97, 4, v99
    v_lshrrev_b32 v98, 1, v97
    v_mul_u32_u24 v98, 0xba0, v98
    buffer_load_dwordx4 v252, s[8:11], s57 offen lds
    s_add_u32 m0, s50, 0x3800
    v_add_u32 v64, v131, v98
    v_bfrev_b32 v98, v97
    v_lshrrev_b32 v98, 27, v98
    v_add3_u32 v109, v99, v98, s50
    v_lshlrev_b32 v99, 7, v185
    v_lshl_add_u32 v99, v186, 4, v99
    v_lshl_add_u32 v101, v187, 9, v99
    buffer_load_dwordx4 v253, s[8:11], s57 offen lds
    s_mov_b64 exec, 0
    s_cmp_eq_u32 s36, 0
    s_cbranch_scc1 L_pg1
    s_cmp_eq_u32 s36, 1
    s_cbranch_scc1 L_pg2
    s_cmp_eq_u32 s36, 2
    s_cbranch_scc1 L_pg3
    s_branch L_pg4
    .p2align 12
L_back:
    s_mov_b64 exec, -1
    s_add_u32 s57, s49, 0x12180
    s_add_u32 m0, s50, 0x6000
    s_waitcnt vmcnt(11)
    ds_read_b64_tr_b16 a[0:1], v254
    buffer_load_dwordx4 v251, s[8:11], s57 offen lds
    s_add_u32 m0, s50, 0x6400
    ds_read_b64_tr_b16 a[2:3], v255
    buffer_load_dwordx4 v252, s[8:11], s57 offen lds
    s_add_u32 m0, s50, 0x6800
    ds_read_b64_tr_b16 a[4:5], v254 offset:32
    ds_read_b64_tr_b16 a[6:7], v255 offset:32
    ds_read_b64_tr_b16 a[8:9], v254 offset:64
    ds_read_b64_tr_b16 a[10:11], v255 offset:64
    v_lshlrev_b32 v196, 16, v196
    v_mul_f32 v196, s68, v196
    ds_write_b32 v125, v196
    v_lshlrev_b32 v197, 16, v197
    buffer_load_dwordx4 v253, s[8:11], s57 offen lds
    s_add_u32 m0, s41, 0x7900
    s_add_u32 s57, s49, 0x1b180
    v_mul_f32 v197, s68, v197
    ds_write_b32 v125, v197 offset:256
    v_lshlrev_b32 v198, 16, v198
    v_mul_f32 v198, s68, v198
    ds_write_b32 v125, v198 offset:512
    buffer_load_dwordx4 v246, s[4:7], s56 offen lds
    s_add_u32 m0, s42, 0x7900
    ds_read2_b32 v[144:145], v121 offset0:26 offset1:27
    ds_read2_b32 v[146:147], v121 offset0:28 offset1:29
    ds_read2_b32 v[148:149], v121 offset0:65 offset1:66
    ds_read2_b32 v[150:151], v121 offset0:67 offset1:68
    ds_read2_b32 v[152:153], v121 offset0:104 offset1:105
    v_add_u32 v130, s50, v101
    ds_read2_b32 v[154:155], v121 offset0:106 offset1:107
    ds_read2_b32 v[156:157], v122 offset0:0 offset1:1
    ds_read2_b32 v[158:159], v122 offset0:2 offset1:3
    v_lshl_add_u32 v99, v187, 10, v99
    s_and_b32 s24, s36, 1
    s_lshl_b32 s25, s24, 10
    buffer_load_dwordx4 v247, s[4:7], s56 offen lds
    s_add_u32 s56, s39, 0xd2000
    s_add_u32 m0, s41, 0x9740
    s_add_u32 s26, s25, s50
    v_add_u32 v241, s26, v99
    s_lshr_b32 s27, s36, 1
    s_mul_i32 s26, s27, 0x1800
    s_add_u32 s26, s26, 0x16600
    v_add_u32 v242, s26, v99
    s_sub_u32 s26, s26, 0x7c0
    v_add_u32 v65, s26, v64
    s_lshl_b32 s25, s24, 5
    s_add_u32 s26, s25, s50
    v_add_u32 v131, s26, v131
    v_mul_u32_u24 v99, 0x2a000, v187
    v_lshl_add_u32 v99, v100, 1, v99
    buffer_load_dwordx4 v246, s[4:7], s56 offen lds
    s_add_u32 m0, s42, 0x9740
    s_waitcnt lgkmcnt(5)
    v_cndmask_b32 v148, v124, v148, s[60:61]
    v_cndmask_b32 v149, v124, v149, s[62:63]
    s_waitcnt lgkmcnt(4)
    v_cndmask_b32 v150, v124, v150, s[64:65]
    v_cndmask_b32 v151, v124, v151, s[66:67]
    s_and_b32 s61, s61, 0xfffffff
    s_and_b32 s63, s63, 0xfffffff
    s_waitcnt lgkmcnt(1)
    v_cndmask_b32 v156, v124, v156, s[60:61]
    v_cndmask_b32 v157, v124, v157, s[62:63]
    s_and_b32 s65, s65, 0xfffffff
    s_waitcnt lgkmcnt(0)
    v_cndmask_b32 v158, v124, v158, s[64:65]
    s_and_b32 s67, s67, 0xfffffff
    v_cndmask_b32 v159, v124, v159, s[66:67]
    buffer_load_dwordx4 v247, s[4:7], s56 offen lds
    s_add_u32 m0, s50, 0x9000
    s_add_u32 s56, s39, 0xfc000
    s_mov_b32 s73, s61
    v_cndmask_b32 v144, v124, v144, s[72:73]
    s_mov_b32 s71, s63
    v_cndmask_b32 v145, v124, v145, s[70:71]
    s_and_b32 s72, s64, 0xfff00000
    s_mov_b32 s73, s65
    v_cndmask_b32 v146, v124, v146, s[72:73]
    s_and_b32 s70, s66, 0xfff00000
    s_mov_b32 s71, s67
    v_cndmask_b32 v147, v124, v147, s[70:71]
    s_and_b32 s61, s61, 0xff
    buffer_load_dwordx4 v251, s[8:11], s57 offen lds
    s_add_u32 m0, s50, 0x9400
    v_cndmask_b32 v152, v124, v152, s[60:61]
    s_and_b32 s63, s63, 0xff
    v_cndmask_b32 v153, v124, v153, s[62:63]
    s_and_b32 s65, s65, 0xff
    v_cndmask_b32 v154, v124, v154, s[64:65]
    s_and_b32 s67, s67, 0xff
    v_cndmask_b32 v155, v124, v155, s[66:67]
    ds_write_b128 v123, v[144:147]
    buffer_load_dwordx4 v252, s[8:11], s57 offen lds
    s_add_u32 m0, s50, 0x9800
    ds_write_b128 v123, v[148:151] offset:960
    s_waitcnt vmcnt(12)
    s_barrier
    ds_write_b128 v123, v[152:155] offset:1920
    ds_write_b128 v123, v[156:159] offset:2880
    buffer_load_dwordx4 v253, s[8:11], s57 offen lds
    s_add_u32 s57, s49, 0x24180
    s_add_u32 m0, s50, 0xc000
    v_lshl_add_u32 v99, v185, 4, v99
    v_cmp_lt_u32 vcc, 5, v186
    v_add_u32 v98, 0x1800, v99
    v_bfrev_b32 v101, 1
    v_cndmask_b32 v98, v98, v101, vcc
    s_sub_u32 s59, 0, s24
    s_mov_b32 vcc_lo, s59
    s_mov_b32 vcc_hi, s59
    v_cndmask_b32 v101, v99, v98, vcc
    v_cndmask_b32 v102, v98, v99, vcc
    s_add_u32 s25, s25, s49
    buffer_load_dwordx4 v251, s[8:11], s57 offen lds
    s_add_u32 m0, s50, 0xc400
    v_add_u32 v243, s25, v101
    v_add_u32 v245, s25, v102
    s_mul_i32 s26, s27, 0xc0
    s_add_u32 s26, s26, 64
    v_add_u32 v244, s26, v101
    s_mul_i32 s25, s35, 0x2a00
    s_add_u32 s51, s51, s25
    s_add_u32 s58, s51, 0
    v_lshlrev_b32 v99, 4, v184
    v_add_u32 v99, 0x12e00, v99
    s_mul_i32 s25, s24, 0x1800
    v_add_u32 v239, s25, v99
    s_sub_u32 s25, 0x1800, s25
    v_add_u32 v240, s25, v99
    buffer_load_dwordx4 v252, s[8:11], s57 offen lds
    s_add_u32 m0, s50, 0xc800
    s_mul_i32 s25, s27, 0xc00
    s_lshl_b32 s26, s24, 11
    s_add_u32 s26, s26, s25
    s_waitcnt vmcnt(12)
    ds_read_b64_tr_b16 a[12:13], v254 offset:12288
    ds_read_b64_tr_b16 a[14:15], v255 offset:12288
    ds_read_b64_tr_b16 a[16:17], v254 offset:12320
    ds_read_b64_tr_b16 a[18:19], v255 offset:12320
    ds_read_b64_tr_b16 a[20:21], v254 offset:12352
    v_add_u32 v237, s26, v99
    ds_read_b64_tr_b16 a[22:23], v255 offset:12352
    buffer_load_dwordx4 v253, s[8:11], s57 offen lds
    s_add_u32 m0, s41, 0xb580
    s_add_u32 s57, s49, 0x2d180
    ds_read_b128 a[236:239], v224
    ds_read_b128 a[240:243], v224 offset:3072
    s_lshl_b32 s26, s24, 3
    s_add_u32 s26, s26, s25
    ds_read_b128 a[244:247], v224 offset:15488
    s_lshl_b32 s25, s36, 2
    s_add_u32 s25, s25, 0x27e00
    s_add_u32 s26, s26, 0x400
    ds_read_b128 a[248:251], v224 offset:18560
    v_add_u32 v238, s26, v99
    s_cmp_eq_u32 s34, 7
    s_cselect_b32 s46, 16, 17
    s_cselect_b32 s47, 10, 18
    s_cselect_b32 s48, 11, 19
    buffer_load_dwordx4 v246, s[4:7], s56 offen lds
    s_add_u32 m0, s42, 0xb580
    ds_read_b128 a[252:255], v227 offset:6144
    ds_read_b128 a[220:223], v224 offset:64
    s_mul_i32 s46, s46, 0x2a000
    s_add_u32 s46, s46, s39
    ds_read_b128 a[224:227], v224 offset:3136
    s_mul_i32 s47, s47, 0x2a000
    s_add_u32 s47, s47, s39
    s_mul_i32 s48, s48, 0x2a000
    ds_read_b128 a[228:231], v224 offset:15552
    s_add_u32 s48, s48, s39
    v_mov_b32 v96, 0x3f803f80
    v_accvgpr_write_b32 a216, v96
    s_waitcnt vmcnt(11)
    ds_read_b64_tr_b16 a[24:25], v254 offset:24576
    s_waitcnt lgkmcnt(8)
    v_mfma_f32_16x16x32_bf16 v[12:15], a[0:3], a[236:239], 0
    s_cmp_eq_u32 s35, 7
    s_cselect_b32 s33, 2, 64
    ds_read_b64_tr_b16 a[26:27], v255 offset:24576
    v_mfma_f32_16x16x32_bf16 v[16:19], a[4:7], a[236:239], 0
    s_sub_u32 s31, s32, 0x140
    buffer_load_dwordx4 v247, s[4:7], s56 offen lds
    v_mfma_f32_16x16x32_bf16 v[20:23], a[8:11], a[236:239], 0
    s_add_u32 s56, s39, 0x126000
    ds_read_b64_tr_b16 a[28:29], v254 offset:24608
    ds_read_b64_tr_b16 a[30:31], v255 offset:24608
    s_waitcnt lgkmcnt(10)
    v_mfma_f32_16x16x32_bf16 v[36:39], a[0:3], a[240:243], 0
    s_add_u32 m0, s41, 0xd3c0
    ds_read_b64_tr_b16 a[32:33], v254 offset:24640
    ds_read_b64_tr_b16 a[34:35], v255 offset:24640
    v_mfma_f32_16x16x32_bf16 v[40:43], a[4:7], a[240:243], 0
    s_mov_b32 s60, 0x2222
    buffer_load_dwordx4 v246, s[4:7], s56 offen lds
    v_mfma_f32_16x16x32_bf16 v[44:47], a[8:11], a[240:243], 0
    s_add_u32 m0, s42, 0xd3c0
    ds_read_b128 a[232:235], v224 offset:18624
    ds_read_b128 a[236:239], v227 offset:6208
    s_waitcnt lgkmcnt(11)
    v_mfma_f32_16x16x32_bf16 v[132:135], a[0:3], a[244:247], 0
    s_mov_b32 s61, 0x4444
    ds_read_b128 a[240:243], v224 offset:128
    v_accvgpr_write_b32 a217, v96
    v_mfma_f32_16x16x32_bf16 v[136:139], a[4:7], a[244:247], 0
    s_mov_b32 s62, 0x8808
    v_accvgpr_write_b32 a218, v96
    v_accvgpr_write_b32 a219, v96
    v_mfma_f32_16x16x32_bf16 v[140:143], a[8:11], a[244:247], 0
    s_mov_b32 s63, 0x32104321
    buffer_load_dwordx4 v247, s[4:7], s56 offen lds
    v_mfma_f32_16x16x32_bf16 v[220:223], a[0:3], a[248:251], 0
    s_add_u32 m0, s50, 0xf000
    ds_read_b128 a[244:247], v224 offset:3200
    v_lshl_add_u32 v61, v187, 1, v60
    v_mfma_f32_16x16x32_bf16 v[216:219], a[4:7], a[248:251], 0
    s_add_u32 s56, s39, 0x150000
    v_lshlrev_b32 v232, 2, v61
    v_lshl_add_u32 v61, v187, 2, v185
    v_mfma_f32_16x16x32_bf16 v[212:215], a[8:11], a[248:251], 0
    s_mov_b32 s64, 0x76540765
    ds_read_b128 a[248:251], v224 offset:15616
    v_lshlrev_b32 v233, 2, v61
    v_mfma_f32_16x16x32_bf16 v[208:211], a[0:3], a[252:255], 0
    s_mov_b32 s65, 0x2222
    buffer_load_dwordx4 v251, s[8:11], s57 offen lds
    v_mfma_f32_16x16x32_bf16 v[204:207], a[4:7], a[252:255], 0
    s_add_u32 m0, s50, 0xf400
    v_sub_u32 v60, v60, v187
    v_mul_i32_i24 v60, 0x140, v60
    v_mfma_f32_16x16x32_bf16 v[200:203], a[8:11], a[252:255], 0
    s_mov_b32 s66, 0x10002100
    ds_read_b128 a[252:255], v224 offset:18688
    v_add_u32 v60, s31, v60
    s_waitcnt lgkmcnt(5)
    v_mfma_f32_16x16x32_bf16 v[12:15], a[12:15], a[220:223], v[12:15]
    s_mov_b32 s67, 0x54326543
    v_lshl_add_u32 v61, v103, 2, 3
    v_cmp_gt_u32 vcc, s29, v186
    v_mfma_f32_16x16x32_bf16 v[16:19], a[16:19], a[220:223], v[16:19]
    s_mov_b32 s68, 0x760007
    buffer_load_dwordx4 v252, s[8:11], s57 offen lds
    v_mfma_f32_16x16x32_bf16 v[20:23], a[20:23], a[220:223], v[20:23]
    s_add_u32 m0, s50, 0xf800
    ds_read_b128 a[220:223], v227 offset:6272
    v_sub_u32 v62, v61, v186
    v_mfma_f32_16x16x32_bf16 v[36:39], a[12:15], a[224:227], v[36:39]
    s_mov_b32 s69, 0x32104321
    v_min_u32 v63, 10, v62
    v_mad_u32_u24 v190, v186, 3, v103
    v_mfma_f32_16x16x32_bf16 v[40:43], a[16:19], a[224:227], v[40:43]
    s_mov_b32 s70, 0x76540765
    v_add_u32 v191, 11, v190
    v_cndmask_b32 v63, v63, v191, vcc
    v_mfma_f32_16x16x32_bf16 v[44:47], a[20:23], a[224:227], v[44:47]
    s_mov_b32 s71, 0x10002100
    ds_read_b128 a[224:227], v224 offset:192
    v_lshl_add_u32 v228, v63, 4, v60
    v_mfma_f32_16x16x32_bf16 v[132:135], a[12:15], a[228:231], v[132:135]
    s_mov_b32 s72, 0x760007
    buffer_load_dwordx4 v253, s[8:11], s57 offen lds
    v_mfma_f32_16x16x32_bf16 v[136:139], a[16:19], a[228:231], v[136:139]
    s_add_u32 s57, s49, 0x300
    v_add_u32 v62, 8, v62
    v_min_u32 v63, 10, v62
    v_mfma_f32_16x16x32_bf16 v[140:143], a[20:23], a[228:231], v[140:143]
    s_add_u32 m0, s50, 0
    ds_read_b128 a[228:231], v224 offset:3264
    v_lshl_add_u32 v62, v103, 4, v186
    v_mfma_f32_16x16x32_bf16 v[220:223], a[12:15], a[232:235], v[220:223]
    s_mov_b32 s73, 0x2222
    v_cmp_gt_u32 vcc, s29, v62
    v_add_u32 v191, 13, v190
    v_mfma_f32_16x16x32_bf16 v[216:219], a[16:19], a[232:235], v[216:219]
    s_mov_b32 s74, 0x8808
    buffer_load_dword v188, v189, s[12:15], s52 offen
    v_mfma_f32_16x16x32_bf16 v[212:215], a[20:23], a[232:235], v[212:215]
    s_mov_b32 s75, 0x760007
    buffer_load_dwordx4 v251, s[8:11], s57 offen lds
    s_waitcnt lgkmcnt(2)
    v_mfma_f32_16x16x32_bf16 v[208:211], a[12:15], a[236:239], v[208:211]
    s_add_u32 m0, s50, 0x400
    ds_read_b128 a[232:235], v224 offset:15680
    v_min_u32 v62, 5, v186
    v_mfma_f32_16x16x32_bf16 v[204:207], a[16:19], a[236:239], v[204:207]
    s_mov_b32 s76, 0x10002100
    v_cndmask_b32 v63, v63, v191, vcc
    v_lshl_add_u32 v229, v63, 4, v60
    v_mfma_f32_16x16x32_bf16 v[200:203], a[20:23], a[236:239], v[200:203]
    s_mov_b32 s77, 0x6666
    ds_read_b128 a[236:239], v224 offset:18752
    v_cmp_lt_u32 vcc, s33, v62
    v_mfma_f32_16x16x32_bf16 v[12:15], a[24:27], a[240:243], v[12:15]
    s_waitcnt vmcnt(15)
    s_barrier
    buffer_load_dwordx4 v252, s[8:11], s57 offen lds
    v_mfma_f32_16x16x32_bf16 v[16:19], a[28:31], a[240:243], v[16:19]
    s_add_u32 m0, s50, 0x800
    v_sub_u32 v63, v61, v62
    v_min_u32 v63, 10, v63
    v_mfma_f32_16x16x32_bf16 v[20:23], a[32:35], a[240:243], v[20:23]
    s_mov_b32 s78, 0x8808
    ds_read_b128 a[240:243], v227 offset:6336
    v_mad_u32_u24 v190, v62, 3, 2
    v_mfma_f32_16x16x32_bf16 v[36:39], a[24:27], a[244:247], v[36:39]
    s_mov_b32 s79, 0x32104321
    v_add_u32 v191, v190, v103
    v_cndmask_b32 v63, v63, v191, vcc
    v_mfma_f32_16x16x32_bf16 v[40:43], a[28:31], a[244:247], v[40:43]
    s_mov_b32 s80, 0x76540765
    buffer_load_dwordx4 v253, s[8:11], s57 offen lds
    v_mfma_f32_16x16x32_bf16 v[44:47], a[32:35], a[244:247], v[44:47]
    s_add_u32 s57, s49, 0x9300
    ds_read_b128 a[244:247], v224 offset:256
    v_lshl_add_u32 v230, v63, 4, v60
    v_mfma_f32_16x16x32_bf16 v[132:135], a[24:27], a[248:251], v[132:135]
    s_add_u32 m0, s50, 0x3000
    v_sub_u32 v63, 11, v62
    v_min_u32 v63, 10, v63
    v_mfma_f32_16x16x32_bf16 v[136:139], a[28:31], a[248:251], v[136:139]
    s_cmp_eq_u32 s34, 0
    s_cmov_b32 s60, 0xbbbb
    s_cmov_b32 s61, 0x4241
    v_mfma_f32_16x16x32_bf16 v[140:143], a[32:35], a[248:251], v[140:143]
    s_cmp_eq_u32 s34, 0
    s_cmov_b32 s62, 0x8898
    s_cmov_b32 s63, 0x30a940ba
    v_mfma_f32_16x16x32_bf16 v[220:223], a[24:27], a[252:255], v[220:223]
    s_cmp_eq_u32 s34, 0
    s_cmov_b32 s64, 0x76549765
    s_cmov_b32 s65, 0x2221
    v_mfma_f32_16x16x32_bf16 v[216:219], a[28:31], a[252:255], v[216:219]
    s_cmp_eq_u32 s34, 0
    s_cmov_b32 s66, 0x10002000
    s_cmov_b32 s68, 0x760097
    v_mfma_f32_16x16x32_bf16 v[212:215], a[32:35], a[252:255], v[212:215]
    s_cmp_eq_u32 s34, 7
    s_cmov_b32 s73, 0x2d22
    s_cmov_b32 s74, 0x1808
    v_mfma_f32_16x16x32_bf16 v[208:211], a[24:27], a[220:223], v[208:211]
    s_cmp_eq_u32 s34, 7
    s_cmov_b32 s75, 0x60007
    s_cmov_b32 s76, 0x1b002100
    v_mfma_f32_16x16x32_bf16 v[204:207], a[28:31], a[220:223], v[204:207]
    s_cmp_eq_u32 s34, 7
    s_cmov_b32 s77, 0x1606
    s_cmov_b32 s78, 0xbbbb
    v_mfma_f32_16x16x32_bf16 v[200:203], a[32:35], a[220:223], v[200:203]
    s_cmp_eq_u32 s34, 7
    s_cmov_b32 s79, 0x321b4321
    s_cmov_b32 s80, 0xa904ba05
    s_waitcnt vmcnt(14)
    ds_read_b64_tr_b16 a[36:37], v254 offset:36864
    ds_read_b64_tr_b16 a[38:39], v255 offset:36864
    ds_read_b64_tr_b16 a[40:41], v254 offset:36896
    ds_read_b64_tr_b16 a[42:43], v255 offset:36896
    ds_read_b64_tr_b16 a[44:45], v254 offset:36928
    buffer_load_dwordx4 v251, s[8:11], s57 offen lds
    ds_read_b64_tr_b16 a[46:47], v255 offset:36928
    s_add_u32 m0, s50, 0x3400
    ds_read_b128 a[248:251], v224 offset:3328
    buffer_load_dwordx4 v252, s[8:11], s57 offen lds
    s_add_u32 m0, s50, 0x3800
    ds_read_b128 a[252:255], v224 offset:15744
    v_bfe_u32 v234, s60, v232, 4
    v_mad_u32_u24 v235, v234, s40, v228
    ds_read_b128 a[220:223], v224 offset:18816
    v_mad_u32_u24 v234, v234, s40, v229
    ds_read_b128 v[144:147], v235
    buffer_load_dwordx4 v253, s[8:11], s57 offen lds
    s_add_u32 s57, s49, 0x12300
    s_add_u32 m0, s50, 0x6000
    ds_read_b128 v[148:151], v234
    v_bfe_u32 v234, s61, v232, 4
    v_mad_u32_u24 v235, v234, s40, v229
    v_mad_u32_u24 v234, v234, s40, v228
    v_add_u32 v191, 2, v190
    s_waitcnt lgkmcnt(9)
    v_mfma_f32_16x16x32_bf16 v[12:15], a[36:39], a[224:227], v[12:15]
    s_waitcnt vmcnt(14) lgkmcnt(7)
    ds_read_b64_tr_b16 a[48:49], v254 offset:49152
    ds_read_b64_tr_b16 a[50:51], v255 offset:49152
    v_mfma_f32_16x16x32_bf16 v[16:19], a[40:43], a[224:227], v[16:19]
    s_waitcnt lgkmcnt(7)
    ds_read_b64_tr_b16 a[52:53], v254 offset:49184
    ds_read_b64_tr_b16 a[54:55], v255 offset:49184
    v_mfma_f32_16x16x32_bf16 v[20:23], a[44:47], a[224:227], v[20:23]
    ds_read_b64_tr_b16 a[56:57], v254 offset:49216
    ds_read_b64_tr_b16 a[58:59], v255 offset:49216
    v_mfma_f32_16x16x32_bf16 v[36:39], a[36:39], a[228:231], v[36:39]
    buffer_load_dwordx4 v251, s[8:11], s57 offen lds
    v_mfma_f32_16x16x32_bf16 v[40:43], a[40:43], a[228:231], v[40:43]
    s_add_u32 m0, s50, 0x6400
    ds_read_b128 a[224:227], v227 offset:6400
    ds_read_b128 v[152:155], v235
    v_mfma_f32_16x16x32_bf16 v[44:47], a[44:47], a[228:231], v[44:47]
    v_cndmask_b32 v63, v63, v191, vcc
    v_lshl_add_u32 v231, v63, 4, s32
    v_mfma_f32_16x16x32_bf16 v[132:135], a[36:39], a[232:235], v[132:135]
    s_mov_b32 vcc_lo, s59
    s_mov_b32 vcc_hi, s59
    ds_read_b128 a[228:231], v224 offset:320
    v_mfma_f32_16x16x32_bf16 v[136:139], a[40:43], a[232:235], v[136:139]
    buffer_load_dwordx4 v252, s[8:11], s57 offen lds
    v_mfma_f32_16x16x32_bf16 v[140:143], a[44:47], a[232:235], v[140:143]
    s_add_u32 m0, s50, 0x6800
    ds_read_b128 a[232:235], v224 offset:3392
    ds_read_b128 v[156:159], v234
    v_mfma_f32_16x16x32_bf16 v[220:223], a[36:39], a[236:239], v[220:223]
    v_bfe_u32 v234, s62, v232, 4
    v_mad_u32_u24 v235, v234, s40, v229
    v_mfma_f32_16x16x32_bf16 v[216:219], a[40:43], a[236:239], v[216:219]
    buffer_load_dwordx4 v253, s[8:11], s57 offen lds
    v_mfma_f32_16x16x32_bf16 v[212:215], a[44:47], a[236:239], v[212:215]
    s_add_u32 s57, s49, 0x1b300
    ds_read_b128 a[236:239], v224 offset:15808
    v_mad_u32_u24 v234, v234, s40, v228
    v_mfma_f32_16x16x32_bf16 v[208:211], a[36:39], a[240:243], v[208:211]
    s_add_u32 m0, s50, 0x9000
    v_mfma_f32_16x16x32_bf16 v[204:207], a[40:43], a[240:243], v[204:207]
    v_mfma_f32_16x16x32_bf16 v[200:203], a[44:47], a[240:243], v[200:203]
    s_waitcnt lgkmcnt(5)
    ds_read_b128 a[240:243], v224 offset:18880
    v_mfma_f32_16x16x32_bf16 v[12:15], a[48:51], a[244:247], v[12:15]
    buffer_load_dwordx4 v251, s[8:11], s57 offen lds
    v_mfma_f32_16x16x32_bf16 v[16:19], a[52:55], a[244:247], v[16:19]
    s_add_u32 m0, s50, 0x9400
    v_mfma_f32_16x16x32_bf16 v[20:23], a[56:59], a[244:247], v[20:23]
    ds_read_b128 a[244:247], v227 offset:6464
    v_mfma_f32_16x16x32_bf16 v[36:39], a[48:51], a[248:251], v[36:39]
    v_mfma_f32_16x16x32_bf16 v[40:43], a[52:55], a[248:251], v[40:43]
    s_waitcnt vmcnt(14)
    buffer_load_dwordx4 v252, s[8:11], s57 offen lds
    v_mfma_f32_16x16x32_bf16 v[44:47], a[56:59], a[248:251], v[44:47]
    s_add_u32 m0, s50, 0x9800
    ds_read_b128 a[248:251], v224 offset:30976
    s_barrier
    v_mfma_f32_16x16x32_bf16 v[132:135], a[48:51], a[252:255], v[132:135]
    v_mfma_f32_16x16x32_bf16 v[136:139], a[52:55], a[252:255], v[136:139]
    v_mfma_f32_16x16x32_bf16 v[140:143], a[56:59], a[252:255], v[140:143]
    ds_read_b128 a[252:255], v224 offset:31040
    v_mfma_f32_16x16x32_bf16 v[220:223], a[48:51], a[220:223], v[220:223]
    buffer_load_dwordx4 v253, s[8:11], s57 offen lds
    v_mfma_f32_16x16x32_bf16 v[216:219], a[52:55], a[220:223], v[216:219]
    s_add_u32 s57, s49, 0x24300
    s_add_u32 m0, s50, 0xc000
    v_mfma_f32_16x16x32_bf16 v[212:215], a[56:59], a[220:223], v[212:215]
    ds_read_b128 a[220:223], v224 offset:31104
    v_mfma_f32_16x16x32_bf16 v[208:211], a[48:51], a[224:227], v[208:211]
    buffer_load_dwordx4 v251, s[8:11], s57 offen lds
    v_mfma_f32_16x16x32_bf16 v[204:207], a[52:55], a[224:227], v[204:207]
    s_add_u32 m0, s50, 0xc400
    v_mfma_f32_16x16x32_bf16 v[200:203], a[56:59], a[224:227], v[200:203]
    s_waitcnt lgkmcnt(2)
    ds_read_b128 a[224:227], v224 offset:31168
    v_mfma_f32_16x16x32_bf16 v[180:183], a[0:3], a[248:251], 0
    v_mfma_f32_16x16x32_bf16 v[176:179], a[4:7], a[248:251], 0
    s_waitcnt lgkmcnt(2)
    v_mfma_f32_16x16x32_bf16 v[176:179], a[16:19], a[252:255], v[176:179]
    s_waitcnt vmcnt(14)
    ds_read_b64_tr_b16 a[60:61], v254 offset:61440
    ds_read_b64_tr_b16 a[62:63], v255 offset:61440
    v_mfma_f32_16x16x32_bf16 v[180:183], a[12:15], a[252:255], v[180:183]
    ds_read_b64_tr_b16 a[64:65], v254 offset:61472
    ds_read_b64_tr_b16 a[66:67], v255 offset:61472
    v_mfma_f32_16x16x32_bf16 v[172:175], a[8:11], a[248:251], 0
    ds_read_b128 a[248:251], v224 offset:34240
    ds_read_b64_tr_b16 a[68:69], v254 offset:61504
    v_mfma_f32_16x16x32_bf16 v[172:175], a[20:23], a[252:255], v[172:175]
    s_waitcnt lgkmcnt(7)
    ds_read_b128 a[252:255], v224 offset:34304
    v_mfma_f32_16x16x32_bf16 v[180:183], a[24:27], a[220:223], v[180:183]
    ds_read_b64_tr_b16 a[70:71], v255 offset:61504
    v_mfma_f32_16x16x32_bf16 v[176:179], a[28:31], a[220:223], v[176:179]
    s_waitcnt lgkmcnt(8)
    buffer_load_dwordx4 v252, s[8:11], s57 offen lds
    v_mfma_f32_16x16x32_bf16 v[176:179], a[40:43], a[224:227], v[176:179]
    s_add_u32 m0, s50, 0xc800
    v_mfma_f32_16x16x32_bf16 v[180:183], a[36:39], a[224:227], v[180:183]
    buffer_load_dwordx4 v253, s[8:11], s57 offen lds
    v_mfma_f32_16x16x32_bf16 v[172:175], a[32:35], a[220:223], v[172:175]
    s_add_u32 s57, s49, 0x2d300
    ds_read_b128 a[220:223], v224 offset:34368
    s_add_u32 m0, s50, 0xf000
    v_mfma_f32_16x16x32_bf16 v[172:175], a[44:47], a[224:227], v[172:175]
    s_waitcnt lgkmcnt(7)
    ds_read_b128 a[224:227], v224 offset:46464
    v_mfma_f32_16x16x32_bf16 v[12:15], a[60:63], a[228:231], v[12:15]
    s_waitcnt lgkmcnt(6)
    v_mfma_f32_16x16x32_bf16 v[16:19], a[64:67], a[228:231], v[16:19]
    v_mfma_f32_16x16x32_bf16 v[36:39], a[60:63], a[232:235], v[36:39]
    s_waitcnt lgkmcnt(2)
    buffer_load_dwordx4 v251, s[8:11], s57 offen lds
    v_mfma_f32_16x16x32_bf16 v[20:23], a[68:71], a[228:231], v[20:23]
    s_add_u32 m0, s50, 0xf400
    ds_read_b128 a[228:231], v224 offset:31232
    v_mfma_f32_16x16x32_bf16 v[40:43], a[64:67], a[232:235], v[40:43]
    buffer_load_dwordx4 v252, s[8:11], s57 offen lds
    v_mfma_f32_16x16x32_bf16 v[44:47], a[68:71], a[232:235], v[44:47]
    s_add_u32 m0, s50, 0xf800
    ds_read_b128 a[232:235], v224 offset:31296
    v_cvt_pk_bf16_f32 v0, v12, v13
    v_mfma_f32_16x16x32_bf16 v[132:135], a[60:63], a[236:239], v[132:135]
    v_cvt_pk_bf16_f32 v1, v14, v15
    v_cvt_pk_bf16_f32 v2, v16, v17
    v_mfma_f32_16x16x32_bf16 v[136:139], a[64:67], a[236:239], v[136:139]
    v_cvt_pk_bf16_f32 v3, v18, v19
    v_cvt_pk_bf16_f32 v4, v20, v21
    v_mfma_f32_16x16x32_bf16 v[140:143], a[68:71], a[236:239], v[140:143]
    ds_read_b128 a[236:239], v224 offset:34048
    v_cvt_pk_bf16_f32 v5, v22, v23
    v_mfma_f32_16x16x32_bf16 v[220:223], a[60:63], a[240:243], v[220:223]
    buffer_load_dwordx4 v253, s[8:11], s57 offen lds
    v_mfma_f32_16x16x32_bf16 v[216:219], a[64:67], a[240:243], v[216:219]
    s_add_u32 s57, s49, 0
    v_cvt_pk_bf16_f32 v24, v36, v37
    v_cvt_pk_bf16_f32 v25, v38, v39
    v_mfma_f32_16x16x32_bf16 v[212:215], a[68:71], a[240:243], v[212:215]
    s_add_u32 m0, s50, 0
    ds_read_b128 a[240:243], v224 offset:34112
    v_cvt_pk_bf16_f32 v26, v40, v41
    v_mfma_f32_16x16x32_bf16 v[208:211], a[60:63], a[244:247], v[208:211]
    v_cvt_pk_bf16_f32 v27, v42, v43
    v_cvt_pk_bf16_f32 v28, v44, v45
    v_mfma_f32_16x16x32_bf16 v[204:207], a[64:67], a[244:247], v[204:207]
    v_cvt_pk_bf16_f32 v29, v46, v47
    v_cvt_pk_bf16_f32 v6, v132, v133
    v_mfma_f32_16x16x32_bf16 v[200:203], a[68:71], a[244:247], v[200:203]
    s_waitcnt lgkmcnt(3)
    ds_read_b128 a[244:247], v224 offset:34176
    v_cvt_pk_bf16_f32 v7, v134, v135
    v_mfma_f32_16x16x32_bf16 v[180:183], a[48:51], a[228:231], v[180:183]
    s_waitcnt lgkmcnt(3)
    v_cvt_pk_bf16_f32 v8, v136, v137
    v_cvt_pk_bf16_f32 v9, v138, v139
    v_mfma_f32_16x16x32_bf16 v[180:183], a[60:63], a[232:235], v[180:183]
    v_cvt_pk_bf16_f32 v10, v140, v141
    v_cvt_pk_bf16_f32 v11, v142, v143
    v_mfma_f32_16x16x32_bf16 v[176:179], a[52:55], a[228:231], v[176:179]
    v_cvt_pk_bf16_f32 v30, v220, v221
    v_cvt_pk_bf16_f32 v31, v222, v223
    v_mfma_f32_16x16x32_bf16 v[176:179], a[64:67], a[232:235], v[176:179]
    v_cvt_pk_bf16_f32 v32, v216, v217
    v_cvt_pk_bf16_f32 v33, v218, v219
    v_mfma_f32_16x16x32_bf16 v[172:175], a[56:59], a[228:231], v[172:175]
    v_cvt_pk_bf16_f32 v12, v180, v181
    v_cvt_pk_bf16_f32 v13, v182, v183
    v_mfma_f32_16x16x32_bf16 v[172:175], a[68:71], a[232:235], v[172:175]
    s_waitcnt lgkmcnt(2)
    ds_read_b128 a[228:231], v224 offset:46528
    ds_read_b128 a[232:235], v224 offset:46592
    v_mfma_f32_16x16x32_bf16 v[220:223], a[0:3], a[236:239], 0
    s_waitcnt lgkmcnt(3)
    v_cvt_pk_bf16_f32 v14, v176, v177
    v_cvt_pk_bf16_f32 v15, v178, v179
    v_mfma_f32_16x16x32_bf16 v[220:223], a[12:15], a[240:243], v[220:223]
    v_cvt_pk_bf16_f32 v34, v212, v213
    v_cvt_pk_bf16_f32 v35, v214, v215
    v_mfma_f32_16x16x32_bf16 v[216:219], a[4:7], a[236:239], 0
    v_cvt_pk_bf16_f32 v16, v172, v173
    v_cvt_pk_bf16_f32 v17, v174, v175
    v_mfma_f32_16x16x32_bf16 v[216:219], a[16:19], a[240:243], v[216:219]
    v_cvt_pk_bf16_f32 v48, v208, v209
    v_cvt_pk_bf16_f32 v49, v210, v211
    v_mfma_f32_16x16x32_bf16 v[212:215], a[8:11], a[236:239], 0
    ds_read_b128 a[236:239], v224 offset:46656
    v_cvt_pk_bf16_f32 v50, v204, v205
    v_mfma_f32_16x16x32_bf16 v[212:215], a[20:23], a[240:243], v[212:215]
    s_waitcnt lgkmcnt(3)
    ds_read_b128 a[240:243], v224 offset:46720
    v_cvt_pk_bf16_f32 v51, v206, v207
    v_mfma_f32_16x16x32_bf16 v[220:223], a[24:27], a[244:247], v[220:223]
L_pg1:
    s_cbranch_execz L_pg5
    v_cvt_pk_bf16_f32 v52, v200, v201
    v_cvt_pk_bf16_f32 v53, v202, v203
    v_mfma_f32_16x16x32_bf16 v[220:223], a[36:39], a[248:251], v[220:223]
    s_waitcnt vmcnt(15)
    ds_read_b64_tr_b16 a[72:73], v254
    ds_read_b64_tr_b16 a[74:75], v255
    v_mfma_f32_16x16x32_bf16 v[216:219], a[28:31], a[244:247], v[216:219]
    ds_read_b64_tr_b16 a[76:77], v254 offset:32
    ds_read_b64_tr_b16 a[78:79], v255 offset:32
    v_mfma_f32_16x16x32_bf16 v[216:219], a[40:43], a[248:251], v[216:219]
    ds_read_b64_tr_b16 a[80:81], v254 offset:64
    ds_read_b64_tr_b16 a[82:83], v255 offset:64
    v_mfma_f32_16x16x32_bf16 v[212:215], a[32:35], a[244:247], v[212:215]
    s_waitcnt vmcnt(12)
    ds_read_b128 a[244:247], v224 offset:46784
    ds_read_b64_tr_b16 a[84:85], v254 offset:12288
    v_mfma_f32_16x16x32_bf16 v[212:215], a[44:47], a[248:251], v[212:215]
    ds_read_b128 a[248:251], v224 offset:49536
    v_mfma_f32_16x16x32_bf16 v[220:223], a[48:51], a[252:255], v[220:223]
    ds_read_b64_tr_b16 a[86:87], v255 offset:12288
    ds_read_b64_tr_b16 a[88:89], v254 offset:12320
    v_mfma_f32_16x16x32_bf16 v[220:223], a[60:63], a[220:223], v[220:223]
    ds_read_b64_tr_b16 a[90:91], v255 offset:12320
    ds_read_b64_tr_b16 a[92:93], v254 offset:12352
    v_mfma_f32_16x16x32_bf16 v[216:219], a[52:55], a[252:255], v[216:219]
    s_waitcnt vmcnt(9)
    ds_read_b64_tr_b16 a[94:95], v255 offset:12352
    ds_read_b64_tr_b16 a[96:97], v254 offset:24576
    v_mfma_f32_16x16x32_bf16 v[216:219], a[64:67], a[220:223], v[216:219]
    ds_read_b64_tr_b16 a[98:99], v255 offset:24576
    ds_read_b64_tr_b16 a[100:101], v254 offset:24608
    v_mfma_f32_16x16x32_bf16 v[212:215], a[56:59], a[252:255], v[212:215]
    v_cvt_pk_bf16_f32 v36, v220, v221
    v_cvt_pk_bf16_f32 v37, v222, v223
    v_mfma_f32_16x16x32_bf16 v[212:215], a[68:71], a[220:223], v[212:215]
    ds_read_b128 a[252:255], v224 offset:49600
    ds_read_b128 a[220:223], v224 offset:49664
    v_mfma_f32_16x16x32_bf16 v[208:211], a[0:3], a[224:227], 0
    s_waitcnt lgkmcnt(14)
    v_cvt_pk_bf16_f32 v38, v216, v217
    v_cvt_pk_bf16_f32 v39, v218, v219
    v_mfma_f32_16x16x32_bf16 v[208:211], a[12:15], a[228:231], v[208:211]
    s_waitcnt lgkmcnt(13)
    buffer_load_dwordx4 v251, s[8:11], s57 offen lds
    v_mfma_f32_16x16x32_bf16 v[204:207], a[4:7], a[224:227], 0
    s_add_u32 m0, s50, 0x400
    v_cvt_pk_bf16_f32 v40, v212, v213
    v_cvt_pk_bf16_f32 v41, v214, v215
    v_mfma_f32_16x16x32_bf16 v[204:207], a[16:19], a[228:231], v[204:207]
    buffer_load_dwordx4 v252, s[8:11], s57 offen lds
    v_mfma_f32_16x16x32_bf16 v[200:203], a[8:11], a[224:227], 0
    s_add_u32 m0, s50, 0x800
    ds_read_b128 a[224:227], v224 offset:49728
    ds_read_b64_tr_b16 a[102:103], v255 offset:24608
    v_mfma_f32_16x16x32_bf16 v[200:203], a[20:23], a[228:231], v[200:203]
    ds_read_b128 a[228:231], v224 offset:49792
    v_mfma_f32_16x16x32_bf16 v[208:211], a[24:27], a[232:235], v[208:211]
    buffer_load_dwordx4 v253, s[8:11], s57 offen lds
    v_mfma_f32_16x16x32_bf16 v[208:211], a[36:39], a[236:239], v[208:211]
    s_add_u32 s57, s49, 0x9000
    ds_read_b64_tr_b16 a[104:105], v254 offset:24640
    ds_read_b64_tr_b16 a[106:107], v255 offset:24640
    v_mfma_f32_16x16x32_bf16 v[204:207], a[28:31], a[232:235], v[204:207]
    s_add_u32 m0, s50, 0x3000
    s_waitcnt vmcnt(9)
    ds_read_b64_tr_b16 a[108:109], v254 offset:36864
    ds_read_b64_tr_b16 a[110:111], v255 offset:36864
    v_mfma_f32_16x16x32_bf16 v[204:207], a[40:43], a[236:239], v[204:207]
    ds_read_b64_tr_b16 a[112:113], v254 offset:36896
    ds_read_b64_tr_b16 a[114:115], v255 offset:36896
    v_mfma_f32_16x16x32_bf16 v[200:203], a[32:35], a[232:235], v[200:203]
    ds_read_b128 a[232:235], v224 offset:49856
    ds_read_b64_tr_b16 a[116:117], v254 offset:36928
    v_mfma_f32_16x16x32_bf16 v[200:203], a[44:47], a[236:239], v[200:203]
    ds_read_b128 a[236:239], v227 offset:37120
    v_mfma_f32_16x16x32_bf16 v[208:211], a[48:51], a[240:243], v[208:211]
    s_waitcnt lgkmcnt(12)
    buffer_load_dwordx4 v251, s[8:11], s57 offen lds
    v_mfma_f32_16x16x32_bf16 v[208:211], a[60:63], a[244:247], v[208:211]
    s_add_u32 m0, s50, 0x3400
    ds_read_b64_tr_b16 a[118:119], v255 offset:36928
    v_mfma_f32_16x16x32_bf16 v[204:207], a[52:55], a[240:243], v[204:207]
    s_waitcnt vmcnt(7)
    buffer_load_dwordx4 v252, s[8:11], s57 offen lds
    v_mfma_f32_16x16x32_bf16 v[204:207], a[64:67], a[244:247], v[204:207]
    s_add_u32 m0, s50, 0x3800
    ds_read_b64_tr_b16 a[120:121], v254 offset:49152
    ds_read_b64_tr_b16 a[122:123], v255 offset:49152
    v_mfma_f32_16x16x32_bf16 v[200:203], a[56:59], a[240:243], v[200:203]
    v_cvt_pk_bf16_f32 v18, v208, v209
    v_cvt_pk_bf16_f32 v19, v210, v211
    v_mfma_f32_16x16x32_bf16 v[200:203], a[68:71], a[244:247], v[200:203]
    ds_read_b128 a[240:243], v227 offset:37184
    v_cvt_pk_bf16_f32 v20, v204, v205
    v_mfma_f32_16x16x32_bf16 v[180:183], a[0:3], a[248:251], 0
    ds_read_b128 a[244:247], v227 offset:37248
    v_cvt_pk_bf16_f32 v21, v206, v207
    v_mfma_f32_16x16x32_bf16 v[180:183], a[12:15], a[252:255], v[180:183]
    buffer_load_dwordx4 v253, s[8:11], s57 offen lds
    v_mfma_f32_16x16x32_bf16 v[176:179], a[4:7], a[248:251], 0
    s_add_u32 s57, s49, 0x12000
    v_cvt_pk_bf16_f32 v22, v200, v201
    v_cvt_pk_bf16_f32 v23, v202, v203
    v_mfma_f32_16x16x32_bf16 v[176:179], a[16:19], a[252:255], v[176:179]
    s_add_u32 m0, s50, 0x6000
    ds_read_b64_tr_b16 a[124:125], v254 offset:49184
    ds_read_b64_tr_b16 a[126:127], v255 offset:49184
    v_mfma_f32_16x16x32_bf16 v[172:175], a[8:11], a[248:251], 0
    ds_read_b128 a[248:251], v227 offset:37312
    ds_read_b64_tr_b16 a[128:129], v254 offset:49216
    v_mfma_f32_16x16x32_bf16 v[172:175], a[20:23], a[252:255], v[172:175]
    ds_read_b128 a[252:255], v227 offset:37376
    v_mfma_f32_16x16x32_bf16 v[180:183], a[24:27], a[220:223], v[180:183]
    s_waitcnt lgkmcnt(8)
    buffer_load_dwordx4 v251, s[8:11], s57 offen lds
    v_mfma_f32_16x16x32_bf16 v[180:183], a[36:39], a[224:227], v[180:183]
    s_add_u32 m0, s50, 0x6400
    ds_read_b64_tr_b16 a[130:131], v255 offset:49216
    v_mfma_f32_16x16x32_bf16 v[176:179], a[28:31], a[220:223], v[176:179]
    v_mfma_f32_16x16x32_bf16 v[176:179], a[40:43], a[224:227], v[176:179]
    s_waitcnt vmcnt(7)
    buffer_load_dwordx4 v252, s[8:11], s57 offen lds
    v_mfma_f32_16x16x32_bf16 v[172:175], a[32:35], a[220:223], v[172:175]
    s_add_u32 m0, s50, 0x6800
    ds_read_b128 a[220:223], v227 offset:37440
    ds_read_b64_tr_b16 a[132:133], v254 offset:61440
    v_mfma_f32_16x16x32_bf16 v[172:175], a[44:47], a[224:227], v[172:175]
    ds_read_b128 a[224:227], v224
    v_mfma_f32_16x16x32_bf16 v[180:183], a[48:51], a[228:231], v[180:183]
    ds_read_b64_tr_b16 a[134:135], v255 offset:61440
    ds_read_b64_tr_b16 a[136:137], v254 offset:61472
    v_mfma_f32_16x16x32_bf16 v[180:183], a[60:63], a[232:235], v[180:183]
    buffer_load_dwordx4 v253, s[8:11], s57 offen lds
    v_mfma_f32_16x16x32_bf16 v[176:179], a[52:55], a[228:231], v[176:179]
    s_add_u32 s57, s49, 0x1b000
    ds_read_b64_tr_b16 a[138:139], v255 offset:61472
    ds_read_b64_tr_b16 a[140:141], v254 offset:61504
    v_mfma_f32_16x16x32_bf16 v[176:179], a[64:67], a[232:235], v[176:179]
    s_add_u32 m0, s50, 0x9000
    ds_read_b64_tr_b16 a[142:143], v255 offset:61504
    v_cvt_pk_bf16_f32 v42, v180, v181
    v_mfma_f32_16x16x32_bf16 v[172:175], a[56:59], a[228:231], v[172:175]
    ds_read_b128 a[228:231], v224 offset:64
    v_cvt_pk_bf16_f32 v43, v182, v183
    v_mfma_f32_16x16x32_bf16 v[172:175], a[68:71], a[232:235], v[172:175]
    ds_read_b128 a[232:235], v224 offset:128
    v_cvt_pk_bf16_f32 v44, v176, v177
    v_mfma_f32_16x16x32_bf16 v[220:223], a[0:3], a[236:239], 0
    s_waitcnt lgkmcnt(10)
    v_cvt_pk_bf16_f32 v45, v178, v179
    v_mfma_f32_16x16x32_bf16 v[220:223], a[12:15], a[240:243], v[220:223]
    buffer_load_dwordx4 v251, s[8:11], s57 offen lds
    v_mfma_f32_16x16x32_bf16 v[216:219], a[4:7], a[236:239], 0
    s_add_u32 m0, s50, 0x9400
    v_cvt_pk_bf16_f32 v46, v172, v173
    v_cvt_pk_bf16_f32 v47, v174, v175
    v_mfma_f32_16x16x32_bf16 v[216:219], a[16:19], a[240:243], v[216:219]
    v_mfma_f32_16x16x32_bf16 v[212:215], a[8:11], a[236:239], 0
    ds_read_b128 a[236:239], v224 offset:192
    v_mfma_f32_16x16x32_bf16 v[212:215], a[20:23], a[240:243], v[212:215]
    s_waitcnt vmcnt(7)
    ds_read_b128 a[240:243], v224 offset:256
    ds_read_b64_tr_b16 a[144:145], v254
    v_mfma_f32_16x16x32_bf16 v[220:223], a[24:27], a[244:247], v[220:223]
    buffer_load_dwordx4 v252, s[8:11], s57 offen lds
    v_mfma_f32_16x16x32_bf16 v[220:223], a[36:39], a[248:251], v[220:223]
    s_add_u32 m0, s50, 0x9800
    ds_read_b64_tr_b16 a[146:147], v255
    ds_read_b64_tr_b16 a[148:149], v254 offset:32
    v_mfma_f32_16x16x32_bf16 v[216:219], a[28:31], a[244:247], v[216:219]
    buffer_load_dwordx4 v253, s[8:11], s57 offen lds
    v_mfma_f32_16x16x32_bf16 v[216:219], a[40:43], a[248:251], v[216:219]
    s_add_u32 s57, s49, 0x24000
    ds_read_b64_tr_b16 a[150:151], v255 offset:32
    ds_read_b64_tr_b16 a[152:153], v254 offset:64
    v_mfma_f32_16x16x32_bf16 v[212:215], a[32:35], a[244:247], v[212:215]
    s_add_u32 m0, s50, 0xc000
    ds_read_b128 a[244:247], v224 offset:320
    ds_read_b64_tr_b16 a[154:155], v255 offset:64
    v_mfma_f32_16x16x32_bf16 v[212:215], a[44:47], a[248:251], v[212:215]
    ds_read_b128 a[248:251], v224 offset:3072
    v_mfma_f32_16x16x32_bf16 v[220:223], a[48:51], a[252:255], v[220:223]
    s_waitcnt lgkmcnt(10)
    buffer_load_dwordx4 v251, s[8:11], s57 offen lds
    v_mfma_f32_16x16x32_bf16 v[220:223], a[60:63], a[220:223], v[220:223]
    s_add_u32 m0, s50, 0xc400
    v_mfma_f32_16x16x32_bf16 v[216:219], a[52:55], a[252:255], v[216:219]
    v_mfma_f32_16x16x32_bf16 v[216:219], a[64:67], a[220:223], v[216:219]
    v_mfma_f32_16x16x32_bf16 v[212:215], a[56:59], a[252:255], v[212:215]
    ds_read_b128 a[252:255], v224 offset:3136
    v_mfma_f32_16x16x32_bf16 v[212:215], a[68:71], a[220:223], v[212:215]
    s_waitcnt vmcnt(7)
    ds_read_b128 a[220:223], v224 offset:3200
    ds_read_b64_tr_b16 a[156:157], v254 offset:12288
    v_mfma_f32_16x16x32_bf16 v[208:211], a[224:227], a[72:75], 0
    v_cvt_pk_bf16_f32 v54, v220, v221
    v_cvt_pk_bf16_f32 v55, v222, v223
    v_mfma_f32_16x16x32_bf16 v[208:211], a[228:231], a[84:87], v[208:211]
    v_cvt_pk_bf16_f32 v56, v216, v217
    v_cvt_pk_bf16_f32 v57, v218, v219
    v_mfma_f32_16x16x32_bf16 v[204:207], a[224:227], a[76:79], 0
    v_cvt_pk_bf16_f32 v58, v212, v213
    v_cvt_pk_bf16_f32 v59, v214, v215
    v_mfma_f32_16x16x32_bf16 v[204:207], a[228:231], a[88:91], v[204:207]
    buffer_load_dwordx4 v252, s[8:11], s57 offen lds
    v_mfma_f32_16x16x32_bf16 v[200:203], a[224:227], a[80:83], 0
    s_add_u32 m0, s50, 0xc800
    ds_read_b128 a[224:227], v224 offset:3264
    ds_read_b64_tr_b16 a[158:159], v255 offset:12288
    v_mfma_f32_16x16x32_bf16 v[200:203], a[228:231], a[92:95], v[200:203]
    ds_read_b128 a[228:231], v224 offset:3328
    v_mfma_f32_16x16x32_bf16 v[208:211], a[232:235], a[96:99], v[208:211]
    s_waitcnt lgkmcnt(6)
    buffer_load_dwordx4 v253, s[8:11], s57 offen lds
    v_mfma_f32_16x16x32_bf16 v[208:211], a[236:239], a[108:111], v[208:211]
    s_add_u32 s57, s49, 0x2d000
    ds_read_b64_tr_b16 a[160:161], v254 offset:12320
    ds_read_b64_tr_b16 a[162:163], v255 offset:12320
    v_mfma_f32_16x16x32_bf16 v[204:207], a[232:235], a[100:103], v[204:207]
    s_add_u32 m0, s50, 0xf000
    ds_read_b64_tr_b16 a[164:165], v254 offset:12352
    ds_read_b64_tr_b16 a[166:167], v255 offset:12352
    v_mfma_f32_16x16x32_bf16 v[204:207], a[236:239], a[112:115], v[204:207]
    buffer_load_dwordx4 v251, s[8:11], s57 offen lds
    v_mfma_f32_16x16x32_bf16 v[200:203], a[232:235], a[104:107], v[200:203]
    s_add_u32 m0, s50, 0xf400
    ds_read_b128 a[232:235], v224 offset:3392
    v_mfma_f32_16x16x32_bf16 v[200:203], a[236:239], a[116:119], v[200:203]
    s_waitcnt vmcnt(7)
    ds_read_b128 a[236:239], v224 offset:15488
    ds_read_b64_tr_b16 a[168:169], v254 offset:24576
    v_mfma_f32_16x16x32_bf16 v[208:211], a[240:243], a[120:123], v[208:211]
    buffer_load_dwordx4 v252, s[8:11], s57 offen lds
    v_mfma_f32_16x16x32_bf16 v[208:211], a[244:247], a[132:135], v[208:211]
    s_add_u32 m0, s50, 0xf800
    ds_read_b64_tr_b16 a[170:171], v255 offset:24576
    ds_read_b64_tr_b16 a[172:173], v254 offset:24608
    v_mfma_f32_16x16x32_bf16 v[204:207], a[240:243], a[124:127], v[204:207]
    ds_read_b64_tr_b16 a[174:175], v255 offset:24608
    ds_read_b64_tr_b16 a[176:177], v254 offset:24640
    v_mfma_f32_16x16x32_bf16 v[204:207], a[244:247], a[136:139], v[204:207]
    ds_read_b64_tr_b16 a[178:179], v255 offset:24640
    v_cvt_pk_bf16_f32 v66, v208, v209
    v_mfma_f32_16x16x32_bf16 v[200:203], a[240:243], a[128:131], v[200:203]
    ds_read_b128 a[240:243], v224 offset:15552
    v_cvt_pk_bf16_f32 v67, v210, v211
    v_mfma_f32_16x16x32_bf16 v[200:203], a[244:247], a[140:143], v[200:203]
    ds_read_b128 a[244:247], v224 offset:15616
    v_mfma_f32_16x16x32_bf16 v[180:183], a[248:251], a[72:75], 0
    s_waitcnt lgkmcnt(10)
    v_cvt_pk_bf16_f32 v88, v204, v205
    v_cvt_pk_bf16_f32 v89, v206, v207
    v_mfma_f32_16x16x32_bf16 v[180:183], a[252:255], a[84:87], v[180:183]
    buffer_load_dwordx4 v253, s[8:11], s57 offen lds
    v_mfma_f32_16x16x32_bf16 v[176:179], a[248:251], a[76:79], 0
    s_add_u32 s57, s49, 0
    v_cvt_pk_bf16_f32 v110, v200, v201
    v_cvt_pk_bf16_f32 v111, v202, v203
    v_mfma_f32_16x16x32_bf16 v[176:179], a[252:255], a[88:91], v[176:179]
    s_add_u32 m0, s50, 0
    v_mfma_f32_16x16x32_bf16 v[172:175], a[248:251], a[80:83], 0
    ds_read_b128 a[248:251], v224 offset:15680
    v_mfma_f32_16x16x32_bf16 v[172:175], a[252:255], a[92:95], v[172:175]
    ds_read_b128 a[252:255], v224 offset:15744
    v_mfma_f32_16x16x32_bf16 v[180:183], a[220:223], a[96:99], v[180:183]
    s_waitcnt vmcnt(6)
    buffer_load_dwordx4 v192, s[12:15], s57 offen lds
    v_mfma_f32_16x16x32_bf16 v[180:183], a[224:227], a[108:111], v[180:183]
    s_add_u32 m0, s50, 0x400
    ds_read_b64_tr_b16 a[180:181], v254 offset:36864
    ds_read_b64_tr_b16 a[182:183], v255 offset:36864
    v_mfma_f32_16x16x32_bf16 v[176:179], a[220:223], a[100:103], v[176:179]
    buffer_load_dwordx4 v193, s[12:15], s57 offen lds
    v_mfma_f32_16x16x32_bf16 v[176:179], a[224:227], a[112:115], v[176:179]
    s_add_u32 m0, s50, 0x800
    ds_read_b64_tr_b16 a[184:185], v254 offset:36896
    ds_read_b64_tr_b16 a[186:187], v255 offset:36896
    v_mfma_f32_16x16x32_bf16 v[172:175], a[220:223], a[104:107], v[172:175]
    ds_read_b128 a[220:223], v224 offset:15808
    ds_read_b64_tr_b16 a[188:189], v254 offset:36928
    v_mfma_f32_16x16x32_bf16 v[172:175], a[224:227], a[116:119], v[172:175]
    ds_read_b128 a[224:227], v224 offset:18560
    v_mfma_f32_16x16x32_bf16 v[180:183], a[228:231], a[120:123], v[180:183]
    s_waitcnt lgkmcnt(9)
    buffer_load_dwordx4 v194, s[12:15], s57 offen lds
    v_mfma_f32_16x16x32_bf16 v[180:183], a[232:235], a[132:135], v[180:183]
    s_add_u32 s57, s49, 0x3000
    ds_read_b64_tr_b16 a[190:191], v255 offset:36928
    s_add_u32 m0, s50, 0x3000
    v_mfma_f32_16x16x32_bf16 v[176:179], a[228:231], a[124:127], v[176:179]
    v_mfma_f32_16x16x32_bf16 v[176:179], a[232:235], a[136:139], v[176:179]
    buffer_load_dwordx4 v86, s[12:15], s57 offen lds
    v_mfma_f32_16x16x32_bf16 v[172:175], a[228:231], a[128:131], v[172:175]
    s_add_u32 m0, s50, 0x3400
    v_cvt_pk_bf16_f32 v68, v180, v181
    v_cvt_pk_bf16_f32 v69, v182, v183
    v_mfma_f32_16x16x32_bf16 v[172:175], a[232:235], a[140:143], v[172:175]
    ds_read_b128 a[228:231], v224 offset:18624
    ds_read_b128 a[232:235], v224 offset:18688
    v_mfma_f32_16x16x32_bf16 v[220:223], a[236:239], a[72:75], 0
    v_cvt_pk_bf16_f32 v90, v176, v177
    v_cvt_pk_bf16_f32 v91, v178, v179
    v_mfma_f32_16x16x32_bf16 v[220:223], a[240:243], a[84:87], v[220:223]
    v_mfma_f32_16x16x32_bf16 v[216:219], a[236:239], a[76:79], 0
    buffer_load_dwordx4 v87, s[12:15], s57 offen lds
    v_mfma_f32_16x16x32_bf16 v[216:219], a[240:243], a[88:91], v[216:219]
    s_add_u32 m0, s50, 0x3800
    v_cvt_pk_bf16_f32 v112, v172, v173
    v_cvt_pk_bf16_f32 v113, v174, v175
    v_mfma_f32_16x16x32_bf16 v[212:215], a[236:239], a[80:83], 0
    s_waitcnt vmcnt(8)
    ds_read_b128 a[236:239], v224 offset:18752
    ds_read_b64_tr_b16 a[192:193], v254 offset:49152
    v_mfma_f32_16x16x32_bf16 v[212:215], a[240:243], a[92:95], v[212:215]
    ds_read_b128 a[240:243], v224 offset:18816
    v_mfma_f32_16x16x32_bf16 v[220:223], a[244:247], a[96:99], v[220:223]
    s_waitcnt lgkmcnt(5)
    buffer_load_dwordx4 v108, s[12:15], s57 offen lds
    v_mfma_f32_16x16x32_bf16 v[220:223], a[248:251], a[108:111], v[220:223]
    s_add_u32 s57, s49, 0x4800
    ds_read_b64_tr_b16 a[194:195], v255 offset:49152
    ds_read_b64_tr_b16 a[196:197], v254 offset:49184
    v_mfma_f32_16x16x32_bf16 v[216:219], a[244:247], a[100:103], v[216:219]
    s_add_u32 m0, s50, 0x6000
    ds_read_b64_tr_b16 a[198:199], v255 offset:49184
    ds_read_b64_tr_b16 a[200:201], v254 offset:49216
    v_mfma_f32_16x16x32_bf16 v[216:219], a[248:251], a[112:115], v[216:219]
    ds_read_b64_tr_b16 a[202:203], v255 offset:49216
    v_mfma_f32_16x16x32_bf16 v[212:215], a[244:247], a[104:107], v[212:215]
    ds_read_b128 a[244:247], v224 offset:18880
    v_mfma_f32_16x16x32_bf16 v[212:215], a[248:251], a[116:119], v[212:215]
    ds_read_b128 a[248:251], v227 offset:6144
    v_mfma_f32_16x16x32_bf16 v[220:223], a[252:255], a[120:123], v[220:223]
    buffer_load_dwordx4 v192, s[12:15], s57 offen lds
    v_mfma_f32_16x16x32_bf16 v[220:223], a[220:223], a[132:135], v[220:223]
    s_add_u32 m0, s50, 0x6400
    v_mfma_f32_16x16x32_bf16 v[216:219], a[252:255], a[124:127], v[216:219]
    buffer_load_dwordx4 v193, s[12:15], s57 offen lds
    v_mfma_f32_16x16x32_bf16 v[216:219], a[220:223], a[136:139], v[216:219]
    s_add_u32 m0, s50, 0x6800
    v_mfma_f32_16x16x32_bf16 v[212:215], a[252:255], a[128:131], v[212:215]
    s_waitcnt vmcnt(8)
    ds_read_b128 a[252:255], v227 offset:6208
    ds_read_b64_tr_b16 a[204:205], v254 offset:61440
    v_mfma_f32_16x16x32_bf16 v[212:215], a[220:223], a[140:143], v[212:215]
    v_cvt_pk_bf16_f32 v72, v220, v221
    v_cvt_pk_bf16_f32 v73, v222, v223
    v_mfma_f32_16x16x32_bf16 v[208:211], a[224:227], a[72:75], 0
    s_waitcnt lgkmcnt(4)
    v_cvt_pk_bf16_f32 v94, v216, v217
    v_cvt_pk_bf16_f32 v95, v218, v219
    v_mfma_f32_16x16x32_bf16 v[208:211], a[228:231], a[84:87], v[208:211]
    ds_read_b128 a[220:223], v227 offset:6272
    ds_read_b64_tr_b16 a[206:207], v255 offset:61440
    v_mfma_f32_16x16x32_bf16 v[204:207], a[224:227], a[76:79], 0
    v_cvt_pk_bf16_f32 v116, v212, v213
    v_cvt_pk_bf16_f32 v117, v214, v215
    v_mfma_f32_16x16x32_bf16 v[204:207], a[228:231], a[88:91], v[204:207]
    buffer_load_dwordx4 v194, s[12:15], s57 offen lds
    v_mfma_f32_16x16x32_bf16 v[200:203], a[224:227], a[80:83], 0
    s_add_u32 s57, s49, 0x9000
    ds_read_b128 a[224:227], v227 offset:6336
    ds_read_b64_tr_b16 a[208:209], v254 offset:61472
    v_mfma_f32_16x16x32_bf16 v[200:203], a[228:231], a[92:95], v[200:203]
    s_add_u32 m0, s50, 0x9000
    ds_read_b128 a[228:231], v227 offset:6400
    v_mfma_f32_16x16x32_bf16 v[208:211], a[232:235], a[96:99], v[208:211]
    buffer_load_dwordx4 v192, s[12:15], s57 offen lds
    v_mfma_f32_16x16x32_bf16 v[208:211], a[236:239], a[108:111], v[208:211]
    s_add_u32 m0, s50, 0x9400
    ds_read_b64_tr_b16 a[210:211], v255 offset:61472
    ds_read_b64_tr_b16 a[212:213], v254 offset:61504
    v_mfma_f32_16x16x32_bf16 v[204:207], a[232:235], a[100:103], v[204:207]
    ds_read_b64_tr_b16 a[214:215], v255 offset:61504
    v_mfma_f32_16x16x32_bf16 v[204:207], a[236:239], a[112:115], v[204:207]
    buffer_load_dwordx4 v193, s[12:15], s57 offen lds
    v_mfma_f32_16x16x32_bf16 v[200:203], a[232:235], a[104:107], v[200:203]
    s_add_u32 m0, s50, 0x9800
    ds_read_b128 a[232:235], v227 offset:6464
    v_mfma_f32_16x16x32_bf16 v[200:203], a[236:239], a[116:119], v[200:203]
    ds_read_b128 a[236:239], v225 offset:24384
    v_mfma_f32_16x16x32_bf16 v[208:211], a[240:243], a[120:123], v[208:211]
    s_waitcnt lgkmcnt(8)
    v_mfma_f32_16x16x32_bf16 v[208:211], a[244:247], a[132:135], v[208:211]
    buffer_load_dwordx4 v194, s[12:15], s57 offen lds
    v_mfma_f32_16x16x32_bf16 v[204:207], a[240:243], a[124:127], v[204:207]
    s_add_u32 s57, s49, 0xc000
    s_add_u32 m0, s50, 0xc000
    v_mfma_f32_16x16x32_bf16 v[204:207], a[244:247], a[136:139], v[204:207]
    v_mfma_f32_16x16x32_bf16 v[200:203], a[240:243], a[128:131], v[200:203]
    ds_read_b128 a[240:243], v225 offset:24448
    v_mfma_f32_16x16x32_bf16 v[200:203], a[244:247], a[140:143], v[200:203]
    v_cvt_pk_bf16_f32 v70, v208, v209
    v_cvt_pk_bf16_f32 v71, v210, v211
    v_mfma_f32_16x16x32_bf16 v[180:183], a[248:251], a[72:75], 0
    ds_read_b128 a[244:247], v225 offset:24512
    v_mfma_f32_16x16x32_bf16 v[180:183], a[252:255], a[84:87], v[180:183]
    v_cvt_pk_bf16_f32 v92, v204, v205
    v_cvt_pk_bf16_f32 v93, v206, v207
    v_mfma_f32_16x16x32_bf16 v[176:179], a[248:251], a[76:79], 0
    v_cvt_pk_bf16_f32 v114, v200, v201
    v_cvt_pk_bf16_f32 v115, v202, v203
    v_mfma_f32_16x16x32_bf16 v[176:179], a[252:255], a[88:91], v[176:179]
    buffer_load_dwordx4 v86, s[12:15], s57 offen lds
    v_mfma_f32_16x16x32_bf16 v[172:175], a[248:251], a[80:83], 0
    s_add_u32 m0, s50, 0xc400
    ds_read_b128 a[248:251], v225 offset:24576
    v_mfma_f32_16x16x32_bf16 v[172:175], a[252:255], a[92:95], v[172:175]
    ds_read_b128 a[252:255], v225 offset:24640
    v_mfma_f32_16x16x32_bf16 v[180:183], a[220:223], a[96:99], v[180:183]
    s_waitcnt lgkmcnt(4)
    buffer_load_dwordx4 v87, s[12:15], s57 offen lds
    v_mfma_f32_16x16x32_bf16 v[180:183], a[224:227], a[108:111], v[180:183]
    s_add_u32 m0, s50, 0xc800
    v_mfma_f32_16x16x32_bf16 v[176:179], a[220:223], a[100:103], v[176:179]
    buffer_load_dwordx4 v108, s[12:15], s57 offen lds
    v_mfma_f32_16x16x32_bf16 v[176:179], a[224:227], a[112:115], v[176:179]
    s_add_u32 s57, s49, 0xd800
    s_add_u32 m0, s50, 0xf000
    v_mfma_f32_16x16x32_bf16 v[172:175], a[220:223], a[104:107], v[172:175]
    ds_read_b128 a[220:223], v225 offset:24704
    v_mfma_f32_16x16x32_bf16 v[172:175], a[224:227], a[116:119], v[172:175]
    ds_read_b128 a[224:227], v225 offset:27456
    v_mfma_f32_16x16x32_bf16 v[180:183], a[228:231], a[120:123], v[180:183]
    buffer_load_dwordx4 v192, s[12:15], s57 offen lds
    v_mfma_f32_16x16x32_bf16 v[180:183], a[232:235], a[132:135], v[180:183]
    s_add_u32 m0, s50, 0xf400
    v_mfma_f32_16x16x32_bf16 v[176:179], a[228:231], a[124:127], v[176:179]
    v_mfma_f32_16x16x32_bf16 v[176:179], a[232:235], a[136:139], v[176:179]
    v_mfma_f32_16x16x32_bf16 v[172:175], a[228:231], a[128:131], v[172:175]
    ds_read_b128 a[228:231], v225 offset:27520
    v_mfma_f32_16x16x32_bf16 v[172:175], a[232:235], a[140:143], v[172:175]
    ds_read_b128 a[232:235], v225 offset:27584
    v_mfma_f32_16x16x32_bf16 v[220:223], a[144:147], a[236:239], 0
    s_waitcnt lgkmcnt(4)
    v_cvt_pk_bf16_f32 v82, v180, v181
    v_cvt_pk_bf16_f32 v83, v182, v183
    v_mfma_f32_16x16x32_bf16 v[220:223], a[156:159], a[240:243], v[220:223]
    v_cvt_pk_bf16_f32 v104, v176, v177
    v_cvt_pk_bf16_f32 v105, v178, v179
    v_mfma_f32_16x16x32_bf16 v[216:219], a[148:151], a[236:239], 0
    v_cvt_pk_bf16_f32 v126, v172, v173
    v_cvt_pk_bf16_f32 v127, v174, v175
    v_mfma_f32_16x16x32_bf16 v[216:219], a[160:163], a[240:243], v[216:219]
    buffer_load_dwordx4 v193, s[12:15], s57 offen lds
    v_mfma_f32_16x16x32_bf16 v[212:215], a[152:155], a[236:239], 0
    s_add_u32 m0, s50, 0xf800
    ds_read_b128 a[236:239], v225 offset:27648
    v_mfma_f32_16x16x32_bf16 v[212:215], a[164:167], a[240:243], v[212:215]
    ds_read_b128 a[240:243], v225 offset:27712
    v_mfma_f32_16x16x32_bf16 v[220:223], a[168:171], a[244:247], v[220:223]
    buffer_load_dwordx4 v194, s[12:15], s57 offen lds
    v_mfma_f32_16x16x32_bf16 v[220:223], a[180:183], a[248:251], v[220:223]
    s_add_u32 m0, s41, 0
    v_mfma_f32_16x16x32_bf16 v[216:219], a[172:175], a[244:247], v[216:219]
    v_mfma_f32_16x16x32_bf16 v[216:219], a[184:187], a[248:251], v[216:219]
    v_mfma_f32_16x16x32_bf16 v[212:215], a[176:179], a[244:247], v[212:215]
    ds_read_b128 a[244:247], v225 offset:27776
    v_mfma_f32_16x16x32_bf16 v[212:215], a[188:191], a[248:251], v[212:215]
    s_waitcnt vmcnt(6)
    ds_read_b128 a[248:251], v224 offset:30976
    ds_read_b64_tr_b16 v[164:165], v109 offset:36864
    v_mfma_f32_16x16x32_bf16 v[220:223], a[192:195], a[252:255], v[220:223]
    s_waitcnt lgkmcnt(5)
    ds_read_b64_tr_b16 v[166:167], v109 offset:38400
    ds_read_b64_tr_b16 v[168:169], v109 offset:36896
    v_mfma_f32_16x16x32_bf16 v[220:223], a[204:207], a[220:223], v[220:223]
    ds_read_b64_tr_b16 v[170:171], v109 offset:38432
    ds_read_b64_tr_b16 v[248:249], v109 offset:36928
    v_mfma_f32_16x16x32_bf16 v[216:219], a[196:199], a[252:255], v[216:219]
    ds_read_b64_tr_b16 v[250:251], v109 offset:38464
    v_mfma_f32_16x16x32_bf16 v[216:219], a[208:211], a[220:223], v[216:219]
    v_mfma_f32_16x16x32_bf16 v[212:215], a[200:203], a[252:255], v[212:215]
    ds_read_b128 a[252:255], v224 offset:31040
    v_mfma_f32_16x16x32_bf16 v[212:215], a[212:215], a[220:223], v[212:215]
    v_mul_f32 v220, s37, v220
    v_mul_f32 v221, s37, v221
    v_mfma_f32_16x16x32_bf16 v[208:211], a[144:147], a[224:227], 0
    s_waitcnt lgkmcnt(8)
    v_mul_f32 v222, s37, v222
    v_mul_f32 v223, s37, v223
    v_mfma_f32_16x16x32_bf16 v[208:211], a[156:159], a[228:231], v[208:211]
    s_barrier
    v_cvt_pk_bf16_f32 v132, v220, v221
    v_cvt_pk_bf16_f32 v133, v222, v223
    v_mfma_f32_16x16x32_bf16 v[204:207], a[148:151], a[224:227], 0
    v_mul_f32 v216, s37, v216
    v_mul_f32 v217, s37, v217
    v_mfma_f32_16x16x32_bf16 v[204:207], a[160:163], a[228:231], v[204:207]
    v_mul_f32 v218, s37, v218
    v_mul_f32 v219, s37, v219
    v_mfma_f32_16x16x32_bf16 v[200:203], a[152:155], a[224:227], 0
    v_cvt_pk_bf16_f32 v134, v216, v217
    v_cvt_pk_bf16_f32 v135, v218, v219
    v_mfma_f32_16x16x32_bf16 v[200:203], a[164:167], a[228:231], v[200:203]
    v_mul_f32 v212, s37, v212
    v_mul_f32 v213, s37, v213
    v_mfma_f32_16x16x32_bf16 v[144:147], v[0:3], v[132:135], v[144:147]
    v_mul_f32 v214, s37, v214
    v_mul_f32 v215, s37, v215
    v_mfma_f32_16x16x32_bf16 v[148:151], v[24:27], v[132:135], v[148:151]
    v_cvt_pk_bf16_f32 v136, v212, v213
    v_cvt_pk_bf16_f32 v137, v214, v215
    v_mfma_f32_16x16x32_bf16 v[152:155], v[30:33], v[132:135], v[152:155]
    ds_read_b128 a[220:223], v224 offset:31104
    ds_read_b128 a[224:227], v224 offset:31168
    v_mfma_f32_16x16x16_bf16 v[144:147], v[4:5], v[136:137], v[144:147]
    ds_read_b128 a[228:231], v224 offset:31232
    v_mfma_f32_16x16x16_bf16 v[148:151], v[28:29], v[136:137], v[148:151]
    buffer_load_dwordx4 v246, s[4:7], s56 offen lds
    v_mfma_f32_16x16x16_bf16 v[152:155], v[34:35], v[136:137], v[152:155]
    s_add_u32 m0, s42, 0
    v_mfma_f32_16x16x32_bf16 v[156:159], v[6:9], v[132:135], v[156:159]
    buffer_load_dwordx4 v247, s[4:7], s56 offen lds
    v_mfma_f32_16x16x32_bf16 v[208:211], a[168:171], a[232:235], v[208:211]
    s_add_u32 s56, s39, 0x17a000
    v_exp_f32 v144, v144
    v_mfma_f32_16x16x32_bf16 v[208:211], a[180:183], a[236:239], v[208:211]
    s_add_u32 m0, s41, 0x1e40
    v_exp_f32 v145, v145
    v_mfma_f32_16x16x16_bf16 v[156:159], v[10:11], v[136:137], v[156:159]
    buffer_load_dwordx4 v246, s[4:7], s56 offen lds
    v_mfma_f32_16x16x32_bf16 v[204:207], a[172:175], a[232:235], v[204:207]
    s_add_u32 m0, s42, 0x1e40
    v_exp_f32 v146, v146
    v_mfma_f32_16x16x32_bf16 v[204:207], a[184:187], a[236:239], v[204:207]
    v_exp_f32 v147, v147
    v_mfma_f32_16x16x32_bf16 v[200:203], a[176:179], a[232:235], v[200:203]
    ds_read_b128 a[232:235], v224 offset:31296
    v_cvt_pk_bf16_f32 v160, v144, v145
    v_mfma_f32_16x16x32_bf16 v[200:203], a[188:191], a[236:239], v[200:203]
    ds_read_b128 a[236:239], v224 offset:34048
    v_cvt_pk_bf16_f32 v161, v146, v147
    v_mfma_f32_16x16x32_bf16 v[208:211], a[192:195], a[240:243], v[208:211]
    buffer_load_dwordx4 v247, s[4:7], s56 offen lds
    v_mfma_f32_16x16x32_bf16 v[208:211], a[204:207], a[244:247], v[208:211]
    s_add_u32 s56, s39, 0x1a4000
    ds_read_b128 v[144:147], v228 offset:1920
    s_add_u32 m0, s41, 0x3c80
    v_mfma_f32_16x16x32_bf16 v[204:207], a[196:199], a[240:243], v[204:207]
L_pg2:
    s_cbranch_execz L_pg6
    v_exp_f32 v148, v148
    v_mfma_f32_16x16x32_bf16 v[204:207], a[208:211], a[244:247], v[204:207]
    buffer_load_dwordx4 v246, s[4:7], s56 offen lds
    v_mfma_f32_16x16x32_bf16 v[200:203], a[200:203], a[240:243], v[200:203]
    s_add_u32 m0, s42, 0x3c80
    v_mul_f32 v208, s37, v208
    v_mul_f32 v209, s37, v209
    v_mfma_f32_16x16x32_bf16 v[200:203], a[212:215], a[244:247], v[200:203]
    s_waitcnt lgkmcnt(3)
    v_mul_f32 v210, s37, v210
    v_mul_f32 v211, s37, v211
    v_mfma_f32_16x16x32_bf16 v[180:183], a[248:251], a[72:75], 0
    v_cvt_pk_bf16_f32 v138, v208, v209
    v_cvt_pk_bf16_f32 v139, v210, v211
    v_mfma_f32_16x16x32_bf16 v[180:183], a[252:255], a[84:87], v[180:183]
    v_mul_f32 v204, s37, v204
    v_mul_f32 v205, s37, v205
    v_mfma_f32_16x16x32_bf16 v[176:179], a[248:251], a[76:79], 0
    v_mul_f32 v206, s37, v206
    v_mul_f32 v207, s37, v207
    v_mfma_f32_16x16x32_bf16 v[176:179], a[252:255], a[88:91], v[176:179]
    s_waitcnt lgkmcnt(0)
    v_cvt_pk_bf16_f32 v140, v204, v205
    v_cvt_pk_bf16_f32 v141, v206, v207
    v_mfma_f32_16x16x32_bf16 v[144:147], v[12:15], v[132:135], v[144:147]
    v_mul_f32 v200, s37, v200
    v_mul_f32 v201, s37, v201
    v_mfma_f32_16x16x32_bf16 v[172:175], a[248:251], a[80:83], 0
    v_mul_f32 v202, s37, v202
    v_mul_f32 v203, s37, v203
    v_mfma_f32_16x16x32_bf16 v[172:175], a[252:255], a[92:95], v[172:175]
    v_cvt_pk_bf16_f32 v142, v200, v201
    v_cvt_pk_bf16_f32 v143, v202, v203
    v_mfma_f32_16x16x16_bf16 v[144:147], v[16:17], v[136:137], v[144:147]
    ds_read_b128 a[240:243], v224 offset:34112
    ds_read_b128 a[244:247], v224 offset:34176
    v_mfma_f32_16x16x32_bf16 v[180:183], a[220:223], a[96:99], v[180:183]
    ds_read_b128 a[248:251], v224 offset:34240
    v_mfma_f32_16x16x32_bf16 v[180:183], a[224:227], a[108:111], v[180:183]
    ds_read_b128 a[252:255], v224 offset:34304
    v_mfma_f32_16x16x32_bf16 v[176:179], a[220:223], a[100:103], v[176:179]
    buffer_load_dwordx4 v247, s[4:7], s56 offen lds
    v_mfma_f32_16x16x32_bf16 v[176:179], a[224:227], a[112:115], v[176:179]
    s_add_u32 s56, s39, 0x1ce000
    v_exp_f32 v149, v149
    v_mfma_f32_16x16x32_bf16 v[172:175], a[220:223], a[104:107], v[172:175]
    s_add_u32 m0, s41, 0x5ac0
    ds_read_b128 a[220:223], v224 offset:34368
    v_cvt_pk_bf16_f32 v162, v148, v149
    v_mfma_f32_16x16x32_bf16 v[172:175], a[224:227], a[116:119], v[172:175]
    ds_read_b128 a[224:227], v224 offset:46464
    v_mfma_f32_16x16x32_bf16 v[180:183], a[228:231], a[120:123], v[180:183]
    buffer_load_dwordx4 v246, s[4:7], s56 offen lds
    v_mfma_f32_16x16x32_bf16 v[180:183], a[232:235], a[132:135], v[180:183]
    s_add_u32 m0, s42, 0x5ac0
    v_exp_f32 v150, v150
    v_mfma_f32_16x16x32_bf16 v[176:179], a[228:231], a[124:127], v[176:179]
    buffer_load_dwordx4 v247, s[4:7], s56 offen lds
    v_mfma_f32_16x16x32_bf16 v[176:179], a[232:235], a[136:139], v[176:179]
    s_add_u32 s56, s39, 0x1f8000
    v_exp_f32 v151, v151
    v_mfma_f32_16x16x32_bf16 v[172:175], a[228:231], a[128:131], v[172:175]
    s_add_u32 m0, s41, 0x7900
    v_cvt_pk_bf16_f32 v74, v180, v181
    v_cvt_pk_bf16_f32 v75, v182, v183
    v_mfma_f32_16x16x32_bf16 v[172:175], a[232:235], a[140:143], v[172:175]
    ds_read_b128 a[228:231], v224 offset:46528
    v_cvt_pk_bf16_f32 v96, v176, v177
    v_mfma_f32_16x16x32_bf16 v[220:223], a[236:239], a[72:75], 0
    s_waitcnt lgkmcnt(3)
    ds_read_b128 a[232:235], v224 offset:46592
    v_cvt_pk_bf16_f32 v97, v178, v179
    v_mfma_f32_16x16x32_bf16 v[220:223], a[240:243], a[84:87], v[220:223]
    v_cvt_pk_bf16_f32 v163, v150, v151
    v_mfma_f32_16x16x32_bf16 v[216:219], a[236:239], a[76:79], 0
    v_cvt_pk_bf16_f32 v118, v172, v173
    v_cvt_pk_bf16_f32 v119, v174, v175
    v_mfma_f32_16x16x32_bf16 v[216:219], a[240:243], a[88:91], v[216:219]
    ds_read_b128 v[148:151], v229 offset:1920
    v_mfma_f32_16x16x32_bf16 v[196:199], a[216:219], v[160:163], 0
    v_exp_f32 v152, v152
    v_mfma_f32_16x16x32_bf16 v[184:187], v[66:69], v[160:163], 0
    v_exp_f32 v153, v153
    v_mfma_f32_16x16x32_bf16 v[188:191], v[88:91], v[160:163], 0
    v_exp_f32 v154, v154
    v_mfma_f32_16x16x32_bf16 v[192:195], v[110:113], v[160:163], 0
    v_exp_f32 v155, v155
    v_mfma_f32_16x16x32_bf16 v[212:215], a[236:239], a[80:83], 0
    ds_read_b128 a[236:239], v224 offset:46656
    v_cvt_pk_bf16_f32 v160, v152, v153
    v_mfma_f32_16x16x32_bf16 v[212:215], a[240:243], a[92:95], v[212:215]
    ds_read_b128 a[240:243], v224 offset:46720
    v_cvt_pk_bf16_f32 v161, v154, v155
    v_mfma_f32_16x16x32_bf16 v[220:223], a[244:247], a[96:99], v[220:223]
    ds_read_b128 v[152:155], v235
    v_bfe_u32 v235, s61, v232, 4
    v_mfma_f32_16x16x32_bf16 v[220:223], a[248:251], a[108:111], v[220:223]
    s_waitcnt lgkmcnt(3)
    v_mad_u32_u24 v235, v235, s40, v230
    v_mfma_f32_16x16x32_bf16 v[148:151], v[36:39], v[132:135], v[148:151]
    v_exp_f32 v156, v156
    v_mfma_f32_16x16x32_bf16 v[216:219], a[244:247], a[100:103], v[216:219]
    v_exp_f32 v157, v157
    v_mfma_f32_16x16x32_bf16 v[216:219], a[248:251], a[112:115], v[216:219]
    v_exp_f32 v158, v158
    v_mfma_f32_16x16x32_bf16 v[212:215], a[244:247], a[104:107], v[212:215]
    ds_read_b128 a[244:247], v224 offset:46784
    v_cvt_pk_bf16_f32 v162, v156, v157
    v_mfma_f32_16x16x32_bf16 v[212:215], a[248:251], a[116:119], v[212:215]
    ds_read_b128 a[248:251], v224 offset:49536
    v_mfma_f32_16x16x16_bf16 v[148:151], v[40:41], v[136:137], v[148:151]
    v_exp_f32 v159, v159
    v_mfma_f32_16x16x32_bf16 v[220:223], a[252:255], a[120:123], v[220:223]
    v_cvt_pk_bf16_f32 v163, v158, v159
    v_mfma_f32_16x16x32_bf16 v[220:223], a[220:223], a[132:135], v[220:223]
    ds_read_b128 v[156:159], v234
    v_bfe_u32 v234, s60, v232, 4
    v_mfma_f32_16x16x32_bf16 v[196:199], a[216:219], v[160:163], v[196:199]
    v_mad_u32_u24 v234, v234, s40, v230
    v_mfma_f32_16x16x32_bf16 v[184:187], v[70:73], v[160:163], v[184:187]
    v_exp_f32 v144, v144
    v_mfma_f32_16x16x32_bf16 v[188:191], v[92:95], v[160:163], v[188:191]
    v_exp_f32 v145, v145
    v_mfma_f32_16x16x32_bf16 v[192:195], v[114:117], v[160:163], v[192:195]
    s_waitcnt lgkmcnt(3)
    v_cvt_pk_bf16_f32 v76, v220, v221
    v_cvt_pk_bf16_f32 v77, v222, v223
    v_mfma_f32_16x16x32_bf16 v[152:155], v[42:45], v[132:135], v[152:155]
    v_exp_f32 v146, v146
    v_mfma_f32_16x16x32_bf16 v[216:219], a[252:255], a[124:127], v[216:219]
    v_exp_f32 v147, v147
    v_mfma_f32_16x16x32_bf16 v[216:219], a[220:223], a[136:139], v[216:219]
    v_cvt_pk_bf16_f32 v160, v144, v145
    v_cvt_pk_bf16_f32 v161, v146, v147
    v_mfma_f32_16x16x16_bf16 v[152:155], v[46:47], v[136:137], v[152:155]
    s_waitcnt lgkmcnt(0)
    ds_read_b128 v[144:147], v234
    v_bfe_u32 v234, s62, v232, 4
    v_mfma_f32_16x16x32_bf16 v[156:159], v[18:21], v[132:135], v[156:159]
    v_mad_u32_u24 v234, v234, s40, v230
    v_mfma_f32_16x16x32_bf16 v[212:215], a[252:255], a[128:131], v[212:215]
    v_cvt_pk_bf16_f32 v98, v216, v217
    v_cvt_pk_bf16_f32 v99, v218, v219
    v_mfma_f32_16x16x32_bf16 v[212:215], a[220:223], a[140:143], v[212:215]
    ds_read_b128 a[252:255], v224 offset:49600
    ds_read_b128 a[220:223], v224 offset:49664
    v_mfma_f32_16x16x16_bf16 v[156:159], v[22:23], v[136:137], v[156:159]
    v_exp_f32 v148, v148
    v_mfma_f32_16x16x32_bf16 v[208:211], a[224:227], a[72:75], 0
    v_exp_f32 v149, v149
    v_mfma_f32_16x16x32_bf16 v[208:211], a[228:231], a[84:87], v[208:211]
    v_exp_f32 v150, v150
    v_mfma_f32_16x16x32_bf16 v[204:207], a[224:227], a[76:79], 0
    v_cvt_pk_bf16_f32 v120, v212, v213
    v_cvt_pk_bf16_f32 v121, v214, v215
    v_mfma_f32_16x16x32_bf16 v[204:207], a[228:231], a[88:91], v[204:207]
    s_waitcnt lgkmcnt(2)
    v_exp_f32 v151, v151
    v_mfma_f32_16x16x32_bf16 v[144:147], v[24:27], v[138:141], v[144:147]
    v_cvt_pk_bf16_f32 v162, v148, v149
    v_cvt_pk_bf16_f32 v163, v150, v151
    v_mfma_f32_16x16x32_bf16 v[200:203], a[224:227], a[80:83], 0
    ds_read_b128 a[224:227], v224 offset:49728
    ds_read_b128 v[148:151], v235
    v_mfma_f32_16x16x32_bf16 v[200:203], a[228:231], a[92:95], v[200:203]
    v_bfe_u32 v235, s63, v233, 4
    v_mad_u32_u24 v235, v235, s40, v231
    v_mfma_f32_16x16x32_bf16 v[196:199], a[216:219], v[160:163], v[196:199]
    s_waitcnt vmcnt(4)
    ds_read_b128 a[228:231], v224 offset:49792
    v_mfma_f32_16x16x32_bf16 v[184:187], v[74:77], v[160:163], v[184:187]
    s_barrier
    ds_read_b128 v[252:255], v224 offset:320
    v_mfma_f32_16x16x32_bf16 v[188:191], v[96:99], v[160:163], v[188:191]
    v_exp_f32 v152, v152
    v_mfma_f32_16x16x32_bf16 v[192:195], v[118:121], v[160:163], v[192:195]
    v_exp_f32 v153, v153
    v_mfma_f32_16x16x16_bf16 v[144:147], v[28:29], v[142:143], v[144:147]
    v_exp_f32 v154, v154
    v_mfma_f32_16x16x32_bf16 v[208:211], a[232:235], a[96:99], v[208:211]
    v_exp_f32 v155, v155
    v_mfma_f32_16x16x32_bf16 v[208:211], a[236:239], a[108:111], v[208:211]
    v_cvt_pk_bf16_f32 v160, v152, v153
    v_cvt_pk_bf16_f32 v161, v154, v155
    v_mfma_f32_16x16x32_bf16 v[204:207], a[232:235], a[100:103], v[204:207]
    ds_read_b128 v[152:155], v230 offset:1920
    v_mfma_f32_16x16x32_bf16 v[204:207], a[236:239], a[112:115], v[204:207]
    s_waitcnt lgkmcnt(3)
    v_exp_f32 v156, v156
    v_mfma_f32_16x16x32_bf16 v[148:151], v[30:33], v[138:141], v[148:151]
    v_exp_f32 v157, v157
    v_mfma_f32_16x16x32_bf16 v[200:203], a[232:235], a[104:107], v[200:203]
    ds_read_b128 a[232:235], v224 offset:49856
    v_cvt_pk_bf16_f32 v162, v156, v157
    v_mfma_f32_16x16x32_bf16 v[200:203], a[236:239], a[116:119], v[200:203]
    ds_read_b128 a[236:239], v227 offset:37120
    v_mfma_f32_16x16x16_bf16 v[148:151], v[34:35], v[142:143], v[148:151]
    v_exp_f32 v158, v158
    v_mfma_f32_16x16x32_bf16 v[208:211], a[240:243], a[120:123], v[208:211]
    v_exp_f32 v159, v159
    v_mfma_f32_16x16x32_bf16 v[208:211], a[244:247], a[132:135], v[208:211]
    v_cvt_pk_bf16_f32 v163, v158, v159
    v_mfma_f32_16x16x32_bf16 v[204:207], a[240:243], a[124:127], v[204:207]
    ds_read_b128 v[156:159], v234
    v_bfe_u32 v234, s64, v233, 4
    v_mfma_f32_16x16x32_bf16 v[204:207], a[244:247], a[136:139], v[204:207]
    v_mad_u32_u24 v234, v234, s40, v231
    v_mfma_f32_16x16x32_bf16 v[196:199], a[216:219], v[160:163], v[196:199]
    s_waitcnt lgkmcnt(3)
    v_exp_f32 v144, v144
    v_mfma_f32_16x16x32_bf16 v[152:155], v[36:39], v[138:141], v[152:155]
    v_cvt_pk_bf16_f32 v80, v208, v209
    v_cvt_pk_bf16_f32 v81, v210, v211
    v_mfma_f32_16x16x32_bf16 v[200:203], a[240:243], a[128:131], v[200:203]
    ds_read_b128 a[240:243], v227 offset:37184
    v_cvt_pk_bf16_f32 v102, v204, v205
    v_mfma_f32_16x16x32_bf16 v[200:203], a[244:247], a[140:143], v[200:203]
    ds_read_b128 a[244:247], v227 offset:37248
    v_cvt_pk_bf16_f32 v103, v206, v207
    v_mfma_f32_16x16x16_bf16 v[152:155], v[40:41], v[142:143], v[152:155]
    v_rcp_f32 v197, v196
    v_mfma_f32_16x16x32_bf16 v[180:183], a[248:251], a[72:75], 0
    v_max3_f32 v236, v236, v196, v197
    v_mfma_f32_16x16x32_bf16 v[180:183], a[252:255], a[84:87], v[180:183]
    s_waitcnt vmcnt(0) lgkmcnt(2)
    ds_write_b128 v130, v[164:167] offset:36864
    v_mfma_f32_16x16x32_bf16 v[156:159], v[42:45], v[138:141], v[156:159]
    v_cvt_pk_bf16_f32 v124, v200, v201
    v_cvt_pk_bf16_f32 v125, v202, v203
    v_mfma_f32_16x16x32_bf16 v[176:179], a[248:251], a[76:79], 0
    ds_write_b128 v130, v[168:171] offset:37888
    v_mfma_f32_16x16x32_bf16 v[176:179], a[252:255], a[88:91], v[176:179]
    ds_write_b128 v130, v[248:251] offset:38912
    v_mfma_f32_16x16x16_bf16 v[156:159], v[46:47], v[142:143], v[156:159]
    v_exp_f32 v145, v145
    v_mfma_f32_16x16x32_bf16 v[172:175], a[248:251], a[80:83], 0
    v_exp_f32 v146, v146
    v_mfma_f32_16x16x32_bf16 v[172:175], a[252:255], a[92:95], v[172:175]
    v_exp_f32 v147, v147
    v_mfma_f32_16x16x32_bf16 v[180:183], a[220:223], a[96:99], v[180:183]
    v_exp_f32 v148, v148
    v_mfma_f32_16x16x32_bf16 v[180:183], a[224:227], a[108:111], v[180:183]
    v_exp_f32 v149, v149
    v_mfma_f32_16x16x32_bf16 v[176:179], a[220:223], a[100:103], v[176:179]
    v_exp_f32 v150, v150
    v_mfma_f32_16x16x32_bf16 v[176:179], a[224:227], a[112:115], v[176:179]
    ds_read_b128 a[248:251], v227 offset:37312
    ds_read_b128 a[252:255], v227 offset:37376
    v_mfma_f32_16x16x32_bf16 v[172:175], a[220:223], a[104:107], v[172:175]
    ds_read_b128 a[220:223], v227 offset:37440
    v_mfma_f32_16x16x32_bf16 v[172:175], a[224:227], a[116:119], v[172:175]
    ds_read_b128 a[224:227], v225 offset:39872
    v_mfma_f32_16x16x32_bf16 v[180:183], a[228:231], a[120:123], v[180:183]
    ds_read_b128 v[164:167], v224 offset:3264
    v_mfma_f32_16x16x32_bf16 v[180:183], a[232:235], a[132:135], v[180:183]
    ds_read_b128 v[168:171], v224 offset:3328
    v_mfma_f32_16x16x32_bf16 v[176:179], a[228:231], a[124:127], v[176:179]
    ds_read_b128 v[248:251], v224 offset:3392
    v_mfma_f32_16x16x32_bf16 v[176:179], a[232:235], a[136:139], v[176:179]
    v_exp_f32 v151, v151
    v_mfma_f32_16x16x32_bf16 v[172:175], a[228:231], a[128:131], v[172:175]
    ds_read_b128 a[228:231], v225 offset:39936
    v_mfma_f32_16x16x32_bf16 v[172:175], a[232:235], a[140:143], v[172:175]
    v_cvt_pk_bf16_f32 v78, v180, v181
    v_cvt_pk_bf16_f32 v79, v182, v183
    v_mfma_f32_16x16x32_bf16 v[220:223], a[236:239], a[72:75], 0
    s_waitcnt lgkmcnt(8)
    ds_read_b128 a[232:235], v225 offset:40000
    v_cvt_pk_bf16_f32 v100, v176, v177
    v_mfma_f32_16x16x32_bf16 v[220:223], a[240:243], a[84:87], v[220:223]
    v_cvt_pk_bf16_f32 v101, v178, v179
    v_mfma_f32_16x16x32_bf16 v[184:187], v[78:81], v[160:163], v[184:187]
    v_cvt_pk_bf16_f32 v122, v172, v173
    v_cvt_pk_bf16_f32 v123, v174, v175
    v_mfma_f32_16x16x32_bf16 v[188:191], v[100:103], v[160:163], v[188:191]
    v_exp_f32 v152, v152
    v_mfma_f32_16x16x32_bf16 v[192:195], v[122:125], v[160:163], v[192:195]
    v_cvt_pk_bf16_f32 v160, v144, v145
    v_cvt_pk_bf16_f32 v161, v146, v147
    v_mfma_f32_16x16x32_bf16 v[216:219], a[236:239], a[76:79], 0
    v_mul_f32 v184, v184, v197
    v_mul_f32 v185, v185, v197
    v_mfma_f32_16x16x32_bf16 v[216:219], a[240:243], a[88:91], v[216:219]
    v_cvt_pk_bf16_f32 v184, v184, v185
    v_mul_f32 v186, v186, v197
    v_mfma_f32_16x16x32_bf16 v[212:215], a[236:239], a[80:83], 0
    ds_read_b128 a[236:239], v225 offset:40064
    v_mul_f32 v187, v187, v197
    v_mfma_f32_16x16x32_bf16 v[212:215], a[240:243], a[92:95], v[212:215]
    ds_read_b128 a[240:243], v225 offset:40128
    v_cvt_pk_bf16_f32 v185, v186, v187
    v_mfma_f32_16x16x32_bf16 v[220:223], a[244:247], a[96:99], v[220:223]
    s_waitcnt lgkmcnt(3)
    v_mul_f32 v188, v188, v197
    v_mul_f32 v189, v189, v197
    v_mfma_f32_16x16x32_bf16 v[220:223], a[248:251], a[108:111], v[220:223]
    v_cvt_pk_bf16_f32 v186, v188, v189
    v_mul_f32 v190, v190, v197
    v_mfma_f32_16x16x32_bf16 v[216:219], a[244:247], a[100:103], v[216:219]
    v_mul_f32 v191, v191, v197
    v_cvt_pk_bf16_f32 v187, v190, v191
    v_mfma_f32_16x16x32_bf16 v[216:219], a[248:251], a[112:115], v[216:219]
    v_mul_f32 v192, v192, v197
    v_mul_f32 v193, v193, v197
    v_mfma_f32_16x16x32_bf16 v[212:215], a[244:247], a[104:107], v[212:215]
    ds_read_b128 a[244:247], v225 offset:40192
    v_cvt_pk_bf16_f32 v188, v192, v193
    v_mfma_f32_16x16x32_bf16 v[212:215], a[248:251], a[116:119], v[212:215]
    v_mul_f32 v194, v194, v197
    v_mul_f32 v195, v195, v197
    v_mfma_f32_16x16x32_bf16 v[220:223], a[252:255], a[120:123], v[220:223]
    ds_read_b128 v[144:147], v235
    v_cvt_pk_bf16_f32 v189, v194, v195
    v_mfma_f32_16x16x32_bf16 v[220:223], a[220:223], a[132:135], v[220:223]
    ds_write_b128 v237, v[184:187]
    v_mfma_f32_16x16x32_bf16 v[216:219], a[252:255], a[124:127], v[216:219]
    ds_write_b64 v238, v[188:189]
    v_mfma_f32_16x16x32_bf16 v[216:219], a[220:223], a[136:139], v[216:219]
    v_bfe_u32 v235, s65, v232, 4
    v_cvt_pk_bf16_f32 v162, v148, v149
    v_mfma_f32_16x16x32_bf16 v[212:215], a[252:255], a[128:131], v[212:215]
    v_cvt_pk_bf16_f32 v163, v150, v151
    v_cvt_pk_bf16_f32 v84, v220, v221
    v_mfma_f32_16x16x32_bf16 v[212:215], a[220:223], a[140:143], v[212:215]
    v_cvt_pk_bf16_f32 v85, v222, v223
    v_mfma_f32_16x16x32_bf16 v[196:199], a[216:219], v[160:163], 0
    v_cvt_pk_bf16_f32 v106, v216, v217
    v_cvt_pk_bf16_f32 v107, v218, v219
    v_mfma_f32_16x16x32_bf16 v[184:187], v[68:71], v[160:163], 0
    ds_read_b128 v[148:151], v234
    v_mad_u32_u24 v234, v235, s40, v229
    v_mfma_f32_16x16x32_bf16 v[188:191], v[90:93], v[160:163], 0
    v_cvt_pk_bf16_f32 v128, v212, v213
    v_cvt_pk_bf16_f32 v129, v214, v215
    v_mfma_f32_16x16x32_bf16 v[192:195], v[112:115], v[160:163], 0
    s_waitcnt lgkmcnt(3)
    ds_read_b64_tr_b16 a[248:249], v109 offset:12288
    v_mad_u32_u24 v235, v235, s40, v228
    v_mfma_f32_16x16x32_bf16 v[144:147], v[48:51], v[138:141], v[144:147]
    ds_read_b64_tr_b16 a[250:251], v109 offset:13824
    ds_read_b64_tr_b16 a[252:253], v109 offset:12320
    v_mfma_f32_16x16x32_bf16 v[208:211], a[144:147], a[224:227], 0
    ds_read_b64_tr_b16 a[254:255], v109 offset:13856
    ds_read_b64_tr_b16 a[220:221], v109 offset:12352
    v_mfma_f32_16x16x32_bf16 v[208:211], a[156:159], a[228:231], v[208:211]
    ds_read_b64_tr_b16 a[222:223], v109 offset:13888
    v_mfma_f32_16x16x16_bf16 v[144:147], v[52:53], v[142:143], v[144:147]
    v_exp_f32 v153, v153
    v_mfma_f32_16x16x32_bf16 v[204:207], a[148:151], a[224:227], 0
    v_exp_f32 v154, v154
    v_mfma_f32_16x16x32_bf16 v[204:207], a[160:163], a[228:231], v[204:207]
    s_waitcnt lgkmcnt(6)
    v_exp_f32 v155, v155
    v_mfma_f32_16x16x32_bf16 v[148:151], v[54:57], v[138:141], v[148:151]
    v_cvt_pk_bf16_f32 v160, v152, v153
    v_cvt_pk_bf16_f32 v161, v154, v155
    v_mfma_f32_16x16x32_bf16 v[200:203], a[152:155], a[224:227], 0
    ds_read_b128 v[152:155], v234
    v_mfma_f32_16x16x32_bf16 v[200:203], a[164:167], a[228:231], v[200:203]
    s_waitcnt lgkmcnt(5)
    ds_write_b128 v130, a[248:251] offset:12288
    v_mfma_f32_16x16x16_bf16 v[148:151], v[58:59], v[142:143], v[148:151]
    s_waitcnt lgkmcnt(4)
    ds_write_b128 v130, a[252:255] offset:13312
    v_mfma_f32_16x16x32_bf16 v[208:211], a[168:171], a[232:235], v[208:211]
    s_waitcnt lgkmcnt(3)
    ds_write_b128 v130, a[220:223] offset:14336
    v_mfma_f32_16x16x32_bf16 v[208:211], a[180:183], a[236:239], v[208:211]
    v_exp_f32 v156, v156
    v_mfma_f32_16x16x32_bf16 v[204:207], a[172:175], a[232:235], v[204:207]
    v_exp_f32 v157, v157
    v_mfma_f32_16x16x32_bf16 v[204:207], a[184:187], a[236:239], v[204:207]
    v_exp_f32 v158, v158
    v_mfma_f32_16x16x32_bf16 v[200:203], a[176:179], a[232:235], v[200:203]
    v_exp_f32 v159, v159
    v_mfma_f32_16x16x32_bf16 v[200:203], a[188:191], a[236:239], v[200:203]
    v_cvt_pk_bf16_f32 v162, v156, v157
    v_cvt_pk_bf16_f32 v163, v158, v159
    v_mfma_f32_16x16x32_bf16 v[208:211], a[192:195], a[240:243], v[208:211]
    v_exp_f32 v144, v144
    v_mfma_f32_16x16x32_bf16 v[208:211], a[204:207], a[244:247], v[208:211]
    v_exp_f32 v145, v145
    v_mfma_f32_16x16x32_bf16 v[196:199], a[216:219], v[160:163], v[196:199]
    ds_read_b128 a[236:239], v224
    ds_read_b128 a[248:251], v224 offset:192
    v_mfma_f32_16x16x32_bf16 v[184:187], v[76:79], v[160:163], v[184:187]
    ds_read_b128 a[252:255], v224 offset:256
    v_mfma_f32_16x16x32_bf16 v[188:191], v[98:101], v[160:163], v[188:191]
    ds_read_b64_tr_b16 a[220:221], v131
    v_mul_f32 v208, s37, v208
    v_mfma_f32_16x16x32_bf16 v[192:195], v[120:123], v[160:163], v[192:195]
    v_mul_f32 v209, s37, v209
    v_mul_f32 v210, s37, v210
    v_mfma_f32_16x16x32_bf16 v[204:207], a[196:199], a[240:243], v[204:207]
    v_mul_f32 v211, s37, v211
    v_cvt_pk_bf16_f32 v132, v208, v209
    v_mfma_f32_16x16x32_bf16 v[204:207], a[208:211], a[244:247], v[204:207]
    ds_read_b64_tr_b16 a[222:223], v131 offset:1536
    v_cvt_pk_bf16_f32 v133, v210, v211
    v_mfma_f32_16x16x32_bf16 v[200:203], a[200:203], a[240:243], v[200:203]
    ds_read_b128 a[240:243], v224 offset:64
    ds_read_b128 v[156:159], v235
    v_mfma_f32_16x16x32_bf16 v[200:203], a[212:215], a[244:247], v[200:203]
    s_waitcnt lgkmcnt(6)
    v_bfe_u32 v235, s62, v232, 4
    v_mad_u32_u24 v234, v235, s40, v228
    v_mul_f32 v204, s37, v204
    v_mul_f32 v205, s37, v205
    v_mfma_f32_16x16x32_bf16 v[180:183], a[0:3], a[236:239], 0
    v_mul_f32 v206, s37, v206
    v_mul_f32 v207, s37, v207
    v_mfma_f32_16x16x32_bf16 v[176:179], a[4:7], a[236:239], 0
    v_cvt_pk_bf16_f32 v134, v204, v205
    v_cvt_pk_bf16_f32 v135, v206, v207
    v_mfma_f32_16x16x32_bf16 v[172:175], a[8:11], a[236:239], 0
    v_mul_f32 v200, s37, v200
    v_mul_f32 v201, s37, v201
    v_mfma_f32_16x16x32_bf16 v[152:155], v[30:33], v[132:135], v[152:155]
    v_mul_f32 v202, s37, v202
    v_mul_f32 v203, s37, v203
    v_mfma_f32_16x16x32_bf16 v[220:223], a[236:239], a[72:75], 0
    v_cvt_pk_bf16_f32 v136, v200, v201
    v_cvt_pk_bf16_f32 v137, v202, v203
    v_mfma_f32_16x16x32_bf16 v[216:219], a[236:239], a[76:79], 0
    s_waitcnt lgkmcnt(1)
    ds_read_b128 a[244:247], v224 offset:128
    v_mad_u32_u24 v235, v235, s40, v229
    v_mfma_f32_16x16x32_bf16 v[216:219], a[240:243], a[88:91], v[216:219]
    ds_read_b64_tr_b16 a[224:225], v109 offset:24576
    ds_read_b64_tr_b16 a[226:227], v109 offset:26112
    v_mfma_f32_16x16x16_bf16 v[152:155], v[34:35], v[136:137], v[152:155]
    s_waitcnt lgkmcnt(3)
    ds_read_b64_tr_b16 a[228:229], v109 offset:24608
    ds_read_b64_tr_b16 a[230:231], v109 offset:26144
    v_mfma_f32_16x16x32_bf16 v[156:159], v[6:9], v[132:135], v[156:159]
    ds_read_b64_tr_b16 a[232:233], v109 offset:24640
    ds_read_b64_tr_b16 a[234:235], v109 offset:26176
    v_mfma_f32_16x16x32_bf16 v[180:183], a[12:15], a[240:243], v[180:183]
    v_exp_f32 v146, v146
    v_mfma_f32_16x16x32_bf16 v[176:179], a[16:19], a[240:243], v[176:179]
    v_exp_f32 v147, v147
    v_mfma_f32_16x16x16_bf16 v[156:159], v[10:11], v[136:137], v[156:159]
    v_cvt_pk_bf16_f32 v160, v144, v145
    v_cvt_pk_bf16_f32 v161, v146, v147
    v_mfma_f32_16x16x32_bf16 v[172:175], a[20:23], a[240:243], v[172:175]
    ds_read_b128 v[144:147], v228 offset:1280
    v_mfma_f32_16x16x32_bf16 v[220:223], a[240:243], a[84:87], v[220:223]
    v_exp_f32 v148, v148
    v_mfma_f32_16x16x32_bf16 v[212:215], a[236:239], a[80:83], 0
    s_waitcnt lgkmcnt(5)
    ds_write_b128 v130, a[224:227] offset:24576
    v_mfma_f32_16x16x32_bf16 v[212:215], a[240:243], a[92:95], v[212:215]
    s_waitcnt lgkmcnt(4)
    ds_write_b128 v130, a[228:231] offset:25600
    v_mfma_f32_16x16x32_bf16 v[180:183], a[24:27], a[244:247], v[180:183]
    s_waitcnt lgkmcnt(3)
    ds_write_b128 v130, a[232:235] offset:26624
    v_mfma_f32_16x16x32_bf16 v[180:183], a[36:39], a[248:251], v[180:183]
    v_exp_f32 v149, v149
    v_mfma_f32_16x16x32_bf16 v[176:179], a[28:31], a[244:247], v[176:179]
    v_exp_f32 v150, v150
    v_mfma_f32_16x16x32_bf16 v[176:179], a[40:43], a[248:251], v[176:179]
    s_waitcnt lgkmcnt(3)
    v_exp_f32 v151, v151
    v_mfma_f32_16x16x32_bf16 v[144:147], v[12:15], v[132:135], v[144:147]
    v_cvt_pk_bf16_f32 v162, v148, v149
    v_cvt_pk_bf16_f32 v163, v150, v151
    v_mfma_f32_16x16x32_bf16 v[172:175], a[32:35], a[244:247], v[172:175]
    v_exp_f32 v152, v152
    v_mfma_f32_16x16x32_bf16 v[172:175], a[44:47], a[248:251], v[172:175]
    v_exp_f32 v153, v153
    v_mfma_f32_16x16x32_bf16 v[196:199], a[216:219], v[160:163], v[196:199]
    v_exp_f32 v154, v154
    v_mfma_f32_16x16x32_bf16 v[184:187], v[82:85], v[160:163], v[184:187]
    ds_read_b64_tr_b16 a[224:225], v131 offset:8
    ds_read_b64_tr_b16 a[226:227], v131 offset:1544
    v_mfma_f32_16x16x32_bf16 v[188:191], v[104:107], v[160:163], v[188:191]
    ds_read_b64_tr_b16 a[228:229], v65
    v_mfma_f32_16x16x32_bf16 v[192:195], v[126:129], v[160:163], v[192:195]
    ds_read_b64_tr_b16 a[230:231], v65 offset:1536
    v_cvt_pk_bf16_f32 v160, v152, v153
    v_mfma_f32_16x16x16_bf16 v[144:147], v[16:17], v[136:137], v[144:147]
    v_rcp_f32 v197, v196
    v_mfma_f32_16x16x32_bf16 v[220:223], a[244:247], a[96:99], v[220:223]
    v_mul_f32 v184, v184, v197
    v_mul_f32 v185, v185, v197
    v_mfma_f32_16x16x32_bf16 v[220:223], a[248:251], a[108:111], v[220:223]
    v_cvt_pk_bf16_f32 v184, v184, v185
    v_mul_f32 v186, v186, v197
    v_mfma_f32_16x16x32_bf16 v[216:219], a[244:247], a[100:103], v[216:219]
    v_mul_f32 v187, v187, v197
    v_cvt_pk_bf16_f32 v185, v186, v187
    v_mfma_f32_16x16x32_bf16 v[216:219], a[248:251], a[112:115], v[216:219]
    v_mul_f32 v188, v188, v197
    v_mul_f32 v189, v189, v197
    v_mfma_f32_16x16x32_bf16 v[212:215], a[244:247], a[104:107], v[212:215]
    v_cvt_pk_bf16_f32 v186, v188, v189
    v_mul_f32 v190, v190, v197
    v_mfma_f32_16x16x32_bf16 v[212:215], a[248:251], a[116:119], v[212:215]
    ds_read_b128 a[248:251], v224 offset:3072
    v_mul_f32 v191, v191, v197
    v_mfma_f32_16x16x32_bf16 v[180:183], a[48:51], a[252:255], v[180:183]
    v_cvt_pk_bf16_f32 v187, v190, v191
    v_mul_f32 v192, v192, v197
    v_mfma_f32_16x16x32_bf16 v[180:183], a[60:63], v[252:255], v[180:183]
    v_mul_f32 v193, v193, v197
    v_cvt_pk_bf16_f32 v188, v192, v193
    v_mfma_f32_16x16x32_bf16 v[176:179], a[52:55], a[252:255], v[176:179]
    v_mul_f32 v194, v194, v197
    v_mul_f32 v195, v195, v197
    v_mfma_f32_16x16x32_bf16 v[176:179], a[64:67], v[252:255], v[176:179]
    v_cvt_pk_bf16_f32 v189, v194, v195
    v_max3_f32 v236, v236, v196, v197
    v_mfma_f32_16x16x32_bf16 v[172:175], a[56:59], a[252:255], v[172:175]
    v_cvt_pk_bf16_f32 v0, v180, v181
    v_cvt_pk_bf16_f32 v1, v182, v183
    v_mfma_f32_16x16x32_bf16 v[172:175], a[68:71], v[252:255], v[172:175]
    ds_write_b128 v237, v[184:187] offset:6144
    v_mfma_f32_16x16x32_bf16 v[220:223], a[252:255], a[120:123], v[220:223]
    v_cvt_pk_bf16_f32 v2, v176, v177
    v_cvt_pk_bf16_f32 v3, v178, v179
    v_mfma_f32_16x16x32_bf16 v[220:223], v[252:255], a[132:135], v[220:223]
    ds_write_b64 v238, v[188:189] offset:6144
    v_mfma_f32_16x16x32_bf16 v[216:219], a[252:255], a[124:127], v[216:219]
    v_exp_f32 v155, v155
    v_mfma_f32_16x16x32_bf16 v[216:219], v[252:255], a[136:139], v[216:219]
    v_cvt_pk_bf16_f32 v4, v172, v173
    v_cvt_pk_bf16_f32 v5, v174, v175
    v_mfma_f32_16x16x32_bf16 v[212:215], a[252:255], a[128:131], v[212:215]
    ds_read_b128 a[252:255], v224 offset:3136
    v_cvt_pk_bf16_f32 v66, v220, v221
    v_mfma_f32_16x16x32_bf16 v[212:215], v[252:255], a[140:143], v[212:215]
    s_waitcnt lgkmcnt(3)
    ds_read_b128 v[252:255], v224 offset:3200
    v_cvt_pk_bf16_f32 v67, v222, v223
    v_mfma_f32_16x16x32_bf16 v[208:211], a[0:3], a[248:251], 0
    v_cvt_pk_bf16_f32 v88, v216, v217
    v_cvt_pk_bf16_f32 v89, v218, v219
    v_mfma_f32_16x16x32_bf16 v[204:207], a[4:7], a[248:251], 0
    ds_read_b64_tr_b16 a[232:233], v65 offset:8
    ds_read_b64_tr_b16 a[234:235], v65 offset:1544
    v_mfma_f32_16x16x32_bf16 v[200:203], a[8:11], a[248:251], 0
    v_cvt_pk_bf16_f32 v110, v212, v213
    v_cvt_pk_bf16_f32 v111, v214, v215
    v_mfma_f32_16x16x32_bf16 v[180:183], a[248:251], a[72:75], 0
    ds_read_b128 v[148:151], v229 offset:1280
    v_cvt_pk_bf16_f32 v161, v154, v155
    v_mfma_f32_16x16x32_bf16 v[176:179], a[248:251], a[76:79], 0
    ds_read_b128 v[152:155], v229 offset:1920
    v_mfma_f32_16x16x32_bf16 v[172:175], a[248:251], a[80:83], 0
    s_waitcnt lgkmcnt(5)
    ds_read_b128 a[248:251], v225 offset:42944
    v_exp_f32 v156, v156
    v_exp_f32 v157, v157
    v_mfma_f32_16x16x32_bf16 v[172:175], a[252:255], a[92:95], v[172:175]
    ds_read_b64_tr_b16 a[236:237], v109 offset:49152
    ds_read_b64_tr_b16 a[238:239], v109 offset:50688
    v_mfma_f32_16x16x32_bf16 v[208:211], a[12:15], a[252:255], v[208:211]
    ds_read_b64_tr_b16 a[240:241], v109 offset:49184
    ds_read_b64_tr_b16 a[242:243], v109 offset:50720
    v_mfma_f32_16x16x32_bf16 v[204:207], a[16:19], a[252:255], v[204:207]
    ds_read_b64_tr_b16 a[244:245], v109 offset:49216
    ds_read_b64_tr_b16 a[246:247], v109 offset:50752
    v_mfma_f32_16x16x32_bf16 v[200:203], a[20:23], a[252:255], v[200:203]
    v_exp_f32 v158, v158
    v_mfma_f32_16x16x32_bf16 v[180:183], a[252:255], a[84:87], v[180:183]
    v_exp_f32 v159, v159
    v_mfma_f32_16x16x32_bf16 v[176:179], a[252:255], a[88:91], v[176:179]
    s_waitcnt lgkmcnt(8)
    ds_read_b128 a[252:255], v225 offset:43008
    v_cvt_pk_bf16_f32 v162, v156, v157
    v_mfma_f32_16x16x32_bf16 v[148:151], v[36:39], v[132:135], v[148:151]
    s_waitcnt lgkmcnt(8)
    v_cvt_pk_bf16_f32 v163, v158, v159
    v_mfma_f32_16x16x32_bf16 v[152:155], v[42:45], v[132:135], v[152:155]
    ds_read_b128 v[156:159], v228 offset:1920
    v_mfma_f32_16x16x32_bf16 v[196:199], a[216:219], v[160:163], 0
L_pg3:
    s_cbranch_execz L_pg7
    v_exp_f32 v144, v144
    v_mfma_f32_16x16x32_bf16 v[184:187], v[70:73], v[160:163], 0
    s_waitcnt lgkmcnt(6)
    ds_write_b128 v130, a[236:239] offset:49152
    v_mfma_f32_16x16x32_bf16 v[188:191], v[92:95], v[160:163], 0
    s_waitcnt lgkmcnt(5)
    ds_write_b128 v130, a[240:243] offset:50176
    v_mfma_f32_16x16x32_bf16 v[192:195], v[114:117], v[160:163], 0
    s_waitcnt lgkmcnt(4)
    ds_write_b128 v130, a[244:247] offset:51200
    v_mfma_f32_16x16x16_bf16 v[148:151], v[40:41], v[136:137], v[148:151]
    v_exp_f32 v145, v145
    v_mfma_f32_16x16x16_bf16 v[152:155], v[46:47], v[136:137], v[152:155]
    s_waitcnt lgkmcnt(3)
    v_exp_f32 v146, v146
    v_mfma_f32_16x16x32_bf16 v[156:159], v[18:21], v[132:135], v[156:159]
    v_exp_f32 v147, v147
    v_mfma_f32_16x16x32_bf16 v[208:211], a[24:27], v[252:255], v[208:211]
    v_cvt_pk_bf16_f32 v160, v144, v145
    v_cvt_pk_bf16_f32 v161, v146, v147
    v_mfma_f32_16x16x32_bf16 v[208:211], a[36:39], v[164:167], v[208:211]
    v_exp_f32 v148, v148
    v_mfma_f32_16x16x16_bf16 v[156:159], v[22:23], v[136:137], v[156:159]
    v_exp_f32 v149, v149
    v_mfma_f32_16x16x32_bf16 v[204:207], a[28:31], v[252:255], v[204:207]
    v_exp_f32 v150, v150
    v_mfma_f32_16x16x32_bf16 v[204:207], a[40:43], v[164:167], v[204:207]
    ds_read_b128 v[144:147], v234
    v_bfe_u32 v234, s65, v232, 4
    v_mfma_f32_16x16x32_bf16 v[200:203], a[32:35], v[252:255], v[200:203]
    ds_read_b64_tr_b16 a[236:237], v109 offset:61440
    v_mad_u32_u24 v234, v234, s40, v230
    v_mfma_f32_16x16x32_bf16 v[200:203], a[44:47], v[164:167], v[200:203]
    ds_read_b64_tr_b16 a[238:239], v109 offset:62976
    ds_read_b64_tr_b16 a[240:241], v109 offset:61472
    v_mfma_f32_16x16x32_bf16 v[180:183], v[252:255], a[96:99], v[180:183]
    ds_read_b64_tr_b16 a[242:243], v109 offset:63008
    ds_read_b64_tr_b16 a[244:245], v109 offset:61504
    v_mfma_f32_16x16x32_bf16 v[180:183], v[164:167], a[108:111], v[180:183]
    ds_read_b64_tr_b16 a[246:247], v109 offset:63040
    v_cvt_pk_bf16_f32 v162, v148, v149
    v_mfma_f32_16x16x32_bf16 v[176:179], v[252:255], a[100:103], v[176:179]
    v_exp_f32 v151, v151
    v_mfma_f32_16x16x32_bf16 v[176:179], v[164:167], a[112:115], v[176:179]
    v_cvt_pk_bf16_f32 v163, v150, v151
    v_mfma_f32_16x16x32_bf16 v[172:175], v[252:255], a[104:107], v[172:175]
    ds_read_b128 v[252:255], v225 offset:43072
    ds_read_b128 v[148:151], v235
    v_mfma_f32_16x16x32_bf16 v[172:175], v[164:167], a[116:119], v[172:175]
    v_bfe_u32 v235, s62, v232, 4
    v_mad_u32_u24 v235, v235, s40, v230
    v_mfma_f32_16x16x32_bf16 v[196:199], a[216:219], v[160:163], v[196:199]
    ds_read_b128 v[164:167], v225 offset:43136
    v_mfma_f32_16x16x32_bf16 v[184:187], v[74:77], v[160:163], v[184:187]
    s_waitcnt lgkmcnt(7)
    ds_write_b128 v130, a[236:239] offset:61440
    v_mfma_f32_16x16x32_bf16 v[188:191], v[96:99], v[160:163], v[188:191]
    s_waitcnt lgkmcnt(6)
    ds_write_b128 v130, a[240:243] offset:62464
    v_mfma_f32_16x16x32_bf16 v[192:195], v[118:121], v[160:163], v[192:195]
    s_waitcnt lgkmcnt(5)
    ds_write_b128 v130, a[244:247] offset:63488
    v_mfma_f32_16x16x32_bf16 v[144:147], v[0:3], v[132:135], v[144:147]
    v_exp_f32 v152, v152
    v_mfma_f32_16x16x32_bf16 v[208:211], a[48:51], v[168:171], v[208:211]
    v_exp_f32 v153, v153
    v_mfma_f32_16x16x32_bf16 v[208:211], a[60:63], v[248:251], v[208:211]
    v_exp_f32 v154, v154
    v_mfma_f32_16x16x32_bf16 v[204:207], a[52:55], v[168:171], v[204:207]
    v_exp_f32 v155, v155
    v_mfma_f32_16x16x32_bf16 v[204:207], a[64:67], v[248:251], v[204:207]
    v_cvt_pk_bf16_f32 v160, v152, v153
    v_cvt_pk_bf16_f32 v161, v154, v155
    v_mfma_f32_16x16x16_bf16 v[144:147], v[4:5], v[136:137], v[144:147]
    v_exp_f32 v156, v156
    v_mfma_f32_16x16x32_bf16 v[200:203], a[56:59], v[168:171], v[200:203]
    v_cvt_pk_bf16_f32 v24, v208, v209
    v_cvt_pk_bf16_f32 v25, v210, v211
    v_mfma_f32_16x16x32_bf16 v[200:203], a[68:71], v[248:251], v[200:203]
    v_cvt_pk_bf16_f32 v26, v204, v205
    v_cvt_pk_bf16_f32 v27, v206, v207
    v_mfma_f32_16x16x32_bf16 v[180:183], v[168:171], a[120:123], v[180:183]
    ds_read_b128 v[152:155], v235
    v_bfe_u32 v235, s66, v233, 4
    v_mfma_f32_16x16x32_bf16 v[180:183], v[248:251], a[132:135], v[180:183]
    s_waitcnt lgkmcnt(3)
    v_mad_u32_u24 v235, v235, s40, v231
    v_mfma_f32_16x16x32_bf16 v[148:151], v[24:27], v[132:135], v[148:151]
    v_cvt_pk_bf16_f32 v28, v200, v201
    v_cvt_pk_bf16_f32 v29, v202, v203
    v_mfma_f32_16x16x32_bf16 v[176:179], v[168:171], a[124:127], v[176:179]
    v_exp_f32 v157, v157
    v_mfma_f32_16x16x32_bf16 v[176:179], v[248:251], a[136:139], v[176:179]
    v_exp_f32 v158, v158
    v_mfma_f32_16x16x16_bf16 v[148:151], v[28:29], v[136:137], v[148:151]
    v_cvt_pk_bf16_f32 v68, v180, v181
    v_cvt_pk_bf16_f32 v69, v182, v183
    v_mfma_f32_16x16x32_bf16 v[172:175], v[168:171], a[128:131], v[172:175]
    ds_read_b128 v[168:171], v225 offset:43200
    v_cvt_pk_bf16_f32 v162, v156, v157
    v_mfma_f32_16x16x32_bf16 v[172:175], v[248:251], a[140:143], v[172:175]
    v_cvt_pk_bf16_f32 v90, v176, v177
    v_cvt_pk_bf16_f32 v91, v178, v179
    v_mfma_f32_16x16x32_bf16 v[220:223], a[144:147], a[248:251], 0
    ds_read_b128 v[248:251], v225 offset:43264
    v_mfma_f32_16x16x32_bf16 v[220:223], a[156:159], a[252:255], v[220:223]
    v_exp_f32 v159, v159
    v_mfma_f32_16x16x32_bf16 v[216:219], a[148:151], a[248:251], 0
    v_cvt_pk_bf16_f32 v163, v158, v159
    v_cvt_pk_bf16_f32 v112, v172, v173
    v_mfma_f32_16x16x32_bf16 v[216:219], a[160:163], a[252:255], v[216:219]
    ds_read_b128 v[156:159], v234
    v_cvt_pk_bf16_f32 v113, v174, v175
    v_mfma_f32_16x16x32_bf16 v[196:199], a[216:219], v[160:163], v[196:199]
    v_bfe_u32 v234, s67, v233, 4
    v_mad_u32_u24 v234, v234, s40, v231
    v_mfma_f32_16x16x32_bf16 v[184:187], v[78:81], v[160:163], v[184:187]
    v_exp_f32 v144, v144
    v_mfma_f32_16x16x32_bf16 v[188:191], v[100:103], v[160:163], v[188:191]
    v_exp_f32 v145, v145
    v_mfma_f32_16x16x32_bf16 v[192:195], v[122:125], v[160:163], v[192:195]
    v_exp_f32 v146, v146
    v_mfma_f32_16x16x32_bf16 v[212:215], a[152:155], a[248:251], 0
    s_waitcnt lgkmcnt(1)
    v_exp_f32 v147, v147
    v_mfma_f32_16x16x32_bf16 v[212:215], a[164:167], a[252:255], v[212:215]
    s_barrier
    ds_read_b128 a[236:239], v227 offset:6144
    ds_read_b128 a[240:243], v227 offset:6208
    v_mfma_f32_16x16x32_bf16 v[220:223], a[168:171], v[252:255], v[220:223]
    ds_read_b128 a[244:247], v227 offset:6272
    v_cvt_pk_bf16_f32 v160, v144, v145
    v_mfma_f32_16x16x32_bf16 v[220:223], a[180:183], v[164:167], v[220:223]
    ds_read_b128 a[248:251], v227 offset:6336
    v_cvt_pk_bf16_f32 v161, v146, v147
    v_mfma_f32_16x16x32_bf16 v[216:219], a[172:175], v[252:255], v[216:219]
    buffer_load_dwordx4 v246, s[4:7], s56 offen lds
    v_mfma_f32_16x16x32_bf16 v[216:219], a[184:187], v[164:167], v[216:219]
    s_add_u32 m0, s42, 0x7900
    ds_read_b128 a[252:255], v239
    ds_read_b128 v[144:147], v230 offset:1280
    v_mfma_f32_16x16x32_bf16 v[212:215], a[176:179], v[252:255], v[212:215]
    v_exp_f32 v148, v148
    v_mfma_f32_16x16x32_bf16 v[212:215], a[188:191], v[164:167], v[212:215]
    ds_read_b128 v[252:255], v240
    v_mfma_f32_16x16x32_bf16 v[220:223], a[192:195], v[168:171], v[220:223]
    ds_read_b128 v[164:167], v239 offset:1024
    v_mfma_f32_16x16x32_bf16 v[220:223], a[204:207], v[248:251], v[220:223]
    v_exp_f32 v149, v149
    v_mfma_f32_16x16x32_bf16 v[216:219], a[196:199], v[168:171], v[216:219]
    v_exp_f32 v150, v150
    v_mfma_f32_16x16x32_bf16 v[216:219], a[208:211], v[248:251], v[216:219]
    v_exp_f32 v151, v151
    v_mfma_f32_16x16x32_bf16 v[212:215], a[200:203], v[168:171], v[212:215]
    s_waitcnt lgkmcnt(3)
    buffer_load_dwordx4 v247, s[4:7], s56 offen lds
    v_mfma_f32_16x16x32_bf16 v[212:215], a[212:215], v[248:251], v[212:215]
    s_add_u32 s56, s39, 0x222000
    v_mul_f32 v220, s37, v220
    v_mul_f32 v221, s37, v221
    v_mfma_f32_16x16x32_bf16 v[208:211], a[220:223], a[252:255], 0
    s_add_u32 m0, s41, 0x9740
    v_mul_f32 v222, s37, v222
    v_mul_f32 v223, s37, v223
    v_mfma_f32_16x16x32_bf16 v[204:207], a[224:227], a[252:255], 0
    v_cvt_pk_bf16_f32 v138, v220, v221
    v_cvt_pk_bf16_f32 v139, v222, v223
    v_mfma_f32_16x16x32_bf16 v[220:223], a[0:3], a[236:239], 0
    v_mul_f32 v216, s37, v216
    v_mul_f32 v217, s37, v217
    v_mfma_f32_16x16x32_bf16 v[220:223], a[12:15], a[240:243], v[220:223]
    v_mul_f32 v218, s37, v218
    v_mul_f32 v219, s37, v219
    v_mfma_f32_16x16x32_bf16 v[220:223], a[24:27], a[244:247], v[220:223]
    v_cvt_pk_bf16_f32 v140, v216, v217
    v_cvt_pk_bf16_f32 v141, v218, v219
    v_mfma_f32_16x16x32_bf16 v[220:223], a[36:39], a[248:251], v[220:223]
    v_mul_f32 v212, s37, v212
    v_mul_f32 v213, s37, v213
    v_mfma_f32_16x16x32_bf16 v[152:155], v[24:27], v[138:141], v[152:155]
    v_mul_f32 v214, s37, v214
    v_mul_f32 v215, s37, v215
    v_mfma_f32_16x16x32_bf16 v[156:159], v[30:33], v[138:141], v[156:159]
    s_waitcnt lgkmcnt(0)
    v_cvt_pk_bf16_f32 v142, v212, v213
    v_cvt_pk_bf16_f32 v143, v214, v215
    v_mfma_f32_16x16x32_bf16 v[144:147], v[36:39], v[138:141], v[144:147]
    buffer_load_dwordx4 v246, s[4:7], s56 offen lds
    v_mfma_f32_16x16x16_bf16 v[152:155], v[28:29], v[142:143], v[152:155]
    s_add_u32 m0, s42, 0x9740
    ds_read_b128 v[168:171], v241 offset:12288
    ds_read_b128 v[248:251], v241 offset:12800
    v_mfma_f32_16x16x16_bf16 v[156:159], v[34:35], v[142:143], v[156:159]
    v_cvt_pk_bf16_f32 v162, v148, v149
    v_cvt_pk_bf16_f32 v163, v150, v151
    v_mfma_f32_16x16x16_bf16 v[144:147], v[40:41], v[142:143], v[144:147]
    ds_read_b128 v[148:151], v230 offset:1920
    v_mfma_f32_16x16x32_bf16 v[196:199], a[216:219], v[160:163], v[196:199]
    v_exp_f32 v152, v152
    v_mfma_f32_16x16x32_bf16 v[184:187], v[66:69], v[160:163], v[184:187]
    v_exp_f32 v153, v153
    v_mfma_f32_16x16x32_bf16 v[188:191], v[88:91], v[160:163], v[188:191]
    v_exp_f32 v154, v154
    v_mfma_f32_16x16x32_bf16 v[192:195], v[110:113], v[160:163], v[192:195]
    v_exp_f32 v155, v155
    v_mfma_f32_16x16x32_bf16 v[216:219], a[4:7], a[236:239], 0
    buffer_load_dwordx4 v247, s[4:7], s56 offen lds
    v_mfma_f32_16x16x32_bf16 v[216:219], a[16:19], a[240:243], v[216:219]
    s_add_u32 s56, s39, 0x24c000
    v_rcp_f32 v197, v196
    v_mfma_f32_16x16x32_bf16 v[212:215], a[8:11], a[236:239], 0
    s_add_u32 m0, s41, 0xb580
    ds_read_b128 a[236:239], v227 offset:6400
    v_mul_f32 v184, v184, v197
    v_mfma_f32_16x16x32_bf16 v[212:215], a[20:23], a[240:243], v[212:215]
    s_waitcnt lgkmcnt(1)
    ds_read_b128 a[240:243], v227 offset:6464
    v_mul_f32 v185, v185, v197
    v_mfma_f32_16x16x32_bf16 v[148:151], v[42:45], v[138:141], v[148:151]
    v_cvt_pk_bf16_f32 v184, v184, v185
    v_mul_f32 v186, v186, v197
    v_mfma_f32_16x16x32_bf16 v[216:219], a[28:31], a[244:247], v[216:219]
    v_mul_f32 v187, v187, v197
    v_cvt_pk_bf16_f32 v185, v186, v187
    v_mfma_f32_16x16x32_bf16 v[216:219], a[40:43], a[248:251], v[216:219]
    v_mul_f32 v188, v188, v197
    v_mul_f32 v189, v189, v197
    v_mfma_f32_16x16x16_bf16 v[148:151], v[46:47], v[142:143], v[148:151]
    v_cvt_pk_bf16_f32 v186, v188, v189
    v_mul_f32 v190, v190, v197
    v_mfma_f32_16x16x32_bf16 v[212:215], a[32:35], a[244:247], v[212:215]
    ds_read_b128 a[244:247], v227 offset:6144
    v_mul_f32 v191, v191, v197
    v_mfma_f32_16x16x32_bf16 v[212:215], a[44:47], a[248:251], v[212:215]
    ds_read_b128 a[248:251], v227 offset:6208
    v_cvt_pk_bf16_f32 v187, v190, v191
    v_mfma_f32_16x16x32_bf16 v[200:203], a[220:223], v[252:255], 0
    s_waitcnt lgkmcnt(3)
    v_mul_f32 v192, v192, v197
    v_mul_f32 v193, v193, v197
    v_mfma_f32_16x16x32_bf16 v[220:223], a[48:51], a[236:239], v[220:223]
    s_waitcnt lgkmcnt(2)
    v_cvt_pk_bf16_f32 v188, v192, v193
    v_mul_f32 v194, v194, v197
    v_mfma_f32_16x16x32_bf16 v[220:223], a[60:63], a[240:243], v[220:223]
    v_mul_f32 v195, v195, v197
    v_cvt_pk_bf16_f32 v189, v194, v195
    v_mfma_f32_16x16x32_bf16 v[216:219], a[52:55], a[236:239], v[216:219]
    v_max3_f32 v236, v236, v196, v197
    v_cvt_pk_bf16_f32 v160, v152, v153
    v_mfma_f32_16x16x32_bf16 v[216:219], a[64:67], a[240:243], v[216:219]
    ds_write_b128 v237, v[184:187] offset:12288
    v_mfma_f32_16x16x32_bf16 v[212:215], a[56:59], a[236:239], v[212:215]
    v_cvt_pk_bf16_f32 v60, v220, v221
    v_cvt_pk_bf16_f32 v61, v222, v223
    v_mfma_f32_16x16x32_bf16 v[212:215], a[68:71], a[240:243], v[212:215]
    ds_write_b64 v238, v[188:189] offset:12288
    v_mfma_f32_16x16x32_bf16 v[180:183], a[224:227], v[252:255], 0
    v_cvt_pk_bf16_f32 v161, v154, v155
    v_cvt_pk_bf16_f32 v62, v216, v217
    v_mfma_f32_16x16x32_bf16 v[176:179], a[228:231], a[252:255], 0
    v_cvt_pk_bf16_f32 v63, v218, v219
    v_mfma_f32_16x16x32_bf16 v[172:175], a[232:235], a[252:255], 0
    s_waitcnt lgkmcnt(2)
    ds_read_b128 a[236:239], v227 offset:6272
    v_cvt_pk_bf16_f32 v64, v212, v213
    v_mfma_f32_16x16x32_bf16 v[220:223], a[244:247], a[72:75], 0
    ds_read_b128 a[240:243], v227 offset:6336
    v_cvt_pk_bf16_f32 v65, v214, v215
    v_mfma_f32_16x16x32_bf16 v[220:223], a[248:251], a[84:87], v[220:223]
    ds_read_b128 v[152:155], v235
    v_bfe_u32 v235, s68, v233, 4
    v_mfma_f32_16x16x32_bf16 v[216:219], a[244:247], a[76:79], 0
    ds_read_b128 a[252:255], v240 offset:1024
    v_mad_u32_u24 v235, v235, s40, v231
    v_mfma_f32_16x16x32_bf16 v[216:219], a[248:251], a[88:91], v[216:219]
    ds_read_b128 v[252:255], v239 offset:2048
    v_mfma_f32_16x16x32_bf16 v[212:215], a[244:247], a[80:83], 0
    ds_read_b128 a[244:247], v227 offset:6400
    v_mfma_f32_16x16x32_bf16 v[212:215], a[248:251], a[92:95], v[212:215]
    ds_read_b128 a[248:251], v227 offset:6464
    v_mfma_f32_16x16x32_bf16 v[208:211], v[168:171], v[164:167], v[208:211]
    v_exp_f32 v156, v156
    v_mfma_f32_16x16x32_bf16 v[204:207], v[248:251], v[164:167], v[204:207]
    s_waitcnt lgkmcnt(6)
    v_exp_f32 v157, v157
    v_mfma_f32_16x16x32_bf16 v[220:223], a[236:239], a[96:99], v[220:223]
    s_waitcnt lgkmcnt(5)
    v_exp_f32 v158, v158
    v_mfma_f32_16x16x32_bf16 v[220:223], a[240:243], a[108:111], v[220:223]
    s_waitcnt lgkmcnt(4)
    v_exp_f32 v159, v159
    v_mfma_f32_16x16x32_bf16 v[152:155], v[48:51], v[138:141], v[152:155]
    v_cvt_pk_bf16_f32 v162, v156, v157
    v_cvt_pk_bf16_f32 v163, v158, v159
    v_mfma_f32_16x16x32_bf16 v[216:219], a[236:239], a[100:103], v[216:219]
    ds_read_b128 v[156:159], v234
    v_bfe_u32 v234, s69, v233, 4
    v_mfma_f32_16x16x32_bf16 v[216:219], a[240:243], a[112:115], v[216:219]
    v_mad_u32_u24 v234, v234, s40, v231
    v_mfma_f32_16x16x32_bf16 v[196:199], a[216:219], v[160:163], 0
    v_exp_f32 v144, v144
    v_mfma_f32_16x16x32_bf16 v[184:187], v[68:71], v[160:163], 0
    v_exp_f32 v145, v145
    v_mfma_f32_16x16x32_bf16 v[188:191], v[90:93], v[160:163], 0
    v_exp_f32 v146, v146
    v_mfma_f32_16x16x32_bf16 v[192:195], v[112:115], v[160:163], 0
    v_exp_f32 v147, v147
    v_mfma_f32_16x16x16_bf16 v[152:155], v[52:53], v[142:143], v[152:155]
    v_cvt_pk_bf16_f32 v160, v144, v145
    v_cvt_pk_bf16_f32 v161, v146, v147
    v_mfma_f32_16x16x32_bf16 v[212:215], a[236:239], a[104:107], v[212:215]
    ds_read_b128 a[236:239], v226 offset:1152
    ds_read_b128 v[144:147], v235
    v_mfma_f32_16x16x32_bf16 v[212:215], a[240:243], a[116:119], v[212:215]
    s_waitcnt lgkmcnt(2)
    v_bfe_u32 v235, s70, v233, 4
    v_mad_u32_u24 v235, v235, s40, v231
    v_mfma_f32_16x16x32_bf16 v[156:159], v[54:57], v[138:141], v[156:159]
    ds_read_b128 a[240:243], v226 offset:1216
    v_mfma_f32_16x16x32_bf16 v[220:223], a[244:247], a[120:123], v[220:223]
    v_exp_f32 v148, v148
    v_mfma_f32_16x16x32_bf16 v[220:223], a[248:251], a[132:135], v[220:223]
    v_exp_f32 v149, v149
    v_mfma_f32_16x16x32_bf16 v[216:219], a[244:247], a[124:127], v[216:219]
    v_exp_f32 v150, v150
    v_mfma_f32_16x16x32_bf16 v[216:219], a[248:251], a[136:139], v[216:219]
    v_exp_f32 v151, v151
    v_mfma_f32_16x16x16_bf16 v[156:159], v[58:59], v[142:143], v[156:159]
    v_cvt_pk_bf16_f32 v162, v148, v149
    v_cvt_pk_bf16_f32 v163, v150, v151
    v_mfma_f32_16x16x32_bf16 v[212:215], a[244:247], a[128:131], v[212:215]
    v_cvt_pk_bf16_f32 v86, v220, v221
    v_cvt_pk_bf16_f32 v87, v222, v223
    v_mfma_f32_16x16x32_bf16 v[212:215], a[248:251], a[140:143], v[212:215]
    v_cvt_pk_bf16_f32 v108, v216, v217
    v_cvt_pk_bf16_f32 v109, v218, v219
    v_mfma_f32_16x16x32_bf16 v[196:199], a[216:219], v[160:163], v[196:199]
    ds_read_b128 a[244:247], v226 offset:1280
    ds_read_b128 a[248:251], v226 offset:1344
    v_mfma_f32_16x16x32_bf16 v[184:187], v[76:79], v[160:163], v[184:187]
    ds_read_b128 v[148:151], v228 offset:640
    v_mfma_f32_16x16x32_bf16 v[188:191], v[98:101], v[160:163], v[188:191]
    v_cvt_pk_bf16_f32 v130, v212, v213
    v_cvt_pk_bf16_f32 v131, v214, v215
    v_mfma_f32_16x16x32_bf16 v[192:195], v[120:123], v[160:163], v[192:195]
    s_waitcnt lgkmcnt(3)
    v_exp_f32 v152, v152
    v_mfma_f32_16x16x32_bf16 v[144:147], v[60:63], v[138:141], v[144:147]
    v_exp_f32 v153, v153
    v_mfma_f32_16x16x32_bf16 v[220:223], a[144:147], a[236:239], 0
    v_exp_f32 v154, v154
    v_mfma_f32_16x16x32_bf16 v[220:223], a[156:159], a[240:243], v[220:223]
    v_exp_f32 v155, v155
    v_mfma_f32_16x16x32_bf16 v[216:219], a[148:151], a[236:239], 0
    v_cvt_pk_bf16_f32 v160, v152, v153
    v_cvt_pk_bf16_f32 v161, v154, v155
    v_mfma_f32_16x16x32_bf16 v[216:219], a[160:163], a[240:243], v[216:219]
    ds_read_b128 v[152:155], v229 offset:640
    v_mfma_f32_16x16x16_bf16 v[144:147], v[64:65], v[142:143], v[144:147]
    v_exp_f32 v156, v156
    v_mfma_f32_16x16x32_bf16 v[212:215], a[152:155], a[236:239], 0
    ds_read_b128 a[236:239], v226 offset:1408
    v_mfma_f32_16x16x32_bf16 v[212:215], a[164:167], a[240:243], v[212:215]
    s_waitcnt lgkmcnt(3)
    ds_read_b128 a[240:243], v226 offset:1472
    v_mfma_f32_16x16x32_bf16 v[220:223], a[168:171], a[244:247], v[220:223]
    v_exp_f32 v157, v157
    v_mfma_f32_16x16x32_bf16 v[220:223], a[180:183], a[248:251], v[220:223]
    v_exp_f32 v158, v158
    v_mfma_f32_16x16x32_bf16 v[216:219], a[172:175], a[244:247], v[216:219]
    v_exp_f32 v159, v159
    v_mfma_f32_16x16x32_bf16 v[216:219], a[184:187], a[248:251], v[216:219]
    v_cvt_pk_bf16_f32 v162, v156, v157
    v_cvt_pk_bf16_f32 v163, v158, v159
    v_mfma_f32_16x16x32_bf16 v[212:215], a[176:179], a[244:247], v[212:215]
    ds_read_b128 a[244:247], v224 offset:15488
    ds_read_b128 v[156:159], v229 offset:1280
    v_mfma_f32_16x16x32_bf16 v[212:215], a[188:191], a[248:251], v[212:215]
    v_exp_f32 v144, v144
    v_mfma_f32_16x16x32_bf16 v[196:199], a[216:219], v[160:163], v[196:199]
    ds_read_b128 a[248:251], v224 offset:15552
    v_mfma_f32_16x16x32_bf16 v[184:187], v[82:85], v[160:163], v[184:187]
    v_exp_f32 v145, v145
    v_mfma_f32_16x16x32_bf16 v[188:191], v[104:107], v[160:163], v[188:191]
    v_exp_f32 v146, v146
    v_mfma_f32_16x16x32_bf16 v[192:195], v[126:129], v[160:163], v[192:195]
    s_waitcnt lgkmcnt(3)
    v_exp_f32 v147, v147
    v_mfma_f32_16x16x32_bf16 v[220:223], a[192:195], a[236:239], v[220:223]
    v_cvt_pk_bf16_f32 v160, v144, v145
    v_cvt_pk_bf16_f32 v161, v146, v147
    v_mfma_f32_16x16x32_bf16 v[220:223], a[204:207], a[240:243], v[220:223]
    ds_read_b128 v[144:147], v228 offset:1280
    v_mfma_f32_16x16x16_bf16 v[196:199], a[216:217], v[160:161], v[196:199]
    v_mfma_f32_16x16x16_bf16 v[184:187], v[86:87], v[160:161], v[184:187]
    v_mfma_f32_16x16x16_bf16 v[188:191], v[108:109], v[160:161], v[188:191]
    v_mfma_f32_16x16x16_bf16 v[192:195], v[130:131], v[160:161], v[192:195]
    v_mfma_f32_16x16x32_bf16 v[216:219], a[196:199], a[236:239], v[216:219]
    v_mfma_f32_16x16x32_bf16 v[216:219], a[208:211], a[240:243], v[216:219]
    v_mfma_f32_16x16x32_bf16 v[212:215], a[200:203], a[236:239], v[212:215]
    v_mul_f32 v220, s37, v220
    v_mul_f32 v221, s37, v221
    v_mfma_f32_16x16x32_bf16 v[212:215], a[212:215], a[240:243], v[212:215]
    v_mul_f32 v222, s37, v222
    v_mul_f32 v223, s37, v223
    v_mfma_f32_16x16x32_bf16 v[200:203], v[168:171], a[252:255], v[200:203]
    v_cvt_pk_bf16_f32 v132, v220, v221
    v_cvt_pk_bf16_f32 v133, v222, v223
    v_mfma_f32_16x16x32_bf16 v[180:183], v[248:251], a[252:255], v[180:183]
    s_waitcnt lgkmcnt(0)
    v_mul_f32 v216, s37, v216
    v_mul_f32 v217, s37, v217
    v_mfma_f32_16x16x32_bf16 v[220:223], a[0:3], a[244:247], 0
    v_mul_f32 v218, s37, v218
    v_mul_f32 v219, s37, v219
    v_mfma_f32_16x16x32_bf16 v[220:223], a[12:15], a[248:251], v[220:223]
    v_cvt_pk_bf16_f32 v134, v216, v217
    v_cvt_pk_bf16_f32 v135, v218, v219
    v_mfma_f32_16x16x32_bf16 v[216:219], a[4:7], a[244:247], 0
    v_mul_f32 v212, s37, v212
    v_mul_f32 v213, s37, v213
    v_mfma_f32_16x16x32_bf16 v[216:219], a[16:19], a[248:251], v[216:219]
    v_mul_f32 v214, s37, v214
    v_mul_f32 v215, s37, v215
    v_mfma_f32_16x16x32_bf16 v[148:151], v[12:15], v[132:135], v[148:151]
    v_cvt_pk_bf16_f32 v136, v212, v213
    v_cvt_pk_bf16_f32 v137, v214, v215
    v_mfma_f32_16x16x32_bf16 v[152:155], v[36:39], v[132:135], v[152:155]
    ds_read_b128 a[236:239], v224 offset:15616
    ds_read_b128 a[240:243], v224 offset:15680
    v_mfma_f32_16x16x32_bf16 v[156:159], v[42:45], v[132:135], v[156:159]
    v_rcp_f32 v197, v196
    v_mfma_f32_16x16x16_bf16 v[148:151], v[16:17], v[136:137], v[148:151]
    v_mul_f32 v184, v184, v197
    v_mul_f32 v185, v185, v197
    v_mfma_f32_16x16x16_bf16 v[152:155], v[40:41], v[136:137], v[152:155]
    v_cvt_pk_bf16_f32 v184, v184, v185
    v_mul_f32 v186, v186, v197
    v_mfma_f32_16x16x16_bf16 v[156:159], v[46:47], v[136:137], v[156:159]
    v_mul_f32 v187, v187, v197
    v_cvt_pk_bf16_f32 v185, v186, v187
    v_mfma_f32_16x16x32_bf16 v[144:147], v[18:21], v[132:135], v[144:147]
    v_mul_f32 v188, v188, v197
    v_mul_f32 v189, v189, v197
    v_mfma_f32_16x16x32_bf16 v[212:215], a[8:11], a[244:247], 0
    ds_read_b128 a[244:247], v224 offset:15744
    v_cvt_pk_bf16_f32 v186, v188, v189
    v_mfma_f32_16x16x32_bf16 v[212:215], a[20:23], a[248:251], v[212:215]
    ds_read_b128 a[248:251], v224 offset:15808
    v_mul_f32 v190, v190, v197
    v_mfma_f32_16x16x16_bf16 v[144:147], v[22:23], v[136:137], v[144:147]
    s_waitcnt lgkmcnt(3)
    v_mul_f32 v191, v191, v197
    v_cvt_pk_bf16_f32 v187, v190, v191
    v_mfma_f32_16x16x32_bf16 v[220:223], a[24:27], a[236:239], v[220:223]
    s_waitcnt lgkmcnt(2)
    v_mul_f32 v192, v192, v197
    v_mul_f32 v193, v193, v197
    v_mfma_f32_16x16x32_bf16 v[220:223], a[36:39], a[240:243], v[220:223]
    v_cvt_pk_bf16_f32 v188, v192, v193
    v_mul_f32 v194, v194, v197
    v_mfma_f32_16x16x32_bf16 v[216:219], a[28:31], a[236:239], v[216:219]
    v_mul_f32 v195, v195, v197
    v_cvt_pk_bf16_f32 v189, v194, v195
    v_mfma_f32_16x16x32_bf16 v[216:219], a[40:43], a[240:243], v[216:219]
    ds_read_b128 v[168:171], v242 offset:12288
    v_max3_f32 v236, v236, v196, v197
    v_mfma_f32_16x16x32_bf16 v[212:215], a[32:35], a[236:239], v[212:215]
    ds_read_b128 a[236:239], v224 offset:15488
    ds_read_b128 v[248:251], v242 offset:12800
    v_mfma_f32_16x16x32_bf16 v[212:215], a[44:47], a[240:243], v[212:215]
    s_waitcnt lgkmcnt(4)
    ds_read_b128 a[240:243], v224 offset:15552
    v_mfma_f32_16x16x32_bf16 v[220:223], a[48:51], a[244:247], v[220:223]
    s_waitcnt lgkmcnt(4)
    ds_write_b128 v237, v[184:187] offset:18432
    v_mfma_f32_16x16x32_bf16 v[220:223], a[60:63], a[248:251], v[220:223]
    ds_write_b64 v238, v[188:189] offset:18432
    v_mfma_f32_16x16x32_bf16 v[216:219], a[52:55], a[244:247], v[216:219]
    v_exp_f32 v148, v148
    v_mfma_f32_16x16x32_bf16 v[216:219], a[64:67], a[248:251], v[216:219]
    v_exp_f32 v149, v149
    v_mfma_f32_16x16x32_bf16 v[212:215], a[56:59], a[244:247], v[212:215]
    v_exp_f32 v150, v150
    v_mfma_f32_16x16x32_bf16 v[212:215], a[68:71], a[248:251], v[212:215]
    s_waitcnt lgkmcnt(5)
    v_cvt_pk_bf16_f32 v6, v220, v221
    v_cvt_pk_bf16_f32 v7, v222, v223
    v_mfma_f32_16x16x32_bf16 v[176:179], v[168:171], v[164:167], v[176:179]
    s_waitcnt lgkmcnt(3)
    ds_read_b128 a[244:247], v224 offset:15616
    v_cvt_pk_bf16_f32 v8, v216, v217
    v_mfma_f32_16x16x32_bf16 v[172:175], v[248:251], v[164:167], v[172:175]
    ds_read_b128 a[248:251], v224 offset:15680
    v_cvt_pk_bf16_f32 v9, v218, v219
    v_mfma_f32_16x16x32_bf16 v[220:223], a[236:239], a[72:75], 0
    s_waitcnt lgkmcnt(4)
    v_cvt_pk_bf16_f32 v10, v212, v213
    v_cvt_pk_bf16_f32 v11, v214, v215
    v_mfma_f32_16x16x32_bf16 v[220:223], a[240:243], a[84:87], v[220:223]
    ds_read_b128 v[164:167], v240 offset:2048
    ds_read_b128 v[168:171], v241 offset:24576
    v_mfma_f32_16x16x32_bf16 v[216:219], a[236:239], a[76:79], 0
    ds_read_b128 v[248:251], v241 offset:25088
    v_cvt_pk_bf16_f32 v160, v148, v149
    v_mfma_f32_16x16x32_bf16 v[216:219], a[240:243], a[88:91], v[216:219]
    ds_read_b128 a[252:255], v239 offset:3072
    v_mfma_f32_16x16x32_bf16 v[212:215], a[236:239], a[80:83], 0
    ds_read_b128 a[236:239], v224 offset:15744
    v_mfma_f32_16x16x32_bf16 v[212:215], a[240:243], a[92:95], v[212:215]
    s_waitcnt lgkmcnt(6)
    ds_read_b128 a[240:243], v224 offset:15808
    v_exp_f32 v151, v151
    v_exp_f32 v152, v152
    v_mfma_f32_16x16x32_bf16 v[220:223], a[244:247], a[96:99], v[220:223]
    s_waitcnt lgkmcnt(6)
    v_cvt_pk_bf16_f32 v161, v150, v151
    v_mfma_f32_16x16x32_bf16 v[220:223], a[248:251], a[108:111], v[220:223]
    ds_read_b128 v[148:151], v228 offset:1920
    v_mfma_f32_16x16x32_bf16 v[216:219], a[244:247], a[100:103], v[216:219]
    v_exp_f32 v153, v153
    v_mfma_f32_16x16x32_bf16 v[216:219], a[248:251], a[112:115], v[216:219]
    s_waitcnt lgkmcnt(5)
    v_exp_f32 v154, v154
    v_mfma_f32_16x16x32_bf16 v[208:211], v[168:171], v[252:255], v[208:211]
    v_exp_f32 v155, v155
    v_mfma_f32_16x16x32_bf16 v[200:203], v[168:171], v[164:167], v[200:203]
    s_waitcnt lgkmcnt(4)
    ds_read_b128 v[168:171], v242 offset:24576
    v_cvt_pk_bf16_f32 v162, v152, v153
    v_mfma_f32_16x16x32_bf16 v[204:207], v[248:251], v[252:255], v[204:207]
    v_cvt_pk_bf16_f32 v163, v154, v155
    v_mfma_f32_16x16x32_bf16 v[180:183], v[248:251], v[164:167], v[180:183]
    ds_read_b128 v[248:251], v242 offset:25088
    ds_read_b128 v[164:167], v239 offset:4096
    v_mfma_f32_16x16x32_bf16 v[196:199], a[216:219], v[160:163], 0
    ds_read_b128 v[152:155], v229 offset:1920
    v_mfma_f32_16x16x32_bf16 v[184:187], v[74:77], v[160:163], 0
    v_exp_f32 v156, v156
    v_mfma_f32_16x16x32_bf16 v[188:191], v[96:99], v[160:163], 0
    v_exp_f32 v157, v157
    v_mfma_f32_16x16x32_bf16 v[192:195], v[118:121], v[160:163], 0
    s_waitcnt lgkmcnt(4)
    v_exp_f32 v158, v158
    v_mfma_f32_16x16x32_bf16 v[148:151], v[0:3], v[132:135], v[148:151]
    v_exp_f32 v159, v159
    v_mfma_f32_16x16x32_bf16 v[212:215], a[244:247], a[104:107], v[212:215]
    ds_read_b128 a[244:247], v224 offset:18560
    v_cvt_pk_bf16_f32 v160, v156, v157
    v_mfma_f32_16x16x32_bf16 v[212:215], a[248:251], a[116:119], v[212:215]
    ds_read_b128 a[248:251], v224 offset:18624
    v_cvt_pk_bf16_f32 v161, v158, v159
    v_mfma_f32_16x16x16_bf16 v[148:151], v[4:5], v[136:137], v[148:151]
    s_waitcnt lgkmcnt(5)
    ds_read_b128 v[156:159], v229 offset:2560
    v_mfma_f32_16x16x32_bf16 v[176:179], v[168:171], v[252:255], v[176:179]
    s_waitcnt lgkmcnt(5)
    ds_read_b128 v[168:171], v241 offset:36864
    v_mfma_f32_16x16x32_bf16 v[172:175], v[248:251], v[252:255], v[172:175]
    s_waitcnt lgkmcnt(4)
    ds_read_b128 v[252:255], v240 offset:3072
    v_mfma_f32_16x16x32_bf16 v[152:155], v[24:27], v[132:135], v[152:155]
    ds_read_b128 v[248:251], v241 offset:37376
    v_mfma_f32_16x16x32_bf16 v[220:223], a[236:239], a[120:123], v[220:223]
    v_exp_f32 v144, v144
    v_mfma_f32_16x16x32_bf16 v[220:223], a[240:243], a[132:135], v[220:223]
    v_exp_f32 v145, v145
    v_mfma_f32_16x16x32_bf16 v[216:219], a[236:239], a[124:127], v[216:219]
    v_exp_f32 v146, v146
    v_mfma_f32_16x16x32_bf16 v[216:219], a[240:243], a[136:139], v[216:219]
    v_exp_f32 v147, v147
    v_mfma_f32_16x16x16_bf16 v[152:155], v[28:29], v[136:137], v[152:155]
    v_cvt_pk_bf16_f32 v162, v144, v145
    v_cvt_pk_bf16_f32 v163, v146, v147
    v_mfma_f32_16x16x32_bf16 v[212:215], a[236:239], a[128:131], v[212:215]
    v_cvt_pk_bf16_f32 v72, v220, v221
    v_cvt_pk_bf16_f32 v73, v222, v223
    v_mfma_f32_16x16x32_bf16 v[212:215], a[240:243], a[140:143], v[212:215]
    v_cvt_pk_bf16_f32 v94, v216, v217
    v_cvt_pk_bf16_f32 v95, v218, v219
    v_mfma_f32_16x16x32_bf16 v[196:199], a[216:219], v[160:163], v[196:199]
    ds_read_b128 a[236:239], v224 offset:18688
    ds_read_b128 a[240:243], v224 offset:18752
    v_mfma_f32_16x16x32_bf16 v[184:187], v[78:81], v[160:163], v[184:187]
    ds_read_b128 v[144:147], v228 offset:2560
    v_mfma_f32_16x16x32_bf16 v[188:191], v[100:103], v[160:163], v[188:191]
    v_cvt_pk_bf16_f32 v116, v212, v213
    v_cvt_pk_bf16_f32 v117, v214, v215
    v_mfma_f32_16x16x32_bf16 v[192:195], v[122:125], v[160:163], v[192:195]
    s_waitcnt lgkmcnt(3)
    v_exp_f32 v148, v148
    v_mfma_f32_16x16x32_bf16 v[208:211], v[168:171], a[252:255], v[208:211]
L_pg4:
    s_cbranch_execz L_pg8
    v_exp_f32 v149, v149
    v_mfma_f32_16x16x32_bf16 v[200:203], v[168:171], v[252:255], v[200:203]
    ds_read_b128 v[168:171], v242 offset:36864
    v_cvt_pk_bf16_f32 v160, v148, v149
    v_mfma_f32_16x16x32_bf16 v[204:207], v[248:251], a[252:255], v[204:207]
    v_exp_f32 v150, v150
    v_mfma_f32_16x16x32_bf16 v[180:183], v[248:251], v[252:255], v[180:183]
    ds_read_b128 v[248:251], v242 offset:37376
    ds_read_b128 v[252:255], v239 offset:5120
    v_mfma_f32_16x16x32_bf16 v[220:223], a[0:3], a[244:247], 0
    v_exp_f32 v151, v151
    v_mfma_f32_16x16x32_bf16 v[220:223], a[12:15], a[248:251], v[220:223]
    v_cvt_pk_bf16_f32 v161, v150, v151
    v_mfma_f32_16x16x32_bf16 v[216:219], a[4:7], a[244:247], 0
    ds_read_b128 v[148:151], v230 offset:640
    v_mfma_f32_16x16x32_bf16 v[216:219], a[16:19], a[248:251], v[216:219]
    s_waitcnt lgkmcnt(4)
    v_exp_f32 v152, v152
    v_mfma_f32_16x16x32_bf16 v[144:147], v[6:9], v[132:135], v[144:147]
    v_exp_f32 v153, v153
    v_mfma_f32_16x16x32_bf16 v[212:215], a[8:11], a[244:247], 0
    ds_read_b128 a[244:247], v224 offset:18816
    v_cvt_pk_bf16_f32 v162, v152, v153
    v_mfma_f32_16x16x32_bf16 v[212:215], a[20:23], a[248:251], v[212:215]
    ds_read_b128 a[248:251], v224 offset:18880
    v_mfma_f32_16x16x16_bf16 v[144:147], v[10:11], v[136:137], v[144:147]
    s_waitcnt lgkmcnt(5)
    v_exp_f32 v154, v154
    v_mfma_f32_16x16x32_bf16 v[176:179], v[168:171], a[252:255], v[176:179]
    s_waitcnt lgkmcnt(4)
    ds_read_b128 v[168:171], v241 offset:49152
    v_mfma_f32_16x16x32_bf16 v[172:175], v[248:251], a[252:255], v[172:175]
    ds_read_b128 a[252:255], v240 offset:4096
    ds_read_b128 v[248:251], v241 offset:49664
    v_mfma_f32_16x16x32_bf16 v[220:223], a[24:27], a[236:239], v[220:223]
    v_exp_f32 v155, v155
    v_mfma_f32_16x16x32_bf16 v[220:223], a[36:39], a[240:243], v[220:223]
    v_cvt_pk_bf16_f32 v163, v154, v155
    v_mfma_f32_16x16x32_bf16 v[216:219], a[28:31], a[236:239], v[216:219]
    ds_read_b128 v[152:155], v230 offset:1280
    v_mfma_f32_16x16x32_bf16 v[216:219], a[40:43], a[240:243], v[216:219]
    v_exp_f32 v144, v144
    v_mfma_f32_16x16x32_bf16 v[196:199], a[216:219], v[160:163], v[196:199]
    v_exp_f32 v145, v145
    v_mfma_f32_16x16x32_bf16 v[184:187], v[66:69], v[160:163], v[184:187]
    v_exp_f32 v146, v146
    v_mfma_f32_16x16x32_bf16 v[188:191], v[88:91], v[160:163], v[188:191]
    v_exp_f32 v147, v147
    v_mfma_f32_16x16x32_bf16 v[192:195], v[110:113], v[160:163], v[192:195]
    v_cvt_pk_bf16_f32 v162, v144, v145
    v_cvt_pk_bf16_f32 v163, v146, v147
    v_mfma_f32_16x16x32_bf16 v[212:215], a[32:35], a[236:239], v[212:215]
    ds_read_b128 a[236:239], v224 offset:18560
    ds_read_b128 v[144:147], v230 offset:2560
    v_mfma_f32_16x16x32_bf16 v[212:215], a[44:47], a[240:243], v[212:215]
    s_waitcnt lgkmcnt(4)
    v_mfma_f32_16x16x32_bf16 v[220:223], a[48:51], a[244:247], v[220:223]
    ds_read_b128 a[240:243], v224 offset:18624
    v_mfma_f32_16x16x32_bf16 v[220:223], a[60:63], a[248:251], v[220:223]
    v_mfma_f32_16x16x32_bf16 v[216:219], a[52:55], a[244:247], v[216:219]
    v_mfma_f32_16x16x32_bf16 v[216:219], a[64:67], a[248:251], v[216:219]
    v_mfma_f32_16x16x32_bf16 v[212:215], a[56:59], a[244:247], v[212:215]
    ds_read_b128 a[244:247], v224 offset:18688
    v_mfma_f32_16x16x32_bf16 v[212:215], a[68:71], a[248:251], v[212:215]
    ds_read_b128 a[248:251], v224 offset:18752
    v_mfma_f32_16x16x32_bf16 v[208:211], v[168:171], v[164:167], v[208:211]
    v_mfma_f32_16x16x32_bf16 v[200:203], v[168:171], a[252:255], v[200:203]
    s_waitcnt lgkmcnt(5)
    v_cvt_pk_bf16_f32 v30, v220, v221
    v_cvt_pk_bf16_f32 v31, v222, v223
    v_mfma_f32_16x16x32_bf16 v[204:207], v[248:251], v[164:167], v[204:207]
    v_cvt_pk_bf16_f32 v32, v216, v217
    v_cvt_pk_bf16_f32 v33, v218, v219
    v_mfma_f32_16x16x32_bf16 v[180:183], v[248:251], a[252:255], v[180:183]
    v_cvt_pk_bf16_f32 v34, v212, v213
    v_cvt_pk_bf16_f32 v35, v214, v215
    v_mfma_f32_16x16x32_bf16 v[156:159], v[30:33], v[132:135], v[156:159]
    s_waitcnt lgkmcnt(2)
    ds_read_b128 v[168:171], v242 offset:49152
    ds_read_b128 v[248:251], v242 offset:49664
    v_mfma_f32_16x16x32_bf16 v[220:223], a[236:239], a[72:75], 0
    v_mfma_f32_16x16x32_bf16 v[220:223], a[240:243], a[84:87], v[220:223]
    v_mfma_f32_16x16x32_bf16 v[216:219], a[236:239], a[76:79], 0
    v_mfma_f32_16x16x32_bf16 v[216:219], a[240:243], a[88:91], v[216:219]
    v_mfma_f32_16x16x16_bf16 v[156:159], v[34:35], v[136:137], v[156:159]
    v_mfma_f32_16x16x32_bf16 v[212:215], a[236:239], a[80:83], 0
    ds_read_b128 a[236:239], v224 offset:18816
    v_mfma_f32_16x16x32_bf16 v[212:215], a[240:243], a[92:95], v[212:215]
    s_waitcnt lgkmcnt(3)
    ds_read_b128 a[240:243], v224 offset:18880
    v_mfma_f32_16x16x32_bf16 v[220:223], a[244:247], a[96:99], v[220:223]
    v_mfma_f32_16x16x32_bf16 v[220:223], a[248:251], a[108:111], v[220:223]
    s_waitcnt lgkmcnt(3)
    v_mfma_f32_16x16x32_bf16 v[176:179], v[168:171], v[164:167], v[176:179]
    s_waitcnt lgkmcnt(2)
    ds_read_b128 v[168:171], v241 offset:61440
    v_mfma_f32_16x16x32_bf16 v[172:175], v[248:251], v[164:167], v[172:175]
    ds_read_b128 v[164:167], v240 offset:5120
    ds_read_b128 v[248:251], v241 offset:61952
    v_mfma_f32_16x16x32_bf16 v[216:219], a[244:247], a[100:103], v[216:219]
    v_exp_f32 v156, v156
    v_mfma_f32_16x16x32_bf16 v[216:219], a[248:251], a[112:115], v[216:219]
    v_exp_f32 v157, v157
    v_mfma_f32_16x16x32_bf16 v[212:215], a[244:247], a[104:107], v[212:215]
    ds_read_b128 a[244:247], v226 offset:4224
    v_cvt_pk_bf16_f32 v160, v156, v157
    v_mfma_f32_16x16x32_bf16 v[212:215], a[248:251], a[116:119], v[212:215]
    s_waitcnt lgkmcnt(5)
    ds_read_b128 a[248:251], v226 offset:4288
    v_mfma_f32_16x16x32_bf16 v[220:223], a[236:239], a[120:123], v[220:223]
    s_waitcnt lgkmcnt(5)
    v_exp_f32 v158, v158
    v_mfma_f32_16x16x32_bf16 v[220:223], a[240:243], a[132:135], v[220:223]
    v_exp_f32 v159, v159
    v_mfma_f32_16x16x32_bf16 v[216:219], a[236:239], a[124:127], v[216:219]
    v_cvt_pk_bf16_f32 v161, v158, v159
    v_mfma_f32_16x16x32_bf16 v[216:219], a[240:243], a[136:139], v[216:219]
    ds_read_b128 v[156:159], v230 offset:1920
    v_mfma_f32_16x16x32_bf16 v[196:199], a[216:219], v[160:163], v[196:199]
    v_mfma_f32_16x16x32_bf16 v[212:215], a[236:239], a[128:131], v[212:215]
    ds_read_b128 a[236:239], v226 offset:4352
    v_cvt_pk_bf16_f32 v70, v220, v221
    v_mfma_f32_16x16x32_bf16 v[212:215], a[240:243], a[140:143], v[212:215]
    s_waitcnt lgkmcnt(4)
    ds_read_b128 a[240:243], v226 offset:4416
    v_cvt_pk_bf16_f32 v71, v222, v223
    v_mfma_f32_16x16x32_bf16 v[208:211], v[168:171], v[252:255], v[208:211]
    v_cvt_pk_bf16_f32 v92, v216, v217
    v_cvt_pk_bf16_f32 v93, v218, v219
    v_mfma_f32_16x16x32_bf16 v[184:187], v[70:73], v[160:163], v[184:187]
    v_rcp_f32 v197, v196
    v_mfma_f32_16x16x32_bf16 v[188:191], v[92:95], v[160:163], v[188:191]
    v_cvt_pk_bf16_f32 v114, v212, v213
    v_cvt_pk_bf16_f32 v115, v214, v215
    v_mfma_f32_16x16x32_bf16 v[200:203], v[168:171], v[164:167], v[200:203]
    ds_read_b128 v[168:171], v242 offset:61440
    v_cvt_pk_bf16_f32 v208, v208, v209
    v_mfma_f32_16x16x32_bf16 v[192:195], v[114:117], v[160:163], v[192:195]
    v_cvt_pk_bf16_f32 v209, v210, v211
    v_mul_f32 v184, v184, v197
    v_mfma_f32_16x16x32_bf16 v[204:207], v[248:251], v[252:255], v[204:207]
    v_mul_f32 v185, v185, v197
    v_cvt_pk_bf16_f32 v184, v184, v185
    v_mfma_f32_16x16x32_bf16 v[180:183], v[248:251], v[164:167], v[180:183]
    s_waitcnt lgkmcnt(3)
    ds_read_b128 v[248:251], v242 offset:61952
    v_cvt_pk_bf16_f32 v200, v200, v201
    v_mfma_f32_16x16x32_bf16 v[220:223], a[144:147], a[244:247], 0
    v_cvt_pk_bf16_f32 v201, v202, v203
    v_mul_f32 v186, v186, v197
    v_mfma_f32_16x16x32_bf16 v[220:223], a[156:159], a[248:251], v[220:223]
    v_cvt_pk_bf16_f32 v210, v204, v205
    v_cvt_pk_bf16_f32 v211, v206, v207
    v_mfma_f32_16x16x32_bf16 v[216:219], a[148:151], a[244:247], 0
    buffer_store_dwordx4 v[208:211], v243, s[20:23], s58 offen sc0 sc1
    v_mfma_f32_16x16x32_bf16 v[216:219], a[160:163], a[248:251], v[216:219]
    s_waitcnt lgkmcnt(1)
    v_cvt_pk_bf16_f32 v202, v180, v181
    v_cvt_pk_bf16_f32 v203, v182, v183
    v_mfma_f32_16x16x32_bf16 v[176:179], v[168:171], v[252:255], v[176:179]
    v_mul_f32 v187, v187, v197
    v_cvt_pk_bf16_f32 v185, v186, v187
    v_mfma_f32_16x16x32_bf16 v[212:215], a[152:155], a[244:247], 0
    ds_read_b128 a[244:247], v226 offset:4480
    v_mul_f32 v188, v188, v197
    v_mfma_f32_16x16x32_bf16 v[212:215], a[164:167], a[248:251], v[212:215]
    s_waitcnt lgkmcnt(1)
    ds_read_b128 a[248:251], v226 offset:4544
    v_mul_f32 v189, v189, v197
    v_mfma_f32_16x16x32_bf16 v[172:175], v[248:251], v[252:255], v[172:175]
    v_cvt_pk_bf16_f32 v176, v176, v177
    v_cvt_pk_bf16_f32 v177, v178, v179
    v_mfma_f32_16x16x32_bf16 v[220:223], a[168:171], a[236:239], v[220:223]
    v_cvt_pk_bf16_f32 v186, v188, v189
    v_mul_f32 v190, v190, v197
    v_mfma_f32_16x16x32_bf16 v[220:223], a[180:183], a[240:243], v[220:223]
    v_mul_f32 v191, v191, v197
    v_cvt_pk_bf16_f32 v187, v190, v191
    v_mfma_f32_16x16x32_bf16 v[216:219], a[172:175], a[236:239], v[216:219]
    v_cvt_pk_bf16_f32 v178, v172, v173
    v_cvt_pk_bf16_f32 v179, v174, v175
    v_mfma_f32_16x16x32_bf16 v[216:219], a[184:187], a[240:243], v[216:219]
    v_mul_f32 v192, v192, v197
    v_mul_f32 v193, v193, v197
    v_mfma_f32_16x16x32_bf16 v[212:215], a[176:179], a[236:239], v[212:215]
    ds_read_b128 a[236:239], v225 offset:8896
    v_cvt_pk_bf16_f32 v188, v192, v193
    v_mfma_f32_16x16x32_bf16 v[212:215], a[188:191], a[240:243], v[212:215]
    s_waitcnt lgkmcnt(2)
    ds_read_b128 a[240:243], v225 offset:8960
    v_mul_f32 v194, v194, v197
    v_mfma_f32_16x16x32_bf16 v[220:223], a[192:195], a[244:247], v[220:223]
    s_waitcnt vmcnt(1) lgkmcnt(2)
    buffer_store_dwordx4 v[200:203], v245, s[20:23], s58 offen sc0 sc1
    v_mfma_f32_16x16x32_bf16 v[220:223], a[204:207], a[248:251], v[220:223]
    s_barrier
    v_mul_f32 v195, v195, v197
    v_cvt_pk_bf16_f32 v189, v194, v195
    v_mfma_f32_16x16x32_bf16 v[216:219], a[196:199], a[244:247], v[216:219]
    ds_read_b128 a[252:255], v239 offset:12288
    v_max3_f32 v236, v236, v196, v197
    v_mfma_f32_16x16x32_bf16 v[216:219], a[208:211], a[248:251], v[216:219]
    ds_write_b128 v237, v[184:187]
    v_mfma_f32_16x16x32_bf16 v[212:215], a[200:203], a[244:247], v[212:215]
    v_mul_f32 v220, s37, v220
    v_mul_f32 v221, s37, v221
    v_mfma_f32_16x16x32_bf16 v[212:215], a[212:215], a[248:251], v[212:215]
    s_waitcnt lgkmcnt(3)
    v_mul_f32 v222, s37, v222
    v_mul_f32 v223, s37, v223
    v_cvt_pk_bf16_f32 v138, v220, v221
    v_cvt_pk_bf16_f32 v139, v222, v223
    v_mfma_f32_16x16x32_bf16 v[220:223], a[144:147], a[236:239], 0
    s_waitcnt lgkmcnt(2)
    v_mul_f32 v216, s37, v216
    v_mul_f32 v217, s37, v217
    v_mfma_f32_16x16x32_bf16 v[220:223], a[156:159], a[240:243], v[220:223]
    v_mul_f32 v218, s37, v218
    v_mul_f32 v219, s37, v219
    v_cvt_pk_bf16_f32 v140, v216, v217
    v_cvt_pk_bf16_f32 v141, v218, v219
    v_mfma_f32_16x16x32_bf16 v[216:219], a[148:151], a[236:239], 0
    v_mul_f32 v212, s37, v212
    v_mul_f32 v213, s37, v213
    v_mfma_f32_16x16x32_bf16 v[216:219], a[160:163], a[240:243], v[216:219]
    v_mul_f32 v214, s37, v214
    v_mul_f32 v215, s37, v215
    v_mfma_f32_16x16x32_bf16 v[148:151], v[36:39], v[138:141], v[148:151]
    v_cvt_pk_bf16_f32 v142, v212, v213
    v_cvt_pk_bf16_f32 v143, v214, v215
    v_mfma_f32_16x16x32_bf16 v[152:155], v[42:45], v[138:141], v[152:155]
    ds_read_b128 a[244:247], v225 offset:9024
    ds_read_b128 a[248:251], v225 offset:9088
    v_mfma_f32_16x16x32_bf16 v[156:159], v[24:27], v[138:141], v[156:159]
    buffer_store_dwordx4 v[176:179], v244, s[20:23], s58 offen sc0 sc1
    v_mfma_f32_16x16x16_bf16 v[148:151], v[40:41], v[142:143], v[148:151]
    s_add_u32 s58, s51, 0x54000
    ds_write_b64 v238, v[188:189]
    v_mfma_f32_16x16x16_bf16 v[152:155], v[46:47], v[142:143], v[152:155]
    v_mfma_f32_16x16x32_bf16 v[144:147], v[30:33], v[138:141], v[144:147]
    ds_read_b128 v[252:255], v240 offset:12288
    ds_read_b128 v[164:167], v239 offset:13312
    v_mfma_f32_16x16x16_bf16 v[156:159], v[28:29], v[142:143], v[156:159]
    ds_read_b128 v[168:171], v241 offset:12288
    v_mfma_f32_16x16x32_bf16 v[212:215], a[152:155], a[236:239], 0
    ds_read_b128 a[236:239], v225 offset:9152
    v_mfma_f32_16x16x32_bf16 v[212:215], a[164:167], a[240:243], v[212:215]
    ds_read_b128 a[240:243], v225 offset:9216
    v_mfma_f32_16x16x16_bf16 v[144:147], v[34:35], v[142:143], v[144:147]
    s_waitcnt lgkmcnt(7)
    ds_read_b128 v[248:251], v241 offset:12800
    v_mfma_f32_16x16x32_bf16 v[220:223], a[168:171], a[244:247], v[220:223]
    s_waitcnt lgkmcnt(7)
    v_exp_f32 v148, v148
    v_mfma_f32_16x16x32_bf16 v[220:223], a[180:183], a[248:251], v[220:223]
    v_exp_f32 v149, v149
    v_mfma_f32_16x16x32_bf16 v[216:219], a[172:175], a[244:247], v[216:219]
    v_exp_f32 v150, v150
    v_mfma_f32_16x16x32_bf16 v[216:219], a[184:187], a[248:251], v[216:219]
    buffer_load_dwordx4 v246, s[4:7], s56 offen lds
    v_mfma_f32_16x16x32_bf16 v[212:215], a[176:179], a[244:247], v[212:215]
    s_add_u32 m0, s42, 0xb580
    ds_read_b128 a[244:247], v224 offset:30976
    v_cvt_pk_bf16_f32 v160, v148, v149
    v_mfma_f32_16x16x32_bf16 v[212:215], a[188:191], a[248:251], v[212:215]
    ds_read_b128 a[248:251], v224 offset:31040
    v_mfma_f32_16x16x32_bf16 v[208:211], a[220:223], a[252:255], 0
    s_waitcnt lgkmcnt(4)
    v_exp_f32 v151, v151
    v_mfma_f32_16x16x32_bf16 v[220:223], a[192:195], a[236:239], v[220:223]
    s_waitcnt lgkmcnt(3)
    v_cvt_pk_bf16_f32 v161, v150, v151
    v_mfma_f32_16x16x32_bf16 v[220:223], a[204:207], a[240:243], v[220:223]
    ds_read_b128 v[148:151], v234
    v_bfe_u32 v234, s71, v233, 4
    v_mfma_f32_16x16x32_bf16 v[216:219], a[196:199], a[236:239], v[216:219]
    v_mad_u32_u24 v234, v234, s40, v231
    v_mfma_f32_16x16x32_bf16 v[216:219], a[208:211], a[240:243], v[216:219]
    v_exp_f32 v152, v152
    v_mfma_f32_16x16x32_bf16 v[212:215], a[200:203], a[236:239], v[212:215]
    ds_read_b128 a[236:239], v224 offset:31104
    v_mul_f32 v220, s37, v220
    v_mfma_f32_16x16x32_bf16 v[212:215], a[212:215], a[240:243], v[212:215]
    v_mul_f32 v221, s37, v221
    v_mul_f32 v222, s37, v222
    v_mfma_f32_16x16x32_bf16 v[200:203], a[220:223], v[252:255], 0
    v_mul_f32 v223, s37, v223
    v_cvt_pk_bf16_f32 v132, v220, v221
    v_mfma_f32_16x16x32_bf16 v[204:207], a[224:227], a[252:255], 0
    v_cvt_pk_bf16_f32 v133, v222, v223
    v_mul_f32 v216, s37, v216
    v_mfma_f32_16x16x32_bf16 v[180:183], a[224:227], v[252:255], 0
    v_mul_f32 v217, s37, v217
    v_mul_f32 v218, s37, v218
    v_mfma_f32_16x16x32_bf16 v[176:179], a[228:231], a[252:255], 0
    s_waitcnt lgkmcnt(1)
    v_mul_f32 v219, s37, v219
    v_cvt_pk_bf16_f32 v134, v216, v217
    v_mfma_f32_16x16x32_bf16 v[148:151], v[54:57], v[138:141], v[148:151]
    v_cvt_pk_bf16_f32 v135, v218, v219
    v_mul_f32 v212, s37, v212
    v_mfma_f32_16x16x32_bf16 v[172:175], a[232:235], a[252:255], 0
    v_mul_f32 v213, s37, v213
    v_mul_f32 v214, s37, v214
    v_mfma_f32_16x16x32_bf16 v[220:223], a[0:3], a[244:247], 0
    v_mul_f32 v215, s37, v215
    v_cvt_pk_bf16_f32 v136, v212, v213
    v_mfma_f32_16x16x32_bf16 v[220:223], a[12:15], a[248:251], v[220:223]
    ds_read_b128 a[240:243], v224 offset:31168
    v_cvt_pk_bf16_f32 v137, v214, v215
    v_mfma_f32_16x16x16_bf16 v[148:151], v[58:59], v[142:143], v[148:151]
    buffer_load_dwordx4 v247, s[4:7], s56 offen lds
    v_mfma_f32_16x16x32_bf16 v[216:219], a[4:7], a[244:247], 0
    s_add_u32 s56, s39, 0x276000
    ds_read_b128 a[252:255], v240 offset:13312
    ds_read_b128 v[252:255], v239 offset:14336
    v_mfma_f32_16x16x32_bf16 v[216:219], a[16:19], a[248:251], v[216:219]
    s_add_u32 m0, s41, 0xd3c0
    v_exp_f32 v153, v153
    v_mfma_f32_16x16x32_bf16 v[212:215], a[8:11], a[244:247], 0
    ds_read_b128 a[244:247], v224 offset:31232
    v_cvt_pk_bf16_f32 v162, v152, v153
    v_mfma_f32_16x16x32_bf16 v[212:215], a[20:23], a[248:251], v[212:215]
    s_waitcnt lgkmcnt(4)
    ds_read_b128 a[248:251], v224 offset:31296
    v_mfma_f32_16x16x32_bf16 v[220:223], a[24:27], a[236:239], v[220:223]
    v_exp_f32 v154, v154
    v_mfma_f32_16x16x32_bf16 v[216:219], a[28:31], a[236:239], v[216:219]
    v_exp_f32 v155, v155
    v_mfma_f32_16x16x32_bf16 v[212:215], a[32:35], a[236:239], v[212:215]
    s_waitcnt lgkmcnt(4)
    ds_read_b128 a[236:239], v224 offset:30976
    v_cvt_pk_bf16_f32 v163, v154, v155
    v_mfma_f32_16x16x32_bf16 v[212:215], a[44:47], a[240:243], v[212:215]
    buffer_load_dwordx4 v246, s[4:7], s56 offen lds
    v_mfma_f32_16x16x32_bf16 v[196:199], a[216:219], v[160:163], 0
    s_add_u32 m0, s42, 0xd3c0
    ds_read_b128 v[152:155], v235
    v_bfe_u32 v235, s67, v233, 4
    v_mfma_f32_16x16x32_bf16 v[184:187], v[76:79], v[160:163], 0
    v_mad_u32_u24 v235, v235, s40, v231
    v_mfma_f32_16x16x32_bf16 v[188:191], v[98:101], v[160:163], 0
    v_exp_f32 v156, v156
    v_mfma_f32_16x16x32_bf16 v[192:195], v[120:123], v[160:163], 0
    v_exp_f32 v157, v157
    v_mfma_f32_16x16x32_bf16 v[220:223], a[36:39], a[240:243], v[220:223]
    v_exp_f32 v158, v158
    v_mfma_f32_16x16x32_bf16 v[216:219], a[40:43], a[240:243], v[216:219]
    s_waitcnt lgkmcnt(2)
    ds_read_b128 a[240:243], v224 offset:31040
    v_cvt_pk_bf16_f32 v160, v156, v157
    v_mfma_f32_16x16x32_bf16 v[220:223], a[48:51], a[244:247], v[220:223]
    v_exp_f32 v159, v159
    v_mfma_f32_16x16x32_bf16 v[220:223], a[60:63], a[248:251], v[220:223]
    buffer_load_dwordx4 v247, s[4:7], s56 offen lds
    v_mfma_f32_16x16x32_bf16 v[216:219], a[52:55], a[244:247], v[216:219]
    s_add_u32 s56, s39, 0x2a0000
    v_cvt_pk_bf16_f32 v161, v158, v159
    s_add_u32 m0, s41, 0
    v_mfma_f32_16x16x32_bf16 v[216:219], a[64:67], a[248:251], v[216:219]
    s_waitcnt lgkmcnt(1)
    ds_read_b128 v[156:159], v229 offset:640
    v_mfma_f32_16x16x32_bf16 v[152:155], v[60:63], v[138:141], v[152:155]
    v_cvt_pk_bf16_f32 v12, v220, v221
    v_cvt_pk_bf16_f32 v13, v222, v223
    v_mfma_f32_16x16x32_bf16 v[212:215], a[56:59], a[244:247], v[212:215]
    ds_read_b128 a[244:247], v224 offset:31104
    v_mfma_f32_16x16x32_bf16 v[212:215], a[68:71], a[248:251], v[212:215]
    ds_read_b128 a[248:251], v224 offset:31168
    v_cvt_pk_bf16_f32 v14, v216, v217
    v_mfma_f32_16x16x16_bf16 v[152:155], v[64:65], v[142:143], v[152:155]
    v_cvt_pk_bf16_f32 v15, v218, v219
    v_mfma_f32_16x16x32_bf16 v[208:211], v[168:171], v[164:167], v[208:211]
    v_exp_f32 v144, v144
    v_mfma_f32_16x16x32_bf16 v[200:203], v[168:171], a[252:255], v[200:203]
    ds_read_b128 v[168:171], v242 offset:12288
    v_cvt_pk_bf16_f32 v16, v212, v213
    v_mfma_f32_16x16x32_bf16 v[204:207], v[248:251], v[164:167], v[204:207]
    v_cvt_pk_bf16_f32 v17, v214, v215
    v_mfma_f32_16x16x32_bf16 v[180:183], v[248:251], a[252:255], v[180:183]
    s_waitcnt lgkmcnt(3)
    ds_read_b128 v[248:251], v242 offset:12800
    ds_read_b128 a[252:255], v239 offset:15360
    v_mfma_f32_16x16x32_bf16 v[156:159], v[42:45], v[132:135], v[156:159]
    v_exp_f32 v145, v145
    v_mfma_f32_16x16x32_bf16 v[220:223], a[236:239], a[72:75], 0
    v_exp_f32 v146, v146
    v_mfma_f32_16x16x32_bf16 v[220:223], a[240:243], a[84:87], v[220:223]
    v_exp_f32 v147, v147
    v_mfma_f32_16x16x32_bf16 v[216:219], a[236:239], a[76:79], 0
    v_cvt_pk_bf16_f32 v162, v144, v145
    v_cvt_pk_bf16_f32 v163, v146, v147
    v_mfma_f32_16x16x32_bf16 v[216:219], a[240:243], a[88:91], v[216:219]
    ds_read_b128 v[144:147], v228 offset:640
    v_mfma_f32_16x16x32_bf16 v[196:199], a[216:219], v[160:163], v[196:199]
    v_exp_f32 v148, v148
    v_mfma_f32_16x16x32_bf16 v[184:187], v[68:71], v[160:163], v[184:187]
    v_exp_f32 v149, v149
    v_mfma_f32_16x16x32_bf16 v[188:191], v[90:93], v[160:163], v[188:191]
    v_exp_f32 v150, v150
    v_mfma_f32_16x16x32_bf16 v[192:195], v[112:115], v[160:163], v[192:195]
    v_exp_f32 v151, v151
    v_mfma_f32_16x16x16_bf16 v[156:159], v[46:47], v[136:137], v[156:159]
    s_waitcnt lgkmcnt(2)
    v_cvt_pk_bf16_f32 v160, v148, v149
    v_cvt_pk_bf16_f32 v161, v150, v151
    v_mfma_f32_16x16x32_bf16 v[176:179], v[168:171], v[164:167], v[176:179]
    ds_read_b128 v[168:171], v241 offset:24576
    ds_read_b128 v[148:151], v228 offset:1280
    v_mfma_f32_16x16x32_bf16 v[172:175], v[248:251], v[164:167], v[172:175]
    v_exp_f32 v152, v152
    v_mfma_f32_16x16x32_bf16 v[212:215], a[236:239], a[80:83], 0
    ds_read_b128 a[236:239], v224 offset:31232
    v_mfma_f32_16x16x32_bf16 v[212:215], a[240:243], a[92:95], v[212:215]
    s_waitcnt lgkmcnt(3)
    ds_read_b128 a[240:243], v224 offset:31296
    v_mfma_f32_16x16x32_bf16 v[144:147], v[18:21], v[132:135], v[144:147]
    ds_read_b128 v[164:167], v240 offset:14336
    v_mfma_f32_16x16x32_bf16 v[220:223], a[244:247], a[96:99], v[220:223]
    ds_read_b128 v[248:251], v241 offset:25088
    v_mfma_f32_16x16x32_bf16 v[220:223], a[248:251], a[108:111], v[220:223]
    v_exp_f32 v153, v153
    v_mfma_f32_16x16x32_bf16 v[216:219], a[244:247], a[100:103], v[216:219]
    v_exp_f32 v154, v154
    v_mfma_f32_16x16x32_bf16 v[216:219], a[248:251], a[112:115], v[216:219]
    v_exp_f32 v155, v155
    v_mfma_f32_16x16x16_bf16 v[144:147], v[22:23], v[136:137], v[144:147]
    s_waitcnt lgkmcnt(4)
    v_cvt_pk_bf16_f32 v162, v152, v153
    v_cvt_pk_bf16_f32 v163, v154, v155
    v_mfma_f32_16x16x32_bf16 v[148:151], v[0:3], v[132:135], v[148:151]
    ds_read_b128 v[152:155], v229 offset:1280
    v_mfma_f32_16x16x32_bf16 v[196:199], a[216:219], v[160:163], v[196:199]
    v_exp_f32 v156, v156
    v_mfma_f32_16x16x32_bf16 v[184:187], v[84:87], v[160:163], v[184:187]
    v_exp_f32 v157, v157
    v_mfma_f32_16x16x32_bf16 v[188:191], v[106:109], v[160:163], v[188:191]
    v_exp_f32 v158, v158
    v_mfma_f32_16x16x32_bf16 v[192:195], v[128:131], v[160:163], v[192:195]
    v_exp_f32 v159, v159
    v_mfma_f32_16x16x16_bf16 v[148:151], v[4:5], v[136:137], v[148:151]
    v_rcp_f32 v197, v196
    v_mfma_f32_16x16x32_bf16 v[212:215], a[244:247], a[104:107], v[212:215]
    ds_read_b128 a[244:247], v224 offset:34048
    v_mul_f32 v184, v184, v197
    v_mfma_f32_16x16x32_bf16 v[212:215], a[248:251], a[116:119], v[212:215]
    s_waitcnt lgkmcnt(2)
    ds_read_b128 a[248:251], v224 offset:34112
    v_mul_f32 v185, v185, v197
    v_mfma_f32_16x16x32_bf16 v[220:223], a[236:239], a[120:123], v[220:223]
    v_cvt_pk_bf16_f32 v184, v184, v185
    v_mul_f32 v186, v186, v197
    v_mfma_f32_16x16x32_bf16 v[220:223], a[240:243], a[132:135], v[220:223]
    s_waitcnt lgkmcnt(2)
    v_mul_f32 v187, v187, v197
    v_cvt_pk_bf16_f32 v185, v186, v187
    v_mfma_f32_16x16x32_bf16 v[152:155], v[24:27], v[132:135], v[152:155]
    v_mul_f32 v188, v188, v197
    v_mul_f32 v189, v189, v197
    v_mfma_f32_16x16x32_bf16 v[216:219], a[236:239], a[124:127], v[216:219]
    v_cvt_pk_bf16_f32 v186, v188, v189
    v_mul_f32 v190, v190, v197
    v_mfma_f32_16x16x32_bf16 v[216:219], a[240:243], a[136:139], v[216:219]
    v_cvt_pk_bf16_f32 v74, v220, v221
    v_cvt_pk_bf16_f32 v75, v222, v223
    v_mfma_f32_16x16x16_bf16 v[152:155], v[28:29], v[136:137], v[152:155]
    v_mul_f32 v191, v191, v197
    v_cvt_pk_bf16_f32 v187, v190, v191
    v_mfma_f32_16x16x32_bf16 v[212:215], a[236:239], a[128:131], v[212:215]
    ds_read_b128 a[236:239], v224 offset:34176
    v_mul_f32 v192, v192, v197
    v_mfma_f32_16x16x32_bf16 v[212:215], a[240:243], a[140:143], v[212:215]
    v_cvt_pk_bf16_f32 v96, v216, v217
    v_cvt_pk_bf16_f32 v97, v218, v219
    v_mfma_f32_16x16x32_bf16 v[208:211], v[168:171], v[252:255], v[208:211]
    ds_read_b128 a[240:243], v224 offset:34240
    v_mul_f32 v193, v193, v197
    v_mfma_f32_16x16x32_bf16 v[200:203], v[168:171], v[164:167], v[200:203]
    v_cvt_pk_bf16_f32 v188, v192, v193
    v_mul_f32 v194, v194, v197
    v_mfma_f32_16x16x32_bf16 v[204:207], v[248:251], v[252:255], v[204:207]
    v_cvt_pk_bf16_f32 v118, v212, v213
    v_cvt_pk_bf16_f32 v119, v214, v215
    v_mfma_f32_16x16x32_bf16 v[180:183], v[248:251], v[164:167], v[180:183]
    s_waitcnt lgkmcnt(2)
    v_mul_f32 v195, v195, v197
    v_cvt_pk_bf16_f32 v189, v194, v195
    v_mfma_f32_16x16x32_bf16 v[220:223], a[0:3], a[244:247], 0
    ds_read_b128 v[168:171], v242 offset:24576
    v_max3_f32 v236, v236, v196, v197
    v_mfma_f32_16x16x32_bf16 v[220:223], a[12:15], a[248:251], v[220:223]
    ds_write_b128 v237, v[184:187] offset:6144
    v_mfma_f32_16x16x32_bf16 v[216:219], a[4:7], a[244:247], 0
    ds_write_b64 v238, v[188:189] offset:6144
    v_mfma_f32_16x16x32_bf16 v[216:219], a[16:19], a[248:251], v[216:219]
    v_cvt_pk_bf16_f32 v160, v156, v157
    v_cvt_pk_bf16_f32 v161, v158, v159
    v_mfma_f32_16x16x32_bf16 v[212:215], a[8:11], a[244:247], 0
    v_exp_f32 v144, v144
    v_mfma_f32_16x16x32_bf16 v[212:215], a[20:23], a[248:251], v[212:215]
    s_waitcnt lgkmcnt(3)
    v_exp_f32 v145, v145
    v_mfma_f32_16x16x32_bf16 v[220:223], a[24:27], a[236:239], v[220:223]
    ds_read_b128 a[244:247], v224 offset:34304
    ds_read_b128 a[248:251], v224 offset:34368
    v_mfma_f32_16x16x32_bf16 v[220:223], a[36:39], a[240:243], v[220:223]
    s_waitcnt lgkmcnt(4)
    ds_read_b128 v[248:251], v242 offset:25088
    v_cvt_pk_bf16_f32 v162, v144, v145
    v_mfma_f32_16x16x32_bf16 v[176:179], v[168:171], v[252:255], v[176:179]
    ds_read_b128 v[168:171], v241 offset:36864
    v_mfma_f32_16x16x32_bf16 v[216:219], a[28:31], a[236:239], v[216:219]
    ds_read_b128 v[164:167], v239 offset:16384
    v_mfma_f32_16x16x32_bf16 v[216:219], a[40:43], a[240:243], v[216:219]
    ds_read_b128 v[156:159], v229 offset:1920
    v_mfma_f32_16x16x32_bf16 v[212:215], a[32:35], a[236:239], v[212:215]
    v_exp_f32 v146, v146
    v_mfma_f32_16x16x32_bf16 v[212:215], a[44:47], a[240:243], v[212:215]
    s_waitcnt lgkmcnt(5)
    ds_read_b128 a[236:239], v224 offset:34048
    v_exp_f32 v147, v147
    ds_read_b128 a[240:243], v224 offset:34112
    v_cvt_pk_bf16_f32 v163, v146, v147
    ds_read_b128 v[144:147], v228 offset:1920
    v_mfma_f32_16x16x32_bf16 v[220:223], a[48:51], a[244:247], v[220:223]
    s_waitcnt lgkmcnt(7)
    v_exp_f32 v148, v148
    v_mfma_f32_16x16x32_bf16 v[220:223], a[60:63], a[248:251], v[220:223]
    v_exp_f32 v149, v149
    v_mfma_f32_16x16x32_bf16 v[196:199], a[216:219], v[160:163], 0
    v_exp_f32 v150, v150
    v_mfma_f32_16x16x32_bf16 v[184:187], v[78:81], v[160:163], 0
    v_exp_f32 v151, v151
    v_mfma_f32_16x16x32_bf16 v[188:191], v[100:103], v[160:163], 0
    v_exp_f32 v152, v152
    v_mfma_f32_16x16x32_bf16 v[192:195], v[122:125], v[160:163], 0
    s_waitcnt lgkmcnt(3)
    v_cvt_pk_bf16_f32 v36, v220, v221
    v_cvt_pk_bf16_f32 v37, v222, v223
    v_mfma_f32_16x16x32_bf16 v[156:159], v[30:33], v[132:135], v[156:159]
    v_cvt_pk_bf16_f32 v160, v148, v149
    v_cvt_pk_bf16_f32 v161, v150, v151
    v_mfma_f32_16x16x32_bf16 v[172:175], v[248:251], v[252:255], v[172:175]
    ds_read_b128 v[252:255], v240 offset:15360
    ds_read_b128 v[248:251], v241 offset:37376
    v_mfma_f32_16x16x32_bf16 v[216:219], a[52:55], a[244:247], v[216:219]
    ds_read_b128 v[148:151], v228 offset:2560
    v_mfma_f32_16x16x32_bf16 v[216:219], a[64:67], a[248:251], v[216:219]
    v_exp_f32 v153, v153
    v_mfma_f32_16x16x16_bf16 v[156:159], v[34:35], v[136:137], v[156:159]
    s_waitcnt lgkmcnt(3)
    v_exp_f32 v154, v154
    v_mfma_f32_16x16x32_bf16 v[144:147], v[6:9], v[132:135], v[144:147]
    v_exp_f32 v155, v155
    v_mfma_f32_16x16x32_bf16 v[212:215], a[56:59], a[244:247], v[212:215]
    ds_read_b128 a[244:247], v224 offset:34176
    v_cvt_pk_bf16_f32 v162, v152, v153
    v_mfma_f32_16x16x32_bf16 v[212:215], a[68:71], a[248:251], v[212:215]
    v_cvt_pk_bf16_f32 v38, v216, v217
    v_cvt_pk_bf16_f32 v39, v218, v219
    v_mfma_f32_16x16x16_bf16 v[144:147], v[10:11], v[136:137], v[144:147]
    ds_read_b128 a[248:251], v224 offset:34240
    v_cvt_pk_bf16_f32 v163, v154, v155
    v_mfma_f32_16x16x32_bf16 v[208:211], v[168:171], a[252:255], v[208:211]
    ds_read_b128 v[152:155], v229 offset:2560
    v_mfma_f32_16x16x32_bf16 v[196:199], a[216:219], v[160:163], v[196:199]
    v_cvt_pk_bf16_f32 v40, v212, v213
    v_cvt_pk_bf16_f32 v41, v214, v215
    v_mfma_f32_16x16x32_bf16 v[184:187], v[66:69], v[160:163], v[184:187]
    v_exp_f32 v156, v156
    v_mfma_f32_16x16x32_bf16 v[188:191], v[88:91], v[160:163], v[188:191]
    v_exp_f32 v157, v157
    v_mfma_f32_16x16x32_bf16 v[192:195], v[110:113], v[160:163], v[192:195]
    s_waitcnt lgkmcnt(3)
    v_exp_f32 v158, v158
    v_mfma_f32_16x16x32_bf16 v[148:151], v[12:15], v[132:135], v[148:151]
    v_exp_f32 v159, v159
    v_mfma_f32_16x16x32_bf16 v[200:203], v[168:171], v[252:255], v[200:203]
    ds_read_b128 v[168:171], v242 offset:36864
    v_cvt_pk_bf16_f32 v160, v156, v157
    v_mfma_f32_16x16x32_bf16 v[204:207], v[248:251], a[252:255], v[204:207]
    v_cvt_pk_bf16_f32 v161, v158, v159
    v_mfma_f32_16x16x16_bf16 v[148:151], v[16:17], v[136:137], v[148:151]
    s_waitcnt lgkmcnt(1)
    ds_read_b128 v[156:159], v230 offset:2560
    v_mfma_f32_16x16x32_bf16 v[152:155], v[36:39], v[132:135], v[152:155]
L_pg5:
    s_cbranch_execz L_back
    v_exp_f32 v144, v144
    v_mfma_f32_16x16x32_bf16 v[180:183], v[248:251], v[252:255], v[180:183]
    ds_read_b128 v[248:251], v242 offset:37376
    ds_read_b128 v[252:255], v239 offset:17408
    v_mfma_f32_16x16x32_bf16 v[220:223], a[236:239], a[72:75], 0
    v_exp_f32 v145, v145
    v_mfma_f32_16x16x32_bf16 v[220:223], a[240:243], a[84:87], v[220:223]
    v_exp_f32 v146, v146
    v_mfma_f32_16x16x16_bf16 v[152:155], v[40:41], v[136:137], v[152:155]
    v_exp_f32 v147, v147
    v_mfma_f32_16x16x32_bf16 v[216:219], a[236:239], a[76:79], 0
    v_cvt_pk_bf16_f32 v162, v144, v145
    v_cvt_pk_bf16_f32 v163, v146, v147
    v_mfma_f32_16x16x32_bf16 v[216:219], a[240:243], a[88:91], v[216:219]
    ds_read_b128 v[144:147], v230 offset:640
    v_mfma_f32_16x16x32_bf16 v[196:199], a[216:219], v[160:163], v[196:199]
    v_exp_f32 v148, v148
    v_mfma_f32_16x16x32_bf16 v[184:187], v[70:73], v[160:163], v[184:187]
    v_exp_f32 v149, v149
    v_mfma_f32_16x16x32_bf16 v[188:191], v[92:95], v[160:163], v[188:191]
    v_exp_f32 v150, v150
    v_mfma_f32_16x16x32_bf16 v[192:195], v[114:117], v[160:163], v[192:195]
    s_waitcnt lgkmcnt(3)
    v_exp_f32 v151, v151
    v_mfma_f32_16x16x32_bf16 v[176:179], v[168:171], a[252:255], v[176:179]
    s_waitcnt lgkmcnt(2)
    ds_read_b128 v[168:171], v241 offset:49152
    v_cvt_pk_bf16_f32 v160, v148, v149
    v_mfma_f32_16x16x32_bf16 v[172:175], v[248:251], a[252:255], v[172:175]
    ds_read_b128 a[252:255], v240 offset:16384
    ds_read_b128 v[248:251], v241 offset:49664
    v_mfma_f32_16x16x32_bf16 v[212:215], a[236:239], a[80:83], 0
    ds_read_b128 a[236:239], v224 offset:34304
    v_cvt_pk_bf16_f32 v161, v150, v151
    v_mfma_f32_16x16x32_bf16 v[212:215], a[240:243], a[92:95], v[212:215]
    ds_read_b128 a[240:243], v224 offset:34368
    v_mfma_f32_16x16x32_bf16 v[220:223], a[244:247], a[96:99], v[220:223]
    ds_read_b128 v[148:151], v230 offset:1280
    v_mfma_f32_16x16x32_bf16 v[220:223], a[248:251], a[108:111], v[220:223]
    v_exp_f32 v152, v152
    v_mfma_f32_16x16x32_bf16 v[216:219], a[244:247], a[100:103], v[216:219]
    v_exp_f32 v153, v153
    v_mfma_f32_16x16x32_bf16 v[216:219], a[248:251], a[112:115], v[216:219]
    v_exp_f32 v154, v154
    v_mfma_f32_16x16x32_bf16 v[212:215], a[244:247], a[104:107], v[212:215]
    ds_read_b128 a[244:247], v225 offset:11968
    v_cvt_pk_bf16_f32 v162, v152, v153
    v_mfma_f32_16x16x32_bf16 v[212:215], a[248:251], a[116:119], v[212:215]
    s_waitcnt lgkmcnt(6)
    ds_read_b128 a[248:251], v225 offset:12032
    v_mfma_f32_16x16x32_bf16 v[208:211], v[168:171], v[164:167], v[208:211]
    s_waitcnt lgkmcnt(6)
    v_exp_f32 v155, v155
    v_mfma_f32_16x16x32_bf16 v[200:203], v[168:171], a[252:255], v[200:203]
    s_waitcnt lgkmcnt(4)
    ds_read_b128 v[168:171], v242 offset:49152
    v_cvt_pk_bf16_f32 v163, v154, v155
    v_mfma_f32_16x16x32_bf16 v[220:223], a[236:239], a[120:123], v[220:223]
    s_waitcnt lgkmcnt(4)
    ds_read_b128 v[152:155], v230 offset:1920
    v_mfma_f32_16x16x32_bf16 v[220:223], a[240:243], a[132:135], v[220:223]
    v_mfma_f32_16x16x32_bf16 v[196:199], a[216:219], v[160:163], v[196:199]
    v_mfma_f32_16x16x32_bf16 v[216:219], a[236:239], a[124:127], v[216:219]
    v_mfma_f32_16x16x32_bf16 v[216:219], a[240:243], a[136:139], v[216:219]
    v_mfma_f32_16x16x32_bf16 v[212:215], a[236:239], a[128:131], v[212:215]
    ds_read_b128 a[236:239], v225 offset:12096
    v_mfma_f32_16x16x32_bf16 v[212:215], a[240:243], a[140:143], v[212:215]
    ds_read_b128 a[240:243], v225 offset:12160
    v_mfma_f32_16x16x32_bf16 v[204:207], v[248:251], v[164:167], v[204:207]
    v_cvt_pk_bf16_f32 v76, v220, v221
    v_cvt_pk_bf16_f32 v77, v222, v223
    v_mfma_f32_16x16x32_bf16 v[180:183], v[248:251], a[252:255], v[180:183]
    v_cvt_pk_bf16_f32 v98, v216, v217
    v_cvt_pk_bf16_f32 v99, v218, v219
    v_mfma_f32_16x16x32_bf16 v[184:187], v[74:77], v[160:163], v[184:187]
    v_cvt_pk_bf16_f32 v120, v212, v213
    v_cvt_pk_bf16_f32 v121, v214, v215
    v_mfma_f32_16x16x32_bf16 v[188:191], v[96:99], v[160:163], v[188:191]
    ds_read_b128 v[248:251], v242 offset:49664
    v_mfma_f32_16x16x32_bf16 v[192:195], v[118:121], v[160:163], v[192:195]
    s_waitcnt lgkmcnt(3)
    v_rcp_f32 v197, v196
    v_mfma_f32_16x16x32_bf16 v[176:179], v[168:171], v[164:167], v[176:179]
    ds_read_b128 v[168:171], v241 offset:61440
    v_mul_f32 v184, v184, v197
    v_mfma_f32_16x16x32_bf16 v[220:223], a[144:147], a[244:247], 0
    v_mul_f32 v185, v185, v197
    v_cvt_pk_bf16_f32 v184, v184, v185
    v_mfma_f32_16x16x32_bf16 v[220:223], a[156:159], a[248:251], v[220:223]
    v_mul_f32 v186, v186, v197
    v_mul_f32 v187, v187, v197
    v_mfma_f32_16x16x32_bf16 v[216:219], a[148:151], a[244:247], 0
    v_cvt_pk_bf16_f32 v185, v186, v187
    v_mul_f32 v188, v188, v197
    v_mfma_f32_16x16x32_bf16 v[216:219], a[160:163], a[248:251], v[216:219]
    v_mul_f32 v189, v189, v197
    v_cvt_pk_bf16_f32 v186, v188, v189
    v_mfma_f32_16x16x32_bf16 v[212:215], a[152:155], a[244:247], 0
    ds_read_b128 a[244:247], v225 offset:12224
    v_mul_f32 v190, v190, v197
    v_mfma_f32_16x16x32_bf16 v[212:215], a[164:167], a[248:251], v[212:215]
    s_waitcnt lgkmcnt(2)
    ds_read_b128 a[248:251], v225 offset:12288
    v_mul_f32 v191, v191, v197
    v_mfma_f32_16x16x32_bf16 v[172:175], v[248:251], v[164:167], v[172:175]
    ds_read_b128 v[164:167], v240 offset:17408
    ds_read_b128 v[248:251], v241 offset:61952
    v_mfma_f32_16x16x32_bf16 v[220:223], a[168:171], a[236:239], v[220:223]
    v_cvt_pk_bf16_f32 v187, v190, v191
    v_mul_f32 v192, v192, v197
    v_mfma_f32_16x16x32_bf16 v[220:223], a[180:183], a[240:243], v[220:223]
    v_mul_f32 v193, v193, v197
    v_cvt_pk_bf16_f32 v188, v192, v193
    v_mfma_f32_16x16x32_bf16 v[216:219], a[172:175], a[236:239], v[216:219]
    v_mul_f32 v194, v194, v197
    v_mul_f32 v195, v195, v197
    v_mfma_f32_16x16x32_bf16 v[216:219], a[184:187], a[240:243], v[216:219]
    v_cvt_pk_bf16_f32 v189, v194, v195
    v_max3_f32 v236, v236, v196, v197
    v_mfma_f32_16x16x32_bf16 v[212:215], a[176:179], a[236:239], v[212:215]
    v_mfma_f32_16x16x32_bf16 v[212:215], a[188:191], a[240:243], v[212:215]
    s_waitcnt lgkmcnt(3)
    v_mfma_f32_16x16x32_bf16 v[220:223], a[192:195], a[244:247], v[220:223]
    s_waitcnt vmcnt(0) lgkmcnt(1)
    v_mfma_f32_16x16x32_bf16 v[220:223], a[204:207], a[248:251], v[220:223]
    s_barrier
    ds_read_b128 a[236:239], v227 offset:37120
    v_mfma_f32_16x16x32_bf16 v[216:219], a[196:199], a[244:247], v[216:219]
    ds_read_b128 a[240:243], v227 offset:37184
    ds_read_b128 a[252:255], v239
    v_mfma_f32_16x16x32_bf16 v[216:219], a[208:211], a[248:251], v[216:219]
    buffer_load_dwordx4 v246, s[4:7], s56 offen lds
    v_mfma_f32_16x16x32_bf16 v[212:215], a[200:203], a[244:247], v[212:215]
    s_add_u32 m0, s42, 0
    v_mul_f32 v220, s37, v220
    v_mul_f32 v221, s37, v221
    v_mfma_f32_16x16x32_bf16 v[212:215], a[212:215], a[248:251], v[212:215]
    v_mul_f32 v222, s37, v222
    v_mul_f32 v223, s37, v223
    v_mfma_f32_16x16x32_bf16 v[208:211], v[168:171], v[252:255], v[208:211]
    v_cvt_pk_bf16_f32 v138, v220, v221
    v_cvt_pk_bf16_f32 v139, v222, v223
    v_mfma_f32_16x16x32_bf16 v[200:203], v[168:171], v[164:167], v[200:203]
    s_waitcnt lgkmcnt(3)
    v_mul_f32 v216, s37, v216
    v_mul_f32 v217, s37, v217
    v_mfma_f32_16x16x32_bf16 v[204:207], v[248:251], v[252:255], v[204:207]
    v_mul_f32 v218, s37, v218
    v_mul_f32 v219, s37, v219
    v_mfma_f32_16x16x32_bf16 v[180:183], v[248:251], v[164:167], v[180:183]
    s_waitcnt lgkmcnt(2)
    v_cvt_pk_bf16_f32 v140, v216, v217
    v_cvt_pk_bf16_f32 v141, v218, v219
    v_mfma_f32_16x16x32_bf16 v[220:223], a[0:3], a[236:239], 0
    s_waitcnt lgkmcnt(1)
    v_mul_f32 v212, s37, v212
    v_mul_f32 v213, s37, v213
    v_mfma_f32_16x16x32_bf16 v[220:223], a[12:15], a[240:243], v[220:223]
    v_mul_f32 v214, s37, v214
    v_mul_f32 v215, s37, v215
    v_mfma_f32_16x16x32_bf16 v[156:159], v[36:39], v[138:141], v[156:159]
    v_cvt_pk_bf16_f32 v142, v212, v213
    v_cvt_pk_bf16_f32 v143, v214, v215
    v_mfma_f32_16x16x32_bf16 v[144:147], v[42:45], v[138:141], v[144:147]
    ds_read_b128 a[244:247], v227 offset:37248
    ds_read_b128 a[248:251], v227 offset:37312
    v_mfma_f32_16x16x32_bf16 v[148:151], v[24:27], v[138:141], v[148:151]
    ds_read_b128 v[168:171], v242 offset:61440
    v_cvt_pk_bf16_f32 v208, v208, v209
    v_mfma_f32_16x16x16_bf16 v[156:159], v[40:41], v[142:143], v[156:159]
    ds_read_b128 v[248:251], v242 offset:61952
    v_cvt_pk_bf16_f32 v209, v210, v211
    v_mfma_f32_16x16x16_bf16 v[144:147], v[46:47], v[142:143], v[144:147]
    v_cvt_pk_bf16_f32 v210, v204, v205
    v_cvt_pk_bf16_f32 v211, v206, v207
    v_mfma_f32_16x16x16_bf16 v[148:151], v[28:29], v[142:143], v[148:151]
    buffer_store_dwordx4 v[208:211], v243, s[20:23], s58 offen sc0 sc1
    v_mfma_f32_16x16x32_bf16 v[152:155], v[30:33], v[138:141], v[152:155]
    ds_read_b128 v[164:167], v239 offset:1024
    v_cvt_pk_bf16_f32 v200, v200, v201
    v_mfma_f32_16x16x32_bf16 v[216:219], a[4:7], a[236:239], 0
    v_cvt_pk_bf16_f32 v201, v202, v203
    v_cvt_pk_bf16_f32 v202, v180, v181
    v_mfma_f32_16x16x32_bf16 v[216:219], a[16:19], a[240:243], v[216:219]
    v_cvt_pk_bf16_f32 v203, v182, v183
    v_mfma_f32_16x16x16_bf16 v[152:155], v[34:35], v[142:143], v[152:155]
    s_waitcnt lgkmcnt(2)
    ds_write_b128 v237, v[184:187] offset:12288
    v_mfma_f32_16x16x32_bf16 v[176:179], v[168:171], v[252:255], v[176:179]
    s_waitcnt lgkmcnt(2)
    ds_write_b64 v238, v[188:189] offset:12288
    v_mfma_f32_16x16x32_bf16 v[172:175], v[248:251], v[252:255], v[172:175]
    v_exp_f32 v156, v156
    v_mfma_f32_16x16x32_bf16 v[212:215], a[8:11], a[236:239], 0
    v_exp_f32 v157, v157
    v_mfma_f32_16x16x32_bf16 v[212:215], a[20:23], a[240:243], v[212:215]
    v_exp_f32 v158, v158
    v_mfma_f32_16x16x32_bf16 v[220:223], a[24:27], a[244:247], v[220:223]
    ds_read_b128 a[236:239], v227 offset:37376
    ds_read_b128 a[240:243], v227 offset:37440
    v_mfma_f32_16x16x32_bf16 v[220:223], a[36:39], a[248:251], v[220:223]
    ds_read_b128 v[252:255], v240
    v_cvt_pk_bf16_f32 v176, v176, v177
    v_mfma_f32_16x16x32_bf16 v[216:219], a[28:31], a[244:247], v[216:219]
    buffer_store_dwordx4 v[200:203], v245, s[20:23], s58 offen sc0 sc1
    v_mfma_f32_16x16x32_bf16 v[216:219], a[40:43], a[248:251], v[216:219]
    ds_read_b128 v[168:171], v241 offset:12288
    v_cvt_pk_bf16_f32 v177, v178, v179
    v_mfma_f32_16x16x32_bf16 v[212:215], a[32:35], a[244:247], v[212:215]
    ds_read_b128 a[244:247], v227 offset:37120
    v_cvt_pk_bf16_f32 v178, v172, v173
    v_mfma_f32_16x16x32_bf16 v[212:215], a[44:47], a[248:251], v[212:215]
    ds_read_b128 a[248:251], v227 offset:37184
    v_cvt_pk_bf16_f32 v179, v174, v175
    v_mfma_f32_16x16x32_bf16 v[208:211], a[220:223], a[252:255], 0
    ds_read_b128 v[248:251], v241 offset:12800
    v_cvt_pk_bf16_f32 v160, v156, v157
    v_mfma_f32_16x16x32_bf16 v[204:207], a[224:227], a[252:255], 0
    s_waitcnt lgkmcnt(6)
    v_exp_f32 v159, v159
    v_mfma_f32_16x16x32_bf16 v[220:223], a[48:51], a[236:239], v[220:223]
    s_waitcnt lgkmcnt(5)
    v_cvt_pk_bf16_f32 v161, v158, v159
    v_mfma_f32_16x16x32_bf16 v[220:223], a[60:63], a[240:243], v[220:223]
    ds_read_b128 v[156:159], v234
    v_bfe_u32 v234, s72, v233, 4
    v_mfma_f32_16x16x32_bf16 v[216:219], a[52:55], a[236:239], v[216:219]
    v_mad_u32_u24 v234, v234, s40, v231
    v_mfma_f32_16x16x32_bf16 v[216:219], a[64:67], a[240:243], v[216:219]
    v_exp_f32 v144, v144
    v_mfma_f32_16x16x32_bf16 v[212:215], a[56:59], a[236:239], v[212:215]
    ds_read_b128 a[236:239], v227 offset:37248
    v_cvt_pk_bf16_f32 v48, v220, v221
    v_mfma_f32_16x16x32_bf16 v[212:215], a[68:71], a[240:243], v[212:215]
    s_waitcnt lgkmcnt(5)
    ds_read_b128 a[240:243], v227 offset:37312
    v_cvt_pk_bf16_f32 v49, v222, v223
    v_mfma_f32_16x16x32_bf16 v[200:203], a[220:223], v[252:255], 0
    v_cvt_pk_bf16_f32 v50, v216, v217
    v_cvt_pk_bf16_f32 v51, v218, v219
    v_mfma_f32_16x16x32_bf16 v[180:183], a[224:227], v[252:255], 0
    buffer_store_dwordx4 v[176:179], v244, s[20:23], s58 offen sc0 sc1
    v_mfma_f32_16x16x32_bf16 v[172:175], a[232:235], a[252:255], 0
    s_add_u32 s58, s51, 0xa8000
    v_cvt_pk_bf16_f32 v52, v212, v213
    v_cvt_pk_bf16_f32 v53, v214, v215
    v_mfma_f32_16x16x32_bf16 v[176:179], a[228:231], a[252:255], 0
    s_waitcnt lgkmcnt(2)
    ds_read_b128 a[252:255], v240 offset:1024
    ds_read_b128 v[252:255], v239 offset:2048
    v_mfma_f32_16x16x32_bf16 v[156:159], v[54:57], v[138:141], v[156:159]
    v_exp_f32 v145, v145
    v_mfma_f32_16x16x32_bf16 v[220:223], a[244:247], a[72:75], 0
    v_exp_f32 v146, v146
    v_mfma_f32_16x16x32_bf16 v[220:223], a[248:251], a[84:87], v[220:223]
    v_exp_f32 v147, v147
    v_mfma_f32_16x16x32_bf16 v[216:219], a[244:247], a[76:79], 0
    v_cvt_pk_bf16_f32 v162, v144, v145
    v_cvt_pk_bf16_f32 v163, v146, v147
    v_mfma_f32_16x16x32_bf16 v[216:219], a[248:251], a[88:91], v[216:219]
    ds_read_b128 v[144:147], v235
    v_bfe_u32 v235, s69, v233, 4
    v_mfma_f32_16x16x32_bf16 v[196:199], a[216:219], v[160:163], 0
    v_mad_u32_u24 v235, v235, s40, v231
    v_mfma_f32_16x16x32_bf16 v[184:187], v[76:79], v[160:163], 0
    v_exp_f32 v148, v148
    v_mfma_f32_16x16x32_bf16 v[188:191], v[98:101], v[160:163], 0
    v_exp_f32 v149, v149
    v_mfma_f32_16x16x32_bf16 v[192:195], v[120:123], v[160:163], 0
    v_exp_f32 v150, v150
    v_mfma_f32_16x16x16_bf16 v[156:159], v[58:59], v[142:143], v[156:159]
    buffer_load_dwordx4 v247, s[4:7], s56 offen lds
    v_mfma_f32_16x16x32_bf16 v[212:215], a[244:247], a[80:83], 0
    s_add_u32 m0, s41, 0x1e40
    ds_read_b128 a[244:247], v227 offset:37376
    v_cvt_pk_bf16_f32 v160, v148, v149
    v_mfma_f32_16x16x32_bf16 v[212:215], a[248:251], a[92:95], v[212:215]
    s_waitcnt lgkmcnt(2)
    ds_read_b128 a[248:251], v227 offset:37440
    v_mfma_f32_16x16x32_bf16 v[220:223], a[236:239], a[96:99], v[220:223]
    v_exp_f32 v151, v151
    v_mfma_f32_16x16x32_bf16 v[220:223], a[240:243], a[108:111], v[220:223]
    s_waitcnt lgkmcnt(2)
    v_cvt_pk_bf16_f32 v161, v150, v151
    v_mfma_f32_16x16x32_bf16 v[144:147], v[60:63], v[138:141], v[144:147]
    ds_read_b128 v[148:151], v234
    v_bfe_u32 v234, s70, v233, 4
    v_mfma_f32_16x16x32_bf16 v[216:219], a[236:239], a[100:103], v[216:219]
    v_mad_u32_u24 v234, v234, s40, v231
    v_mfma_f32_16x16x32_bf16 v[216:219], a[240:243], a[112:115], v[216:219]
    v_exp_f32 v152, v152
    v_mfma_f32_16x16x16_bf16 v[144:147], v[64:65], v[142:143], v[144:147]
    buffer_load_dwordx4 v246, s[4:7], s46 offen lds
    v_mfma_f32_16x16x32_bf16 v[212:215], a[236:239], a[104:107], v[212:215]
    s_add_u32 m0, s42, 0x1e40
    ds_read_b128 a[236:239], v225 offset:24384
    v_mfma_f32_16x16x32_bf16 v[212:215], a[240:243], a[116:119], v[212:215]
    s_waitcnt lgkmcnt(3)
    ds_read_b128 a[240:243], v225 offset:24448
    v_mfma_f32_16x16x32_bf16 v[220:223], a[244:247], a[120:123], v[220:223]
    s_waitcnt lgkmcnt(3)
    v_exp_f32 v153, v153
    v_mfma_f32_16x16x32_bf16 v[220:223], a[248:251], a[132:135], v[220:223]
    v_exp_f32 v154, v154
    v_mfma_f32_16x16x32_bf16 v[216:219], a[244:247], a[124:127], v[216:219]
    v_exp_f32 v155, v155
    v_mfma_f32_16x16x32_bf16 v[216:219], a[248:251], a[136:139], v[216:219]
    s_waitcnt lgkmcnt(2)
    v_cvt_pk_bf16_f32 v162, v152, v153
    v_cvt_pk_bf16_f32 v163, v154, v155
    v_mfma_f32_16x16x32_bf16 v[148:151], v[48:51], v[138:141], v[148:151]
    ds_read_b128 v[152:155], v228 offset:640
    v_cvt_pk_bf16_f32 v82, v220, v221
    v_mfma_f32_16x16x32_bf16 v[196:199], a[216:219], v[160:163], v[196:199]
    v_cvt_pk_bf16_f32 v83, v222, v223
    v_mfma_f32_16x16x32_bf16 v[184:187], v[68:71], v[160:163], v[184:187]
    v_cvt_pk_bf16_f32 v104, v216, v217
    v_cvt_pk_bf16_f32 v105, v218, v219
    v_mfma_f32_16x16x32_bf16 v[188:191], v[90:93], v[160:163], v[188:191]
    buffer_load_dwordx4 v247, s[4:7], s46 offen lds
    v_mfma_f32_16x16x32_bf16 v[192:195], v[112:115], v[160:163], v[192:195]
    s_add_u32 m0, s41, 0x3c80
    v_exp_f32 v156, v156
    v_mfma_f32_16x16x16_bf16 v[148:151], v[52:53], v[142:143], v[148:151]
    v_exp_f32 v157, v157
    v_mfma_f32_16x16x32_bf16 v[212:215], a[244:247], a[128:131], v[212:215]
    ds_read_b128 a[244:247], v225 offset:24512
    v_cvt_pk_bf16_f32 v160, v156, v157
    v_mfma_f32_16x16x32_bf16 v[212:215], a[248:251], a[140:143], v[212:215]
    s_waitcnt lgkmcnt(2)
    ds_read_b128 a[248:251], v225 offset:24576
    v_mfma_f32_16x16x32_bf16 v[220:223], a[144:147], a[236:239], 0
    v_exp_f32 v158, v158
    v_mfma_f32_16x16x32_bf16 v[220:223], a[156:159], a[240:243], v[220:223]
    v_exp_f32 v159, v159
    v_mfma_f32_16x16x32_bf16 v[216:219], a[148:151], a[236:239], 0
    v_cvt_pk_bf16_f32 v161, v158, v159
    v_mfma_f32_16x16x32_bf16 v[216:219], a[160:163], a[240:243], v[216:219]
    v_cvt_pk_bf16_f32 v126, v212, v213
    v_cvt_pk_bf16_f32 v127, v214, v215
    v_mfma_f32_16x16x32_bf16 v[212:215], a[152:155], a[236:239], 0
    ds_read_b128 a[236:239], v225 offset:24640
    ds_read_b128 v[156:159], v229 offset:640
    v_mfma_f32_16x16x32_bf16 v[212:215], a[164:167], a[240:243], v[212:215]
    v_exp_f32 v144, v144
    v_mfma_f32_16x16x32_bf16 v[208:211], v[168:171], v[164:167], v[208:211]
    s_waitcnt lgkmcnt(3)
    ds_read_b128 a[240:243], v225 offset:24704
    v_mfma_f32_16x16x32_bf16 v[220:223], a[168:171], a[244:247], v[220:223]
    s_waitcnt lgkmcnt(3)
    v_exp_f32 v145, v145
    v_mfma_f32_16x16x32_bf16 v[220:223], a[180:183], a[248:251], v[220:223]
    v_exp_f32 v146, v146
    v_mfma_f32_16x16x32_bf16 v[216:219], a[172:175], a[244:247], v[216:219]
    v_exp_f32 v147, v147
    v_mfma_f32_16x16x32_bf16 v[216:219], a[184:187], a[248:251], v[216:219]
    v_cvt_pk_bf16_f32 v162, v144, v145
    v_cvt_pk_bf16_f32 v163, v146, v147
    v_mfma_f32_16x16x32_bf16 v[212:215], a[176:179], a[244:247], v[212:215]
    ds_read_b128 a[244:247], v224 offset:46464
    ds_read_b128 v[144:147], v229 offset:1280
    v_mfma_f32_16x16x32_bf16 v[212:215], a[188:191], a[248:251], v[212:215]
    v_exp_f32 v148, v148
    v_mfma_f32_16x16x32_bf16 v[196:199], a[216:219], v[160:163], v[196:199]
    ds_read_b128 a[248:251], v224 offset:46528
    v_mfma_f32_16x16x32_bf16 v[184:187], v[84:87], v[160:163], v[184:187]
    v_exp_f32 v149, v149
    v_mfma_f32_16x16x32_bf16 v[188:191], v[106:109], v[160:163], v[188:191]
    v_exp_f32 v150, v150
    v_mfma_f32_16x16x32_bf16 v[192:195], v[128:131], v[160:163], v[192:195]
    s_waitcnt lgkmcnt(3)
    v_exp_f32 v151, v151
    v_mfma_f32_16x16x32_bf16 v[220:223], a[192:195], a[236:239], v[220:223]
    v_cvt_pk_bf16_f32 v160, v148, v149
    v_cvt_pk_bf16_f32 v161, v150, v151
    v_mfma_f32_16x16x32_bf16 v[220:223], a[204:207], a[240:243], v[220:223]
    ds_read_b128 v[148:151], v228 offset:1280
    v_mfma_f32_16x16x16_bf16 v[196:199], a[216:217], v[160:161], v[196:199]
    v_mfma_f32_16x16x16_bf16 v[184:187], v[82:83], v[160:161], v[184:187]
    v_mfma_f32_16x16x16_bf16 v[188:191], v[104:105], v[160:161], v[188:191]
    v_mfma_f32_16x16x16_bf16 v[192:195], v[126:127], v[160:161], v[192:195]
    v_mfma_f32_16x16x32_bf16 v[216:219], a[196:199], a[236:239], v[216:219]
    v_mfma_f32_16x16x32_bf16 v[216:219], a[208:211], a[240:243], v[216:219]
    v_mfma_f32_16x16x32_bf16 v[212:215], a[200:203], a[236:239], v[212:215]
    v_mul_f32 v220, s37, v220
    v_mul_f32 v221, s37, v221
    v_mfma_f32_16x16x32_bf16 v[212:215], a[212:215], a[240:243], v[212:215]
    v_mul_f32 v222, s37, v222
    v_mul_f32 v223, s37, v223
    v_mfma_f32_16x16x32_bf16 v[200:203], v[168:171], a[252:255], v[200:203]
    v_cvt_pk_bf16_f32 v132, v220, v221
    v_cvt_pk_bf16_f32 v133, v222, v223
    v_mfma_f32_16x16x32_bf16 v[204:207], v[248:251], v[164:167], v[204:207]
    v_mul_f32 v216, s37, v216
    v_mul_f32 v217, s37, v217
    v_mfma_f32_16x16x32_bf16 v[180:183], v[248:251], a[252:255], v[180:183]
    s_waitcnt lgkmcnt(0)
    v_mul_f32 v218, s37, v218
    v_mul_f32 v219, s37, v219
    v_mfma_f32_16x16x32_bf16 v[220:223], a[0:3], a[244:247], 0
    v_cvt_pk_bf16_f32 v134, v216, v217
    v_cvt_pk_bf16_f32 v135, v218, v219
    v_mfma_f32_16x16x32_bf16 v[220:223], a[12:15], a[248:251], v[220:223]
    v_mul_f32 v212, s37, v212
    v_mul_f32 v213, s37, v213
    v_mfma_f32_16x16x32_bf16 v[152:155], v[0:3], v[132:135], v[152:155]
    v_mul_f32 v214, s37, v214
    v_mul_f32 v215, s37, v215
    v_mfma_f32_16x16x32_bf16 v[156:159], v[24:27], v[132:135], v[156:159]
    v_cvt_pk_bf16_f32 v136, v212, v213
    v_cvt_pk_bf16_f32 v137, v214, v215
    v_mfma_f32_16x16x32_bf16 v[144:147], v[30:33], v[132:135], v[144:147]
    ds_read_b128 a[236:239], v224 offset:46592
    ds_read_b128 a[240:243], v224 offset:46656
    v_mfma_f32_16x16x16_bf16 v[152:155], v[4:5], v[136:137], v[152:155]
    v_rcp_f32 v197, v196
    v_mfma_f32_16x16x16_bf16 v[156:159], v[28:29], v[136:137], v[156:159]
    v_mul_f32 v184, v184, v197
    v_mul_f32 v185, v185, v197
    v_mfma_f32_16x16x16_bf16 v[144:147], v[34:35], v[136:137], v[144:147]
    v_cvt_pk_bf16_f32 v184, v184, v185
    v_mul_f32 v186, v186, v197
    v_mfma_f32_16x16x32_bf16 v[148:151], v[6:9], v[132:135], v[148:151]
    v_mul_f32 v187, v187, v197
    v_cvt_pk_bf16_f32 v185, v186, v187
    v_mfma_f32_16x16x32_bf16 v[216:219], a[4:7], a[244:247], 0
    v_mul_f32 v188, v188, v197
    v_mul_f32 v189, v189, v197
    v_mfma_f32_16x16x32_bf16 v[216:219], a[16:19], a[248:251], v[216:219]
    v_cvt_pk_bf16_f32 v186, v188, v189
    v_mul_f32 v190, v190, v197
    v_mfma_f32_16x16x16_bf16 v[148:151], v[10:11], v[136:137], v[148:151]
    v_mul_f32 v191, v191, v197
    v_cvt_pk_bf16_f32 v187, v190, v191
    v_mfma_f32_16x16x32_bf16 v[212:215], a[8:11], a[244:247], 0
    ds_read_b128 a[244:247], v224 offset:46720
    v_mul_f32 v192, v192, v197
    v_mfma_f32_16x16x32_bf16 v[212:215], a[20:23], a[248:251], v[212:215]
    s_waitcnt lgkmcnt(2)
    ds_read_b128 a[248:251], v224 offset:46784
    v_mul_f32 v193, v193, v197
    v_mfma_f32_16x16x32_bf16 v[220:223], a[24:27], a[236:239], v[220:223]
    s_waitcnt lgkmcnt(2)
    v_cvt_pk_bf16_f32 v188, v192, v193
    v_mul_f32 v194, v194, v197
    v_mfma_f32_16x16x32_bf16 v[220:223], a[36:39], a[240:243], v[220:223]
    v_mul_f32 v195, v195, v197
    v_cvt_pk_bf16_f32 v189, v194, v195
    v_mfma_f32_16x16x32_bf16 v[216:219], a[28:31], a[236:239], v[216:219]
    ds_read_b128 v[168:171], v242 offset:12288
    v_max3_f32 v236, v236, v196, v197
    v_mfma_f32_16x16x32_bf16 v[216:219], a[40:43], a[240:243], v[216:219]
    ds_write_b128 v237, v[184:187] offset:18432
    v_mfma_f32_16x16x32_bf16 v[212:215], a[32:35], a[236:239], v[212:215]
    ds_write_b64 v238, v[188:189] offset:18432
    v_mfma_f32_16x16x32_bf16 v[212:215], a[44:47], a[240:243], v[212:215]
    s_waitcnt lgkmcnt(4)
    v_exp_f32 v152, v152
    v_mfma_f32_16x16x32_bf16 v[220:223], a[48:51], a[244:247], v[220:223]
    s_waitcnt lgkmcnt(3)
    v_exp_f32 v153, v153
    v_mfma_f32_16x16x32_bf16 v[220:223], a[60:63], a[248:251], v[220:223]
    v_exp_f32 v154, v154
    v_mfma_f32_16x16x32_bf16 v[216:219], a[52:55], a[244:247], v[216:219]
    ds_read_b128 a[236:239], v224 offset:46464
    ds_read_b128 a[240:243], v224 offset:46528
    v_mfma_f32_16x16x32_bf16 v[216:219], a[64:67], a[248:251], v[216:219]
    s_waitcnt lgkmcnt(4)
    ds_read_b128 v[248:251], v242 offset:12800
    v_cvt_pk_bf16_f32 v160, v152, v153
    v_mfma_f32_16x16x32_bf16 v[176:179], v[168:171], v[164:167], v[176:179]
    v_cvt_pk_bf16_f32 v18, v220, v221
    v_cvt_pk_bf16_f32 v19, v222, v223
    v_mfma_f32_16x16x32_bf16 v[212:215], a[56:59], a[244:247], v[212:215]
    ds_read_b128 a[244:247], v224 offset:46592
    ds_read_b128 v[168:171], v241 offset:24576
    v_mfma_f32_16x16x32_bf16 v[212:215], a[68:71], a[248:251], v[212:215]
    s_waitcnt lgkmcnt(4)
    v_cvt_pk_bf16_f32 v20, v216, v217
    v_cvt_pk_bf16_f32 v21, v218, v219
    ds_read_b128 a[248:251], v224 offset:46656
    ds_read_b128 a[252:255], v239 offset:3072
    v_exp_f32 v155, v155
    v_exp_f32 v156, v156
    v_cvt_pk_bf16_f32 v161, v154, v155
    ds_read_b128 v[152:155], v228 offset:1920
    v_cvt_pk_bf16_f32 v22, v212, v213
    v_cvt_pk_bf16_f32 v23, v214, v215
    v_mfma_f32_16x16x32_bf16 v[220:223], a[236:239], a[72:75], 0
    s_waitcnt lgkmcnt(6)
    v_exp_f32 v157, v157
    v_mfma_f32_16x16x32_bf16 v[220:223], a[240:243], a[84:87], v[220:223]
    s_waitcnt lgkmcnt(5)
    v_exp_f32 v158, v158
    v_mfma_f32_16x16x32_bf16 v[172:175], v[248:251], v[164:167], v[172:175]
    ds_read_b128 v[164:167], v240 offset:2048
    ds_read_b128 v[248:251], v241 offset:25088
    v_mfma_f32_16x16x32_bf16 v[216:219], a[236:239], a[76:79], 0
    v_exp_f32 v159, v159
    v_mfma_f32_16x16x32_bf16 v[216:219], a[240:243], a[88:91], v[216:219]
    s_waitcnt lgkmcnt(5)
    v_cvt_pk_bf16_f32 v162, v156, v157
    v_cvt_pk_bf16_f32 v163, v158, v159
    v_mfma_f32_16x16x32_bf16 v[208:211], v[168:171], v[252:255], v[208:211]
    ds_read_b128 v[156:159], v229 offset:1920
    v_mfma_f32_16x16x32_bf16 v[196:199], a[216:219], v[160:163], 0
    v_exp_f32 v144, v144
    v_mfma_f32_16x16x32_bf16 v[184:187], v[66:69], v[160:163], 0
    v_exp_f32 v145, v145
    v_mfma_f32_16x16x32_bf16 v[188:191], v[88:91], v[160:163], 0
    v_exp_f32 v146, v146
    v_mfma_f32_16x16x32_bf16 v[192:195], v[110:113], v[160:163], 0
    s_waitcnt lgkmcnt(3)
    v_exp_f32 v147, v147
    v_mfma_f32_16x16x32_bf16 v[152:155], v[12:15], v[132:135], v[152:155]
    s_waitcnt lgkmcnt(2)
    v_cvt_pk_bf16_f32 v160, v144, v145
    v_cvt_pk_bf16_f32 v161, v146, v147
    v_mfma_f32_16x16x32_bf16 v[200:203], v[168:171], v[164:167], v[200:203]
    s_waitcnt lgkmcnt(1)
    ds_read_b128 v[168:171], v242 offset:24576
    ds_read_b128 v[144:147], v229 offset:2560
    v_mfma_f32_16x16x32_bf16 v[204:207], v[248:251], v[252:255], v[204:207]
    v_exp_f32 v148, v148
    v_mfma_f32_16x16x16_bf16 v[152:155], v[16:17], v[136:137], v[152:155]
    s_waitcnt lgkmcnt(2)
    v_exp_f32 v149, v149
    v_mfma_f32_16x16x32_bf16 v[156:159], v[36:39], v[132:135], v[156:159]
    v_exp_f32 v150, v150
    v_mfma_f32_16x16x32_bf16 v[180:183], v[248:251], v[164:167], v[180:183]
    ds_read_b128 v[248:251], v242 offset:25088
    ds_read_b128 v[164:167], v239 offset:4096
    v_mfma_f32_16x16x32_bf16 v[212:215], a[236:239], a[80:83], 0
    ds_read_b128 a[236:239], v224 offset:46720
    v_cvt_pk_bf16_f32 v162, v148, v149
    v_mfma_f32_16x16x32_bf16 v[212:215], a[240:243], a[92:95], v[212:215]
    ds_read_b128 a[240:243], v224 offset:46784
    v_mfma_f32_16x16x16_bf16 v[156:159], v[40:41], v[136:137], v[156:159]
    v_exp_f32 v151, v151
    v_mfma_f32_16x16x32_bf16 v[220:223], a[244:247], a[96:99], v[220:223]
    v_cvt_pk_bf16_f32 v163, v150, v151
    v_mfma_f32_16x16x32_bf16 v[220:223], a[248:251], a[108:111], v[220:223]
    ds_read_b128 v[148:151], v228 offset:2560
    v_mfma_f32_16x16x32_bf16 v[196:199], a[216:219], v[160:163], v[196:199]
    v_exp_f32 v152, v152
    v_mfma_f32_16x16x32_bf16 v[184:187], v[70:73], v[160:163], v[184:187]
    v_exp_f32 v153, v153
    v_mfma_f32_16x16x32_bf16 v[188:191], v[92:95], v[160:163], v[188:191]
    v_exp_f32 v154, v154
    v_mfma_f32_16x16x32_bf16 v[192:195], v[114:117], v[160:163], v[192:195]
    s_waitcnt lgkmcnt(5)
    v_exp_f32 v155, v155
    v_mfma_f32_16x16x32_bf16 v[176:179], v[168:171], v[252:255], v[176:179]
    s_waitcnt lgkmcnt(4)
    ds_read_b128 v[168:171], v241 offset:36864
    v_cvt_pk_bf16_f32 v160, v152, v153
    v_mfma_f32_16x16x32_bf16 v[172:175], v[248:251], v[252:255], v[172:175]
    ds_read_b128 v[252:255], v240 offset:3072
    ds_read_b128 v[248:251], v241 offset:37376
    v_mfma_f32_16x16x32_bf16 v[216:219], a[244:247], a[100:103], v[216:219]
    v_cvt_pk_bf16_f32 v161, v154, v155
    v_mfma_f32_16x16x32_bf16 v[216:219], a[248:251], a[112:115], v[216:219]
    s_waitcnt lgkmcnt(3)
    ds_read_b128 v[152:155], v230 offset:640
    v_mfma_f32_16x16x32_bf16 v[148:151], v[18:21], v[132:135], v[148:151]
    v_exp_f32 v156, v156
    v_mfma_f32_16x16x32_bf16 v[212:215], a[244:247], a[104:107], v[212:215]
    ds_read_b128 a[244:247], v224 offset:49536
    v_mfma_f32_16x16x32_bf16 v[212:215], a[248:251], a[116:119], v[212:215]
    ds_read_b128 a[248:251], v224 offset:49600
    v_mfma_f32_16x16x32_bf16 v[220:223], a[236:239], a[120:123], v[220:223]
    v_exp_f32 v157, v157
    v_mfma_f32_16x16x32_bf16 v[220:223], a[240:243], a[132:135], v[220:223]
    v_exp_f32 v158, v158
    v_mfma_f32_16x16x16_bf16 v[148:151], v[22:23], v[136:137], v[148:151]
    v_exp_f32 v159, v159
    v_mfma_f32_16x16x32_bf16 v[216:219], a[236:239], a[124:127], v[216:219]
    v_cvt_pk_bf16_f32 v162, v156, v157
    v_cvt_pk_bf16_f32 v163, v158, v159
    v_mfma_f32_16x16x32_bf16 v[216:219], a[240:243], a[136:139], v[216:219]
    ds_read_b128 v[156:159], v230 offset:1280
    v_cvt_pk_bf16_f32 v80, v220, v221
    v_mfma_f32_16x16x32_bf16 v[196:199], a[216:219], v[160:163], v[196:199]
    v_cvt_pk_bf16_f32 v81, v222, v223
    v_mfma_f32_16x16x32_bf16 v[184:187], v[74:77], v[160:163], v[184:187]
    v_exp_f32 v148, v148
    v_mfma_f32_16x16x32_bf16 v[188:191], v[96:99], v[160:163], v[188:191]
    v_exp_f32 v149, v149
    v_mfma_f32_16x16x32_bf16 v[192:195], v[118:121], v[160:163], v[192:195]
    v_cvt_pk_bf16_f32 v102, v216, v217
    v_cvt_pk_bf16_f32 v103, v218, v219
    v_mfma_f32_16x16x32_bf16 v[212:215], a[236:239], a[128:131], v[212:215]
    ds_read_b128 a[236:239], v224 offset:49664
    v_cvt_pk_bf16_f32 v162, v148, v149
    v_mfma_f32_16x16x32_bf16 v[212:215], a[240:243], a[140:143], v[212:215]
    s_waitcnt lgkmcnt(2)
    ds_read_b128 a[240:243], v224 offset:49728
    v_mfma_f32_16x16x32_bf16 v[208:211], v[168:171], a[252:255], v[208:211]
L_pg6:
    s_cbranch_execz L_back
    v_exp_f32 v150, v150
    v_mfma_f32_16x16x32_bf16 v[200:203], v[168:171], v[252:255], v[200:203]
    ds_read_b128 v[168:171], v242 offset:36864
    v_mfma_f32_16x16x32_bf16 v[204:207], v[248:251], a[252:255], v[204:207]
    v_exp_f32 v151, v151
    v_mfma_f32_16x16x32_bf16 v[180:183], v[248:251], v[252:255], v[180:183]
    v_cvt_pk_bf16_f32 v124, v212, v213
    v_cvt_pk_bf16_f32 v125, v214, v215
    v_mfma_f32_16x16x32_bf16 v[220:223], a[0:3], a[244:247], 0
    ds_read_b128 v[248:251], v242 offset:37376
    ds_read_b128 v[252:255], v239 offset:5120
    v_mfma_f32_16x16x32_bf16 v[220:223], a[12:15], a[248:251], v[220:223]
    v_cvt_pk_bf16_f32 v163, v150, v151
    v_mfma_f32_16x16x32_bf16 v[216:219], a[4:7], a[244:247], 0
    ds_read_b128 v[148:151], v230 offset:2560
    v_mfma_f32_16x16x32_bf16 v[216:219], a[16:19], a[248:251], v[216:219]
    v_mfma_f32_16x16x32_bf16 v[212:215], a[8:11], a[244:247], 0
    ds_read_b128 a[244:247], v224 offset:49792
    v_mfma_f32_16x16x32_bf16 v[212:215], a[20:23], a[248:251], v[212:215]
    s_waitcnt lgkmcnt(4)
    ds_read_b128 a[248:251], v224 offset:49856
    v_mfma_f32_16x16x32_bf16 v[176:179], v[168:171], a[252:255], v[176:179]
    ds_read_b128 v[168:171], v241 offset:49152
    v_mfma_f32_16x16x32_bf16 v[220:223], a[24:27], a[236:239], v[220:223]
    v_mfma_f32_16x16x32_bf16 v[220:223], a[36:39], a[240:243], v[220:223]
    s_waitcnt lgkmcnt(5)
    v_mfma_f32_16x16x32_bf16 v[172:175], v[248:251], a[252:255], v[172:175]
    ds_read_b128 a[252:255], v240 offset:4096
    ds_read_b128 v[248:251], v241 offset:49664
    v_mfma_f32_16x16x32_bf16 v[216:219], a[28:31], a[236:239], v[216:219]
    v_mfma_f32_16x16x32_bf16 v[216:219], a[40:43], a[240:243], v[216:219]
    v_mfma_f32_16x16x32_bf16 v[212:215], a[32:35], a[236:239], v[212:215]
    ds_read_b128 a[236:239], v224 offset:49536
    v_mfma_f32_16x16x32_bf16 v[212:215], a[44:47], a[240:243], v[212:215]
    s_waitcnt lgkmcnt(5)
    ds_read_b128 a[240:243], v224 offset:49600
    v_mfma_f32_16x16x32_bf16 v[220:223], a[48:51], a[244:247], v[220:223]
    s_waitcnt lgkmcnt(5)
    v_mfma_f32_16x16x32_bf16 v[220:223], a[60:63], a[248:251], v[220:223]
    v_mfma_f32_16x16x32_bf16 v[216:219], a[52:55], a[244:247], v[216:219]
    v_mfma_f32_16x16x32_bf16 v[216:219], a[64:67], a[248:251], v[216:219]
    v_mfma_f32_16x16x32_bf16 v[212:215], a[56:59], a[244:247], v[212:215]
    ds_read_b128 a[244:247], v224 offset:49664
    v_mfma_f32_16x16x32_bf16 v[212:215], a[68:71], a[248:251], v[212:215]
    s_waitcnt lgkmcnt(4)
    ds_read_b128 a[248:251], v224 offset:49728
    v_mfma_f32_16x16x32_bf16 v[208:211], v[168:171], v[164:167], v[208:211]
    v_mfma_f32_16x16x32_bf16 v[200:203], v[168:171], a[252:255], v[200:203]
    s_waitcnt lgkmcnt(4)
    v_cvt_pk_bf16_f32 v42, v220, v221
    v_cvt_pk_bf16_f32 v43, v222, v223
    v_mfma_f32_16x16x32_bf16 v[204:207], v[248:251], v[164:167], v[204:207]
    v_cvt_pk_bf16_f32 v44, v216, v217
    v_cvt_pk_bf16_f32 v45, v218, v219
    v_mfma_f32_16x16x32_bf16 v[180:183], v[248:251], a[252:255], v[180:183]
    v_cvt_pk_bf16_f32 v46, v212, v213
    v_cvt_pk_bf16_f32 v47, v214, v215
    v_mfma_f32_16x16x32_bf16 v[144:147], v[42:45], v[132:135], v[144:147]
    s_waitcnt lgkmcnt(2)
    ds_read_b128 v[168:171], v242 offset:49152
    ds_read_b128 v[248:251], v242 offset:49664
    v_mfma_f32_16x16x32_bf16 v[220:223], a[236:239], a[72:75], 0
    v_mfma_f32_16x16x32_bf16 v[220:223], a[240:243], a[84:87], v[220:223]
    v_mfma_f32_16x16x32_bf16 v[216:219], a[236:239], a[76:79], 0
    v_mfma_f32_16x16x32_bf16 v[216:219], a[240:243], a[88:91], v[216:219]
    v_mfma_f32_16x16x16_bf16 v[144:147], v[46:47], v[136:137], v[144:147]
    v_mfma_f32_16x16x32_bf16 v[212:215], a[236:239], a[80:83], 0
    ds_read_b128 a[236:239], v224 offset:49792
    v_mfma_f32_16x16x32_bf16 v[212:215], a[240:243], a[92:95], v[212:215]
    s_waitcnt lgkmcnt(3)
    ds_read_b128 a[240:243], v224 offset:49856
    v_mfma_f32_16x16x32_bf16 v[220:223], a[244:247], a[96:99], v[220:223]
    v_mfma_f32_16x16x32_bf16 v[220:223], a[248:251], a[108:111], v[220:223]
    s_waitcnt lgkmcnt(3)
    v_mfma_f32_16x16x32_bf16 v[176:179], v[168:171], v[164:167], v[176:179]
    s_waitcnt lgkmcnt(2)
    ds_read_b128 v[168:171], v241 offset:61440
    v_mfma_f32_16x16x32_bf16 v[172:175], v[248:251], v[164:167], v[172:175]
    ds_read_b128 v[164:167], v240 offset:5120
    ds_read_b128 v[248:251], v241 offset:61952
    v_mfma_f32_16x16x32_bf16 v[216:219], a[244:247], a[100:103], v[216:219]
    v_exp_f32 v144, v144
    v_mfma_f32_16x16x32_bf16 v[216:219], a[248:251], a[112:115], v[216:219]
    v_exp_f32 v145, v145
    v_mfma_f32_16x16x32_bf16 v[212:215], a[244:247], a[104:107], v[212:215]
    ds_read_b128 a[244:247], v225 offset:27456
    v_cvt_pk_bf16_f32 v160, v144, v145
    v_mfma_f32_16x16x32_bf16 v[212:215], a[248:251], a[116:119], v[212:215]
    s_waitcnt lgkmcnt(5)
    ds_read_b128 a[248:251], v225 offset:27520
    v_mfma_f32_16x16x32_bf16 v[220:223], a[236:239], a[120:123], v[220:223]
    s_waitcnt lgkmcnt(5)
    v_exp_f32 v146, v146
    v_mfma_f32_16x16x32_bf16 v[220:223], a[240:243], a[132:135], v[220:223]
    v_exp_f32 v147, v147
    v_mfma_f32_16x16x32_bf16 v[216:219], a[236:239], a[124:127], v[216:219]
    v_cvt_pk_bf16_f32 v161, v146, v147
    v_mfma_f32_16x16x32_bf16 v[216:219], a[240:243], a[136:139], v[216:219]
    ds_read_b128 v[144:147], v230 offset:1920
    v_mfma_f32_16x16x32_bf16 v[196:199], a[216:219], v[160:163], v[196:199]
    v_mfma_f32_16x16x32_bf16 v[212:215], a[236:239], a[128:131], v[212:215]
    ds_read_b128 a[236:239], v225 offset:27584
    v_cvt_pk_bf16_f32 v78, v220, v221
    v_mfma_f32_16x16x32_bf16 v[212:215], a[240:243], a[140:143], v[212:215]
    s_waitcnt lgkmcnt(4)
    ds_read_b128 a[240:243], v225 offset:27648
    v_cvt_pk_bf16_f32 v79, v222, v223
    v_mfma_f32_16x16x32_bf16 v[208:211], v[168:171], v[252:255], v[208:211]
    v_cvt_pk_bf16_f32 v100, v216, v217
    v_cvt_pk_bf16_f32 v101, v218, v219
    v_mfma_f32_16x16x32_bf16 v[184:187], v[78:81], v[160:163], v[184:187]
    v_rcp_f32 v197, v196
    v_mfma_f32_16x16x32_bf16 v[188:191], v[100:103], v[160:163], v[188:191]
    v_cvt_pk_bf16_f32 v122, v212, v213
    v_cvt_pk_bf16_f32 v123, v214, v215
    v_mfma_f32_16x16x32_bf16 v[200:203], v[168:171], v[164:167], v[200:203]
    ds_read_b128 v[168:171], v242 offset:61440
    v_cvt_pk_bf16_f32 v208, v208, v209
    v_mfma_f32_16x16x32_bf16 v[192:195], v[122:125], v[160:163], v[192:195]
    v_cvt_pk_bf16_f32 v209, v210, v211
    v_mul_f32 v184, v184, v197
    v_mfma_f32_16x16x32_bf16 v[204:207], v[248:251], v[252:255], v[204:207]
    v_mul_f32 v185, v185, v197
    v_cvt_pk_bf16_f32 v184, v184, v185
    v_mfma_f32_16x16x32_bf16 v[180:183], v[248:251], v[164:167], v[180:183]
    s_waitcnt lgkmcnt(3)
    ds_read_b128 v[248:251], v242 offset:61952
    v_cvt_pk_bf16_f32 v200, v200, v201
    v_mfma_f32_16x16x32_bf16 v[220:223], a[144:147], a[244:247], 0
    v_cvt_pk_bf16_f32 v201, v202, v203
    v_mul_f32 v186, v186, v197
    v_mfma_f32_16x16x32_bf16 v[220:223], a[156:159], a[248:251], v[220:223]
    v_cvt_pk_bf16_f32 v210, v204, v205
    v_cvt_pk_bf16_f32 v211, v206, v207
    v_mfma_f32_16x16x32_bf16 v[216:219], a[148:151], a[244:247], 0
    buffer_store_dwordx4 v[208:211], v243, s[20:23], s58 offen sc0 sc1
    v_mfma_f32_16x16x32_bf16 v[216:219], a[160:163], a[248:251], v[216:219]
    s_waitcnt lgkmcnt(1)
    v_cvt_pk_bf16_f32 v202, v180, v181
    v_cvt_pk_bf16_f32 v203, v182, v183
    v_mfma_f32_16x16x32_bf16 v[176:179], v[168:171], v[252:255], v[176:179]
    v_mul_f32 v187, v187, v197
    v_cvt_pk_bf16_f32 v185, v186, v187
    v_mfma_f32_16x16x32_bf16 v[212:215], a[152:155], a[244:247], 0
    ds_read_b128 a[244:247], v225 offset:27712
    v_mul_f32 v188, v188, v197
    v_mfma_f32_16x16x32_bf16 v[212:215], a[164:167], a[248:251], v[212:215]
    s_waitcnt lgkmcnt(1)
    ds_read_b128 a[248:251], v225 offset:27776
    v_mul_f32 v189, v189, v197
    v_mfma_f32_16x16x32_bf16 v[172:175], v[248:251], v[252:255], v[172:175]
    v_cvt_pk_bf16_f32 v176, v176, v177
    v_cvt_pk_bf16_f32 v177, v178, v179
    v_mfma_f32_16x16x32_bf16 v[220:223], a[168:171], a[236:239], v[220:223]
    v_cvt_pk_bf16_f32 v186, v188, v189
    v_mul_f32 v190, v190, v197
    v_mfma_f32_16x16x32_bf16 v[220:223], a[180:183], a[240:243], v[220:223]
    v_mul_f32 v191, v191, v197
    v_cvt_pk_bf16_f32 v187, v190, v191
    v_mfma_f32_16x16x32_bf16 v[216:219], a[172:175], a[236:239], v[216:219]
    v_cvt_pk_bf16_f32 v178, v172, v173
    v_cvt_pk_bf16_f32 v179, v174, v175
    v_mfma_f32_16x16x32_bf16 v[216:219], a[184:187], a[240:243], v[216:219]
    v_mul_f32 v192, v192, v197
    v_mul_f32 v193, v193, v197
    v_mfma_f32_16x16x32_bf16 v[212:215], a[176:179], a[236:239], v[212:215]
    ds_read_b128 a[236:239], v225 offset:39872
    v_cvt_pk_bf16_f32 v188, v192, v193
    v_mfma_f32_16x16x32_bf16 v[212:215], a[188:191], a[240:243], v[212:215]
    s_waitcnt lgkmcnt(2)
    ds_read_b128 a[240:243], v225 offset:39936
    v_mul_f32 v194, v194, v197
    v_mfma_f32_16x16x32_bf16 v[220:223], a[192:195], a[244:247], v[220:223]
    s_waitcnt vmcnt(1) lgkmcnt(2)
    buffer_store_dwordx4 v[200:203], v245, s[20:23], s58 offen sc0 sc1
    v_mfma_f32_16x16x32_bf16 v[220:223], a[204:207], a[248:251], v[220:223]
    s_barrier
    v_mul_f32 v195, v195, v197
    v_cvt_pk_bf16_f32 v189, v194, v195
    v_mfma_f32_16x16x32_bf16 v[216:219], a[196:199], a[244:247], v[216:219]
    ds_read_b128 a[252:255], v239 offset:12288
    v_max3_f32 v236, v236, v196, v197
    v_mfma_f32_16x16x32_bf16 v[216:219], a[208:211], a[248:251], v[216:219]
    ds_write_b128 v237, v[184:187]
    v_mfma_f32_16x16x32_bf16 v[212:215], a[200:203], a[244:247], v[212:215]
    v_mul_f32 v220, s37, v220
    v_mul_f32 v221, s37, v221
    v_mfma_f32_16x16x32_bf16 v[212:215], a[212:215], a[248:251], v[212:215]
    s_waitcnt lgkmcnt(3)
    v_mul_f32 v222, s37, v222
    v_mul_f32 v223, s37, v223
    v_cvt_pk_bf16_f32 v138, v220, v221
    v_cvt_pk_bf16_f32 v139, v222, v223
    v_mfma_f32_16x16x32_bf16 v[220:223], a[144:147], a[236:239], 0
    s_waitcnt lgkmcnt(2)
    v_mul_f32 v216, s37, v216
    v_mul_f32 v217, s37, v217
    v_mfma_f32_16x16x32_bf16 v[220:223], a[156:159], a[240:243], v[220:223]
    v_mul_f32 v218, s37, v218
    v_mul_f32 v219, s37, v219
    v_cvt_pk_bf16_f32 v140, v216, v217
    v_cvt_pk_bf16_f32 v141, v218, v219
    v_mfma_f32_16x16x32_bf16 v[216:219], a[148:151], a[236:239], 0
    v_mul_f32 v212, s37, v212
    v_mul_f32 v213, s37, v213
    v_mfma_f32_16x16x32_bf16 v[216:219], a[160:163], a[240:243], v[216:219]
    v_mul_f32 v214, s37, v214
    v_mul_f32 v215, s37, v215
    v_mfma_f32_16x16x32_bf16 v[152:155], v[24:27], v[138:141], v[152:155]
    v_cvt_pk_bf16_f32 v142, v212, v213
    v_cvt_pk_bf16_f32 v143, v214, v215
    v_mfma_f32_16x16x32_bf16 v[156:159], v[30:33], v[138:141], v[156:159]
    ds_read_b128 a[244:247], v225 offset:40000
    ds_read_b128 a[248:251], v225 offset:40064
    v_mfma_f32_16x16x32_bf16 v[144:147], v[36:39], v[138:141], v[144:147]
    buffer_store_dwordx4 v[176:179], v244, s[20:23], s58 offen sc0 sc1
    v_mfma_f32_16x16x16_bf16 v[152:155], v[28:29], v[142:143], v[152:155]
    s_add_u32 s58, s51, 0xfc000
    ds_write_b64 v238, v[188:189]
    v_mfma_f32_16x16x16_bf16 v[156:159], v[34:35], v[142:143], v[156:159]
    v_mfma_f32_16x16x32_bf16 v[148:151], v[42:45], v[138:141], v[148:151]
    ds_read_b128 v[252:255], v240 offset:12288
    ds_read_b128 v[164:167], v239 offset:13312
    v_mfma_f32_16x16x16_bf16 v[144:147], v[40:41], v[142:143], v[144:147]
    ds_read_b128 v[168:171], v241 offset:12288
    v_mfma_f32_16x16x32_bf16 v[212:215], a[152:155], a[236:239], 0
    ds_read_b128 a[236:239], v225 offset:40128
    v_mfma_f32_16x16x32_bf16 v[212:215], a[164:167], a[240:243], v[212:215]
    ds_read_b128 a[240:243], v225 offset:40192
    v_mfma_f32_16x16x16_bf16 v[148:151], v[46:47], v[142:143], v[148:151]
    s_waitcnt lgkmcnt(7)
    ds_read_b128 v[248:251], v241 offset:12800
    v_mfma_f32_16x16x32_bf16 v[220:223], a[168:171], a[244:247], v[220:223]
    s_waitcnt lgkmcnt(7)
    v_exp_f32 v152, v152
    v_mfma_f32_16x16x32_bf16 v[220:223], a[180:183], a[248:251], v[220:223]
    v_exp_f32 v153, v153
    v_mfma_f32_16x16x32_bf16 v[216:219], a[172:175], a[244:247], v[216:219]
    v_exp_f32 v154, v154
    v_mfma_f32_16x16x32_bf16 v[216:219], a[184:187], a[248:251], v[216:219]
    buffer_load_dwordx4 v246, s[4:7], s47 offen lds
    v_mfma_f32_16x16x32_bf16 v[212:215], a[176:179], a[244:247], v[212:215]
    s_add_u32 m0, s42, 0x3c80
    ds_read_b128 a[244:247], v224
    v_cvt_pk_bf16_f32 v160, v152, v153
    v_mfma_f32_16x16x32_bf16 v[212:215], a[188:191], a[248:251], v[212:215]
    ds_read_b128 a[248:251], v224 offset:64
    v_mfma_f32_16x16x32_bf16 v[208:211], a[220:223], a[252:255], 0
    s_waitcnt lgkmcnt(4)
    v_exp_f32 v155, v155
    v_mfma_f32_16x16x32_bf16 v[220:223], a[192:195], a[236:239], v[220:223]
    s_waitcnt lgkmcnt(3)
    v_cvt_pk_bf16_f32 v161, v154, v155
    v_mfma_f32_16x16x32_bf16 v[220:223], a[204:207], a[240:243], v[220:223]
    ds_read_b128 v[152:155], v235
    v_bfe_u32 v235, s73, v232, 4
    v_mfma_f32_16x16x32_bf16 v[216:219], a[196:199], a[236:239], v[216:219]
    v_exp_f32 v156, v156
    v_mfma_f32_16x16x32_bf16 v[216:219], a[208:211], a[240:243], v[216:219]
    v_exp_f32 v157, v157
    v_mfma_f32_16x16x32_bf16 v[212:215], a[200:203], a[236:239], v[212:215]
    ds_read_b128 a[236:239], v224 offset:128
    v_mul_f32 v220, s37, v220
    v_mfma_f32_16x16x32_bf16 v[212:215], a[212:215], a[240:243], v[212:215]
    v_mul_f32 v221, s37, v221
    v_mul_f32 v222, s37, v222
    v_mfma_f32_16x16x32_bf16 v[200:203], a[220:223], v[252:255], 0
    v_mul_f32 v223, s37, v223
    v_cvt_pk_bf16_f32 v132, v220, v221
    v_mfma_f32_16x16x32_bf16 v[204:207], a[224:227], a[252:255], 0
    v_cvt_pk_bf16_f32 v133, v222, v223
    v_mul_f32 v216, s37, v216
    v_mfma_f32_16x16x32_bf16 v[180:183], a[224:227], v[252:255], 0
    v_mul_f32 v217, s37, v217
    v_mul_f32 v218, s37, v218
    v_mfma_f32_16x16x32_bf16 v[176:179], a[228:231], a[252:255], 0
    s_waitcnt lgkmcnt(1)
    v_mul_f32 v219, s37, v219
    v_cvt_pk_bf16_f32 v134, v216, v217
    v_mfma_f32_16x16x32_bf16 v[152:155], v[60:63], v[138:141], v[152:155]
    v_cvt_pk_bf16_f32 v135, v218, v219
    v_mul_f32 v212, s37, v212
    v_mfma_f32_16x16x32_bf16 v[172:175], a[232:235], a[252:255], 0
    v_mul_f32 v213, s37, v213
    v_mul_f32 v214, s37, v214
    v_mfma_f32_16x16x32_bf16 v[220:223], a[0:3], a[244:247], 0
    v_mul_f32 v215, s37, v215
    v_cvt_pk_bf16_f32 v136, v212, v213
    v_mfma_f32_16x16x32_bf16 v[220:223], a[12:15], a[248:251], v[220:223]
    ds_read_b128 a[240:243], v224 offset:192
    v_cvt_pk_bf16_f32 v137, v214, v215
    v_mfma_f32_16x16x16_bf16 v[152:155], v[64:65], v[142:143], v[152:155]
    buffer_load_dwordx4 v247, s[4:7], s47 offen lds
    v_mfma_f32_16x16x32_bf16 v[216:219], a[4:7], a[244:247], 0
    s_add_u32 m0, s41, 0x5ac0
    ds_read_b128 a[252:255], v240 offset:13312
    ds_read_b128 v[252:255], v239 offset:14336
    v_mfma_f32_16x16x32_bf16 v[216:219], a[16:19], a[248:251], v[216:219]
    v_exp_f32 v158, v158
    v_mfma_f32_16x16x32_bf16 v[212:215], a[8:11], a[244:247], 0
    ds_read_b128 a[244:247], v224 offset:256
    v_cvt_pk_bf16_f32 v162, v156, v157
    v_mfma_f32_16x16x32_bf16 v[212:215], a[20:23], a[248:251], v[212:215]
    s_waitcnt lgkmcnt(4)
    ds_read_b128 a[248:251], v224 offset:320
    v_mfma_f32_16x16x32_bf16 v[220:223], a[24:27], a[236:239], v[220:223]
    v_exp_f32 v159, v159
    v_mfma_f32_16x16x32_bf16 v[216:219], a[28:31], a[236:239], v[216:219]
    v_cvt_pk_bf16_f32 v163, v158, v159
    v_mfma_f32_16x16x32_bf16 v[212:215], a[32:35], a[236:239], v[212:215]
    s_waitcnt lgkmcnt(4)
    ds_read_b128 a[236:239], v224
    ds_read_b128 v[156:159], v234
    v_mfma_f32_16x16x32_bf16 v[212:215], a[44:47], a[240:243], v[212:215]
    buffer_load_dwordx4 v246, s[4:7], s48 offen lds
    v_mfma_f32_16x16x32_bf16 v[196:199], a[216:219], v[160:163], 0
    s_add_u32 m0, s42, 0x5ac0
    v_mad_u32_u24 v234, v235, s40, v229
    v_mad_u32_u24 v235, v235, s40, v228
    v_mfma_f32_16x16x32_bf16 v[184:187], v[68:71], v[160:163], 0
    v_cndmask_b32 v246, v245, v243, vcc
    v_mfma_f32_16x16x32_bf16 v[188:191], v[90:93], v[160:163], 0
    v_exp_f32 v144, v144
    v_mfma_f32_16x16x32_bf16 v[192:195], v[112:115], v[160:163], 0
    v_exp_f32 v145, v145
    v_mfma_f32_16x16x32_bf16 v[220:223], a[36:39], a[240:243], v[220:223]
    v_exp_f32 v146, v146
    v_mfma_f32_16x16x32_bf16 v[216:219], a[40:43], a[240:243], v[216:219]
    s_waitcnt lgkmcnt(2)
    ds_read_b128 a[240:243], v224 offset:64
    v_cvt_pk_bf16_f32 v160, v144, v145
    v_mfma_f32_16x16x32_bf16 v[220:223], a[48:51], a[244:247], v[220:223]
    v_exp_f32 v147, v147
    v_mfma_f32_16x16x32_bf16 v[220:223], a[60:63], a[248:251], v[220:223]
    s_waitcnt lgkmcnt(1)
    buffer_load_dwordx4 v247, s[4:7], s48 offen lds
    v_mfma_f32_16x16x32_bf16 v[156:159], v[48:51], v[138:141], v[156:159]
    v_bfrev_b32 v247, 1
    v_cvt_pk_bf16_f32 v161, v146, v147
    v_mfma_f32_16x16x32_bf16 v[216:219], a[52:55], a[244:247], v[216:219]
    ds_read_b128 v[144:147], v234
    v_mfma_f32_16x16x32_bf16 v[216:219], a[64:67], a[248:251], v[216:219]
    v_exp_f32 v148, v148
    v_mfma_f32_16x16x16_bf16 v[156:159], v[52:53], v[142:143], v[156:159]
    v_cvt_pk_bf16_f32 v0, v220, v221
    v_cvt_pk_bf16_f32 v1, v222, v223
    v_mfma_f32_16x16x32_bf16 v[212:215], a[56:59], a[244:247], v[212:215]
    ds_read_b128 a[244:247], v224 offset:128
    v_mfma_f32_16x16x32_bf16 v[212:215], a[68:71], a[248:251], v[212:215]
    ds_read_b128 a[248:251], v224 offset:192
    v_cvt_pk_bf16_f32 v2, v216, v217
    v_mfma_f32_16x16x32_bf16 v[208:211], v[168:171], v[164:167], v[208:211]
    v_cvt_pk_bf16_f32 v3, v218, v219
    v_mfma_f32_16x16x32_bf16 v[200:203], v[168:171], a[252:255], v[200:203]
    ds_read_b128 v[168:171], v242 offset:12288
    v_mfma_f32_16x16x32_bf16 v[204:207], v[248:251], v[164:167], v[204:207]
    v_exp_f32 v149, v149
    v_mfma_f32_16x16x32_bf16 v[180:183], v[248:251], a[252:255], v[180:183]
    s_waitcnt lgkmcnt(3)
    v_cvt_pk_bf16_f32 v4, v212, v213
    v_cvt_pk_bf16_f32 v5, v214, v215
    v_mfma_f32_16x16x32_bf16 v[144:147], v[30:33], v[132:135], v[144:147]
    ds_read_b128 v[248:251], v242 offset:12800
    ds_read_b128 a[252:255], v239 offset:15360
    v_mfma_f32_16x16x32_bf16 v[220:223], a[236:239], a[72:75], 0
    v_exp_f32 v150, v150
    v_mfma_f32_16x16x32_bf16 v[220:223], a[240:243], a[84:87], v[220:223]
    v_exp_f32 v151, v151
    v_mfma_f32_16x16x16_bf16 v[144:147], v[34:35], v[136:137], v[144:147]
    v_cvt_pk_bf16_f32 v162, v148, v149
    v_cvt_pk_bf16_f32 v163, v150, v151
    v_mfma_f32_16x16x32_bf16 v[216:219], a[236:239], a[76:79], 0
    ds_read_b128 v[148:151], v235
    v_bfe_u32 v235, s74, v232, 4
    v_mfma_f32_16x16x32_bf16 v[216:219], a[240:243], a[88:91], v[216:219]
    v_mad_u32_u24 v234, v235, s40, v228
    v_mad_u32_u24 v235, v235, s40, v229
    v_mfma_f32_16x16x32_bf16 v[196:199], a[216:219], v[160:163], v[196:199]
    v_exp_f32 v152, v152
    v_mfma_f32_16x16x32_bf16 v[184:187], v[76:79], v[160:163], v[184:187]
    v_exp_f32 v153, v153
    v_mfma_f32_16x16x32_bf16 v[188:191], v[98:101], v[160:163], v[188:191]
    v_exp_f32 v154, v154
    v_mfma_f32_16x16x32_bf16 v[192:195], v[120:123], v[160:163], v[192:195]
    s_waitcnt lgkmcnt(3)
    v_exp_f32 v155, v155
    v_mfma_f32_16x16x32_bf16 v[176:179], v[168:171], v[164:167], v[176:179]
    s_waitcnt lgkmcnt(2)
    ds_read_b128 v[168:171], v241 offset:24576
    v_cvt_pk_bf16_f32 v160, v152, v153
    v_mfma_f32_16x16x32_bf16 v[172:175], v[248:251], v[164:167], v[172:175]
    ds_read_b128 v[164:167], v240 offset:14336
    ds_read_b128 v[248:251], v241 offset:25088
    v_mfma_f32_16x16x32_bf16 v[212:215], a[236:239], a[80:83], 0
    ds_read_b128 a[236:239], v224 offset:256
    v_cvt_pk_bf16_f32 v161, v154, v155
    v_mfma_f32_16x16x32_bf16 v[212:215], a[240:243], a[92:95], v[212:215]
    ds_read_b128 a[240:243], v224 offset:320
    v_mfma_f32_16x16x16_bf16 v[196:199], a[216:217], v[160:161], v[196:199]
    ds_read_b128 v[152:155], v228 offset:1280
    v_mfma_f32_16x16x16_bf16 v[184:187], v[86:87], v[160:161], v[184:187]
    v_exp_f32 v156, v156
    v_mfma_f32_16x16x16_bf16 v[188:191], v[108:109], v[160:161], v[188:191]
    v_exp_f32 v157, v157
    v_mfma_f32_16x16x16_bf16 v[192:195], v[130:131], v[160:161], v[192:195]
    s_waitcnt lgkmcnt(6)
    v_exp_f32 v158, v158
    v_mfma_f32_16x16x32_bf16 v[148:151], v[6:9], v[132:135], v[148:151]
    v_exp_f32 v159, v159
    v_mfma_f32_16x16x32_bf16 v[220:223], a[244:247], a[96:99], v[220:223]
    v_cvt_pk_bf16_f32 v160, v156, v157
    v_cvt_pk_bf16_f32 v161, v158, v159
    v_mfma_f32_16x16x32_bf16 v[220:223], a[248:251], a[108:111], v[220:223]
    ds_read_b128 v[156:159], v229 offset:1280
    v_mfma_f32_16x16x16_bf16 v[196:199], a[216:217], v[160:161], v[196:199]
    v_exp_f32 v144, v144
    v_mfma_f32_16x16x16_bf16 v[184:187], v[82:83], v[160:161], v[184:187]
    v_exp_f32 v145, v145
    v_mfma_f32_16x16x16_bf16 v[188:191], v[104:105], v[160:161], v[188:191]
    v_exp_f32 v146, v146
    v_mfma_f32_16x16x16_bf16 v[192:195], v[126:127], v[160:161], v[192:195]
    v_exp_f32 v147, v147
    v_mfma_f32_16x16x16_bf16 v[148:151], v[10:11], v[136:137], v[148:151]
    s_waitcnt lgkmcnt(1)
    v_rcp_f32 v197, v196
    v_mfma_f32_16x16x32_bf16 v[152:155], v[12:15], v[132:135], v[152:155]
    v_mul_f32 v184, v184, v197
    v_mul_f32 v185, v185, v197
    v_mfma_f32_16x16x32_bf16 v[216:219], a[244:247], a[100:103], v[216:219]
    v_cvt_pk_bf16_f32 v184, v184, v185
    v_mul_f32 v186, v186, v197
    v_mfma_f32_16x16x32_bf16 v[216:219], a[248:251], a[112:115], v[216:219]
    v_mul_f32 v187, v187, v197
    v_cvt_pk_bf16_f32 v185, v186, v187
    v_mfma_f32_16x16x16_bf16 v[152:155], v[16:17], v[136:137], v[152:155]
    s_waitcnt lgkmcnt(0)
    v_mul_f32 v188, v188, v197
    v_mul_f32 v189, v189, v197
    v_mfma_f32_16x16x32_bf16 v[156:159], v[36:39], v[132:135], v[156:159]
    v_cvt_pk_bf16_f32 v186, v188, v189
    v_mul_f32 v190, v190, v197
    v_mfma_f32_16x16x32_bf16 v[212:215], a[244:247], a[104:107], v[212:215]
    ds_read_b128 a[244:247], v224 offset:3072
    v_mul_f32 v191, v191, v197
    v_mfma_f32_16x16x32_bf16 v[212:215], a[248:251], a[116:119], v[212:215]
    ds_read_b128 a[248:251], v224 offset:3136
    v_cvt_pk_bf16_f32 v187, v190, v191
    v_mfma_f32_16x16x16_bf16 v[156:159], v[40:41], v[136:137], v[156:159]
    v_mul_f32 v192, v192, v197
    v_mul_f32 v193, v193, v197
    v_mfma_f32_16x16x32_bf16 v[220:223], a[236:239], a[120:123], v[220:223]
    v_cvt_pk_bf16_f32 v188, v192, v193
    v_mul_f32 v194, v194, v197
    v_mfma_f32_16x16x32_bf16 v[220:223], a[240:243], a[132:135], v[220:223]
    v_mul_f32 v195, v195, v197
    v_cvt_pk_bf16_f32 v189, v194, v195
    v_mfma_f32_16x16x32_bf16 v[216:219], a[236:239], a[124:127], v[216:219]
    v_max3_f32 v236, v236, v196, v197
    v_cvt_pk_bf16_f32 v160, v144, v145
    v_mfma_f32_16x16x32_bf16 v[216:219], a[240:243], a[136:139], v[216:219]
    ds_write_b128 v237, v[184:187] offset:6144
    v_mfma_f32_16x16x32_bf16 v[212:215], a[236:239], a[128:131], v[212:215]
    v_cvt_pk_bf16_f32 v66, v220, v221
    v_cvt_pk_bf16_f32 v67, v222, v223
    v_mfma_f32_16x16x32_bf16 v[212:215], a[240:243], a[140:143], v[212:215]
    ds_write_b64 v238, v[188:189] offset:6144
    v_mfma_f32_16x16x32_bf16 v[208:211], v[168:171], v[252:255], v[208:211]
    v_cvt_pk_bf16_f32 v161, v146, v147
    v_cvt_pk_bf16_f32 v88, v216, v217
    v_mfma_f32_16x16x32_bf16 v[200:203], v[168:171], v[164:167], v[200:203]
    v_cvt_pk_bf16_f32 v89, v218, v219
    v_mfma_f32_16x16x32_bf16 v[204:207], v[248:251], v[252:255], v[204:207]
    ds_read_b128 a[236:239], v224 offset:3200
    v_cvt_pk_bf16_f32 v110, v212, v213
    v_mfma_f32_16x16x32_bf16 v[180:183], v[248:251], v[164:167], v[180:183]
    s_waitcnt lgkmcnt(3)
    ds_read_b128 a[240:243], v224 offset:3264
    v_cvt_pk_bf16_f32 v111, v214, v215
    v_mfma_f32_16x16x32_bf16 v[220:223], a[0:3], a[244:247], 0
    ds_read_b128 v[168:171], v242 offset:24576
    ds_read_b128 v[248:251], v242 offset:25088
    v_mfma_f32_16x16x32_bf16 v[220:223], a[12:15], a[248:251], v[220:223]
    ds_read_b128 v[164:167], v239 offset:16384
    v_mfma_f32_16x16x32_bf16 v[216:219], a[4:7], a[244:247], 0
    ds_read_b128 v[144:147], v229 offset:1920
    v_mfma_f32_16x16x32_bf16 v[216:219], a[16:19], a[248:251], v[216:219]
    v_exp_f32 v148, v148
    v_mfma_f32_16x16x32_bf16 v[212:215], a[8:11], a[244:247], 0
    ds_read_b128 a[244:247], v224 offset:3328
    v_mfma_f32_16x16x32_bf16 v[212:215], a[20:23], a[248:251], v[212:215]
    s_waitcnt lgkmcnt(6)
    ds_read_b128 a[248:251], v224 offset:3392
    v_exp_f32 v149, v149
    v_exp_f32 v150, v150
    v_mfma_f32_16x16x32_bf16 v[220:223], a[24:27], a[236:239], v[220:223]
    s_waitcnt lgkmcnt(6)
    v_exp_f32 v151, v151
    v_mfma_f32_16x16x32_bf16 v[220:223], a[36:39], a[240:243], v[220:223]
    s_waitcnt lgkmcnt(5)
    v_cvt_pk_bf16_f32 v162, v148, v149
    v_cvt_pk_bf16_f32 v163, v150, v151
    v_mfma_f32_16x16x32_bf16 v[176:179], v[168:171], v[252:255], v[176:179]
    ds_read_b128 v[168:171], v241 offset:36864
    ds_read_b128 v[148:151], v228 offset:1920
    v_mfma_f32_16x16x32_bf16 v[196:199], a[216:219], v[160:163], 0
    v_exp_f32 v152, v152
    v_mfma_f32_16x16x32_bf16 v[184:187], v[70:73], v[160:163], 0
    v_exp_f32 v153, v153
    v_mfma_f32_16x16x32_bf16 v[188:191], v[92:95], v[160:163], 0
    v_exp_f32 v154, v154
    v_mfma_f32_16x16x32_bf16 v[192:195], v[114:117], v[160:163], 0
    s_waitcnt lgkmcnt(4)
    v_exp_f32 v155, v155
    v_mfma_f32_16x16x32_bf16 v[144:147], v[42:45], v[132:135], v[144:147]
    v_cvt_pk_bf16_f32 v160, v152, v153
    v_cvt_pk_bf16_f32 v161, v154, v155
    v_mfma_f32_16x16x32_bf16 v[172:175], v[248:251], v[252:255], v[172:175]
    ds_read_b128 v[252:255], v240 offset:15360
    ds_read_b128 v[248:251], v241 offset:37376
    v_mfma_f32_16x16x32_bf16 v[216:219], a[28:31], a[236:239], v[216:219]
    ds_read_b128 v[152:155], v234
    v_bfe_u32 v234, s73, v232, 4
    v_mfma_f32_16x16x32_bf16 v[216:219], a[40:43], a[240:243], v[216:219]
    v_mad_u32_u24 v234, v234, s40, v230
    v_mfma_f32_16x16x16_bf16 v[144:147], v[46:47], v[136:137], v[144:147]
    s_waitcnt lgkmcnt(3)
    v_exp_f32 v156, v156
    v_mfma_f32_16x16x32_bf16 v[148:151], v[18:21], v[132:135], v[148:151]
    v_exp_f32 v157, v157
    v_mfma_f32_16x16x32_bf16 v[212:215], a[32:35], a[236:239], v[212:215]
    ds_read_b128 a[236:239], v224 offset:3072
    v_cvt_pk_bf16_f32 v162, v156, v157
    v_mfma_f32_16x16x32_bf16 v[212:215], a[44:47], a[240:243], v[212:215]
    ds_read_b128 a[240:243], v224 offset:3136
    v_mfma_f32_16x16x16_bf16 v[148:151], v[22:23], v[136:137], v[148:151]
    v_exp_f32 v158, v158
    v_mfma_f32_16x16x32_bf16 v[220:223], a[48:51], a[244:247], v[220:223]
    v_exp_f32 v159, v159
    v_mfma_f32_16x16x32_bf16 v[220:223], a[60:63], a[248:251], v[220:223]
    v_cvt_pk_bf16_f32 v163, v158, v159
    v_mfma_f32_16x16x32_bf16 v[216:219], a[52:55], a[244:247], v[216:219]
    ds_read_b128 v[156:159], v235
    v_bfe_u32 v235, s74, v232, 4
    v_mfma_f32_16x16x32_bf16 v[216:219], a[64:67], a[248:251], v[216:219]
    v_mad_u32_u24 v235, v235, s40, v230
    v_mfma_f32_16x16x32_bf16 v[196:199], a[216:219], v[160:163], v[196:199]
    v_exp_f32 v144, v144
    v_mfma_f32_16x16x32_bf16 v[184:187], v[74:77], v[160:163], v[184:187]
    v_cvt_pk_bf16_f32 v24, v220, v221
    v_cvt_pk_bf16_f32 v25, v222, v223
    v_mfma_f32_16x16x32_bf16 v[188:191], v[96:99], v[160:163], v[188:191]
    v_exp_f32 v145, v145
    v_mfma_f32_16x16x32_bf16 v[192:195], v[118:121], v[160:163], v[192:195]
    s_waitcnt lgkmcnt(2)
    v_cvt_pk_bf16_f32 v26, v216, v217
    v_cvt_pk_bf16_f32 v27, v218, v219
    v_mfma_f32_16x16x32_bf16 v[152:155], v[0:3], v[132:135], v[152:155]
    v_exp_f32 v146, v146
    v_mfma_f32_16x16x32_bf16 v[212:215], a[56:59], a[244:247], v[212:215]
    ds_read_b128 a[244:247], v224 offset:3200
    v_cvt_pk_bf16_f32 v160, v144, v145
    v_mfma_f32_16x16x32_bf16 v[212:215], a[68:71], a[248:251], v[212:215]
    ds_read_b128 a[248:251], v224 offset:3264
    v_mfma_f32_16x16x16_bf16 v[152:155], v[4:5], v[136:137], v[152:155]
    s_waitcnt lgkmcnt(2)
    v_exp_f32 v147, v147
    v_mfma_f32_16x16x32_bf16 v[156:159], v[24:27], v[132:135], v[156:159]
    v_cvt_pk_bf16_f32 v161, v146, v147
    v_mfma_f32_16x16x32_bf16 v[208:211], v[168:171], a[252:255], v[208:211]
    ds_read_b128 v[144:147], v235
    v_bfe_u32 v235, s67, v233, 4
    v_mfma_f32_16x16x32_bf16 v[200:203], v[168:171], v[252:255], v[200:203]
    v_cvt_pk_bf16_f32 v28, v212, v213
    v_cvt_pk_bf16_f32 v29, v214, v215
    v_mfma_f32_16x16x32_bf16 v[204:207], v[248:251], a[252:255], v[204:207]
    ds_read_b128 v[168:171], v242 offset:36864
    v_mad_u32_u24 v235, v235, s40, v231
    v_mfma_f32_16x16x16_bf16 v[156:159], v[28:29], v[136:137], v[156:159]
    v_exp_f32 v148, v148
    v_mfma_f32_16x16x32_bf16 v[180:183], v[248:251], v[252:255], v[180:183]
    ds_read_b128 v[248:251], v242 offset:37376
    ds_read_b128 v[252:255], v239 offset:17408
    v_mfma_f32_16x16x32_bf16 v[220:223], a[236:239], a[72:75], 0
L_pg7:
    s_cbranch_execz L_back
    v_exp_f32 v149, v149
    v_mfma_f32_16x16x32_bf16 v[220:223], a[240:243], a[84:87], v[220:223]
    v_exp_f32 v150, v150
    v_mfma_f32_16x16x32_bf16 v[216:219], a[236:239], a[76:79], 0
    v_exp_f32 v151, v151
    v_mfma_f32_16x16x32_bf16 v[216:219], a[240:243], a[88:91], v[216:219]
    v_cvt_pk_bf16_f32 v162, v148, v149
    v_cvt_pk_bf16_f32 v163, v150, v151
    v_mfma_f32_16x16x32_bf16 v[212:215], a[236:239], a[80:83], 0
    ds_read_b128 a[236:239], v224 offset:3328
    ds_read_b128 v[148:151], v234
    v_mfma_f32_16x16x32_bf16 v[212:215], a[240:243], a[92:95], v[212:215]
    v_bfe_u32 v234, s75, v233, 4
    v_mad_u32_u24 v234, v234, s40, v231
    v_mfma_f32_16x16x32_bf16 v[196:199], a[216:219], v[160:163], v[196:199]
    ds_read_b128 a[240:243], v224 offset:3392
    v_mfma_f32_16x16x32_bf16 v[184:187], v[78:81], v[160:163], v[184:187]
    v_exp_f32 v152, v152
    v_mfma_f32_16x16x32_bf16 v[188:191], v[100:103], v[160:163], v[188:191]
    v_exp_f32 v153, v153
    v_mfma_f32_16x16x32_bf16 v[192:195], v[122:125], v[160:163], v[192:195]
    s_waitcnt lgkmcnt(4)
    v_exp_f32 v154, v154
    v_mfma_f32_16x16x32_bf16 v[176:179], v[168:171], a[252:255], v[176:179]
    ds_read_b128 v[168:171], v241 offset:49152
    v_cvt_pk_bf16_f32 v160, v152, v153
    v_mfma_f32_16x16x32_bf16 v[172:175], v[248:251], a[252:255], v[172:175]
    ds_read_b128 a[252:255], v240 offset:16384
    ds_read_b128 v[248:251], v241 offset:49664
    v_mfma_f32_16x16x32_bf16 v[220:223], a[244:247], a[96:99], v[220:223]
    v_exp_f32 v155, v155
    v_mfma_f32_16x16x32_bf16 v[220:223], a[248:251], a[108:111], v[220:223]
    v_cvt_pk_bf16_f32 v161, v154, v155
    v_mfma_f32_16x16x32_bf16 v[216:219], a[244:247], a[100:103], v[216:219]
    ds_read_b128 v[152:155], v230 offset:1280
    v_mfma_f32_16x16x32_bf16 v[216:219], a[248:251], a[112:115], v[216:219]
    v_exp_f32 v156, v156
    v_mfma_f32_16x16x32_bf16 v[212:215], a[244:247], a[104:107], v[212:215]
    ds_read_b128 a[244:247], v225 offset:42944
    v_mfma_f32_16x16x32_bf16 v[212:215], a[248:251], a[116:119], v[212:215]
    s_waitcnt lgkmcnt(5)
    ds_read_b128 a[248:251], v225 offset:43008
    v_mfma_f32_16x16x32_bf16 v[220:223], a[236:239], a[120:123], v[220:223]
    v_exp_f32 v157, v157
    v_mfma_f32_16x16x32_bf16 v[220:223], a[240:243], a[132:135], v[220:223]
    v_exp_f32 v158, v158
    v_mfma_f32_16x16x32_bf16 v[216:219], a[236:239], a[124:127], v[216:219]
    v_exp_f32 v159, v159
    v_mfma_f32_16x16x32_bf16 v[216:219], a[240:243], a[136:139], v[216:219]
    v_cvt_pk_bf16_f32 v162, v156, v157
    v_cvt_pk_bf16_f32 v163, v158, v159
    v_mfma_f32_16x16x32_bf16 v[212:215], a[236:239], a[128:131], v[212:215]
    ds_read_b128 a[236:239], v225 offset:43072
    v_cvt_pk_bf16_f32 v68, v220, v221
    v_mfma_f32_16x16x32_bf16 v[212:215], a[240:243], a[140:143], v[212:215]
    ds_read_b128 a[240:243], v225 offset:43136
    v_cvt_pk_bf16_f32 v69, v222, v223
    v_mfma_f32_16x16x32_bf16 v[196:199], a[216:219], v[160:163], v[196:199]
    v_cvt_pk_bf16_f32 v90, v216, v217
    v_cvt_pk_bf16_f32 v91, v218, v219
    v_mfma_f32_16x16x32_bf16 v[184:187], v[66:69], v[160:163], v[184:187]
    ds_read_b128 v[156:159], v230 offset:1920
    v_mfma_f32_16x16x32_bf16 v[188:191], v[88:91], v[160:163], v[188:191]
    s_waitcnt lgkmcnt(4)
    v_cvt_pk_bf16_f32 v112, v212, v213
    v_cvt_pk_bf16_f32 v113, v214, v215
    v_mfma_f32_16x16x32_bf16 v[208:211], v[168:171], v[164:167], v[208:211]
    v_rcp_f32 v197, v196
    v_mfma_f32_16x16x32_bf16 v[192:195], v[110:113], v[160:163], v[192:195]
    v_max3_f32 v236, v236, v196, v197
    v_mul_f32 v184, v184, v197
    v_mfma_f32_16x16x32_bf16 v[200:203], v[168:171], a[252:255], v[200:203]
    ds_read_b128 v[168:171], v242 offset:49152
    v_mul_f32 v185, v185, v197
    v_mfma_f32_16x16x32_bf16 v[204:207], v[248:251], v[164:167], v[204:207]
    v_cvt_pk_bf16_f32 v184, v184, v185
    v_mul_f32 v186, v186, v197
    v_mfma_f32_16x16x32_bf16 v[180:183], v[248:251], a[252:255], v[180:183]
    ds_read_b128 v[248:251], v242 offset:49664
    v_mul_f32 v187, v187, v197
    v_mfma_f32_16x16x32_bf16 v[220:223], a[144:147], a[244:247], 0
    s_waitcnt lgkmcnt(4)
    v_cvt_pk_bf16_f32 v185, v186, v187
    v_mul_f32 v188, v188, v197
    v_mfma_f32_16x16x32_bf16 v[220:223], a[156:159], a[248:251], v[220:223]
    v_mul_f32 v189, v189, v197
    v_cvt_pk_bf16_f32 v186, v188, v189
    v_mfma_f32_16x16x32_bf16 v[216:219], a[148:151], a[244:247], 0
    v_mul_f32 v190, v190, v197
    v_mul_f32 v191, v191, v197
    v_mfma_f32_16x16x32_bf16 v[216:219], a[160:163], a[248:251], v[216:219]
    v_cvt_pk_bf16_f32 v187, v190, v191
    v_mul_f32 v192, v192, v197
    v_mfma_f32_16x16x32_bf16 v[212:215], a[152:155], a[244:247], 0
    ds_read_b128 a[244:247], v225 offset:43200
    v_mul_f32 v193, v193, v197
    v_mfma_f32_16x16x32_bf16 v[212:215], a[164:167], a[248:251], v[212:215]
    s_waitcnt lgkmcnt(2)
    ds_read_b128 a[248:251], v225 offset:43264
    v_cvt_pk_bf16_f32 v188, v192, v193
    v_mfma_f32_16x16x32_bf16 v[176:179], v[168:171], v[164:167], v[176:179]
    ds_read_b128 v[168:171], v241 offset:61440
    v_mul_f32 v194, v194, v197
    v_mfma_f32_16x16x32_bf16 v[220:223], a[168:171], a[236:239], v[220:223]
    v_mul_f32 v195, v195, v197
    v_cvt_pk_bf16_f32 v189, v194, v195
    v_mfma_f32_16x16x32_bf16 v[220:223], a[180:183], a[240:243], v[220:223]
    s_waitcnt lgkmcnt(3)
    v_cndmask_b32 v225, v243, v245, vcc
    v_mfma_f32_16x16x32_bf16 v[172:175], v[248:251], v[164:167], v[172:175]
    ds_read_b128 v[164:167], v240 offset:17408
    ds_read_b128 v[248:251], v241 offset:61952
    v_mfma_f32_16x16x32_bf16 v[216:219], a[172:175], a[236:239], v[216:219]
    v_mfma_f32_16x16x32_bf16 v[216:219], a[184:187], a[240:243], v[216:219]
    v_mfma_f32_16x16x32_bf16 v[212:215], a[176:179], a[236:239], v[212:215]
    v_mfma_f32_16x16x32_bf16 v[212:215], a[188:191], a[240:243], v[212:215]
    s_waitcnt lgkmcnt(4)
    v_mfma_f32_16x16x32_bf16 v[220:223], a[192:195], a[244:247], v[220:223]
    s_waitcnt lgkmcnt(3)
    v_mfma_f32_16x16x32_bf16 v[220:223], a[204:207], a[248:251], v[220:223]
    v_mfma_f32_16x16x32_bf16 v[216:219], a[196:199], a[244:247], v[216:219]
    s_waitcnt vmcnt(0) lgkmcnt(1)
    v_mfma_f32_16x16x32_bf16 v[216:219], a[208:211], a[248:251], v[216:219]
    s_barrier
    ds_read_b128 a[236:239], v227 offset:6144
    v_mfma_f32_16x16x32_bf16 v[212:215], a[200:203], a[244:247], v[212:215]
    ds_read_b128 a[240:243], v227 offset:6208
    ds_read_b128 a[244:247], v227 offset:6272
    v_mfma_f32_16x16x32_bf16 v[212:215], a[212:215], a[248:251], v[212:215]
    v_mul_f32 v220, s37, v220
    v_mul_f32 v221, s37, v221
    v_mfma_f32_16x16x32_bf16 v[208:211], v[168:171], v[252:255], v[208:211]
    v_mul_f32 v222, s37, v222
    v_mul_f32 v223, s37, v223
    v_mfma_f32_16x16x32_bf16 v[200:203], v[168:171], v[164:167], v[200:203]
    s_waitcnt lgkmcnt(3)
    v_cvt_pk_bf16_f32 v138, v220, v221
    v_cvt_pk_bf16_f32 v139, v222, v223
    v_mfma_f32_16x16x32_bf16 v[204:207], v[248:251], v[252:255], v[204:207]
    v_mul_f32 v216, s37, v216
    v_mul_f32 v217, s37, v217
    v_mfma_f32_16x16x32_bf16 v[180:183], v[248:251], v[164:167], v[180:183]
    v_mul_f32 v218, s37, v218
    v_mul_f32 v219, s37, v219
    v_cvt_pk_bf16_f32 v140, v216, v217
    v_cvt_pk_bf16_f32 v141, v218, v219
    v_mul_f32 v212, s37, v212
    v_mul_f32 v213, s37, v213
    v_mfma_f32_16x16x32_bf16 v[144:147], v[24:27], v[138:141], v[144:147]
    v_mul_f32 v214, s37, v214
    v_mul_f32 v215, s37, v215
    v_mfma_f32_16x16x32_bf16 v[148:151], v[30:33], v[138:141], v[148:151]
    v_cvt_pk_bf16_f32 v142, v212, v213
    v_cvt_pk_bf16_f32 v143, v214, v215
    v_mfma_f32_16x16x32_bf16 v[152:155], v[36:39], v[138:141], v[152:155]
    ds_read_b128 a[248:251], v227 offset:6336
    ds_read_b128 v[168:171], v242 offset:61440
    v_mfma_f32_16x16x16_bf16 v[144:147], v[28:29], v[142:143], v[144:147]
    ds_read_b128 v[248:251], v242 offset:61952
    v_cvt_pk_bf16_f32 v208, v208, v209
    v_mfma_f32_16x16x16_bf16 v[148:151], v[34:35], v[142:143], v[148:151]
    v_cvt_pk_bf16_f32 v209, v210, v211
    v_cvt_pk_bf16_f32 v210, v204, v205
    v_mfma_f32_16x16x16_bf16 v[152:155], v[40:41], v[142:143], v[152:155]
    v_cvt_pk_bf16_f32 v211, v206, v207
    v_cvt_pk_bf16_f32 v200, v200, v201
    v_mfma_f32_16x16x32_bf16 v[156:159], v[42:45], v[138:141], v[156:159]
    s_waitcnt lgkmcnt(3)
    buffer_store_dwordx4 v[208:211], v243, s[20:23], s58 offen sc0 sc1
    v_mfma_f32_16x16x32_bf16 v[220:223], a[0:3], a[236:239], 0
    ds_read_b128 a[252:255], v239
    v_cvt_pk_bf16_f32 v201, v202, v203
    v_mfma_f32_16x16x32_bf16 v[220:223], a[12:15], a[240:243], v[220:223]
    v_cvt_pk_bf16_f32 v202, v180, v181
    v_cvt_pk_bf16_f32 v203, v182, v183
    v_mfma_f32_16x16x16_bf16 v[156:159], v[46:47], v[142:143], v[156:159]
    s_waitcnt lgkmcnt(2)
    ds_write_b128 v237, v[184:187] offset:12288
    v_mfma_f32_16x16x32_bf16 v[176:179], v[168:171], v[252:255], v[176:179]
    s_waitcnt lgkmcnt(2)
    ds_write_b64 v238, v[188:189] offset:12288
    v_mfma_f32_16x16x32_bf16 v[172:175], v[248:251], v[252:255], v[172:175]
    v_exp_f32 v144, v144
    v_mfma_f32_16x16x32_bf16 v[216:219], a[4:7], a[236:239], 0
    v_exp_f32 v145, v145
    v_mfma_f32_16x16x32_bf16 v[216:219], a[16:19], a[240:243], v[216:219]
    v_exp_f32 v146, v146
    v_mfma_f32_16x16x32_bf16 v[212:215], a[8:11], a[236:239], 0
    ds_read_b128 a[236:239], v227 offset:6400
    v_cvt_pk_bf16_f32 v176, v176, v177
    v_mfma_f32_16x16x32_bf16 v[212:215], a[20:23], a[240:243], v[212:215]
    ds_read_b128 a[240:243], v227 offset:6464
    v_cvt_pk_bf16_f32 v177, v178, v179
    v_mfma_f32_16x16x32_bf16 v[220:223], a[24:27], a[244:247], v[220:223]
    v_cvt_pk_bf16_f32 v178, v172, v173
    v_cvt_pk_bf16_f32 v179, v174, v175
    v_mfma_f32_16x16x32_bf16 v[220:223], a[36:39], a[248:251], v[220:223]
    buffer_store_dwordx4 v[200:203], v245, s[20:23], s58 offen sc0 sc1
    v_mfma_f32_16x16x32_bf16 v[216:219], a[28:31], a[244:247], v[216:219]
    ds_read_b128 v[252:255], v240
    ds_read_b128 v[164:167], v239 offset:1024
    v_mfma_f32_16x16x32_bf16 v[216:219], a[40:43], a[248:251], v[216:219]
    ds_read_b128 v[168:171], v241 offset:12288
    v_cvt_pk_bf16_f32 v160, v144, v145
    v_mfma_f32_16x16x32_bf16 v[212:215], a[32:35], a[244:247], v[212:215]
    ds_read_b128 a[244:247], v227 offset:6144
    v_mfma_f32_16x16x32_bf16 v[212:215], a[44:47], a[248:251], v[212:215]
    s_waitcnt lgkmcnt(5)
    ds_read_b128 a[248:251], v227 offset:6208
    v_mfma_f32_16x16x32_bf16 v[220:223], a[48:51], a[236:239], v[220:223]
    s_waitcnt lgkmcnt(5)
    ds_read_b128 v[248:251], v241 offset:12800
    v_mfma_f32_16x16x32_bf16 v[220:223], a[60:63], a[240:243], v[220:223]
    v_exp_f32 v147, v147
    v_mfma_f32_16x16x32_bf16 v[216:219], a[52:55], a[236:239], v[216:219]
    v_cvt_pk_bf16_f32 v161, v146, v147
    v_mfma_f32_16x16x32_bf16 v[216:219], a[64:67], a[240:243], v[216:219]
    ds_read_b128 v[144:147], v235
    v_bfe_u32 v235, s76, v233, 4
    v_mfma_f32_16x16x32_bf16 v[212:215], a[56:59], a[236:239], v[212:215]
    ds_read_b128 a[236:239], v227 offset:6272
    v_cvt_pk_bf16_f32 v54, v220, v221
    v_mfma_f32_16x16x32_bf16 v[212:215], a[68:71], a[240:243], v[212:215]
    ds_read_b128 a[240:243], v227 offset:6336
    v_cvt_pk_bf16_f32 v55, v222, v223
    v_mfma_f32_16x16x32_bf16 v[208:211], a[220:223], a[252:255], 0
    s_waitcnt lgkmcnt(8)
    v_cvt_pk_bf16_f32 v56, v216, v217
    v_cvt_pk_bf16_f32 v57, v218, v219
    v_mfma_f32_16x16x32_bf16 v[200:203], a[220:223], v[252:255], 0
    buffer_store_dwordx4 v[176:179], v244, s[20:23], s58 offen sc0 sc1
    v_mfma_f32_16x16x32_bf16 v[204:207], a[224:227], a[252:255], 0
    s_add_u32 s58, s51, 0x150000
    v_cvt_pk_bf16_f32 v58, v212, v213
    v_cvt_pk_bf16_f32 v59, v214, v215
    v_mfma_f32_16x16x32_bf16 v[180:183], a[224:227], v[252:255], 0
    ds_read_b128 v[252:255], v239 offset:2048
    v_mad_u32_u24 v235, v235, s40, v231
    v_mfma_f32_16x16x32_bf16 v[176:179], a[228:231], a[252:255], 0
    v_exp_f32 v148, v148
    v_mfma_f32_16x16x32_bf16 v[172:175], a[232:235], a[252:255], 0
    s_waitcnt lgkmcnt(3)
    ds_read_b128 a[252:255], v240 offset:1024
    v_mfma_f32_16x16x32_bf16 v[144:147], v[48:51], v[138:141], v[144:147]
    v_exp_f32 v149, v149
    v_mfma_f32_16x16x32_bf16 v[220:223], a[244:247], a[72:75], 0
    v_exp_f32 v150, v150
    v_mfma_f32_16x16x32_bf16 v[220:223], a[248:251], a[84:87], v[220:223]
    v_exp_f32 v151, v151
    v_mfma_f32_16x16x32_bf16 v[216:219], a[244:247], a[76:79], 0
    v_cvt_pk_bf16_f32 v162, v148, v149
    v_cvt_pk_bf16_f32 v163, v150, v151
    v_mfma_f32_16x16x32_bf16 v[216:219], a[248:251], a[88:91], v[216:219]
    ds_read_b128 v[148:151], v234
    v_bfe_u32 v234, s73, v232, 4
    v_mfma_f32_16x16x32_bf16 v[196:199], a[216:219], v[160:163], 0
    v_exp_f32 v152, v152
    v_mfma_f32_16x16x32_bf16 v[184:187], v[68:71], v[160:163], 0
    v_exp_f32 v153, v153
    v_mfma_f32_16x16x32_bf16 v[188:191], v[90:93], v[160:163], 0
    v_exp_f32 v154, v154
    v_mfma_f32_16x16x32_bf16 v[192:195], v[112:115], v[160:163], 0
    v_exp_f32 v155, v155
    v_mfma_f32_16x16x16_bf16 v[144:147], v[52:53], v[142:143], v[144:147]
    v_cvt_pk_bf16_f32 v160, v152, v153
    v_cvt_pk_bf16_f32 v161, v154, v155
    v_mfma_f32_16x16x32_bf16 v[212:215], a[244:247], a[80:83], 0
    ds_read_b128 a[244:247], v227 offset:6400
    ds_read_b128 v[152:155], v235
    v_mfma_f32_16x16x32_bf16 v[212:215], a[248:251], a[92:95], v[212:215]
    s_waitcnt lgkmcnt(3)
    v_mad_u32_u24 v235, v234, s40, v228
    v_mad_u32_u24 v234, v234, s40, v229
    v_mfma_f32_16x16x32_bf16 v[220:223], a[236:239], a[96:99], v[220:223]
    ds_read_b128 a[248:251], v227 offset:6464
    v_cndmask_b32 v227, v240, v239, vcc
    v_mfma_f32_16x16x32_bf16 v[220:223], a[240:243], a[108:111], v[220:223]
    s_waitcnt lgkmcnt(3)
    v_exp_f32 v156, v156
    v_mfma_f32_16x16x32_bf16 v[148:151], v[54:57], v[138:141], v[148:151]
    v_exp_f32 v157, v157
    v_mfma_f32_16x16x32_bf16 v[216:219], a[236:239], a[100:103], v[216:219]
    v_exp_f32 v158, v158
    v_mfma_f32_16x16x32_bf16 v[216:219], a[240:243], a[112:115], v[216:219]
    v_exp_f32 v159, v159
    v_mfma_f32_16x16x32_bf16 v[212:215], a[236:239], a[104:107], v[212:215]
    ds_read_b128 a[236:239], v226 offset:1152
    v_cvt_pk_bf16_f32 v162, v156, v157
    v_mfma_f32_16x16x32_bf16 v[212:215], a[240:243], a[116:119], v[212:215]
    ds_read_b128 a[240:243], v226 offset:1216
    v_cvt_pk_bf16_f32 v163, v158, v159
    v_mfma_f32_16x16x16_bf16 v[148:151], v[58:59], v[142:143], v[148:151]
    ds_read_b128 v[156:159], v235
    v_mfma_f32_16x16x32_bf16 v[196:199], a[216:219], v[160:163], v[196:199]
    v_exp_f32 v144, v144
    v_mfma_f32_16x16x32_bf16 v[184:187], v[76:79], v[160:163], v[184:187]
    v_exp_f32 v145, v145
    v_mfma_f32_16x16x32_bf16 v[188:191], v[98:101], v[160:163], v[188:191]
    v_exp_f32 v146, v146
    v_mfma_f32_16x16x32_bf16 v[192:195], v[120:123], v[160:163], v[192:195]
    s_waitcnt lgkmcnt(3)
    v_exp_f32 v147, v147
    v_mfma_f32_16x16x32_bf16 v[152:155], v[60:63], v[138:141], v[152:155]
    v_cvt_pk_bf16_f32 v160, v144, v145
    v_cvt_pk_bf16_f32 v161, v146, v147
    v_mfma_f32_16x16x32_bf16 v[220:223], a[244:247], a[120:123], v[220:223]
    ds_read_b128 v[144:147], v234
    v_bfe_u32 v234, s77, v232, 4
    v_mfma_f32_16x16x32_bf16 v[220:223], a[248:251], a[132:135], v[220:223]
    v_mad_u32_u24 v235, v234, s40, v228
    v_mad_u32_u24 v234, v234, s40, v229
    v_mfma_f32_16x16x16_bf16 v[196:199], a[216:217], v[160:161], v[196:199]
    v_exp_f32 v148, v148
    v_mfma_f32_16x16x16_bf16 v[184:187], v[82:83], v[160:161], v[184:187]
    v_exp_f32 v149, v149
    v_mfma_f32_16x16x16_bf16 v[188:191], v[104:105], v[160:161], v[188:191]
    v_exp_f32 v150, v150
    v_mfma_f32_16x16x16_bf16 v[192:195], v[126:127], v[160:161], v[192:195]
    v_cvt_pk_bf16_f32 v84, v220, v221
    v_cvt_pk_bf16_f32 v85, v222, v223
    v_mfma_f32_16x16x16_bf16 v[152:155], v[64:65], v[142:143], v[152:155]
    v_exp_f32 v151, v151
    v_mfma_f32_16x16x32_bf16 v[216:219], a[244:247], a[124:127], v[216:219]
    v_cvt_pk_bf16_f32 v160, v148, v149
    v_cvt_pk_bf16_f32 v161, v150, v151
    v_mfma_f32_16x16x32_bf16 v[216:219], a[248:251], a[136:139], v[216:219]
    ds_read_b128 v[148:151], v229 offset:1280
    v_mfma_f32_16x16x32_bf16 v[212:215], a[244:247], a[128:131], v[212:215]
    ds_read_b128 a[244:247], v226 offset:1280
    v_mfma_f32_16x16x32_bf16 v[212:215], a[248:251], a[140:143], v[212:215]
    s_waitcnt lgkmcnt(2)
    ds_read_b128 a[248:251], v226 offset:1344
    v_mfma_f32_16x16x32_bf16 v[220:223], a[144:147], a[236:239], 0
    v_exp_f32 v152, v152
    v_mfma_f32_16x16x32_bf16 v[220:223], a[156:159], a[240:243], v[220:223]
    v_cvt_pk_bf16_f32 v106, v216, v217
    v_cvt_pk_bf16_f32 v107, v218, v219
    v_mfma_f32_16x16x32_bf16 v[216:219], a[148:151], a[236:239], 0
    v_exp_f32 v153, v153
    v_mfma_f32_16x16x32_bf16 v[216:219], a[160:163], a[240:243], v[216:219]
    v_cvt_pk_bf16_f32 v128, v212, v213
    v_cvt_pk_bf16_f32 v129, v214, v215
    v_mfma_f32_16x16x32_bf16 v[212:215], a[152:155], a[236:239], 0
    ds_read_b128 a[236:239], v226 offset:1408
    v_cvt_pk_bf16_f32 v162, v152, v153
    v_mfma_f32_16x16x32_bf16 v[212:215], a[164:167], a[240:243], v[212:215]
    ds_read_b128 a[240:243], v226 offset:1472
    v_mfma_f32_16x16x32_bf16 v[208:211], v[168:171], v[164:167], v[208:211]
    s_waitcnt lgkmcnt(3)
    v_exp_f32 v154, v154
    v_mfma_f32_16x16x32_bf16 v[220:223], a[168:171], a[244:247], v[220:223]
    s_waitcnt lgkmcnt(2)
    v_exp_f32 v155, v155
    v_mfma_f32_16x16x32_bf16 v[220:223], a[180:183], a[248:251], v[220:223]
    v_cvt_pk_bf16_f32 v163, v154, v155
    v_mfma_f32_16x16x32_bf16 v[216:219], a[172:175], a[244:247], v[216:219]
    ds_read_b128 v[152:155], v228 offset:1280
    v_mfma_f32_16x16x32_bf16 v[216:219], a[184:187], a[248:251], v[216:219]
    v_mfma_f32_16x16x32_bf16 v[196:199], a[216:219], v[160:163], v[196:199]
    v_mfma_f32_16x16x32_bf16 v[184:187], v[84:87], v[160:163], v[184:187]
    v_mfma_f32_16x16x32_bf16 v[188:191], v[106:109], v[160:163], v[188:191]
    v_mfma_f32_16x16x32_bf16 v[192:195], v[128:131], v[160:163], v[192:195]
    v_mfma_f32_16x16x32_bf16 v[212:215], a[176:179], a[244:247], v[212:215]
    ds_read_b128 a[244:247], v224 offset:15488
    v_mfma_f32_16x16x32_bf16 v[212:215], a[188:191], a[248:251], v[212:215]
    s_waitcnt lgkmcnt(2)
    ds_read_b128 a[248:251], v224 offset:15552
    v_mfma_f32_16x16x32_bf16 v[220:223], a[192:195], a[236:239], v[220:223]
    v_rcp_f32 v197, v196
    v_mfma_f32_16x16x32_bf16 v[220:223], a[204:207], a[240:243], v[220:223]
    v_mul_f32 v184, v184, v197
    v_mul_f32 v185, v185, v197
    v_mfma_f32_16x16x32_bf16 v[216:219], a[196:199], a[236:239], v[216:219]
    v_cvt_pk_bf16_f32 v184, v184, v185
    v_mul_f32 v186, v186, v197
    v_mfma_f32_16x16x32_bf16 v[216:219], a[208:211], a[240:243], v[216:219]
    v_mul_f32 v187, v187, v197
    v_cvt_pk_bf16_f32 v185, v186, v187
    v_mfma_f32_16x16x32_bf16 v[212:215], a[200:203], a[236:239], v[212:215]
    v_mul_f32 v220, s37, v220
    v_mul_f32 v221, s37, v221
    v_mfma_f32_16x16x32_bf16 v[212:215], a[212:215], a[240:243], v[212:215]
    v_mul_f32 v222, s37, v222
    v_mul_f32 v223, s37, v223
    v_mfma_f32_16x16x32_bf16 v[200:203], v[168:171], a[252:255], v[200:203]
    v_cvt_pk_bf16_f32 v132, v220, v221
    v_cvt_pk_bf16_f32 v133, v222, v223
    v_mfma_f32_16x16x32_bf16 v[204:207], v[248:251], v[164:167], v[204:207]
    v_mul_f32 v216, s37, v216
    v_mul_f32 v217, s37, v217
    v_mfma_f32_16x16x32_bf16 v[180:183], v[248:251], a[252:255], v[180:183]
    s_waitcnt lgkmcnt(1)
    v_mul_f32 v218, s37, v218
    v_mul_f32 v219, s37, v219
    v_mfma_f32_16x16x32_bf16 v[220:223], a[0:3], a[244:247], 0
    s_waitcnt lgkmcnt(0)
    v_cvt_pk_bf16_f32 v134, v216, v217
    v_cvt_pk_bf16_f32 v135, v218, v219
    v_mfma_f32_16x16x32_bf16 v[220:223], a[12:15], a[248:251], v[220:223]
    v_mul_f32 v212, s37, v212
    v_mul_f32 v213, s37, v213
    v_mfma_f32_16x16x32_bf16 v[156:159], v[12:15], v[132:135], v[156:159]
    v_mul_f32 v214, s37, v214
    v_mul_f32 v215, s37, v215
    v_mfma_f32_16x16x32_bf16 v[144:147], v[36:39], v[132:135], v[144:147]
    v_cvt_pk_bf16_f32 v136, v212, v213
    v_cvt_pk_bf16_f32 v137, v214, v215
    v_mfma_f32_16x16x32_bf16 v[148:151], v[42:45], v[132:135], v[148:151]
    ds_read_b128 a[236:239], v224 offset:15616
    ds_read_b128 a[240:243], v224 offset:15680
    v_mfma_f32_16x16x16_bf16 v[156:159], v[16:17], v[136:137], v[156:159]
    v_mul_f32 v188, v188, v197
    v_mul_f32 v189, v189, v197
    v_mfma_f32_16x16x16_bf16 v[144:147], v[40:41], v[136:137], v[144:147]
    v_cvt_pk_bf16_f32 v186, v188, v189
    v_mul_f32 v190, v190, v197
    v_mfma_f32_16x16x16_bf16 v[148:151], v[46:47], v[136:137], v[148:151]
    v_mul_f32 v191, v191, v197
    v_cvt_pk_bf16_f32 v187, v190, v191
    v_mfma_f32_16x16x32_bf16 v[152:155], v[18:21], v[132:135], v[152:155]
    v_mul_f32 v192, v192, v197
    v_mul_f32 v193, v193, v197
    v_mfma_f32_16x16x32_bf16 v[216:219], a[4:7], a[244:247], 0
    v_cvt_pk_bf16_f32 v188, v192, v193
    v_mul_f32 v194, v194, v197
    v_mfma_f32_16x16x32_bf16 v[216:219], a[16:19], a[248:251], v[216:219]
    v_mul_f32 v195, v195, v197
    v_cvt_pk_bf16_f32 v189, v194, v195
    v_mfma_f32_16x16x16_bf16 v[152:155], v[22:23], v[136:137], v[152:155]
    ds_read_b128 v[168:171], v242 offset:12288
    v_max3_f32 v236, v236, v196, v197
    v_mfma_f32_16x16x32_bf16 v[212:215], a[8:11], a[244:247], 0
    ds_read_b128 a[244:247], v224 offset:15744
    ds_read_b128 v[248:251], v242 offset:12800
    v_mfma_f32_16x16x32_bf16 v[212:215], a[20:23], a[248:251], v[212:215]
    s_waitcnt lgkmcnt(4)
    ds_read_b128 a[248:251], v224 offset:15808
    v_mfma_f32_16x16x32_bf16 v[220:223], a[24:27], a[236:239], v[220:223]
    s_waitcnt lgkmcnt(4)
    ds_write_b128 v237, v[184:187] offset:18432
    v_mfma_f32_16x16x32_bf16 v[220:223], a[36:39], a[240:243], v[220:223]
    ds_write_b64 v238, v[188:189] offset:18432
    v_mfma_f32_16x16x32_bf16 v[216:219], a[28:31], a[236:239], v[216:219]
    v_exp_f32 v156, v156
    v_mfma_f32_16x16x32_bf16 v[216:219], a[40:43], a[240:243], v[216:219]
    v_exp_f32 v157, v157
    v_mfma_f32_16x16x32_bf16 v[212:215], a[32:35], a[236:239], v[212:215]
    v_exp_f32 v158, v158
    v_mfma_f32_16x16x32_bf16 v[212:215], a[44:47], a[240:243], v[212:215]
    s_waitcnt lgkmcnt(5)
    ds_read_b128 a[236:239], v224 offset:15488
    ds_read_b128 a[240:243], v224 offset:15552
    v_mfma_f32_16x16x32_bf16 v[176:179], v[168:171], v[164:167], v[176:179]
    s_waitcnt lgkmcnt(5)
    ds_read_b128 v[168:171], v241 offset:24576
    v_cvt_pk_bf16_f32 v160, v156, v157
    v_mfma_f32_16x16x32_bf16 v[172:175], v[248:251], v[164:167], v[172:175]
    ds_read_b128 v[164:167], v240 offset:2048
    v_mfma_f32_16x16x32_bf16 v[220:223], a[48:51], a[244:247], v[220:223]
    s_waitcnt lgkmcnt(6)
    ds_read_b128 v[248:251], v241 offset:25088
    v_mfma_f32_16x16x32_bf16 v[220:223], a[60:63], a[248:251], v[220:223]
    ds_read_b128 a[252:255], v239 offset:3072
    v_mfma_f32_16x16x32_bf16 v[216:219], a[52:55], a[244:247], v[216:219]
    v_exp_f32 v159, v159
    v_mfma_f32_16x16x32_bf16 v[216:219], a[64:67], a[248:251], v[216:219]
    v_cvt_pk_bf16_f32 v161, v158, v159
    v_mfma_f32_16x16x32_bf16 v[212:215], a[56:59], a[244:247], v[212:215]
    ds_read_b128 a[244:247], v224 offset:15616
    ds_read_b128 v[156:159], v235
    v_mfma_f32_16x16x32_bf16 v[212:215], a[68:71], a[248:251], v[212:215]
    s_waitcnt lgkmcnt(7)
    v_cvt_pk_bf16_f32 v6, v220, v221
    v_cvt_pk_bf16_f32 v7, v222, v223
    v_mfma_f32_16x16x32_bf16 v[220:223], a[236:239], a[72:75], 0
    s_waitcnt lgkmcnt(6)
    v_cvt_pk_bf16_f32 v8, v216, v217
    v_cvt_pk_bf16_f32 v9, v218, v219
    v_mfma_f32_16x16x32_bf16 v[220:223], a[240:243], a[84:87], v[220:223]
    s_waitcnt lgkmcnt(5)
    ds_read_b128 a[248:251], v224 offset:15680
    v_mfma_f32_16x16x32_bf16 v[208:211], v[168:171], v[252:255], v[208:211]
    s_waitcnt lgkmcnt(5)
    v_cvt_pk_bf16_f32 v10, v212, v213
    v_cvt_pk_bf16_f32 v11, v214, v215
    v_mfma_f32_16x16x32_bf16 v[200:203], v[168:171], v[164:167], v[200:203]
    s_waitcnt lgkmcnt(4)
    ds_read_b128 v[168:171], v242 offset:24576
    v_mfma_f32_16x16x32_bf16 v[204:207], v[248:251], v[252:255], v[204:207]
    v_exp_f32 v144, v144
    v_mfma_f32_16x16x32_bf16 v[180:183], v[248:251], v[164:167], v[180:183]
    ds_read_b128 v[248:251], v242 offset:25088
    ds_read_b128 v[164:167], v239 offset:4096
    v_mfma_f32_16x16x32_bf16 v[216:219], a[236:239], a[76:79], 0
    v_exp_f32 v145, v145
    v_mfma_f32_16x16x32_bf16 v[216:219], a[240:243], a[88:91], v[216:219]
    s_waitcnt lgkmcnt(4)
    v_exp_f32 v146, v146
    v_mfma_f32_16x16x32_bf16 v[156:159], v[0:3], v[132:135], v[156:159]
    v_exp_f32 v147, v147
    v_mfma_f32_16x16x32_bf16 v[212:215], a[236:239], a[80:83], 0
    ds_read_b128 a[236:239], v224 offset:15744
    v_cvt_pk_bf16_f32 v162, v144, v145
    v_mfma_f32_16x16x32_bf16 v[212:215], a[240:243], a[92:95], v[212:215]
    ds_read_b128 a[240:243], v224 offset:15808
    v_cvt_pk_bf16_f32 v163, v146, v147
    v_mfma_f32_16x16x16_bf16 v[156:159], v[4:5], v[136:137], v[156:159]
    ds_read_b128 v[144:147], v234
    v_bfe_u32 v234, s78, v232, 4
    v_mfma_f32_16x16x32_bf16 v[196:199], a[216:219], v[160:163], 0
    v_mad_u32_u24 v235, v234, s40, v229
    v_mad_u32_u24 v234, v234, s40, v228
    v_mfma_f32_16x16x32_bf16 v[184:187], v[74:77], v[160:163], 0
    v_mov_b32 v5, s25
    v_mfma_f32_16x16x32_bf16 v[188:191], v[96:99], v[160:163], 0
    v_exp_f32 v148, v148
    v_mfma_f32_16x16x32_bf16 v[192:195], v[118:121], v[160:163], 0
    s_waitcnt lgkmcnt(4)
    v_exp_f32 v149, v149
    v_mfma_f32_16x16x32_bf16 v[176:179], v[168:171], v[252:255], v[176:179]
    ds_read_b128 v[168:171], v241 offset:36864
    v_cvt_pk_bf16_f32 v160, v148, v149
    v_mfma_f32_16x16x32_bf16 v[172:175], v[248:251], v[252:255], v[172:175]
    ds_read_b128 v[252:255], v240 offset:3072
    ds_read_b128 v[248:251], v241 offset:37376
    v_mfma_f32_16x16x32_bf16 v[220:223], a[244:247], a[96:99], v[220:223]
    v_exp_f32 v150, v150
    v_mfma_f32_16x16x32_bf16 v[220:223], a[248:251], a[108:111], v[220:223]
    s_waitcnt lgkmcnt(3)
    v_exp_f32 v151, v151
    v_mfma_f32_16x16x32_bf16 v[144:147], v[24:27], v[132:135], v[144:147]
    v_cvt_pk_bf16_f32 v161, v150, v151
    v_mfma_f32_16x16x32_bf16 v[216:219], a[244:247], a[100:103], v[216:219]
    ds_read_b128 v[148:151], v235
    v_bfe_u32 v235, s77, v232, 4
    v_mfma_f32_16x16x32_bf16 v[216:219], a[248:251], a[112:115], v[216:219]
    v_mad_u32_u24 v235, v235, s40, v230
    v_mfma_f32_16x16x16_bf16 v[144:147], v[28:29], v[136:137], v[144:147]
    v_exp_f32 v152, v152
    v_mfma_f32_16x16x32_bf16 v[212:215], a[244:247], a[104:107], v[212:215]
    ds_read_b128 a[244:247], v224 offset:18560
    v_mfma_f32_16x16x32_bf16 v[212:215], a[248:251], a[116:119], v[212:215]
    ds_read_b128 a[248:251], v224 offset:18624
    v_mfma_f32_16x16x32_bf16 v[220:223], a[236:239], a[120:123], v[220:223]
    v_exp_f32 v153, v153
    v_mfma_f32_16x16x32_bf16 v[220:223], a[240:243], a[132:135], v[220:223]
    v_exp_f32 v154, v154
    v_mfma_f32_16x16x32_bf16 v[216:219], a[236:239], a[124:127], v[216:219]
    v_exp_f32 v155, v155
    v_mfma_f32_16x16x32_bf16 v[216:219], a[240:243], a[136:139], v[216:219]
    v_cvt_pk_bf16_f32 v162, v152, v153
    v_cvt_pk_bf16_f32 v163, v154, v155
    v_mfma_f32_16x16x32_bf16 v[212:215], a[236:239], a[128:131], v[212:215]
    ds_read_b128 a[236:239], v224 offset:18688
    v_cvt_pk_bf16_f32 v72, v220, v221
    v_mfma_f32_16x16x32_bf16 v[212:215], a[240:243], a[140:143], v[212:215]
    ds_read_b128 a[240:243], v224 offset:18752
    v_cvt_pk_bf16_f32 v73, v222, v223
    v_mfma_f32_16x16x32_bf16 v[196:199], a[216:219], v[160:163], v[196:199]
    v_cvt_pk_bf16_f32 v94, v216, v217
    v_cvt_pk_bf16_f32 v95, v218, v219
    v_mfma_f32_16x16x32_bf16 v[184:187], v[78:81], v[160:163], v[184:187]
    ds_read_b128 v[152:155], v234
    v_bfe_u32 v234, s73, v232, 4
    v_mfma_f32_16x16x32_bf16 v[188:191], v[100:103], v[160:163], v[188:191]
    v_cvt_pk_bf16_f32 v116, v212, v213
    v_cvt_pk_bf16_f32 v117, v214, v215
    v_mfma_f32_16x16x32_bf16 v[192:195], v[122:125], v[160:163], v[192:195]
    s_waitcnt lgkmcnt(3)
    v_mad_u32_u24 v234, v234, s40, v230
    v_mfma_f32_16x16x32_bf16 v[208:211], v[168:171], a[252:255], v[208:211]
    v_exp_f32 v156, v156
    v_mfma_f32_16x16x32_bf16 v[200:203], v[168:171], v[252:255], v[200:203]
    ds_read_b128 v[168:171], v242 offset:36864
    v_mfma_f32_16x16x32_bf16 v[204:207], v[248:251], a[252:255], v[204:207]
    v_exp_f32 v157, v157
    v_mfma_f32_16x16x32_bf16 v[180:183], v[248:251], v[252:255], v[180:183]
    ds_read_b128 v[248:251], v242 offset:37376
    ds_read_b128 v[252:255], v239 offset:5120
    v_mfma_f32_16x16x32_bf16 v[220:223], a[0:3], a[244:247], 0
    ds_read_b128 a[0:3], v241 offset:12288
    v_cvt_pk_bf16_f32 v160, v156, v157
    v_mfma_f32_16x16x32_bf16 v[220:223], a[12:15], a[248:251], v[220:223]
    s_waitcnt lgkmcnt(4)
    ds_read_b128 a[12:15], v242 offset:12800
    v_mfma_f32_16x16x32_bf16 v[152:155], v[6:9], v[132:135], v[152:155]
L_pg8:
    s_cbranch_execz L_back
    v_exp_f32 v158, v158
    v_mfma_f32_16x16x32_bf16 v[216:219], a[4:7], a[244:247], 0
    ds_read_b128 a[4:7], v241 offset:12800
    v_mov_b32 v6, 0x27e00
    v_mfma_f32_16x16x32_bf16 v[216:219], a[16:19], a[248:251], v[216:219]
    ds_read_b128 a[16:19], v241 offset:24576
    v_mfma_f32_16x16x16_bf16 v[152:155], v[10:11], v[136:137], v[152:155]
    s_waitcnt lgkmcnt(6)
    v_exp_f32 v159, v159
    v_mfma_f32_16x16x32_bf16 v[176:179], v[168:171], a[252:255], v[176:179]
    ds_read_b128 v[168:171], v242 offset:61440
    v_cvt_pk_bf16_f32 v161, v158, v159
    v_mfma_f32_16x16x32_bf16 v[212:215], a[8:11], a[244:247], 0
    ds_read_b128 a[244:247], v224 offset:18816
    ds_read_b128 a[8:11], v242 offset:12288
    v_mfma_f32_16x16x32_bf16 v[212:215], a[20:23], a[248:251], v[212:215]
    s_waitcnt lgkmcnt(8)
    ds_read_b128 a[248:251], v224 offset:18880
    v_mfma_f32_16x16x32_bf16 v[172:175], v[248:251], a[252:255], v[172:175]
    ds_read_b128 a[20:23], v241 offset:25088
    v_mfma_f32_16x16x32_bf16 v[220:223], a[24:27], a[236:239], v[220:223]
    ds_read_b128 a[24:27], v242 offset:24576
    v_mfma_f32_16x16x32_bf16 v[220:223], a[36:39], a[240:243], v[220:223]
    ds_read_b128 a[36:39], v241 offset:37376
    v_mfma_f32_16x16x32_bf16 v[216:219], a[28:31], a[236:239], v[216:219]
    ds_read_b128 a[28:31], v242 offset:25088
    v_mfma_f32_16x16x32_bf16 v[216:219], a[40:43], a[240:243], v[216:219]
    ds_read_b128 a[40:43], v242 offset:36864
    v_mfma_f32_16x16x32_bf16 v[212:215], a[32:35], a[236:239], v[212:215]
    ds_read_b128 a[236:239], v224 offset:18560
    v_mfma_f32_16x16x32_bf16 v[212:215], a[44:47], a[240:243], v[212:215]
    s_waitcnt lgkmcnt(8)
    ds_read_b128 a[240:243], v224 offset:18624
    v_mfma_f32_16x16x32_bf16 v[220:223], a[48:51], a[244:247], v[220:223]
    ds_read_b128 a[32:35], v241 offset:36864
    v_mfma_f32_16x16x32_bf16 v[216:219], a[52:55], a[244:247], v[216:219]
    s_waitcnt lgkmcnt(8)
    ds_read_b128 a[44:47], v242 offset:37376
    v_mfma_f32_16x16x32_bf16 v[216:219], a[64:67], a[248:251], v[216:219]
    ds_read_b128 a[48:51], v241 offset:49152
    v_mfma_f32_16x16x32_bf16 v[220:223], a[60:63], a[248:251], v[220:223]
    ds_read_b128 a[52:55], v241 offset:49664
    v_mfma_f32_16x16x32_bf16 v[212:215], a[56:59], a[244:247], v[212:215]
    ds_read_b128 a[244:247], v224 offset:18688
    v_mfma_f32_16x16x32_bf16 v[212:215], a[68:71], a[248:251], v[212:215]
    s_waitcnt lgkmcnt(6)
    ds_read_b128 a[248:251], v224 offset:18752
    v_exp_f32 v144, v144
    v_cvt_pk_bf16_f32 v32, v216, v217
    v_cvt_pk_bf16_f32 v33, v218, v219
    v_cvt_pk_bf16_f32 v30, v220, v221
    v_cvt_pk_bf16_f32 v31, v222, v223
    ds_read_b128 a[56:59], v242 offset:49152
    v_mfma_f32_16x16x32_bf16 v[220:223], a[236:239], a[72:75], 0
    s_waitcnt lgkmcnt(7)
    v_cvt_pk_bf16_f32 v34, v212, v213
    v_cvt_pk_bf16_f32 v35, v214, v215
    v_mfma_f32_16x16x32_bf16 v[220:223], a[240:243], a[84:87], v[220:223]
    ds_read_b128 a[60:63], v242 offset:49664
    ds_read_b128 a[64:67], v241 offset:61440
    v_mfma_f32_16x16x32_bf16 v[148:151], v[30:33], v[132:135], v[148:151]
    ds_read_b128 a[68:71], v241 offset:61952
    v_mfma_f32_16x16x32_bf16 v[216:219], a[236:239], a[76:79], 0
    ds_read_b128 a[252:255], v240 offset:4096
    v_mfma_f32_16x16x32_bf16 v[216:219], a[240:243], a[88:91], v[216:219]
    s_waitcnt lgkmcnt(8)
    ds_read_b128 v[248:251], v242 offset:61952
    v_mfma_f32_16x16x32_bf16 v[208:211], a[48:51], v[164:167], v[208:211]
    ds_read_b128 v[156:159], v234
    v_bfe_u32 v234, s78, v232, 4
    v_mfma_f32_16x16x16_bf16 v[148:151], v[34:35], v[136:137], v[148:151]
    s_waitcnt lgkmcnt(9)
    v_mad_u32_u24 v234, v234, s40, v230
    v_mfma_f32_16x16x32_bf16 v[204:207], a[52:55], v[164:167], v[204:207]
    s_waitcnt lgkmcnt(6)
    v_exp_f32 v145, v145
    v_mfma_f32_16x16x32_bf16 v[176:179], a[56:59], v[164:167], v[176:179]
    v_exp_f32 v146, v146
    v_mfma_f32_16x16x32_bf16 v[212:215], a[236:239], a[80:83], 0
    ds_read_b128 a[236:239], v224 offset:18816
    v_cvt_pk_bf16_f32 v162, v144, v145
    v_mfma_f32_16x16x32_bf16 v[212:215], a[240:243], a[92:95], v[212:215]
    s_waitcnt lgkmcnt(6)
    ds_read_b128 a[240:243], v224 offset:18880
    v_cndmask_b32 v224, v239, v240, vcc
    v_mfma_f32_16x16x32_bf16 v[172:175], a[60:63], v[164:167], v[172:175]
    ds_read_b128 v[164:167], v240 offset:5120
    v_mfma_f32_16x16x32_bf16 v[220:223], a[244:247], a[96:99], v[220:223]
    v_exp_f32 v147, v147
    v_mfma_f32_16x16x32_bf16 v[220:223], a[248:251], a[108:111], v[220:223]
    s_waitcnt lgkmcnt(5)
    v_cvt_pk_bf16_f32 v163, v146, v147
    v_mfma_f32_16x16x32_bf16 v[200:203], a[48:51], a[252:255], v[200:203]
    ds_read_b128 v[144:147], v230 offset:1280
    v_mfma_f32_16x16x32_bf16 v[196:199], a[216:219], v[160:163], v[196:199]
    v_exp_f32 v148, v148
    v_mfma_f32_16x16x32_bf16 v[184:187], v[66:69], v[160:163], v[184:187]
    v_exp_f32 v149, v149
    v_mfma_f32_16x16x32_bf16 v[188:191], v[88:91], v[160:163], v[188:191]
    v_exp_f32 v150, v150
    v_mfma_f32_16x16x32_bf16 v[192:195], v[110:113], v[160:163], v[192:195]
    v_exp_f32 v151, v151
    v_mfma_f32_16x16x32_bf16 v[180:183], a[52:55], a[252:255], v[180:183]
    s_waitcnt lgkmcnt(1)
    v_cvt_pk_bf16_f32 v160, v148, v149
    v_cvt_pk_bf16_f32 v161, v150, v151
    v_mfma_f32_16x16x32_bf16 v[216:219], a[244:247], a[100:103], v[216:219]
    s_barrier
    ds_read_b128 v[148:151], v235
    v_bfe_u32 v235, s79, v233, 4
    v_mfma_f32_16x16x32_bf16 v[216:219], a[248:251], a[112:115], v[216:219]
    ds_read_b128 a[252:255], v239 offset:12288
    v_mad_u32_u24 v235, v235, s40, v231
    v_mfma_f32_16x16x32_bf16 v[212:215], a[244:247], a[104:107], v[212:215]
    ds_read_b128 a[244:247], v226 offset:4224
    v_mfma_f32_16x16x32_bf16 v[212:215], a[248:251], a[116:119], v[212:215]
    ds_read_b128 a[248:251], v226 offset:4288
    v_mfma_f32_16x16x32_bf16 v[220:223], a[236:239], a[120:123], v[220:223]
    v_exp_f32 v152, v152
    v_mfma_f32_16x16x32_bf16 v[220:223], a[240:243], a[132:135], v[220:223]
    v_exp_f32 v153, v153
    v_mfma_f32_16x16x32_bf16 v[216:219], a[236:239], a[124:127], v[216:219]
    v_exp_f32 v154, v154
    v_mfma_f32_16x16x32_bf16 v[216:219], a[240:243], a[136:139], v[216:219]
    v_exp_f32 v155, v155
    v_mfma_f32_16x16x32_bf16 v[212:215], a[236:239], a[128:131], v[212:215]
    ds_read_b128 a[236:239], v226 offset:4352
    v_cvt_pk_bf16_f32 v162, v152, v153
    v_mfma_f32_16x16x32_bf16 v[212:215], a[240:243], a[140:143], v[212:215]
    v_cvt_pk_bf16_f32 v70, v220, v221
    v_cvt_pk_bf16_f32 v71, v222, v223
    v_mfma_f32_16x16x32_bf16 v[208:211], a[64:67], v[252:255], v[208:211]
    v_cvt_pk_bf16_f32 v92, v216, v217
    v_cvt_pk_bf16_f32 v93, v218, v219
    v_mfma_f32_16x16x32_bf16 v[200:203], a[64:67], v[164:167], v[200:203]
    ds_read_b128 a[240:243], v226 offset:4416
    v_cvt_pk_bf16_f32 v163, v154, v155
    v_mfma_f32_16x16x32_bf16 v[204:207], a[68:71], v[252:255], v[204:207]
    v_cvt_pk_bf16_f32 v114, v212, v213
    v_cvt_pk_bf16_f32 v115, v214, v215
    v_mfma_f32_16x16x32_bf16 v[196:199], a[216:219], v[160:163], v[196:199]
    ds_read_b128 v[152:155], v234
    v_cvt_pk_bf16_f32 v208, v208, v209
    v_mfma_f32_16x16x32_bf16 v[184:187], v[70:73], v[160:163], v[184:187]
    v_cvt_pk_bf16_f32 v209, v210, v211
    v_cvt_pk_bf16_f32 v200, v200, v201
    v_mfma_f32_16x16x32_bf16 v[188:191], v[92:95], v[160:163], v[188:191]
    v_cvt_pk_bf16_f32 v210, v204, v205
    v_cvt_pk_bf16_f32 v211, v206, v207
    v_mfma_f32_16x16x32_bf16 v[192:195], v[114:117], v[160:163], v[192:195]
    buffer_store_dwordx4 v[208:211], v243, s[20:23], s58 offen sc0 sc1
    v_mfma_f32_16x16x32_bf16 v[180:183], a[68:71], v[164:167], v[180:183]
    v_cvt_pk_bf16_f32 v201, v202, v203
    v_bfe_u32 v234, s80, v233, 4
    v_mfma_f32_16x16x32_bf16 v[176:179], v[168:171], v[252:255], v[176:179]
    v_rcp_f32 v197, v196
    v_mfma_f32_16x16x32_bf16 v[172:175], v[248:251], v[252:255], v[172:175]
    s_waitcnt lgkmcnt(2)
    v_mul_f32 v184, v184, v197
    v_mul_f32 v185, v185, v197
    v_mfma_f32_16x16x32_bf16 v[220:223], a[144:147], a[244:247], 0
    v_cvt_pk_bf16_f32 v202, v180, v181
    v_cvt_pk_bf16_f32 v203, v182, v183
    v_mfma_f32_16x16x32_bf16 v[220:223], a[156:159], a[248:251], v[220:223]
    v_cvt_pk_bf16_f32 v176, v176, v177
    v_cvt_pk_bf16_f32 v177, v178, v179
    v_mfma_f32_16x16x32_bf16 v[216:219], a[148:151], a[244:247], 0
    v_cvt_pk_bf16_f32 v178, v172, v173
    v_cvt_pk_bf16_f32 v179, v174, v175
    v_mfma_f32_16x16x32_bf16 v[216:219], a[160:163], a[248:251], v[216:219]
    v_cvt_pk_bf16_f32 v184, v184, v185
    v_mul_f32 v186, v186, v197
    v_mfma_f32_16x16x32_bf16 v[212:215], a[152:155], a[244:247], 0
    ds_read_b128 a[244:247], v226 offset:4480
    v_mul_f32 v187, v187, v197
    v_mfma_f32_16x16x32_bf16 v[212:215], a[164:167], a[248:251], v[212:215]
    ds_read_b128 a[248:251], v226 offset:4544
    v_cvt_pk_bf16_f32 v185, v186, v187
    v_mfma_f32_16x16x32_bf16 v[220:223], a[168:171], a[236:239], v[220:223]
    s_waitcnt lgkmcnt(2)
    v_mul_f32 v188, v188, v197
    v_mul_f32 v189, v189, v197
    v_mfma_f32_16x16x32_bf16 v[220:223], a[180:183], a[240:243], v[220:223]
    v_cvt_pk_bf16_f32 v186, v188, v189
    v_mul_f32 v190, v190, v197
    v_mfma_f32_16x16x32_bf16 v[216:219], a[172:175], a[236:239], v[216:219]
    buffer_store_dwordx4 v[200:203], v245, s[20:23], s58 offen sc0 sc1
    v_mfma_f32_16x16x32_bf16 v[216:219], a[184:187], a[240:243], v[216:219]
    v_mul_f32 v191, v191, v197
    v_cvt_pk_bf16_f32 v187, v190, v191
    v_mfma_f32_16x16x32_bf16 v[212:215], a[176:179], a[236:239], v[212:215]
    v_mul_f32 v192, v192, v197
    v_mul_f32 v193, v193, v197
    v_mfma_f32_16x16x32_bf16 v[212:215], a[188:191], a[240:243], v[212:215]
    s_waitcnt lgkmcnt(1)
    v_cvt_pk_bf16_f32 v188, v192, v193
    v_mul_f32 v194, v194, v197
    v_mfma_f32_16x16x32_bf16 v[220:223], a[192:195], a[244:247], v[220:223]
    s_waitcnt lgkmcnt(0)
    v_mul_f32 v195, v195, v197
    v_cvt_pk_bf16_f32 v189, v194, v195
    v_mfma_f32_16x16x32_bf16 v[220:223], a[204:207], a[248:251], v[220:223]
    v_max3_f32 v236, v236, v196, v197
    v_mad_u32_u24 v234, v234, s40, v231
    v_mfma_f32_16x16x32_bf16 v[216:219], a[196:199], a[244:247], v[216:219]
    ds_write_b128 v237, v[184:187]
    v_mfma_f32_16x16x32_bf16 v[216:219], a[208:211], a[248:251], v[216:219]
    ds_write_b64 v238, v[188:189]
    v_mfma_f32_16x16x32_bf16 v[212:215], a[200:203], a[244:247], v[212:215]
    v_cndmask_b32 v226, v244, v247, vcc
    v_mul_f32 v220, s37, v220
    v_mfma_f32_16x16x32_bf16 v[212:215], a[212:215], a[248:251], v[212:215]
    v_mul_f32 v221, s37, v221
    v_mul_f32 v222, s37, v222
    v_mfma_f32_16x16x32_bf16 v[208:211], a[220:223], a[252:255], 0
    v_mul_f32 v223, s37, v223
    v_cvt_pk_bf16_f32 v138, v220, v221
    v_mfma_f32_16x16x32_bf16 v[204:207], a[224:227], a[252:255], 0
    v_cvt_pk_bf16_f32 v139, v222, v223
    v_mul_f32 v216, s37, v216
    v_mfma_f32_16x16x32_bf16 v[172:175], a[232:235], a[252:255], 0
    v_mul_f32 v217, s37, v217
    v_mul_f32 v218, s37, v218
    v_mul_f32 v219, s37, v219
    v_cvt_pk_bf16_f32 v140, v216, v217
    v_cvt_pk_bf16_f32 v141, v218, v219
    v_mul_f32 v212, s37, v212
    v_mul_f32 v213, s37, v213
    v_mfma_f32_16x16x32_bf16 v[156:159], v[36:39], v[138:141], v[156:159]
    v_mul_f32 v214, s37, v214
    v_mul_f32 v215, s37, v215
    v_mfma_f32_16x16x32_bf16 v[144:147], v[42:45], v[138:141], v[144:147]
    v_cvt_pk_bf16_f32 v142, v212, v213
    v_cvt_pk_bf16_f32 v143, v214, v215
    v_mfma_f32_16x16x32_bf16 v[148:151], v[24:27], v[138:141], v[148:151]
    buffer_store_dwordx4 v[176:179], v244, s[20:23], s58 offen sc0 sc1
    v_mfma_f32_16x16x16_bf16 v[156:159], v[40:41], v[142:143], v[156:159]
    s_add_u32 s58, s51, 0x1a4000
    ds_read_b128 v[252:255], v240 offset:12288
    ds_read_b128 v[164:167], v239 offset:13312
    v_mfma_f32_16x16x16_bf16 v[144:147], v[46:47], v[142:143], v[144:147]
    s_waitcnt lgkmcnt(2)
    s_barrier
    ds_read_b128 v[168:171], v242 offset:61440
    v_cndmask_b32 v247, v247, v244, vcc
    v_mfma_f32_16x16x16_bf16 v[148:151], v[28:29], v[142:143], v[148:151]
    ds_read_b128 v[248:251], v242 offset:61952
    v_mfma_f32_16x16x32_bf16 v[152:155], v[30:33], v[138:141], v[152:155]
    v_exp_f32 v156, v156
    v_mfma_f32_16x16x32_bf16 v[176:179], a[228:231], a[252:255], 0
    ds_read_b128 a[252:255], v240 offset:13312
    v_exp_f32 v157, v157
    v_exp_f32 v158, v158
    v_exp_f32 v159, v159
    v_mfma_f32_16x16x16_bf16 v[152:155], v[34:35], v[142:143], v[152:155]
    s_waitcnt lgkmcnt(4)
    v_cvt_pk_bf16_f32 v160, v156, v157
    v_cvt_pk_bf16_f32 v161, v158, v159
    ds_read_b128 v[156:159], v235
    v_exp_f32 v144, v144
    v_mfma_f32_16x16x32_bf16 v[200:203], a[220:223], v[252:255], 0
    v_exp_f32 v145, v145
    v_mfma_f32_16x16x32_bf16 v[180:183], a[224:227], v[252:255], 0
    s_waitcnt lgkmcnt(4)
    ds_read_b128 v[252:255], v239 offset:14336
    v_cvt_pk_bf16_f32 v162, v144, v145
    v_mfma_f32_16x16x32_bf16 v[208:211], a[0:3], v[164:167], v[208:211]
    v_exp_f32 v146, v146
    v_mfma_f32_16x16x32_bf16 v[204:207], a[4:7], v[164:167], v[204:207]
    s_waitcnt lgkmcnt(2)
    v_exp_f32 v147, v147
    v_mfma_f32_16x16x32_bf16 v[200:203], a[0:3], a[252:255], v[200:203]
    v_cvt_pk_bf16_f32 v163, v146, v147
    v_mfma_f32_16x16x32_bf16 v[180:183], a[4:7], a[252:255], v[180:183]
    ds_read_b128 v[144:147], v234
    v_mfma_f32_16x16x32_bf16 v[196:199], a[216:219], v[160:163], 0
    ds_read_b128 a[252:255], v239 offset:15360
    v_mfma_f32_16x16x32_bf16 v[184:187], v[76:79], v[160:163], 0
    v_exp_f32 v148, v148
    v_mfma_f32_16x16x32_bf16 v[188:191], v[98:101], v[160:163], 0
    v_exp_f32 v149, v149
    v_mfma_f32_16x16x32_bf16 v[192:195], v[120:123], v[160:163], 0
    s_waitcnt lgkmcnt(3)
    v_exp_f32 v150, v150
    v_mfma_f32_16x16x32_bf16 v[156:159], v[48:51], v[138:141], v[156:159]
    v_exp_f32 v151, v151
    v_mfma_f32_16x16x32_bf16 v[176:179], a[8:11], v[164:167], v[176:179]
    v_cvt_pk_bf16_f32 v160, v148, v149
    v_cvt_pk_bf16_f32 v161, v150, v151
    v_mfma_f32_16x16x32_bf16 v[172:175], a[12:15], v[164:167], v[172:175]
    ds_read_b128 v[164:167], v240 offset:14336
    v_mfma_f32_16x16x16_bf16 v[156:159], v[52:53], v[142:143], v[156:159]
    s_waitcnt lgkmcnt(2)
    v_exp_f32 v152, v152
    v_mfma_f32_16x16x32_bf16 v[144:147], v[54:57], v[138:141], v[144:147]
    v_exp_f32 v153, v153
    v_mfma_f32_16x16x32_bf16 v[208:211], a[16:19], v[252:255], v[208:211]
    v_exp_f32 v154, v154
    v_mfma_f32_16x16x32_bf16 v[204:207], a[20:23], v[252:255], v[204:207]
    v_exp_f32 v155, v155
    v_mfma_f32_16x16x32_bf16 v[176:179], a[24:27], v[252:255], v[176:179]
    v_cvt_pk_bf16_f32 v162, v152, v153
    v_cvt_pk_bf16_f32 v163, v154, v155
    v_mfma_f32_16x16x16_bf16 v[144:147], v[58:59], v[142:143], v[144:147]
    v_exp_f32 v156, v156
    v_mfma_f32_16x16x32_bf16 v[196:199], a[216:219], v[160:163], v[196:199]
    v_exp_f32 v157, v157
    v_mfma_f32_16x16x32_bf16 v[184:187], v[68:71], v[160:163], v[184:187]
    v_exp_f32 v158, v158
    v_mfma_f32_16x16x32_bf16 v[188:191], v[90:93], v[160:163], v[188:191]
    v_exp_f32 v159, v159
    v_mfma_f32_16x16x32_bf16 v[192:195], v[112:115], v[160:163], v[192:195]
    s_waitcnt lgkmcnt(0)
    v_cvt_pk_bf16_f32 v160, v156, v157
    v_cvt_pk_bf16_f32 v161, v158, v159
    v_mfma_f32_16x16x32_bf16 v[200:203], a[16:19], v[164:167], v[200:203]
    v_exp_f32 v144, v144
    v_mfma_f32_16x16x32_bf16 v[180:183], a[20:23], v[164:167], v[180:183]
    ds_read_b128 v[164:167], v239 offset:16384
    v_mfma_f32_16x16x32_bf16 v[172:175], a[28:31], v[252:255], v[172:175]
    ds_read_b128 v[252:255], v240 offset:15360
    v_mfma_f32_16x16x32_bf16 v[208:211], a[32:35], a[252:255], v[208:211]
    v_exp_f32 v145, v145
    v_mfma_f32_16x16x32_bf16 v[204:207], a[36:39], a[252:255], v[204:207]
    v_exp_f32 v146, v146
    v_mfma_f32_16x16x32_bf16 v[176:179], a[40:43], a[252:255], v[176:179]
    v_exp_f32 v147, v147
    v_mfma_f32_16x16x32_bf16 v[172:175], a[44:47], a[252:255], v[172:175]
    ds_read_b128 a[252:255], v240 offset:16384
    v_cvt_pk_bf16_f32 v162, v144, v145
    v_cvt_pk_bf16_f32 v163, v146, v147
    s_nop 1
    v_mfma_f32_16x16x32_bf16 v[196:199], a[216:219], v[160:163], v[196:199]
    v_mfma_f32_16x16x32_bf16 v[184:187], v[82:85], v[160:163], v[184:187]
    v_mfma_f32_16x16x32_bf16 v[188:191], v[104:107], v[160:163], v[188:191]
    v_mfma_f32_16x16x32_bf16 v[192:195], v[126:129], v[160:163], v[192:195]
    s_waitcnt lgkmcnt(1)
    v_mfma_f32_16x16x32_bf16 v[200:203], a[32:35], v[252:255], v[200:203]
    v_mfma_f32_16x16x32_bf16 v[180:183], a[36:39], v[252:255], v[180:183]
    ds_read_b128 v[252:255], v239 offset:17408
    v_mfma_f32_16x16x32_bf16 v[208:211], a[48:51], v[164:167], v[208:211]
    s_waitcnt lgkmcnt(1)
    v_mfma_f32_16x16x32_bf16 v[200:203], a[48:51], a[252:255], v[200:203]
    v_rcp_f32 v197, v196
    v_mfma_f32_16x16x32_bf16 v[204:207], a[52:55], v[164:167], v[204:207]
    v_mul_f32 v184, v184, v197
    v_mul_f32 v185, v185, v197
    v_mfma_f32_16x16x32_bf16 v[180:183], a[52:55], a[252:255], v[180:183]
    ds_read_b128 a[252:255], v224
    v_cvt_pk_bf16_f32 v184, v184, v185
    v_mfma_f32_16x16x32_bf16 v[176:179], a[56:59], v[164:167], v[176:179]
    v_mul_f32 v186, v186, v197
    v_mul_f32 v187, v187, v197
    v_mfma_f32_16x16x32_bf16 v[172:175], a[60:63], v[164:167], v[172:175]
    s_waitcnt lgkmcnt(1)
    ds_read_b128 v[164:167], v240 offset:17408
    v_cvt_pk_bf16_f32 v185, v186, v187
    v_mul_f32 v188, v188, v197
    v_mul_f32 v189, v189, v197
    v_cvt_pk_bf16_f32 v186, v188, v189
    v_mul_f32 v190, v190, v197
    v_mul_f32 v191, v191, v197
    v_cvt_pk_bf16_f32 v187, v190, v191
    v_mfma_f32_16x16x32_bf16 v[208:211], a[64:67], v[252:255], v[208:211]
    v_mul_f32 v192, v192, v197
    v_mul_f32 v193, v193, v197
    v_mfma_f32_16x16x32_bf16 v[204:207], a[68:71], v[252:255], v[204:207]
    v_cvt_pk_bf16_f32 v188, v192, v193
    v_mul_f32 v194, v194, v197
    v_mfma_f32_16x16x32_bf16 v[176:179], v[168:171], v[252:255], v[176:179]
    ds_read_b128 v[168:171], v242 offset:61440
    v_mul_f32 v195, v195, v197
    v_mfma_f32_16x16x32_bf16 v[172:175], v[248:251], v[252:255], v[172:175]
    s_waitcnt lgkmcnt(2)
    v_cvt_pk_bf16_f32 v208, v208, v209
    v_cvt_pk_bf16_f32 v209, v210, v211
    v_cvt_pk_bf16_f32 v210, v204, v205
    v_cvt_pk_bf16_f32 v211, v206, v207
    v_mfma_f32_16x16x32_bf16 v[204:207], a[224:227], a[252:255], 0
    s_waitcnt lgkmcnt(1)
    buffer_store_dwordx4 v[208:211], v243, s[20:23], s58 offen sc0 sc1
    v_mfma_f32_16x16x32_bf16 v[200:203], a[64:67], v[164:167], v[200:203]
    ds_read_b128 v[252:255], v224 offset:1024
    v_cvt_pk_bf16_f32 v176, v176, v177
    v_mfma_f32_16x16x32_bf16 v[180:183], a[68:71], v[164:167], v[180:183]
    ds_read_b128 v[164:167], v224 offset:2048
    v_cvt_pk_bf16_f32 v177, v178, v179
    v_mfma_f32_16x16x32_bf16 v[208:211], a[220:223], a[252:255], 0
    v_cvt_pk_bf16_f32 v178, v172, v173
    v_cvt_pk_bf16_f32 v179, v174, v175
    v_cvt_pk_bf16_f32 v200, v200, v201
    v_cvt_pk_bf16_f32 v201, v202, v203
    ds_read_b128 v[248:251], v242 offset:61952
    v_cvt_pk_bf16_f32 v202, v180, v181
    v_cvt_pk_bf16_f32 v203, v182, v183
    v_mfma_f32_16x16x32_bf16 v[180:183], a[232:235], a[252:255], 0
    s_waitcnt lgkmcnt(2)
    v_cvt_pk_bf16_f32 v189, v194, v195
    v_max3_f32 v236, v236, v196, v197
    ds_write_b128 v237, v[184:187] offset:6144
    ds_write_b64 v238, v[188:189] offset:6144
    v_cmp_lt_f32 vcc, 0x53800000, v236
    v_mfma_f32_16x16x32_bf16 v[208:211], a[0:3], v[252:255], v[208:211]
    v_mfma_f32_16x16x32_bf16 v[204:207], a[4:7], v[252:255], v[204:207]
    s_or_b32 s24, vcc_lo, vcc_hi
    v_mov_b32 v4, s24
    v_mfma_f32_16x16x32_bf16 v[180:183], a[12:15], v[252:255], v[180:183]
    s_waitcnt lgkmcnt(3)
    buffer_store_dwordx4 v[200:203], v245, s[20:23], s58 offen sc0 sc1
    v_mfma_f32_16x16x32_bf16 v[208:211], a[16:19], v[164:167], v[208:211]
    ds_write_b32 v5, v4
    v_mfma_f32_16x16x32_bf16 v[200:203], a[228:231], a[252:255], 0
    ds_read_b128 a[252:255], v224 offset:3072
    v_mfma_f32_16x16x32_bf16 v[200:203], a[8:11], v[252:255], v[200:203]
    ds_read_b128 v[252:255], v224 offset:4096
    v_mfma_f32_16x16x32_bf16 v[204:207], a[20:23], v[164:167], v[204:207]
    v_mfma_f32_16x16x32_bf16 v[200:203], a[24:27], v[164:167], v[200:203]
    v_mfma_f32_16x16x32_bf16 v[180:183], a[28:31], v[164:167], v[180:183]
    s_waitcnt lgkmcnt(1)
    ds_read_b128 v[164:167], v224 offset:5120
    s_barrier
    ds_read_b128 v[0:3], v6
    v_mfma_f32_16x16x32_bf16 v[208:211], a[32:35], a[252:255], v[208:211]
    v_mfma_f32_16x16x32_bf16 v[204:207], a[36:39], a[252:255], v[204:207]
    buffer_store_dwordx4 v[176:179], v244, s[20:23], s58 offen sc0 sc1
    v_mfma_f32_16x16x32_bf16 v[200:203], a[40:43], a[252:255], v[200:203]
    s_add_u32 s58, s51, 0x1f8000
    v_mfma_f32_16x16x32_bf16 v[180:183], a[44:47], a[252:255], v[180:183]
    s_waitcnt lgkmcnt(2)
    ds_read_b128 a[252:255], v227
    v_mfma_f32_16x16x32_bf16 v[208:211], a[48:51], v[252:255], v[208:211]
    v_mfma_f32_16x16x32_bf16 v[204:207], a[52:55], v[252:255], v[204:207]
    v_mfma_f32_16x16x32_bf16 v[200:203], a[56:59], v[252:255], v[200:203]
    s_waitcnt lgkmcnt(1)
    v_or3_b32 v0, v0, v1, v2
    v_or_b32 v0, v0, v3
    v_mfma_f32_16x16x32_bf16 v[180:183], a[60:63], v[252:255], v[180:183]
    ds_read_b128 v[252:255], v227 offset:1024
    v_readfirstlane_b32 s24, v0
    v_mfma_f32_16x16x32_bf16 v[208:211], a[64:67], v[164:167], v[208:211]
    v_mfma_f32_16x16x32_bf16 v[204:207], a[68:71], v[164:167], v[204:207]
    v_mfma_f32_16x16x32_bf16 v[200:203], v[168:171], v[164:167], v[200:203]
    ds_read_b128 v[168:171], v242 offset:61440
    v_mfma_f32_16x16x32_bf16 v[180:183], v[248:251], v[164:167], v[180:183]
    s_waitcnt lgkmcnt(2)
    ds_read_b128 v[164:167], v227 offset:2048
    ds_read_b128 v[248:251], v242 offset:61952
    v_mfma_f32_16x16x32_bf16 v[176:179], a[220:223], a[252:255], 0
    v_mfma_f32_16x16x32_bf16 v[172:175], a[224:227], a[252:255], 0
    v_cvt_pk_bf16_f32 v208, v208, v209
    v_cvt_pk_bf16_f32 v209, v210, v211
    v_cvt_pk_bf16_f32 v210, v204, v205
    v_cvt_pk_bf16_f32 v211, v206, v207
    v_mfma_f32_16x16x32_bf16 v[204:207], a[232:235], a[252:255], 0
    s_waitcnt lgkmcnt(3)
    buffer_store_dwordx4 v[208:211], v225, s[20:23], s58 offen sc0 sc1
    v_mfma_f32_16x16x32_bf16 v[176:179], a[0:3], v[252:255], v[176:179]
    v_cvt_pk_bf16_f32 v200, v200, v201
    v_cvt_pk_bf16_f32 v201, v202, v203
    v_mfma_f32_16x16x32_bf16 v[208:211], a[228:231], a[252:255], 0
    v_cvt_pk_bf16_f32 v202, v180, v181
    v_cvt_pk_bf16_f32 v203, v182, v183
    v_mfma_f32_16x16x32_bf16 v[172:175], a[4:7], v[252:255], v[172:175]
    ds_read_b128 a[252:255], v227 offset:3072
    v_mfma_f32_16x16x32_bf16 v[208:211], a[8:11], v[252:255], v[208:211]
    v_mfma_f32_16x16x32_bf16 v[204:207], a[12:15], v[252:255], v[204:207]
    s_waitcnt lgkmcnt(2)
    ds_read_b128 v[252:255], v227 offset:4096
    v_mfma_f32_16x16x32_bf16 v[176:179], a[16:19], v[164:167], v[176:179]
    v_mfma_f32_16x16x32_bf16 v[172:175], a[20:23], v[164:167], v[172:175]
    v_mfma_f32_16x16x32_bf16 v[208:211], a[24:27], v[164:167], v[208:211]
    v_mfma_f32_16x16x32_bf16 v[204:207], a[28:31], v[164:167], v[204:207]
    s_waitcnt lgkmcnt(1)
    ds_read_b128 v[164:167], v227 offset:5120
    v_mfma_f32_16x16x32_bf16 v[176:179], a[32:35], a[252:255], v[176:179]
    buffer_store_dwordx4 v[200:203], v226, s[20:23], s58 offen sc0 sc1
    v_mfma_f32_16x16x32_bf16 v[172:175], a[36:39], a[252:255], v[172:175]
    s_add_u32 s58, s51, 0x1f8000
    v_mfma_f32_16x16x32_bf16 v[208:211], a[40:43], a[252:255], v[208:211]
    v_mfma_f32_16x16x32_bf16 v[204:207], a[44:47], a[252:255], v[204:207]
    s_waitcnt lgkmcnt(1)
    v_mfma_f32_16x16x32_bf16 v[176:179], a[48:51], v[252:255], v[176:179]
    v_mfma_f32_16x16x32_bf16 v[172:175], a[52:55], v[252:255], v[172:175]
    v_mfma_f32_16x16x32_bf16 v[208:211], a[56:59], v[252:255], v[208:211]
    v_mfma_f32_16x16x32_bf16 v[204:207], a[60:63], v[252:255], v[204:207]
    s_waitcnt lgkmcnt(0)
    v_mfma_f32_16x16x32_bf16 v[176:179], a[64:67], v[164:167], v[176:179]
    v_mfma_f32_16x16x32_bf16 v[172:175], a[68:71], v[164:167], v[172:175]
    v_mfma_f32_16x16x32_bf16 v[208:211], v[168:171], v[164:167], v[208:211]
    v_mfma_f32_16x16x32_bf16 v[204:207], v[248:251], v[164:167], v[204:207]
    s_nop 4
    v_cvt_pk_bf16_f32 v176, v176, v177
    v_cvt_pk_bf16_f32 v177, v178, v179
    v_cvt_pk_bf16_f32 v178, v172, v173
    v_cvt_pk_bf16_f32 v179, v174, v175
    buffer_store_dwordx4 v[176:179], v246, s[20:23], s58 offen sc0 sc1
    v_cvt_pk_bf16_f32 v208, v208, v209
    v_cvt_pk_bf16_f32 v209, v210, v211
    v_cvt_pk_bf16_f32 v210, v204, v205
    v_cvt_pk_bf16_f32 v211, v206, v207
    buffer_store_dwordx4 v[208:211], v247, s[20:23], s58 offen sc0 sc1
    s_nop 1
    s_cmp_lg_u32 s24, 0
    s_cbranch_scc1 L_safe
L_exit:
    s_endpgm
L_end:
L_safe:
    s_waitcnt vmcnt(0) lgkmcnt(0)
    s_barrier
    v_mbcnt_lo_u32_b32 v0, -1, 0
    v_mbcnt_hi_u32_b32 v0, -1, v0
    s_lshl_b32 s24, s36, 6
    v_add_u32 v0, s24, v0
    s_load_dwordx4 s[24:27], s[0:1], 0
    s_load_dwordx4 s[28:31], s[0:1], 16
    s_load_dwordx2 s[32:33], s[0:1], 32
    v_lshrrev_b32 v74, 6, v0
    v_and_b32 v184, 63, v0
    v_readfirstlane_b32 s36, v74
    v_mul_u32_u24 v76, 0x2aab, v184
    v_lshrrev_b32 v76, 16, v76
    v_mul_u32_u24 v74, 6, v76
    v_sub_u32 v77, v184, v74
    v_lshrrev_b32 v74, 1, v76
    v_and_b32 v74, 4, v74
    v_xor_b32 v76, v76, v74
    v_mul_u32_u24 v74, 0x480, v76
    v_lshl_add_u32 v251, v77, 4, v74
    v_add_u32 v79, 64, v184
    v_mul_u32_u24 v78, 0x2aab, v79
    v_lshrrev_b32 v78, 16, v78
    v_mul_u32_u24 v74, 6, v78
    v_sub_u32 v79, v79, v74
    v_lshrrev_b32 v74, 1, v78
    v_and_b32 v74, 4, v74
    v_xor_b32 v78, v78, v74
    v_mul_u32_u24 v74, 0x480, v78
    v_lshl_add_u32 v252, v79, 4, v74
    v_add_u32 v81, 0x80, v184
    v_mul_u32_u24 v80, 0x2aab, v81
    v_lshrrev_b32 v80, 16, v80
    v_mul_u32_u24 v74, 6, v80
    v_sub_u32 v81, v81, v74
    v_lshrrev_b32 v74, 1, v80
    v_and_b32 v74, 4, v74
    v_xor_b32 v80, v80, v74
    v_mul_u32_u24 v74, 0x480, v80
    v_lshl_add_u32 v253, v81, 4, v74
    s_mul_i32 s49, s36, 0x60
    s_mul_i32 s50, s36, 0xc00
    s_add_u32 s50, s50, 0x15e00
    s_mov_b32 s10, 0x36000
    s_mov_b32 s11, 0x20000
    s_mov_b32 s18, 0x548
    s_mov_b32 s19, 0x20000
    s_mul_i32 s58, s36, 0x152
    v_lshlrev_b32 v199, 1, v184
    s_add_u32 s57, s49, 0x180
    s_add_u32 m0, s50, 0
    s_lshr_b32 s53, s2, 3
    s_and_b32 s54, s2, 1
    s_lshl_b32 s54, s54, 2
    s_lshr_b32 s55, s53, 3
    s_or_b32 s34, s54, s55
    s_and_b32 s35, s53, 7
    s_bfe_u32 s54, s2, 0x10002
    s_mul_i32 s54, s54, 0x15000
    s_bfe_u32 s55, s2, 0x10001
    s_mul_i32 s55, s55, 0x180
    s_add_u32 s38, s54, s55
    s_lshl_b32 s41, s36, 10
    s_add_u32 s42, s41, 0x1000
    s_min_u32 s42, s42, 0x1a00
    s_mul_i32 s54, s35, 14
    s_sub_u32 s54, s54, 3
    s_movk_i32 s53, 0x6f
    s_lshr_b32 s55, s41, 4
    v_add_u32 v96, s55, v184
    v_mul_u32_u24 v97, 0xaab, v96
    v_lshrrev_b32 v97, 16, v97
    v_mul_u32_u24 v98, 24, v97
    v_sub_u32 v96, v96, v98
    v_and_b32 v98, 2, v97
    v_xor_b32 v96, v96, v98
    v_add_u32 v97, s54, v97
    v_med3_i32 v97, v97, 0, s53
    v_mul_u32_u24 v97, 0x300, v97
    v_lshl_add_u32 v246, v96, 4, v97
    s_lshr_b32 s55, s42, 4
    v_add_u32 v96, s55, v184
    v_mul_u32_u24 v97, 0xaab, v96
    v_lshrrev_b32 v97, 16, v97
    v_mul_u32_u24 v98, 24, v97
    v_sub_u32 v96, v96, v98
    v_and_b32 v98, 2, v97
    v_xor_b32 v96, v96, v98
    v_add_u32 v97, s54, v97
    v_med3_i32 v97, v97, 0, s53
    v_mul_u32_u24 v97, 0x300, v97
    v_lshl_add_u32 v247, v96, 4, v97
    s_mul_i32 s51, s34, 0x24c000
    s_add_u32 s51, s51, s38
    s_sub_u32 s39, s51, 0x7e000
    s_cmp_eq_u32 s34, 0
    s_cselect_b32 s43, 8, 0
    s_cselect_b32 s44, 9, 1
    s_cselect_b32 s45, 3, 2
    s_mul_i32 s43, s43, 0x2a000
    s_add_u32 s43, s43, s39
    s_mul_i32 s44, s44, 0x2a000
    s_add_u32 s44, s44, s39
    s_mul_i32 s45, s45, 0x2a000
    s_add_u32 s45, s45, s39
    s_mov_b32 s6, 0x1260000
    s_mov_b32 s7, 0x20000
    s_mov_b32 s14, 0x12000
    s_mov_b32 s15, 0x20000
    s_mov_b32 s22, 0x1260000
    s_mov_b32 s23, 0x20000
    s_add_u32 s56, s39, 0x7e000
    v_lshrrev_b32 v185, 4, v184
    v_and_b32 v186, 7, v184
    v_bfe_u32 v187, v184, 3, 1
    v_bfe_u32 v96, v184, 2, 2
    v_and_b32 v97, 3, v184
    v_and_b32 v103, 1, v185
    v_lshl_add_u32 v99, v185, 3, v96
    v_lshl_add_u32 v99, v103, 2, v99
    v_lshl_add_u32 v101, v97, 3, s50
    s_waitcnt lgkmcnt(0)
    s_mov_b32 s8, s26
    s_and_b32 s9, s27, 0xffff
    s_mov_b32 s16, s30
    s_and_b32 s17, s31, 0xffff
    buffer_load_ushort v196, v199, s[16:19], s58 offen
    buffer_load_ushort v197, v199, s[16:19], s58 offen offset:128
    buffer_load_ushort v198, v199, s[16:19], s58 offen offset:256
    buffer_load_dwordx4 v251, s[8:11], s57 offen lds
    s_add_u32 m0, s50, 0x400
    s_mov_b32 s4, s24
    s_and_b32 s5, s25, 0xffff
    s_mov_b32 s12, s28
    s_and_b32 s13, s29, 0xffff
    buffer_load_dwordx4 v252, s[8:11], s57 offen lds
    s_add_u32 m0, s50, 0x800
    s_mov_b32 s20, s32
    s_and_b32 s21, s33, 0xffff
    s_movk_i32 s27, 0x60
    v_mad_u32_u24 v254, v99, s27, v101
    v_xor_b32 v99, 4, v99
    v_mad_u32_u24 v255, v99, s27, v101
    v_mul_u32_u24 v102, 0x1e40, v187
    v_and_b32 v98, 2, v184
    v_xor_b32 v98, v98, v185
    v_lshlrev_b32 v98, 4, v98
    buffer_load_dwordx4 v253, s[8:11], s57 offen lds
    s_add_u32 m0, s41, 0
    s_add_u32 s57, s49, 0x9180
    v_mul_u32_u24 v100, 0x180, v186
    v_add3_u32 v224, v98, v100, v102
    v_mul_u32_u24 v99, 0x1e40, v96
    v_mul_u32_u24 v227, 0x180, v97
    v_add3_u32 v227, v227, v98, v99
    s_cmp_eq_u32 s35, 0
    s_cselect_b32 s29, 3, 0
    s_cselect_b32 s30, -3, -2
    buffer_load_dwordx4 v246, s[4:7], s43 offen lds
    s_add_u32 m0, s42, 0
    s_mul_i32 s32, s36, 0xf00
    s_add_u32 s32, s32, 0xf200
    s_mov_b32 s40, 0x140
    s_lshl_b32 s31, s36, 10
    s_add_u32 s31, s31, 0x12e40
    v_mul_u32_u24 v119, 13, v184
    v_lshrrev_b32 v119, 8, v119
    v_mul_u32_u24 v118, 20, v119
    v_sub_u32 v118, v184, v118
    buffer_load_dwordx4 v247, s[4:7], s43 offen lds
    s_add_u32 m0, s41, 0x1e40
    v_add_u32 v120, -11, v118
    v_max_i32 v120, 0, v120
    v_mul_u32_u24 v121, 11, v120
    v_lshrrev_b32 v121, 5, v121
    v_mul_u32_u24 v122, 3, v121
    v_sub_u32 v120, v120, v122
    v_lshlrev_b32 v120, 2, v120
    buffer_load_dwordx4 v246, s[4:7], s44 offen lds
    s_add_u32 m0, s42, 0x1e40
    v_sub_u32 v121, v120, v121
    v_cmp_lt_u32 vcc, 10, v118
    v_add_u32 v121, s29, v121
    v_add_u32 v120, s30, v120
    v_add_u32 v122, -3, v118
    v_cndmask_b32 v121, v118, v121, vcc
    v_cndmask_b32 v120, v122, v120, vcc
    buffer_load_dwordx4 v247, s[4:7], s44 offen lds
    s_add_u32 m0, s41, 0x3c80
    v_mad_u32_u24 v121, v119, 13, v121
    v_lshl_add_u32 v121, v121, 2, s31
    s_cmp_eq_u32 s34, 0
    s_cselect_b32 s28, 0x208, 0
    v_add_u32 v122, s28, v121
    v_cmp_gt_u32 s[60:61], 7, v120
    v_add_u32 v120, 1, v120
    v_cmp_gt_u32 s[62:63], 7, v120
    buffer_load_dwordx4 v246, s[4:7], s45 offen lds
    s_add_u32 m0, s42, 0x3c80
    v_add_u32 v120, 1, v120
    v_cmp_gt_u32 s[64:65], 7, v120
    v_add_u32 v120, 1, v120
    v_cmp_gt_u32 s[66:67], 7, v120
    v_lshl_add_u32 v123, v184, 4, s32
    v_lshl_add_u32 v125, v184, 2, s31
    s_mov_b32 s68, 0x40ddb3d7
    buffer_load_dwordx4 v247, s[4:7], s45 offen lds
    s_add_u32 m0, s41, 0x5ac0
    v_mov_b32 v124, 0xf149f2ca
    s_and_b32 s72, s60, 0xfff00000
    s_and_b32 s70, s62, 0xfff00000
    v_mul_u32_u24 v74, 0x180, v76
    v_lshl_add_u32 v192, v77, 4, v74
    v_and_b32 v74, 16, v76
    v_mul_u32_u24 v74, 0x300, v74
    v_add_u32 v86, v74, v192
    v_mul_u32_u24 v74, 0x180, v78
    buffer_load_dwordx4 v246, s[4:7], s56 offen lds
    s_add_u32 m0, s42, 0x5ac0
    v_lshl_add_u32 v193, v79, 4, v74
    v_and_b32 v74, 16, v78
    v_mul_u32_u24 v74, 0x300, v74
    v_add_u32 v87, v74, v193
    v_mul_u32_u24 v74, 0x180, v80
    v_lshl_add_u32 v194, v81, 4, v74
    v_and_b32 v74, 16, v80
    buffer_load_dwordx4 v247, s[4:7], s56 offen lds
    s_add_u32 m0, s50, 0x3000
    s_add_u32 s56, s39, 0xa8000
    v_mul_u32_u24 v74, 0x300, v74
    v_add_u32 v108, v74, v194
    v_add_u32 v98, 3, v186
    v_and_b32 v98, 2, v98
    v_xor_b32 v98, v98, v185
    v_lshl_add_u32 v98, v98, 4, v100
    buffer_load_dwordx4 v251, s[8:11], s57 offen lds
    s_add_u32 m0, s50, 0x3400
    v_add_u32 v225, v98, v102
    v_xor_b32 v99, 1, v187
    v_mul_u32_u24 v99, 0xd3c0, v99
    v_add_u32 v226, v98, v99
    v_lshl_add_u32 v99, v185, 2, v96
    v_and_b32 v98, 2, v185
    v_lshlrev_b32 v98, 1, v98
    buffer_load_dwordx4 v252, s[8:11], s57 offen lds
    s_add_u32 m0, s50, 0x3800
    v_xor_b32 v99, v99, v98
    v_mul_u32_u24 v99, 0x60, v99
    v_lshl_add_u32 v131, v97, 4, v99
    v_lshrrev_b32 v98, 1, v97
    v_mul_u32_u24 v98, 0xba0, v98
    v_add_u32 v64, v131, v98
    v_bfrev_b32 v98, v97
    buffer_load_dwordx4 v253, s[8:11], s57 offen lds
    s_add_u32 s57, s49, 0x12180
    s_add_u32 m0, s50, 0x6000
    v_lshrrev_b32 v98, 27, v98
    v_add3_u32 v109, v99, v98, s50
    v_lshlrev_b32 v99, 7, v185
    v_lshl_add_u32 v99, v186, 4, v99
    v_lshl_add_u32 v101, v187, 9, v99
    v_add_u32 v130, s50, v101
    buffer_load_dwordx4 v251, s[8:11], s57 offen lds
    s_add_u32 m0, s50, 0x6400
    v_lshl_add_u32 v99, v187, 10, v99
    s_and_b32 s24, s36, 1
    s_lshl_b32 s25, s24, 10
    s_add_u32 s26, s25, s50
    v_add_u32 v241, s26, v99
    s_lshr_b32 s27, s36, 1
    s_mul_i32 s26, s27, 0x1800
    s_add_u32 s26, s26, 0x16600
    v_add_u32 v242, s26, v99
    s_sub_u32 s26, s26, 0x7c0
    buffer_load_dwordx4 v252, s[8:11], s57 offen lds
    s_add_u32 m0, s50, 0x6800
    v_add_u32 v65, s26, v64
    s_lshl_b32 s25, s24, 5
    s_add_u32 s26, s25, s50
    v_add_u32 v131, s26, v131
    v_mul_u32_u24 v99, 0x2a000, v187
    v_lshl_add_u32 v99, v100, 1, v99
    v_lshl_add_u32 v99, v185, 4, v99
    v_cmp_lt_u32 vcc, 5, v186
    v_add_u32 v98, 0x1800, v99
    buffer_load_dwordx4 v253, s[8:11], s57 offen lds
    s_add_u32 m0, s41, 0x7900
    s_add_u32 s57, s49, 0x1b180
    v_bfrev_b32 v101, 1
    v_cndmask_b32 v98, v98, v101, vcc
    s_sub_u32 s59, 0, s24
    s_mov_b32 vcc_lo, s59
    s_mov_b32 vcc_hi, s59
    v_cndmask_b32 v101, v99, v98, vcc
    v_cndmask_b32 v102, v98, v99, vcc
    buffer_load_dwordx4 v246, s[4:7], s56 offen lds
    s_add_u32 m0, s42, 0x7900
    s_add_u32 s25, s25, s49
    v_add_u32 v243, s25, v101
    v_add_u32 v245, s25, v102
    s_mul_i32 s26, s27, 0xc0
    s_add_u32 s26, s26, 64
    v_add_u32 v244, s26, v101
    s_mul_i32 s25, s35, 0x2a00
    s_add_u32 s51, s51, s25
    s_add_u32 s58, s51, 0
    v_lshlrev_b32 v99, 4, v184
    v_add_u32 v99, 0x12e00, v99
    s_mul_i32 s25, s24, 0x1800
    v_add_u32 v239, s25, v99
    s_sub_u32 s25, 0x1800, s25
    v_add_u32 v240, s25, v99
    s_mul_i32 s25, s27, 0xc00
    s_lshl_b32 s26, s24, 11
    s_add_u32 s26, s26, s25
    v_add_u32 v237, s26, v99
    s_lshl_b32 s26, s24, 3
    s_add_u32 s26, s26, s25
    s_add_u32 s26, s26, 0x400
    v_add_u32 v238, s26, v99
    s_mov_b32 s37, 0x3e553b95
    s_cmp_eq_u32 s34, 7
    s_cselect_b32 s46, 16, 17
    s_cselect_b32 s47, 10, 18
    s_cselect_b32 s48, 11, 19
    s_mul_i32 s46, s46, 0x2a000
    s_add_u32 s46, s46, s39
    s_mul_i32 s47, s47, 0x2a000
    s_add_u32 s47, s47, s39
    s_mul_i32 s48, s48, 0x2a000
    s_add_u32 s48, s48, s39
    v_mov_b32 v96, 0x3f803f80
    v_accvgpr_write_b32 a216, v96
    v_accvgpr_write_b32 a217, v96
    v_accvgpr_write_b32 a218, v96
    s_waitcnt vmcnt(20)
    v_lshlrev_b32 v196, 16, v196
    v_mul_f32 v196, s68, v196
    ds_write_b32 v125, v196
    s_waitcnt vmcnt(19)
    v_lshlrev_b32 v197, 16, v197
    v_mul_f32 v197, s68, v197
    ds_write_b32 v125, v197 offset:256
    s_waitcnt vmcnt(18)
    v_lshlrev_b32 v198, 16, v198
    v_mul_f32 v198, s68, v198
    ds_write_b32 v125, v198 offset:512
    v_accvgpr_write_b32 a219, v96
    s_cmp_eq_u32 s35, 7
    s_cselect_b32 s33, 2, 64
    buffer_load_dwordx4 v247, s[4:7], s56 offen lds
    s_add_u32 s56, s39, 0xd2000
    s_add_u32 m0, s41, 0x9740
    ds_read2_b32 v[144:145], v121 offset0:26 offset1:27
    ds_read2_b32 v[146:147], v121 offset0:28 offset1:29
    ds_read2_b32 v[148:149], v121 offset0:65 offset1:66
    ds_read2_b32 v[150:151], v121 offset0:67 offset1:68
    ds_read2_b32 v[152:153], v121 offset0:104 offset1:105
    v_lshrrev_b32 v60, 1, v185
    ds_read2_b32 v[154:155], v121 offset0:106 offset1:107
    ds_read2_b32 v[156:157], v122 offset0:0 offset1:1
    ds_read2_b32 v[158:159], v122 offset0:2 offset1:3
    buffer_load_dwordx4 v246, s[4:7], s56 offen lds
    s_add_u32 m0, s42, 0x9740
    v_lshl_add_u32 v61, v187, 1, v60
    v_lshlrev_b32 v232, 2, v61
    v_lshl_add_u32 v61, v187, 2, v185
    v_lshlrev_b32 v233, 2, v61
    v_sub_u32 v60, v60, v187
    v_mul_i32_i24 v60, 0x140, v60
    s_sub_u32 s31, s32, 0x140
    v_add_u32 v60, s31, v60
    v_lshl_add_u32 v61, v103, 2, 3
    v_cmp_gt_u32 vcc, s29, v186
    v_sub_u32 v62, v61, v186
    v_min_u32 v63, 10, v62
    v_mad_u32_u24 v190, v186, 3, v103
    buffer_load_dwordx4 v247, s[4:7], s56 offen lds
    s_add_u32 m0, s50, 0x9000
    s_add_u32 s56, s39, 0xfc000
    s_waitcnt vmcnt(18)
    ds_read_b64_tr_b16 a[0:1], v254
    ds_read_b64_tr_b16 a[2:3], v255
    ds_read_b64_tr_b16 a[4:5], v254 offset:32
    ds_read_b64_tr_b16 a[6:7], v255 offset:32
    ds_read_b64_tr_b16 a[8:9], v254 offset:64
    s_waitcnt lgkmcnt(10)
    v_cndmask_b32 v148, v124, v148, s[60:61]
    ds_read_b64_tr_b16 a[10:11], v255 offset:64
    v_cndmask_b32 v149, v124, v149, s[62:63]
    buffer_load_dwordx4 v251, s[8:11], s57 offen lds
    s_add_u32 m0, s50, 0x9400
    s_waitcnt lgkmcnt(7)
    v_cndmask_b32 v150, v124, v150, s[64:65]
    v_cndmask_b32 v151, v124, v151, s[66:67]
    s_and_b32 s61, s61, 0xfffffff
    v_cndmask_b32 v156, v124, v156, s[60:61]
    s_and_b32 s63, s63, 0xfffffff
    v_cndmask_b32 v157, v124, v157, s[62:63]
    s_and_b32 s65, s65, 0xfffffff
    s_waitcnt lgkmcnt(6)
    v_cndmask_b32 v158, v124, v158, s[64:65]
    s_and_b32 s67, s67, 0xfffffff
    v_cndmask_b32 v159, v124, v159, s[66:67]
    s_mov_b32 s73, s61
    buffer_load_dwordx4 v252, s[8:11], s57 offen lds
    s_add_u32 m0, s50, 0x9800
    v_cndmask_b32 v144, v124, v144, s[72:73]
    s_mov_b32 s71, s63
    v_cndmask_b32 v145, v124, v145, s[70:71]
    s_and_b32 s72, s64, 0xfff00000
    s_mov_b32 s73, s65
    v_cndmask_b32 v146, v124, v146, s[72:73]
    s_and_b32 s70, s66, 0xfff00000
    s_mov_b32 s71, s67
    v_cndmask_b32 v147, v124, v147, s[70:71]
    s_and_b32 s61, s61, 0xff
    v_cndmask_b32 v152, v124, v152, s[60:61]
    s_and_b32 s63, s63, 0xff
    v_cndmask_b32 v153, v124, v153, s[62:63]
    buffer_load_dwordx4 v253, s[8:11], s57 offen lds
    s_add_u32 s57, s49, 0x24180
    s_add_u32 m0, s50, 0xc000
    s_and_b32 s65, s65, 0xff
    v_cndmask_b32 v154, v124, v154, s[64:65]
    s_and_b32 s67, s67, 0xff
    v_cndmask_b32 v155, v124, v155, s[66:67]
    ds_write_b128 v123, v[144:147]
    buffer_load_dwordx4 v251, s[8:11], s57 offen lds
    s_add_u32 m0, s50, 0xc400
    s_waitcnt vmcnt(18)
    s_barrier
    ds_write_b128 v123, v[148:151] offset:960
    ds_write_b128 v123, v[152:155] offset:1920
    ds_write_b128 v123, v[156:159] offset:2880
    buffer_load_dwordx4 v252, s[8:11], s57 offen lds
    s_add_u32 m0, s50, 0xc800
    v_add_u32 v191, 11, v190
    v_cndmask_b32 v63, v63, v191, vcc
    v_lshl_add_u32 v228, v63, 4, v60
    v_add_u32 v62, 8, v62
    v_min_u32 v63, 10, v62
    v_lshl_add_u32 v62, v103, 4, v186
    v_cmp_gt_u32 vcc, s29, v62
    v_add_u32 v191, 13, v190
    v_min_u32 v62, 5, v186
    buffer_load_dwordx4 v253, s[8:11], s57 offen lds
    s_add_u32 m0, s41, 0xb580
    s_add_u32 s57, s49, 0x2d180
    v_cndmask_b32 v63, v63, v191, vcc
    v_lshl_add_u32 v229, v63, 4, v60
    v_cmp_lt_u32 vcc, s33, v62
    v_sub_u32 v63, v61, v62
    v_min_u32 v63, 10, v63
    v_mad_u32_u24 v190, v62, 3, 2
    v_add_u32 v191, v190, v103
    v_cndmask_b32 v63, v63, v191, vcc
    v_lshl_add_u32 v230, v63, 4, v60
    v_sub_u32 v63, 11, v62
    buffer_load_dwordx4 v246, s[4:7], s56 offen lds
    s_add_u32 m0, s42, 0xb580
    v_min_u32 v63, 10, v63
    v_add_u32 v191, 2, v190
    v_cndmask_b32 v63, v63, v191, vcc
    s_mov_b32 vcc_lo, s59
    s_mov_b32 vcc_hi, s59
    v_lshl_add_u32 v231, v63, 4, s32
    s_mov_b32 s60, 0x2222
    ds_read_b128 a[236:239], v224
    ds_read_b128 a[240:243], v224 offset:64
    s_mov_b32 s61, 0x4444
    s_mov_b32 s62, 0x8808
    buffer_load_dwordx4 v247, s[4:7], s56 offen lds
    s_add_u32 s56, s39, 0x126000
    s_add_u32 m0, s41, 0xd3c0
    ds_read_b128 a[244:247], v224 offset:128
    ds_read_b128 a[248:251], v224 offset:192
    s_waitcnt vmcnt(18)
    s_barrier
    s_mov_b32 s63, 0x32104321
    ds_read_b128 a[252:255], v224 offset:256
    s_mov_b32 s64, 0x76540765
    s_mov_b32 s65, 0x2222
    s_mov_b32 s66, 0x10002100
    ds_read_b128 a[220:223], v224 offset:320
    s_mov_b32 s67, 0x54326543
    s_mov_b32 s68, 0x760007
    s_mov_b32 s69, 0x32104321
    buffer_load_dwordx4 v246, s[4:7], s56 offen lds
    s_add_u32 m0, s42, 0xd3c0
    ds_read_b128 a[224:227], v224 offset:3072
    ds_read_b128 a[228:231], v224 offset:3136
    s_mov_b32 s70, 0x76540765
    s_mov_b32 s71, 0x10002100
    s_mov_b32 s72, 0x760007
    ds_read_b128 a[232:235], v224 offset:3200
    s_mov_b32 s73, 0x2222
    s_mov_b32 s74, 0x8808
    s_mov_b32 s75, 0x760007
    s_waitcnt lgkmcnt(8)
    v_mfma_f32_16x16x32_bf16 v[220:223], a[0:3], a[236:239], 0
    s_mov_b32 s76, 0x10002100
    ds_read_b128 v[160:163], v228 offset:1920
    s_mov_b32 s77, 0x6666
    v_mfma_f32_16x16x32_bf16 v[216:219], a[4:7], a[236:239], 0
    s_mov_b32 s78, 0x8808
    buffer_load_dwordx4 v247, s[4:7], s56 offen lds
    v_mfma_f32_16x16x32_bf16 v[212:215], a[8:11], a[236:239], 0
    s_add_u32 m0, s50, 0xf000
    ds_read_b128 a[236:239], v224 offset:3264
    ds_read_b128 v[164:167], v229 offset:1920
    s_add_u32 s56, s39, 0x150000
    s_mov_b32 s79, 0x32104321
    s_mov_b32 s80, 0x76540765
    s_cmp_eq_u32 s34, 0
    s_cmov_b32 s60, 0xbbbb
    s_cmov_b32 s61, 0x4241
    v_bfe_u32 v234, s60, v232, 4
    v_mad_u32_u24 v235, v234, s40, v228
    buffer_load_dwordx4 v251, s[8:11], s57 offen lds
    s_waitcnt lgkmcnt(5)
    v_mfma_f32_16x16x32_bf16 v[208:211], a[0:3], a[224:227], 0
    s_add_u32 m0, s50, 0xf400
    s_waitcnt vmcnt(18)
    ds_read_b64_tr_b16 a[12:13], v254 offset:12288
    ds_read_b64_tr_b16 a[14:15], v255 offset:12288
    v_mfma_f32_16x16x32_bf16 v[204:207], a[4:7], a[224:227], 0
    s_cmp_eq_u32 s34, 0
    s_cmov_b32 s62, 0x8898
    s_cmov_b32 s63, 0x30a940ba
    v_mfma_f32_16x16x32_bf16 v[200:203], a[8:11], a[224:227], 0
    s_cmp_eq_u32 s34, 0
    s_cmov_b32 s64, 0x76549765
    s_cmov_b32 s65, 0x2221
    buffer_load_dwordx4 v252, s[8:11], s57 offen lds
    s_add_u32 m0, s50, 0xf800
    ds_read_b128 a[224:227], v224 offset:15680
    ds_read_b64_tr_b16 a[16:17], v254 offset:12320
    ds_read_b64_tr_b16 a[18:19], v255 offset:12320
    v_mad_u32_u24 v234, v234, s40, v229
    ds_read_b64_tr_b16 a[20:21], v254 offset:12352
    ds_read_b64_tr_b16 a[22:23], v255 offset:12352
    ds_read_b128 v[144:147], v235
    v_bfe_u32 v250, s61, v232, 4
    v_bfe_u32 v235, s62, v232, 4
    s_cmp_eq_u32 s34, 0
    s_cmov_b32 s66, 0x10002000
    s_cmov_b32 s68, 0x760097
    buffer_load_dwordx4 v253, s[8:11], s57 offen lds
    s_add_u32 s57, s49, 0x300
    s_add_u32 m0, s50, 0
    ds_read_b128 v[148:151], v234
    s_waitcnt lgkmcnt(7)
    v_mfma_f32_16x16x32_bf16 v[220:223], a[12:15], a[240:243], v[220:223]
    s_cmp_eq_u32 s34, 7
    s_cmov_b32 s73, 0x2d22
    s_cmov_b32 s74, 0x1808
    v_mfma_f32_16x16x32_bf16 v[208:211], a[12:15], a[228:231], v[208:211]
    s_cmp_eq_u32 s34, 7
    s_cmov_b32 s75, 0x60007
    s_cmov_b32 s76, 0x1b002100
    v_mad_u32_u24 v234, v250, s40, v229
    ds_read_b128 v[152:155], v234
    buffer_load_dwordx4 v251, s[8:11], s57 offen lds
    s_waitcnt vmcnt(18)
    ds_read_b64_tr_b16 a[24:25], v254 offset:24576
    ds_read_b64_tr_b16 a[26:27], v255 offset:24576
    s_add_u32 m0, s50, 0x400
    s_waitcnt lgkmcnt(7)
    v_mfma_f32_16x16x32_bf16 v[216:219], a[16:19], a[240:243], v[216:219]
    s_cmp_eq_u32 s34, 7
    s_cmov_b32 s77, 0x1606
    s_cmov_b32 s78, 0xbbbb
    s_waitcnt lgkmcnt(5)
    v_mfma_f32_16x16x32_bf16 v[212:215], a[20:23], a[240:243], v[212:215]
    s_cmp_eq_u32 s34, 7
    s_cmov_b32 s79, 0x321b4321
    s_cmov_b32 s80, 0xa904ba05
    v_mfma_f32_16x16x32_bf16 v[204:207], a[16:19], a[228:231], v[204:207]
    ds_read_b128 a[240:243], v224 offset:3328
    ds_read_b64_tr_b16 a[28:29], v254 offset:24608
    v_mfma_f32_16x16x32_bf16 v[200:203], a[20:23], a[228:231], v[200:203]
    s_waitcnt lgkmcnt(2)
    ds_read_b128 a[228:231], v224 offset:15744
    buffer_load_dwordx4 v252, s[8:11], s57 offen lds
    ds_read_b64_tr_b16 a[30:31], v255 offset:24608
    ds_read_b64_tr_b16 a[32:33], v254 offset:24640
    s_add_u32 m0, s50, 0x800
    ds_read_b64_tr_b16 a[34:35], v255 offset:24640
    v_mad_u32_u24 v250, v250, s40, v228
    ds_read_b128 v[156:159], v250
    v_mad_u32_u24 v250, v235, s40, v229
    v_mad_u32_u24 v235, v235, s40, v228
    v_bfe_u32 v234, s60, v232, 4
    buffer_load_dwordx4 v253, s[8:11], s57 offen lds
    v_mfma_f32_16x16x32_bf16 v[220:223], a[24:27], a[244:247], v[220:223]
    s_add_u32 s57, s49, 0x9300
    ds_read_b128 v[168:171], v250
    v_mad_u32_u24 v234, v234, s40, v230
    v_mfma_f32_16x16x32_bf16 v[208:211], a[24:27], a[232:235], v[208:211]
    s_add_u32 m0, s50, 0x3000
    ds_read_b128 v[172:175], v235
    v_bfe_u32 v235, s61, v232, 4
    v_mad_u32_u24 v235, v235, s40, v230
    v_bfe_u32 v250, s62, v232, 4
    v_mad_u32_u24 v250, v250, s40, v230
    buffer_load_dwordx4 v251, s[8:11], s57 offen lds
    s_add_u32 m0, s50, 0x3400
    s_nop 0
    s_waitcnt lgkmcnt(5)
    v_mfma_f32_16x16x32_bf16 v[216:219], a[28:31], a[244:247], v[216:219]
    s_waitcnt lgkmcnt(3)
    v_mfma_f32_16x16x32_bf16 v[212:215], a[32:35], a[244:247], v[212:215]
    ds_read_b128 a[244:247], v224 offset:3392
    v_mfma_f32_16x16x32_bf16 v[204:207], a[28:31], a[232:235], v[204:207]
    s_waitcnt vmcnt(14)
    v_mfma_f32_16x16x32_bf16 v[200:203], a[32:35], a[232:235], v[200:203]
    s_barrier
    ds_read_b128 a[232:235], v224 offset:15808
    buffer_load_dwordx4 v252, s[8:11], s57 offen lds
    s_add_u32 m0, s50, 0x3800
    s_nop 0
    buffer_load_dwordx4 v253, s[8:11], s57 offen lds
    s_add_u32 s57, s49, 0x12300
    s_add_u32 m0, s50, 0x6000
    s_nop 0
    buffer_load_dwordx4 v251, s[8:11], s57 offen lds
    s_add_u32 m0, s50, 0x6400
    s_nop 0
    ds_read_b64_tr_b16 a[36:37], v254 offset:36864
    ds_read_b64_tr_b16 a[38:39], v255 offset:36864
    ds_read_b64_tr_b16 a[40:41], v254 offset:36896
    ds_read_b64_tr_b16 a[42:43], v255 offset:36896
    ds_read_b64_tr_b16 a[44:45], v254 offset:36928
    buffer_load_dwordx4 v252, s[8:11], s57 offen lds
    ds_read_b64_tr_b16 a[46:47], v255 offset:36928
    s_add_u32 m0, s50, 0x6800
    s_nop 0
    buffer_load_dwordx4 v253, s[8:11], s57 offen lds
    s_add_u32 s57, s49, 0x1b300
    s_add_u32 m0, s50, 0x9000
    s_waitcnt lgkmcnt(4)
    v_mfma_f32_16x16x32_bf16 v[220:223], a[36:39], a[248:251], v[220:223]
    s_waitcnt lgkmcnt(2)
    v_mfma_f32_16x16x32_bf16 v[216:219], a[40:43], a[248:251], v[216:219]
    s_waitcnt lgkmcnt(0)
    v_mfma_f32_16x16x32_bf16 v[212:215], a[44:47], a[248:251], v[212:215]
    ds_read_b128 a[248:251], v224 offset:15488
    v_mfma_f32_16x16x32_bf16 v[208:211], a[36:39], a[236:239], v[208:211]
    s_waitcnt vmcnt(16)
    buffer_load_dwordx4 v251, s[8:11], s57 offen lds
    v_mfma_f32_16x16x32_bf16 v[204:207], a[40:43], a[236:239], v[204:207]
    s_add_u32 m0, s50, 0x9400
    ds_read_b64_tr_b16 a[48:49], v254 offset:49152
    ds_read_b64_tr_b16 a[50:51], v255 offset:49152
    v_mfma_f32_16x16x32_bf16 v[200:203], a[44:47], a[236:239], v[200:203]
    s_waitcnt lgkmcnt(0)
    ds_read_b128 a[236:239], v224 offset:18560
    ds_read_b64_tr_b16 a[52:53], v254 offset:49184
    ds_read_b64_tr_b16 a[54:55], v255 offset:49184
    buffer_load_dwordx4 v252, s[8:11], s57 offen lds
    ds_read_b64_tr_b16 a[56:57], v254 offset:49216
    ds_read_b64_tr_b16 a[58:59], v255 offset:49216
    s_add_u32 m0, s50, 0x9800
    s_nop 0
    buffer_load_dwordx4 v253, s[8:11], s57 offen lds
    s_add_u32 s57, s49, 0x24300
    s_add_u32 m0, s50, 0xc000
    v_mfma_f32_16x16x32_bf16 v[220:223], a[48:51], a[252:255], v[220:223]
    v_mfma_f32_16x16x32_bf16 v[208:211], a[48:51], a[240:243], v[208:211]
    s_waitcnt lgkmcnt(2)
    v_mfma_f32_16x16x32_bf16 v[216:219], a[52:55], a[252:255], v[216:219]
    s_waitcnt lgkmcnt(0)
    v_mfma_f32_16x16x32_bf16 v[212:215], a[56:59], a[252:255], v[212:215]
    ds_read_b128 a[252:255], v224 offset:15552
    v_mfma_f32_16x16x32_bf16 v[204:207], a[52:55], a[240:243], v[204:207]
    s_waitcnt vmcnt(12)
    buffer_load_dwordx4 v251, s[8:11], s57 offen lds
    v_mfma_f32_16x16x32_bf16 v[200:203], a[56:59], a[240:243], v[200:203]
    s_add_u32 m0, s50, 0xc400
    ds_read_b128 a[240:243], v224 offset:18624
    buffer_load_dwordx4 v252, s[8:11], s57 offen lds
    s_add_u32 m0, s50, 0xc800
    s_nop 0
    s_barrier
    buffer_load_dwordx4 v253, s[8:11], s57 offen lds
    s_add_u32 s57, s49, 0x2d300
    s_add_u32 m0, s50, 0xf000
    ds_read_b64_tr_b16 a[60:61], v254 offset:61440
    ds_read_b64_tr_b16 a[62:63], v255 offset:61440
    ds_read_b64_tr_b16 a[64:65], v254 offset:61472
    ds_read_b64_tr_b16 a[66:67], v255 offset:61472
    ds_read_b64_tr_b16 a[68:69], v254 offset:61504
    ds_read_b64_tr_b16 a[70:71], v255 offset:61504
    s_waitcnt lgkmcnt(4)
    v_mfma_f32_16x16x32_bf16 v[220:223], a[60:63], a[220:223], v[220:223]
    s_waitcnt lgkmcnt(2)
    v_mfma_f32_16x16x32_bf16 v[216:219], a[64:67], a[220:223], v[216:219]
    s_waitcnt lgkmcnt(0)
    v_mfma_f32_16x16x32_bf16 v[212:215], a[68:71], a[220:223], v[212:215]
    ds_read_b128 a[220:223], v224 offset:15616
    v_mfma_f32_16x16x32_bf16 v[208:211], a[60:63], a[244:247], v[208:211]
    s_waitcnt vmcnt(12)
    buffer_load_dwordx4 v251, s[8:11], s57 offen lds
    v_mfma_f32_16x16x32_bf16 v[204:207], a[64:67], a[244:247], v[204:207]
    s_add_u32 m0, s50, 0xf400
    ds_read_b64_tr_b16 a[72:73], v254
    v_cvt_pk_bf16_f32 v0, v220, v221
    v_mfma_f32_16x16x32_bf16 v[200:203], a[68:71], a[244:247], v[200:203]
    v_cvt_pk_bf16_f32 v1, v222, v223
    v_cvt_pk_bf16_f32 v2, v216, v217
    v_mfma_f32_16x16x32_bf16 v[220:223], a[0:3], a[248:251], 0
    v_cvt_pk_bf16_f32 v3, v218, v219
    v_cvt_pk_bf16_f32 v4, v212, v213
    v_mfma_f32_16x16x32_bf16 v[220:223], a[12:15], a[252:255], v[220:223]
    v_cvt_pk_bf16_f32 v5, v214, v215
    v_cvt_pk_bf16_f32 v24, v208, v209
    v_mfma_f32_16x16x32_bf16 v[216:219], a[4:7], a[248:251], 0
    v_cvt_pk_bf16_f32 v25, v210, v211
    v_cvt_pk_bf16_f32 v26, v204, v205
    v_mfma_f32_16x16x32_bf16 v[216:219], a[16:19], a[252:255], v[216:219]
    v_cvt_pk_bf16_f32 v27, v206, v207
    v_cvt_pk_bf16_f32 v28, v200, v201
    v_mfma_f32_16x16x32_bf16 v[212:215], a[8:11], a[248:251], 0
    ds_read_b128 a[244:247], v224 offset:18688
    v_cvt_pk_bf16_f32 v29, v202, v203
    v_mfma_f32_16x16x32_bf16 v[212:215], a[20:23], a[252:255], v[212:215]
    s_waitcnt lgkmcnt(2)
    ds_read_b128 a[248:251], v224 offset:18752
    ds_read_b128 a[252:255], v224 offset:18816
    v_mfma_f32_16x16x32_bf16 v[220:223], a[24:27], a[220:223], v[220:223]
    buffer_load_dwordx4 v252, s[8:11], s57 offen lds
    v_mfma_f32_16x16x32_bf16 v[220:223], a[36:39], a[224:227], v[220:223]
    s_add_u32 m0, s50, 0xf800
    ds_read_b64_tr_b16 a[74:75], v255
    ds_read_b64_tr_b16 a[76:77], v254 offset:32
    v_mfma_f32_16x16x32_bf16 v[216:219], a[28:31], a[220:223], v[216:219]
    buffer_load_dwordx4 v253, s[8:11], s57 offen lds
    v_mfma_f32_16x16x32_bf16 v[216:219], a[40:43], a[224:227], v[216:219]
    s_add_u32 s57, s49, 0
    ds_read_b64_tr_b16 a[78:79], v255 offset:32
    ds_read_b64_tr_b16 a[80:81], v254 offset:64
    v_mfma_f32_16x16x32_bf16 v[212:215], a[32:35], a[220:223], v[212:215]
    s_add_u32 m0, s50, 0
    ds_read_b128 a[220:223], v224 offset:18880
    ds_read_b64_tr_b16 a[82:83], v255 offset:64
    v_mfma_f32_16x16x32_bf16 v[212:215], a[44:47], a[224:227], v[212:215]
    ds_read_b128 a[224:227], v227 offset:6144
    v_mfma_f32_16x16x32_bf16 v[220:223], a[48:51], a[228:231], v[220:223]
    s_waitcnt vmcnt(12)
    ds_read_b64_tr_b16 a[84:85], v254 offset:12288
    ds_read_b64_tr_b16 a[86:87], v255 offset:12288
    v_mfma_f32_16x16x32_bf16 v[220:223], a[60:63], a[232:235], v[220:223]
    ds_read_b64_tr_b16 a[88:89], v254 offset:12320
    ds_read_b64_tr_b16 a[90:91], v255 offset:12320
    v_mfma_f32_16x16x32_bf16 v[216:219], a[52:55], a[228:231], v[216:219]
    ds_read_b64_tr_b16 a[92:93], v254 offset:12352
    ds_read_b64_tr_b16 a[94:95], v255 offset:12352
    v_mfma_f32_16x16x32_bf16 v[216:219], a[64:67], a[232:235], v[216:219]
    v_mfma_f32_16x16x32_bf16 v[212:215], a[56:59], a[228:231], v[212:215]
    ds_read_b128 a[228:231], v227 offset:6208
    v_cvt_pk_bf16_f32 v6, v220, v221
    v_mfma_f32_16x16x32_bf16 v[212:215], a[68:71], a[232:235], v[212:215]
    ds_read_b128 a[232:235], v227 offset:6272
    v_cvt_pk_bf16_f32 v7, v222, v223
    v_mfma_f32_16x16x32_bf16 v[208:211], a[0:3], a[236:239], 0
    v_mfma_f32_16x16x32_bf16 v[208:211], a[12:15], a[240:243], v[208:211]
    v_cvt_pk_bf16_f32 v8, v216, v217
    v_cvt_pk_bf16_f32 v9, v218, v219
    v_mfma_f32_16x16x32_bf16 v[204:207], a[4:7], a[236:239], 0
    s_waitcnt lgkmcnt(9)
    buffer_load_dwordx4 v251, s[8:11], s57 offen lds
    v_mfma_f32_16x16x32_bf16 v[204:207], a[16:19], a[240:243], v[204:207]
    s_add_u32 m0, s50, 0x400
    v_cvt_pk_bf16_f32 v10, v212, v213
    v_cvt_pk_bf16_f32 v11, v214, v215
    v_mfma_f32_16x16x32_bf16 v[200:203], a[8:11], a[236:239], 0
    s_waitcnt vmcnt(10)
    ds_read_b128 a[236:239], v227 offset:6336
    ds_read_b64_tr_b16 a[96:97], v254 offset:24576
    v_mfma_f32_16x16x32_bf16 v[200:203], a[20:23], a[240:243], v[200:203]
    ds_read_b128 a[240:243], v227 offset:6400
    v_mfma_f32_16x16x32_bf16 v[208:211], a[24:27], a[244:247], v[208:211]
    buffer_load_dwordx4 v252, s[8:11], s57 offen lds
    v_mfma_f32_16x16x32_bf16 v[208:211], a[36:39], a[248:251], v[208:211]
    s_add_u32 m0, s50, 0x800
    ds_read_b64_tr_b16 a[98:99], v255 offset:24576
    ds_read_b64_tr_b16 a[100:101], v254 offset:24608
    v_mfma_f32_16x16x32_bf16 v[204:207], a[28:31], a[244:247], v[204:207]
    buffer_load_dwordx4 v253, s[8:11], s57 offen lds
    v_mfma_f32_16x16x32_bf16 v[204:207], a[40:43], a[248:251], v[204:207]
    s_add_u32 s57, s49, 0x9000
    ds_read_b64_tr_b16 a[102:103], v255 offset:24608
    ds_read_b64_tr_b16 a[104:105], v254 offset:24640
    v_mfma_f32_16x16x32_bf16 v[200:203], a[32:35], a[244:247], v[200:203]
    s_add_u32 m0, s50, 0x3000
    ds_read_b128 a[244:247], v227 offset:6464
    ds_read_b64_tr_b16 a[106:107], v255 offset:24640
    v_mfma_f32_16x16x32_bf16 v[200:203], a[44:47], a[248:251], v[200:203]
    ds_read_b128 a[248:251], v224 offset:30976
    v_mfma_f32_16x16x32_bf16 v[208:211], a[48:51], a[252:255], v[208:211]
    s_waitcnt lgkmcnt(10)
    buffer_load_dwordx4 v251, s[8:11], s57 offen lds
    v_mfma_f32_16x16x32_bf16 v[208:211], a[60:63], a[220:223], v[208:211]
    s_add_u32 m0, s50, 0x3400
    v_mfma_f32_16x16x32_bf16 v[204:207], a[52:55], a[252:255], v[204:207]
    v_mfma_f32_16x16x32_bf16 v[204:207], a[64:67], a[220:223], v[204:207]
    s_waitcnt vmcnt(10)
    buffer_load_dwordx4 v252, s[8:11], s57 offen lds
    v_mfma_f32_16x16x32_bf16 v[200:203], a[56:59], a[252:255], v[200:203]
    s_add_u32 m0, s50, 0x3800
    ds_read_b128 a[252:255], v224 offset:31040
    ds_read_b64_tr_b16 a[108:109], v254 offset:36864
    v_mfma_f32_16x16x32_bf16 v[200:203], a[68:71], a[220:223], v[200:203]
    v_cvt_pk_bf16_f32 v30, v208, v209
    v_cvt_pk_bf16_f32 v31, v210, v211
    v_mfma_f32_16x16x32_bf16 v[220:223], a[0:3], a[224:227], 0
    v_cvt_pk_bf16_f32 v32, v204, v205
    v_cvt_pk_bf16_f32 v33, v206, v207
    v_mfma_f32_16x16x32_bf16 v[220:223], a[12:15], a[228:231], v[220:223]
    ds_read_b128 a[220:223], v224 offset:31104
    ds_read_b64_tr_b16 a[110:111], v255 offset:36864
    v_mfma_f32_16x16x32_bf16 v[216:219], a[4:7], a[224:227], 0
    v_cvt_pk_bf16_f32 v34, v200, v201
    v_cvt_pk_bf16_f32 v35, v202, v203
    v_mfma_f32_16x16x32_bf16 v[216:219], a[16:19], a[228:231], v[216:219]
    buffer_load_dwordx4 v253, s[8:11], s57 offen lds
    v_mfma_f32_16x16x32_bf16 v[212:215], a[8:11], a[224:227], 0
    s_add_u32 s57, s49, 0x12000
    ds_read_b128 a[224:227], v224 offset:31168
    ds_read_b64_tr_b16 a[112:113], v254 offset:36896
    v_mfma_f32_16x16x32_bf16 v[212:215], a[20:23], a[228:231], v[212:215]
    s_add_u32 m0, s50, 0x6000
    ds_read_b128 a[228:231], v224 offset:31232
    v_mfma_f32_16x16x32_bf16 v[220:223], a[24:27], a[232:235], v[220:223]
    s_waitcnt lgkmcnt(7)
    buffer_load_dwordx4 v251, s[8:11], s57 offen lds
    v_mfma_f32_16x16x32_bf16 v[220:223], a[36:39], a[236:239], v[220:223]
    s_add_u32 m0, s50, 0x6400
    ds_read_b64_tr_b16 a[114:115], v255 offset:36896
    ds_read_b64_tr_b16 a[116:117], v254 offset:36928
    v_mfma_f32_16x16x32_bf16 v[216:219], a[28:31], a[232:235], v[216:219]
    ds_read_b64_tr_b16 a[118:119], v255 offset:36928
    v_mfma_f32_16x16x32_bf16 v[216:219], a[40:43], a[236:239], v[216:219]
    v_mfma_f32_16x16x32_bf16 v[212:215], a[32:35], a[232:235], v[212:215]
    s_waitcnt vmcnt(10)
    ds_read_b128 a[232:235], v224 offset:31296
    ds_read_b64_tr_b16 a[120:121], v254 offset:49152
    v_mfma_f32_16x16x32_bf16 v[212:215], a[44:47], a[236:239], v[212:215]
    ds_read_b128 a[236:239], v224 offset:34048
    v_mfma_f32_16x16x32_bf16 v[220:223], a[48:51], a[240:243], v[220:223]
    buffer_load_dwordx4 v252, s[8:11], s57 offen lds
    v_mfma_f32_16x16x32_bf16 v[220:223], a[60:63], a[244:247], v[220:223]
    s_add_u32 m0, s50, 0x6800
    ds_read_b64_tr_b16 a[122:123], v255 offset:49152
    ds_read_b64_tr_b16 a[124:125], v254 offset:49184
    v_mfma_f32_16x16x32_bf16 v[216:219], a[52:55], a[240:243], v[216:219]
    buffer_load_dwordx4 v253, s[8:11], s57 offen lds
    v_mfma_f32_16x16x32_bf16 v[216:219], a[64:67], a[244:247], v[216:219]
    s_add_u32 s57, s49, 0x1b000
    ds_read_b64_tr_b16 a[126:127], v255 offset:49184
    v_cvt_pk_bf16_f32 v48, v220, v221
    v_mfma_f32_16x16x32_bf16 v[212:215], a[56:59], a[240:243], v[212:215]
    s_add_u32 m0, s50, 0x9000
    ds_read_b128 a[240:243], v224 offset:34112
    v_cvt_pk_bf16_f32 v49, v222, v223
    v_mfma_f32_16x16x32_bf16 v[212:215], a[68:71], a[244:247], v[212:215]
    v_cvt_pk_bf16_f32 v50, v216, v217
    v_cvt_pk_bf16_f32 v51, v218, v219
    v_mfma_f32_16x16x32_bf16 v[208:211], a[0:3], a[248:251], 0
    s_waitcnt lgkmcnt(7)
    ds_read_b128 a[244:247], v224 offset:34176
    ds_read_b64_tr_b16 a[128:129], v254 offset:49216
    v_mfma_f32_16x16x32_bf16 v[208:211], a[12:15], a[252:255], v[208:211]
    buffer_load_dwordx4 v251, s[8:11], s57 offen lds
    v_mfma_f32_16x16x32_bf16 v[204:207], a[4:7], a[248:251], 0
    s_add_u32 m0, s50, 0x9400
    v_cvt_pk_bf16_f32 v52, v212, v213
    v_cvt_pk_bf16_f32 v53, v214, v215
    v_mfma_f32_16x16x32_bf16 v[204:207], a[16:19], a[252:255], v[204:207]
    ds_read_b64_tr_b16 a[130:131], v255 offset:49216
    v_mfma_f32_16x16x32_bf16 v[200:203], a[8:11], a[248:251], 0
    s_waitcnt vmcnt(10)
    ds_read_b128 a[248:251], v224 offset:34240
    ds_read_b64_tr_b16 a[132:133], v254 offset:61440
    v_mfma_f32_16x16x32_bf16 v[200:203], a[20:23], a[252:255], v[200:203]
    ds_read_b128 a[252:255], v224 offset:34304
    v_mfma_f32_16x16x32_bf16 v[208:211], a[24:27], a[220:223], v[208:211]
    buffer_load_dwordx4 v252, s[8:11], s57 offen lds
    v_mfma_f32_16x16x32_bf16 v[208:211], a[36:39], a[224:227], v[208:211]
    s_add_u32 m0, s50, 0x9800
    ds_read_b64_tr_b16 a[134:135], v255 offset:61440
    ds_read_b64_tr_b16 a[136:137], v254 offset:61472
    v_mfma_f32_16x16x32_bf16 v[204:207], a[28:31], a[220:223], v[204:207]
    ds_read_b64_tr_b16 a[138:139], v255 offset:61472
    ds_read_b64_tr_b16 a[140:141], v254 offset:61504
    v_mfma_f32_16x16x32_bf16 v[204:207], a[40:43], a[224:227], v[204:207]
    buffer_load_dwordx4 v253, s[8:11], s57 offen lds
    v_mfma_f32_16x16x32_bf16 v[200:203], a[32:35], a[220:223], v[200:203]
    s_add_u32 s57, s49, 0x24000
    ds_read_b128 a[220:223], v224 offset:34368
    ds_read_b64_tr_b16 a[142:143], v255 offset:61504
    v_mfma_f32_16x16x32_bf16 v[200:203], a[44:47], a[224:227], v[200:203]
    s_add_u32 m0, s50, 0xc000
    ds_read_b128 a[224:227], v224 offset:46464
    v_mfma_f32_16x16x32_bf16 v[208:211], a[48:51], a[228:231], v[208:211]
    s_waitcnt lgkmcnt(10)
    v_mfma_f32_16x16x32_bf16 v[208:211], a[60:63], a[232:235], v[208:211]
    buffer_load_dwordx4 v251, s[8:11], s57 offen lds
    v_mfma_f32_16x16x32_bf16 v[204:207], a[52:55], a[228:231], v[204:207]
    s_add_u32 m0, s50, 0xc400
    v_mfma_f32_16x16x32_bf16 v[204:207], a[64:67], a[232:235], v[204:207]
    v_mfma_f32_16x16x32_bf16 v[200:203], a[56:59], a[228:231], v[200:203]
    s_waitcnt vmcnt(10)
    ds_read_b128 a[228:231], v224 offset:46528
    ds_read_b64_tr_b16 a[144:145], v254
    v_mfma_f32_16x16x32_bf16 v[200:203], a[68:71], a[232:235], v[200:203]
    v_cvt_pk_bf16_f32 v12, v208, v209
    v_cvt_pk_bf16_f32 v13, v210, v211
    v_mfma_f32_16x16x32_bf16 v[220:223], a[0:3], a[236:239], 0
    ds_read_b128 a[232:235], v224 offset:46592
    v_cvt_pk_bf16_f32 v14, v204, v205
    v_mfma_f32_16x16x32_bf16 v[220:223], a[12:15], a[240:243], v[220:223]
    ds_read_b64_tr_b16 a[146:147], v255
    v_cvt_pk_bf16_f32 v15, v206, v207
    v_mfma_f32_16x16x32_bf16 v[216:219], a[4:7], a[236:239], 0
    v_cvt_pk_bf16_f32 v16, v200, v201
    v_cvt_pk_bf16_f32 v17, v202, v203
    v_mfma_f32_16x16x32_bf16 v[216:219], a[16:19], a[240:243], v[216:219]
    buffer_load_dwordx4 v252, s[8:11], s57 offen lds
    v_mfma_f32_16x16x32_bf16 v[212:215], a[8:11], a[236:239], 0
    s_add_u32 m0, s50, 0xc800
    ds_read_b128 a[236:239], v224 offset:46656
    ds_read_b64_tr_b16 a[148:149], v254 offset:32
    v_mfma_f32_16x16x32_bf16 v[212:215], a[20:23], a[240:243], v[212:215]
    ds_read_b128 a[240:243], v224 offset:46720
    v_mfma_f32_16x16x32_bf16 v[220:223], a[24:27], a[244:247], v[220:223]
    s_waitcnt lgkmcnt(7)
    buffer_load_dwordx4 v253, s[8:11], s57 offen lds
    v_mfma_f32_16x16x32_bf16 v[220:223], a[36:39], a[248:251], v[220:223]
    s_add_u32 s57, s49, 0x2d000
    ds_read_b64_tr_b16 a[150:151], v255 offset:32
    ds_read_b64_tr_b16 a[152:153], v254 offset:64
    v_mfma_f32_16x16x32_bf16 v[216:219], a[28:31], a[244:247], v[216:219]
    s_add_u32 m0, s50, 0xf000
    ds_read_b64_tr_b16 a[154:155], v255 offset:64
    v_mfma_f32_16x16x32_bf16 v[216:219], a[40:43], a[248:251], v[216:219]
    s_waitcnt vmcnt(9)
    buffer_load_dwordx4 v251, s[8:11], s57 offen lds
    v_mfma_f32_16x16x32_bf16 v[212:215], a[32:35], a[244:247], v[212:215]
    s_add_u32 m0, s50, 0xf400
    ds_read_b128 a[244:247], v224 offset:46784
    ds_read_b64_tr_b16 a[156:157], v254 offset:12288
    v_mfma_f32_16x16x32_bf16 v[212:215], a[44:47], a[248:251], v[212:215]
    ds_read_b128 a[248:251], v224 offset:49536
    v_mfma_f32_16x16x32_bf16 v[220:223], a[48:51], a[252:255], v[220:223]
    buffer_load_dwordx4 v252, s[8:11], s57 offen lds
    v_mfma_f32_16x16x32_bf16 v[220:223], a[60:63], a[220:223], v[220:223]
    s_add_u32 m0, s50, 0xf800
    ds_read_b64_tr_b16 a[158:159], v255 offset:12288
    ds_read_b64_tr_b16 a[160:161], v254 offset:12320
    v_mfma_f32_16x16x32_bf16 v[216:219], a[52:55], a[252:255], v[216:219]
    ds_read_b64_tr_b16 a[162:163], v255 offset:12320
    ds_read_b64_tr_b16 a[164:165], v254 offset:12352
    v_mfma_f32_16x16x32_bf16 v[216:219], a[64:67], a[220:223], v[216:219]
    ds_read_b64_tr_b16 a[166:167], v255 offset:12352
    v_cvt_pk_bf16_f32 v36, v220, v221
    v_mfma_f32_16x16x32_bf16 v[212:215], a[56:59], a[252:255], v[212:215]
    ds_read_b128 a[252:255], v224 offset:49600
    v_cvt_pk_bf16_f32 v37, v222, v223
    v_mfma_f32_16x16x32_bf16 v[212:215], a[68:71], a[220:223], v[212:215]
    ds_read_b128 a[220:223], v224 offset:49664
    v_mfma_f32_16x16x32_bf16 v[208:211], a[0:3], a[224:227], 0
    s_waitcnt lgkmcnt(10)
    v_cvt_pk_bf16_f32 v38, v216, v217
    v_cvt_pk_bf16_f32 v39, v218, v219
    v_mfma_f32_16x16x32_bf16 v[208:211], a[12:15], a[228:231], v[208:211]
    buffer_load_dwordx4 v253, s[8:11], s57 offen lds
    v_mfma_f32_16x16x32_bf16 v[204:207], a[4:7], a[224:227], 0
    s_add_u32 s57, s49, 0
    v_cvt_pk_bf16_f32 v40, v212, v213
    v_cvt_pk_bf16_f32 v41, v214, v215
    v_mfma_f32_16x16x32_bf16 v[204:207], a[16:19], a[228:231], v[204:207]
    s_add_u32 m0, s50, 0
    v_mfma_f32_16x16x32_bf16 v[200:203], a[8:11], a[224:227], 0
    s_waitcnt vmcnt(9)
    ds_read_b128 a[224:227], v224 offset:49728
    ds_read_b64_tr_b16 a[168:169], v254 offset:24576
    v_mfma_f32_16x16x32_bf16 v[200:203], a[20:23], a[228:231], v[200:203]
    ds_read_b128 a[228:231], v224 offset:49792
    v_mfma_f32_16x16x32_bf16 v[208:211], a[24:27], a[232:235], v[208:211]
    buffer_load_dwordx4 v192, s[12:15], s57 offen lds
    v_mfma_f32_16x16x32_bf16 v[208:211], a[36:39], a[236:239], v[208:211]
    s_add_u32 m0, s50, 0x400
    ds_read_b64_tr_b16 a[170:171], v255 offset:24576
    ds_read_b64_tr_b16 a[172:173], v254 offset:24608
    v_mfma_f32_16x16x32_bf16 v[204:207], a[28:31], a[232:235], v[204:207]
    buffer_load_dwordx4 v193, s[12:15], s57 offen lds
    v_mfma_f32_16x16x32_bf16 v[204:207], a[40:43], a[236:239], v[204:207]
    s_add_u32 m0, s50, 0x800
    ds_read_b64_tr_b16 a[174:175], v255 offset:24608
    ds_read_b64_tr_b16 a[176:177], v254 offset:24640
    v_mfma_f32_16x16x32_bf16 v[200:203], a[32:35], a[232:235], v[200:203]
    ds_read_b128 a[232:235], v224 offset:49856
    ds_read_b64_tr_b16 a[178:179], v255 offset:24640
    v_mfma_f32_16x16x32_bf16 v[200:203], a[44:47], a[236:239], v[200:203]
    ds_read_b128 a[236:239], v227 offset:37120
    v_mfma_f32_16x16x32_bf16 v[208:211], a[48:51], a[240:243], v[208:211]
    s_waitcnt lgkmcnt(10)
    buffer_load_dwordx4 v194, s[12:15], s57 offen lds
    v_mfma_f32_16x16x32_bf16 v[208:211], a[60:63], a[244:247], v[208:211]
    s_add_u32 s57, s49, 0x3000
    s_add_u32 m0, s50, 0x3000
    v_mfma_f32_16x16x32_bf16 v[204:207], a[52:55], a[240:243], v[204:207]
    v_mfma_f32_16x16x32_bf16 v[204:207], a[64:67], a[244:247], v[204:207]
    v_mfma_f32_16x16x32_bf16 v[200:203], a[56:59], a[240:243], v[200:203]
    s_waitcnt vmcnt(9)
    ds_read_b128 a[240:243], v227 offset:37184
    ds_read_b64_tr_b16 a[180:181], v254 offset:36864
    v_mfma_f32_16x16x32_bf16 v[200:203], a[68:71], a[244:247], v[200:203]
    v_cvt_pk_bf16_f32 v18, v208, v209
    v_cvt_pk_bf16_f32 v19, v210, v211
    v_mfma_f32_16x16x32_bf16 v[220:223], a[0:3], a[248:251], 0
    ds_read_b128 a[244:247], v227 offset:37248
    v_cvt_pk_bf16_f32 v20, v204, v205
    v_mfma_f32_16x16x32_bf16 v[220:223], a[12:15], a[252:255], v[220:223]
    ds_read_b64_tr_b16 a[182:183], v255 offset:36864
    v_cvt_pk_bf16_f32 v21, v206, v207
    v_mfma_f32_16x16x32_bf16 v[216:219], a[4:7], a[248:251], 0
    v_cvt_pk_bf16_f32 v22, v200, v201
    v_cvt_pk_bf16_f32 v23, v202, v203
    v_mfma_f32_16x16x32_bf16 v[216:219], a[16:19], a[252:255], v[216:219]
    buffer_load_dwordx4 v86, s[12:15], s57 offen lds
    v_mfma_f32_16x16x32_bf16 v[212:215], a[8:11], a[248:251], 0
    s_add_u32 m0, s50, 0x3400
    ds_read_b128 a[248:251], v227 offset:37312
    ds_read_b64_tr_b16 a[184:185], v254 offset:36896
    v_mfma_f32_16x16x32_bf16 v[212:215], a[20:23], a[252:255], v[212:215]
    ds_read_b128 a[252:255], v227 offset:37376
    v_mfma_f32_16x16x32_bf16 v[220:223], a[24:27], a[220:223], v[220:223]
    s_waitcnt lgkmcnt(7)
    buffer_load_dwordx4 v87, s[12:15], s57 offen lds
    v_mfma_f32_16x16x32_bf16 v[220:223], a[36:39], a[224:227], v[220:223]
    s_add_u32 m0, s50, 0x3800
    ds_read_b64_tr_b16 a[186:187], v255 offset:36896
    ds_read_b64_tr_b16 a[188:189], v254 offset:36928
    v_mfma_f32_16x16x32_bf16 v[216:219], a[28:31], a[220:223], v[216:219]
    buffer_load_dwordx4 v108, s[12:15], s57 offen lds
    v_mfma_f32_16x16x32_bf16 v[216:219], a[40:43], a[224:227], v[216:219]
    s_add_u32 s57, s49, 0x4800
    ds_read_b64_tr_b16 a[190:191], v255 offset:36928
    s_add_u32 m0, s50, 0x6000
    v_mfma_f32_16x16x32_bf16 v[212:215], a[32:35], a[220:223], v[212:215]
    s_waitcnt vmcnt(9)
    ds_read_b128 a[220:223], v227 offset:37440
    ds_read_b64_tr_b16 a[192:193], v254 offset:49152
    v_mfma_f32_16x16x32_bf16 v[212:215], a[44:47], a[224:227], v[212:215]
    ds_read_b128 a[224:227], v224
    v_mfma_f32_16x16x32_bf16 v[220:223], a[48:51], a[228:231], v[220:223]
    buffer_load_dwordx4 v192, s[12:15], s57 offen lds
    v_mfma_f32_16x16x32_bf16 v[220:223], a[60:63], a[232:235], v[220:223]
    s_add_u32 m0, s50, 0x6400
    ds_read_b64_tr_b16 a[194:195], v255 offset:49152
    ds_read_b64_tr_b16 a[196:197], v254 offset:49184
    v_mfma_f32_16x16x32_bf16 v[216:219], a[52:55], a[228:231], v[216:219]
    ds_read_b64_tr_b16 a[198:199], v255 offset:49184
    ds_read_b64_tr_b16 a[200:201], v254 offset:49216
    v_mfma_f32_16x16x32_bf16 v[216:219], a[64:67], a[232:235], v[216:219]
    ds_read_b64_tr_b16 a[202:203], v255 offset:49216
    v_cvt_pk_bf16_f32 v42, v220, v221
    v_mfma_f32_16x16x32_bf16 v[212:215], a[56:59], a[228:231], v[212:215]
    ds_read_b128 a[228:231], v224 offset:64
    v_cvt_pk_bf16_f32 v43, v222, v223
    v_mfma_f32_16x16x32_bf16 v[212:215], a[68:71], a[232:235], v[212:215]
    ds_read_b128 a[232:235], v224 offset:128
    v_mfma_f32_16x16x32_bf16 v[208:211], a[0:3], a[236:239], 0
    s_waitcnt lgkmcnt(10)
    v_cvt_pk_bf16_f32 v44, v216, v217
    v_cvt_pk_bf16_f32 v45, v218, v219
    v_mfma_f32_16x16x32_bf16 v[208:211], a[12:15], a[240:243], v[208:211]
    buffer_load_dwordx4 v193, s[12:15], s57 offen lds
    v_mfma_f32_16x16x32_bf16 v[204:207], a[4:7], a[236:239], 0
    s_add_u32 m0, s50, 0x6800
    v_cvt_pk_bf16_f32 v46, v212, v213
    v_cvt_pk_bf16_f32 v47, v214, v215
    v_mfma_f32_16x16x32_bf16 v[204:207], a[16:19], a[240:243], v[204:207]
    s_waitcnt vmcnt(8)
    buffer_load_dwordx4 v194, s[12:15], s57 offen lds
    v_mfma_f32_16x16x32_bf16 v[200:203], a[8:11], a[236:239], 0
    s_add_u32 s57, s49, 0x9000
    ds_read_b128 a[236:239], v224 offset:192
    ds_read_b64_tr_b16 a[204:205], v254 offset:61440
    v_mfma_f32_16x16x32_bf16 v[200:203], a[20:23], a[240:243], v[200:203]
    s_add_u32 m0, s50, 0x9000
    ds_read_b128 a[240:243], v224 offset:256
    v_mfma_f32_16x16x32_bf16 v[208:211], a[24:27], a[244:247], v[208:211]
    ds_read_b64_tr_b16 a[206:207], v255 offset:61440
    ds_read_b64_tr_b16 a[208:209], v254 offset:61472
    v_mfma_f32_16x16x32_bf16 v[208:211], a[36:39], a[248:251], v[208:211]
    buffer_load_dwordx4 v192, s[12:15], s57 offen lds
    v_mfma_f32_16x16x32_bf16 v[204:207], a[28:31], a[244:247], v[204:207]
    s_add_u32 m0, s50, 0x9400
    ds_read_b64_tr_b16 a[210:211], v255 offset:61472
    ds_read_b64_tr_b16 a[212:213], v254 offset:61504
    v_mfma_f32_16x16x32_bf16 v[204:207], a[40:43], a[248:251], v[204:207]
    ds_read_b64_tr_b16 a[214:215], v255 offset:61504
    v_mfma_f32_16x16x32_bf16 v[200:203], a[32:35], a[244:247], v[200:203]
    ds_read_b128 a[244:247], v224 offset:320
    v_mfma_f32_16x16x32_bf16 v[200:203], a[44:47], a[248:251], v[200:203]
    ds_read_b128 a[248:251], v224 offset:3072
    v_mfma_f32_16x16x32_bf16 v[208:211], a[48:51], a[252:255], v[208:211]
    s_waitcnt lgkmcnt(10)
    buffer_load_dwordx4 v193, s[12:15], s57 offen lds
    v_mfma_f32_16x16x32_bf16 v[208:211], a[60:63], a[220:223], v[208:211]
    s_add_u32 m0, s50, 0x9800
    v_mfma_f32_16x16x32_bf16 v[204:207], a[52:55], a[252:255], v[204:207]
    v_mfma_f32_16x16x32_bf16 v[204:207], a[64:67], a[220:223], v[204:207]
    buffer_load_dwordx4 v194, s[12:15], s57 offen lds
    v_mfma_f32_16x16x32_bf16 v[200:203], a[56:59], a[252:255], v[200:203]
    s_add_u32 s57, s49, 0xc000
    ds_read_b128 a[252:255], v224 offset:3136
    s_add_u32 m0, s50, 0xc000
    v_mfma_f32_16x16x32_bf16 v[200:203], a[68:71], a[220:223], v[200:203]
    v_cvt_pk_bf16_f32 v54, v208, v209
    v_cvt_pk_bf16_f32 v55, v210, v211
    v_mfma_f32_16x16x32_bf16 v[220:223], a[224:227], a[72:75], 0
    v_cvt_pk_bf16_f32 v56, v204, v205
    v_cvt_pk_bf16_f32 v57, v206, v207
    v_mfma_f32_16x16x32_bf16 v[220:223], a[228:231], a[84:87], v[220:223]
    ds_read_b128 a[220:223], v224 offset:3200
    v_mfma_f32_16x16x32_bf16 v[216:219], a[224:227], a[76:79], 0
    v_cvt_pk_bf16_f32 v58, v200, v201
    v_cvt_pk_bf16_f32 v59, v202, v203
    v_mfma_f32_16x16x32_bf16 v[216:219], a[228:231], a[88:91], v[216:219]
    buffer_load_dwordx4 v86, s[12:15], s57 offen lds
    v_mfma_f32_16x16x32_bf16 v[212:215], a[224:227], a[80:83], 0
    s_add_u32 m0, s50, 0xc400
    ds_read_b128 a[224:227], v224 offset:3264
    v_mfma_f32_16x16x32_bf16 v[212:215], a[228:231], a[92:95], v[212:215]
    ds_read_b128 a[228:231], v224 offset:3328
    v_mfma_f32_16x16x32_bf16 v[220:223], a[232:235], a[96:99], v[220:223]
    s_waitcnt lgkmcnt(4)
    buffer_load_dwordx4 v87, s[12:15], s57 offen lds
    v_mfma_f32_16x16x32_bf16 v[220:223], a[236:239], a[108:111], v[220:223]
    s_add_u32 m0, s50, 0xc800
    v_mfma_f32_16x16x32_bf16 v[216:219], a[232:235], a[100:103], v[216:219]
    v_mfma_f32_16x16x32_bf16 v[216:219], a[236:239], a[112:115], v[216:219]
    v_mfma_f32_16x16x32_bf16 v[212:215], a[232:235], a[104:107], v[212:215]
    ds_read_b128 a[232:235], v224 offset:3392
    v_mfma_f32_16x16x32_bf16 v[212:215], a[236:239], a[116:119], v[212:215]
    ds_read_b128 a[236:239], v224 offset:15488
    v_mfma_f32_16x16x32_bf16 v[220:223], a[240:243], a[120:123], v[220:223]
    buffer_load_dwordx4 v108, s[12:15], s57 offen lds
    v_mfma_f32_16x16x32_bf16 v[220:223], a[244:247], a[132:135], v[220:223]
    s_add_u32 s57, s49, 0xd800
    s_add_u32 m0, s50, 0xf000
    v_mfma_f32_16x16x32_bf16 v[216:219], a[240:243], a[124:127], v[216:219]
    buffer_load_dwordx4 v192, s[12:15], s57 offen lds
    v_mfma_f32_16x16x32_bf16 v[216:219], a[244:247], a[136:139], v[216:219]
    s_add_u32 m0, s50, 0xf400
    v_mfma_f32_16x16x32_bf16 v[212:215], a[240:243], a[128:131], v[212:215]
    ds_read_b128 a[240:243], v224 offset:15552
    v_cvt_pk_bf16_f32 v66, v220, v221
    v_mfma_f32_16x16x32_bf16 v[212:215], a[244:247], a[140:143], v[212:215]
    ds_read_b128 a[244:247], v224 offset:15616
    v_cvt_pk_bf16_f32 v67, v222, v223
    v_mfma_f32_16x16x32_bf16 v[208:211], a[248:251], a[72:75], 0
    s_waitcnt lgkmcnt(4)
    v_cvt_pk_bf16_f32 v88, v216, v217
    v_cvt_pk_bf16_f32 v89, v218, v219
    v_mfma_f32_16x16x32_bf16 v[208:211], a[252:255], a[84:87], v[208:211]
    buffer_load_dwordx4 v193, s[12:15], s57 offen lds
    v_mfma_f32_16x16x32_bf16 v[204:207], a[248:251], a[76:79], 0
    s_add_u32 m0, s50, 0xf800
    v_cvt_pk_bf16_f32 v110, v212, v213
    v_cvt_pk_bf16_f32 v111, v214, v215
    v_mfma_f32_16x16x32_bf16 v[204:207], a[252:255], a[88:91], v[204:207]
    v_mfma_f32_16x16x32_bf16 v[200:203], a[248:251], a[80:83], 0
    ds_read_b128 a[248:251], v224 offset:15680
    v_mfma_f32_16x16x32_bf16 v[200:203], a[252:255], a[92:95], v[200:203]
    ds_read_b128 a[252:255], v224 offset:15744
    v_mfma_f32_16x16x32_bf16 v[208:211], a[220:223], a[96:99], v[208:211]
    buffer_load_dwordx4 v194, s[12:15], s57 offen lds
    v_mfma_f32_16x16x32_bf16 v[208:211], a[224:227], a[108:111], v[208:211]
    s_add_u32 m0, s41, 0
    v_mfma_f32_16x16x32_bf16 v[204:207], a[220:223], a[100:103], v[204:207]
    v_mfma_f32_16x16x32_bf16 v[204:207], a[224:227], a[112:115], v[204:207]
    v_mfma_f32_16x16x32_bf16 v[200:203], a[220:223], a[104:107], v[200:203]
    ds_read_b128 a[220:223], v224 offset:15808
    v_mfma_f32_16x16x32_bf16 v[200:203], a[224:227], a[116:119], v[200:203]
    ds_read_b128 a[224:227], v224 offset:18560
    v_mfma_f32_16x16x32_bf16 v[208:211], a[228:231], a[120:123], v[208:211]
    s_waitcnt lgkmcnt(4)
    v_mfma_f32_16x16x32_bf16 v[208:211], a[232:235], a[132:135], v[208:211]
    v_mfma_f32_16x16x32_bf16 v[204:207], a[228:231], a[124:127], v[204:207]
    v_mfma_f32_16x16x32_bf16 v[204:207], a[232:235], a[136:139], v[204:207]
    v_mfma_f32_16x16x32_bf16 v[200:203], a[228:231], a[128:131], v[200:203]
    ds_read_b128 a[228:231], v224 offset:18624
    v_mfma_f32_16x16x32_bf16 v[200:203], a[232:235], a[140:143], v[200:203]
    ds_read_b128 a[232:235], v224 offset:18688
    v_mfma_f32_16x16x32_bf16 v[220:223], a[236:239], a[72:75], 0
    v_mfma_f32_16x16x32_bf16 v[220:223], a[240:243], a[84:87], v[220:223]
    v_cvt_pk_bf16_f32 v68, v208, v209
    v_cvt_pk_bf16_f32 v69, v210, v211
    v_mfma_f32_16x16x32_bf16 v[216:219], a[236:239], a[76:79], 0
    v_cvt_pk_bf16_f32 v90, v204, v205
    v_cvt_pk_bf16_f32 v91, v206, v207
    v_mfma_f32_16x16x32_bf16 v[216:219], a[240:243], a[88:91], v[216:219]
    v_cvt_pk_bf16_f32 v112, v200, v201
    v_cvt_pk_bf16_f32 v113, v202, v203
    v_mfma_f32_16x16x32_bf16 v[212:215], a[236:239], a[80:83], 0
    ds_read_b128 a[236:239], v224 offset:18752
    v_mfma_f32_16x16x32_bf16 v[212:215], a[240:243], a[92:95], v[212:215]
    ds_read_b128 a[240:243], v224 offset:18816
    v_mfma_f32_16x16x32_bf16 v[220:223], a[244:247], a[96:99], v[220:223]
    s_waitcnt lgkmcnt(4)
    v_mfma_f32_16x16x32_bf16 v[220:223], a[248:251], a[108:111], v[220:223]
    v_mfma_f32_16x16x32_bf16 v[216:219], a[244:247], a[100:103], v[216:219]
    v_mfma_f32_16x16x32_bf16 v[216:219], a[248:251], a[112:115], v[216:219]
    v_mfma_f32_16x16x32_bf16 v[212:215], a[244:247], a[104:107], v[212:215]
    ds_read_b128 a[244:247], v224 offset:18880
    v_mfma_f32_16x16x32_bf16 v[212:215], a[248:251], a[116:119], v[212:215]
    ds_read_b128 a[248:251], v227 offset:6144
    v_mfma_f32_16x16x32_bf16 v[220:223], a[252:255], a[120:123], v[220:223]
    v_mfma_f32_16x16x32_bf16 v[220:223], a[220:223], a[132:135], v[220:223]
    v_mfma_f32_16x16x32_bf16 v[216:219], a[252:255], a[124:127], v[216:219]
    v_mfma_f32_16x16x32_bf16 v[216:219], a[220:223], a[136:139], v[216:219]
    v_mfma_f32_16x16x32_bf16 v[212:215], a[252:255], a[128:131], v[212:215]
    ds_read_b128 a[252:255], v227 offset:6208
    v_mfma_f32_16x16x32_bf16 v[212:215], a[220:223], a[140:143], v[212:215]
    ds_read_b128 a[220:223], v227 offset:6272
    v_mfma_f32_16x16x32_bf16 v[208:211], a[224:227], a[72:75], 0
    s_waitcnt lgkmcnt(4)
    v_mfma_f32_16x16x32_bf16 v[208:211], a[228:231], a[84:87], v[208:211]
    v_cvt_pk_bf16_f32 v72, v220, v221
    v_cvt_pk_bf16_f32 v73, v222, v223
    v_mfma_f32_16x16x32_bf16 v[204:207], a[224:227], a[76:79], 0
    v_cvt_pk_bf16_f32 v94, v216, v217
    v_cvt_pk_bf16_f32 v95, v218, v219
    v_mfma_f32_16x16x32_bf16 v[204:207], a[228:231], a[88:91], v[204:207]
    v_cvt_pk_bf16_f32 v116, v212, v213
    v_cvt_pk_bf16_f32 v117, v214, v215
    v_mfma_f32_16x16x32_bf16 v[200:203], a[224:227], a[80:83], 0
    ds_read_b128 a[224:227], v227 offset:6336
    v_mfma_f32_16x16x32_bf16 v[200:203], a[228:231], a[92:95], v[200:203]
    ds_read_b128 a[228:231], v227 offset:6400
    v_mfma_f32_16x16x32_bf16 v[208:211], a[232:235], a[96:99], v[208:211]
    v_mfma_f32_16x16x32_bf16 v[208:211], a[236:239], a[108:111], v[208:211]
    v_mfma_f32_16x16x32_bf16 v[204:207], a[232:235], a[100:103], v[204:207]
    v_mfma_f32_16x16x32_bf16 v[204:207], a[236:239], a[112:115], v[204:207]
    v_mfma_f32_16x16x32_bf16 v[200:203], a[232:235], a[104:107], v[200:203]
    ds_read_b128 a[232:235], v227 offset:6464
    v_mfma_f32_16x16x32_bf16 v[200:203], a[236:239], a[116:119], v[200:203]
    ds_read_b128 a[236:239], v225 offset:24384
    v_mfma_f32_16x16x32_bf16 v[208:211], a[240:243], a[120:123], v[208:211]
    s_waitcnt lgkmcnt(4)
    v_mfma_f32_16x16x32_bf16 v[208:211], a[244:247], a[132:135], v[208:211]
    v_mfma_f32_16x16x32_bf16 v[204:207], a[240:243], a[124:127], v[204:207]
    v_mfma_f32_16x16x32_bf16 v[204:207], a[244:247], a[136:139], v[204:207]
    v_mfma_f32_16x16x32_bf16 v[200:203], a[240:243], a[128:131], v[200:203]
    ds_read_b128 a[240:243], v225 offset:24448
    v_mfma_f32_16x16x32_bf16 v[200:203], a[244:247], a[140:143], v[200:203]
    ds_read_b128 a[244:247], v225 offset:24512
    v_mfma_f32_16x16x32_bf16 v[220:223], a[248:251], a[72:75], 0
    v_mfma_f32_16x16x32_bf16 v[220:223], a[252:255], a[84:87], v[220:223]
    v_cvt_pk_bf16_f32 v70, v208, v209
    v_cvt_pk_bf16_f32 v71, v210, v211
    v_mfma_f32_16x16x32_bf16 v[216:219], a[248:251], a[76:79], 0
    v_cvt_pk_bf16_f32 v92, v204, v205
    v_cvt_pk_bf16_f32 v93, v206, v207
    v_mfma_f32_16x16x32_bf16 v[216:219], a[252:255], a[88:91], v[216:219]
    v_cvt_pk_bf16_f32 v114, v200, v201
    v_cvt_pk_bf16_f32 v115, v202, v203
    v_mfma_f32_16x16x32_bf16 v[212:215], a[248:251], a[80:83], 0
    ds_read_b128 a[248:251], v225 offset:24576
    v_mfma_f32_16x16x32_bf16 v[212:215], a[252:255], a[92:95], v[212:215]
    ds_read_b128 a[252:255], v225 offset:24640
    v_mfma_f32_16x16x32_bf16 v[220:223], a[220:223], a[96:99], v[220:223]
    s_waitcnt lgkmcnt(4)
    v_mfma_f32_16x16x32_bf16 v[220:223], a[224:227], a[108:111], v[220:223]
    v_mfma_f32_16x16x32_bf16 v[216:219], a[220:223], a[100:103], v[216:219]
    v_mfma_f32_16x16x32_bf16 v[216:219], a[224:227], a[112:115], v[216:219]
    v_mfma_f32_16x16x32_bf16 v[212:215], a[220:223], a[104:107], v[212:215]
    ds_read_b128 a[220:223], v225 offset:24704
    v_mfma_f32_16x16x32_bf16 v[212:215], a[224:227], a[116:119], v[212:215]
    ds_read_b128 a[224:227], v225 offset:27456
    v_mfma_f32_16x16x32_bf16 v[220:223], a[228:231], a[120:123], v[220:223]
    v_mfma_f32_16x16x32_bf16 v[220:223], a[232:235], a[132:135], v[220:223]
    v_mfma_f32_16x16x32_bf16 v[216:219], a[228:231], a[124:127], v[216:219]
    v_mfma_f32_16x16x32_bf16 v[216:219], a[232:235], a[136:139], v[216:219]
    v_mfma_f32_16x16x32_bf16 v[212:215], a[228:231], a[128:131], v[212:215]
    ds_read_b128 a[228:231], v225 offset:27520
    v_mfma_f32_16x16x32_bf16 v[212:215], a[232:235], a[140:143], v[212:215]
    ds_read_b128 a[232:235], v225 offset:27584
    v_mfma_f32_16x16x32_bf16 v[208:211], a[144:147], a[236:239], 0
    s_waitcnt lgkmcnt(4)
    v_mfma_f32_16x16x32_bf16 v[208:211], a[156:159], a[240:243], v[208:211]
    v_cvt_pk_bf16_f32 v82, v220, v221
    v_cvt_pk_bf16_f32 v83, v222, v223
    v_mfma_f32_16x16x32_bf16 v[204:207], a[148:151], a[236:239], 0
    v_cvt_pk_bf16_f32 v104, v216, v217
    v_cvt_pk_bf16_f32 v105, v218, v219
    v_mfma_f32_16x16x32_bf16 v[204:207], a[160:163], a[240:243], v[204:207]
    v_cvt_pk_bf16_f32 v126, v212, v213
    v_cvt_pk_bf16_f32 v127, v214, v215
    v_mfma_f32_16x16x32_bf16 v[200:203], a[152:155], a[236:239], 0
    ds_read_b128 a[236:239], v225 offset:27648
    v_mfma_f32_16x16x32_bf16 v[200:203], a[164:167], a[240:243], v[200:203]
    ds_read_b128 a[240:243], v225 offset:27712
    v_mfma_f32_16x16x32_bf16 v[208:211], a[168:171], a[244:247], v[208:211]
    v_mfma_f32_16x16x32_bf16 v[208:211], a[180:183], a[248:251], v[208:211]
    v_mfma_f32_16x16x32_bf16 v[204:207], a[172:175], a[244:247], v[204:207]
    v_mfma_f32_16x16x32_bf16 v[204:207], a[184:187], a[248:251], v[204:207]
    v_mfma_f32_16x16x32_bf16 v[200:203], a[176:179], a[244:247], v[200:203]
    ds_read_b128 a[244:247], v225 offset:27776
    v_mfma_f32_16x16x32_bf16 v[200:203], a[188:191], a[248:251], v[200:203]
    ds_read_b128 a[248:251], v224 offset:30976
    v_mfma_f32_16x16x32_bf16 v[208:211], a[192:195], a[252:255], v[208:211]
    s_waitcnt lgkmcnt(4)
    v_mfma_f32_16x16x32_bf16 v[208:211], a[204:207], a[220:223], v[208:211]
    v_mfma_f32_16x16x32_bf16 v[204:207], a[196:199], a[252:255], v[204:207]
    v_mfma_f32_16x16x32_bf16 v[204:207], a[208:211], a[220:223], v[204:207]
    v_mfma_f32_16x16x32_bf16 v[200:203], a[200:203], a[252:255], v[200:203]
    ds_read_b128 a[252:255], v224 offset:31040
    v_mfma_f32_16x16x32_bf16 v[200:203], a[212:215], a[220:223], v[200:203]
    s_waitcnt lgkmcnt(2)
    ds_read_b128 a[220:223], v224 offset:31104
    v_mfma_f32_16x16x32_bf16 v[220:223], a[144:147], a[224:227], 0
    s_barrier
    v_cvt_pk_bf16_f32 v132, v208, v209
    v_mfma_f32_16x16x32_bf16 v[220:223], a[156:159], a[228:231], v[220:223]
    v_cvt_pk_bf16_f32 v133, v210, v211
    v_cvt_pk_bf16_f32 v134, v204, v205
    v_mfma_f32_16x16x32_bf16 v[216:219], a[148:151], a[224:227], 0
    v_cvt_pk_bf16_f32 v135, v206, v207
    v_cvt_pk_bf16_f32 v136, v200, v201
    v_mfma_f32_16x16x32_bf16 v[216:219], a[160:163], a[228:231], v[216:219]
    v_cvt_pk_bf16_f32 v137, v202, v203
    v_mfma_f32_16x16x32_bf16 v[144:147], v[0:3], v[132:135], v[144:147]
    buffer_load_dwordx4 v246, s[4:7], s56 offen lds
    v_mfma_f32_16x16x32_bf16 v[148:151], v[24:27], v[132:135], v[148:151]
    s_add_u32 m0, s42, 0
    v_mfma_f32_16x16x32_bf16 v[152:155], v[30:33], v[132:135], v[152:155]
    buffer_load_dwordx4 v247, s[4:7], s56 offen lds
    v_mfma_f32_16x16x32_bf16 v[156:159], v[6:9], v[132:135], v[156:159]
    s_add_u32 s56, s39, 0x17a000
    s_add_u32 m0, s41, 0x1e40
    v_mfma_f32_16x16x16_bf16 v[144:147], v[4:5], v[136:137], v[144:147]
    v_mfma_f32_16x16x16_bf16 v[148:151], v[28:29], v[136:137], v[148:151]
    buffer_load_dwordx4 v246, s[4:7], s56 offen lds
    v_mfma_f32_16x16x16_bf16 v[152:155], v[34:35], v[136:137], v[152:155]
    s_add_u32 m0, s42, 0x1e40
    v_mfma_f32_16x16x16_bf16 v[156:159], v[10:11], v[136:137], v[156:159]
    v_mfma_f32_16x16x32_bf16 v[160:163], v[12:15], v[132:135], v[160:163]
    v_mfma_f32_16x16x32_bf16 v[164:167], v[36:39], v[132:135], v[164:167]
    buffer_load_dwordx4 v247, s[4:7], s56 offen lds
    v_mfma_f32_16x16x32_bf16 v[168:171], v[42:45], v[132:135], v[168:171]
    s_add_u32 s56, s39, 0x1a4000
    v_max3_f32 v248, v144, v145, v146
    v_max3_f32 v249, v147, v148, v149
    v_mfma_f32_16x16x16_bf16 v[160:163], v[16:17], v[136:137], v[160:163]
    s_add_u32 m0, s41, 0x3c80
    v_max3_f32 v248, v248, v150, v151
    v_max3_f32 v249, v249, v152, v153
    v_mfma_f32_16x16x16_bf16 v[164:167], v[40:41], v[136:137], v[164:167]
    v_max3_f32 v248, v248, v154, v155
    v_max3_f32 v249, v249, v156, v157
    v_mfma_f32_16x16x16_bf16 v[168:171], v[46:47], v[136:137], v[168:171]
    buffer_load_dwordx4 v246, s[4:7], s56 offen lds
    v_mfma_f32_16x16x32_bf16 v[172:175], v[18:21], v[132:135], v[172:175]
    s_add_u32 m0, s42, 0x3c80
    v_max3_f32 v248, v248, v158, v159
    v_max3_f32 v249, v249, v160, v161
    v_mfma_f32_16x16x32_bf16 v[212:215], a[152:155], a[224:227], 0
    ds_read_b128 a[224:227], v224 offset:31168
    v_max3_f32 v248, v248, v162, v163
    v_mfma_f32_16x16x32_bf16 v[212:215], a[164:167], a[228:231], v[212:215]
    ds_read_b128 a[228:231], v224 offset:31232
    v_max3_f32 v249, v249, v164, v165
    v_mfma_f32_16x16x16_bf16 v[172:175], v[22:23], v[136:137], v[172:175]
    v_max3_f32 v248, v248, v166, v167
    v_max3_f32 v249, v249, v168, v169
    v_mfma_f32_16x16x32_bf16 v[220:223], a[168:171], a[232:235], v[220:223]
    buffer_load_dwordx4 v247, s[4:7], s56 offen lds
    v_mfma_f32_16x16x32_bf16 v[220:223], a[180:183], a[236:239], v[220:223]
    s_add_u32 s56, s39, 0x1ce000
    v_max3_f32 v248, v248, v170, v171
    s_add_u32 m0, s41, 0x5ac0
    v_mfma_f32_16x16x32_bf16 v[216:219], a[172:175], a[232:235], v[216:219]
    v_max3_f32 v249, v249, v172, v173
    v_max3_f32 v248, v248, v174, v175
    v_mfma_f32_16x16x32_bf16 v[216:219], a[184:187], a[236:239], v[216:219]
    v_max_f32 v248, v248, v249
    v_mov_b32 v249, v248
    v_mfma_f32_16x16x32_bf16 v[212:215], a[176:179], a[232:235], v[212:215]
    ds_read_b128 a[232:235], v224 offset:31296
    v_mfma_f32_16x16x32_bf16 v[212:215], a[188:191], a[236:239], v[212:215]
    ds_read_b128 a[236:239], v224 offset:34048
    v_mfma_f32_16x16x32_bf16 v[220:223], a[192:195], a[240:243], v[220:223]
    buffer_load_dwordx4 v246, s[4:7], s56 offen lds
    v_mfma_f32_16x16x32_bf16 v[220:223], a[204:207], a[244:247], v[220:223]
    s_add_u32 m0, s42, 0x5ac0
    v_permlane16_swap_b32 v248, v249
    v_mfma_f32_16x16x32_bf16 v[216:219], a[196:199], a[240:243], v[216:219]
    buffer_load_dwordx4 v247, s[4:7], s56 offen lds
    v_mfma_f32_16x16x32_bf16 v[216:219], a[208:211], a[244:247], v[216:219]
    s_add_u32 s56, s39, 0x1f8000
    v_max_f32 v248, v248, v249
    v_mov_b32 v249, v248
    v_mfma_f32_16x16x32_bf16 v[212:215], a[200:203], a[240:243], v[212:215]
    s_add_u32 m0, s41, 0x7900
    v_cvt_pk_bf16_f32 v138, v220, v221
    v_cvt_pk_bf16_f32 v139, v222, v223
    v_mfma_f32_16x16x32_bf16 v[212:215], a[212:215], a[244:247], v[212:215]
    s_waitcnt lgkmcnt(2)
    v_cvt_pk_bf16_f32 v140, v216, v217
    v_cvt_pk_bf16_f32 v141, v218, v219
    v_mfma_f32_16x16x32_bf16 v[208:211], a[248:251], a[72:75], 0
    ds_read_b128 a[240:243], v224 offset:34112
    ds_read_b128 a[244:247], v224 offset:34176
    v_mfma_f32_16x16x32_bf16 v[208:211], a[252:255], a[84:87], v[208:211]
    v_permlane32_swap_b32 v248, v249
    v_mfma_f32_16x16x32_bf16 v[204:207], a[248:251], a[76:79], 0
    v_cvt_pk_bf16_f32 v142, v212, v213
    v_cvt_pk_bf16_f32 v143, v214, v215
    v_mfma_f32_16x16x32_bf16 v[204:207], a[252:255], a[88:91], v[204:207]
    v_max_f32 v248, v248, v249
    v_mul_f32 v236, s37, v248
    v_mfma_f32_16x16x32_bf16 v[200:203], a[248:251], a[80:83], 0
    ds_read_b128 a[248:251], v224 offset:34240
    v_fma_f32 v144, v144, s37, -v236
    v_mfma_f32_16x16x32_bf16 v[200:203], a[252:255], a[92:95], v[200:203]
    ds_read_b128 a[252:255], v224 offset:34304
    v_fma_f32 v145, v145, s37, -v236
    v_mfma_f32_16x16x32_bf16 v[208:211], a[220:223], a[96:99], v[208:211]
    v_fma_f32 v146, v146, s37, -v236
    v_fma_f32 v147, v147, s37, -v236
    v_mfma_f32_16x16x32_bf16 v[208:211], a[224:227], a[108:111], v[208:211]
    v_exp_f32 v144, v144
    v_mfma_f32_16x16x32_bf16 v[204:207], a[220:223], a[100:103], v[204:207]
    v_exp_f32 v145, v145
    v_mfma_f32_16x16x32_bf16 v[204:207], a[224:227], a[112:115], v[204:207]
    v_exp_f32 v146, v146
    v_mfma_f32_16x16x32_bf16 v[200:203], a[220:223], a[104:107], v[200:203]
    ds_read_b128 a[220:223], v224 offset:34368
    v_cvt_pk_bf16_f32 v176, v144, v145
    v_mfma_f32_16x16x32_bf16 v[200:203], a[224:227], a[116:119], v[200:203]
    ds_read_b128 a[224:227], v224 offset:46464
    v_fma_f32 v148, v148, s37, -v236
    v_mfma_f32_16x16x32_bf16 v[208:211], a[228:231], a[120:123], v[208:211]
    s_waitcnt lgkmcnt(4)
    v_exp_f32 v147, v147
    v_mfma_f32_16x16x32_bf16 v[208:211], a[232:235], a[132:135], v[208:211]
    v_cvt_pk_bf16_f32 v177, v146, v147
    v_fma_f32 v149, v149, s37, -v236
    v_mfma_f32_16x16x32_bf16 v[204:207], a[228:231], a[124:127], v[204:207]
    ds_read_b128 v[144:147], v234
    v_bfe_u32 v234, s63, v233, 4
    v_mfma_f32_16x16x32_bf16 v[204:207], a[232:235], a[136:139], v[204:207]
    v_mad_u32_u24 v234, v234, s40, v231
    v_fma_f32 v150, v150, s37, -v236
    v_mfma_f32_16x16x32_bf16 v[200:203], a[228:231], a[128:131], v[200:203]
    v_cvt_pk_bf16_f32 v74, v208, v209
    v_cvt_pk_bf16_f32 v75, v210, v211
    v_mfma_f32_16x16x32_bf16 v[200:203], a[232:235], a[140:143], v[200:203]
    ds_read_b128 a[228:231], v224 offset:46528
    ds_read_b128 a[232:235], v224 offset:46592
    v_mfma_f32_16x16x32_bf16 v[220:223], a[236:239], a[72:75], 0
    v_cvt_pk_bf16_f32 v96, v204, v205
    v_cvt_pk_bf16_f32 v97, v206, v207
    v_mfma_f32_16x16x32_bf16 v[220:223], a[240:243], a[84:87], v[220:223]
    v_fma_f32 v151, v151, s37, -v236
    v_fma_f32 v152, v152, s37, -v236
    v_mfma_f32_16x16x32_bf16 v[216:219], a[236:239], a[76:79], 0
    v_cvt_pk_bf16_f32 v118, v200, v201
    v_cvt_pk_bf16_f32 v119, v202, v203
    v_mfma_f32_16x16x32_bf16 v[216:219], a[240:243], a[88:91], v[216:219]
    v_exp_f32 v148, v148
    v_mfma_f32_16x16x32_bf16 v[212:215], a[236:239], a[80:83], 0
    ds_read_b128 a[236:239], v224 offset:46656
    v_fma_f32 v153, v153, s37, -v236
    v_mfma_f32_16x16x32_bf16 v[212:215], a[240:243], a[92:95], v[212:215]
    s_waitcnt lgkmcnt(3)
    ds_read_b128 a[240:243], v224 offset:46720
    v_fma_f32 v154, v154, s37, -v236
    v_mfma_f32_16x16x32_bf16 v[144:147], v[24:27], v[138:141], v[144:147]
    v_exp_f32 v149, v149
    v_mfma_f32_16x16x32_bf16 v[220:223], a[244:247], a[96:99], v[220:223]
    v_exp_f32 v150, v150
    v_mfma_f32_16x16x32_bf16 v[220:223], a[248:251], a[108:111], v[220:223]
    v_exp_f32 v151, v151
    v_mfma_f32_16x16x32_bf16 v[216:219], a[244:247], a[100:103], v[216:219]
    v_cvt_pk_bf16_f32 v178, v148, v149
    v_cvt_pk_bf16_f32 v179, v150, v151
    v_mfma_f32_16x16x32_bf16 v[216:219], a[248:251], a[112:115], v[216:219]
    ds_read_b128 v[148:151], v235
    v_bfe_u32 v235, s64, v233, 4
    v_mfma_f32_16x16x32_bf16 v[196:199], a[216:219], v[176:179], 0
    v_mad_u32_u24 v235, v235, s40, v231
    v_fma_f32 v155, v155, s37, -v236
    v_mfma_f32_16x16x32_bf16 v[184:187], v[66:69], v[176:179], 0
    v_exp_f32 v152, v152
    v_mfma_f32_16x16x32_bf16 v[188:191], v[88:91], v[176:179], 0
    v_exp_f32 v153, v153
    v_mfma_f32_16x16x32_bf16 v[192:195], v[110:113], v[176:179], 0
    v_exp_f32 v154, v154
    v_mfma_f32_16x16x16_bf16 v[144:147], v[28:29], v[142:143], v[144:147]
    v_exp_f32 v155, v155
    v_mfma_f32_16x16x32_bf16 v[212:215], a[244:247], a[104:107], v[212:215]
    ds_read_b128 a[244:247], v224 offset:46784
    v_cvt_pk_bf16_f32 v180, v152, v153
    v_mfma_f32_16x16x32_bf16 v[212:215], a[248:251], a[116:119], v[212:215]
    s_waitcnt vmcnt(20)
    ds_read_b64_tr_b16 a[248:249], v109 offset:12288
    ds_read_b64_tr_b16 a[250:251], v109 offset:13824
    v_mfma_f32_16x16x32_bf16 v[220:223], a[252:255], a[120:123], v[220:223]
    v_cvt_pk_bf16_f32 v181, v154, v155
    v_fma_f32 v156, v156, s37, -v236
    v_mfma_f32_16x16x32_bf16 v[220:223], a[220:223], a[132:135], v[220:223]
    s_waitcnt lgkmcnt(3)
    ds_read_b128 v[152:155], v230 offset:1920
    v_fma_f32 v157, v157, s37, -v236
    v_mfma_f32_16x16x32_bf16 v[148:151], v[30:33], v[138:141], v[148:151]
    v_fma_f32 v158, v158, s37, -v236
    v_fma_f32 v159, v159, s37, -v236
    v_mfma_f32_16x16x32_bf16 v[216:219], a[252:255], a[124:127], v[216:219]
    v_exp_f32 v156, v156
    v_mfma_f32_16x16x32_bf16 v[216:219], a[220:223], a[136:139], v[216:219]
    v_cvt_pk_bf16_f32 v76, v220, v221
    v_cvt_pk_bf16_f32 v77, v222, v223
    v_mfma_f32_16x16x16_bf16 v[148:151], v[34:35], v[142:143], v[148:151]
    v_exp_f32 v157, v157
    v_mfma_f32_16x16x32_bf16 v[212:215], a[252:255], a[128:131], v[212:215]
    ds_read_b64_tr_b16 a[252:253], v109 offset:12320
    ds_read_b64_tr_b16 a[254:255], v109 offset:13856
    v_mfma_f32_16x16x32_bf16 v[212:215], a[220:223], a[140:143], v[212:215]
    v_cvt_pk_bf16_f32 v98, v216, v217
    v_cvt_pk_bf16_f32 v99, v218, v219
    v_mfma_f32_16x16x32_bf16 v[208:211], a[224:227], a[72:75], 0
    ds_read_b64_tr_b16 a[220:221], v109 offset:12352
    ds_read_b64_tr_b16 a[222:223], v109 offset:13888
    v_mfma_f32_16x16x32_bf16 v[208:211], a[228:231], a[84:87], v[208:211]
    s_waitcnt vmcnt(4) lgkmcnt(4)
    v_exp_f32 v158, v158
    v_mfma_f32_16x16x32_bf16 v[152:155], v[36:39], v[138:141], v[152:155]
    s_barrier
    v_cvt_pk_bf16_f32 v120, v212, v213
    v_cvt_pk_bf16_f32 v121, v214, v215
    v_mfma_f32_16x16x32_bf16 v[204:207], a[224:227], a[76:79], 0
    ds_read_b128 v[252:255], v224 offset:320
    v_cvt_pk_bf16_f32 v182, v156, v157
    v_mfma_f32_16x16x32_bf16 v[204:207], a[228:231], a[88:91], v[204:207]
    v_exp_f32 v159, v159
    v_mfma_f32_16x16x16_bf16 v[152:155], v[40:41], v[142:143], v[152:155]
    v_cvt_pk_bf16_f32 v183, v158, v159
    v_fma_f32 v160, v160, s37, -v236
    v_mfma_f32_16x16x32_bf16 v[200:203], a[224:227], a[80:83], 0
    ds_read_b128 a[224:227], v224 offset:49536
    ds_read_b128 v[156:159], v250
    v_mfma_f32_16x16x32_bf16 v[200:203], a[228:231], a[92:95], v[200:203]
    v_bfe_u32 v250, s65, v232, 4
    v_fma_f32 v161, v161, s37, -v236
    v_mfma_f32_16x16x32_bf16 v[196:199], a[216:219], v[180:183], v[196:199]
    ds_read_b128 a[228:231], v224 offset:49600
    v_fma_f32 v162, v162, s37, -v236
    v_mfma_f32_16x16x32_bf16 v[184:187], v[70:73], v[180:183], v[184:187]
    v_fma_f32 v163, v163, s37, -v236
    v_fma_f32 v164, v164, s37, -v236
    v_mfma_f32_16x16x32_bf16 v[188:191], v[92:95], v[180:183], v[188:191]
    v_exp_f32 v160, v160
    v_mfma_f32_16x16x32_bf16 v[192:195], v[114:117], v[180:183], v[192:195]
    v_exp_f32 v161, v161
    v_mfma_f32_16x16x32_bf16 v[208:211], a[232:235], a[96:99], v[208:211]
    v_exp_f32 v162, v162
    v_mfma_f32_16x16x32_bf16 v[208:211], a[236:239], a[108:111], v[208:211]
    v_exp_f32 v163, v163
    v_mfma_f32_16x16x32_bf16 v[204:207], a[232:235], a[100:103], v[204:207]
    v_cvt_pk_bf16_f32 v176, v160, v161
    v_cvt_pk_bf16_f32 v177, v162, v163
    v_mfma_f32_16x16x32_bf16 v[204:207], a[236:239], a[112:115], v[204:207]
    s_waitcnt lgkmcnt(1)
    ds_read_b128 v[160:163], v234
    v_mad_u32_u24 v234, v250, s40, v229
    v_mfma_f32_16x16x32_bf16 v[156:159], v[42:45], v[138:141], v[156:159]
    v_mad_u32_u24 v250, v250, s40, v228
    v_fma_f32 v165, v165, s37, -v236
    v_mfma_f32_16x16x32_bf16 v[200:203], a[232:235], a[104:107], v[200:203]
    ds_read_b128 a[232:235], v224 offset:49664
    v_fma_f32 v166, v166, s37, -v236
    v_mfma_f32_16x16x32_bf16 v[200:203], a[236:239], a[116:119], v[200:203]
    ds_read_b128 a[236:239], v224 offset:49728
    v_fma_f32 v167, v167, s37, -v236
    v_mfma_f32_16x16x16_bf16 v[156:159], v[46:47], v[142:143], v[156:159]
    s_waitcnt vmcnt(0)
    ds_write_b128 v130, a[248:251] offset:12288
    v_mfma_f32_16x16x32_bf16 v[208:211], a[240:243], a[120:123], v[208:211]
    ds_write_b128 v130, a[252:255] offset:13312
    v_mfma_f32_16x16x32_bf16 v[208:211], a[244:247], a[132:135], v[208:211]
    s_waitcnt lgkmcnt(4)
    ds_write_b128 v130, a[220:223] offset:14336
    v_mfma_f32_16x16x32_bf16 v[160:163], v[48:51], v[138:141], v[160:163]
    v_exp_f32 v164, v164
    v_mfma_f32_16x16x32_bf16 v[204:207], a[240:243], a[124:127], v[204:207]
    v_exp_f32 v165, v165
    v_mfma_f32_16x16x32_bf16 v[204:207], a[244:247], a[136:139], v[204:207]
    v_exp_f32 v166, v166
    v_mfma_f32_16x16x32_bf16 v[200:203], a[240:243], a[128:131], v[200:203]
    v_cvt_pk_bf16_f32 v80, v208, v209
    v_cvt_pk_bf16_f32 v81, v210, v211
    v_mfma_f32_16x16x32_bf16 v[200:203], a[244:247], a[140:143], v[200:203]
    v_exp_f32 v167, v167
    v_mfma_f32_16x16x16_bf16 v[160:163], v[52:53], v[142:143], v[160:163]
    v_cvt_pk_bf16_f32 v178, v164, v165
    v_cvt_pk_bf16_f32 v102, v204, v205
    v_mfma_f32_16x16x32_bf16 v[220:223], a[224:227], a[72:75], 0
    v_cvt_pk_bf16_f32 v103, v206, v207
    v_cvt_pk_bf16_f32 v179, v166, v167
    v_mfma_f32_16x16x32_bf16 v[220:223], a[228:231], a[84:87], v[220:223]
    v_cvt_pk_bf16_f32 v124, v200, v201
    v_cvt_pk_bf16_f32 v125, v202, v203
    v_mfma_f32_16x16x32_bf16 v[196:199], a[216:219], v[176:179], v[196:199]
    ds_read_b128 a[240:243], v224 offset:49792
    ds_read_b128 a[244:247], v224 offset:49856
    v_mfma_f32_16x16x32_bf16 v[184:187], v[74:77], v[176:179], v[184:187]
    ds_read_b128 v[164:167], v235
    v_bfe_u32 v235, s62, v232, 4
    v_mfma_f32_16x16x32_bf16 v[188:191], v[96:99], v[176:179], v[188:191]
    v_fma_f32 v168, v168, s37, -v236
    v_fma_f32 v169, v169, s37, -v236
    v_mfma_f32_16x16x32_bf16 v[192:195], v[118:121], v[176:179], v[192:195]
    ds_read_b64_tr_b16 a[248:249], v109 offset:24576
    ds_read_b64_tr_b16 a[250:251], v109 offset:26112
    v_mfma_f32_16x16x32_bf16 v[216:219], a[224:227], a[76:79], 0
    ds_read_b64_tr_b16 a[252:253], v109 offset:24608
    ds_read_b64_tr_b16 a[254:255], v109 offset:26144
    v_mfma_f32_16x16x32_bf16 v[216:219], a[228:231], a[88:91], v[216:219]
    ds_read_b64_tr_b16 a[220:221], v109 offset:24640
    ds_read_b64_tr_b16 a[222:223], v109 offset:26176
    v_mfma_f32_16x16x32_bf16 v[212:215], a[224:227], a[80:83], 0
    ds_read_b128 a[224:227], v225 offset:39872
    v_fma_f32 v170, v170, s37, -v236
    v_mfma_f32_16x16x32_bf16 v[212:215], a[228:231], a[92:95], v[212:215]
    s_waitcnt lgkmcnt(11)
    ds_read_b128 a[228:231], v225 offset:39936
    v_fma_f32 v171, v171, s37, -v236
    v_mfma_f32_16x16x32_bf16 v[220:223], a[232:235], a[96:99], v[220:223]
    v_exp_f32 v168, v168
    v_mfma_f32_16x16x32_bf16 v[220:223], a[236:239], a[108:111], v[220:223]
    v_exp_f32 v169, v169
    v_mfma_f32_16x16x32_bf16 v[216:219], a[232:235], a[100:103], v[216:219]
    v_exp_f32 v170, v170
    v_mfma_f32_16x16x32_bf16 v[216:219], a[236:239], a[112:115], v[216:219]
    s_waitcnt lgkmcnt(8)
    v_exp_f32 v171, v171
    v_mfma_f32_16x16x32_bf16 v[164:167], v[54:57], v[138:141], v[164:167]
    s_waitcnt lgkmcnt(6)
    ds_write_b128 v130, a[248:251] offset:24576
    v_mfma_f32_16x16x32_bf16 v[212:215], a[232:235], a[104:107], v[212:215]
    s_waitcnt lgkmcnt(5)
    ds_write_b128 v130, a[252:255] offset:25600
    v_mfma_f32_16x16x32_bf16 v[212:215], a[236:239], a[116:119], v[212:215]
    s_waitcnt lgkmcnt(4)
    ds_write_b128 v130, a[220:223] offset:26624
    v_mfma_f32_16x16x32_bf16 v[220:223], a[240:243], a[120:123], v[220:223]
    v_cvt_pk_bf16_f32 v180, v168, v169
    v_cvt_pk_bf16_f32 v181, v170, v171
    v_mfma_f32_16x16x32_bf16 v[220:223], a[244:247], a[132:135], v[220:223]
    v_fma_f32 v172, v172, s37, -v236
    v_fma_f32 v173, v173, s37, -v236
    v_mfma_f32_16x16x16_bf16 v[164:167], v[58:59], v[142:143], v[164:167]
    v_fma_f32 v174, v174, s37, -v236
    v_fma_f32 v175, v175, s37, -v236
    v_mfma_f32_16x16x32_bf16 v[216:219], a[240:243], a[124:127], v[216:219]
    v_exp_f32 v172, v172
    v_mfma_f32_16x16x32_bf16 v[216:219], a[244:247], a[136:139], v[216:219]
    v_cvt_pk_bf16_f32 v78, v220, v221
    v_cvt_pk_bf16_f32 v79, v222, v223
    v_mfma_f32_16x16x32_bf16 v[212:215], a[240:243], a[128:131], v[212:215]
    v_exp_f32 v173, v173
    v_mfma_f32_16x16x32_bf16 v[212:215], a[244:247], a[140:143], v[212:215]
    s_waitcnt lgkmcnt(3)
    v_exp_f32 v174, v174
    v_mfma_f32_16x16x32_bf16 v[208:211], a[144:147], a[224:227], 0
    ds_read_b128 a[232:235], v225 offset:40000
    v_cvt_pk_bf16_f32 v100, v216, v217
    v_mfma_f32_16x16x32_bf16 v[208:211], a[156:159], a[228:231], v[208:211]
    ds_read_b128 a[236:239], v225 offset:40064
    v_cvt_pk_bf16_f32 v101, v218, v219
    v_mfma_f32_16x16x32_bf16 v[204:207], a[148:151], a[224:227], 0
    v_cvt_pk_bf16_f32 v122, v212, v213
    v_cvt_pk_bf16_f32 v123, v214, v215
    v_mfma_f32_16x16x32_bf16 v[204:207], a[160:163], a[228:231], v[204:207]
    ds_read_b128 a[240:243], v225 offset:40128
    ds_read_b128 a[244:247], v225 offset:40192
    v_mfma_f32_16x16x32_bf16 v[200:203], a[152:155], a[224:227], 0
    ds_read_b128 a[248:251], v227 offset:37120
    v_cvt_pk_bf16_f32 v182, v172, v173
    v_mfma_f32_16x16x32_bf16 v[200:203], a[164:167], a[228:231], v[200:203]
    ds_read_b128 a[252:255], v227 offset:37184
    v_exp_f32 v175, v175
    v_max3_f32 v248, v144, v145, v146
    ds_read_b128 a[220:223], v227 offset:37248
    v_cvt_pk_bf16_f32 v183, v174, v175
    ds_read_b128 a[224:227], v227 offset:37312
    v_max3_f32 v249, v147, v148, v149
    v_mfma_f32_16x16x32_bf16 v[196:199], a[216:219], v[180:183], v[196:199]
    ds_read_b128 a[228:231], v227 offset:37376
    v_max3_f32 v248, v248, v150, v151
    v_mfma_f32_16x16x32_bf16 v[184:187], v[78:81], v[180:183], v[184:187]
    ds_read_b128 v[168:171], v234
    v_bfe_u32 v234, s62, v232, 4
    v_mfma_f32_16x16x32_bf16 v[188:191], v[100:103], v[180:183], v[188:191]
    ds_read_b128 v[172:175], v250
    v_mad_u32_u24 v250, v235, s40, v228
    v_mfma_f32_16x16x32_bf16 v[192:195], v[122:125], v[180:183], v[192:195]
    s_waitcnt lgkmcnt(9)
    v_rcp_f32 v197, v196
    v_mfma_f32_16x16x32_bf16 v[208:211], a[168:171], a[232:235], v[208:211]
    v_mul_f32 v184, v184, v197
    v_mul_f32 v185, v185, v197
    v_mfma_f32_16x16x32_bf16 v[208:211], a[180:183], a[236:239], v[208:211]
    v_cvt_pk_bf16_f32 v184, v184, v185
    v_mul_f32 v186, v186, v197
    v_mfma_f32_16x16x32_bf16 v[204:207], a[172:175], a[232:235], v[204:207]
    v_mul_f32 v187, v187, v197
    v_cvt_pk_bf16_f32 v185, v186, v187
    v_mfma_f32_16x16x32_bf16 v[204:207], a[184:187], a[236:239], v[204:207]
    v_mul_f32 v188, v188, v197
    v_mul_f32 v189, v189, v197
    v_mfma_f32_16x16x32_bf16 v[200:203], a[176:179], a[232:235], v[200:203]
    ds_read_b128 a[232:235], v227 offset:37440
    v_cvt_pk_bf16_f32 v186, v188, v189
    v_mfma_f32_16x16x32_bf16 v[200:203], a[188:191], a[236:239], v[200:203]
    s_waitcnt lgkmcnt(4)
    v_mul_f32 v190, v190, v197
    v_mul_f32 v191, v191, v197
    v_mfma_f32_16x16x32_bf16 v[208:211], a[192:195], a[240:243], v[208:211]
    v_cvt_pk_bf16_f32 v187, v190, v191
    v_mul_f32 v192, v192, v197
    v_mfma_f32_16x16x32_bf16 v[208:211], a[204:207], a[244:247], v[208:211]
    v_mul_f32 v193, v193, v197
    v_cvt_pk_bf16_f32 v188, v192, v193
    v_mfma_f32_16x16x32_bf16 v[204:207], a[196:199], a[240:243], v[204:207]
    v_mul_f32 v194, v194, v197
    v_mul_f32 v195, v195, v197
    v_mfma_f32_16x16x32_bf16 v[204:207], a[208:211], a[244:247], v[204:207]
    v_cvt_pk_bf16_f32 v189, v194, v195
    v_mad_u32_u24 v235, v235, s40, v229
    v_mfma_f32_16x16x32_bf16 v[200:203], a[200:203], a[240:243], v[200:203]
    v_cvt_pk_bf16_f32 v132, v208, v209
    v_cvt_pk_bf16_f32 v133, v210, v211
    v_mfma_f32_16x16x32_bf16 v[200:203], a[212:215], a[244:247], v[200:203]
    ds_write_b128 v237, v[184:187]
    v_mfma_f32_16x16x32_bf16 v[220:223], a[248:251], a[72:75], 0
    v_cvt_pk_bf16_f32 v134, v204, v205
    v_cvt_pk_bf16_f32 v135, v206, v207
    v_mfma_f32_16x16x32_bf16 v[220:223], a[252:255], a[84:87], v[220:223]
    s_waitcnt lgkmcnt(1)
    ds_write_b64 v238, v[188:189]
    v_mfma_f32_16x16x32_bf16 v[168:171], v[30:33], v[132:135], v[168:171]
    v_mad_u32_u24 v234, v234, s40, v230
    v_cvt_pk_bf16_f32 v136, v200, v201
    v_mfma_f32_16x16x32_bf16 v[172:175], v[6:9], v[132:135], v[172:175]
    v_cvt_pk_bf16_f32 v137, v202, v203
    v_max3_f32 v249, v249, v152, v153
    v_mfma_f32_16x16x32_bf16 v[216:219], a[248:251], a[76:79], 0
    ds_read_b64_tr_b16 a[236:237], v109 offset:36864
    ds_read_b64_tr_b16 a[238:239], v109 offset:38400
    v_mfma_f32_16x16x32_bf16 v[216:219], a[252:255], a[88:91], v[216:219]
    ds_read_b64_tr_b16 a[240:241], v109 offset:36896
    ds_read_b64_tr_b16 a[242:243], v109 offset:38432
    v_mfma_f32_16x16x16_bf16 v[168:171], v[34:35], v[136:137], v[168:171]
    ds_read_b64_tr_b16 a[244:245], v109 offset:36928
    ds_read_b64_tr_b16 a[246:247], v109 offset:38464
    v_mfma_f32_16x16x16_bf16 v[172:175], v[10:11], v[136:137], v[172:175]
    v_max3_f32 v248, v248, v154, v155
    v_max3_f32 v249, v249, v156, v157
    v_mfma_f32_16x16x32_bf16 v[212:215], a[248:251], a[80:83], 0
    ds_read_b64_tr_b16 a[248:249], v109 offset:49152
    ds_read_b64_tr_b16 a[250:251], v109 offset:50688
    v_mfma_f32_16x16x32_bf16 v[212:215], a[252:255], a[92:95], v[212:215]
    ds_read_b64_tr_b16 a[252:253], v109 offset:49184
    ds_read_b64_tr_b16 a[254:255], v109 offset:50720
    v_mfma_f32_16x16x32_bf16 v[220:223], a[220:223], a[96:99], v[220:223]
    v_max3_f32 v248, v248, v158, v159
    v_max3_f32 v249, v249, v160, v161
    v_mfma_f32_16x16x32_bf16 v[220:223], a[224:227], a[108:111], v[220:223]
    v_max3_f32 v248, v248, v162, v163
    v_max3_f32 v249, v249, v164, v165
    v_mfma_f32_16x16x32_bf16 v[216:219], a[220:223], a[100:103], v[216:219]
    s_waitcnt lgkmcnt(8)
    ds_write_b128 v130, a[236:239] offset:36864
    v_mfma_f32_16x16x32_bf16 v[216:219], a[224:227], a[112:115], v[216:219]
    s_waitcnt lgkmcnt(7)
    ds_write_b128 v130, a[240:243] offset:37888
    v_mfma_f32_16x16x32_bf16 v[212:215], a[220:223], a[104:107], v[212:215]
    s_waitcnt lgkmcnt(6)
    ds_write_b128 v130, a[244:247] offset:38912
    v_mfma_f32_16x16x32_bf16 v[212:215], a[224:227], a[116:119], v[212:215]
    v_max3_f32 v248, v248, v166, v167
    v_max_f32 v248, v248, v249
    v_mfma_f32_16x16x32_bf16 v[220:223], a[228:231], a[120:123], v[220:223]
    v_mov_b32 v249, v248
    v_mfma_f32_16x16x32_bf16 v[220:223], a[232:235], a[132:135], v[220:223]
    v_mfma_f32_16x16x32_bf16 v[216:219], a[228:231], a[124:127], v[216:219]
    v_permlane16_swap_b32 v248, v249
    v_mfma_f32_16x16x32_bf16 v[216:219], a[232:235], a[136:139], v[216:219]
    v_max_f32 v248, v248, v249
    v_mov_b32 v249, v248
    v_mfma_f32_16x16x32_bf16 v[212:215], a[228:231], a[128:131], v[212:215]
    v_mfma_f32_16x16x32_bf16 v[212:215], a[232:235], a[140:143], v[212:215]
    s_waitcnt lgkmcnt(3)
    v_permlane32_swap_b32 v248, v249
    v_cvt_pk_bf16_f32 v84, v220, v221
    v_cvt_pk_bf16_f32 v85, v222, v223
    ds_read_b128 a[236:239], v224
    v_cvt_pk_bf16_f32 v106, v216, v217
    v_cvt_pk_bf16_f32 v107, v218, v219
    ds_read_b128 a[240:243], v224 offset:64
    ds_read_b128 a[244:247], v224 offset:128
    v_cvt_pk_bf16_f32 v128, v212, v213
    v_cvt_pk_bf16_f32 v129, v214, v215
    ds_read_b64_tr_b16 a[220:221], v109 offset:49216
    ds_read_b64_tr_b16 a[222:223], v109 offset:50752
    ds_write_b128 v130, a[248:251] offset:49152
    ds_write_b128 v130, a[252:255] offset:50176
    v_max_f32 v248, v248, v249
    v_mul_f32 v236, s37, v248
    v_fma_f32 v144, v144, s37, -v236
    v_fma_f32 v145, v145, s37, -v236
    v_fma_f32 v146, v146, s37, -v236
    v_fma_f32 v147, v147, s37, -v236
    v_exp_f32 v144, v144
    v_exp_f32 v145, v145
    s_waitcnt lgkmcnt(6)
    v_mfma_f32_16x16x32_bf16 v[208:211], a[0:3], a[236:239], 0
    s_waitcnt lgkmcnt(5)
    v_exp_f32 v146, v146
    v_mfma_f32_16x16x32_bf16 v[208:211], a[12:15], a[240:243], v[208:211]
    v_exp_f32 v147, v147
    v_mfma_f32_16x16x32_bf16 v[204:207], a[4:7], a[236:239], 0
    v_cvt_pk_bf16_f32 v176, v144, v145
    v_cvt_pk_bf16_f32 v177, v146, v147
    v_mfma_f32_16x16x32_bf16 v[204:207], a[16:19], a[240:243], v[204:207]
    ds_read_b128 a[248:251], v224 offset:192
    ds_read_b128 a[252:255], v224 offset:256
    v_mfma_f32_16x16x32_bf16 v[200:203], a[8:11], a[236:239], 0
    ds_read_b128 v[144:147], v228 offset:1280
    v_fma_f32 v148, v148, s37, -v236
    v_mfma_f32_16x16x32_bf16 v[200:203], a[20:23], a[240:243], v[200:203]
    v_fma_f32 v149, v149, s37, -v236
    v_fma_f32 v150, v150, s37, -v236
    v_mfma_f32_16x16x32_bf16 v[220:223], a[236:239], a[72:75], 0
    s_waitcnt lgkmcnt(5)
    ds_write_b128 v130, a[220:223] offset:51200
    v_mfma_f32_16x16x32_bf16 v[220:223], a[240:243], a[84:87], v[220:223]
    v_fma_f32 v151, v151, s37, -v236
    v_fma_f32 v152, v152, s37, -v236
    v_mfma_f32_16x16x32_bf16 v[216:219], a[236:239], a[76:79], 0
    v_exp_f32 v148, v148
    v_mfma_f32_16x16x32_bf16 v[216:219], a[240:243], a[88:91], v[216:219]
    v_exp_f32 v149, v149
    v_mfma_f32_16x16x32_bf16 v[212:215], a[236:239], a[80:83], 0
    ds_read_b128 a[236:239], v224 offset:3072
    ds_read_b64_tr_b16 a[220:221], v131
    v_mfma_f32_16x16x32_bf16 v[212:215], a[240:243], a[92:95], v[212:215]
    ds_read_b128 a[240:243], v224 offset:3136
    v_cvt_pk_bf16_f32 v178, v148, v149
    v_mfma_f32_16x16x32_bf16 v[208:211], a[24:27], a[244:247], v[208:211]
    s_waitcnt lgkmcnt(6)
    ds_read_b64_tr_b16 a[222:223], v131 offset:1536
    v_fma_f32 v153, v153, s37, -v236
    v_mfma_f32_16x16x32_bf16 v[208:211], a[36:39], a[248:251], v[208:211]
    s_waitcnt lgkmcnt(5)
    ds_read_b64_tr_b16 a[224:225], v109 offset:61440
    v_fma_f32 v154, v154, s37, -v236
    v_mfma_f32_16x16x32_bf16 v[144:147], v[12:15], v[132:135], v[144:147]
    ds_read_b64_tr_b16 a[226:227], v109 offset:62976
    ds_read_b64_tr_b16 a[228:229], v109 offset:61472
    v_mfma_f32_16x16x32_bf16 v[204:207], a[28:31], a[244:247], v[204:207]
    ds_read_b64_tr_b16 a[230:231], v109 offset:63008
    ds_read_b64_tr_b16 a[232:233], v109 offset:61504
    v_mfma_f32_16x16x32_bf16 v[204:207], a[40:43], a[248:251], v[204:207]
    ds_read_b64_tr_b16 a[234:235], v109 offset:63040
    v_fma_f32 v155, v155, s37, -v236
    v_mfma_f32_16x16x16_bf16 v[144:147], v[16:17], v[136:137], v[144:147]
    v_exp_f32 v150, v150
    v_mfma_f32_16x16x32_bf16 v[200:203], a[32:35], a[244:247], v[200:203]
    v_exp_f32 v151, v151
    v_mfma_f32_16x16x32_bf16 v[200:203], a[44:47], a[248:251], v[200:203]
    v_cvt_pk_bf16_f32 v179, v150, v151
    v_fma_f32 v156, v156, s37, -v236
    v_mfma_f32_16x16x32_bf16 v[220:223], a[244:247], a[96:99], v[220:223]
    ds_read_b128 v[148:151], v229 offset:1280
    v_fma_f32 v157, v157, s37, -v236
    v_mfma_f32_16x16x32_bf16 v[220:223], a[248:251], a[108:111], v[220:223]
    v_exp_f32 v152, v152
    v_mfma_f32_16x16x32_bf16 v[196:199], a[216:219], v[176:179], 0
    s_waitcnt lgkmcnt(5)
    ds_write_b128 v130, a[224:227] offset:61440
    v_mfma_f32_16x16x32_bf16 v[184:187], v[68:71], v[176:179], 0
    s_waitcnt lgkmcnt(4)
    ds_write_b128 v130, a[228:231] offset:62464
    v_mfma_f32_16x16x32_bf16 v[188:191], v[90:93], v[176:179], 0
    s_waitcnt lgkmcnt(3)
    ds_write_b128 v130, a[232:235] offset:63488
    v_mfma_f32_16x16x32_bf16 v[192:195], v[112:115], v[176:179], 0
    v_exp_f32 v153, v153
    v_mfma_f32_16x16x32_bf16 v[216:219], a[244:247], a[100:103], v[216:219]
    v_exp_f32 v154, v154
    v_mfma_f32_16x16x32_bf16 v[216:219], a[248:251], a[112:115], v[216:219]
    s_waitcnt lgkmcnt(3)
    v_exp_f32 v155, v155
    v_mfma_f32_16x16x32_bf16 v[148:151], v[36:39], v[132:135], v[148:151]
    v_cvt_pk_bf16_f32 v180, v152, v153
    v_cvt_pk_bf16_f32 v181, v154, v155
    v_mfma_f32_16x16x32_bf16 v[212:215], a[244:247], a[104:107], v[212:215]
    v_fma_f32 v158, v158, s37, -v236
    v_fma_f32 v159, v159, s37, -v236
    v_mfma_f32_16x16x32_bf16 v[212:215], a[248:251], a[116:119], v[212:215]
    v_exp_f32 v156, v156
    v_mfma_f32_16x16x16_bf16 v[148:151], v[40:41], v[136:137], v[148:151]
    v_exp_f32 v157, v157
    v_mfma_f32_16x16x32_bf16 v[208:211], a[48:51], a[252:255], v[208:211]
    ds_read_b128 a[244:247], v224 offset:3200
    ds_read_b128 a[248:251], v224 offset:3264
    v_mfma_f32_16x16x32_bf16 v[208:211], a[60:63], v[252:255], v[208:211]
    ds_read_b64_tr_b16 a[224:225], v131 offset:8
    v_cvt_pk_bf16_f32 v182, v156, v157
    v_mfma_f32_16x16x32_bf16 v[204:207], a[52:55], a[252:255], v[204:207]
    ds_read_b64_tr_b16 a[226:227], v131 offset:1544
    v_fma_f32 v160, v160, s37, -v236
    v_mfma_f32_16x16x32_bf16 v[204:207], a[64:67], v[252:255], v[204:207]
    ds_read_b64_tr_b16 a[228:229], v65
    v_fma_f32 v161, v161, s37, -v236
    v_mfma_f32_16x16x32_bf16 v[200:203], a[56:59], a[252:255], v[200:203]
    v_cvt_pk_bf16_f32 v0, v208, v209
    v_cvt_pk_bf16_f32 v1, v210, v211
    v_mfma_f32_16x16x32_bf16 v[200:203], a[68:71], v[252:255], v[200:203]
    ds_read_b64_tr_b16 a[230:231], v65 offset:1536
    ds_read_b64_tr_b16 a[232:233], v65 offset:8
    v_mfma_f32_16x16x32_bf16 v[220:223], a[252:255], a[120:123], v[220:223]
    v_cvt_pk_bf16_f32 v2, v204, v205
    v_cvt_pk_bf16_f32 v3, v206, v207
    v_mfma_f32_16x16x32_bf16 v[220:223], v[252:255], a[132:135], v[220:223]
    ds_read_b64_tr_b16 a[234:235], v65 offset:1544
    ds_read_b128 v[152:155], v229 offset:1920
    v_mfma_f32_16x16x32_bf16 v[216:219], a[252:255], a[124:127], v[216:219]
    v_cvt_pk_bf16_f32 v4, v200, v201
    v_cvt_pk_bf16_f32 v5, v202, v203
    v_mfma_f32_16x16x32_bf16 v[216:219], v[252:255], a[136:139], v[216:219]
    v_exp_f32 v158, v158
    v_mfma_f32_16x16x32_bf16 v[212:215], a[252:255], a[128:131], v[212:215]
    v_cvt_pk_bf16_f32 v66, v220, v221
    v_cvt_pk_bf16_f32 v67, v222, v223
    v_mfma_f32_16x16x32_bf16 v[212:215], v[252:255], a[140:143], v[212:215]
    ds_read_b128 a[252:255], v224 offset:3328
    ds_read_b128 v[252:255], v224 offset:3392
    v_mfma_f32_16x16x32_bf16 v[208:211], a[0:3], a[236:239], 0
    v_cvt_pk_bf16_f32 v88, v216, v217
    v_cvt_pk_bf16_f32 v89, v218, v219
    v_mfma_f32_16x16x32_bf16 v[208:211], a[12:15], a[240:243], v[208:211]
    v_exp_f32 v159, v159
    v_mfma_f32_16x16x32_bf16 v[204:207], a[4:7], a[236:239], 0
    v_cvt_pk_bf16_f32 v110, v212, v213
    v_cvt_pk_bf16_f32 v111, v214, v215
    v_mfma_f32_16x16x32_bf16 v[204:207], a[16:19], a[240:243], v[204:207]
    v_cvt_pk_bf16_f32 v183, v158, v159
    v_fma_f32 v162, v162, s37, -v236
    v_mfma_f32_16x16x32_bf16 v[200:203], a[8:11], a[236:239], 0
    ds_read_b128 v[156:159], v228 offset:1920
    v_fma_f32 v163, v163, s37, -v236
    v_mfma_f32_16x16x32_bf16 v[200:203], a[20:23], a[240:243], v[200:203]
    v_exp_f32 v160, v160
    v_mfma_f32_16x16x32_bf16 v[196:199], a[216:219], v[180:183], v[196:199]
    v_exp_f32 v161, v161
    v_mfma_f32_16x16x32_bf16 v[184:187], v[76:79], v[180:183], v[184:187]
    v_exp_f32 v162, v162
    v_mfma_f32_16x16x32_bf16 v[188:191], v[98:101], v[180:183], v[188:191]
    v_exp_f32 v163, v163
    v_mfma_f32_16x16x32_bf16 v[192:195], v[120:123], v[180:183], v[192:195]
    s_waitcnt lgkmcnt(2)
    v_cvt_pk_bf16_f32 v176, v160, v161
    v_cvt_pk_bf16_f32 v177, v162, v163
    v_mfma_f32_16x16x32_bf16 v[152:155], v[42:45], v[132:135], v[152:155]
    ds_read_b128 v[160:163], v250
    v_bfe_u32 v250, s66, v233, 4
    v_mfma_f32_16x16x32_bf16 v[220:223], a[236:239], a[72:75], 0
    v_mad_u32_u24 v250, v250, s40, v231
    v_fma_f32 v164, v164, s37, -v236
    v_mfma_f32_16x16x32_bf16 v[220:223], a[240:243], a[84:87], v[220:223]
    v_fma_f32 v165, v165, s37, -v236
    v_fma_f32 v166, v166, s37, -v236
    v_mfma_f32_16x16x16_bf16 v[152:155], v[46:47], v[136:137], v[152:155]
    s_waitcnt lgkmcnt(1)
    v_fma_f32 v167, v167, s37, -v236
    v_max3_f32 v248, v168, v169, v170
    v_mfma_f32_16x16x32_bf16 v[156:159], v[18:21], v[132:135], v[156:159]
    v_exp_f32 v164, v164
    v_mfma_f32_16x16x32_bf16 v[216:219], a[236:239], a[76:79], 0
    v_exp_f32 v165, v165
    v_mfma_f32_16x16x32_bf16 v[216:219], a[240:243], a[88:91], v[216:219]
    v_exp_f32 v166, v166
    v_mfma_f32_16x16x32_bf16 v[212:215], a[236:239], a[80:83], 0
    ds_read_b128 a[236:239], v225 offset:42944
    v_cvt_pk_bf16_f32 v178, v164, v165
    v_mfma_f32_16x16x32_bf16 v[212:215], a[240:243], a[92:95], v[212:215]
    ds_read_b128 a[240:243], v225 offset:43008
    v_max3_f32 v249, v171, v172, v173
    v_mfma_f32_16x16x16_bf16 v[156:159], v[22:23], v[136:137], v[156:159]
    s_waitcnt lgkmcnt(2)
    v_exp_f32 v167, v167
    v_mfma_f32_16x16x32_bf16 v[160:163], v[0:3], v[132:135], v[160:163]
    v_cvt_pk_bf16_f32 v179, v166, v167
    v_max3_f32 v248, v248, v174, v175
    v_mfma_f32_16x16x32_bf16 v[208:211], a[24:27], a[244:247], v[208:211]
    ds_read_b128 v[164:167], v235
    v_bfe_u32 v235, s65, v232, 4
    v_mfma_f32_16x16x32_bf16 v[208:211], a[36:39], a[248:251], v[208:211]
    v_mad_u32_u24 v235, v235, s40, v230
    v_max3_f32 v249, v249, v144, v145
    v_mfma_f32_16x16x32_bf16 v[196:199], a[216:219], v[176:179], v[196:199]
    v_max3_f32 v248, v248, v146, v147
    v_max3_f32 v249, v249, v148, v149
    v_mfma_f32_16x16x32_bf16 v[184:187], v[82:85], v[176:179], v[184:187]
    v_max3_f32 v248, v248, v150, v151
    v_max3_f32 v249, v249, v152, v153
    v_mfma_f32_16x16x32_bf16 v[188:191], v[104:107], v[176:179], v[188:191]
    v_max3_f32 v248, v248, v154, v155
    v_max3_f32 v249, v249, v156, v157
    v_mfma_f32_16x16x32_bf16 v[192:195], v[126:129], v[176:179], v[192:195]
    v_rcp_f32 v197, v196
    v_mfma_f32_16x16x16_bf16 v[160:163], v[4:5], v[136:137], v[160:163]
    v_mul_f32 v184, v184, v197
    v_mul_f32 v185, v185, v197
    v_mfma_f32_16x16x32_bf16 v[204:207], a[28:31], a[244:247], v[204:207]
    v_cvt_pk_bf16_f32 v184, v184, v185
    v_mul_f32 v186, v186, v197
    v_mfma_f32_16x16x32_bf16 v[204:207], a[40:43], a[248:251], v[204:207]
    v_mul_f32 v187, v187, v197
    v_cvt_pk_bf16_f32 v185, v186, v187
    v_mfma_f32_16x16x32_bf16 v[200:203], a[32:35], a[244:247], v[200:203]
    v_mul_f32 v188, v188, v197
    v_mul_f32 v189, v189, v197
    v_mfma_f32_16x16x32_bf16 v[200:203], a[44:47], a[248:251], v[200:203]
    v_cvt_pk_bf16_f32 v186, v188, v189
    v_mul_f32 v190, v190, v197
    v_mfma_f32_16x16x32_bf16 v[220:223], a[244:247], a[96:99], v[220:223]
    v_mul_f32 v191, v191, v197
    v_cvt_pk_bf16_f32 v187, v190, v191
    v_mfma_f32_16x16x32_bf16 v[220:223], a[248:251], a[108:111], v[220:223]
    v_mul_f32 v192, v192, v197
    v_mul_f32 v193, v193, v197
    v_mfma_f32_16x16x32_bf16 v[216:219], a[244:247], a[100:103], v[216:219]
    v_cvt_pk_bf16_f32 v188, v192, v193
    v_mul_f32 v194, v194, v197
    v_mfma_f32_16x16x32_bf16 v[216:219], a[248:251], a[112:115], v[216:219]
    v_mul_f32 v195, v195, v197
    v_cvt_pk_bf16_f32 v189, v194, v195
    v_mfma_f32_16x16x32_bf16 v[212:215], a[244:247], a[104:107], v[212:215]
    ds_read_b128 a[244:247], v225 offset:43072
    v_max3_f32 v248, v248, v158, v159
    v_mfma_f32_16x16x32_bf16 v[212:215], a[248:251], a[116:119], v[212:215]
    ds_read_b128 a[248:251], v225 offset:43136
    v_max3_f32 v249, v249, v160, v161
    v_mfma_f32_16x16x32_bf16 v[208:211], a[48:51], a[252:255], v[208:211]
    ds_write_b128 v237, v[184:187] offset:6144
    v_mfma_f32_16x16x32_bf16 v[208:211], a[60:63], v[252:255], v[208:211]
    ds_write_b64 v238, v[188:189] offset:6144
    v_mfma_f32_16x16x32_bf16 v[204:207], a[52:55], a[252:255], v[204:207]
    v_max3_f32 v248, v248, v162, v163
    v_mfma_f32_16x16x32_bf16 v[204:207], a[64:67], v[252:255], v[204:207]
    v_mfma_f32_16x16x32_bf16 v[200:203], a[56:59], a[252:255], v[200:203]
    v_mfma_f32_16x16x32_bf16 v[200:203], a[68:71], v[252:255], v[200:203]
    v_mfma_f32_16x16x32_bf16 v[220:223], a[252:255], a[120:123], v[220:223]
    v_mfma_f32_16x16x32_bf16 v[220:223], v[252:255], a[132:135], v[220:223]
    v_cvt_pk_bf16_f32 v24, v208, v209
    v_cvt_pk_bf16_f32 v25, v210, v211
    v_mfma_f32_16x16x32_bf16 v[216:219], a[252:255], a[124:127], v[216:219]
    v_mfma_f32_16x16x32_bf16 v[216:219], v[252:255], a[136:139], v[216:219]
    v_cvt_pk_bf16_f32 v26, v204, v205
    v_cvt_pk_bf16_f32 v27, v206, v207
    v_mfma_f32_16x16x32_bf16 v[212:215], a[252:255], a[128:131], v[212:215]
    v_cvt_pk_bf16_f32 v28, v200, v201
    v_cvt_pk_bf16_f32 v29, v202, v203
    v_mfma_f32_16x16x32_bf16 v[212:215], v[252:255], a[140:143], v[212:215]
    s_waitcnt lgkmcnt(2)
    v_cvt_pk_bf16_f32 v68, v220, v221
    v_cvt_pk_bf16_f32 v69, v222, v223
    v_mfma_f32_16x16x32_bf16 v[164:167], v[24:27], v[132:135], v[164:167]
    v_cvt_pk_bf16_f32 v90, v216, v217
    v_cvt_pk_bf16_f32 v91, v218, v219
    v_mfma_f32_16x16x32_bf16 v[208:211], a[144:147], a[236:239], 0
    ds_read_b128 a[252:255], v225 offset:43200
    ds_read_b128 v[252:255], v225 offset:43264
    v_mfma_f32_16x16x32_bf16 v[208:211], a[156:159], a[240:243], v[208:211]
    v_cvt_pk_bf16_f32 v112, v212, v213
    v_cvt_pk_bf16_f32 v113, v214, v215
    v_mfma_f32_16x16x16_bf16 v[164:167], v[28:29], v[136:137], v[164:167]
    v_mfma_f32_16x16x32_bf16 v[204:207], a[148:151], a[236:239], 0
    v_mfma_f32_16x16x32_bf16 v[204:207], a[160:163], a[240:243], v[204:207]
    v_mfma_f32_16x16x32_bf16 v[200:203], a[152:155], a[236:239], 0
    ds_read_b128 a[236:239], v226 offset:1152
    v_mfma_f32_16x16x32_bf16 v[200:203], a[164:167], a[240:243], v[200:203]
    ds_read_b128 a[240:243], v226 offset:1216
    v_mfma_f32_16x16x32_bf16 v[208:211], a[168:171], a[244:247], v[208:211]
    v_mfma_f32_16x16x32_bf16 v[208:211], a[180:183], a[248:251], v[208:211]
    v_max3_f32 v249, v249, v164, v165
    v_max3_f32 v248, v248, v166, v167
    v_mfma_f32_16x16x32_bf16 v[204:207], a[172:175], a[244:247], v[204:207]
    s_waitcnt lgkmcnt(2)
    v_max_f32 v248, v248, v249
    v_mov_b32 v249, v248
    v_mfma_f32_16x16x32_bf16 v[204:207], a[184:187], a[248:251], v[204:207]
    s_barrier
    buffer_load_dwordx4 v246, s[4:7], s56 offen lds
    v_mfma_f32_16x16x32_bf16 v[200:203], a[176:179], a[244:247], v[200:203]
    s_add_u32 m0, s42, 0x7900
    ds_read_b128 a[244:247], v226 offset:1280
    v_mfma_f32_16x16x32_bf16 v[200:203], a[188:191], a[248:251], v[200:203]
    ds_read_b128 a[248:251], v226 offset:1344
    v_mfma_f32_16x16x32_bf16 v[208:211], a[192:195], a[252:255], v[208:211]
    v_permlane16_swap_b32 v248, v249
    v_mfma_f32_16x16x32_bf16 v[208:211], a[204:207], v[252:255], v[208:211]
    v_max_f32 v248, v248, v249
    v_mov_b32 v249, v248
    v_mfma_f32_16x16x32_bf16 v[204:207], a[196:199], a[252:255], v[204:207]
    v_mfma_f32_16x16x32_bf16 v[204:207], a[208:211], v[252:255], v[204:207]
    v_permlane32_swap_b32 v248, v249
    v_mfma_f32_16x16x32_bf16 v[200:203], a[200:203], a[252:255], v[200:203]
    ds_read_b128 a[252:255], v226 offset:1408
    v_max_f32 v248, v248, v249
    v_mfma_f32_16x16x32_bf16 v[200:203], a[212:215], v[252:255], v[200:203]
    s_waitcnt lgkmcnt(3)
    v_cvt_pk_bf16_f32 v138, v208, v209
    v_cvt_pk_bf16_f32 v139, v210, v211
    v_mfma_f32_16x16x32_bf16 v[220:223], a[144:147], a[236:239], 0
    v_cvt_pk_bf16_f32 v140, v204, v205
    v_cvt_pk_bf16_f32 v141, v206, v207
    v_mfma_f32_16x16x32_bf16 v[220:223], a[156:159], a[240:243], v[220:223]
    ds_read_b128 v[252:255], v226 offset:1472
    v_mul_f32 v236, s37, v248
    v_mfma_f32_16x16x32_bf16 v[216:219], a[148:151], a[236:239], 0
    v_cvt_pk_bf16_f32 v142, v200, v201
    v_cvt_pk_bf16_f32 v143, v202, v203
    v_mfma_f32_16x16x32_bf16 v[216:219], a[160:163], a[240:243], v[216:219]
    buffer_load_dwordx4 v247, s[4:7], s56 offen lds
    v_mfma_f32_16x16x32_bf16 v[212:215], a[152:155], a[236:239], 0
    s_add_u32 s56, s39, 0x222000
    ds_read_b128 a[236:239], v227 offset:6144
    v_fma_f32 v168, v168, s37, -v236
    v_mfma_f32_16x16x32_bf16 v[212:215], a[164:167], a[240:243], v[212:215]
    s_add_u32 m0, s41, 0x9740
    ds_read_b128 a[240:243], v227 offset:6208
    v_fma_f32 v169, v169, s37, -v236
    s_waitcnt lgkmcnt(4)
    v_mfma_f32_16x16x32_bf16 v[220:223], a[168:171], a[244:247], v[220:223]
    v_fma_f32 v170, v170, s37, -v236
    v_fma_f32 v171, v171, s37, -v236
    v_mfma_f32_16x16x32_bf16 v[220:223], a[180:183], a[248:251], v[220:223]
    v_exp_f32 v168, v168
    v_mfma_f32_16x16x32_bf16 v[216:219], a[172:175], a[244:247], v[216:219]
    v_exp_f32 v169, v169
    v_mfma_f32_16x16x32_bf16 v[216:219], a[184:187], a[248:251], v[216:219]
    v_exp_f32 v170, v170
    v_mfma_f32_16x16x32_bf16 v[212:215], a[176:179], a[244:247], v[212:215]
    ds_read_b128 a[244:247], v227 offset:6272
    v_cvt_pk_bf16_f32 v180, v168, v169
    v_mfma_f32_16x16x32_bf16 v[212:215], a[188:191], a[248:251], v[212:215]
    s_waitcnt lgkmcnt(3)
    ds_read_b128 a[248:251], v227 offset:6336
    v_fma_f32 v172, v172, s37, -v236
    v_mfma_f32_16x16x32_bf16 v[220:223], a[192:195], a[252:255], v[220:223]
    buffer_load_dwordx4 v246, s[4:7], s56 offen lds
    v_mfma_f32_16x16x32_bf16 v[220:223], a[204:207], v[252:255], v[220:223]
    s_add_u32 m0, s42, 0x9740
    v_exp_f32 v171, v171
    v_mfma_f32_16x16x32_bf16 v[216:219], a[196:199], a[252:255], v[216:219]
    v_cvt_pk_bf16_f32 v181, v170, v171
    v_fma_f32 v173, v173, s37, -v236
    v_mfma_f32_16x16x32_bf16 v[216:219], a[208:211], v[252:255], v[216:219]
    ds_read_b128 v[168:171], v234
    v_bfe_u32 v234, s67, v233, 4
    v_mfma_f32_16x16x32_bf16 v[212:215], a[200:203], a[252:255], v[212:215]
    v_cvt_pk_bf16_f32 v132, v220, v221
    v_cvt_pk_bf16_f32 v133, v222, v223
    v_mfma_f32_16x16x32_bf16 v[212:215], a[212:215], v[252:255], v[212:215]
    s_waitcnt lgkmcnt(3)
    ds_read_b128 a[252:255], v227 offset:6400
    ds_read_b128 v[252:255], v227 offset:6464
    v_mfma_f32_16x16x32_bf16 v[208:211], a[0:3], a[236:239], 0
    v_cvt_pk_bf16_f32 v134, v216, v217
    v_cvt_pk_bf16_f32 v135, v218, v219
    v_mfma_f32_16x16x32_bf16 v[208:211], a[12:15], a[240:243], v[208:211]
    v_mad_u32_u24 v234, v234, s40, v231
    v_fma_f32 v174, v174, s37, -v236
    v_mfma_f32_16x16x32_bf16 v[204:207], a[4:7], a[236:239], 0
    v_cvt_pk_bf16_f32 v136, v212, v213
    v_cvt_pk_bf16_f32 v137, v214, v215
    v_mfma_f32_16x16x32_bf16 v[204:207], a[16:19], a[240:243], v[204:207]
    buffer_load_dwordx4 v247, s[4:7], s56 offen lds
    v_mfma_f32_16x16x32_bf16 v[200:203], a[8:11], a[236:239], 0
    s_add_u32 s56, s39, 0x24c000
    v_fma_f32 v175, v175, s37, -v236
    v_fma_f32 v144, v144, s37, -v236
    v_mfma_f32_16x16x32_bf16 v[200:203], a[20:23], a[240:243], v[200:203]
    s_add_u32 m0, s41, 0xb580
    v_exp_f32 v172, v172
    s_waitcnt lgkmcnt(2)
    v_mfma_f32_16x16x32_bf16 v[168:171], v[24:27], v[138:141], v[168:171]
    v_exp_f32 v173, v173
    v_mfma_f32_16x16x32_bf16 v[220:223], a[236:239], a[72:75], 0
    v_exp_f32 v174, v174
    v_mfma_f32_16x16x32_bf16 v[220:223], a[240:243], a[84:87], v[220:223]
    v_exp_f32 v175, v175
    v_mfma_f32_16x16x32_bf16 v[216:219], a[236:239], a[76:79], 0
    v_cvt_pk_bf16_f32 v182, v172, v173
    v_cvt_pk_bf16_f32 v183, v174, v175
    v_mfma_f32_16x16x32_bf16 v[216:219], a[240:243], a[88:91], v[216:219]
    ds_read_b128 v[172:175], v235
    v_bfe_u32 v235, s68, v233, 4
    v_mfma_f32_16x16x32_bf16 v[196:199], a[216:219], v[180:183], 0
    v_mad_u32_u24 v235, v235, s40, v231
    v_fma_f32 v145, v145, s37, -v236
    v_mfma_f32_16x16x32_bf16 v[184:187], v[70:73], v[180:183], 0
    v_fma_f32 v146, v146, s37, -v236
    v_fma_f32 v147, v147, s37, -v236
    v_mfma_f32_16x16x32_bf16 v[188:191], v[92:95], v[180:183], 0
    v_exp_f32 v144, v144
    v_mfma_f32_16x16x32_bf16 v[192:195], v[114:117], v[180:183], 0
    v_exp_f32 v145, v145
    v_mfma_f32_16x16x16_bf16 v[168:171], v[28:29], v[142:143], v[168:171]
    v_exp_f32 v146, v146
    v_mfma_f32_16x16x32_bf16 v[212:215], a[236:239], a[80:83], 0
    ds_read_b128 a[236:239], v239
    v_cvt_pk_bf16_f32 v176, v144, v145
    v_mfma_f32_16x16x32_bf16 v[212:215], a[240:243], a[92:95], v[212:215]
    ds_read_b128 a[240:243], v240
    v_fma_f32 v148, v148, s37, -v236
    v_mfma_f32_16x16x32_bf16 v[208:211], a[24:27], a[244:247], v[208:211]
    v_exp_f32 v147, v147
    v_mfma_f32_16x16x32_bf16 v[208:211], a[36:39], a[248:251], v[208:211]
    s_waitcnt lgkmcnt(2)
    v_cvt_pk_bf16_f32 v177, v146, v147
    v_fma_f32 v149, v149, s37, -v236
    v_mfma_f32_16x16x32_bf16 v[172:175], v[30:33], v[138:141], v[172:175]
    ds_read_b128 v[144:147], v230 offset:1280
    v_fma_f32 v150, v150, s37, -v236
    v_mfma_f32_16x16x32_bf16 v[204:207], a[28:31], a[244:247], v[204:207]
    v_fma_f32 v151, v151, s37, -v236
    v_fma_f32 v152, v152, s37, -v236
    v_mfma_f32_16x16x32_bf16 v[204:207], a[40:43], a[248:251], v[204:207]
    v_exp_f32 v148, v148
    v_mfma_f32_16x16x16_bf16 v[172:175], v[34:35], v[142:143], v[172:175]
    v_exp_f32 v149, v149
    v_mfma_f32_16x16x32_bf16 v[200:203], a[32:35], a[244:247], v[200:203]
    v_exp_f32 v150, v150
    v_mfma_f32_16x16x32_bf16 v[200:203], a[44:47], a[248:251], v[200:203]
    v_exp_f32 v151, v151
    v_mfma_f32_16x16x32_bf16 v[220:223], a[244:247], a[96:99], v[220:223]
    v_cvt_pk_bf16_f32 v178, v148, v149
    v_cvt_pk_bf16_f32 v179, v150, v151
    v_mfma_f32_16x16x32_bf16 v[220:223], a[248:251], a[108:111], v[220:223]
    ds_read_b128 v[148:151], v230 offset:1920
    v_fma_f32 v153, v153, s37, -v236
    v_mfma_f32_16x16x32_bf16 v[196:199], a[216:219], v[176:179], v[196:199]
    v_fma_f32 v154, v154, s37, -v236
    v_fma_f32 v155, v155, s37, -v236
    v_mfma_f32_16x16x32_bf16 v[184:187], v[74:77], v[176:179], v[184:187]
    v_exp_f32 v152, v152
    v_mfma_f32_16x16x32_bf16 v[188:191], v[96:99], v[176:179], v[188:191]
    v_exp_f32 v153, v153
    v_mfma_f32_16x16x32_bf16 v[192:195], v[118:121], v[176:179], v[192:195]
    s_waitcnt lgkmcnt(1)
    v_exp_f32 v154, v154
    v_mfma_f32_16x16x32_bf16 v[144:147], v[36:39], v[138:141], v[144:147]
    v_exp_f32 v155, v155
    v_mfma_f32_16x16x32_bf16 v[216:219], a[244:247], a[100:103], v[216:219]
    v_cvt_pk_bf16_f32 v180, v152, v153
    v_cvt_pk_bf16_f32 v181, v154, v155
    v_mfma_f32_16x16x32_bf16 v[216:219], a[248:251], a[112:115], v[216:219]
    ds_read_b128 v[152:155], v250
    v_bfe_u32 v250, s69, v233, 4
    v_mfma_f32_16x16x16_bf16 v[144:147], v[40:41], v[142:143], v[144:147]
    s_waitcnt lgkmcnt(1)
    v_mad_u32_u24 v250, v250, s40, v231
    v_fma_f32 v156, v156, s37, -v236
    v_mfma_f32_16x16x32_bf16 v[148:151], v[42:45], v[138:141], v[148:151]
    v_fma_f32 v157, v157, s37, -v236
    v_fma_f32 v158, v158, s37, -v236
    v_mfma_f32_16x16x32_bf16 v[212:215], a[244:247], a[104:107], v[212:215]
    ds_read_b128 a[244:247], v239 offset:1024
    v_fma_f32 v159, v159, s37, -v236
    v_mfma_f32_16x16x32_bf16 v[212:215], a[248:251], a[116:119], v[212:215]
    ds_read_b128 a[248:251], v240 offset:1024
    v_fma_f32 v160, v160, s37, -v236
    v_mfma_f32_16x16x16_bf16 v[148:151], v[46:47], v[142:143], v[148:151]
    v_exp_f32 v156, v156
    v_mfma_f32_16x16x32_bf16 v[208:211], a[48:51], a[252:255], v[208:211]
    v_exp_f32 v157, v157
    v_mfma_f32_16x16x32_bf16 v[208:211], a[60:63], v[252:255], v[208:211]
    v_exp_f32 v158, v158
    v_mfma_f32_16x16x32_bf16 v[204:207], a[52:55], a[252:255], v[204:207]
    v_exp_f32 v159, v159
    v_mfma_f32_16x16x32_bf16 v[204:207], a[64:67], v[252:255], v[204:207]
    s_waitcnt lgkmcnt(2)
    v_cvt_pk_bf16_f32 v182, v156, v157
    v_cvt_pk_bf16_f32 v183, v158, v159
    v_mfma_f32_16x16x32_bf16 v[152:155], v[48:51], v[138:141], v[152:155]
    ds_read_b128 v[156:159], v234
    v_cvt_pk_bf16_f32 v60, v208, v209
    v_mfma_f32_16x16x32_bf16 v[196:199], a[216:219], v[180:183], v[196:199]
    v_cvt_pk_bf16_f32 v61, v210, v211
    v_bfe_u32 v234, s70, v233, 4
    v_mfma_f32_16x16x32_bf16 v[184:187], v[78:81], v[180:183], v[184:187]
    v_cvt_pk_bf16_f32 v62, v204, v205
    v_cvt_pk_bf16_f32 v63, v206, v207
    v_mfma_f32_16x16x32_bf16 v[188:191], v[100:103], v[180:183], v[188:191]
    v_mad_u32_u24 v234, v234, s40, v231
    v_fma_f32 v161, v161, s37, -v236
    v_mfma_f32_16x16x32_bf16 v[192:195], v[122:125], v[180:183], v[192:195]
    v_fma_f32 v162, v162, s37, -v236
    v_fma_f32 v163, v163, s37, -v236
    v_mfma_f32_16x16x16_bf16 v[152:155], v[52:53], v[142:143], v[152:155]
    v_exp_f32 v160, v160
    v_mfma_f32_16x16x32_bf16 v[200:203], a[56:59], a[252:255], v[200:203]
    v_exp_f32 v161, v161
    v_mfma_f32_16x16x32_bf16 v[200:203], a[68:71], v[252:255], v[200:203]
    v_exp_f32 v162, v162
    v_mfma_f32_16x16x32_bf16 v[220:223], a[252:255], a[120:123], v[220:223]
    v_exp_f32 v163, v163
    v_mfma_f32_16x16x32_bf16 v[220:223], v[252:255], a[132:135], v[220:223]
    s_waitcnt lgkmcnt(0)
    v_cvt_pk_bf16_f32 v176, v160, v161
    v_cvt_pk_bf16_f32 v177, v162, v163
    v_mfma_f32_16x16x32_bf16 v[156:159], v[54:57], v[138:141], v[156:159]
    ds_read_b128 v[160:163], v235
    v_cvt_pk_bf16_f32 v64, v200, v201
    v_mfma_f32_16x16x32_bf16 v[216:219], a[252:255], a[124:127], v[216:219]
    v_cvt_pk_bf16_f32 v65, v202, v203
    v_bfe_u32 v235, s71, v233, 4
    v_mfma_f32_16x16x32_bf16 v[216:219], v[252:255], a[136:139], v[216:219]
    v_cvt_pk_bf16_f32 v86, v220, v221
    v_cvt_pk_bf16_f32 v87, v222, v223
    v_mfma_f32_16x16x16_bf16 v[156:159], v[58:59], v[142:143], v[156:159]
    v_mad_u32_u24 v235, v235, s40, v231
    v_fma_f32 v164, v164, s37, -v236
    v_mfma_f32_16x16x32_bf16 v[212:215], a[252:255], a[128:131], v[212:215]
    ds_read_b128 a[252:255], v241 offset:12288
    v_fma_f32 v165, v165, s37, -v236
    v_mfma_f32_16x16x32_bf16 v[212:215], v[252:255], a[140:143], v[212:215]
    v_cvt_pk_bf16_f32 v108, v216, v217
    v_cvt_pk_bf16_f32 v109, v218, v219
    v_mfma_f32_16x16x32_bf16 v[208:211], a[220:223], a[236:239], 0
    ds_read_b128 v[252:255], v241 offset:12800
    v_fma_f32 v166, v166, s37, -v236
    v_mfma_f32_16x16x32_bf16 v[200:203], a[220:223], a[240:243], 0
    v_fma_f32 v167, v167, s37, -v236
    v_max3_f32 v248, v168, v169, v170
    v_mfma_f32_16x16x32_bf16 v[204:207], a[224:227], a[236:239], 0
    s_waitcnt lgkmcnt(2)
    v_cvt_pk_bf16_f32 v130, v212, v213
    v_cvt_pk_bf16_f32 v131, v214, v215
    v_mfma_f32_16x16x32_bf16 v[160:163], v[60:63], v[138:141], v[160:163]
    v_exp_f32 v164, v164
    v_mfma_f32_16x16x32_bf16 v[220:223], a[224:227], a[240:243], 0
    ds_read_b128 a[240:243], v242 offset:12800
    v_max3_f32 v249, v171, v172, v173
    v_mfma_f32_16x16x32_bf16 v[216:219], a[228:231], a[236:239], 0
    v_exp_f32 v165, v165
    v_mfma_f32_16x16x16_bf16 v[160:163], v[64:65], v[142:143], v[160:163]
    v_exp_f32 v166, v166
    v_mfma_f32_16x16x32_bf16 v[212:215], a[232:235], a[236:239], 0
    s_waitcnt lgkmcnt(2)
    ds_read_b128 a[236:239], v242 offset:12288
    v_cvt_pk_bf16_f32 v178, v164, v165
    v_mfma_f32_16x16x32_bf16 v[208:211], a[252:255], a[244:247], v[208:211]
    v_exp_f32 v167, v167
    v_mfma_f32_16x16x32_bf16 v[200:203], a[252:255], a[248:251], v[200:203]
    s_waitcnt lgkmcnt(2)
    ds_read_b128 a[252:255], v241 offset:24576
    v_cvt_pk_bf16_f32 v179, v166, v167
    v_mfma_f32_16x16x32_bf16 v[204:207], v[252:255], a[244:247], v[204:207]
    ds_read_b128 v[164:167], v228 offset:640
    v_max3_f32 v248, v248, v174, v175
    v_mfma_f32_16x16x32_bf16 v[196:199], a[216:219], v[176:179], v[196:199]
    v_max3_f32 v249, v249, v144, v145
    v_max3_f32 v248, v248, v146, v147
    v_mfma_f32_16x16x32_bf16 v[184:187], v[66:69], v[176:179], v[184:187]
    v_max3_f32 v249, v249, v148, v149
    v_max3_f32 v248, v248, v150, v151
    v_mfma_f32_16x16x32_bf16 v[188:191], v[88:91], v[176:179], v[188:191]
    v_max3_f32 v249, v249, v152, v153
    v_max3_f32 v248, v248, v154, v155
    v_mfma_f32_16x16x32_bf16 v[192:195], v[110:113], v[176:179], v[192:195]
    v_rcp_f32 v197, v196
    v_mfma_f32_16x16x32_bf16 v[220:223], v[252:255], a[248:251], v[220:223]
    s_waitcnt lgkmcnt(2)
    ds_read_b128 a[248:251], v240 offset:2048
    ds_read_b128 v[252:255], v241 offset:25088
    v_mfma_f32_16x16x32_bf16 v[216:219], a[236:239], a[244:247], v[216:219]
    ds_read_b128 a[236:239], v242 offset:24576
    v_mul_f32 v184, v184, v197
    v_mfma_f32_16x16x32_bf16 v[212:215], a[240:243], a[244:247], v[212:215]
    s_waitcnt lgkmcnt(3)
    ds_read_b128 a[244:247], v239 offset:2048
    v_mul_f32 v185, v185, v197
    v_cvt_pk_bf16_f32 v184, v184, v185
    v_mul_f32 v186, v186, v197
    ds_read_b128 a[240:243], v242 offset:25088
    v_mfma_f32_16x16x32_bf16 v[164:167], v[12:15], v[132:135], v[164:167]
    v_mul_f32 v187, v187, v197
    v_cvt_pk_bf16_f32 v185, v186, v187
    v_mul_f32 v188, v188, v197
    v_mul_f32 v189, v189, v197
    v_cvt_pk_bf16_f32 v186, v188, v189
    v_mul_f32 v190, v190, v197
    v_mfma_f32_16x16x16_bf16 v[164:167], v[16:17], v[136:137], v[164:167]
    s_waitcnt lgkmcnt(4)
    v_mul_f32 v191, v191, v197
    v_cvt_pk_bf16_f32 v187, v190, v191
    v_mul_f32 v192, v192, v197
    v_mul_f32 v193, v193, v197
    v_cvt_pk_bf16_f32 v188, v192, v193
    v_mul_f32 v194, v194, v197
    v_mul_f32 v195, v195, v197
    v_mfma_f32_16x16x32_bf16 v[200:203], a[252:255], a[248:251], v[200:203]
    s_waitcnt lgkmcnt(3)
    v_cvt_pk_bf16_f32 v189, v194, v195
    v_max3_f32 v249, v249, v156, v157
    v_mfma_f32_16x16x32_bf16 v[220:223], v[252:255], a[248:251], v[220:223]
    s_waitcnt lgkmcnt(1)
    ds_read_b128 a[248:251], v240 offset:3072
    ds_write_b128 v237, v[184:187] offset:12288
    v_mfma_f32_16x16x32_bf16 v[208:211], a[252:255], a[244:247], v[208:211]
    ds_write_b64 v238, v[188:189] offset:12288
    v_mfma_f32_16x16x32_bf16 v[204:207], v[252:255], a[244:247], v[204:207]
    v_max3_f32 v248, v248, v158, v159
    v_max3_f32 v249, v249, v160, v161
    v_mfma_f32_16x16x32_bf16 v[216:219], a[236:239], a[244:247], v[216:219]
    s_waitcnt lgkmcnt(3)
    v_max3_f32 v248, v248, v162, v163
    v_max_f32 v248, v248, v249
    v_mfma_f32_16x16x32_bf16 v[212:215], a[240:243], a[244:247], v[212:215]
    v_mov_b32 v249, v248
    s_nop 1
    ds_read_b128 a[244:247], v239 offset:3072
    ds_read_b128 a[252:255], v241 offset:36864
    v_permlane16_swap_b32 v248, v249
    ds_read_b128 v[252:255], v241 offset:37376
    v_max_f32 v248, v248, v249
    ds_read_b128 a[236:239], v242 offset:36864
    v_mov_b32 v249, v248
    ds_read_b128 a[240:243], v242 offset:37376
    s_nop 0
    v_permlane32_swap_b32 v248, v249
    v_max_f32 v248, v248, v249
    v_mul_f32 v236, s37, v248
    v_fma_f32 v168, v168, s37, -v236
    v_fma_f32 v169, v169, s37, -v236
    v_fma_f32 v170, v170, s37, -v236
    v_fma_f32 v171, v171, s37, -v236
    v_exp_f32 v168, v168
    v_exp_f32 v169, v169
    v_exp_f32 v170, v170
    v_exp_f32 v171, v171
    v_cvt_pk_bf16_f32 v180, v168, v169
    v_cvt_pk_bf16_f32 v181, v170, v171
    ds_read_b128 v[168:171], v229 offset:640
    s_waitcnt lgkmcnt(4)
    v_mfma_f32_16x16x32_bf16 v[208:211], a[252:255], a[244:247], v[208:211]
    v_fma_f32 v172, v172, s37, -v236
    v_fma_f32 v173, v173, s37, -v236
    v_mfma_f32_16x16x32_bf16 v[200:203], a[252:255], a[248:251], v[200:203]
    s_waitcnt lgkmcnt(3)
    ds_read_b128 a[252:255], v241 offset:49152
    v_fma_f32 v174, v174, s37, -v236
    v_mfma_f32_16x16x32_bf16 v[204:207], v[252:255], a[244:247], v[204:207]
    v_fma_f32 v175, v175, s37, -v236
    v_fma_f32 v144, v144, s37, -v236
    v_mfma_f32_16x16x32_bf16 v[220:223], v[252:255], a[248:251], v[220:223]
    s_waitcnt lgkmcnt(3)
    ds_read_b128 a[248:251], v240 offset:4096
    ds_read_b128 v[252:255], v241 offset:49664
    v_mfma_f32_16x16x32_bf16 v[216:219], a[236:239], a[244:247], v[216:219]
    s_waitcnt lgkmcnt(4)
    ds_read_b128 a[236:239], v242 offset:49152
    v_fma_f32 v145, v145, s37, -v236
    v_mfma_f32_16x16x32_bf16 v[212:215], a[240:243], a[244:247], v[212:215]
    s_waitcnt lgkmcnt(4)
    ds_read_b128 a[244:247], v239 offset:4096
    v_exp_f32 v172, v172
    v_exp_f32 v173, v173
    ds_read_b128 a[240:243], v242 offset:49664
    v_exp_f32 v174, v174
    v_exp_f32 v175, v175
    v_mfma_f32_16x16x32_bf16 v[168:171], v[36:39], v[132:135], v[168:171]
    v_cvt_pk_bf16_f32 v182, v172, v173
    v_cvt_pk_bf16_f32 v183, v174, v175
    ds_read_b128 v[172:175], v229 offset:1280
    v_fma_f32 v146, v146, s37, -v236
    v_mfma_f32_16x16x32_bf16 v[196:199], a[216:219], v[180:183], 0
    v_fma_f32 v147, v147, s37, -v236
    v_fma_f32 v148, v148, s37, -v236
    v_mfma_f32_16x16x32_bf16 v[184:187], v[68:71], v[180:183], 0
    v_exp_f32 v144, v144
    v_mfma_f32_16x16x32_bf16 v[188:191], v[90:93], v[180:183], 0
    v_exp_f32 v145, v145
    v_mfma_f32_16x16x32_bf16 v[192:195], v[112:115], v[180:183], 0
    v_exp_f32 v146, v146
    v_mfma_f32_16x16x16_bf16 v[168:171], v[40:41], v[136:137], v[168:171]
    s_waitcnt lgkmcnt(2)
    v_exp_f32 v147, v147
    v_mfma_f32_16x16x32_bf16 v[208:211], a[252:255], a[244:247], v[208:211]
    v_cvt_pk_bf16_f32 v176, v144, v145
    v_cvt_pk_bf16_f32 v177, v146, v147
    v_mfma_f32_16x16x32_bf16 v[200:203], a[252:255], a[248:251], v[200:203]
    ds_read_b128 a[252:255], v241 offset:61440
    ds_read_b128 v[144:147], v228 offset:1280
    v_mfma_f32_16x16x32_bf16 v[204:207], v[252:255], a[244:247], v[204:207]
    s_waitcnt lgkmcnt(2)
    v_fma_f32 v149, v149, s37, -v236
    v_fma_f32 v150, v150, s37, -v236
    v_mfma_f32_16x16x32_bf16 v[172:175], v[42:45], v[132:135], v[172:175]
    v_fma_f32 v151, v151, s37, -v236
    v_fma_f32 v152, v152, s37, -v236
    v_mfma_f32_16x16x32_bf16 v[220:223], v[252:255], a[248:251], v[220:223]
    ds_read_b128 a[248:251], v240 offset:5120
    ds_read_b128 v[252:255], v241 offset:61952
    v_mfma_f32_16x16x32_bf16 v[216:219], a[236:239], a[244:247], v[216:219]
    ds_read_b128 a[236:239], v242 offset:61440
    v_fma_f32 v153, v153, s37, -v236
    v_mfma_f32_16x16x16_bf16 v[172:175], v[46:47], v[136:137], v[172:175]
    v_exp_f32 v148, v148
    v_mfma_f32_16x16x32_bf16 v[212:215], a[240:243], a[244:247], v[212:215]
    ds_read_b128 a[244:247], v239 offset:5120
    ds_read_b128 a[240:243], v242 offset:61952
    v_exp_f32 v149, v149
    v_exp_f32 v150, v150
    v_exp_f32 v151, v151
    v_cvt_pk_bf16_f32 v178, v148, v149
    v_cvt_pk_bf16_f32 v179, v150, v151
    ds_read_b128 v[148:151], v228 offset:1920
    v_fma_f32 v154, v154, s37, -v236
    v_mfma_f32_16x16x32_bf16 v[196:199], a[216:219], v[176:179], v[196:199]
    v_fma_f32 v155, v155, s37, -v236
    v_fma_f32 v156, v156, s37, -v236
    v_mfma_f32_16x16x32_bf16 v[184:187], v[76:79], v[176:179], v[184:187]
    v_exp_f32 v152, v152
    v_mfma_f32_16x16x32_bf16 v[188:191], v[98:101], v[176:179], v[188:191]
    v_exp_f32 v153, v153
    v_mfma_f32_16x16x32_bf16 v[192:195], v[120:123], v[176:179], v[192:195]
    s_waitcnt lgkmcnt(5)
    v_exp_f32 v154, v154
    v_mfma_f32_16x16x32_bf16 v[144:147], v[18:21], v[132:135], v[144:147]
    s_waitcnt lgkmcnt(2)
    v_exp_f32 v155, v155
    v_mfma_f32_16x16x32_bf16 v[208:211], a[252:255], a[244:247], v[208:211]
    v_cvt_pk_bf16_f32 v180, v152, v153
    v_cvt_pk_bf16_f32 v181, v154, v155
    v_mfma_f32_16x16x32_bf16 v[200:203], a[252:255], a[248:251], v[200:203]
    ds_read_b128 a[252:255], v224 offset:15616
    ds_read_b128 v[152:155], v229 offset:1920
    v_mfma_f32_16x16x16_bf16 v[144:147], v[22:23], v[136:137], v[144:147]
    s_waitcnt lgkmcnt(2)
    v_fma_f32 v157, v157, s37, -v236
    v_fma_f32 v158, v158, s37, -v236
    v_mfma_f32_16x16x32_bf16 v[148:151], v[0:3], v[132:135], v[148:151]
    v_cvt_pk_bf16_f32 v208, v208, v209
    v_cvt_pk_bf16_f32 v209, v210, v211
    v_mfma_f32_16x16x32_bf16 v[204:207], v[252:255], a[244:247], v[204:207]
    v_cvt_pk_bf16_f32 v200, v200, v201
    v_cvt_pk_bf16_f32 v201, v202, v203
    v_mfma_f32_16x16x32_bf16 v[220:223], v[252:255], a[248:251], v[220:223]
    ds_read_b128 a[248:251], v224 offset:15552
    ds_read_b128 v[252:255], v224 offset:15680
    v_mfma_f32_16x16x16_bf16 v[148:151], v[4:5], v[136:137], v[148:151]
    v_fma_f32 v159, v159, s37, -v236
    v_fma_f32 v160, v160, s37, -v236
    v_mfma_f32_16x16x32_bf16 v[216:219], a[236:239], a[244:247], v[216:219]
    ds_read_b128 a[236:239], v224 offset:15744
    v_cvt_pk_bf16_f32 v210, v204, v205
    v_mfma_f32_16x16x32_bf16 v[212:215], a[240:243], a[244:247], v[212:215]
    s_waitcnt lgkmcnt(3)
    ds_read_b128 a[244:247], v224 offset:15488
    ds_read_b128 a[240:243], v224 offset:15808
    v_cvt_pk_bf16_f32 v211, v206, v207
    buffer_store_dwordx4 v[208:211], v243, s[20:23], s58 offen sc0 sc1
    v_mfma_f32_16x16x32_bf16 v[152:155], v[24:27], v[132:135], v[152:155]
    v_cvt_pk_bf16_f32 v202, v220, v221
    v_cvt_pk_bf16_f32 v203, v222, v223
    v_cvt_pk_bf16_f32 v216, v216, v217
    v_cvt_pk_bf16_f32 v217, v218, v219
    v_cvt_pk_bf16_f32 v218, v212, v213
    v_cvt_pk_bf16_f32 v219, v214, v215
    v_mfma_f32_16x16x16_bf16 v[152:155], v[28:29], v[136:137], v[152:155]
    s_waitcnt lgkmcnt(1)
    v_exp_f32 v156, v156
    v_exp_f32 v157, v157
    v_exp_f32 v158, v158
    v_exp_f32 v159, v159
    v_cvt_pk_bf16_f32 v182, v156, v157
    v_cvt_pk_bf16_f32 v183, v158, v159
    ds_read_b128 v[156:159], v229 offset:2560
    v_mfma_f32_16x16x32_bf16 v[208:211], a[0:3], a[244:247], 0
    v_fma_f32 v161, v161, s37, -v236
    v_fma_f32 v162, v162, s37, -v236
    v_mfma_f32_16x16x32_bf16 v[208:211], a[12:15], a[248:251], v[208:211]
    v_fma_f32 v163, v163, s37, -v236
    v_max3_f32 v248, v164, v165, v166
    v_mfma_f32_16x16x32_bf16 v[196:199], a[216:219], v[180:183], v[196:199]
    v_exp_f32 v160, v160
    v_mfma_f32_16x16x32_bf16 v[184:187], v[82:85], v[180:183], v[184:187]
    v_exp_f32 v161, v161
    v_mfma_f32_16x16x32_bf16 v[188:191], v[104:107], v[180:183], v[188:191]
    v_exp_f32 v162, v162
    v_mfma_f32_16x16x32_bf16 v[192:195], v[126:129], v[180:183], v[192:195]
    buffer_store_dwordx4 v[200:203], v245, s[20:23], s58 offen sc0 sc1
    v_mfma_f32_16x16x32_bf16 v[204:207], a[4:7], a[244:247], 0
    v_exp_f32 v163, v163
    v_mfma_f32_16x16x32_bf16 v[204:207], a[16:19], a[248:251], v[204:207]
    v_cvt_pk_bf16_f32 v176, v160, v161
    v_cvt_pk_bf16_f32 v177, v162, v163
    v_mfma_f32_16x16x32_bf16 v[200:203], a[8:11], a[244:247], 0
    ds_read_b128 v[160:163], v228 offset:2560
    v_max3_f32 v249, v167, v168, v169
    v_mfma_f32_16x16x32_bf16 v[200:203], a[20:23], a[248:251], v[200:203]
    v_max3_f32 v248, v248, v170, v171
    v_max3_f32 v249, v249, v172, v173
    v_mfma_f32_16x16x16_bf16 v[196:199], a[216:217], v[176:177], v[196:199]
    v_max3_f32 v248, v248, v174, v175
    v_max3_f32 v249, v249, v144, v145
    v_mfma_f32_16x16x16_bf16 v[184:187], v[86:87], v[176:177], v[184:187]
    v_max3_f32 v248, v248, v146, v147
    v_max3_f32 v249, v249, v148, v149
    v_mfma_f32_16x16x16_bf16 v[188:191], v[108:109], v[176:177], v[188:191]
    v_max3_f32 v248, v248, v150, v151
    v_max3_f32 v249, v249, v152, v153
    v_mfma_f32_16x16x16_bf16 v[192:195], v[130:131], v[176:177], v[192:195]
    v_rcp_f32 v197, v196
    v_mfma_f32_16x16x32_bf16 v[220:223], a[244:247], a[72:75], 0
    v_mul_f32 v184, v184, v197
    v_mul_f32 v185, v185, v197
    v_mfma_f32_16x16x32_bf16 v[220:223], a[248:251], a[84:87], v[220:223]
    v_cvt_pk_bf16_f32 v184, v184, v185
    v_mul_f32 v186, v186, v197
    v_mfma_f32_16x16x32_bf16 v[212:215], a[244:247], a[80:83], 0
    v_mul_f32 v187, v187, v197
    v_cvt_pk_bf16_f32 v185, v186, v187
    v_mfma_f32_16x16x32_bf16 v[212:215], a[248:251], a[92:95], v[212:215]
    buffer_store_dwordx4 v[216:219], v244, s[20:23], s58 offen sc0 sc1
    v_mfma_f32_16x16x32_bf16 v[208:211], a[24:27], a[252:255], v[208:211]
    s_add_u32 s58, s51, 0x54000
    v_mul_f32 v188, v188, v197
    v_mul_f32 v189, v189, v197
    v_mfma_f32_16x16x32_bf16 v[208:211], a[36:39], v[252:255], v[208:211]
    v_cvt_pk_bf16_f32 v186, v188, v189
    v_mul_f32 v190, v190, v197
    v_mfma_f32_16x16x32_bf16 v[216:219], a[244:247], a[76:79], 0
    ds_read_b128 a[244:247], v224 offset:18560
    v_mul_f32 v191, v191, v197
    v_mfma_f32_16x16x32_bf16 v[216:219], a[248:251], a[88:91], v[216:219]
    ds_read_b128 a[248:251], v224 offset:18624
    v_cvt_pk_bf16_f32 v187, v190, v191
    v_mfma_f32_16x16x32_bf16 v[204:207], a[28:31], a[252:255], v[204:207]
    v_mul_f32 v192, v192, v197
    v_mul_f32 v193, v193, v197
    v_mfma_f32_16x16x32_bf16 v[204:207], a[40:43], v[252:255], v[204:207]
    v_cvt_pk_bf16_f32 v188, v192, v193
    v_mul_f32 v194, v194, v197
    v_mfma_f32_16x16x32_bf16 v[200:203], a[32:35], a[252:255], v[200:203]
    v_mul_f32 v195, v195, v197
    v_cvt_pk_bf16_f32 v189, v194, v195
    v_mfma_f32_16x16x32_bf16 v[200:203], a[44:47], v[252:255], v[200:203]
    ds_write_b128 v237, v[184:187] offset:18432
    v_mfma_f32_16x16x32_bf16 v[220:223], a[252:255], a[96:99], v[220:223]
    ds_write_b64 v238, v[188:189] offset:18432
    v_mfma_f32_16x16x32_bf16 v[220:223], v[252:255], a[108:111], v[220:223]
    v_max3_f32 v248, v248, v154, v155
    v_mfma_f32_16x16x32_bf16 v[216:219], a[252:255], a[100:103], v[216:219]
    v_mfma_f32_16x16x32_bf16 v[216:219], v[252:255], a[112:115], v[216:219]
    v_mfma_f32_16x16x32_bf16 v[212:215], a[252:255], a[104:107], v[212:215]
    ds_read_b128 a[252:255], v224 offset:18688
    v_mfma_f32_16x16x32_bf16 v[212:215], v[252:255], a[116:119], v[212:215]
    ds_read_b128 v[252:255], v224 offset:18752
    v_mfma_f32_16x16x32_bf16 v[208:211], a[48:51], a[236:239], v[208:211]
    s_waitcnt lgkmcnt(4)
    v_mfma_f32_16x16x32_bf16 v[208:211], a[60:63], a[240:243], v[208:211]
    v_mfma_f32_16x16x32_bf16 v[204:207], a[52:55], a[236:239], v[204:207]
    v_mfma_f32_16x16x32_bf16 v[204:207], a[64:67], a[240:243], v[204:207]
    v_mfma_f32_16x16x32_bf16 v[200:203], a[56:59], a[236:239], v[200:203]
    v_mfma_f32_16x16x32_bf16 v[200:203], a[68:71], a[240:243], v[200:203]
    v_mfma_f32_16x16x32_bf16 v[220:223], a[236:239], a[120:123], v[220:223]
    v_mfma_f32_16x16x32_bf16 v[220:223], a[240:243], a[132:135], v[220:223]
    v_mfma_f32_16x16x32_bf16 v[216:219], a[236:239], a[124:127], v[216:219]
    v_mfma_f32_16x16x32_bf16 v[216:219], a[240:243], a[136:139], v[216:219]
    v_cvt_pk_bf16_f32 v6, v208, v209
    v_cvt_pk_bf16_f32 v7, v210, v211
    v_mfma_f32_16x16x32_bf16 v[212:215], a[236:239], a[128:131], v[212:215]
    v_cvt_pk_bf16_f32 v8, v204, v205
    v_cvt_pk_bf16_f32 v9, v206, v207
    v_mfma_f32_16x16x32_bf16 v[212:215], a[240:243], a[140:143], v[212:215]
    v_cvt_pk_bf16_f32 v10, v200, v201
    v_cvt_pk_bf16_f32 v11, v202, v203
    v_mfma_f32_16x16x32_bf16 v[160:163], v[6:9], v[132:135], v[160:163]
    v_cvt_pk_bf16_f32 v72, v220, v221
    v_cvt_pk_bf16_f32 v73, v222, v223
    v_mfma_f32_16x16x32_bf16 v[208:211], a[0:3], a[244:247], 0
    v_cvt_pk_bf16_f32 v94, v216, v217
    v_cvt_pk_bf16_f32 v95, v218, v219
    v_mfma_f32_16x16x32_bf16 v[208:211], a[12:15], a[248:251], v[208:211]
    v_cvt_pk_bf16_f32 v116, v212, v213
    v_cvt_pk_bf16_f32 v117, v214, v215
    v_mfma_f32_16x16x16_bf16 v[160:163], v[10:11], v[136:137], v[160:163]
    ds_read_b128 a[236:239], v224 offset:18816
    ds_read_b128 a[240:243], v224 offset:18880
    v_mfma_f32_16x16x32_bf16 v[204:207], a[4:7], a[244:247], 0
    v_mfma_f32_16x16x32_bf16 v[204:207], a[16:19], a[248:251], v[204:207]
    v_mfma_f32_16x16x32_bf16 v[200:203], a[8:11], a[244:247], 0
    v_mfma_f32_16x16x32_bf16 v[200:203], a[20:23], a[248:251], v[200:203]
    v_mfma_f32_16x16x32_bf16 v[220:223], a[244:247], a[72:75], 0
    v_mfma_f32_16x16x32_bf16 v[220:223], a[248:251], a[84:87], v[220:223]
    v_mfma_f32_16x16x32_bf16 v[216:219], a[244:247], a[76:79], 0
    v_mfma_f32_16x16x32_bf16 v[216:219], a[248:251], a[88:91], v[216:219]
    v_mfma_f32_16x16x32_bf16 v[212:215], a[244:247], a[80:83], 0
    ds_read_b128 a[244:247], v226 offset:4224
    v_mfma_f32_16x16x32_bf16 v[212:215], a[248:251], a[92:95], v[212:215]
    s_waitcnt lgkmcnt(2)
    ds_read_b128 a[248:251], v226 offset:4288
    v_mfma_f32_16x16x32_bf16 v[208:211], a[24:27], a[252:255], v[208:211]
    v_mfma_f32_16x16x32_bf16 v[208:211], a[36:39], v[252:255], v[208:211]
    v_mfma_f32_16x16x32_bf16 v[204:207], a[28:31], a[252:255], v[204:207]
    v_mfma_f32_16x16x32_bf16 v[204:207], a[40:43], v[252:255], v[204:207]
    v_mfma_f32_16x16x32_bf16 v[200:203], a[32:35], a[252:255], v[200:203]
    v_mfma_f32_16x16x32_bf16 v[200:203], a[44:47], v[252:255], v[200:203]
    v_mfma_f32_16x16x32_bf16 v[220:223], a[252:255], a[96:99], v[220:223]
    v_mfma_f32_16x16x32_bf16 v[220:223], v[252:255], a[108:111], v[220:223]
    v_mfma_f32_16x16x32_bf16 v[216:219], a[252:255], a[100:103], v[216:219]
    v_mfma_f32_16x16x32_bf16 v[216:219], v[252:255], a[112:115], v[216:219]
    v_mfma_f32_16x16x32_bf16 v[212:215], a[252:255], a[104:107], v[212:215]
    ds_read_b128 a[252:255], v226 offset:4352
    v_mfma_f32_16x16x32_bf16 v[212:215], v[252:255], a[116:119], v[212:215]
    ds_read_b128 v[252:255], v226 offset:4416
    v_mfma_f32_16x16x32_bf16 v[208:211], a[48:51], a[236:239], v[208:211]
    s_waitcnt lgkmcnt(2)
    v_mfma_f32_16x16x32_bf16 v[208:211], a[60:63], a[240:243], v[208:211]
    v_mfma_f32_16x16x32_bf16 v[204:207], a[52:55], a[236:239], v[204:207]
    v_mfma_f32_16x16x32_bf16 v[204:207], a[64:67], a[240:243], v[204:207]
    v_mfma_f32_16x16x32_bf16 v[200:203], a[56:59], a[236:239], v[200:203]
    v_mfma_f32_16x16x32_bf16 v[200:203], a[68:71], a[240:243], v[200:203]
    v_mfma_f32_16x16x32_bf16 v[220:223], a[236:239], a[120:123], v[220:223]
    v_mfma_f32_16x16x32_bf16 v[220:223], a[240:243], a[132:135], v[220:223]
    v_mfma_f32_16x16x32_bf16 v[216:219], a[236:239], a[124:127], v[216:219]
    v_mfma_f32_16x16x32_bf16 v[216:219], a[240:243], a[136:139], v[216:219]
    v_cvt_pk_bf16_f32 v30, v208, v209
    v_cvt_pk_bf16_f32 v31, v210, v211
    v_mfma_f32_16x16x32_bf16 v[212:215], a[236:239], a[128:131], v[212:215]
    v_cvt_pk_bf16_f32 v32, v204, v205
    v_cvt_pk_bf16_f32 v33, v206, v207
    v_mfma_f32_16x16x32_bf16 v[212:215], a[240:243], a[140:143], v[212:215]
    v_cvt_pk_bf16_f32 v34, v200, v201
    v_cvt_pk_bf16_f32 v35, v202, v203
    v_mfma_f32_16x16x32_bf16 v[156:159], v[30:33], v[132:135], v[156:159]
    v_cvt_pk_bf16_f32 v70, v220, v221
    v_cvt_pk_bf16_f32 v71, v222, v223
    v_mfma_f32_16x16x32_bf16 v[208:211], a[144:147], a[244:247], 0
    v_cvt_pk_bf16_f32 v92, v216, v217
    v_cvt_pk_bf16_f32 v93, v218, v219
    v_mfma_f32_16x16x32_bf16 v[208:211], a[156:159], a[248:251], v[208:211]
    v_cvt_pk_bf16_f32 v114, v212, v213
    v_cvt_pk_bf16_f32 v115, v214, v215
    v_mfma_f32_16x16x16_bf16 v[156:159], v[34:35], v[136:137], v[156:159]
    ds_read_b128 a[236:239], v226 offset:4480
    ds_read_b128 a[240:243], v226 offset:4544
    v_mfma_f32_16x16x32_bf16 v[204:207], a[148:151], a[244:247], 0
    v_mfma_f32_16x16x32_bf16 v[204:207], a[160:163], a[248:251], v[204:207]
    v_mfma_f32_16x16x32_bf16 v[200:203], a[152:155], a[244:247], 0
    ds_read_b128 a[244:247], v225 offset:8896
    v_mfma_f32_16x16x32_bf16 v[200:203], a[164:167], a[248:251], v[200:203]
    s_waitcnt lgkmcnt(3)
    ds_read_b128 a[248:251], v225 offset:8960
    v_max3_f32 v249, v249, v156, v157
    v_mfma_f32_16x16x32_bf16 v[208:211], a[168:171], a[252:255], v[208:211]
    v_max3_f32 v248, v248, v158, v159
    v_max3_f32 v249, v249, v160, v161
    v_mfma_f32_16x16x32_bf16 v[208:211], a[180:183], v[252:255], v[208:211]
    v_max3_f32 v248, v248, v162, v163
    v_max_f32 v248, v248, v249
    v_mfma_f32_16x16x32_bf16 v[204:207], a[172:175], a[252:255], v[204:207]
    v_mov_b32 v249, v248
    v_mfma_f32_16x16x32_bf16 v[204:207], a[184:187], v[252:255], v[204:207]
    v_mfma_f32_16x16x32_bf16 v[200:203], a[176:179], a[252:255], v[200:203]
    s_waitcnt vmcnt(3) lgkmcnt(2)
    ds_read_b128 a[252:255], v225 offset:9024
    s_barrier
    v_mfma_f32_16x16x32_bf16 v[200:203], a[188:191], v[252:255], v[200:203]
    ds_read_b128 v[252:255], v225 offset:9088
    v_mfma_f32_16x16x32_bf16 v[208:211], a[192:195], a[236:239], v[208:211]
    buffer_load_dwordx4 v246, s[4:7], s56 offen lds
    v_mfma_f32_16x16x32_bf16 v[208:211], a[204:207], a[240:243], v[208:211]
    s_add_u32 m0, s42, 0xb580
    v_permlane16_swap_b32 v248, v249
    v_mfma_f32_16x16x32_bf16 v[204:207], a[196:199], a[236:239], v[204:207]
    v_max_f32 v248, v248, v249
    v_mov_b32 v249, v248
    v_mfma_f32_16x16x32_bf16 v[204:207], a[208:211], a[240:243], v[204:207]
    v_mfma_f32_16x16x32_bf16 v[200:203], a[200:203], a[236:239], v[200:203]
    ds_read_b128 a[236:239], v225 offset:9152
    v_cvt_pk_bf16_f32 v138, v208, v209
    v_mfma_f32_16x16x32_bf16 v[200:203], a[212:215], a[240:243], v[200:203]
    s_waitcnt lgkmcnt(3)
    ds_read_b128 a[240:243], v225 offset:9216
    v_cvt_pk_bf16_f32 v139, v210, v211
    v_mfma_f32_16x16x32_bf16 v[220:223], a[144:147], a[244:247], 0
    v_permlane32_swap_b32 v248, v249
    v_mfma_f32_16x16x32_bf16 v[220:223], a[156:159], a[248:251], v[220:223]
    v_cvt_pk_bf16_f32 v140, v204, v205
    v_cvt_pk_bf16_f32 v141, v206, v207
    v_mfma_f32_16x16x32_bf16 v[216:219], a[148:151], a[244:247], 0
    v_cvt_pk_bf16_f32 v142, v200, v201
    v_cvt_pk_bf16_f32 v143, v202, v203
    v_mfma_f32_16x16x32_bf16 v[216:219], a[160:163], a[248:251], v[216:219]
    buffer_load_dwordx4 v247, s[4:7], s56 offen lds
    v_mfma_f32_16x16x32_bf16 v[212:215], a[152:155], a[244:247], 0
    s_add_u32 s56, s39, 0x276000
    ds_read_b128 a[244:247], v239 offset:12288
    v_max_f32 v248, v248, v249
    v_mfma_f32_16x16x32_bf16 v[212:215], a[164:167], a[248:251], v[212:215]
    s_add_u32 m0, s41, 0xd3c0
    ds_read_b128 a[248:251], v240 offset:12288
    v_mul_f32 v236, s37, v248
    s_waitcnt lgkmcnt(4)
    v_mfma_f32_16x16x32_bf16 v[220:223], a[168:171], a[252:255], v[220:223]
    v_fma_f32 v164, v164, s37, -v236
    v_fma_f32 v165, v165, s37, -v236
    v_mfma_f32_16x16x32_bf16 v[220:223], a[180:183], v[252:255], v[220:223]
    v_fma_f32 v166, v166, s37, -v236
    v_fma_f32 v167, v167, s37, -v236
    v_mfma_f32_16x16x32_bf16 v[216:219], a[172:175], a[252:255], v[216:219]
    v_exp_f32 v164, v164
    v_mfma_f32_16x16x32_bf16 v[216:219], a[184:187], v[252:255], v[216:219]
    v_exp_f32 v165, v165
    v_mfma_f32_16x16x32_bf16 v[212:215], a[176:179], a[252:255], v[212:215]
    ds_read_b128 a[252:255], v239 offset:13312
    v_cvt_pk_bf16_f32 v180, v164, v165
    v_mfma_f32_16x16x32_bf16 v[212:215], a[188:191], v[252:255], v[212:215]
    s_waitcnt lgkmcnt(3)
    buffer_load_dwordx4 v246, s[4:7], s56 offen lds
    v_mfma_f32_16x16x32_bf16 v[220:223], a[192:195], a[236:239], v[220:223]
    s_add_u32 m0, s42, 0xd3c0
    ds_read_b128 v[252:255], v240 offset:13312
    v_fma_f32 v168, v168, s37, -v236
    v_mfma_f32_16x16x32_bf16 v[220:223], a[204:207], a[240:243], v[220:223]
    v_exp_f32 v166, v166
    v_mfma_f32_16x16x32_bf16 v[216:219], a[196:199], a[236:239], v[216:219]
    v_exp_f32 v167, v167
    v_mfma_f32_16x16x32_bf16 v[216:219], a[208:211], a[240:243], v[216:219]
    v_cvt_pk_bf16_f32 v181, v166, v167
    v_fma_f32 v169, v169, s37, -v236
    v_mfma_f32_16x16x32_bf16 v[212:215], a[200:203], a[236:239], v[212:215]
    ds_read_b128 a[236:239], v241 offset:12288
    v_cvt_pk_bf16_f32 v132, v220, v221
    v_mfma_f32_16x16x32_bf16 v[212:215], a[212:215], a[240:243], v[212:215]
    s_waitcnt lgkmcnt(3)
    ds_read_b128 a[240:243], v241 offset:12800
    v_cvt_pk_bf16_f32 v133, v222, v223
    v_mfma_f32_16x16x32_bf16 v[208:211], a[220:223], a[244:247], 0
    v_cvt_pk_bf16_f32 v134, v216, v217
    v_cvt_pk_bf16_f32 v135, v218, v219
    v_mfma_f32_16x16x32_bf16 v[200:203], a[220:223], a[248:251], 0
    buffer_load_dwordx4 v247, s[4:7], s56 offen lds
    v_mfma_f32_16x16x32_bf16 v[204:207], a[224:227], a[244:247], 0
    s_add_u32 s56, s39, 0x2a0000
    v_cvt_pk_bf16_f32 v136, v212, v213
    v_cvt_pk_bf16_f32 v137, v214, v215
    v_mfma_f32_16x16x32_bf16 v[220:223], a[224:227], a[248:251], 0
    s_add_u32 m0, s41, 0
    ds_read_b128 a[248:251], v242 offset:12800
    ds_read_b128 v[164:167], v230 offset:640
    v_mfma_f32_16x16x32_bf16 v[216:219], a[228:231], a[244:247], 0
    v_fma_f32 v170, v170, s37, -v236
    v_fma_f32 v171, v171, s37, -v236
    v_mfma_f32_16x16x32_bf16 v[212:215], a[232:235], a[244:247], 0
    s_waitcnt lgkmcnt(3)
    ds_read_b128 a[244:247], v242 offset:12288
    v_exp_f32 v168, v168
    v_exp_f32 v169, v169
    v_mfma_f32_16x16x32_bf16 v[208:211], a[236:239], a[252:255], v[208:211]
    v_exp_f32 v170, v170
    v_mfma_f32_16x16x32_bf16 v[200:203], a[236:239], v[252:255], v[200:203]
    s_waitcnt lgkmcnt(3)
    ds_read_b128 a[236:239], v241 offset:24576
    v_cvt_pk_bf16_f32 v182, v168, v169
    v_mfma_f32_16x16x32_bf16 v[204:207], a[240:243], a[252:255], v[204:207]
    v_exp_f32 v171, v171
    v_mfma_f32_16x16x32_bf16 v[220:223], a[240:243], v[252:255], v[220:223]
    ds_read_b128 v[252:255], v240 offset:14336
    ds_read_b128 a[240:243], v241 offset:25088
    v_cvt_pk_bf16_f32 v183, v170, v171
    v_fma_f32 v172, v172, s37, -v236
    ds_read_b128 v[168:171], v230 offset:1280
    v_mfma_f32_16x16x32_bf16 v[196:199], a[216:219], v[180:183], 0
    v_fma_f32 v173, v173, s37, -v236
    v_fma_f32 v174, v174, s37, -v236
    v_mfma_f32_16x16x32_bf16 v[184:187], v[74:77], v[180:183], 0
    v_fma_f32 v175, v175, s37, -v236
    v_fma_f32 v144, v144, s37, -v236
    v_mfma_f32_16x16x32_bf16 v[188:191], v[96:99], v[180:183], 0
    v_exp_f32 v172, v172
    v_mfma_f32_16x16x32_bf16 v[192:195], v[118:121], v[180:183], 0
    s_waitcnt lgkmcnt(4)
    v_exp_f32 v173, v173
    v_mfma_f32_16x16x32_bf16 v[164:167], v[36:39], v[138:141], v[164:167]
    v_exp_f32 v174, v174
    v_mfma_f32_16x16x32_bf16 v[216:219], a[244:247], a[252:255], v[216:219]
    ds_read_b128 a[244:247], v242 offset:24576
    v_cvt_pk_bf16_f32 v176, v172, v173
    v_mfma_f32_16x16x32_bf16 v[212:215], a[248:251], a[252:255], v[212:215]
    ds_read_b128 a[252:255], v239 offset:14336
    ds_read_b128 a[248:251], v242 offset:25088
    v_mfma_f32_16x16x16_bf16 v[164:167], v[40:41], v[142:143], v[164:167]
    s_waitcnt lgkmcnt(5)
    v_exp_f32 v175, v175
    v_mfma_f32_16x16x32_bf16 v[200:203], a[236:239], v[252:255], v[200:203]
    s_waitcnt lgkmcnt(3)
    v_cvt_pk_bf16_f32 v177, v174, v175
    v_fma_f32 v145, v145, s37, -v236
    v_mfma_f32_16x16x32_bf16 v[168:171], v[42:45], v[138:141], v[168:171]
    ds_read_b128 v[172:175], v230 offset:1920
    v_fma_f32 v146, v146, s37, -v236
    v_mfma_f32_16x16x32_bf16 v[220:223], a[240:243], v[252:255], v[220:223]
    ds_read_b128 v[252:255], v240 offset:15360
    v_fma_f32 v147, v147, s37, -v236
    v_exp_f32 v144, v144
    v_mfma_f32_16x16x16_bf16 v[168:171], v[46:47], v[142:143], v[168:171]
    s_waitcnt lgkmcnt(3)
    v_exp_f32 v145, v145
    v_exp_f32 v146, v146
    v_exp_f32 v147, v147
    v_cvt_pk_bf16_f32 v178, v144, v145
    v_cvt_pk_bf16_f32 v179, v146, v147
    ds_read_b128 v[144:147], v230 offset:2560
    v_mfma_f32_16x16x32_bf16 v[208:211], a[236:239], a[252:255], v[208:211]
    ds_read_b128 a[236:239], v241 offset:36864
    v_fma_f32 v148, v148, s37, -v236
    v_mfma_f32_16x16x32_bf16 v[196:199], a[216:219], v[176:179], v[196:199]
    v_fma_f32 v149, v149, s37, -v236
    v_fma_f32 v150, v150, s37, -v236
    v_mfma_f32_16x16x32_bf16 v[184:187], v[78:81], v[176:179], v[184:187]
    v_fma_f32 v151, v151, s37, -v236
    v_fma_f32 v152, v152, s37, -v236
    v_mfma_f32_16x16x32_bf16 v[188:191], v[100:103], v[176:179], v[188:191]
    v_exp_f32 v148, v148
    v_mfma_f32_16x16x32_bf16 v[192:195], v[122:125], v[176:179], v[192:195]
    s_waitcnt lgkmcnt(3)
    v_exp_f32 v149, v149
    v_mfma_f32_16x16x32_bf16 v[172:175], v[24:27], v[138:141], v[172:175]
    v_exp_f32 v150, v150
    v_mfma_f32_16x16x32_bf16 v[204:207], a[240:243], a[252:255], v[204:207]
    ds_read_b128 a[240:243], v241 offset:37376
    v_cvt_pk_bf16_f32 v180, v148, v149
    v_mfma_f32_16x16x32_bf16 v[216:219], a[244:247], a[252:255], v[216:219]
    ds_read_b128 a[244:247], v242 offset:36864
    v_fma_f32 v153, v153, s37, -v236
    v_mfma_f32_16x16x16_bf16 v[172:175], v[28:29], v[142:143], v[172:175]
    s_waitcnt lgkmcnt(3)
    v_exp_f32 v151, v151
    v_mfma_f32_16x16x32_bf16 v[144:147], v[30:33], v[138:141], v[144:147]
    v_cvt_pk_bf16_f32 v181, v150, v151
    v_fma_f32 v154, v154, s37, -v236
    v_mfma_f32_16x16x32_bf16 v[212:215], a[248:251], a[252:255], v[212:215]
    s_waitcnt lgkmcnt(2)
    ds_read_b128 a[252:255], v239 offset:15360
    ds_read_b128 a[248:251], v242 offset:37376
    v_mfma_f32_16x16x32_bf16 v[200:203], a[236:239], v[252:255], v[200:203]
    ds_read_b128 v[148:151], v250
    v_bfe_u32 v250, s67, v233, 4
    v_mfma_f32_16x16x16_bf16 v[144:147], v[34:35], v[142:143], v[144:147]
    s_waitcnt lgkmcnt(4)
    v_mad_u32_u24 v250, v250, s40, v231
    v_fma_f32 v155, v155, s37, -v236
    v_exp_f32 v152, v152
    v_exp_f32 v153, v153
    v_exp_f32 v154, v154
    v_mfma_f32_16x16x32_bf16 v[220:223], a[240:243], v[252:255], v[220:223]
    ds_read_b128 v[252:255], v240 offset:16384
    v_exp_f32 v155, v155
    v_cvt_pk_bf16_f32 v182, v152, v153
    v_cvt_pk_bf16_f32 v183, v154, v155
    ds_read_b128 v[152:155], v234
    v_bfe_u32 v234, s72, v233, 4
    v_mfma_f32_16x16x32_bf16 v[196:199], a[216:219], v[180:183], v[196:199]
    v_mad_u32_u24 v234, v234, s40, v231
    v_fma_f32 v156, v156, s37, -v236
    v_mfma_f32_16x16x32_bf16 v[184:187], v[66:69], v[180:183], v[184:187]
    v_fma_f32 v157, v157, s37, -v236
    v_fma_f32 v158, v158, s37, -v236
    v_mfma_f32_16x16x32_bf16 v[188:191], v[88:91], v[180:183], v[188:191]
    v_fma_f32 v159, v159, s37, -v236
    v_fma_f32 v160, v160, s37, -v236
    v_mfma_f32_16x16x32_bf16 v[192:195], v[110:113], v[180:183], v[192:195]
    s_waitcnt lgkmcnt(2)
    v_exp_f32 v156, v156
    v_mfma_f32_16x16x32_bf16 v[148:151], v[54:57], v[138:141], v[148:151]
    v_exp_f32 v157, v157
    v_mfma_f32_16x16x32_bf16 v[208:211], a[236:239], a[252:255], v[208:211]
    ds_read_b128 a[236:239], v241 offset:49152
    v_cvt_pk_bf16_f32 v176, v156, v157
    v_mfma_f32_16x16x32_bf16 v[204:207], a[240:243], a[252:255], v[204:207]
    ds_read_b128 a[240:243], v241 offset:49664
    v_fma_f32 v161, v161, s37, -v236
    v_mfma_f32_16x16x16_bf16 v[148:151], v[58:59], v[142:143], v[148:151]
    s_waitcnt lgkmcnt(2)
    v_exp_f32 v158, v158
    v_mfma_f32_16x16x32_bf16 v[152:155], v[60:63], v[138:141], v[152:155]
    v_exp_f32 v159, v159
    v_mfma_f32_16x16x32_bf16 v[216:219], a[244:247], a[252:255], v[216:219]
    ds_read_b128 a[244:247], v242 offset:49152
    v_cvt_pk_bf16_f32 v177, v158, v159
    v_mfma_f32_16x16x32_bf16 v[212:215], a[248:251], a[252:255], v[212:215]
    ds_read_b128 a[252:255], v239 offset:16384
    ds_read_b128 a[248:251], v242 offset:49664
    v_mfma_f32_16x16x16_bf16 v[152:155], v[64:65], v[142:143], v[152:155]
    s_waitcnt lgkmcnt(4)
    ds_read_b128 v[156:159], v229 offset:640
    v_fma_f32 v162, v162, s37, -v236
    v_fma_f32 v163, v163, s37, -v236
    v_exp_f32 v160, v160
    v_exp_f32 v161, v161
    v_exp_f32 v162, v162
    v_mfma_f32_16x16x32_bf16 v[200:203], a[236:239], v[252:255], v[200:203]
    s_waitcnt lgkmcnt(4)
    v_exp_f32 v163, v163
    v_mfma_f32_16x16x32_bf16 v[220:223], a[240:243], v[252:255], v[220:223]
    ds_read_b128 v[252:255], v240 offset:17408
    v_cvt_pk_bf16_f32 v178, v160, v161
    v_cvt_pk_bf16_f32 v179, v162, v163
    ds_read_b128 v[160:163], v228 offset:640
    v_max3_f32 v248, v164, v165, v166
    v_mfma_f32_16x16x32_bf16 v[196:199], a[216:219], v[176:179], v[196:199]
    v_max3_f32 v249, v167, v168, v169
    v_max3_f32 v248, v248, v170, v171
    v_mfma_f32_16x16x32_bf16 v[184:187], v[70:73], v[176:179], v[184:187]
    v_max3_f32 v249, v249, v172, v173
    v_max3_f32 v248, v248, v174, v175
    v_mfma_f32_16x16x32_bf16 v[188:191], v[92:95], v[176:179], v[188:191]
    v_max3_f32 v249, v249, v144, v145
    v_max3_f32 v248, v248, v146, v147
    v_mfma_f32_16x16x32_bf16 v[192:195], v[114:117], v[176:179], v[192:195]
    s_waitcnt lgkmcnt(2)
    v_rcp_f32 v197, v196
    v_mfma_f32_16x16x32_bf16 v[156:159], v[42:45], v[132:135], v[156:159]
    v_mul_f32 v184, v184, v197
    v_mul_f32 v185, v185, v197
    v_mfma_f32_16x16x32_bf16 v[208:211], a[236:239], a[252:255], v[208:211]
    ds_read_b128 a[236:239], v241 offset:61440
    v_cvt_pk_bf16_f32 v184, v184, v185
    v_mfma_f32_16x16x32_bf16 v[204:207], a[240:243], a[252:255], v[204:207]
    ds_read_b128 a[240:243], v241 offset:61952
    v_mul_f32 v186, v186, v197
    v_mfma_f32_16x16x16_bf16 v[156:159], v[46:47], v[136:137], v[156:159]
    s_waitcnt lgkmcnt(2)
    v_mul_f32 v187, v187, v197
    v_cvt_pk_bf16_f32 v185, v186, v187
    v_mfma_f32_16x16x32_bf16 v[160:163], v[18:21], v[132:135], v[160:163]
    v_mul_f32 v188, v188, v197
    v_mul_f32 v189, v189, v197
    v_mfma_f32_16x16x32_bf16 v[216:219], a[244:247], a[252:255], v[216:219]
    ds_read_b128 a[244:247], v242 offset:61440
    v_cvt_pk_bf16_f32 v186, v188, v189
    v_mfma_f32_16x16x32_bf16 v[212:215], a[248:251], a[252:255], v[212:215]
    ds_read_b128 a[252:255], v239 offset:17408
    ds_read_b128 a[248:251], v242 offset:61952
    v_mfma_f32_16x16x16_bf16 v[160:163], v[22:23], v[136:137], v[160:163]
    s_waitcnt lgkmcnt(4)
    v_mul_f32 v190, v190, v197
    v_mul_f32 v191, v191, v197
    v_cvt_pk_bf16_f32 v187, v190, v191
    v_mul_f32 v192, v192, v197
    v_mul_f32 v193, v193, v197
    v_cvt_pk_bf16_f32 v188, v192, v193
    v_mul_f32 v194, v194, v197
    v_mul_f32 v195, v195, v197
    v_mfma_f32_16x16x32_bf16 v[200:203], a[236:239], v[252:255], v[200:203]
    s_waitcnt lgkmcnt(3)
    v_cvt_pk_bf16_f32 v189, v194, v195
    v_max3_f32 v249, v249, v148, v149
    v_mfma_f32_16x16x32_bf16 v[220:223], a[240:243], v[252:255], v[220:223]
    s_waitcnt lgkmcnt(1)
    ds_read_b128 v[252:255], v224 offset:31040
    ds_write_b128 v237, v[184:187]
    ds_write_b64 v238, v[188:189]
    v_max3_f32 v248, v248, v150, v151
    v_max3_f32 v249, v249, v152, v153
    v_cvt_pk_bf16_f32 v200, v200, v201
    v_cvt_pk_bf16_f32 v201, v202, v203
    v_max3_f32 v248, v248, v154, v155
    v_mfma_f32_16x16x32_bf16 v[208:211], a[236:239], a[252:255], v[208:211]
    v_cvt_pk_bf16_f32 v202, v220, v221
    v_cvt_pk_bf16_f32 v203, v222, v223
    v_mfma_f32_16x16x32_bf16 v[204:207], a[240:243], a[252:255], v[204:207]
    buffer_store_dwordx4 v[200:203], v245, s[20:23], s58 offen sc0 sc1
    v_mfma_f32_16x16x32_bf16 v[216:219], a[244:247], a[252:255], v[216:219]
    s_waitcnt lgkmcnt(3)
    ds_read_b128 a[236:239], v224 offset:31104
    ds_read_b128 a[240:243], v224 offset:31168
    v_mfma_f32_16x16x32_bf16 v[212:215], a[248:251], a[252:255], v[212:215]
    ds_read_b128 a[252:255], v224 offset:30976
    v_cvt_pk_bf16_f32 v208, v208, v209
    v_cvt_pk_bf16_f32 v209, v210, v211
    v_cvt_pk_bf16_f32 v210, v204, v205
    ds_read_b128 a[244:247], v224 offset:31232
    v_cvt_pk_bf16_f32 v211, v206, v207
    ds_read_b128 a[248:251], v224 offset:31296
    v_cvt_pk_bf16_f32 v216, v216, v217
    v_cvt_pk_bf16_f32 v217, v218, v219
    v_cvt_pk_bf16_f32 v218, v212, v213
    v_cvt_pk_bf16_f32 v219, v214, v215
    v_max_f32 v248, v248, v249
    v_mov_b32 v249, v248
    s_nop 1
    v_permlane16_swap_b32 v248, v249
    v_max_f32 v248, v248, v249
    v_mov_b32 v249, v248
    s_nop 1
    v_permlane32_swap_b32 v248, v249
    v_max_f32 v248, v248, v249
    v_mul_f32 v236, s37, v248
    v_fma_f32 v164, v164, s37, -v236
    v_fma_f32 v165, v165, s37, -v236
    v_fma_f32 v166, v166, s37, -v236
    v_fma_f32 v167, v167, s37, -v236
    v_exp_f32 v164, v164
    v_exp_f32 v165, v165
    s_waitcnt lgkmcnt(2)
    v_mfma_f32_16x16x32_bf16 v[204:207], a[4:7], a[252:255], 0
    buffer_store_dwordx4 v[208:211], v243, s[20:23], s58 offen sc0 sc1
    v_mfma_f32_16x16x32_bf16 v[204:207], a[16:19], v[252:255], v[204:207]
    v_exp_f32 v166, v166
    v_mfma_f32_16x16x32_bf16 v[208:211], a[0:3], a[252:255], 0
    v_exp_f32 v167, v167
    v_mfma_f32_16x16x32_bf16 v[208:211], a[12:15], v[252:255], v[208:211]
    v_cvt_pk_bf16_f32 v180, v164, v165
    v_cvt_pk_bf16_f32 v181, v166, v167
    v_mfma_f32_16x16x32_bf16 v[200:203], a[8:11], a[252:255], 0
    ds_read_b128 v[164:167], v228 offset:1280
    v_fma_f32 v168, v168, s37, -v236
    v_mfma_f32_16x16x32_bf16 v[200:203], a[20:23], v[252:255], v[200:203]
    v_fma_f32 v169, v169, s37, -v236
    v_fma_f32 v170, v170, s37, -v236
    v_mfma_f32_16x16x32_bf16 v[220:223], a[252:255], a[72:75], 0
    v_fma_f32 v171, v171, s37, -v236
    v_fma_f32 v172, v172, s37, -v236
    v_mfma_f32_16x16x32_bf16 v[220:223], v[252:255], a[84:87], v[220:223]
    v_exp_f32 v168, v168
    v_mfma_f32_16x16x32_bf16 v[212:215], a[252:255], a[80:83], 0
    v_exp_f32 v169, v169
    v_mfma_f32_16x16x32_bf16 v[212:215], v[252:255], a[92:95], v[212:215]
    v_exp_f32 v170, v170
    v_mfma_f32_16x16x32_bf16 v[208:211], a[24:27], a[236:239], v[208:211]
    v_exp_f32 v171, v171
    v_mfma_f32_16x16x32_bf16 v[208:211], a[36:39], a[240:243], v[208:211]
    v_cvt_pk_bf16_f32 v182, v168, v169
    v_cvt_pk_bf16_f32 v183, v170, v171
    v_mfma_f32_16x16x32_bf16 v[204:207], a[28:31], a[236:239], v[204:207]
    buffer_store_dwordx4 v[216:219], v244, s[20:23], s58 offen sc0 sc1
    v_mfma_f32_16x16x32_bf16 v[204:207], a[40:43], a[240:243], v[204:207]
    s_add_u32 s58, s51, 0xa8000
    ds_read_b128 v[168:171], v229 offset:1280
    v_fma_f32 v173, v173, s37, -v236
    v_mfma_f32_16x16x32_bf16 v[196:199], a[216:219], v[180:183], 0
    v_fma_f32 v174, v174, s37, -v236
    v_fma_f32 v175, v175, s37, -v236
    v_mfma_f32_16x16x32_bf16 v[184:187], v[76:79], v[180:183], 0
    v_exp_f32 v172, v172
    v_mfma_f32_16x16x32_bf16 v[188:191], v[98:101], v[180:183], 0
    v_exp_f32 v173, v173
    v_mfma_f32_16x16x32_bf16 v[192:195], v[120:123], v[180:183], 0
    s_waitcnt lgkmcnt(1)
    v_exp_f32 v174, v174
    v_mfma_f32_16x16x32_bf16 v[164:167], v[0:3], v[132:135], v[164:167]
    v_exp_f32 v175, v175
    v_mfma_f32_16x16x32_bf16 v[216:219], a[252:255], a[76:79], 0
    ds_read_b128 a[252:255], v224 offset:34048
    v_cvt_pk_bf16_f32 v176, v172, v173
    v_mfma_f32_16x16x32_bf16 v[216:219], v[252:255], a[88:91], v[216:219]
    ds_read_b128 v[252:255], v224 offset:34112
    v_cvt_pk_bf16_f32 v177, v174, v175
    v_mfma_f32_16x16x16_bf16 v[164:167], v[4:5], v[136:137], v[164:167]
    s_waitcnt lgkmcnt(2)
    ds_read_b128 v[172:175], v229 offset:1920
    v_fma_f32 v144, v144, s37, -v236
    v_mfma_f32_16x16x32_bf16 v[168:171], v[24:27], v[132:135], v[168:171]
    v_fma_f32 v145, v145, s37, -v236
    v_fma_f32 v146, v146, s37, -v236
    v_mfma_f32_16x16x32_bf16 v[200:203], a[32:35], a[236:239], v[200:203]
    v_fma_f32 v147, v147, s37, -v236
    v_fma_f32 v148, v148, s37, -v236
    v_mfma_f32_16x16x32_bf16 v[200:203], a[44:47], a[240:243], v[200:203]
    v_exp_f32 v144, v144
    v_mfma_f32_16x16x16_bf16 v[168:171], v[28:29], v[136:137], v[168:171]
    v_exp_f32 v145, v145
    v_mfma_f32_16x16x32_bf16 v[220:223], a[236:239], a[96:99], v[220:223]
    v_exp_f32 v146, v146
    v_mfma_f32_16x16x32_bf16 v[220:223], a[240:243], a[108:111], v[220:223]
    v_exp_f32 v147, v147
    v_mfma_f32_16x16x32_bf16 v[216:219], a[236:239], a[100:103], v[216:219]
    v_cvt_pk_bf16_f32 v178, v144, v145
    v_cvt_pk_bf16_f32 v179, v146, v147
    v_mfma_f32_16x16x32_bf16 v[216:219], a[240:243], a[112:115], v[216:219]
    ds_read_b128 v[144:147], v228 offset:1920
    v_fma_f32 v149, v149, s37, -v236
    v_mfma_f32_16x16x32_bf16 v[196:199], a[216:219], v[176:179], v[196:199]
    v_fma_f32 v150, v150, s37, -v236
    v_fma_f32 v151, v151, s37, -v236
    v_mfma_f32_16x16x32_bf16 v[184:187], v[68:71], v[176:179], v[184:187]
    v_exp_f32 v148, v148
    v_mfma_f32_16x16x32_bf16 v[188:191], v[90:93], v[176:179], v[188:191]
    v_exp_f32 v149, v149
    v_mfma_f32_16x16x32_bf16 v[192:195], v[112:115], v[176:179], v[192:195]
    s_waitcnt lgkmcnt(1)
    v_exp_f32 v150, v150
    v_mfma_f32_16x16x32_bf16 v[172:175], v[30:33], v[132:135], v[172:175]
    v_exp_f32 v151, v151
    v_mfma_f32_16x16x32_bf16 v[212:215], a[236:239], a[104:107], v[212:215]
    ds_read_b128 a[236:239], v224 offset:34176
    v_cvt_pk_bf16_f32 v180, v148, v149
    v_mfma_f32_16x16x32_bf16 v[212:215], a[240:243], a[116:119], v[212:215]
    ds_read_b128 a[240:243], v224 offset:34240
    v_cvt_pk_bf16_f32 v181, v150, v151
    v_mfma_f32_16x16x16_bf16 v[172:175], v[34:35], v[136:137], v[172:175]
    s_waitcnt lgkmcnt(2)
    ds_read_b128 v[148:151], v228 offset:2560
    v_fma_f32 v152, v152, s37, -v236
    v_mfma_f32_16x16x32_bf16 v[144:147], v[6:9], v[132:135], v[144:147]
    v_fma_f32 v153, v153, s37, -v236
    v_fma_f32 v154, v154, s37, -v236
    v_mfma_f32_16x16x32_bf16 v[208:211], a[48:51], a[244:247], v[208:211]
    v_fma_f32 v155, v155, s37, -v236
    v_max3_f32 v248, v156, v157, v158
    v_mfma_f32_16x16x32_bf16 v[208:211], a[60:63], a[248:251], v[208:211]
    v_exp_f32 v152, v152
    v_mfma_f32_16x16x16_bf16 v[144:147], v[10:11], v[136:137], v[144:147]
    v_exp_f32 v153, v153
    v_mfma_f32_16x16x32_bf16 v[204:207], a[52:55], a[244:247], v[204:207]
    v_exp_f32 v154, v154
    v_mfma_f32_16x16x32_bf16 v[204:207], a[64:67], a[248:251], v[204:207]
    v_exp_f32 v155, v155
    v_mfma_f32_16x16x32_bf16 v[200:203], a[56:59], a[244:247], v[200:203]
    v_cvt_pk_bf16_f32 v12, v208, v209
    v_cvt_pk_bf16_f32 v13, v210, v211
    v_mfma_f32_16x16x32_bf16 v[200:203], a[68:71], a[248:251], v[200:203]
    v_cvt_pk_bf16_f32 v182, v152, v153
    v_cvt_pk_bf16_f32 v183, v154, v155
    v_mfma_f32_16x16x32_bf16 v[220:223], a[244:247], a[120:123], v[220:223]
    v_cvt_pk_bf16_f32 v14, v204, v205
    v_cvt_pk_bf16_f32 v15, v206, v207
    v_mfma_f32_16x16x32_bf16 v[220:223], a[248:251], a[132:135], v[220:223]
    ds_read_b128 v[152:155], v229 offset:2560
    v_max3_f32 v249, v159, v160, v161
    v_mfma_f32_16x16x32_bf16 v[196:199], a[216:219], v[180:183], v[196:199]
    v_cvt_pk_bf16_f32 v16, v200, v201
    v_cvt_pk_bf16_f32 v17, v202, v203
    v_mfma_f32_16x16x32_bf16 v[184:187], v[84:87], v[180:183], v[184:187]
    v_max3_f32 v248, v248, v162, v163
    v_max3_f32 v249, v249, v164, v165
    v_mfma_f32_16x16x32_bf16 v[188:191], v[106:109], v[180:183], v[188:191]
    v_cvt_pk_bf16_f32 v74, v220, v221
    v_cvt_pk_bf16_f32 v75, v222, v223
    v_mfma_f32_16x16x32_bf16 v[192:195], v[128:131], v[180:183], v[192:195]
    s_waitcnt lgkmcnt(1)
    v_rcp_f32 v197, v196
    v_mfma_f32_16x16x32_bf16 v[148:151], v[12:15], v[132:135], v[148:151]
    v_mul_f32 v184, v184, v197
    v_mul_f32 v185, v185, v197
    v_mfma_f32_16x16x32_bf16 v[216:219], a[244:247], a[124:127], v[216:219]
    v_cvt_pk_bf16_f32 v184, v184, v185
    v_mul_f32 v186, v186, v197
    v_mfma_f32_16x16x32_bf16 v[216:219], a[248:251], a[136:139], v[216:219]
    v_mul_f32 v187, v187, v197
    v_cvt_pk_bf16_f32 v185, v186, v187
    v_mfma_f32_16x16x16_bf16 v[148:151], v[16:17], v[136:137], v[148:151]
    v_mul_f32 v188, v188, v197
    v_mul_f32 v189, v189, v197
    v_mfma_f32_16x16x32_bf16 v[212:215], a[244:247], a[128:131], v[212:215]
    ds_read_b128 a[244:247], v224 offset:34304
    v_cvt_pk_bf16_f32 v186, v188, v189
    v_mfma_f32_16x16x32_bf16 v[212:215], a[248:251], a[140:143], v[212:215]
    v_cvt_pk_bf16_f32 v96, v216, v217
    v_cvt_pk_bf16_f32 v97, v218, v219
    v_mfma_f32_16x16x32_bf16 v[208:211], a[0:3], a[252:255], 0
    ds_read_b128 a[248:251], v224 offset:34368
    v_mul_f32 v190, v190, v197
    v_mfma_f32_16x16x32_bf16 v[208:211], a[12:15], v[252:255], v[208:211]
    v_mul_f32 v191, v191, v197
    v_cvt_pk_bf16_f32 v187, v190, v191
    v_mfma_f32_16x16x32_bf16 v[204:207], a[4:7], a[252:255], 0
    v_cvt_pk_bf16_f32 v118, v212, v213
    v_cvt_pk_bf16_f32 v119, v214, v215
    v_mfma_f32_16x16x32_bf16 v[204:207], a[16:19], v[252:255], v[204:207]
    v_mul_f32 v192, v192, v197
    v_mul_f32 v193, v193, v197
    v_mfma_f32_16x16x32_bf16 v[200:203], a[8:11], a[252:255], 0
    v_cvt_pk_bf16_f32 v188, v192, v193
    v_mul_f32 v194, v194, v197
    v_mfma_f32_16x16x32_bf16 v[200:203], a[20:23], v[252:255], v[200:203]
    v_mul_f32 v195, v195, v197
    v_cvt_pk_bf16_f32 v189, v194, v195
    v_mfma_f32_16x16x32_bf16 v[220:223], a[252:255], a[72:75], 0
    ds_write_b128 v237, v[184:187] offset:6144
    v_mfma_f32_16x16x32_bf16 v[220:223], v[252:255], a[84:87], v[220:223]
    ds_write_b64 v238, v[188:189] offset:6144
    v_mfma_f32_16x16x32_bf16 v[216:219], a[252:255], a[76:79], 0
    v_max3_f32 v248, v248, v166, v167
    v_max3_f32 v249, v249, v168, v169
    v_mfma_f32_16x16x32_bf16 v[216:219], v[252:255], a[88:91], v[216:219]
    v_max3_f32 v248, v248, v170, v171
    v_max3_f32 v249, v249, v172, v173
    v_mfma_f32_16x16x32_bf16 v[212:215], a[252:255], a[80:83], 0
    v_max3_f32 v248, v248, v174, v175
    v_max3_f32 v249, v249, v144, v145
    v_mfma_f32_16x16x32_bf16 v[212:215], v[252:255], a[92:95], v[212:215]
    ds_read_b128 a[252:255], v225 offset:11968
    ds_read_b128 v[252:255], v225 offset:12032
    v_mfma_f32_16x16x32_bf16 v[208:211], a[24:27], a[236:239], v[208:211]
    v_max3_f32 v248, v248, v146, v147
    v_max3_f32 v249, v249, v148, v149
    v_mfma_f32_16x16x32_bf16 v[208:211], a[36:39], a[240:243], v[208:211]
    v_max3_f32 v248, v248, v150, v151
    v_mfma_f32_16x16x32_bf16 v[204:207], a[28:31], a[236:239], v[204:207]
    v_mfma_f32_16x16x32_bf16 v[204:207], a[40:43], a[240:243], v[204:207]
    v_mfma_f32_16x16x32_bf16 v[200:203], a[32:35], a[236:239], v[200:203]
    v_mfma_f32_16x16x32_bf16 v[200:203], a[44:47], a[240:243], v[200:203]
    v_mfma_f32_16x16x32_bf16 v[220:223], a[236:239], a[96:99], v[220:223]
    v_mfma_f32_16x16x32_bf16 v[220:223], a[240:243], a[108:111], v[220:223]
    v_mfma_f32_16x16x32_bf16 v[216:219], a[236:239], a[100:103], v[216:219]
    v_mfma_f32_16x16x32_bf16 v[216:219], a[240:243], a[112:115], v[216:219]
    v_mfma_f32_16x16x32_bf16 v[212:215], a[236:239], a[104:107], v[212:215]
    ds_read_b128 a[236:239], v225 offset:12096
    v_mfma_f32_16x16x32_bf16 v[212:215], a[240:243], a[116:119], v[212:215]
    s_waitcnt lgkmcnt(1)
    ds_read_b128 a[240:243], v225 offset:12160
    v_mfma_f32_16x16x32_bf16 v[208:211], a[48:51], a[244:247], v[208:211]
    v_mfma_f32_16x16x32_bf16 v[208:211], a[60:63], a[248:251], v[208:211]
    v_mfma_f32_16x16x32_bf16 v[204:207], a[52:55], a[244:247], v[204:207]
    v_mfma_f32_16x16x32_bf16 v[204:207], a[64:67], a[248:251], v[204:207]
    v_mfma_f32_16x16x32_bf16 v[200:203], a[56:59], a[244:247], v[200:203]
    v_mfma_f32_16x16x32_bf16 v[200:203], a[68:71], a[248:251], v[200:203]
    v_mfma_f32_16x16x32_bf16 v[220:223], a[244:247], a[120:123], v[220:223]
    v_mfma_f32_16x16x32_bf16 v[220:223], a[248:251], a[132:135], v[220:223]
    v_mfma_f32_16x16x32_bf16 v[216:219], a[244:247], a[124:127], v[216:219]
    v_mfma_f32_16x16x32_bf16 v[216:219], a[248:251], a[136:139], v[216:219]
    v_cvt_pk_bf16_f32 v36, v208, v209
    v_cvt_pk_bf16_f32 v37, v210, v211
    v_mfma_f32_16x16x32_bf16 v[212:215], a[244:247], a[128:131], v[212:215]
    v_cvt_pk_bf16_f32 v38, v204, v205
    v_cvt_pk_bf16_f32 v39, v206, v207
    v_mfma_f32_16x16x32_bf16 v[212:215], a[248:251], a[140:143], v[212:215]
    v_cvt_pk_bf16_f32 v40, v200, v201
    v_cvt_pk_bf16_f32 v41, v202, v203
    v_mfma_f32_16x16x32_bf16 v[152:155], v[36:39], v[132:135], v[152:155]
    v_cvt_pk_bf16_f32 v76, v220, v221
    v_cvt_pk_bf16_f32 v77, v222, v223
    v_mfma_f32_16x16x32_bf16 v[208:211], a[144:147], a[252:255], 0
    v_cvt_pk_bf16_f32 v98, v216, v217
    v_cvt_pk_bf16_f32 v99, v218, v219
    v_mfma_f32_16x16x32_bf16 v[208:211], a[156:159], v[252:255], v[208:211]
    v_cvt_pk_bf16_f32 v120, v212, v213
    v_cvt_pk_bf16_f32 v121, v214, v215
    v_mfma_f32_16x16x16_bf16 v[152:155], v[40:41], v[136:137], v[152:155]
    ds_read_b128 a[244:247], v225 offset:12224
    ds_read_b128 a[248:251], v225 offset:12288
    v_mfma_f32_16x16x32_bf16 v[204:207], a[148:151], a[252:255], 0
    v_mfma_f32_16x16x32_bf16 v[204:207], a[160:163], v[252:255], v[204:207]
    v_mfma_f32_16x16x32_bf16 v[200:203], a[152:155], a[252:255], 0
    ds_read_b128 a[252:255], v225 offset:24384
    v_mfma_f32_16x16x32_bf16 v[200:203], a[164:167], v[252:255], v[200:203]
    s_waitcnt lgkmcnt(3)
    ds_read_b128 v[252:255], v225 offset:24448
    v_max3_f32 v249, v249, v152, v153
    v_mfma_f32_16x16x32_bf16 v[208:211], a[168:171], a[236:239], v[208:211]
    v_max3_f32 v248, v248, v154, v155
    v_max_f32 v248, v248, v249
    v_mfma_f32_16x16x32_bf16 v[208:211], a[180:183], a[240:243], v[208:211]
    v_mov_b32 v249, v248
    v_mfma_f32_16x16x32_bf16 v[204:207], a[172:175], a[236:239], v[204:207]
    v_mfma_f32_16x16x32_bf16 v[204:207], a[184:187], a[240:243], v[204:207]
    v_permlane16_swap_b32 v248, v249
    v_mfma_f32_16x16x32_bf16 v[200:203], a[176:179], a[236:239], v[200:203]
    s_waitcnt vmcnt(3) lgkmcnt(2)
    ds_read_b128 a[236:239], v225 offset:24512
    v_max_f32 v248, v248, v249
    v_mfma_f32_16x16x32_bf16 v[200:203], a[188:191], a[240:243], v[200:203]
    s_barrier
    ds_read_b128 a[240:243], v225 offset:24576
    v_mov_b32 v249, v248
    v_mfma_f32_16x16x32_bf16 v[208:211], a[192:195], a[244:247], v[208:211]
    buffer_load_dwordx4 v246, s[4:7], s56 offen lds
    v_mfma_f32_16x16x32_bf16 v[208:211], a[204:207], a[248:251], v[208:211]
    s_add_u32 m0, s42, 0
    v_permlane32_swap_b32 v248, v249
    v_mfma_f32_16x16x32_bf16 v[204:207], a[196:199], a[244:247], v[204:207]
    v_max_f32 v248, v248, v249
    v_mul_f32 v236, s37, v248
    v_mfma_f32_16x16x32_bf16 v[204:207], a[208:211], a[248:251], v[204:207]
    v_fma_f32 v156, v156, s37, -v236
    v_fma_f32 v157, v157, s37, -v236
    v_mfma_f32_16x16x32_bf16 v[200:203], a[200:203], a[244:247], v[200:203]
    v_cvt_pk_bf16_f32 v138, v208, v209
    v_cvt_pk_bf16_f32 v139, v210, v211
    v_mfma_f32_16x16x32_bf16 v[200:203], a[212:215], a[248:251], v[200:203]
    s_waitcnt lgkmcnt(2)
    ds_read_b128 a[244:247], v225 offset:24640
    ds_read_b128 a[248:251], v225 offset:24704
    v_mfma_f32_16x16x32_bf16 v[220:223], a[144:147], a[252:255], 0
    v_cvt_pk_bf16_f32 v140, v204, v205
    v_cvt_pk_bf16_f32 v141, v206, v207
    v_mfma_f32_16x16x32_bf16 v[220:223], a[156:159], v[252:255], v[220:223]
    v_fma_f32 v158, v158, s37, -v236
    v_fma_f32 v159, v159, s37, -v236
    v_mfma_f32_16x16x32_bf16 v[216:219], a[148:151], a[252:255], 0
    v_cvt_pk_bf16_f32 v142, v200, v201
    v_cvt_pk_bf16_f32 v143, v202, v203
    v_mfma_f32_16x16x32_bf16 v[216:219], a[160:163], v[252:255], v[216:219]
    buffer_load_dwordx4 v247, s[4:7], s56 offen lds
    v_mfma_f32_16x16x32_bf16 v[212:215], a[152:155], a[252:255], 0
    s_add_u32 m0, s41, 0x1e40
    ds_read_b128 a[252:255], v227 offset:37120
    v_fma_f32 v160, v160, s37, -v236
    v_mfma_f32_16x16x32_bf16 v[212:215], a[164:167], v[252:255], v[212:215]
    s_waitcnt lgkmcnt(3)
    ds_read_b128 v[252:255], v227 offset:37184
    v_fma_f32 v161, v161, s37, -v236
    v_mfma_f32_16x16x32_bf16 v[220:223], a[168:171], a[236:239], v[220:223]
    v_exp_f32 v156, v156
    v_mfma_f32_16x16x32_bf16 v[220:223], a[180:183], a[240:243], v[220:223]
    v_exp_f32 v157, v157
    v_mfma_f32_16x16x32_bf16 v[216:219], a[172:175], a[236:239], v[216:219]
    v_exp_f32 v158, v158
    v_mfma_f32_16x16x32_bf16 v[216:219], a[184:187], a[240:243], v[216:219]
    v_exp_f32 v159, v159
    v_mfma_f32_16x16x32_bf16 v[212:215], a[176:179], a[236:239], v[212:215]
    ds_read_b128 a[236:239], v227 offset:37248
    v_cvt_pk_bf16_f32 v176, v156, v157
    v_mfma_f32_16x16x32_bf16 v[212:215], a[188:191], a[240:243], v[212:215]
    s_waitcnt lgkmcnt(3)
    ds_read_b128 a[240:243], v227 offset:37312
    v_cvt_pk_bf16_f32 v177, v158, v159
    v_mfma_f32_16x16x32_bf16 v[220:223], a[192:195], a[244:247], v[220:223]
    buffer_load_dwordx4 v246, s[4:7], s46 offen lds
    v_mfma_f32_16x16x32_bf16 v[220:223], a[204:207], a[248:251], v[220:223]
    s_add_u32 m0, s42, 0x1e40
    ds_read_b128 v[156:159], v230 offset:2560
    v_fma_f32 v162, v162, s37, -v236
    v_mfma_f32_16x16x32_bf16 v[216:219], a[196:199], a[244:247], v[216:219]
    v_fma_f32 v163, v163, s37, -v236
    v_fma_f32 v164, v164, s37, -v236
    v_mfma_f32_16x16x32_bf16 v[216:219], a[208:211], a[248:251], v[216:219]
    v_exp_f32 v160, v160
    v_mfma_f32_16x16x32_bf16 v[212:215], a[200:203], a[244:247], v[212:215]
    v_cvt_pk_bf16_f32 v132, v220, v221
    v_cvt_pk_bf16_f32 v133, v222, v223
    v_mfma_f32_16x16x32_bf16 v[212:215], a[212:215], a[248:251], v[212:215]
    s_waitcnt lgkmcnt(3)
    ds_read_b128 a[244:247], v227 offset:37376
    ds_read_b128 a[248:251], v227 offset:37440
    v_mfma_f32_16x16x32_bf16 v[208:211], a[0:3], a[252:255], 0
    v_cvt_pk_bf16_f32 v134, v216, v217
    v_cvt_pk_bf16_f32 v135, v218, v219
    v_mfma_f32_16x16x32_bf16 v[208:211], a[12:15], v[252:255], v[208:211]
    v_exp_f32 v161, v161
    v_mfma_f32_16x16x32_bf16 v[204:207], a[4:7], a[252:255], 0
    v_cvt_pk_bf16_f32 v136, v212, v213
    v_cvt_pk_bf16_f32 v137, v214, v215
    v_mfma_f32_16x16x32_bf16 v[204:207], a[16:19], v[252:255], v[204:207]
    s_waitcnt lgkmcnt(2)
    buffer_load_dwordx4 v247, s[4:7], s46 offen lds
    v_mfma_f32_16x16x32_bf16 v[156:159], v[36:39], v[138:141], v[156:159]
    s_add_u32 m0, s41, 0x3c80
    v_exp_f32 v162, v162
    v_mfma_f32_16x16x32_bf16 v[200:203], a[8:11], a[252:255], 0
    v_exp_f32 v163, v163
    v_mfma_f32_16x16x32_bf16 v[200:203], a[20:23], v[252:255], v[200:203]
    v_cvt_pk_bf16_f32 v178, v160, v161
    v_cvt_pk_bf16_f32 v179, v162, v163
    v_mfma_f32_16x16x16_bf16 v[156:159], v[40:41], v[142:143], v[156:159]
    ds_read_b128 v[160:163], v230 offset:640
    v_fma_f32 v165, v165, s37, -v236
    v_mfma_f32_16x16x32_bf16 v[196:199], a[216:219], v[176:179], 0
    v_fma_f32 v166, v166, s37, -v236
    v_fma_f32 v167, v167, s37, -v236
    v_mfma_f32_16x16x32_bf16 v[184:187], v[78:81], v[176:179], 0
    v_exp_f32 v164, v164
    v_mfma_f32_16x16x32_bf16 v[188:191], v[100:103], v[176:179], 0
    v_exp_f32 v165, v165
    v_mfma_f32_16x16x32_bf16 v[192:195], v[122:125], v[176:179], 0
    v_exp_f32 v166, v166
    v_mfma_f32_16x16x32_bf16 v[220:223], a[252:255], a[72:75], 0
    v_exp_f32 v167, v167
    v_mfma_f32_16x16x32_bf16 v[220:223], v[252:255], a[84:87], v[220:223]
    v_cvt_pk_bf16_f32 v180, v164, v165
    v_cvt_pk_bf16_f32 v181, v166, v167
    v_mfma_f32_16x16x32_bf16 v[216:219], a[252:255], a[76:79], 0
    ds_read_b128 v[164:167], v230 offset:1280
    v_fma_f32 v168, v168, s37, -v236
    v_mfma_f32_16x16x32_bf16 v[216:219], v[252:255], a[88:91], v[216:219]
    s_waitcnt lgkmcnt(1)
    v_fma_f32 v169, v169, s37, -v236
    v_fma_f32 v170, v170, s37, -v236
    v_mfma_f32_16x16x32_bf16 v[160:163], v[42:45], v[138:141], v[160:163]
    v_fma_f32 v171, v171, s37, -v236
    v_fma_f32 v172, v172, s37, -v236
    v_mfma_f32_16x16x32_bf16 v[212:215], a[252:255], a[80:83], 0
    ds_read_b128 a[252:255], v239
    v_fma_f32 v173, v173, s37, -v236
    v_mfma_f32_16x16x32_bf16 v[212:215], v[252:255], a[92:95], v[212:215]
    ds_read_b128 v[252:255], v240
    v_fma_f32 v174, v174, s37, -v236
    v_mfma_f32_16x16x16_bf16 v[160:163], v[46:47], v[142:143], v[160:163]
    v_exp_f32 v168, v168
    v_mfma_f32_16x16x32_bf16 v[208:211], a[24:27], a[236:239], v[208:211]
    v_exp_f32 v169, v169
    v_mfma_f32_16x16x32_bf16 v[208:211], a[36:39], a[240:243], v[208:211]
    v_exp_f32 v170, v170
    v_mfma_f32_16x16x32_bf16 v[204:207], a[28:31], a[236:239], v[204:207]
    v_exp_f32 v171, v171
    v_mfma_f32_16x16x32_bf16 v[204:207], a[40:43], a[240:243], v[204:207]
    s_waitcnt lgkmcnt(2)
    v_cvt_pk_bf16_f32 v182, v168, v169
    v_cvt_pk_bf16_f32 v183, v170, v171
    v_mfma_f32_16x16x32_bf16 v[164:167], v[24:27], v[138:141], v[164:167]
    ds_read_b128 v[168:171], v230 offset:1920
    v_fma_f32 v175, v175, s37, -v236
    v_mfma_f32_16x16x32_bf16 v[196:199], a[216:219], v[180:183], v[196:199]
    v_exp_f32 v172, v172
    v_mfma_f32_16x16x32_bf16 v[184:187], v[66:69], v[180:183], v[184:187]
    v_exp_f32 v173, v173
    v_mfma_f32_16x16x32_bf16 v[188:191], v[88:91], v[180:183], v[188:191]
    v_exp_f32 v174, v174
    v_mfma_f32_16x16x32_bf16 v[192:195], v[110:113], v[180:183], v[192:195]
    v_exp_f32 v175, v175
    v_mfma_f32_16x16x16_bf16 v[164:167], v[28:29], v[142:143], v[164:167]
    v_cvt_pk_bf16_f32 v176, v172, v173
    v_cvt_pk_bf16_f32 v177, v174, v175
    v_mfma_f32_16x16x32_bf16 v[200:203], a[32:35], a[236:239], v[200:203]
    ds_read_b128 v[172:175], v235
    v_bfe_u32 v235, s69, v233, 4
    v_mfma_f32_16x16x32_bf16 v[200:203], a[44:47], a[240:243], v[200:203]
    v_mad_u32_u24 v235, v235, s40, v231
    v_fma_f32 v144, v144, s37, -v236
    v_mfma_f32_16x16x32_bf16 v[220:223], a[236:239], a[96:99], v[220:223]
    v_fma_f32 v145, v145, s37, -v236
    v_fma_f32 v146, v146, s37, -v236
    v_mfma_f32_16x16x32_bf16 v[220:223], a[240:243], a[108:111], v[220:223]
    s_waitcnt lgkmcnt(1)
    v_fma_f32 v147, v147, s37, -v236
    v_fma_f32 v148, v148, s37, -v236
    v_mfma_f32_16x16x32_bf16 v[168:171], v[30:33], v[138:141], v[168:171]
    v_exp_f32 v144, v144
    v_mfma_f32_16x16x32_bf16 v[216:219], a[236:239], a[100:103], v[216:219]
    v_exp_f32 v145, v145
    v_mfma_f32_16x16x32_bf16 v[216:219], a[240:243], a[112:115], v[216:219]
    v_exp_f32 v146, v146
    v_mfma_f32_16x16x32_bf16 v[212:215], a[236:239], a[104:107], v[212:215]
    ds_read_b128 a[236:239], v239 offset:1024
    v_cvt_pk_bf16_f32 v178, v144, v145
    v_mfma_f32_16x16x32_bf16 v[212:215], a[240:243], a[116:119], v[212:215]
    ds_read_b128 a[240:243], v240 offset:1024
    v_fma_f32 v149, v149, s37, -v236
    v_mfma_f32_16x16x16_bf16 v[168:171], v[34:35], v[142:143], v[168:171]
    s_waitcnt lgkmcnt(2)
    v_exp_f32 v147, v147
    v_mfma_f32_16x16x32_bf16 v[172:175], v[54:57], v[138:141], v[172:175]
    v_cvt_pk_bf16_f32 v179, v146, v147
    v_fma_f32 v150, v150, s37, -v236
    v_mfma_f32_16x16x32_bf16 v[208:211], a[48:51], a[244:247], v[208:211]
    ds_read_b128 v[144:147], v250
    v_bfe_u32 v250, s70, v233, 4
    v_mfma_f32_16x16x32_bf16 v[208:211], a[60:63], a[248:251], v[208:211]
    v_mad_u32_u24 v250, v250, s40, v231
    v_fma_f32 v151, v151, s37, -v236
    v_mfma_f32_16x16x32_bf16 v[196:199], a[216:219], v[176:179], v[196:199]
    v_exp_f32 v148, v148
    v_mfma_f32_16x16x32_bf16 v[184:187], v[70:73], v[176:179], v[184:187]
    v_exp_f32 v149, v149
    v_mfma_f32_16x16x32_bf16 v[188:191], v[92:95], v[176:179], v[188:191]
    v_exp_f32 v150, v150
    v_mfma_f32_16x16x32_bf16 v[192:195], v[114:117], v[176:179], v[192:195]
    v_cvt_pk_bf16_f32 v48, v208, v209
    v_cvt_pk_bf16_f32 v49, v210, v211
    v_mfma_f32_16x16x16_bf16 v[172:175], v[58:59], v[142:143], v[172:175]
    v_exp_f32 v151, v151
    v_mfma_f32_16x16x32_bf16 v[204:207], a[52:55], a[244:247], v[204:207]
    v_cvt_pk_bf16_f32 v180, v148, v149
    v_cvt_pk_bf16_f32 v181, v150, v151
    v_mfma_f32_16x16x32_bf16 v[204:207], a[64:67], a[248:251], v[204:207]
    s_waitcnt lgkmcnt(0)
    ds_read_b128 v[148:151], v234
    v_bfe_u32 v234, s73, v232, 4
    v_mfma_f32_16x16x32_bf16 v[144:147], v[60:63], v[138:141], v[144:147]
    v_fma_f32 v152, v152, s37, -v236
    v_fma_f32 v153, v153, s37, -v236
    v_mfma_f32_16x16x32_bf16 v[200:203], a[56:59], a[244:247], v[200:203]
    v_fma_f32 v154, v154, s37, -v236
    v_fma_f32 v155, v155, s37, -v236
    v_mfma_f32_16x16x32_bf16 v[200:203], a[68:71], a[248:251], v[200:203]
    v_cvt_pk_bf16_f32 v50, v204, v205
    v_cvt_pk_bf16_f32 v51, v206, v207
    v_mfma_f32_16x16x16_bf16 v[144:147], v[64:65], v[142:143], v[144:147]
    v_exp_f32 v152, v152
    v_mfma_f32_16x16x32_bf16 v[220:223], a[244:247], a[120:123], v[220:223]
    v_exp_f32 v153, v153
    v_mfma_f32_16x16x32_bf16 v[220:223], a[248:251], a[132:135], v[220:223]
    v_exp_f32 v154, v154
    v_mfma_f32_16x16x32_bf16 v[216:219], a[244:247], a[124:127], v[216:219]
    v_cvt_pk_bf16_f32 v52, v200, v201
    v_cvt_pk_bf16_f32 v53, v202, v203
    v_mfma_f32_16x16x32_bf16 v[216:219], a[248:251], a[136:139], v[216:219]
    s_waitcnt lgkmcnt(0)
    v_exp_f32 v155, v155
    v_mfma_f32_16x16x32_bf16 v[148:151], v[48:51], v[138:141], v[148:151]
    v_cvt_pk_bf16_f32 v182, v152, v153
    v_cvt_pk_bf16_f32 v82, v220, v221
    v_mfma_f32_16x16x32_bf16 v[212:215], a[244:247], a[128:131], v[212:215]
    ds_read_b128 a[244:247], v241 offset:12288
    v_cvt_pk_bf16_f32 v83, v222, v223
    v_mfma_f32_16x16x32_bf16 v[212:215], a[248:251], a[140:143], v[212:215]
    v_cvt_pk_bf16_f32 v104, v216, v217
    v_cvt_pk_bf16_f32 v105, v218, v219
    v_mfma_f32_16x16x16_bf16 v[148:151], v[52:53], v[142:143], v[148:151]
    ds_read_b128 a[248:251], v241 offset:12800
    v_cvt_pk_bf16_f32 v183, v154, v155
    v_mfma_f32_16x16x32_bf16 v[208:211], a[220:223], a[252:255], 0
    ds_read_b128 v[152:155], v228 offset:640
    v_max3_f32 v248, v156, v157, v158
    v_mfma_f32_16x16x32_bf16 v[196:199], a[216:219], v[180:183], v[196:199]
    v_cvt_pk_bf16_f32 v126, v212, v213
    v_cvt_pk_bf16_f32 v127, v214, v215
    v_mfma_f32_16x16x32_bf16 v[184:187], v[74:77], v[180:183], v[184:187]
    v_max3_f32 v249, v159, v160, v161
    v_max3_f32 v248, v248, v162, v163
    v_mfma_f32_16x16x32_bf16 v[188:191], v[96:99], v[180:183], v[188:191]
    v_max3_f32 v249, v249, v164, v165
    v_max3_f32 v248, v248, v166, v167
    v_mfma_f32_16x16x32_bf16 v[192:195], v[118:121], v[180:183], v[192:195]
    v_rcp_f32 v197, v196
    v_mfma_f32_16x16x32_bf16 v[200:203], a[220:223], v[252:255], 0
    v_mul_f32 v184, v184, v197
    v_mul_f32 v185, v185, v197
    v_mfma_f32_16x16x32_bf16 v[204:207], a[224:227], a[252:255], 0
    v_cvt_pk_bf16_f32 v184, v184, v185
    v_mul_f32 v186, v186, v197
    v_mfma_f32_16x16x32_bf16 v[220:223], a[224:227], v[252:255], 0
    ds_read_b128 v[252:255], v242 offset:12800
    v_mul_f32 v187, v187, v197
    v_mfma_f32_16x16x32_bf16 v[216:219], a[228:231], a[252:255], 0
    s_waitcnt lgkmcnt(1)
    v_cvt_pk_bf16_f32 v185, v186, v187
    v_mul_f32 v188, v188, v197
    v_mfma_f32_16x16x32_bf16 v[152:155], v[0:3], v[132:135], v[152:155]
    v_mul_f32 v189, v189, v197
    v_cvt_pk_bf16_f32 v186, v188, v189
    v_mfma_f32_16x16x32_bf16 v[212:215], a[232:235], a[252:255], 0
    ds_read_b128 a[252:255], v242 offset:12288
    v_mul_f32 v190, v190, v197
    v_mfma_f32_16x16x32_bf16 v[208:211], a[244:247], a[236:239], v[208:211]
    v_mul_f32 v191, v191, v197
    v_cvt_pk_bf16_f32 v187, v190, v191
    v_mfma_f32_16x16x16_bf16 v[152:155], v[4:5], v[136:137], v[152:155]
    v_mul_f32 v192, v192, v197
    v_mul_f32 v193, v193, v197
    v_mfma_f32_16x16x32_bf16 v[200:203], a[244:247], a[240:243], v[200:203]
    ds_read_b128 a[244:247], v241 offset:24576
    v_cvt_pk_bf16_f32 v188, v192, v193
    v_mfma_f32_16x16x32_bf16 v[204:207], a[248:251], a[236:239], v[204:207]
    v_mul_f32 v194, v194, v197
    v_mul_f32 v195, v195, v197
    v_mfma_f32_16x16x32_bf16 v[220:223], a[248:251], a[240:243], v[220:223]
    s_waitcnt lgkmcnt(2)
    ds_read_b128 a[240:243], v240 offset:2048
    ds_read_b128 a[248:251], v241 offset:25088
    v_mfma_f32_16x16x32_bf16 v[212:215], v[252:255], a[236:239], v[212:215]
    s_waitcnt lgkmcnt(3)
    ds_read_b128 v[252:255], v242 offset:25088
    v_cvt_pk_bf16_f32 v189, v194, v195
    v_max3_f32 v249, v249, v168, v169
    v_max3_f32 v248, v248, v170, v171
    ds_write_b128 v237, v[184:187] offset:12288
    v_mfma_f32_16x16x32_bf16 v[216:219], a[252:255], a[236:239], v[216:219]
    s_waitcnt lgkmcnt(3)
    ds_write_b64 v238, v[188:189] offset:12288
    v_max3_f32 v249, v249, v172, v173
    v_max3_f32 v248, v248, v174, v175
    v_max3_f32 v249, v249, v144, v145
    v_max3_f32 v248, v248, v146, v147
    v_max3_f32 v249, v249, v148, v149
    v_max3_f32 v248, v248, v150, v151
    v_max_f32 v248, v248, v249
    v_mov_b32 v249, v248
    s_nop 1
    v_permlane16_swap_b32 v248, v249
    v_mfma_f32_16x16x32_bf16 v[200:203], a[244:247], a[240:243], v[200:203]
    s_waitcnt lgkmcnt(3)
    ds_read_b128 a[236:239], v239 offset:2048
    ds_read_b128 a[252:255], v242 offset:24576
    v_mfma_f32_16x16x32_bf16 v[220:223], a[248:251], a[240:243], v[220:223]
    s_waitcnt lgkmcnt(1)
    ds_read_b128 a[240:243], v240 offset:3072
    v_max_f32 v248, v248, v249
    v_mov_b32 v249, v248
    s_nop 1
    v_permlane32_swap_b32 v248, v249
    v_max_f32 v248, v248, v249
    v_mul_f32 v236, s37, v248
    v_fma_f32 v156, v156, s37, -v236
    v_fma_f32 v157, v157, s37, -v236
    v_fma_f32 v158, v158, s37, -v236
    v_fma_f32 v159, v159, s37, -v236
    v_exp_f32 v156, v156
    v_exp_f32 v157, v157
    v_exp_f32 v158, v158
    v_exp_f32 v159, v159
    v_cvt_pk_bf16_f32 v176, v156, v157
    v_cvt_pk_bf16_f32 v177, v158, v159
    ds_read_b128 v[156:159], v229 offset:640
    v_fma_f32 v160, v160, s37, -v236
    v_fma_f32 v161, v161, s37, -v236
    v_mfma_f32_16x16x32_bf16 v[208:211], a[244:247], a[236:239], v[208:211]
    ds_read_b128 a[244:247], v241 offset:36864
    v_fma_f32 v162, v162, s37, -v236
    v_mfma_f32_16x16x32_bf16 v[204:207], a[248:251], a[236:239], v[204:207]
    s_waitcnt lgkmcnt(3)
    ds_read_b128 a[248:251], v241 offset:37376
    v_fma_f32 v163, v163, s37, -v236
    v_mfma_f32_16x16x32_bf16 v[216:219], a[252:255], a[236:239], v[216:219]
    ds_read_b128 a[252:255], v242 offset:36864
    v_fma_f32 v164, v164, s37, -v236
    v_mfma_f32_16x16x32_bf16 v[212:215], v[252:255], a[236:239], v[212:215]
    ds_read_b128 a[236:239], v239 offset:3072
    ds_read_b128 v[252:255], v242 offset:37376
    v_exp_f32 v160, v160
    v_exp_f32 v161, v161
    v_exp_f32 v162, v162
    v_exp_f32 v163, v163
    v_cvt_pk_bf16_f32 v178, v160, v161
    v_cvt_pk_bf16_f32 v179, v162, v163
    ds_read_b128 v[160:163], v229 offset:1280
    v_fma_f32 v165, v165, s37, -v236
    v_mfma_f32_16x16x32_bf16 v[196:199], a[216:219], v[176:179], 0
    v_fma_f32 v166, v166, s37, -v236
    v_fma_f32 v167, v167, s37, -v236
    v_mfma_f32_16x16x32_bf16 v[184:187], v[76:79], v[176:179], 0
    v_exp_f32 v164, v164
    v_mfma_f32_16x16x32_bf16 v[188:191], v[98:101], v[176:179], 0
    v_exp_f32 v165, v165
    v_mfma_f32_16x16x32_bf16 v[192:195], v[120:123], v[176:179], 0
    s_waitcnt lgkmcnt(5)
    v_exp_f32 v166, v166
    v_mfma_f32_16x16x32_bf16 v[156:159], v[24:27], v[132:135], v[156:159]
    s_waitcnt lgkmcnt(2)
    v_exp_f32 v167, v167
    v_mfma_f32_16x16x32_bf16 v[208:211], a[244:247], a[236:239], v[208:211]
    v_cvt_pk_bf16_f32 v180, v164, v165
    v_cvt_pk_bf16_f32 v181, v166, v167
    v_mfma_f32_16x16x32_bf16 v[200:203], a[244:247], a[240:243], v[200:203]
    ds_read_b128 a[244:247], v241 offset:49152
    ds_read_b128 v[164:167], v228 offset:1280
    v_mfma_f32_16x16x16_bf16 v[156:159], v[28:29], v[136:137], v[156:159]
    s_waitcnt lgkmcnt(2)
    v_fma_f32 v168, v168, s37, -v236
    v_fma_f32 v169, v169, s37, -v236
    v_mfma_f32_16x16x32_bf16 v[160:163], v[30:33], v[132:135], v[160:163]
    v_fma_f32 v170, v170, s37, -v236
    v_fma_f32 v171, v171, s37, -v236
    v_mfma_f32_16x16x32_bf16 v[204:207], a[248:251], a[236:239], v[204:207]
    v_exp_f32 v168, v168
    v_mfma_f32_16x16x32_bf16 v[220:223], a[248:251], a[240:243], v[220:223]
    ds_read_b128 a[240:243], v240 offset:4096
    ds_read_b128 a[248:251], v241 offset:49664
    v_mfma_f32_16x16x16_bf16 v[160:163], v[34:35], v[136:137], v[160:163]
    v_exp_f32 v169, v169
    v_mfma_f32_16x16x32_bf16 v[216:219], a[252:255], a[236:239], v[216:219]
    ds_read_b128 a[252:255], v242 offset:49152
    v_cvt_pk_bf16_f32 v182, v168, v169
    v_mfma_f32_16x16x32_bf16 v[212:215], v[252:255], a[236:239], v[212:215]
    s_waitcnt lgkmcnt(3)
    ds_read_b128 a[236:239], v239 offset:4096
    ds_read_b128 v[252:255], v242 offset:49664
    v_exp_f32 v170, v170
    v_exp_f32 v171, v171
    v_fma_f32 v172, v172, s37, -v236
    v_cvt_pk_bf16_f32 v183, v170, v171
    ds_read_b128 v[168:171], v228 offset:1920
    v_mfma_f32_16x16x32_bf16 v[164:167], v[6:9], v[132:135], v[164:167]
    v_fma_f32 v173, v173, s37, -v236
    v_fma_f32 v174, v174, s37, -v236
    v_mfma_f32_16x16x32_bf16 v[196:199], a[216:219], v[180:183], v[196:199]
    v_fma_f32 v175, v175, s37, -v236
    v_fma_f32 v144, v144, s37, -v236
    v_mfma_f32_16x16x32_bf16 v[184:187], v[68:71], v[180:183], v[184:187]
    v_exp_f32 v172, v172
    v_mfma_f32_16x16x32_bf16 v[188:191], v[90:93], v[180:183], v[188:191]
    v_exp_f32 v173, v173
    v_mfma_f32_16x16x32_bf16 v[192:195], v[112:115], v[180:183], v[192:195]
    v_exp_f32 v174, v174
    v_mfma_f32_16x16x16_bf16 v[164:167], v[10:11], v[136:137], v[164:167]
    s_waitcnt lgkmcnt(2)
    v_exp_f32 v175, v175
    v_mfma_f32_16x16x32_bf16 v[208:211], a[244:247], a[236:239], v[208:211]
    v_cvt_pk_bf16_f32 v176, v172, v173
    v_cvt_pk_bf16_f32 v177, v174, v175
    v_mfma_f32_16x16x32_bf16 v[200:203], a[244:247], a[240:243], v[200:203]
    ds_read_b128 a[244:247], v241 offset:61440
    ds_read_b128 v[172:175], v229 offset:1920
    v_mfma_f32_16x16x32_bf16 v[204:207], a[248:251], a[236:239], v[204:207]
    s_waitcnt lgkmcnt(2)
    v_fma_f32 v145, v145, s37, -v236
    v_fma_f32 v146, v146, s37, -v236
    v_mfma_f32_16x16x32_bf16 v[168:171], v[12:15], v[132:135], v[168:171]
    v_fma_f32 v147, v147, s37, -v236
    v_fma_f32 v148, v148, s37, -v236
    v_mfma_f32_16x16x32_bf16 v[220:223], a[248:251], a[240:243], v[220:223]
    ds_read_b128 a[240:243], v240 offset:5120
    ds_read_b128 a[248:251], v241 offset:61952
    v_mfma_f32_16x16x32_bf16 v[216:219], a[252:255], a[236:239], v[216:219]
    ds_read_b128 a[252:255], v242 offset:61440
    v_fma_f32 v149, v149, s37, -v236
    v_mfma_f32_16x16x16_bf16 v[168:171], v[16:17], v[136:137], v[168:171]
    v_exp_f32 v144, v144
    v_mfma_f32_16x16x32_bf16 v[212:215], v[252:255], a[236:239], v[212:215]
    ds_read_b128 a[236:239], v239 offset:5120
    ds_read_b128 v[252:255], v242 offset:61952
    v_exp_f32 v145, v145
    v_exp_f32 v146, v146
    v_exp_f32 v147, v147
    v_cvt_pk_bf16_f32 v178, v144, v145
    v_cvt_pk_bf16_f32 v179, v146, v147
    ds_read_b128 v[144:147], v229 offset:2560
    v_fma_f32 v150, v150, s37, -v236
    v_mfma_f32_16x16x32_bf16 v[196:199], a[216:219], v[176:179], v[196:199]
    v_fma_f32 v151, v151, s37, -v236
    v_max3_f32 v248, v152, v153, v154
    v_mfma_f32_16x16x32_bf16 v[184:187], v[84:87], v[176:179], v[184:187]
    v_exp_f32 v148, v148
    v_mfma_f32_16x16x32_bf16 v[188:191], v[106:109], v[176:179], v[188:191]
    v_exp_f32 v149, v149
    v_mfma_f32_16x16x32_bf16 v[192:195], v[128:131], v[176:179], v[192:195]
    s_waitcnt lgkmcnt(5)
    v_exp_f32 v150, v150
    v_mfma_f32_16x16x32_bf16 v[172:175], v[36:39], v[132:135], v[172:175]
    s_waitcnt lgkmcnt(2)
    v_exp_f32 v151, v151
    v_mfma_f32_16x16x32_bf16 v[208:211], a[244:247], a[236:239], v[208:211]
    v_cvt_pk_bf16_f32 v180, v148, v149
    v_cvt_pk_bf16_f32 v181, v150, v151
    v_mfma_f32_16x16x32_bf16 v[200:203], a[244:247], a[240:243], v[200:203]
    ds_read_b128 a[244:247], v224 offset:46592
    ds_read_b128 v[148:151], v228 offset:2560
    v_mfma_f32_16x16x16_bf16 v[196:199], a[216:217], v[180:181], v[196:199]
    v_max3_f32 v249, v155, v156, v157
    v_max3_f32 v248, v248, v158, v159
    v_mfma_f32_16x16x16_bf16 v[184:187], v[82:83], v[180:181], v[184:187]
    v_cvt_pk_bf16_f32 v208, v208, v209
    v_cvt_pk_bf16_f32 v209, v210, v211
    v_mfma_f32_16x16x16_bf16 v[188:191], v[104:105], v[180:181], v[188:191]
    v_cvt_pk_bf16_f32 v200, v200, v201
    v_cvt_pk_bf16_f32 v201, v202, v203
    v_mfma_f32_16x16x16_bf16 v[192:195], v[126:127], v[180:181], v[192:195]
    v_rcp_f32 v197, v196
    v_mfma_f32_16x16x16_bf16 v[172:175], v[40:41], v[136:137], v[172:175]
    v_mul_f32 v184, v184, v197
    v_mul_f32 v185, v185, v197
    v_mfma_f32_16x16x32_bf16 v[204:207], a[248:251], a[236:239], v[204:207]
    v_cvt_pk_bf16_f32 v184, v184, v185
    v_mul_f32 v186, v186, v197
    v_mfma_f32_16x16x32_bf16 v[220:223], a[248:251], a[240:243], v[220:223]
    ds_read_b128 a[240:243], v224 offset:46528
    ds_read_b128 a[248:251], v224 offset:46656
    v_mfma_f32_16x16x32_bf16 v[216:219], a[252:255], a[236:239], v[216:219]
    s_waitcnt lgkmcnt(4)
    ds_read_b128 a[252:255], v224 offset:46720
    v_mul_f32 v187, v187, v197
    v_mfma_f32_16x16x32_bf16 v[212:215], v[252:255], a[236:239], v[212:215]
    ds_read_b128 a[236:239], v224 offset:46464
    v_cvt_pk_bf16_f32 v210, v204, v205
    v_cvt_pk_bf16_f32 v211, v206, v207
    buffer_store_dwordx4 v[208:211], v243, s[20:23], s58 offen sc0 sc1
    ds_read_b128 v[252:255], v224 offset:46784
    v_cvt_pk_bf16_f32 v202, v220, v221
    v_cvt_pk_bf16_f32 v203, v222, v223
    v_cvt_pk_bf16_f32 v216, v216, v217
    v_cvt_pk_bf16_f32 v217, v218, v219
    v_cvt_pk_bf16_f32 v218, v212, v213
    v_cvt_pk_bf16_f32 v219, v214, v215
    v_cvt_pk_bf16_f32 v185, v186, v187
    v_mul_f32 v188, v188, v197
    v_mul_f32 v189, v189, v197
    v_cvt_pk_bf16_f32 v186, v188, v189
    v_mul_f32 v190, v190, v197
    v_mul_f32 v191, v191, v197
    v_cvt_pk_bf16_f32 v187, v190, v191
    v_mul_f32 v192, v192, v197
    v_mul_f32 v193, v193, v197
    v_cvt_pk_bf16_f32 v188, v192, v193
    v_mul_f32 v194, v194, v197
    v_mul_f32 v195, v195, v197
    v_cvt_pk_bf16_f32 v189, v194, v195
    ds_write_b128 v237, v[184:187] offset:18432
    s_waitcnt lgkmcnt(2)
    v_mfma_f32_16x16x32_bf16 v[208:211], a[0:3], a[236:239], 0
    ds_write_b64 v238, v[188:189] offset:18432
    v_mfma_f32_16x16x32_bf16 v[208:211], a[12:15], a[240:243], v[208:211]
    v_max3_f32 v249, v249, v160, v161
    v_max3_f32 v248, v248, v162, v163
    v_mfma_f32_16x16x32_bf16 v[204:207], a[4:7], a[236:239], 0
    v_max3_f32 v249, v249, v164, v165
    v_max3_f32 v248, v248, v166, v167
    v_mfma_f32_16x16x32_bf16 v[204:207], a[16:19], a[240:243], v[204:207]
    v_max3_f32 v249, v249, v168, v169
    v_max3_f32 v248, v248, v170, v171
    v_mfma_f32_16x16x32_bf16 v[220:223], a[236:239], a[72:75], 0
    buffer_store_dwordx4 v[200:203], v245, s[20:23], s58 offen sc0 sc1
    v_mfma_f32_16x16x32_bf16 v[220:223], a[240:243], a[84:87], v[220:223]
    v_max3_f32 v249, v249, v172, v173
    v_max3_f32 v248, v248, v174, v175
    v_mfma_f32_16x16x32_bf16 v[200:203], a[8:11], a[236:239], 0
    v_mfma_f32_16x16x32_bf16 v[200:203], a[20:23], a[240:243], v[200:203]
    v_mfma_f32_16x16x32_bf16 v[212:215], a[236:239], a[80:83], 0
    v_mfma_f32_16x16x32_bf16 v[212:215], a[240:243], a[92:95], v[212:215]
    v_mfma_f32_16x16x32_bf16 v[208:211], a[24:27], a[244:247], v[208:211]
    v_mfma_f32_16x16x32_bf16 v[208:211], a[36:39], a[248:251], v[208:211]
    v_mfma_f32_16x16x32_bf16 v[204:207], a[28:31], a[244:247], v[204:207]
    v_mfma_f32_16x16x32_bf16 v[204:207], a[40:43], a[248:251], v[204:207]
    v_mfma_f32_16x16x32_bf16 v[200:203], a[32:35], a[244:247], v[200:203]
    v_mfma_f32_16x16x32_bf16 v[200:203], a[44:47], a[248:251], v[200:203]
    v_mfma_f32_16x16x32_bf16 v[220:223], a[244:247], a[96:99], v[220:223]
    buffer_store_dwordx4 v[216:219], v244, s[20:23], s58 offen sc0 sc1
    v_mfma_f32_16x16x32_bf16 v[220:223], a[248:251], a[108:111], v[220:223]
    s_add_u32 s58, s51, 0xfc000
    v_mfma_f32_16x16x32_bf16 v[216:219], a[236:239], a[76:79], 0
    ds_read_b128 a[236:239], v224 offset:49536
    v_mfma_f32_16x16x32_bf16 v[216:219], a[240:243], a[88:91], v[216:219]
    ds_read_b128 a[240:243], v224 offset:49600
    v_mfma_f32_16x16x32_bf16 v[216:219], a[244:247], a[100:103], v[216:219]
    v_mfma_f32_16x16x32_bf16 v[216:219], a[248:251], a[112:115], v[216:219]
    v_mfma_f32_16x16x32_bf16 v[212:215], a[244:247], a[104:107], v[212:215]
    ds_read_b128 a[244:247], v224 offset:49664
    v_mfma_f32_16x16x32_bf16 v[212:215], a[248:251], a[116:119], v[212:215]
    ds_read_b128 a[248:251], v224 offset:49728
    v_mfma_f32_16x16x32_bf16 v[208:211], a[48:51], a[252:255], v[208:211]
    s_waitcnt lgkmcnt(4)
    v_mfma_f32_16x16x32_bf16 v[208:211], a[60:63], v[252:255], v[208:211]
    v_mfma_f32_16x16x32_bf16 v[204:207], a[52:55], a[252:255], v[204:207]
    v_mfma_f32_16x16x32_bf16 v[204:207], a[64:67], v[252:255], v[204:207]
    v_mfma_f32_16x16x32_bf16 v[200:203], a[56:59], a[252:255], v[200:203]
    v_mfma_f32_16x16x32_bf16 v[200:203], a[68:71], v[252:255], v[200:203]
    v_mfma_f32_16x16x32_bf16 v[220:223], a[252:255], a[120:123], v[220:223]
    v_mfma_f32_16x16x32_bf16 v[220:223], v[252:255], a[132:135], v[220:223]
    v_mfma_f32_16x16x32_bf16 v[216:219], a[252:255], a[124:127], v[216:219]
    v_mfma_f32_16x16x32_bf16 v[216:219], v[252:255], a[136:139], v[216:219]
    v_cvt_pk_bf16_f32 v18, v208, v209
    v_cvt_pk_bf16_f32 v19, v210, v211
    v_mfma_f32_16x16x32_bf16 v[212:215], a[252:255], a[128:131], v[212:215]
    v_cvt_pk_bf16_f32 v20, v204, v205
    v_cvt_pk_bf16_f32 v21, v206, v207
    v_mfma_f32_16x16x32_bf16 v[212:215], v[252:255], a[140:143], v[212:215]
    v_cvt_pk_bf16_f32 v22, v200, v201
    v_cvt_pk_bf16_f32 v23, v202, v203
    v_mfma_f32_16x16x32_bf16 v[148:151], v[18:21], v[132:135], v[148:151]
    s_waitcnt lgkmcnt(0)
    v_cvt_pk_bf16_f32 v80, v220, v221
    v_cvt_pk_bf16_f32 v81, v222, v223
    v_mfma_f32_16x16x32_bf16 v[208:211], a[0:3], a[236:239], 0
    v_cvt_pk_bf16_f32 v102, v216, v217
    v_cvt_pk_bf16_f32 v103, v218, v219
    v_mfma_f32_16x16x32_bf16 v[208:211], a[12:15], a[240:243], v[208:211]
    v_cvt_pk_bf16_f32 v124, v212, v213
    v_cvt_pk_bf16_f32 v125, v214, v215
    v_mfma_f32_16x16x16_bf16 v[148:151], v[22:23], v[136:137], v[148:151]
    ds_read_b128 a[252:255], v224 offset:49792
    ds_read_b128 v[252:255], v224 offset:49856
    v_mfma_f32_16x16x32_bf16 v[204:207], a[4:7], a[236:239], 0
    v_mfma_f32_16x16x32_bf16 v[204:207], a[16:19], a[240:243], v[204:207]
    v_mfma_f32_16x16x32_bf16 v[200:203], a[8:11], a[236:239], 0
    v_mfma_f32_16x16x32_bf16 v[200:203], a[20:23], a[240:243], v[200:203]
    v_mfma_f32_16x16x32_bf16 v[220:223], a[236:239], a[72:75], 0
    v_mfma_f32_16x16x32_bf16 v[220:223], a[240:243], a[84:87], v[220:223]
    v_mfma_f32_16x16x32_bf16 v[216:219], a[236:239], a[76:79], 0
    v_mfma_f32_16x16x32_bf16 v[216:219], a[240:243], a[88:91], v[216:219]
    v_mfma_f32_16x16x32_bf16 v[212:215], a[236:239], a[80:83], 0
    ds_read_b128 a[236:239], v225 offset:27456
    v_mfma_f32_16x16x32_bf16 v[212:215], a[240:243], a[92:95], v[212:215]
    ds_read_b128 a[240:243], v225 offset:27520
    v_mfma_f32_16x16x32_bf16 v[208:211], a[24:27], a[244:247], v[208:211]
    v_mfma_f32_16x16x32_bf16 v[208:211], a[36:39], a[248:251], v[208:211]
    v_mfma_f32_16x16x32_bf16 v[204:207], a[28:31], a[244:247], v[204:207]
    v_mfma_f32_16x16x32_bf16 v[204:207], a[40:43], a[248:251], v[204:207]
    v_mfma_f32_16x16x32_bf16 v[200:203], a[32:35], a[244:247], v[200:203]
    v_mfma_f32_16x16x32_bf16 v[200:203], a[44:47], a[248:251], v[200:203]
    v_mfma_f32_16x16x32_bf16 v[220:223], a[244:247], a[96:99], v[220:223]
    v_mfma_f32_16x16x32_bf16 v[220:223], a[248:251], a[108:111], v[220:223]
    v_mfma_f32_16x16x32_bf16 v[216:219], a[244:247], a[100:103], v[216:219]
    v_mfma_f32_16x16x32_bf16 v[216:219], a[248:251], a[112:115], v[216:219]
    v_mfma_f32_16x16x32_bf16 v[212:215], a[244:247], a[104:107], v[212:215]
    ds_read_b128 a[244:247], v225 offset:27584
    v_mfma_f32_16x16x32_bf16 v[212:215], a[248:251], a[116:119], v[212:215]
    s_waitcnt lgkmcnt(1)
    ds_read_b128 a[248:251], v225 offset:27648
    v_mfma_f32_16x16x32_bf16 v[208:211], a[48:51], a[252:255], v[208:211]
    v_mfma_f32_16x16x32_bf16 v[208:211], a[60:63], v[252:255], v[208:211]
    v_mfma_f32_16x16x32_bf16 v[204:207], a[52:55], a[252:255], v[204:207]
    v_mfma_f32_16x16x32_bf16 v[204:207], a[64:67], v[252:255], v[204:207]
    v_mfma_f32_16x16x32_bf16 v[200:203], a[56:59], a[252:255], v[200:203]
    v_mfma_f32_16x16x32_bf16 v[200:203], a[68:71], v[252:255], v[200:203]
    v_mfma_f32_16x16x32_bf16 v[220:223], a[252:255], a[120:123], v[220:223]
    v_mfma_f32_16x16x32_bf16 v[220:223], v[252:255], a[132:135], v[220:223]
    v_mfma_f32_16x16x32_bf16 v[216:219], a[252:255], a[124:127], v[216:219]
    v_mfma_f32_16x16x32_bf16 v[216:219], v[252:255], a[136:139], v[216:219]
    v_cvt_pk_bf16_f32 v42, v208, v209
    v_cvt_pk_bf16_f32 v43, v210, v211
    v_mfma_f32_16x16x32_bf16 v[212:215], a[252:255], a[128:131], v[212:215]
    v_cvt_pk_bf16_f32 v44, v204, v205
    v_cvt_pk_bf16_f32 v45, v206, v207
    v_mfma_f32_16x16x32_bf16 v[212:215], v[252:255], a[140:143], v[212:215]
    v_cvt_pk_bf16_f32 v46, v200, v201
    v_cvt_pk_bf16_f32 v47, v202, v203
    v_mfma_f32_16x16x32_bf16 v[144:147], v[42:45], v[132:135], v[144:147]
    v_cvt_pk_bf16_f32 v78, v220, v221
    v_cvt_pk_bf16_f32 v79, v222, v223
    v_mfma_f32_16x16x32_bf16 v[208:211], a[144:147], a[236:239], 0
    v_cvt_pk_bf16_f32 v100, v216, v217
    v_cvt_pk_bf16_f32 v101, v218, v219
    v_mfma_f32_16x16x32_bf16 v[208:211], a[156:159], a[240:243], v[208:211]
    v_cvt_pk_bf16_f32 v122, v212, v213
    v_cvt_pk_bf16_f32 v123, v214, v215
    v_mfma_f32_16x16x16_bf16 v[144:147], v[46:47], v[136:137], v[144:147]
    ds_read_b128 a[252:255], v225 offset:27712
    ds_read_b128 v[252:255], v225 offset:27776
    v_mfma_f32_16x16x32_bf16 v[204:207], a[148:151], a[236:239], 0
    v_mfma_f32_16x16x32_bf16 v[204:207], a[160:163], a[240:243], v[204:207]
    v_mfma_f32_16x16x32_bf16 v[200:203], a[152:155], a[236:239], 0
    ds_read_b128 a[236:239], v225 offset:39872
    v_mfma_f32_16x16x32_bf16 v[200:203], a[164:167], a[240:243], v[200:203]
    s_waitcnt lgkmcnt(3)
    ds_read_b128 a[240:243], v225 offset:39936
    v_max3_f32 v249, v249, v144, v145
    v_mfma_f32_16x16x32_bf16 v[208:211], a[168:171], a[244:247], v[208:211]
    v_max3_f32 v248, v248, v146, v147
    v_max3_f32 v249, v249, v148, v149
    v_mfma_f32_16x16x32_bf16 v[208:211], a[180:183], a[248:251], v[208:211]
    v_max3_f32 v248, v248, v150, v151
    v_max_f32 v248, v248, v249
    v_mfma_f32_16x16x32_bf16 v[204:207], a[172:175], a[244:247], v[204:207]
    v_mov_b32 v249, v248
    v_mfma_f32_16x16x32_bf16 v[204:207], a[184:187], a[248:251], v[204:207]
    v_mfma_f32_16x16x32_bf16 v[200:203], a[176:179], a[244:247], v[200:203]
    s_waitcnt vmcnt(3) lgkmcnt(2)
    ds_read_b128 a[244:247], v225 offset:40000
    s_barrier
    v_mfma_f32_16x16x32_bf16 v[200:203], a[188:191], a[248:251], v[200:203]
    ds_read_b128 a[248:251], v225 offset:40064
    v_mfma_f32_16x16x32_bf16 v[208:211], a[192:195], a[252:255], v[208:211]
    buffer_load_dwordx4 v246, s[4:7], s47 offen lds
    v_mfma_f32_16x16x32_bf16 v[208:211], a[204:207], v[252:255], v[208:211]
    s_add_u32 m0, s42, 0x3c80
    v_permlane16_swap_b32 v248, v249
    v_mfma_f32_16x16x32_bf16 v[204:207], a[196:199], a[252:255], v[204:207]
    v_max_f32 v248, v248, v249
    v_mov_b32 v249, v248
    v_mfma_f32_16x16x32_bf16 v[204:207], a[208:211], v[252:255], v[204:207]
    v_mfma_f32_16x16x32_bf16 v[200:203], a[200:203], a[252:255], v[200:203]
    ds_read_b128 a[252:255], v225 offset:40128
    v_cvt_pk_bf16_f32 v138, v208, v209
    v_mfma_f32_16x16x32_bf16 v[200:203], a[212:215], v[252:255], v[200:203]
    s_waitcnt lgkmcnt(3)
    ds_read_b128 v[252:255], v225 offset:40192
    v_cvt_pk_bf16_f32 v139, v210, v211
    v_mfma_f32_16x16x32_bf16 v[220:223], a[144:147], a[236:239], 0
    v_permlane32_swap_b32 v248, v249
    v_mfma_f32_16x16x32_bf16 v[220:223], a[156:159], a[240:243], v[220:223]
    v_cvt_pk_bf16_f32 v140, v204, v205
    v_cvt_pk_bf16_f32 v141, v206, v207
    v_mfma_f32_16x16x32_bf16 v[216:219], a[148:151], a[236:239], 0
    v_cvt_pk_bf16_f32 v142, v200, v201
    v_cvt_pk_bf16_f32 v143, v202, v203
    v_mfma_f32_16x16x32_bf16 v[216:219], a[160:163], a[240:243], v[216:219]
    buffer_load_dwordx4 v247, s[4:7], s47 offen lds
    v_mfma_f32_16x16x32_bf16 v[212:215], a[152:155], a[236:239], 0
    s_add_u32 m0, s41, 0x5ac0
    ds_read_b128 a[236:239], v239 offset:12288
    v_max_f32 v248, v248, v249
    v_mfma_f32_16x16x32_bf16 v[212:215], a[164:167], a[240:243], v[212:215]
    s_waitcnt lgkmcnt(3)
    ds_read_b128 a[240:243], v240 offset:12288
    v_mul_f32 v236, s37, v248
    v_mfma_f32_16x16x32_bf16 v[220:223], a[168:171], a[244:247], v[220:223]
    v_fma_f32 v152, v152, s37, -v236
    v_fma_f32 v153, v153, s37, -v236
    v_mfma_f32_16x16x32_bf16 v[220:223], a[180:183], a[248:251], v[220:223]
    v_fma_f32 v154, v154, s37, -v236
    v_fma_f32 v155, v155, s37, -v236
    v_mfma_f32_16x16x32_bf16 v[216:219], a[172:175], a[244:247], v[216:219]
    v_exp_f32 v152, v152
    v_mfma_f32_16x16x32_bf16 v[216:219], a[184:187], a[248:251], v[216:219]
    v_exp_f32 v153, v153
    v_mfma_f32_16x16x32_bf16 v[212:215], a[176:179], a[244:247], v[212:215]
    ds_read_b128 a[244:247], v239 offset:13312
    v_cvt_pk_bf16_f32 v176, v152, v153
    v_mfma_f32_16x16x32_bf16 v[212:215], a[188:191], a[248:251], v[212:215]
    s_waitcnt lgkmcnt(3)
    buffer_load_dwordx4 v246, s[4:7], s48 offen lds
    v_mfma_f32_16x16x32_bf16 v[220:223], a[192:195], a[252:255], v[220:223]
    s_add_u32 m0, s42, 0x5ac0
    ds_read_b128 a[248:251], v240 offset:13312
    v_cndmask_b32 v246, v245, v243, vcc
    v_mfma_f32_16x16x32_bf16 v[220:223], a[204:207], v[252:255], v[220:223]
    v_exp_f32 v154, v154
    v_mfma_f32_16x16x32_bf16 v[216:219], a[196:199], a[252:255], v[216:219]
    v_exp_f32 v155, v155
    v_mfma_f32_16x16x32_bf16 v[216:219], a[208:211], v[252:255], v[216:219]
    v_cvt_pk_bf16_f32 v177, v154, v155
    v_fma_f32 v156, v156, s37, -v236
    v_mfma_f32_16x16x32_bf16 v[212:215], a[200:203], a[252:255], v[212:215]
    ds_read_b128 a[252:255], v241 offset:12288
    v_cvt_pk_bf16_f32 v132, v220, v221
    v_mfma_f32_16x16x32_bf16 v[212:215], a[212:215], v[252:255], v[212:215]
    s_waitcnt lgkmcnt(3)
    ds_read_b128 v[252:255], v241 offset:12800
    v_cvt_pk_bf16_f32 v133, v222, v223
    v_mfma_f32_16x16x32_bf16 v[208:211], a[220:223], a[236:239], 0
    v_cvt_pk_bf16_f32 v134, v216, v217
    v_cvt_pk_bf16_f32 v135, v218, v219
    v_mfma_f32_16x16x32_bf16 v[200:203], a[220:223], a[240:243], 0
    buffer_load_dwordx4 v247, s[4:7], s48 offen lds
    v_mfma_f32_16x16x32_bf16 v[204:207], a[224:227], a[236:239], 0
    v_cvt_pk_bf16_f32 v136, v212, v213
    v_cvt_pk_bf16_f32 v137, v214, v215
    v_mfma_f32_16x16x32_bf16 v[220:223], a[224:227], a[240:243], 0
    ds_read_b128 a[240:243], v242 offset:12800
    ds_read_b128 v[152:155], v230 offset:640
    v_mfma_f32_16x16x32_bf16 v[216:219], a[228:231], a[236:239], 0
    v_bfrev_b32 v247, 1
    v_fma_f32 v157, v157, s37, -v236
    v_mfma_f32_16x16x32_bf16 v[212:215], a[232:235], a[236:239], 0
    s_waitcnt lgkmcnt(3)
    ds_read_b128 a[236:239], v242 offset:12288
    v_fma_f32 v158, v158, s37, -v236
    v_fma_f32 v159, v159, s37, -v236
    v_exp_f32 v156, v156
    v_mfma_f32_16x16x32_bf16 v[208:211], a[252:255], a[244:247], v[208:211]
    v_exp_f32 v157, v157
    v_mfma_f32_16x16x32_bf16 v[200:203], a[252:255], a[248:251], v[200:203]
    s_waitcnt lgkmcnt(3)
    ds_read_b128 a[252:255], v241 offset:24576
    v_cvt_pk_bf16_f32 v178, v156, v157
    v_mfma_f32_16x16x32_bf16 v[204:207], v[252:255], a[244:247], v[204:207]
    v_exp_f32 v158, v158
    v_mfma_f32_16x16x32_bf16 v[220:223], v[252:255], a[248:251], v[220:223]
    s_waitcnt lgkmcnt(3)
    ds_read_b128 a[248:251], v240 offset:14336
    ds_read_b128 v[252:255], v241 offset:25088
    v_exp_f32 v159, v159
    v_fma_f32 v160, v160, s37, -v236
    v_mfma_f32_16x16x32_bf16 v[212:215], a[240:243], a[244:247], v[212:215]
    s_waitcnt lgkmcnt(4)
    ds_read_b128 a[240:243], v242 offset:25088
    v_cvt_pk_bf16_f32 v179, v158, v159
    ds_read_b128 v[156:159], v230 offset:1280
    v_mfma_f32_16x16x32_bf16 v[152:155], v[24:27], v[138:141], v[152:155]
    v_fma_f32 v161, v161, s37, -v236
    v_fma_f32 v162, v162, s37, -v236
    v_mfma_f32_16x16x32_bf16 v[196:199], a[216:219], v[176:179], 0
    v_fma_f32 v163, v163, s37, -v236
    v_fma_f32 v164, v164, s37, -v236
    v_mfma_f32_16x16x32_bf16 v[184:187], v[66:69], v[176:179], 0
    v_exp_f32 v160, v160
    v_mfma_f32_16x16x32_bf16 v[188:191], v[88:91], v[176:179], 0
    v_exp_f32 v161, v161
    v_mfma_f32_16x16x32_bf16 v[192:195], v[110:113], v[176:179], 0
    v_exp_f32 v162, v162
    v_mfma_f32_16x16x16_bf16 v[152:155], v[28:29], v[142:143], v[152:155]
    s_waitcnt lgkmcnt(4)
    v_exp_f32 v163, v163
    v_mfma_f32_16x16x32_bf16 v[216:219], a[236:239], a[244:247], v[216:219]
    s_waitcnt lgkmcnt(3)
    ds_read_b128 a[244:247], v239 offset:14336
    ds_read_b128 a[236:239], v242 offset:24576
    v_mfma_f32_16x16x32_bf16 v[200:203], a[252:255], a[248:251], v[200:203]
    s_waitcnt lgkmcnt(4)
    v_cvt_pk_bf16_f32 v180, v160, v161
    v_cvt_pk_bf16_f32 v181, v162, v163
    v_mfma_f32_16x16x32_bf16 v[220:223], v[252:255], a[248:251], v[220:223]
    s_waitcnt lgkmcnt(2)
    ds_read_b128 a[248:251], v240 offset:15360
    ds_read_b128 v[160:163], v230 offset:1920
    v_mfma_f32_16x16x32_bf16 v[156:159], v[30:33], v[138:141], v[156:159]
    v_fma_f32 v165, v165, s37, -v236
    v_fma_f32 v166, v166, s37, -v236
    v_fma_f32 v167, v167, s37, -v236
    v_exp_f32 v164, v164
    v_exp_f32 v165, v165
    v_exp_f32 v166, v166
    v_mfma_f32_16x16x16_bf16 v[156:159], v[34:35], v[142:143], v[156:159]
    v_exp_f32 v167, v167
    v_cvt_pk_bf16_f32 v182, v164, v165
    v_cvt_pk_bf16_f32 v183, v166, v167
    ds_read_b128 v[164:167], v230 offset:2560
    v_fma_f32 v168, v168, s37, -v236
    v_mfma_f32_16x16x32_bf16 v[196:199], a[216:219], v[180:183], v[196:199]
    v_fma_f32 v169, v169, s37, -v236
    v_fma_f32 v170, v170, s37, -v236
    v_mfma_f32_16x16x32_bf16 v[184:187], v[70:73], v[180:183], v[184:187]
    v_fma_f32 v171, v171, s37, -v236
    v_fma_f32 v172, v172, s37, -v236
    v_mfma_f32_16x16x32_bf16 v[188:191], v[92:95], v[180:183], v[188:191]
    v_exp_f32 v168, v168
    v_mfma_f32_16x16x32_bf16 v[192:195], v[114:117], v[180:183], v[192:195]
    s_waitcnt lgkmcnt(1)
    v_exp_f32 v169, v169
    v_mfma_f32_16x16x32_bf16 v[160:163], v[36:39], v[138:141], v[160:163]
    v_exp_f32 v170, v170
    v_mfma_f32_16x16x32_bf16 v[208:211], a[252:255], a[244:247], v[208:211]
    ds_read_b128 a[252:255], v241 offset:36864
    v_cvt_pk_bf16_f32 v176, v168, v169
    v_mfma_f32_16x16x32_bf16 v[204:207], v[252:255], a[244:247], v[204:207]
    ds_read_b128 v[252:255], v241 offset:37376
    v_fma_f32 v173, v173, s37, -v236
    v_mfma_f32_16x16x16_bf16 v[160:163], v[40:41], v[142:143], v[160:163]
    s_waitcnt lgkmcnt(2)
    v_exp_f32 v171, v171
    v_mfma_f32_16x16x32_bf16 v[164:167], v[42:45], v[138:141], v[164:167]
    v_cvt_pk_bf16_f32 v177, v170, v171
    v_fma_f32 v174, v174, s37, -v236
    v_mfma_f32_16x16x32_bf16 v[216:219], a[236:239], a[244:247], v[216:219]
    ds_read_b128 a[236:239], v242 offset:36864
    ds_read_b128 v[168:171], v235
    v_mfma_f32_16x16x32_bf16 v[212:215], a[240:243], a[244:247], v[212:215]
    v_mad_u32_u24 v235, v234, s40, v229
    v_mad_u32_u24 v234, v234, s40, v228
    v_mfma_f32_16x16x16_bf16 v[164:167], v[46:47], v[142:143], v[164:167]
    s_waitcnt lgkmcnt(3)
    ds_read_b128 a[244:247], v239 offset:15360
    v_fma_f32 v175, v175, s37, -v236
    ds_read_b128 a[240:243], v242 offset:37376
    v_exp_f32 v172, v172
    v_exp_f32 v173, v173
    v_mfma_f32_16x16x32_bf16 v[200:203], a[252:255], a[248:251], v[200:203]
    s_waitcnt lgkmcnt(4)
    v_exp_f32 v174, v174
    v_mfma_f32_16x16x32_bf16 v[220:223], v[252:255], a[248:251], v[220:223]
    ds_read_b128 a[248:251], v240 offset:16384
    v_exp_f32 v175, v175
    v_cvt_pk_bf16_f32 v178, v172, v173
    v_cvt_pk_bf16_f32 v179, v174, v175
    ds_read_b128 v[172:175], v250
    v_bfe_u32 v250, s74, v232, 4
    v_mfma_f32_16x16x32_bf16 v[196:199], a[216:219], v[176:179], v[196:199]
    v_fma_f32 v144, v144, s37, -v236
    v_fma_f32 v145, v145, s37, -v236
    v_mfma_f32_16x16x32_bf16 v[184:187], v[74:77], v[176:179], v[184:187]
    v_fma_f32 v146, v146, s37, -v236
    v_fma_f32 v147, v147, s37, -v236
    v_mfma_f32_16x16x32_bf16 v[188:191], v[96:99], v[176:179], v[188:191]
    v_exp_f32 v144, v144
    v_mfma_f32_16x16x32_bf16 v[192:195], v[118:121], v[176:179], v[192:195]
    s_waitcnt lgkmcnt(4)
    v_exp_f32 v145, v145
    v_mfma_f32_16x16x32_bf16 v[168:171], v[60:63], v[138:141], v[168:171]
    s_waitcnt lgkmcnt(3)
    v_exp_f32 v146, v146
    v_mfma_f32_16x16x32_bf16 v[208:211], a[252:255], a[244:247], v[208:211]
    ds_read_b128 a[252:255], v241 offset:49152
    v_cvt_pk_bf16_f32 v180, v144, v145
    v_mfma_f32_16x16x32_bf16 v[204:207], v[252:255], a[244:247], v[204:207]
    ds_read_b128 v[252:255], v241 offset:49664
    v_fma_f32 v148, v148, s37, -v236
    v_mfma_f32_16x16x16_bf16 v[168:171], v[64:65], v[142:143], v[168:171]
    s_waitcnt lgkmcnt(2)
    v_exp_f32 v147, v147
    v_mfma_f32_16x16x32_bf16 v[172:175], v[48:51], v[138:141], v[172:175]
    v_cvt_pk_bf16_f32 v181, v146, v147
    v_fma_f32 v149, v149, s37, -v236
    v_mfma_f32_16x16x32_bf16 v[216:219], a[236:239], a[244:247], v[216:219]
    ds_read_b128 a[236:239], v242 offset:49152
    ds_read_b128 v[144:147], v235
    v_mfma_f32_16x16x32_bf16 v[212:215], a[240:243], a[244:247], v[212:215]
    v_bfe_u32 v235, s74, v232, 4
    v_mad_u32_u24 v235, v235, s40, v230
    v_mfma_f32_16x16x16_bf16 v[172:175], v[52:53], v[142:143], v[172:175]
    s_waitcnt lgkmcnt(3)
    ds_read_b128 a[244:247], v239 offset:16384
    v_fma_f32 v150, v150, s37, -v236
    ds_read_b128 a[240:243], v242 offset:49664
    v_fma_f32 v151, v151, s37, -v236
    v_exp_f32 v148, v148
    v_mfma_f32_16x16x32_bf16 v[200:203], a[252:255], a[248:251], v[200:203]
    s_waitcnt lgkmcnt(4)
    v_exp_f32 v149, v149
    v_mfma_f32_16x16x32_bf16 v[220:223], v[252:255], a[248:251], v[220:223]
    ds_read_b128 a[248:251], v240 offset:17408
    v_exp_f32 v150, v150
    v_exp_f32 v151, v151
    v_cvt_pk_bf16_f32 v182, v148, v149
    v_cvt_pk_bf16_f32 v183, v150, v151
    ds_read_b128 v[148:151], v234
    v_mad_u32_u24 v234, v250, s40, v228
    v_mfma_f32_16x16x32_bf16 v[196:199], a[216:219], v[180:183], v[196:199]
    v_mad_u32_u24 v250, v250, s40, v229
    v_max3_f32 v248, v152, v153, v154
    v_mfma_f32_16x16x32_bf16 v[184:187], v[78:81], v[180:183], v[184:187]
    v_max3_f32 v249, v155, v156, v157
    v_max3_f32 v248, v248, v158, v159
    v_mfma_f32_16x16x32_bf16 v[188:191], v[100:103], v[180:183], v[188:191]
    v_max3_f32 v249, v249, v160, v161
    v_max3_f32 v248, v248, v162, v163
    v_mfma_f32_16x16x32_bf16 v[192:195], v[122:125], v[180:183], v[192:195]
    s_waitcnt lgkmcnt(4)
    v_rcp_f32 v197, v196
    v_mfma_f32_16x16x32_bf16 v[144:147], v[30:33], v[132:135], v[144:147]
    s_waitcnt lgkmcnt(3)
    v_mul_f32 v184, v184, v197
    v_mul_f32 v185, v185, v197
    v_mfma_f32_16x16x32_bf16 v[208:211], a[252:255], a[244:247], v[208:211]
    ds_read_b128 a[252:255], v241 offset:61440
    v_cvt_pk_bf16_f32 v184, v184, v185
    v_mfma_f32_16x16x32_bf16 v[204:207], v[252:255], a[244:247], v[204:207]
    ds_read_b128 v[252:255], v241 offset:61952
    v_mul_f32 v186, v186, v197
    v_mfma_f32_16x16x16_bf16 v[144:147], v[34:35], v[136:137], v[144:147]
    s_waitcnt lgkmcnt(2)
    v_mul_f32 v187, v187, v197
    v_cvt_pk_bf16_f32 v185, v186, v187
    v_mfma_f32_16x16x32_bf16 v[148:151], v[6:9], v[132:135], v[148:151]
    v_mul_f32 v188, v188, v197
    v_mul_f32 v189, v189, v197
    v_mfma_f32_16x16x32_bf16 v[216:219], a[236:239], a[244:247], v[216:219]
    ds_read_b128 a[236:239], v242 offset:61440
    v_cvt_pk_bf16_f32 v186, v188, v189
    v_mfma_f32_16x16x32_bf16 v[212:215], a[240:243], a[244:247], v[212:215]
    ds_read_b128 a[244:247], v239 offset:17408
    ds_read_b128 a[240:243], v242 offset:61952
    v_mfma_f32_16x16x16_bf16 v[148:151], v[10:11], v[136:137], v[148:151]
    s_waitcnt lgkmcnt(4)
    v_mul_f32 v190, v190, v197
    v_mul_f32 v191, v191, v197
    v_cvt_pk_bf16_f32 v187, v190, v191
    v_mul_f32 v192, v192, v197
    v_mul_f32 v193, v193, v197
    v_cvt_pk_bf16_f32 v188, v192, v193
    v_mul_f32 v194, v194, v197
    v_mul_f32 v195, v195, v197
    v_mfma_f32_16x16x32_bf16 v[200:203], a[252:255], a[248:251], v[200:203]
    s_waitcnt lgkmcnt(3)
    v_cvt_pk_bf16_f32 v189, v194, v195
    v_max3_f32 v249, v249, v164, v165
    v_mfma_f32_16x16x32_bf16 v[220:223], v[252:255], a[248:251], v[220:223]
    s_waitcnt lgkmcnt(1)
    ds_read_b128 a[248:251], v224 offset:64
    ds_write_b128 v237, v[184:187]
    ds_write_b64 v238, v[188:189]
    v_max3_f32 v248, v248, v166, v167
    v_max3_f32 v249, v249, v168, v169
    v_cvt_pk_bf16_f32 v200, v200, v201
    v_cvt_pk_bf16_f32 v201, v202, v203
    v_max3_f32 v248, v248, v170, v171
    v_mfma_f32_16x16x32_bf16 v[208:211], a[252:255], a[244:247], v[208:211]
    v_cvt_pk_bf16_f32 v202, v220, v221
    v_cvt_pk_bf16_f32 v203, v222, v223
    v_mfma_f32_16x16x32_bf16 v[204:207], v[252:255], a[244:247], v[204:207]
    buffer_store_dwordx4 v[200:203], v245, s[20:23], s58 offen sc0 sc1
    v_mfma_f32_16x16x32_bf16 v[216:219], a[236:239], a[244:247], v[216:219]
    s_waitcnt lgkmcnt(3)
    ds_read_b128 a[252:255], v224 offset:128
    ds_read_b128 v[252:255], v224 offset:192
    v_mfma_f32_16x16x32_bf16 v[212:215], a[240:243], a[244:247], v[212:215]
    ds_read_b128 a[244:247], v224
    v_cvt_pk_bf16_f32 v208, v208, v209
    v_cvt_pk_bf16_f32 v209, v210, v211
    v_cvt_pk_bf16_f32 v210, v204, v205
    ds_read_b128 a[236:239], v224 offset:256
    v_cvt_pk_bf16_f32 v211, v206, v207
    ds_read_b128 a[240:243], v224 offset:320
    v_cvt_pk_bf16_f32 v216, v216, v217
    v_cvt_pk_bf16_f32 v217, v218, v219
    v_cvt_pk_bf16_f32 v218, v212, v213
    v_cvt_pk_bf16_f32 v219, v214, v215
    v_max3_f32 v249, v249, v172, v173
    v_max3_f32 v248, v248, v174, v175
    v_max_f32 v248, v248, v249
    v_mov_b32 v249, v248
    s_nop 1
    v_permlane16_swap_b32 v248, v249
    v_max_f32 v248, v248, v249
    v_mov_b32 v249, v248
    s_nop 1
    v_permlane32_swap_b32 v248, v249
    v_max_f32 v248, v248, v249
    v_mul_f32 v236, s37, v248
    v_fma_f32 v152, v152, s37, -v236
    v_fma_f32 v153, v153, s37, -v236
    v_fma_f32 v154, v154, s37, -v236
    v_fma_f32 v155, v155, s37, -v236
    v_exp_f32 v152, v152
    s_waitcnt lgkmcnt(2)
    v_mfma_f32_16x16x32_bf16 v[204:207], a[4:7], a[244:247], 0
    buffer_store_dwordx4 v[208:211], v243, s[20:23], s58 offen sc0 sc1
    v_mfma_f32_16x16x32_bf16 v[204:207], a[16:19], a[248:251], v[204:207]
    v_exp_f32 v153, v153
    v_mfma_f32_16x16x32_bf16 v[208:211], a[0:3], a[244:247], 0
    v_exp_f32 v154, v154
    v_mfma_f32_16x16x32_bf16 v[208:211], a[12:15], a[248:251], v[208:211]
    v_exp_f32 v155, v155
    v_mfma_f32_16x16x32_bf16 v[200:203], a[8:11], a[244:247], 0
    v_cvt_pk_bf16_f32 v176, v152, v153
    v_cvt_pk_bf16_f32 v177, v154, v155
    v_mfma_f32_16x16x32_bf16 v[200:203], a[20:23], a[248:251], v[200:203]
    ds_read_b128 v[152:155], v228 offset:1280
    v_fma_f32 v156, v156, s37, -v236
    v_mfma_f32_16x16x32_bf16 v[220:223], a[244:247], a[72:75], 0
    v_fma_f32 v157, v157, s37, -v236
    v_fma_f32 v158, v158, s37, -v236
    v_mfma_f32_16x16x32_bf16 v[220:223], a[248:251], a[84:87], v[220:223]
    v_fma_f32 v159, v159, s37, -v236
    v_fma_f32 v160, v160, s37, -v236
    v_mfma_f32_16x16x32_bf16 v[212:215], a[244:247], a[80:83], 0
    v_exp_f32 v156, v156
    v_mfma_f32_16x16x32_bf16 v[212:215], a[248:251], a[92:95], v[212:215]
    v_exp_f32 v157, v157
    v_mfma_f32_16x16x32_bf16 v[208:211], a[24:27], a[252:255], v[208:211]
    v_exp_f32 v158, v158
    v_mfma_f32_16x16x32_bf16 v[208:211], a[36:39], v[252:255], v[208:211]
    v_exp_f32 v159, v159
    v_mfma_f32_16x16x32_bf16 v[204:207], a[28:31], a[252:255], v[204:207]
    s_waitcnt lgkmcnt(0)
    buffer_store_dwordx4 v[216:219], v244, s[20:23], s58 offen sc0 sc1
    v_mfma_f32_16x16x32_bf16 v[204:207], a[40:43], v[252:255], v[204:207]
    s_add_u32 s58, s51, 0x150000
    v_cvt_pk_bf16_f32 v178, v156, v157
    v_cvt_pk_bf16_f32 v179, v158, v159
    v_mfma_f32_16x16x32_bf16 v[152:155], v[12:15], v[132:135], v[152:155]
    ds_read_b128 v[156:159], v229 offset:1280
    v_fma_f32 v161, v161, s37, -v236
    v_mfma_f32_16x16x32_bf16 v[196:199], a[216:219], v[176:179], 0
    v_fma_f32 v162, v162, s37, -v236
    v_fma_f32 v163, v163, s37, -v236
    v_mfma_f32_16x16x32_bf16 v[184:187], v[68:71], v[176:179], 0
    v_exp_f32 v160, v160
    v_mfma_f32_16x16x32_bf16 v[188:191], v[90:93], v[176:179], 0
    v_exp_f32 v161, v161
    v_mfma_f32_16x16x32_bf16 v[192:195], v[112:115], v[176:179], 0
    v_exp_f32 v162, v162
    v_mfma_f32_16x16x16_bf16 v[152:155], v[16:17], v[136:137], v[152:155]
    v_exp_f32 v163, v163
    v_mfma_f32_16x16x32_bf16 v[216:219], a[244:247], a[76:79], 0
    ds_read_b128 a[244:247], v224 offset:3072
    v_cvt_pk_bf16_f32 v180, v160, v161
    v_mfma_f32_16x16x32_bf16 v[216:219], a[248:251], a[88:91], v[216:219]
    ds_read_b128 a[248:251], v224 offset:3136
    v_cvt_pk_bf16_f32 v181, v162, v163
    v_mfma_f32_16x16x32_bf16 v[200:203], a[32:35], a[252:255], v[200:203]
    ds_read_b128 v[160:163], v229 offset:1920
    v_fma_f32 v164, v164, s37, -v236
    v_mfma_f32_16x16x32_bf16 v[200:203], a[44:47], v[252:255], v[200:203]
    s_waitcnt lgkmcnt(3)
    v_fma_f32 v165, v165, s37, -v236
    v_fma_f32 v166, v166, s37, -v236
    v_mfma_f32_16x16x32_bf16 v[156:159], v[36:39], v[132:135], v[156:159]
    v_fma_f32 v167, v167, s37, -v236
    v_fma_f32 v168, v168, s37, -v236
    v_mfma_f32_16x16x32_bf16 v[220:223], a[252:255], a[96:99], v[220:223]
    v_exp_f32 v164, v164
    v_mfma_f32_16x16x32_bf16 v[220:223], v[252:255], a[108:111], v[220:223]
    v_exp_f32 v165, v165
    v_mfma_f32_16x16x16_bf16 v[156:159], v[40:41], v[136:137], v[156:159]
    v_exp_f32 v166, v166
    v_mfma_f32_16x16x32_bf16 v[216:219], a[252:255], a[100:103], v[216:219]
    v_exp_f32 v167, v167
    v_mfma_f32_16x16x32_bf16 v[216:219], v[252:255], a[112:115], v[216:219]
    v_cvt_pk_bf16_f32 v182, v164, v165
    v_cvt_pk_bf16_f32 v183, v166, v167
    v_mfma_f32_16x16x32_bf16 v[212:215], a[252:255], a[104:107], v[212:215]
    ds_read_b128 a[252:255], v224 offset:3200
    ds_read_b128 v[164:167], v228 offset:1920
    v_mfma_f32_16x16x32_bf16 v[212:215], v[252:255], a[116:119], v[212:215]
    v_fma_f32 v169, v169, s37, -v236
    v_fma_f32 v170, v170, s37, -v236
    v_mfma_f32_16x16x32_bf16 v[196:199], a[216:219], v[180:183], v[196:199]
    ds_read_b128 v[252:255], v224 offset:3264
    v_fma_f32 v171, v171, s37, -v236
    v_mfma_f32_16x16x32_bf16 v[184:187], v[76:79], v[180:183], v[184:187]
    v_exp_f32 v168, v168
    v_mfma_f32_16x16x32_bf16 v[188:191], v[98:101], v[180:183], v[188:191]
    v_exp_f32 v169, v169
    v_mfma_f32_16x16x32_bf16 v[192:195], v[120:123], v[180:183], v[192:195]
    s_waitcnt lgkmcnt(3)
    v_exp_f32 v170, v170
    v_mfma_f32_16x16x32_bf16 v[160:163], v[42:45], v[132:135], v[160:163]
    v_exp_f32 v171, v171
    v_mfma_f32_16x16x32_bf16 v[208:211], a[48:51], a[236:239], v[208:211]
    v_cvt_pk_bf16_f32 v176, v168, v169
    v_cvt_pk_bf16_f32 v177, v170, v171
    v_mfma_f32_16x16x32_bf16 v[208:211], a[60:63], a[240:243], v[208:211]
    ds_read_b128 v[168:171], v234
    v_bfe_u32 v234, s67, v233, 4
    v_mfma_f32_16x16x16_bf16 v[196:199], a[216:217], v[176:177], v[196:199]
    v_mad_u32_u24 v234, v234, s40, v231
    v_fma_f32 v172, v172, s37, -v236
    v_mfma_f32_16x16x16_bf16 v[184:187], v[86:87], v[176:177], v[184:187]
    v_fma_f32 v173, v173, s37, -v236
    v_fma_f32 v174, v174, s37, -v236
    v_mfma_f32_16x16x16_bf16 v[188:191], v[108:109], v[176:177], v[188:191]
    v_cvt_pk_bf16_f32 v0, v208, v209
    v_cvt_pk_bf16_f32 v1, v210, v211
    v_mfma_f32_16x16x16_bf16 v[192:195], v[130:131], v[176:177], v[192:195]
    v_fma_f32 v175, v175, s37, -v236
    v_max3_f32 v248, v144, v145, v146
    v_mfma_f32_16x16x16_bf16 v[160:163], v[46:47], v[136:137], v[160:163]
    s_waitcnt lgkmcnt(1)
    v_exp_f32 v172, v172
    v_mfma_f32_16x16x32_bf16 v[164:167], v[18:21], v[132:135], v[164:167]
    v_exp_f32 v173, v173
    v_mfma_f32_16x16x32_bf16 v[204:207], a[52:55], a[236:239], v[204:207]
    v_exp_f32 v174, v174
    v_mfma_f32_16x16x32_bf16 v[204:207], a[64:67], a[240:243], v[204:207]
    v_exp_f32 v175, v175
    v_mfma_f32_16x16x32_bf16 v[200:203], a[56:59], a[236:239], v[200:203]
    v_cvt_pk_bf16_f32 v180, v172, v173
    v_cvt_pk_bf16_f32 v181, v174, v175
    v_mfma_f32_16x16x32_bf16 v[200:203], a[68:71], a[240:243], v[200:203]
    ds_read_b128 v[172:175], v250
    v_bfe_u32 v250, s73, v232, 4
    v_mfma_f32_16x16x16_bf16 v[196:199], a[216:217], v[180:181], v[196:199]
    v_cvt_pk_bf16_f32 v2, v204, v205
    v_cvt_pk_bf16_f32 v3, v206, v207
    v_mfma_f32_16x16x16_bf16 v[184:187], v[82:83], v[180:181], v[184:187]
    v_mad_u32_u24 v250, v250, s40, v230
    v_max3_f32 v249, v147, v148, v149
    v_mfma_f32_16x16x16_bf16 v[188:191], v[104:105], v[180:181], v[188:191]
    v_cvt_pk_bf16_f32 v4, v200, v201
    v_cvt_pk_bf16_f32 v5, v202, v203
    v_mfma_f32_16x16x16_bf16 v[192:195], v[126:127], v[180:181], v[192:195]
    v_rcp_f32 v197, v196
    v_mfma_f32_16x16x16_bf16 v[164:167], v[22:23], v[136:137], v[164:167]
    s_waitcnt lgkmcnt(1)
    v_mul_f32 v184, v184, v197
    v_mul_f32 v185, v185, v197
    v_mfma_f32_16x16x32_bf16 v[168:171], v[0:3], v[132:135], v[168:171]
    v_cvt_pk_bf16_f32 v184, v184, v185
    v_mul_f32 v186, v186, v197
    v_mfma_f32_16x16x32_bf16 v[220:223], a[236:239], a[120:123], v[220:223]
    v_mul_f32 v187, v187, v197
    v_cvt_pk_bf16_f32 v185, v186, v187
    v_mfma_f32_16x16x32_bf16 v[220:223], a[240:243], a[132:135], v[220:223]
    v_mul_f32 v188, v188, v197
    v_mul_f32 v189, v189, v197
    v_mfma_f32_16x16x16_bf16 v[168:171], v[4:5], v[136:137], v[168:171]
    v_cvt_pk_bf16_f32 v186, v188, v189
    v_mul_f32 v190, v190, v197
    v_mfma_f32_16x16x32_bf16 v[216:219], a[236:239], a[124:127], v[216:219]
    v_mul_f32 v191, v191, v197
    v_cvt_pk_bf16_f32 v187, v190, v191
    v_mfma_f32_16x16x32_bf16 v[216:219], a[240:243], a[136:139], v[216:219]
    v_cvt_pk_bf16_f32 v66, v220, v221
    v_cvt_pk_bf16_f32 v67, v222, v223
    v_mfma_f32_16x16x32_bf16 v[212:215], a[236:239], a[128:131], v[212:215]
    ds_read_b128 a[236:239], v224 offset:3328
    v_mul_f32 v192, v192, v197
    v_mfma_f32_16x16x32_bf16 v[212:215], a[240:243], a[140:143], v[212:215]
    ds_read_b128 a[240:243], v224 offset:3392
    v_mul_f32 v193, v193, v197
    v_mfma_f32_16x16x32_bf16 v[208:211], a[0:3], a[244:247], 0
    v_cvt_pk_bf16_f32 v88, v216, v217
    v_cvt_pk_bf16_f32 v89, v218, v219
    v_mfma_f32_16x16x32_bf16 v[208:211], a[12:15], a[248:251], v[208:211]
    v_cvt_pk_bf16_f32 v188, v192, v193
    v_mul_f32 v194, v194, v197
    v_mfma_f32_16x16x32_bf16 v[204:207], a[4:7], a[244:247], 0
    v_cvt_pk_bf16_f32 v110, v212, v213
    v_cvt_pk_bf16_f32 v111, v214, v215
    v_mfma_f32_16x16x32_bf16 v[204:207], a[16:19], a[248:251], v[204:207]
    v_mul_f32 v195, v195, v197
    v_cvt_pk_bf16_f32 v189, v194, v195
    v_mfma_f32_16x16x32_bf16 v[200:203], a[8:11], a[244:247], 0
    ds_write_b128 v237, v[184:187] offset:6144
    v_mfma_f32_16x16x32_bf16 v[200:203], a[20:23], a[248:251], v[200:203]
    ds_write_b64 v238, v[188:189] offset:6144
    v_mfma_f32_16x16x32_bf16 v[220:223], a[244:247], a[72:75], 0
    v_max3_f32 v248, v248, v150, v151
    v_max3_f32 v249, v249, v152, v153
    v_mfma_f32_16x16x32_bf16 v[220:223], a[248:251], a[84:87], v[220:223]
    v_max3_f32 v248, v248, v154, v155
    v_max3_f32 v249, v249, v156, v157
    v_mfma_f32_16x16x32_bf16 v[216:219], a[244:247], a[76:79], 0
    v_max3_f32 v248, v248, v158, v159
    v_max3_f32 v249, v249, v160, v161
    v_mfma_f32_16x16x32_bf16 v[216:219], a[248:251], a[88:91], v[216:219]
    v_max3_f32 v248, v248, v162, v163
    v_max3_f32 v249, v249, v164, v165
    v_mfma_f32_16x16x32_bf16 v[212:215], a[244:247], a[80:83], 0
    ds_read_b128 a[244:247], v225 offset:42944
    v_max3_f32 v248, v248, v166, v167
    v_mfma_f32_16x16x32_bf16 v[212:215], a[248:251], a[92:95], v[212:215]
    ds_read_b128 a[248:251], v225 offset:43008
    v_max3_f32 v249, v249, v168, v169
    v_mfma_f32_16x16x32_bf16 v[208:211], a[24:27], a[252:255], v[208:211]
    v_max3_f32 v248, v248, v170, v171
    v_mfma_f32_16x16x32_bf16 v[208:211], a[36:39], v[252:255], v[208:211]
    v_mfma_f32_16x16x32_bf16 v[204:207], a[28:31], a[252:255], v[204:207]
    v_mfma_f32_16x16x32_bf16 v[204:207], a[40:43], v[252:255], v[204:207]
    s_waitcnt vmcnt(3) lgkmcnt(2)
    v_mfma_f32_16x16x32_bf16 v[200:203], a[32:35], a[252:255], v[200:203]
    s_barrier
    v_mfma_f32_16x16x32_bf16 v[200:203], a[44:47], v[252:255], v[200:203]
    v_mfma_f32_16x16x32_bf16 v[220:223], a[252:255], a[96:99], v[220:223]
    v_mfma_f32_16x16x32_bf16 v[220:223], v[252:255], a[108:111], v[220:223]
    v_mfma_f32_16x16x32_bf16 v[216:219], a[252:255], a[100:103], v[216:219]
    v_mfma_f32_16x16x32_bf16 v[216:219], v[252:255], a[112:115], v[216:219]
    v_mfma_f32_16x16x32_bf16 v[212:215], a[252:255], a[104:107], v[212:215]
    ds_read_b128 a[252:255], v225 offset:43072
    v_mfma_f32_16x16x32_bf16 v[212:215], v[252:255], a[116:119], v[212:215]
    ds_read_b128 v[252:255], v225 offset:43136
    v_mfma_f32_16x16x32_bf16 v[208:211], a[48:51], a[236:239], v[208:211]
    v_mfma_f32_16x16x32_bf16 v[208:211], a[60:63], a[240:243], v[208:211]
    v_mfma_f32_16x16x32_bf16 v[204:207], a[52:55], a[236:239], v[204:207]
    v_mfma_f32_16x16x32_bf16 v[204:207], a[64:67], a[240:243], v[204:207]
    v_mfma_f32_16x16x32_bf16 v[200:203], a[56:59], a[236:239], v[200:203]
    v_mfma_f32_16x16x32_bf16 v[200:203], a[68:71], a[240:243], v[200:203]
    v_mfma_f32_16x16x32_bf16 v[220:223], a[236:239], a[120:123], v[220:223]
    v_mfma_f32_16x16x32_bf16 v[220:223], a[240:243], a[132:135], v[220:223]
    v_mfma_f32_16x16x32_bf16 v[216:219], a[236:239], a[124:127], v[216:219]
    v_mfma_f32_16x16x32_bf16 v[216:219], a[240:243], a[136:139], v[216:219]
    v_cvt_pk_bf16_f32 v24, v208, v209
    v_cvt_pk_bf16_f32 v25, v210, v211
    v_mfma_f32_16x16x32_bf16 v[212:215], a[236:239], a[128:131], v[212:215]
    v_cvt_pk_bf16_f32 v26, v204, v205
    v_cvt_pk_bf16_f32 v27, v206, v207
    v_mfma_f32_16x16x32_bf16 v[212:215], a[240:243], a[140:143], v[212:215]
    v_cvt_pk_bf16_f32 v28, v200, v201
    v_cvt_pk_bf16_f32 v29, v202, v203
    v_mfma_f32_16x16x32_bf16 v[172:175], v[24:27], v[132:135], v[172:175]
    s_waitcnt lgkmcnt(0)
    v_cvt_pk_bf16_f32 v68, v220, v221
    v_cvt_pk_bf16_f32 v69, v222, v223
    v_mfma_f32_16x16x32_bf16 v[208:211], a[144:147], a[244:247], 0
    v_cvt_pk_bf16_f32 v90, v216, v217
    v_cvt_pk_bf16_f32 v91, v218, v219
    v_mfma_f32_16x16x32_bf16 v[208:211], a[156:159], a[248:251], v[208:211]
    v_cvt_pk_bf16_f32 v112, v212, v213
    v_cvt_pk_bf16_f32 v113, v214, v215
    v_mfma_f32_16x16x16_bf16 v[172:175], v[28:29], v[136:137], v[172:175]
    ds_read_b128 a[236:239], v225 offset:43200
    ds_read_b128 a[240:243], v225 offset:43264
    v_mfma_f32_16x16x32_bf16 v[204:207], a[148:151], a[244:247], 0
    v_cndmask_b32 v225, v243, v245, vcc
    v_mfma_f32_16x16x32_bf16 v[204:207], a[160:163], a[248:251], v[204:207]
    v_mfma_f32_16x16x32_bf16 v[200:203], a[152:155], a[244:247], 0
    ds_read_b128 a[244:247], v226 offset:1152
    v_mfma_f32_16x16x32_bf16 v[200:203], a[164:167], a[248:251], v[200:203]
    ds_read_b128 a[248:251], v226 offset:1216
    v_max3_f32 v249, v249, v172, v173
    v_mfma_f32_16x16x32_bf16 v[208:211], a[168:171], a[252:255], v[208:211]
    v_max3_f32 v248, v248, v174, v175
    v_max_f32 v248, v248, v249
    v_mfma_f32_16x16x32_bf16 v[208:211], a[180:183], v[252:255], v[208:211]
    v_mov_b32 v249, v248
    v_mfma_f32_16x16x32_bf16 v[204:207], a[172:175], a[252:255], v[204:207]
    v_mfma_f32_16x16x32_bf16 v[204:207], a[184:187], v[252:255], v[204:207]
    v_permlane16_swap_b32 v248, v249
    v_mfma_f32_16x16x32_bf16 v[200:203], a[176:179], a[252:255], v[200:203]
    ds_read_b128 a[252:255], v226 offset:1280
    v_max_f32 v248, v248, v249
    v_mfma_f32_16x16x32_bf16 v[200:203], a[188:191], v[252:255], v[200:203]
    s_waitcnt lgkmcnt(4)
    ds_read_b128 v[252:255], v226 offset:1344
    v_mov_b32 v249, v248
    v_mfma_f32_16x16x32_bf16 v[208:211], a[192:195], a[236:239], v[208:211]
    s_waitcnt lgkmcnt(4)
    v_mfma_f32_16x16x32_bf16 v[208:211], a[204:207], a[240:243], v[208:211]
    v_permlane32_swap_b32 v248, v249
    v_mfma_f32_16x16x32_bf16 v[204:207], a[196:199], a[236:239], v[204:207]
    v_max_f32 v248, v248, v249
    v_mul_f32 v236, s37, v248
    v_mfma_f32_16x16x32_bf16 v[204:207], a[208:211], a[240:243], v[204:207]
    v_fma_f32 v144, v144, s37, -v236
    v_fma_f32 v145, v145, s37, -v236
    v_mfma_f32_16x16x32_bf16 v[200:203], a[200:203], a[236:239], v[200:203]
    v_cvt_pk_bf16_f32 v138, v208, v209
    v_cvt_pk_bf16_f32 v139, v210, v211
    v_mfma_f32_16x16x32_bf16 v[200:203], a[212:215], a[240:243], v[200:203]
    s_waitcnt lgkmcnt(2)
    ds_read_b128 a[236:239], v226 offset:1408
    ds_read_b128 a[240:243], v226 offset:1472
    v_mfma_f32_16x16x32_bf16 v[220:223], a[144:147], a[244:247], 0
    v_cvt_pk_bf16_f32 v140, v204, v205
    v_cvt_pk_bf16_f32 v141, v206, v207
    v_mfma_f32_16x16x32_bf16 v[220:223], a[156:159], a[248:251], v[220:223]
    v_fma_f32 v146, v146, s37, -v236
    v_fma_f32 v147, v147, s37, -v236
    v_mfma_f32_16x16x32_bf16 v[216:219], a[148:151], a[244:247], 0
    v_cvt_pk_bf16_f32 v142, v200, v201
    v_cvt_pk_bf16_f32 v143, v202, v203
    v_mfma_f32_16x16x32_bf16 v[216:219], a[160:163], a[248:251], v[216:219]
    v_exp_f32 v144, v144
    v_mfma_f32_16x16x32_bf16 v[212:215], a[152:155], a[244:247], 0
    ds_read_b128 a[244:247], v227 offset:6144
    v_fma_f32 v148, v148, s37, -v236
    v_mfma_f32_16x16x32_bf16 v[212:215], a[164:167], a[248:251], v[212:215]
    s_waitcnt lgkmcnt(3)
    ds_read_b128 a[248:251], v227 offset:6208
    v_fma_f32 v149, v149, s37, -v236
    v_mfma_f32_16x16x32_bf16 v[220:223], a[168:171], a[252:255], v[220:223]
    v_exp_f32 v145, v145
    v_mfma_f32_16x16x32_bf16 v[220:223], a[180:183], v[252:255], v[220:223]
    v_exp_f32 v146, v146
    v_mfma_f32_16x16x32_bf16 v[216:219], a[172:175], a[252:255], v[216:219]
    v_exp_f32 v147, v147
    v_mfma_f32_16x16x32_bf16 v[216:219], a[184:187], v[252:255], v[216:219]
    v_cvt_pk_bf16_f32 v176, v144, v145
    v_cvt_pk_bf16_f32 v177, v146, v147
    v_mfma_f32_16x16x32_bf16 v[212:215], a[176:179], a[252:255], v[212:215]
    ds_read_b128 a[252:255], v227 offset:6272
    ds_read_b128 v[144:147], v235
    v_mfma_f32_16x16x32_bf16 v[212:215], a[188:191], v[252:255], v[212:215]
    s_waitcnt lgkmcnt(4)
    v_bfe_u32 v235, s75, v233, 4
    v_mad_u32_u24 v235, v235, s40, v231
    v_mfma_f32_16x16x32_bf16 v[220:223], a[192:195], a[236:239], v[220:223]
    ds_read_b128 v[252:255], v227 offset:6336
    v_fma_f32 v150, v150, s37, -v236
    v_mfma_f32_16x16x32_bf16 v[220:223], a[204:207], a[240:243], v[220:223]
    v_fma_f32 v151, v151, s37, -v236
    v_fma_f32 v152, v152, s37, -v236
    v_mfma_f32_16x16x32_bf16 v[216:219], a[196:199], a[236:239], v[216:219]
    v_exp_f32 v148, v148
    v_mfma_f32_16x16x32_bf16 v[216:219], a[208:211], a[240:243], v[216:219]
    v_exp_f32 v149, v149
    v_mfma_f32_16x16x32_bf16 v[212:215], a[200:203], a[236:239], v[212:215]
    ds_read_b128 a[236:239], v227 offset:6400
    v_cvt_pk_bf16_f32 v132, v220, v221
    v_mfma_f32_16x16x32_bf16 v[212:215], a[212:215], a[240:243], v[212:215]
    s_waitcnt lgkmcnt(4)
    ds_read_b128 a[240:243], v227 offset:6464
    v_cvt_pk_bf16_f32 v133, v222, v223
    v_mfma_f32_16x16x32_bf16 v[208:211], a[0:3], a[244:247], 0
    v_cvt_pk_bf16_f32 v134, v216, v217
    v_cvt_pk_bf16_f32 v135, v218, v219
    v_mfma_f32_16x16x32_bf16 v[208:211], a[12:15], a[248:251], v[208:211]
    s_waitcnt lgkmcnt(3)
    v_cndmask_b32 v227, v240, v239, vcc
    v_cvt_pk_bf16_f32 v178, v148, v149
    v_mfma_f32_16x16x32_bf16 v[144:147], v[24:27], v[138:141], v[144:147]
    v_cvt_pk_bf16_f32 v136, v212, v213
    v_cvt_pk_bf16_f32 v137, v214, v215
    v_mfma_f32_16x16x32_bf16 v[204:207], a[4:7], a[244:247], 0
    v_exp_f32 v150, v150
    v_mfma_f32_16x16x32_bf16 v[204:207], a[16:19], a[248:251], v[204:207]
    v_exp_f32 v151, v151
    v_mfma_f32_16x16x16_bf16 v[144:147], v[28:29], v[142:143], v[144:147]
    v_cvt_pk_bf16_f32 v179, v150, v151
    v_fma_f32 v153, v153, s37, -v236
    v_mfma_f32_16x16x32_bf16 v[200:203], a[8:11], a[244:247], 0
    ds_read_b128 v[148:151], v250
    v_bfe_u32 v250, s76, v233, 4
    v_mfma_f32_16x16x32_bf16 v[200:203], a[20:23], a[248:251], v[200:203]
    v_mad_u32_u24 v250, v250, s40, v231
    v_fma_f32 v154, v154, s37, -v236
    v_mfma_f32_16x16x32_bf16 v[196:199], a[216:219], v[176:179], 0
    v_fma_f32 v155, v155, s37, -v236
    v_fma_f32 v156, v156, s37, -v236
    v_mfma_f32_16x16x32_bf16 v[184:187], v[70:73], v[176:179], 0
    v_exp_f32 v152, v152
    v_mfma_f32_16x16x32_bf16 v[188:191], v[92:95], v[176:179], 0
    v_exp_f32 v153, v153
    v_mfma_f32_16x16x32_bf16 v[192:195], v[114:117], v[176:179], 0
    v_exp_f32 v154, v154
    v_mfma_f32_16x16x32_bf16 v[220:223], a[244:247], a[72:75], 0
    v_exp_f32 v155, v155
    v_mfma_f32_16x16x32_bf16 v[220:223], a[248:251], a[84:87], v[220:223]
    v_cvt_pk_bf16_f32 v180, v152, v153
    v_cvt_pk_bf16_f32 v181, v154, v155
    v_mfma_f32_16x16x32_bf16 v[216:219], a[244:247], a[76:79], 0
    ds_read_b128 v[152:155], v230 offset:1280
    v_fma_f32 v157, v157, s37, -v236
    v_mfma_f32_16x16x32_bf16 v[216:219], a[248:251], a[88:91], v[216:219]
    s_waitcnt lgkmcnt(1)
    v_fma_f32 v158, v158, s37, -v236
    v_fma_f32 v159, v159, s37, -v236
    v_mfma_f32_16x16x32_bf16 v[148:151], v[30:33], v[138:141], v[148:151]
    v_exp_f32 v156, v156
    v_mfma_f32_16x16x32_bf16 v[212:215], a[244:247], a[80:83], 0
    ds_read_b128 a[244:247], v239
    v_fma_f32 v160, v160, s37, -v236
    v_mfma_f32_16x16x32_bf16 v[212:215], a[248:251], a[92:95], v[212:215]
    ds_read_b128 a[248:251], v240
    v_fma_f32 v161, v161, s37, -v236
    v_mfma_f32_16x16x16_bf16 v[148:151], v[34:35], v[142:143], v[148:151]
    v_exp_f32 v157, v157
    v_mfma_f32_16x16x32_bf16 v[208:211], a[24:27], a[252:255], v[208:211]
    v_exp_f32 v158, v158
    v_mfma_f32_16x16x32_bf16 v[208:211], a[36:39], v[252:255], v[208:211]
    v_exp_f32 v159, v159
    v_mfma_f32_16x16x32_bf16 v[204:207], a[28:31], a[252:255], v[204:207]
    v_cvt_pk_bf16_f32 v182, v156, v157
    v_cvt_pk_bf16_f32 v183, v158, v159
    v_mfma_f32_16x16x32_bf16 v[204:207], a[40:43], v[252:255], v[204:207]
    ds_read_b128 v[156:159], v230 offset:1920
    v_fma_f32 v162, v162, s37, -v236
    v_mfma_f32_16x16x32_bf16 v[196:199], a[216:219], v[180:183], v[196:199]
    v_fma_f32 v163, v163, s37, -v236
    v_fma_f32 v164, v164, s37, -v236
    v_mfma_f32_16x16x32_bf16 v[184:187], v[74:77], v[180:183], v[184:187]
    v_exp_f32 v160, v160
    v_mfma_f32_16x16x32_bf16 v[188:191], v[96:99], v[180:183], v[188:191]
    v_exp_f32 v161, v161
    v_mfma_f32_16x16x32_bf16 v[192:195], v[118:121], v[180:183], v[192:195]
    s_waitcnt lgkmcnt(2)
    v_exp_f32 v162, v162
    v_mfma_f32_16x16x32_bf16 v[152:155], v[36:39], v[138:141], v[152:155]
    v_exp_f32 v163, v163
    v_mfma_f32_16x16x32_bf16 v[200:203], a[32:35], a[252:255], v[200:203]
    v_cvt_pk_bf16_f32 v176, v160, v161
    v_cvt_pk_bf16_f32 v177, v162, v163
    v_mfma_f32_16x16x32_bf16 v[200:203], a[44:47], v[252:255], v[200:203]
    ds_read_b128 v[160:163], v234
    v_bfe_u32 v234, s73, v232, 4
    v_mfma_f32_16x16x16_bf16 v[152:155], v[40:41], v[142:143], v[152:155]
    s_waitcnt lgkmcnt(1)
    v_fma_f32 v165, v165, s37, -v236
    v_fma_f32 v166, v166, s37, -v236
    v_mfma_f32_16x16x32_bf16 v[156:159], v[42:45], v[138:141], v[156:159]
    v_fma_f32 v167, v167, s37, -v236
    v_fma_f32 v168, v168, s37, -v236
    v_mfma_f32_16x16x32_bf16 v[220:223], a[252:255], a[96:99], v[220:223]
    v_exp_f32 v164, v164
    v_mfma_f32_16x16x32_bf16 v[220:223], v[252:255], a[108:111], v[220:223]
    v_exp_f32 v165, v165
    v_mfma_f32_16x16x16_bf16 v[156:159], v[46:47], v[142:143], v[156:159]
    v_exp_f32 v166, v166
    v_mfma_f32_16x16x32_bf16 v[216:219], a[252:255], a[100:103], v[216:219]
    v_exp_f32 v167, v167
    v_mfma_f32_16x16x32_bf16 v[216:219], v[252:255], a[112:115], v[216:219]
    v_cvt_pk_bf16_f32 v178, v164, v165
    v_cvt_pk_bf16_f32 v179, v166, v167
    v_mfma_f32_16x16x32_bf16 v[212:215], a[252:255], a[104:107], v[212:215]
    ds_read_b128 a[252:255], v239 offset:1024
    ds_read_b128 v[164:167], v235
    v_mfma_f32_16x16x32_bf16 v[212:215], v[252:255], a[116:119], v[212:215]
    v_mad_u32_u24 v235, v234, s40, v228
    v_mad_u32_u24 v234, v234, s40, v229
    v_mfma_f32_16x16x32_bf16 v[196:199], a[216:219], v[176:179], v[196:199]
    ds_read_b128 v[252:255], v240 offset:1024
    v_fma_f32 v169, v169, s37, -v236
    v_mfma_f32_16x16x32_bf16 v[184:187], v[78:81], v[176:179], v[184:187]
    v_fma_f32 v170, v170, s37, -v236
    v_fma_f32 v171, v171, s37, -v236
    v_mfma_f32_16x16x32_bf16 v[188:191], v[100:103], v[176:179], v[188:191]
    v_exp_f32 v168, v168
    v_mfma_f32_16x16x32_bf16 v[192:195], v[122:125], v[176:179], v[192:195]
    s_waitcnt lgkmcnt(3)
    v_exp_f32 v169, v169
    v_mfma_f32_16x16x32_bf16 v[160:163], v[48:51], v[138:141], v[160:163]
    v_exp_f32 v170, v170
    v_mfma_f32_16x16x32_bf16 v[208:211], a[48:51], a[236:239], v[208:211]
    v_exp_f32 v171, v171
    v_mfma_f32_16x16x32_bf16 v[208:211], a[60:63], a[240:243], v[208:211]
    v_cvt_pk_bf16_f32 v180, v168, v169
    v_cvt_pk_bf16_f32 v181, v170, v171
    v_mfma_f32_16x16x16_bf16 v[160:163], v[52:53], v[142:143], v[160:163]
    ds_read_b128 v[168:171], v250
    v_bfe_u32 v250, s77, v232, 4
    v_mfma_f32_16x16x32_bf16 v[204:207], a[52:55], a[236:239], v[204:207]
    v_fma_f32 v172, v172, s37, -v236
    v_fma_f32 v173, v173, s37, -v236
    v_mfma_f32_16x16x32_bf16 v[204:207], a[64:67], a[240:243], v[204:207]
    v_cvt_pk_bf16_f32 v54, v208, v209
    v_cvt_pk_bf16_f32 v55, v210, v211
    v_mfma_f32_16x16x32_bf16 v[200:203], a[56:59], a[236:239], v[200:203]
    v_fma_f32 v174, v174, s37, -v236
    v_fma_f32 v175, v175, s37, -v236
    v_mfma_f32_16x16x32_bf16 v[200:203], a[68:71], a[240:243], v[200:203]
    v_exp_f32 v172, v172
    v_mfma_f32_16x16x32_bf16 v[220:223], a[236:239], a[120:123], v[220:223]
    v_cvt_pk_bf16_f32 v56, v204, v205
    v_cvt_pk_bf16_f32 v57, v206, v207
    v_mfma_f32_16x16x32_bf16 v[220:223], a[240:243], a[132:135], v[220:223]
    s_waitcnt lgkmcnt(1)
    v_exp_f32 v173, v173
    v_mfma_f32_16x16x32_bf16 v[164:167], v[54:57], v[138:141], v[164:167]
    v_exp_f32 v174, v174
    v_mfma_f32_16x16x32_bf16 v[216:219], a[236:239], a[124:127], v[216:219]
    v_cvt_pk_bf16_f32 v58, v200, v201
    v_cvt_pk_bf16_f32 v59, v202, v203
    v_mfma_f32_16x16x32_bf16 v[216:219], a[240:243], a[136:139], v[216:219]
    v_exp_f32 v175, v175
    v_mfma_f32_16x16x16_bf16 v[164:167], v[58:59], v[142:143], v[164:167]
    s_waitcnt lgkmcnt(0)
    v_cvt_pk_bf16_f32 v84, v220, v221
    v_cvt_pk_bf16_f32 v85, v222, v223
    v_mfma_f32_16x16x32_bf16 v[168:171], v[60:63], v[138:141], v[168:171]
    v_cvt_pk_bf16_f32 v182, v172, v173
    v_cvt_pk_bf16_f32 v183, v174, v175
    v_mfma_f32_16x16x32_bf16 v[212:215], a[236:239], a[128:131], v[212:215]
    v_cvt_pk_bf16_f32 v106, v216, v217
    v_cvt_pk_bf16_f32 v107, v218, v219
    v_mfma_f32_16x16x32_bf16 v[212:215], a[240:243], a[140:143], v[212:215]
    ds_read_b128 a[236:239], v241 offset:12288
    ds_read_b128 a[240:243], v241 offset:12800
    v_mfma_f32_16x16x32_bf16 v[196:199], a[216:219], v[180:183], v[196:199]
    ds_read_b128 v[172:175], v235
    v_bfe_u32 v235, s78, v232, 4
    v_mfma_f32_16x16x32_bf16 v[184:187], v[66:69], v[180:183], v[184:187]
    v_max3_f32 v248, v144, v145, v146
    v_max3_f32 v249, v147, v148, v149
    v_mfma_f32_16x16x32_bf16 v[188:191], v[88:91], v[180:183], v[188:191]
    v_cvt_pk_bf16_f32 v128, v212, v213
    v_cvt_pk_bf16_f32 v129, v214, v215
    v_mfma_f32_16x16x32_bf16 v[192:195], v[110:113], v[180:183], v[192:195]
    v_rcp_f32 v197, v196
    v_mfma_f32_16x16x16_bf16 v[168:171], v[64:65], v[142:143], v[168:171]
    v_mul_f32 v184, v184, v197
    v_mul_f32 v185, v185, v197
    v_mfma_f32_16x16x32_bf16 v[208:211], a[220:223], a[244:247], 0
    v_cvt_pk_bf16_f32 v184, v184, v185
    v_mul_f32 v186, v186, v197
    v_mfma_f32_16x16x32_bf16 v[200:203], a[220:223], a[248:251], 0
    v_mul_f32 v187, v187, v197
    v_cvt_pk_bf16_f32 v185, v186, v187
    v_mfma_f32_16x16x32_bf16 v[204:207], a[224:227], a[244:247], 0
    v_mul_f32 v188, v188, v197
    v_mul_f32 v189, v189, v197
    v_mfma_f32_16x16x32_bf16 v[220:223], a[224:227], a[248:251], 0
    ds_read_b128 a[248:251], v242 offset:12800
    v_cvt_pk_bf16_f32 v186, v188, v189
    v_mfma_f32_16x16x32_bf16 v[216:219], a[228:231], a[244:247], 0
    s_waitcnt lgkmcnt(1)
    v_mul_f32 v190, v190, v197
    v_mul_f32 v191, v191, v197
    v_mfma_f32_16x16x32_bf16 v[172:175], v[12:15], v[132:135], v[172:175]
    v_cvt_pk_bf16_f32 v187, v190, v191
    v_mul_f32 v192, v192, v197
    v_mfma_f32_16x16x32_bf16 v[212:215], a[232:235], a[244:247], 0
    ds_read_b128 a[244:247], v242 offset:12288
    v_mul_f32 v193, v193, v197
    v_mfma_f32_16x16x32_bf16 v[208:211], a[236:239], a[252:255], v[208:211]
    v_cvt_pk_bf16_f32 v188, v192, v193
    v_mul_f32 v194, v194, v197
    v_mfma_f32_16x16x16_bf16 v[172:175], v[16:17], v[136:137], v[172:175]
    v_mul_f32 v195, v195, v197
    v_cvt_pk_bf16_f32 v189, v194, v195
    v_mfma_f32_16x16x32_bf16 v[200:203], a[236:239], v[252:255], v[200:203]
    ds_read_b128 a[236:239], v241 offset:24576
    v_max3_f32 v248, v248, v150, v151
    v_mfma_f32_16x16x32_bf16 v[204:207], a[240:243], a[252:255], v[204:207]
    ds_write_b128 v237, v[184:187] offset:12288
    v_mfma_f32_16x16x32_bf16 v[220:223], a[240:243], v[252:255], v[220:223]
    s_waitcnt lgkmcnt(3)
    ds_write_b64 v238, v[188:189] offset:12288
    v_mfma_f32_16x16x32_bf16 v[212:215], a[248:251], a[252:255], v[212:215]
    s_waitcnt lgkmcnt(3)
    v_max3_f32 v249, v249, v152, v153
    v_max3_f32 v248, v248, v154, v155
    v_max3_f32 v249, v249, v156, v157
    v_max3_f32 v248, v248, v158, v159
    v_mfma_f32_16x16x32_bf16 v[216:219], a[244:247], a[252:255], v[216:219]
    v_max3_f32 v249, v249, v160, v161
    v_max3_f32 v248, v248, v162, v163
    v_max3_f32 v249, v249, v164, v165
    v_max3_f32 v248, v248, v166, v167
    v_max3_f32 v249, v249, v168, v169
    v_max3_f32 v248, v248, v170, v171
    ds_read_b128 a[252:255], v239 offset:2048
    ds_read_b128 v[252:255], v240 offset:2048
    v_max_f32 v248, v248, v249
    v_mov_b32 v249, v248
    ds_read_b128 a[240:243], v241 offset:25088
    s_nop 0
    ds_read_b128 a[244:247], v242 offset:24576
    v_permlane16_swap_b32 v248, v249
    v_max_f32 v248, v248, v249
    ds_read_b128 a[248:251], v242 offset:25088
    v_mov_b32 v249, v248
    s_nop 1
    v_permlane32_swap_b32 v248, v249
    v_max_f32 v248, v248, v249
    v_mul_f32 v236, s37, v248
    v_fma_f32 v144, v144, s37, -v236
    v_fma_f32 v145, v145, s37, -v236
    v_fma_f32 v146, v146, s37, -v236
    v_fma_f32 v147, v147, s37, -v236
    v_exp_f32 v144, v144
    v_exp_f32 v145, v145
    v_exp_f32 v146, v146
    s_waitcnt lgkmcnt(4)
    v_mfma_f32_16x16x32_bf16 v[208:211], a[236:239], a[252:255], v[208:211]
    s_waitcnt lgkmcnt(3)
    v_exp_f32 v147, v147
    v_mfma_f32_16x16x32_bf16 v[200:203], a[236:239], v[252:255], v[200:203]
    s_waitcnt lgkmcnt(2)
    ds_read_b128 a[236:239], v241 offset:36864
    v_cvt_pk_bf16_f32 v176, v144, v145
    v_mfma_f32_16x16x32_bf16 v[204:207], a[240:243], a[252:255], v[204:207]
    v_cvt_pk_bf16_f32 v177, v146, v147
    v_fma_f32 v148, v148, s37, -v236
    v_mfma_f32_16x16x32_bf16 v[220:223], a[240:243], v[252:255], v[220:223]
    s_waitcnt lgkmcnt(2)
    ds_read_b128 v[252:255], v240 offset:3072
    ds_read_b128 a[240:243], v241 offset:37376
    v_mfma_f32_16x16x32_bf16 v[216:219], a[244:247], a[252:255], v[216:219]
    s_waitcnt lgkmcnt(3)
    ds_read_b128 a[244:247], v242 offset:36864
    v_fma_f32 v149, v149, s37, -v236
    v_mfma_f32_16x16x32_bf16 v[212:215], a[248:251], a[252:255], v[212:215]
    ds_read_b128 a[252:255], v239 offset:3072
    v_fma_f32 v150, v150, s37, -v236
    v_fma_f32 v151, v151, s37, -v236
    v_exp_f32 v148, v148
    ds_read_b128 a[248:251], v242 offset:37376
    ds_read_b128 v[144:147], v234
    v_mad_u32_u24 v234, v250, s40, v228
    v_mad_u32_u24 v250, v250, s40, v229
    v_exp_f32 v149, v149
    v_exp_f32 v150, v150
    v_exp_f32 v151, v151
    v_cvt_pk_bf16_f32 v178, v148, v149
    v_cvt_pk_bf16_f32 v179, v150, v151
    ds_read_b128 v[148:151], v229 offset:1280
    v_fma_f32 v152, v152, s37, -v236
    v_mfma_f32_16x16x32_bf16 v[196:199], a[216:219], v[176:179], 0
    v_fma_f32 v153, v153, s37, -v236
    v_fma_f32 v154, v154, s37, -v236
    v_mfma_f32_16x16x32_bf16 v[184:187], v[68:71], v[176:179], 0
    v_fma_f32 v155, v155, s37, -v236
    v_fma_f32 v156, v156, s37, -v236
    v_mfma_f32_16x16x32_bf16 v[188:191], v[90:93], v[176:179], 0
    v_exp_f32 v152, v152
    v_mfma_f32_16x16x32_bf16 v[192:195], v[112:115], v[176:179], 0
    s_waitcnt lgkmcnt(3)
    v_exp_f32 v153, v153
    v_mfma_f32_16x16x32_bf16 v[208:211], a[236:239], a[252:255], v[208:211]
    v_exp_f32 v154, v154
    v_mfma_f32_16x16x32_bf16 v[200:203], a[236:239], v[252:255], v[200:203]
    s_waitcnt lgkmcnt(1)
    ds_read_b128 a[236:239], v241 offset:49152
    v_cvt_pk_bf16_f32 v180, v152, v153
    v_mfma_f32_16x16x32_bf16 v[144:147], v[36:39], v[132:135], v[144:147]
    v_exp_f32 v155, v155
    v_mfma_f32_16x16x32_bf16 v[204:207], a[240:243], a[252:255], v[204:207]
    s_waitcnt lgkmcnt(1)
    v_cvt_pk_bf16_f32 v181, v154, v155
    v_fma_f32 v157, v157, s37, -v236
    v_mfma_f32_16x16x32_bf16 v[148:151], v[42:45], v[132:135], v[148:151]
    ds_read_b128 v[152:155], v228 offset:1280
    v_fma_f32 v158, v158, s37, -v236
    v_mfma_f32_16x16x16_bf16 v[144:147], v[40:41], v[136:137], v[144:147]
    v_fma_f32 v159, v159, s37, -v236
    v_fma_f32 v160, v160, s37, -v236
    v_mfma_f32_16x16x32_bf16 v[220:223], a[240:243], v[252:255], v[220:223]
    ds_read_b128 v[252:255], v240 offset:4096
    ds_read_b128 a[240:243], v241 offset:49664
    v_mfma_f32_16x16x16_bf16 v[148:151], v[46:47], v[136:137], v[148:151]
    v_exp_f32 v156, v156
    v_mfma_f32_16x16x32_bf16 v[216:219], a[244:247], a[252:255], v[216:219]
    ds_read_b128 a[244:247], v242 offset:49152
    v_fma_f32 v161, v161, s37, -v236
    v_mfma_f32_16x16x32_bf16 v[212:215], a[248:251], a[252:255], v[212:215]
    ds_read_b128 a[252:255], v239 offset:4096
    ds_read_b128 a[248:251], v242 offset:49664
    v_exp_f32 v157, v157
    v_exp_f32 v158, v158
    v_exp_f32 v159, v159
    v_cvt_pk_bf16_f32 v182, v156, v157
    v_cvt_pk_bf16_f32 v183, v158, v159
    ds_read_b128 v[156:159], v234
    v_bfe_u32 v234, s73, v232, 4
    v_mfma_f32_16x16x32_bf16 v[196:199], a[216:219], v[180:183], v[196:199]
    v_mad_u32_u24 v234, v234, s40, v230
    v_fma_f32 v162, v162, s37, -v236
    v_mfma_f32_16x16x32_bf16 v[184:187], v[76:79], v[180:183], v[184:187]
    v_fma_f32 v163, v163, s37, -v236
    v_fma_f32 v164, v164, s37, -v236
    v_mfma_f32_16x16x32_bf16 v[188:191], v[98:101], v[180:183], v[188:191]
    v_exp_f32 v160, v160
    v_mfma_f32_16x16x32_bf16 v[192:195], v[120:123], v[180:183], v[192:195]
    s_waitcnt lgkmcnt(5)
    v_exp_f32 v161, v161
    v_mfma_f32_16x16x32_bf16 v[152:155], v[18:21], v[132:135], v[152:155]
    s_waitcnt lgkmcnt(2)
    v_exp_f32 v162, v162
    v_mfma_f32_16x16x32_bf16 v[208:211], a[236:239], a[252:255], v[208:211]
    v_exp_f32 v163, v163
    v_mfma_f32_16x16x32_bf16 v[200:203], a[236:239], v[252:255], v[200:203]
    ds_read_b128 a[236:239], v241 offset:61440
    v_cvt_pk_bf16_f32 v176, v160, v161
    v_mfma_f32_16x16x16_bf16 v[152:155], v[22:23], v[136:137], v[152:155]
    s_waitcnt lgkmcnt(1)
    v_cvt_pk_bf16_f32 v177, v162, v163
    v_fma_f32 v165, v165, s37, -v236
    v_mfma_f32_16x16x32_bf16 v[156:159], v[0:3], v[132:135], v[156:159]
    ds_read_b128 v[160:163], v250
    v_mad_u32_u24 v250, v235, s40, v229
    v_mfma_f32_16x16x16_bf16 v[196:199], a[216:217], v[176:177], v[196:199]
    v_mad_u32_u24 v235, v235, s40, v228
    v_fma_f32 v166, v166, s37, -v236
    v_mfma_f32_16x16x16_bf16 v[184:187], v[82:83], v[176:177], v[184:187]
    v_fma_f32 v167, v167, s37, -v236
    v_fma_f32 v168, v168, s37, -v236
    v_mfma_f32_16x16x16_bf16 v[188:191], v[104:105], v[176:177], v[188:191]
    v_exp_f32 v164, v164
    v_mfma_f32_16x16x16_bf16 v[192:195], v[126:127], v[176:177], v[192:195]
    v_exp_f32 v165, v165
    v_mfma_f32_16x16x16_bf16 v[156:159], v[4:5], v[136:137], v[156:159]
    v_exp_f32 v166, v166
    v_mfma_f32_16x16x32_bf16 v[204:207], a[240:243], a[252:255], v[204:207]
    v_exp_f32 v167, v167
    v_mfma_f32_16x16x32_bf16 v[220:223], a[240:243], v[252:255], v[220:223]
    ds_read_b128 v[252:255], v240 offset:5120
    ds_read_b128 a[240:243], v241 offset:61952
    v_mfma_f32_16x16x32_bf16 v[216:219], a[244:247], a[252:255], v[216:219]
    s_waitcnt lgkmcnt(2)
    ds_read_b128 a[244:247], v242 offset:61440
    v_cvt_pk_bf16_f32 v180, v164, v165
    v_mfma_f32_16x16x32_bf16 v[160:163], v[24:27], v[132:135], v[160:163]
    v_cvt_pk_bf16_f32 v181, v166, v167
    v_fma_f32 v169, v169, s37, -v236
    v_mfma_f32_16x16x32_bf16 v[212:215], a[248:251], a[252:255], v[212:215]
    ds_read_b128 a[252:255], v239 offset:5120
    ds_read_b128 a[248:251], v242 offset:61952
    v_fma_f32 v170, v170, s37, -v236
    v_mfma_f32_16x16x16_bf16 v[160:163], v[28:29], v[136:137], v[160:163]
    s_waitcnt lgkmcnt(4)
    ds_read_b128 v[164:167], v250
    v_bfe_u32 v250, s78, v232, 4
    v_mad_u32_u24 v250, v250, s40, v230
    v_fma_f32 v171, v171, s37, -v236
    v_exp_f32 v168, v168
    v_exp_f32 v169, v169
    v_exp_f32 v170, v170
    v_exp_f32 v171, v171
    v_cvt_pk_bf16_f32 v182, v168, v169
    v_cvt_pk_bf16_f32 v183, v170, v171
    ds_read_b128 v[168:171], v235
    v_mfma_f32_16x16x32_bf16 v[200:203], a[236:239], v[252:255], v[200:203]
    v_bfe_u32 v235, s77, v232, 4
    v_mad_u32_u24 v235, v235, s40, v230
    v_mfma_f32_16x16x32_bf16 v[196:199], a[216:219], v[180:183], v[196:199]
    v_max3_f32 v248, v172, v173, v174
    v_max3_f32 v249, v175, v144, v145
    v_mfma_f32_16x16x32_bf16 v[184:187], v[84:87], v[180:183], v[184:187]
    v_max3_f32 v248, v248, v146, v147
    v_max3_f32 v249, v249, v148, v149
    v_mfma_f32_16x16x32_bf16 v[188:191], v[106:109], v[180:183], v[188:191]
    v_cvt_pk_bf16_f32 v200, v200, v201
    v_cvt_pk_bf16_f32 v201, v202, v203
    v_mfma_f32_16x16x32_bf16 v[192:195], v[128:131], v[180:183], v[192:195]
    s_waitcnt lgkmcnt(3)
    v_rcp_f32 v197, v196
    v_mfma_f32_16x16x32_bf16 v[208:211], a[236:239], a[252:255], v[208:211]
    ds_read_b128 a[236:239], v224 offset:15616
    v_mul_f32 v184, v184, v197
    v_mfma_f32_16x16x32_bf16 v[204:207], a[240:243], a[252:255], v[204:207]
    v_mul_f32 v185, v185, v197
    v_cvt_pk_bf16_f32 v184, v184, v185
    v_mfma_f32_16x16x32_bf16 v[220:223], a[240:243], v[252:255], v[220:223]
    ds_read_b128 v[252:255], v224 offset:15552
    ds_read_b128 a[240:243], v224 offset:15680
    v_mfma_f32_16x16x32_bf16 v[216:219], a[244:247], a[252:255], v[216:219]
    s_waitcnt lgkmcnt(4)
    ds_read_b128 a[244:247], v224 offset:15744
    v_cvt_pk_bf16_f32 v208, v208, v209
    v_mfma_f32_16x16x32_bf16 v[212:215], a[248:251], a[252:255], v[212:215]
    ds_read_b128 a[252:255], v224 offset:15488
    v_cvt_pk_bf16_f32 v209, v210, v211
    v_cvt_pk_bf16_f32 v210, v204, v205
    v_cvt_pk_bf16_f32 v211, v206, v207
    ds_read_b128 a[248:251], v224 offset:15808
    buffer_store_dwordx4 v[208:211], v243, s[20:23], s58 offen sc0 sc1
    v_cvt_pk_bf16_f32 v202, v220, v221
    v_cvt_pk_bf16_f32 v203, v222, v223
    v_cvt_pk_bf16_f32 v216, v216, v217
    v_cvt_pk_bf16_f32 v217, v218, v219
    v_cvt_pk_bf16_f32 v218, v212, v213
    v_cvt_pk_bf16_f32 v219, v214, v215
    v_mul_f32 v186, v186, v197
    v_mul_f32 v187, v187, v197
    v_cvt_pk_bf16_f32 v185, v186, v187
    v_mul_f32 v188, v188, v197
    v_mul_f32 v189, v189, v197
    v_cvt_pk_bf16_f32 v186, v188, v189
    v_mul_f32 v190, v190, v197
    v_mul_f32 v191, v191, v197
    v_cvt_pk_bf16_f32 v187, v190, v191
    v_mul_f32 v192, v192, v197
    v_mul_f32 v193, v193, v197
    v_cvt_pk_bf16_f32 v188, v192, v193
    v_mul_f32 v194, v194, v197
    v_mul_f32 v195, v195, v197
    v_cvt_pk_bf16_f32 v189, v194, v195
    ds_write_b128 v237, v[184:187] offset:18432
    s_waitcnt lgkmcnt(2)
    v_mfma_f32_16x16x32_bf16 v[208:211], a[0:3], a[252:255], 0
    ds_write_b64 v238, v[188:189] offset:18432
    v_mfma_f32_16x16x32_bf16 v[208:211], a[12:15], v[252:255], v[208:211]
    v_max3_f32 v248, v248, v150, v151
    v_max3_f32 v249, v249, v152, v153
    v_mfma_f32_16x16x32_bf16 v[204:207], a[4:7], a[252:255], 0
    v_max3_f32 v248, v248, v154, v155
    v_max3_f32 v249, v249, v156, v157
    v_mfma_f32_16x16x32_bf16 v[204:207], a[16:19], v[252:255], v[204:207]
    buffer_store_dwordx4 v[200:203], v245, s[20:23], s58 offen sc0 sc1
    v_mfma_f32_16x16x32_bf16 v[220:223], a[252:255], a[72:75], 0
    v_max3_f32 v248, v248, v158, v159
    v_max3_f32 v249, v249, v160, v161
    v_mfma_f32_16x16x32_bf16 v[220:223], v[252:255], a[84:87], v[220:223]
    v_max3_f32 v248, v248, v162, v163
    v_mfma_f32_16x16x32_bf16 v[200:203], a[8:11], a[252:255], 0
    v_mfma_f32_16x16x32_bf16 v[200:203], a[20:23], v[252:255], v[200:203]
    v_mfma_f32_16x16x32_bf16 v[212:215], a[252:255], a[80:83], 0
    v_mfma_f32_16x16x32_bf16 v[212:215], v[252:255], a[92:95], v[212:215]
    v_mfma_f32_16x16x32_bf16 v[208:211], a[24:27], a[236:239], v[208:211]
    s_waitcnt lgkmcnt(0)
    v_mfma_f32_16x16x32_bf16 v[208:211], a[36:39], a[240:243], v[208:211]
    s_barrier
    v_mfma_f32_16x16x32_bf16 v[204:207], a[28:31], a[236:239], v[204:207]
    v_mfma_f32_16x16x32_bf16 v[204:207], a[40:43], a[240:243], v[204:207]
    v_mfma_f32_16x16x32_bf16 v[200:203], a[32:35], a[236:239], v[200:203]
    v_mfma_f32_16x16x32_bf16 v[200:203], a[44:47], a[240:243], v[200:203]
    buffer_store_dwordx4 v[216:219], v244, s[20:23], s58 offen sc0 sc1
    v_mfma_f32_16x16x32_bf16 v[220:223], a[236:239], a[96:99], v[220:223]
    s_add_u32 s58, s51, 0x1a4000
    v_mfma_f32_16x16x32_bf16 v[220:223], a[240:243], a[108:111], v[220:223]
    v_mfma_f32_16x16x32_bf16 v[216:219], a[252:255], a[76:79], 0
    ds_read_b128 a[252:255], v224 offset:18560
    v_mfma_f32_16x16x32_bf16 v[216:219], v[252:255], a[88:91], v[216:219]
    ds_read_b128 v[252:255], v224 offset:18624
    v_mfma_f32_16x16x32_bf16 v[216:219], a[236:239], a[100:103], v[216:219]
    v_mfma_f32_16x16x32_bf16 v[216:219], a[240:243], a[112:115], v[216:219]
    v_mfma_f32_16x16x32_bf16 v[212:215], a[236:239], a[104:107], v[212:215]
    ds_read_b128 a[236:239], v224 offset:18688
    v_mfma_f32_16x16x32_bf16 v[212:215], a[240:243], a[116:119], v[212:215]
    ds_read_b128 a[240:243], v224 offset:18752
    v_mfma_f32_16x16x32_bf16 v[208:211], a[48:51], a[244:247], v[208:211]
    v_mfma_f32_16x16x32_bf16 v[208:211], a[60:63], a[248:251], v[208:211]
    v_mfma_f32_16x16x32_bf16 v[204:207], a[52:55], a[244:247], v[204:207]
    v_mfma_f32_16x16x32_bf16 v[204:207], a[64:67], a[248:251], v[204:207]
    v_mfma_f32_16x16x32_bf16 v[200:203], a[56:59], a[244:247], v[200:203]
    v_mfma_f32_16x16x32_bf16 v[200:203], a[68:71], a[248:251], v[200:203]
    v_mfma_f32_16x16x32_bf16 v[220:223], a[244:247], a[120:123], v[220:223]
    v_mfma_f32_16x16x32_bf16 v[220:223], a[248:251], a[132:135], v[220:223]
    v_mfma_f32_16x16x32_bf16 v[216:219], a[244:247], a[124:127], v[216:219]
    v_mfma_f32_16x16x32_bf16 v[216:219], a[248:251], a[136:139], v[216:219]
    v_cvt_pk_bf16_f32 v6, v208, v209
    v_cvt_pk_bf16_f32 v7, v210, v211
    v_mfma_f32_16x16x32_bf16 v[212:215], a[244:247], a[128:131], v[212:215]
    v_cvt_pk_bf16_f32 v8, v204, v205
    v_cvt_pk_bf16_f32 v9, v206, v207
    v_mfma_f32_16x16x32_bf16 v[212:215], a[248:251], a[140:143], v[212:215]
    v_cvt_pk_bf16_f32 v10, v200, v201
    v_cvt_pk_bf16_f32 v11, v202, v203
    v_mfma_f32_16x16x32_bf16 v[168:171], v[6:9], v[132:135], v[168:171]
    s_waitcnt lgkmcnt(0)
    v_cvt_pk_bf16_f32 v72, v220, v221
    v_cvt_pk_bf16_f32 v73, v222, v223
    v_mfma_f32_16x16x32_bf16 v[208:211], a[0:3], a[252:255], 0
    v_cvt_pk_bf16_f32 v94, v216, v217
    v_cvt_pk_bf16_f32 v95, v218, v219
    v_mfma_f32_16x16x32_bf16 v[208:211], a[12:15], v[252:255], v[208:211]
    v_cvt_pk_bf16_f32 v116, v212, v213
    v_cvt_pk_bf16_f32 v117, v214, v215
    v_mfma_f32_16x16x16_bf16 v[168:171], v[10:11], v[136:137], v[168:171]
    ds_read_b128 a[244:247], v224 offset:18816
    ds_read_b128 a[248:251], v224 offset:18880
    v_mfma_f32_16x16x32_bf16 v[204:207], a[4:7], a[252:255], 0
    ds_read_b128 a[0:3], v241 offset:12288
    v_cndmask_b32 v224, v239, v240, vcc
    v_mfma_f32_16x16x32_bf16 v[204:207], a[16:19], v[252:255], v[204:207]
    ds_read_b128 a[4:7], v241 offset:12800
    v_mfma_f32_16x16x32_bf16 v[200:203], a[8:11], a[252:255], 0
    ds_read_b128 a[8:11], v242 offset:12288
    v_mfma_f32_16x16x32_bf16 v[200:203], a[20:23], v[252:255], v[200:203]
    ds_read_b128 a[12:15], v242 offset:12800
    v_mfma_f32_16x16x32_bf16 v[220:223], a[252:255], a[72:75], 0
    ds_read_b128 a[16:19], v241 offset:24576
    v_mfma_f32_16x16x32_bf16 v[220:223], v[252:255], a[84:87], v[220:223]
    ds_read_b128 a[20:23], v241 offset:25088
    v_mfma_f32_16x16x32_bf16 v[216:219], a[252:255], a[76:79], 0
    v_mfma_f32_16x16x32_bf16 v[216:219], v[252:255], a[88:91], v[216:219]
    v_mfma_f32_16x16x32_bf16 v[212:215], a[252:255], a[80:83], 0
    ds_read_b128 a[252:255], v226 offset:4224
    v_mfma_f32_16x16x32_bf16 v[212:215], v[252:255], a[92:95], v[212:215]
    ds_read_b128 v[252:255], v226 offset:4288
    v_mfma_f32_16x16x32_bf16 v[208:211], a[24:27], a[236:239], v[208:211]
    ds_read_b128 a[24:27], v242 offset:24576
    v_mfma_f32_16x16x32_bf16 v[208:211], a[36:39], a[240:243], v[208:211]
    ds_read_b128 a[36:39], v241 offset:37376
    v_mfma_f32_16x16x32_bf16 v[204:207], a[28:31], a[236:239], v[204:207]
    ds_read_b128 a[28:31], v242 offset:25088
    v_mfma_f32_16x16x32_bf16 v[204:207], a[40:43], a[240:243], v[204:207]
    ds_read_b128 a[40:43], v242 offset:36864
    v_mfma_f32_16x16x32_bf16 v[200:203], a[32:35], a[236:239], v[200:203]
    ds_read_b128 a[32:35], v241 offset:36864
    v_mfma_f32_16x16x32_bf16 v[200:203], a[44:47], a[240:243], v[200:203]
    ds_read_b128 a[44:47], v242 offset:37376
    v_mfma_f32_16x16x32_bf16 v[220:223], a[236:239], a[96:99], v[220:223]
    v_mfma_f32_16x16x32_bf16 v[220:223], a[240:243], a[108:111], v[220:223]
    v_mfma_f32_16x16x32_bf16 v[216:219], a[236:239], a[100:103], v[216:219]
    v_mfma_f32_16x16x32_bf16 v[216:219], a[240:243], a[112:115], v[216:219]
    v_mfma_f32_16x16x32_bf16 v[212:215], a[236:239], a[104:107], v[212:215]
    ds_read_b128 a[236:239], v226 offset:4352
    v_mfma_f32_16x16x32_bf16 v[212:215], a[240:243], a[116:119], v[212:215]
    s_waitcnt lgkmcnt(5)
    ds_read_b128 a[240:243], v226 offset:4416
    v_mfma_f32_16x16x32_bf16 v[208:211], a[48:51], a[244:247], v[208:211]
    ds_read_b128 a[48:51], v241 offset:49152
    v_mfma_f32_16x16x32_bf16 v[208:211], a[60:63], a[248:251], v[208:211]
    ds_read_b128 a[60:63], v242 offset:49664
    v_mfma_f32_16x16x32_bf16 v[204:207], a[52:55], a[244:247], v[204:207]
    ds_read_b128 a[52:55], v241 offset:49664
    v_mfma_f32_16x16x32_bf16 v[204:207], a[64:67], a[248:251], v[204:207]
    ds_read_b128 a[64:67], v241 offset:61440
    v_mfma_f32_16x16x32_bf16 v[200:203], a[56:59], a[244:247], v[200:203]
    ds_read_b128 a[56:59], v242 offset:49152
    v_mfma_f32_16x16x32_bf16 v[200:203], a[68:71], a[248:251], v[200:203]
    v_cvt_pk_bf16_f32 v30, v208, v209
    v_cvt_pk_bf16_f32 v31, v210, v211
    v_mfma_f32_16x16x32_bf16 v[220:223], a[244:247], a[120:123], v[220:223]
    ds_read_b128 a[68:71], v241 offset:61952
    v_cvt_pk_bf16_f32 v32, v204, v205
    v_mfma_f32_16x16x32_bf16 v[220:223], a[248:251], a[132:135], v[220:223]
    v_cvt_pk_bf16_f32 v33, v206, v207
    v_mfma_f32_16x16x32_bf16 v[216:219], a[244:247], a[124:127], v[216:219]
    v_cvt_pk_bf16_f32 v34, v200, v201
    v_cvt_pk_bf16_f32 v35, v202, v203
    v_mfma_f32_16x16x32_bf16 v[216:219], a[248:251], a[136:139], v[216:219]
    v_mfma_f32_16x16x32_bf16 v[164:167], v[30:33], v[132:135], v[164:167]
    v_mfma_f32_16x16x32_bf16 v[212:215], a[244:247], a[128:131], v[212:215]
    ds_read_b128 a[244:247], v226 offset:4480
    v_cvt_pk_bf16_f32 v70, v220, v221
    v_mfma_f32_16x16x32_bf16 v[212:215], a[248:251], a[140:143], v[212:215]
    ds_read_b128 a[248:251], v226 offset:4544
    v_cvt_pk_bf16_f32 v71, v222, v223
    v_mfma_f32_16x16x16_bf16 v[164:167], v[34:35], v[136:137], v[164:167]
    v_cvt_pk_bf16_f32 v92, v216, v217
    v_cvt_pk_bf16_f32 v93, v218, v219
    v_mfma_f32_16x16x32_bf16 v[208:211], a[144:147], a[252:255], 0
    v_cndmask_b32 v226, v244, v247, vcc
    v_cndmask_b32 v247, v247, v244, vcc
    v_mfma_f32_16x16x32_bf16 v[208:211], a[156:159], v[252:255], v[208:211]
    v_cvt_pk_bf16_f32 v114, v212, v213
    v_cvt_pk_bf16_f32 v115, v214, v215
    v_mfma_f32_16x16x32_bf16 v[204:207], a[148:151], a[252:255], 0
    v_max3_f32 v249, v249, v164, v165
    v_max3_f32 v248, v248, v166, v167
    v_mfma_f32_16x16x32_bf16 v[204:207], a[160:163], v[252:255], v[204:207]
    v_max3_f32 v249, v249, v168, v169
    v_max3_f32 v248, v248, v170, v171
    v_mfma_f32_16x16x32_bf16 v[200:203], a[152:155], a[252:255], 0
    ds_read_b128 a[252:255], v239 offset:12288
    v_max_f32 v248, v248, v249
    v_mfma_f32_16x16x32_bf16 v[200:203], a[164:167], v[252:255], v[200:203]
    s_waitcnt lgkmcnt(3)
    ds_read_b128 v[252:255], v240 offset:12288
    v_mov_b32 v249, v248
    v_mfma_f32_16x16x32_bf16 v[208:211], a[168:171], a[236:239], v[208:211]
    v_mfma_f32_16x16x32_bf16 v[208:211], a[180:183], a[240:243], v[208:211]
    v_permlane16_swap_b32 v248, v249
    v_mfma_f32_16x16x32_bf16 v[204:207], a[172:175], a[236:239], v[204:207]
    v_max_f32 v248, v248, v249
    v_mov_b32 v249, v248
    v_mfma_f32_16x16x32_bf16 v[204:207], a[184:187], a[240:243], v[204:207]
    v_mfma_f32_16x16x32_bf16 v[200:203], a[176:179], a[236:239], v[200:203]
    ds_read_b128 a[236:239], v239 offset:13312
    v_mfma_f32_16x16x32_bf16 v[200:203], a[188:191], a[240:243], v[200:203]
    s_waitcnt lgkmcnt(3)
    ds_read_b128 a[240:243], v240 offset:13312
    v_mfma_f32_16x16x32_bf16 v[208:211], a[192:195], a[244:247], v[208:211]
    v_permlane32_swap_b32 v248, v249
    v_mfma_f32_16x16x32_bf16 v[208:211], a[204:207], a[248:251], v[208:211]
    v_max_f32 v248, v248, v249
    v_mul_f32 v236, s37, v248
    v_mfma_f32_16x16x32_bf16 v[204:207], a[196:199], a[244:247], v[204:207]
    v_fma_f32 v172, v172, s37, -v236
    v_fma_f32 v173, v173, s37, -v236
    v_mfma_f32_16x16x32_bf16 v[204:207], a[208:211], a[248:251], v[204:207]
    v_fma_f32 v174, v174, s37, -v236
    v_fma_f32 v175, v175, s37, -v236
    v_mfma_f32_16x16x32_bf16 v[200:203], a[200:203], a[244:247], v[200:203]
    v_cvt_pk_bf16_f32 v138, v208, v209
    v_cvt_pk_bf16_f32 v139, v210, v211
    v_mfma_f32_16x16x32_bf16 v[200:203], a[212:215], a[248:251], v[200:203]
    s_waitcnt lgkmcnt(2)
    ds_read_b128 a[244:247], v239 offset:14336
    ds_read_b128 a[248:251], v240 offset:14336
    v_mfma_f32_16x16x32_bf16 v[220:223], a[220:223], a[252:255], 0
    v_cvt_pk_bf16_f32 v140, v204, v205
    v_cvt_pk_bf16_f32 v141, v206, v207
    v_mfma_f32_16x16x32_bf16 v[212:215], a[220:223], v[252:255], 0
    v_exp_f32 v172, v172
    v_mfma_f32_16x16x32_bf16 v[216:219], a[224:227], a[252:255], 0
    v_cvt_pk_bf16_f32 v142, v200, v201
    v_cvt_pk_bf16_f32 v143, v202, v203
    v_mfma_f32_16x16x32_bf16 v[208:211], a[224:227], v[252:255], 0
    ds_read_b128 v[252:255], v240 offset:15360
    v_fma_f32 v144, v144, s37, -v236
    v_mfma_f32_16x16x32_bf16 v[204:207], a[228:231], a[252:255], 0
    v_exp_f32 v173, v173
    v_mfma_f32_16x16x32_bf16 v[200:203], a[232:235], a[252:255], 0
    s_waitcnt lgkmcnt(3)
    ds_read_b128 a[252:255], v239 offset:15360
    v_cvt_pk_bf16_f32 v176, v172, v173
    v_mfma_f32_16x16x32_bf16 v[220:223], a[0:3], a[236:239], v[220:223]
    v_exp_f32 v174, v174
    v_mfma_f32_16x16x32_bf16 v[212:215], a[0:3], a[240:243], v[212:215]
    v_exp_f32 v175, v175
    v_mfma_f32_16x16x32_bf16 v[216:219], a[4:7], a[236:239], v[216:219]
    v_cvt_pk_bf16_f32 v177, v174, v175
    v_fma_f32 v145, v145, s37, -v236
    v_mfma_f32_16x16x32_bf16 v[208:211], a[4:7], a[240:243], v[208:211]
    ds_read_b128 a[240:243], v240 offset:16384
    ds_read_b128 v[172:175], v234
    v_mfma_f32_16x16x32_bf16 v[204:207], a[8:11], a[236:239], v[204:207]
    v_bfe_u32 v234, s79, v233, 4
    v_mad_u32_u24 v234, v234, s40, v231
    v_mfma_f32_16x16x32_bf16 v[200:203], a[12:15], a[236:239], v[200:203]
    s_waitcnt lgkmcnt(4)
    ds_read_b128 a[236:239], v239 offset:16384
    v_fma_f32 v146, v146, s37, -v236
    v_mfma_f32_16x16x32_bf16 v[220:223], a[16:19], a[244:247], v[220:223]
    v_fma_f32 v147, v147, s37, -v236
    v_fma_f32 v148, v148, s37, -v236
    v_mfma_f32_16x16x32_bf16 v[212:215], a[16:19], a[248:251], v[212:215]
    v_exp_f32 v144, v144
    v_mfma_f32_16x16x32_bf16 v[216:219], a[20:23], a[244:247], v[216:219]
    v_exp_f32 v145, v145
    v_mfma_f32_16x16x32_bf16 v[208:211], a[20:23], a[248:251], v[208:211]
    ds_read_b128 a[248:251], v240 offset:17408
    v_cvt_pk_bf16_f32 v178, v144, v145
    v_mfma_f32_16x16x32_bf16 v[204:207], a[24:27], a[244:247], v[204:207]
    v_exp_f32 v146, v146
    v_mfma_f32_16x16x32_bf16 v[200:203], a[28:31], a[244:247], v[200:203]
    s_waitcnt lgkmcnt(4)
    ds_read_b128 a[244:247], v239 offset:17408
    v_fma_f32 v149, v149, s37, -v236
    v_mfma_f32_16x16x32_bf16 v[220:223], a[32:35], a[252:255], v[220:223]
    s_waitcnt lgkmcnt(3)
    v_exp_f32 v147, v147
    v_mfma_f32_16x16x32_bf16 v[172:175], v[36:39], v[138:141], v[172:175]
    v_cvt_pk_bf16_f32 v179, v146, v147
    v_fma_f32 v150, v150, s37, -v236
    v_mfma_f32_16x16x32_bf16 v[212:215], a[32:35], v[252:255], v[212:215]
    ds_read_b128 v[144:147], v230 offset:1280
    v_fma_f32 v151, v151, s37, -v236
    v_mfma_f32_16x16x32_bf16 v[196:199], a[216:219], v[176:179], 0
    v_exp_f32 v148, v148
    v_mfma_f32_16x16x32_bf16 v[184:187], v[74:77], v[176:179], 0
    v_exp_f32 v149, v149
    v_mfma_f32_16x16x32_bf16 v[188:191], v[96:99], v[176:179], 0
    v_exp_f32 v150, v150
    v_mfma_f32_16x16x32_bf16 v[192:195], v[118:121], v[176:179], 0
    v_exp_f32 v151, v151
    v_mfma_f32_16x16x16_bf16 v[172:175], v[40:41], v[142:143], v[172:175]
    v_cvt_pk_bf16_f32 v180, v148, v149
    v_cvt_pk_bf16_f32 v181, v150, v151
    v_mfma_f32_16x16x32_bf16 v[216:219], a[36:39], a[252:255], v[216:219]
    ds_read_b128 v[148:151], v235
    v_bfe_u32 v235, s80, v233, 4
    v_mfma_f32_16x16x32_bf16 v[208:211], a[36:39], v[252:255], v[208:211]
    ds_read_b128 v[252:255], v242 offset:61952
    v_mad_u32_u24 v235, v235, s40, v231
    v_mfma_f32_16x16x32_bf16 v[204:207], a[40:43], a[252:255], v[204:207]
    s_waitcnt lgkmcnt(2)
    v_fma_f32 v152, v152, s37, -v236
    v_fma_f32 v153, v153, s37, -v236
    v_mfma_f32_16x16x32_bf16 v[144:147], v[42:45], v[138:141], v[144:147]
    v_fma_f32 v154, v154, s37, -v236
    v_fma_f32 v155, v155, s37, -v236
    v_mfma_f32_16x16x32_bf16 v[200:203], a[44:47], a[252:255], v[200:203]
    ds_read_b128 a[252:255], v242 offset:61440
    v_fma_f32 v156, v156, s37, -v236
    v_mfma_f32_16x16x32_bf16 v[220:223], a[48:51], a[236:239], v[220:223]
    v_exp_f32 v152, v152
    v_mfma_f32_16x16x16_bf16 v[144:147], v[46:47], v[142:143], v[144:147]
    v_exp_f32 v153, v153
    v_mfma_f32_16x16x32_bf16 v[212:215], a[48:51], a[240:243], v[212:215]
    v_exp_f32 v154, v154
    v_mfma_f32_16x16x32_bf16 v[216:219], a[52:55], a[236:239], v[216:219]
    s_waitcnt lgkmcnt(2)
    v_exp_f32 v155, v155
    v_mfma_f32_16x16x32_bf16 v[148:151], v[24:27], v[138:141], v[148:151]
    v_cvt_pk_bf16_f32 v182, v152, v153
    v_cvt_pk_bf16_f32 v183, v154, v155
    v_mfma_f32_16x16x32_bf16 v[208:211], a[52:55], a[240:243], v[208:211]
    ds_read_b128 v[152:155], v250
    v_fma_f32 v157, v157, s37, -v236
    v_mfma_f32_16x16x32_bf16 v[196:199], a[216:219], v[180:183], v[196:199]
    v_fma_f32 v158, v158, s37, -v236
    v_fma_f32 v159, v159, s37, -v236
    v_mfma_f32_16x16x32_bf16 v[184:187], v[78:81], v[180:183], v[184:187]
    v_exp_f32 v156, v156
    v_mfma_f32_16x16x32_bf16 v[188:191], v[100:103], v[180:183], v[188:191]
    v_exp_f32 v157, v157
    v_mfma_f32_16x16x32_bf16 v[192:195], v[122:125], v[180:183], v[192:195]
    v_exp_f32 v158, v158
    v_mfma_f32_16x16x16_bf16 v[148:151], v[28:29], v[142:143], v[148:151]
    v_exp_f32 v159, v159
    v_mfma_f32_16x16x32_bf16 v[204:207], a[56:59], a[236:239], v[204:207]
    v_cvt_pk_bf16_f32 v176, v156, v157
    v_cvt_pk_bf16_f32 v177, v158, v159
    v_mfma_f32_16x16x32_bf16 v[200:203], a[60:63], a[236:239], v[200:203]
    ds_read_b128 v[156:159], v234
    v_fma_f32 v160, v160, s37, -v236
    v_mfma_f32_16x16x32_bf16 v[220:223], a[64:67], a[244:247], v[220:223]
    s_waitcnt lgkmcnt(1)
    v_fma_f32 v161, v161, s37, -v236
    v_fma_f32 v162, v162, s37, -v236
    v_mfma_f32_16x16x32_bf16 v[152:155], v[30:33], v[138:141], v[152:155]
    v_fma_f32 v163, v163, s37, -v236
    v_fma_f32 v164, v164, s37, -v236
    v_mfma_f32_16x16x32_bf16 v[212:215], a[64:67], a[248:251], v[212:215]
    v_exp_f32 v160, v160
    v_mfma_f32_16x16x32_bf16 v[216:219], a[68:71], a[244:247], v[216:219]
    v_cvt_pk_bf16_f32 v220, v220, v221
    v_cvt_pk_bf16_f32 v221, v222, v223
    v_mfma_f32_16x16x16_bf16 v[152:155], v[34:35], v[142:143], v[152:155]
    v_exp_f32 v161, v161
    v_mfma_f32_16x16x32_bf16 v[208:211], a[68:71], a[248:251], v[208:211]
    v_exp_f32 v162, v162
    v_mfma_f32_16x16x32_bf16 v[204:207], a[252:255], a[244:247], v[204:207]
    v_cvt_pk_bf16_f32 v212, v212, v213
    v_cvt_pk_bf16_f32 v222, v216, v217
    v_mfma_f32_16x16x32_bf16 v[200:203], v[252:255], a[244:247], v[200:203]
    s_waitcnt lgkmcnt(0)
    v_cvt_pk_bf16_f32 v223, v218, v219
    v_cvt_pk_bf16_f32 v213, v214, v215
    v_mfma_f32_16x16x32_bf16 v[156:159], v[48:51], v[138:141], v[156:159]
    buffer_store_dwordx4 v[220:223], v243, s[20:23], s58 offen sc0 sc1
    v_cvt_pk_bf16_f32 v214, v208, v209
    v_cvt_pk_bf16_f32 v215, v210, v211
    v_cvt_pk_bf16_f32 v204, v204, v205
    v_cvt_pk_bf16_f32 v205, v206, v207
    v_cvt_pk_bf16_f32 v206, v200, v201
    v_mfma_f32_16x16x16_bf16 v[156:159], v[52:53], v[142:143], v[156:159]
    v_cvt_pk_bf16_f32 v207, v202, v203
    v_exp_f32 v163, v163
    v_cvt_pk_bf16_f32 v178, v160, v161
    v_cvt_pk_bf16_f32 v179, v162, v163
    ds_read_b128 v[160:163], v235
    v_fma_f32 v165, v165, s37, -v236
    v_mfma_f32_16x16x32_bf16 v[196:199], a[216:219], v[176:179], v[196:199]
    v_fma_f32 v166, v166, s37, -v236
    v_fma_f32 v167, v167, s37, -v236
    v_mfma_f32_16x16x32_bf16 v[184:187], v[66:69], v[176:179], v[184:187]
    v_exp_f32 v164, v164
    v_mfma_f32_16x16x32_bf16 v[188:191], v[88:91], v[176:179], v[188:191]
    v_exp_f32 v165, v165
    v_mfma_f32_16x16x32_bf16 v[192:195], v[110:113], v[176:179], v[192:195]
    s_waitcnt lgkmcnt(0)
    v_exp_f32 v166, v166
    v_exp_f32 v167, v167
    v_cvt_pk_bf16_f32 v180, v164, v165
    v_cvt_pk_bf16_f32 v181, v166, v167
    v_fma_f32 v168, v168, s37, -v236
    v_fma_f32 v169, v169, s37, -v236
    v_fma_f32 v170, v170, s37, -v236
    v_fma_f32 v171, v171, s37, -v236
    v_exp_f32 v168, v168
    v_exp_f32 v169, v169
    buffer_store_dwordx4 v[212:215], v245, s[20:23], s58 offen sc0 sc1
    v_mfma_f32_16x16x32_bf16 v[160:163], v[54:57], v[138:141], v[160:163]
    v_exp_f32 v170, v170
    v_exp_f32 v171, v171
    v_cvt_pk_bf16_f32 v182, v168, v169
    v_cvt_pk_bf16_f32 v183, v170, v171
    v_max3_f32 v248, v172, v173, v174
    v_max3_f32 v249, v175, v144, v145
    v_mfma_f32_16x16x16_bf16 v[160:163], v[58:59], v[142:143], v[160:163]
    v_max3_f32 v248, v248, v146, v147
    v_max3_f32 v249, v249, v148, v149
    v_mfma_f32_16x16x32_bf16 v[196:199], a[216:219], v[180:183], v[196:199]
    v_max3_f32 v248, v248, v150, v151
    v_max3_f32 v249, v249, v152, v153
    v_mfma_f32_16x16x32_bf16 v[184:187], v[70:73], v[180:183], v[184:187]
    v_max3_f32 v248, v248, v154, v155
    v_max3_f32 v249, v249, v156, v157
    v_mfma_f32_16x16x32_bf16 v[188:191], v[92:95], v[180:183], v[188:191]
    v_max3_f32 v248, v248, v158, v159
    v_max3_f32 v249, v249, v160, v161
    v_mfma_f32_16x16x32_bf16 v[192:195], v[114:117], v[180:183], v[192:195]
    v_rcp_f32 v197, v196
    v_max3_f32 v248, v248, v162, v163
    v_mul_f32 v184, v184, v197
    v_mul_f32 v185, v185, v197
    v_cvt_pk_bf16_f32 v184, v184, v185
    v_mul_f32 v186, v186, v197
    v_mul_f32 v187, v187, v197
    v_cvt_pk_bf16_f32 v185, v186, v187
    v_mul_f32 v188, v188, v197
    v_mul_f32 v189, v189, v197
    v_cvt_pk_bf16_f32 v186, v188, v189
    v_mul_f32 v190, v190, v197
    v_mul_f32 v191, v191, v197
    v_cvt_pk_bf16_f32 v187, v190, v191
    buffer_store_dwordx4 v[204:207], v244, s[20:23], s58 offen sc0 sc1
    v_mul_f32 v192, v192, v197
    v_mul_f32 v193, v193, v197
    v_cvt_pk_bf16_f32 v188, v192, v193
    v_mul_f32 v194, v194, v197
    v_mul_f32 v195, v195, v197
    v_cvt_pk_bf16_f32 v189, v194, v195
    ds_write_b128 v237, v[184:187]
    ds_write_b64 v238, v[188:189]
    s_add_u32 s58, s51, 0x1f8000
    v_max_f32 v248, v248, v249
    v_mov_b32 v249, v248
    s_nop 1
    v_permlane16_swap_b32 v248, v249
    v_max_f32 v248, v248, v249
    v_mov_b32 v249, v248
    s_nop 1
    v_permlane32_swap_b32 v248, v249
    v_max_f32 v248, v248, v249
    v_mul_f32 v236, s37, v248
    v_fma_f32 v172, v172, s37, -v236
    v_fma_f32 v173, v173, s37, -v236
    v_fma_f32 v174, v174, s37, -v236
    v_fma_f32 v175, v175, s37, -v236
    v_exp_f32 v172, v172
    v_exp_f32 v173, v173
    v_exp_f32 v174, v174
    v_exp_f32 v175, v175
    v_cvt_pk_bf16_f32 v176, v172, v173
    v_cvt_pk_bf16_f32 v177, v174, v175
    v_fma_f32 v144, v144, s37, -v236
    v_fma_f32 v145, v145, s37, -v236
    v_fma_f32 v146, v146, s37, -v236
    v_fma_f32 v147, v147, s37, -v236
    v_exp_f32 v144, v144
    v_exp_f32 v145, v145
    v_exp_f32 v146, v146
    v_exp_f32 v147, v147
    v_cvt_pk_bf16_f32 v178, v144, v145
    v_cvt_pk_bf16_f32 v179, v146, v147
    v_fma_f32 v148, v148, s37, -v236
    s_waitcnt lgkmcnt(0)
    s_barrier
    v_mfma_f32_16x16x32_bf16 v[196:199], a[216:219], v[176:179], 0
    ds_read_b128 a[236:239], v224
    ds_read_b128 a[240:243], v224 offset:1024
    v_mfma_f32_16x16x32_bf16 v[184:187], v[76:79], v[176:179], 0
    ds_read_b128 a[244:247], v224 offset:2048
    v_fma_f32 v149, v149, s37, -v236
    v_mfma_f32_16x16x32_bf16 v[188:191], v[98:101], v[176:179], 0
    ds_read_b128 a[248:251], v224 offset:3072
    v_fma_f32 v150, v150, s37, -v236
    v_mfma_f32_16x16x32_bf16 v[192:195], v[120:123], v[176:179], 0
    s_waitcnt lgkmcnt(3)
    ds_read_b128 a[252:255], v224 offset:4096
    v_fma_f32 v151, v151, s37, -v236
    v_exp_f32 v148, v148
    ds_read_b128 v[252:255], v224 offset:5120
    v_exp_f32 v149, v149
    v_exp_f32 v150, v150
    v_exp_f32 v151, v151
    v_cvt_pk_bf16_f32 v180, v148, v149
    v_cvt_pk_bf16_f32 v181, v150, v151
    v_fma_f32 v152, v152, s37, -v236
    v_fma_f32 v153, v153, s37, -v236
    v_fma_f32 v154, v154, s37, -v236
    v_fma_f32 v155, v155, s37, -v236
    v_exp_f32 v152, v152
    v_mfma_f32_16x16x32_bf16 v[220:223], a[220:223], a[236:239], 0
    v_exp_f32 v153, v153
    v_mfma_f32_16x16x32_bf16 v[216:219], a[224:227], a[236:239], 0
    v_exp_f32 v154, v154
    v_mfma_f32_16x16x32_bf16 v[212:215], a[228:231], a[236:239], 0
    v_exp_f32 v155, v155
    v_mfma_f32_16x16x32_bf16 v[208:211], a[232:235], a[236:239], 0
    s_waitcnt lgkmcnt(3)
    ds_read_b128 a[236:239], v242 offset:61440
    v_cvt_pk_bf16_f32 v182, v152, v153
    v_mfma_f32_16x16x32_bf16 v[220:223], a[0:3], a[240:243], v[220:223]
    v_cvt_pk_bf16_f32 v183, v154, v155
    v_fma_f32 v156, v156, s37, -v236
    v_mfma_f32_16x16x32_bf16 v[216:219], a[4:7], a[240:243], v[216:219]
    v_fma_f32 v157, v157, s37, -v236
    v_fma_f32 v158, v158, s37, -v236
    v_mfma_f32_16x16x32_bf16 v[196:199], a[216:219], v[180:183], v[196:199]
    v_fma_f32 v159, v159, s37, -v236
    v_fma_f32 v160, v160, s37, -v236
    v_mfma_f32_16x16x32_bf16 v[184:187], v[68:71], v[180:183], v[184:187]
    v_exp_f32 v156, v156
    v_mfma_f32_16x16x32_bf16 v[188:191], v[90:93], v[180:183], v[188:191]
    v_exp_f32 v157, v157
    v_mfma_f32_16x16x32_bf16 v[192:195], v[112:115], v[180:183], v[192:195]
    v_exp_f32 v158, v158
    v_mfma_f32_16x16x32_bf16 v[212:215], a[8:11], a[240:243], v[212:215]
    v_exp_f32 v159, v159
    v_mfma_f32_16x16x32_bf16 v[208:211], a[12:15], a[240:243], v[208:211]
    ds_read_b128 a[240:243], v242 offset:61952
    v_cvt_pk_bf16_f32 v176, v156, v157
    v_mfma_f32_16x16x32_bf16 v[220:223], a[16:19], a[244:247], v[220:223]
    v_cvt_pk_bf16_f32 v177, v158, v159
    v_fma_f32 v161, v161, s37, -v236
    v_mfma_f32_16x16x32_bf16 v[216:219], a[20:23], a[244:247], v[216:219]
    v_fma_f32 v162, v162, s37, -v236
    v_fma_f32 v163, v163, s37, -v236
    v_mfma_f32_16x16x32_bf16 v[212:215], a[24:27], a[244:247], v[212:215]
    v_exp_f32 v160, v160
    v_mfma_f32_16x16x32_bf16 v[208:211], a[28:31], a[244:247], v[208:211]
    s_waitcnt lgkmcnt(1)
    v_exp_f32 v161, v161
    v_mfma_f32_16x16x32_bf16 v[220:223], a[32:35], a[248:251], v[220:223]
    v_exp_f32 v162, v162
    v_mfma_f32_16x16x32_bf16 v[216:219], a[36:39], a[248:251], v[216:219]
    v_exp_f32 v163, v163
    v_mfma_f32_16x16x32_bf16 v[212:215], a[40:43], a[248:251], v[212:215]
    v_cvt_pk_bf16_f32 v178, v160, v161
    v_cvt_pk_bf16_f32 v179, v162, v163
    v_mfma_f32_16x16x32_bf16 v[208:211], a[44:47], a[248:251], v[208:211]
    v_mfma_f32_16x16x32_bf16 v[220:223], a[48:51], a[252:255], v[220:223]
    v_mfma_f32_16x16x32_bf16 v[196:199], a[216:219], v[176:179], v[196:199]
    v_mfma_f32_16x16x32_bf16 v[184:187], v[82:85], v[176:179], v[184:187]
    v_mfma_f32_16x16x32_bf16 v[188:191], v[104:107], v[176:179], v[188:191]
    v_mfma_f32_16x16x32_bf16 v[192:195], v[126:129], v[176:179], v[192:195]
    v_mfma_f32_16x16x32_bf16 v[216:219], a[52:55], a[252:255], v[216:219]
    v_mfma_f32_16x16x32_bf16 v[212:215], a[56:59], a[252:255], v[212:215]
    v_mfma_f32_16x16x32_bf16 v[208:211], a[60:63], a[252:255], v[208:211]
    v_mfma_f32_16x16x32_bf16 v[220:223], a[64:67], v[252:255], v[220:223]
    v_mfma_f32_16x16x32_bf16 v[216:219], a[68:71], v[252:255], v[216:219]
    v_rcp_f32 v197, v196
    v_mfma_f32_16x16x32_bf16 v[212:215], a[236:239], v[252:255], v[212:215]
    s_waitcnt lgkmcnt(0)
    v_mul_f32 v184, v184, v197
    v_mul_f32 v185, v185, v197
    v_mfma_f32_16x16x32_bf16 v[208:211], a[240:243], v[252:255], v[208:211]
    v_cvt_pk_bf16_f32 v184, v184, v185
    v_mul_f32 v186, v186, v197
    v_cvt_pk_bf16_f32 v220, v220, v221
    v_cvt_pk_bf16_f32 v221, v222, v223
    v_cvt_pk_bf16_f32 v222, v216, v217
    v_cvt_pk_bf16_f32 v223, v218, v219
    buffer_store_dwordx4 v[220:223], v225, s[20:23], s58 offen sc0 sc1
    v_cvt_pk_bf16_f32 v212, v212, v213
    v_cvt_pk_bf16_f32 v213, v214, v215
    v_cvt_pk_bf16_f32 v214, v208, v209
    v_cvt_pk_bf16_f32 v215, v210, v211
    v_mul_f32 v187, v187, v197
    v_cvt_pk_bf16_f32 v185, v186, v187
    v_mul_f32 v188, v188, v197
    v_mul_f32 v189, v189, v197
    v_cvt_pk_bf16_f32 v186, v188, v189
    v_mul_f32 v190, v190, v197
    v_mul_f32 v191, v191, v197
    v_cvt_pk_bf16_f32 v187, v190, v191
    v_mul_f32 v192, v192, v197
    v_mul_f32 v193, v193, v197
    v_cvt_pk_bf16_f32 v188, v192, v193
    v_mul_f32 v194, v194, v197
    v_mul_f32 v195, v195, v197
    v_cvt_pk_bf16_f32 v189, v194, v195
    ds_write_b128 v237, v[184:187] offset:6144
    ds_write_b64 v238, v[188:189] offset:6144
    buffer_store_dwordx4 v[212:215], v226, s[20:23], s58 offen sc0 sc1
    s_add_u32 s58, s51, 0x1f8000
    s_waitcnt lgkmcnt(0)
    s_barrier
    ds_read_b128 a[244:247], v227
    ds_read_b128 a[248:251], v227 offset:1024
    ds_read_b128 a[252:255], v227 offset:2048
    ds_read_b128 v[252:255], v227 offset:3072
    ds_read_b128 a[236:239], v227 offset:4096
    ds_read_b128 a[240:243], v227 offset:5120
    s_waitcnt lgkmcnt(5)
    v_mfma_f32_16x16x32_bf16 v[204:207], a[220:223], a[244:247], 0
    v_mfma_f32_16x16x32_bf16 v[200:203], a[224:227], a[244:247], 0
    v_mfma_f32_16x16x32_bf16 v[220:223], a[228:231], a[244:247], 0
    v_mfma_f32_16x16x32_bf16 v[216:219], a[232:235], a[244:247], 0
    s_waitcnt lgkmcnt(3)
    ds_read_b128 a[244:247], v242 offset:61440
    v_mfma_f32_16x16x32_bf16 v[204:207], a[0:3], a[248:251], v[204:207]
    v_mfma_f32_16x16x32_bf16 v[200:203], a[4:7], a[248:251], v[200:203]
    v_mfma_f32_16x16x32_bf16 v[220:223], a[8:11], a[248:251], v[220:223]
    v_mfma_f32_16x16x32_bf16 v[216:219], a[12:15], a[248:251], v[216:219]
    ds_read_b128 a[248:251], v242 offset:61952
    v_mfma_f32_16x16x32_bf16 v[204:207], a[16:19], a[252:255], v[204:207]
    v_mfma_f32_16x16x32_bf16 v[200:203], a[20:23], a[252:255], v[200:203]
    v_mfma_f32_16x16x32_bf16 v[220:223], a[24:27], a[252:255], v[220:223]
    v_mfma_f32_16x16x32_bf16 v[216:219], a[28:31], a[252:255], v[216:219]
    s_waitcnt lgkmcnt(2)
    v_mfma_f32_16x16x32_bf16 v[204:207], a[32:35], v[252:255], v[204:207]
    v_mfma_f32_16x16x32_bf16 v[200:203], a[36:39], v[252:255], v[200:203]
    v_mfma_f32_16x16x32_bf16 v[220:223], a[40:43], v[252:255], v[220:223]
    v_mfma_f32_16x16x32_bf16 v[216:219], a[44:47], v[252:255], v[216:219]
    v_mfma_f32_16x16x32_bf16 v[204:207], a[48:51], a[236:239], v[204:207]
    v_mfma_f32_16x16x32_bf16 v[200:203], a[52:55], a[236:239], v[200:203]
    v_mfma_f32_16x16x32_bf16 v[220:223], a[56:59], a[236:239], v[220:223]
    v_mfma_f32_16x16x32_bf16 v[216:219], a[60:63], a[236:239], v[216:219]
    v_mfma_f32_16x16x32_bf16 v[204:207], a[64:67], a[240:243], v[204:207]
    v_mfma_f32_16x16x32_bf16 v[200:203], a[68:71], a[240:243], v[200:203]
    s_waitcnt lgkmcnt(0)
    v_mfma_f32_16x16x32_bf16 v[220:223], a[244:247], a[240:243], v[220:223]
    v_mfma_f32_16x16x32_bf16 v[216:219], a[248:251], a[240:243], v[216:219]
    s_nop 4
    v_cvt_pk_bf16_f32 v204, v204, v205
    v_cvt_pk_bf16_f32 v205, v206, v207
    v_cvt_pk_bf16_f32 v206, v200, v201
    v_cvt_pk_bf16_f32 v207, v202, v203
    buffer_store_dwordx4 v[204:207], v246, s[20:23], s58 offen sc0 sc1
    v_cvt_pk_bf16_f32 v220, v220, v221
    v_cvt_pk_bf16_f32 v221, v222, v223
    v_cvt_pk_bf16_f32 v222, v216, v217
    v_cvt_pk_bf16_f32 v223, v218, v219
    buffer_store_dwordx4 v[220:223], v247, s[20:23], s58 offen sc0 sc1
    s_endpgm
.section .rodata,"a"
.p2align 6
.amdhsa_kernel standalone__neighborhood_dinat__vision_kernel
  .amdhsa_next_free_vgpr 512
  .amdhsa_next_free_sgpr 102
  .amdhsa_accum_offset 256
  .amdhsa_group_segment_fixed_size 0
  .amdhsa_kernarg_size 56
  .amdhsa_user_sgpr_count 2
  .amdhsa_user_sgpr_kernarg_segment_ptr 1
  .amdhsa_system_sgpr_workgroup_id_x 1
.end_amdhsa_kernel
```

```asm
; @launch grid=(256,1,1) block=(256,1,1) lds=163344
.amdgcn_target "amdgcn-amd-amdhsa--gfx950"
.text
.globl standalone__neighborhood_dinat__vision_kernel
.p2align 8
.type standalone__neighborhood_dinat__vision_kernel,@function
standalone__neighborhood_dinat__vision_kernel:
    s_cmp_ge_u32 s2, 256
    s_cbranch_scc1 L_exit
L_go:
    s_load_dwordx2 s[8:9], s[0:1], 8
    s_load_dwordx2 s[4:5], s[0:1], 0
    s_load_dwordx2 s[16:17], s[0:1], 24
    s_load_dwordx2 s[12:13], s[0:1], 16
    s_load_dwordx2 s[20:21], s[0:1], 32
    s_getpc_b64 s[24:25]
    s_mov_b32 s26, L_end-L_go-64
    s_mov_b32 s27, 0x20000
    s_lshl_b32 s52, s2, 10
    v_lshlrev_b32 v189, 5, v0
    s_and_b32 s53, s52, 0xe000
    buffer_load_dword v188, v189, s[24:27], s53 offen
    v_lshrrev_b32 v74, 6, v0
    v_and_b32 v60, 63, v0
    v_readfirstlane_b32 s36, v74
    v_mul_u32_u24 v76, 0x2aab, v60
    v_lshrrev_b32 v76, 16, v76
    v_mul_u32_u24 v74, 6, v76
    v_sub_u32 v77, v60, v74
    v_lshrrev_b32 v74, 1, v76
    v_and_b32 v74, 4, v74
    v_xor_b32 v76, v76, v74
    v_mul_u32_u24 v74, 0x480, v76
    v_lshl_add_u32 v251, v77, 4, v74
    v_add_u32 v79, 64, v60
    v_mul_u32_u24 v78, 0x2aab, v79
    v_lshrrev_b32 v78, 16, v78
    v_mul_u32_u24 v74, 6, v78
    v_sub_u32 v79, v60, v74
    v_lshrrev_b32 v74, 1, v78
    v_and_b32 v74, 4, v74
    v_xor_b32 v78, v78, v74
    v_mul_u32_u24 v74, 0x480, v78
    v_lshl_add_u32 v252, v79, 4, v74
    v_add_u32 v81, 0x80, v60
    v_mul_u32_u24 v80, 0x2aab, v81
    v_lshrrev_b32 v80, 16, v80
    v_mul_u32_u24 v74, 6, v80
    v_sub_u32 v81, v60, v74
    v_lshrrev_b32 v74, 1, v80
    v_and_b32 v74, 4, v74
    v_xor_b32 v80, v80, v74
    v_mul_u32_u24 v74, 0x480, v80
    v_lshl_add_u32 v253, v81, 4, v74
    s_mul_i32 s49, s36, 0x60
    s_mul_i32 s50, s36, 0xc00
    s_add_u32 s50, s50, 0x15e00
    s_mov_b32 s10, 0x36000
    s_mov_b32 s11, 0x20000
    s_mov_b32 s6, 0x1260400
    s_mov_b32 s7, 0x20000
    s_mov_b32 s18, 0x548
    s_mov_b32 s19, 0x20000
    s_mov_b32 s14, 0x12000
    s_mov_b32 s15, 0x20000
    s_mov_b32 s22, 0x1260000
    s_mov_b32 s23, 0x20000
    s_and_b32 s53, s52, 0x3e000
    s_mul_i32 s58, s36, 0x152
    v_lshlrev_b32 v199, 1, v60
    s_add_u32 s57, s49, 0x180
    s_add_u32 m0, s50, 0
    s_bfe_u32 s35, s2, 0x30003
    s_lshr_b32 s55, s2, 6
    s_and_b32 s54, s2, 1
    s_lshl2_add_u32 s34, s54, s55
    s_and_b32 s46, s55, 1
    s_bfe_u32 s54, s2, 0x10002
    s_mul_i32 s54, s54, 0x15000
    s_bfe_u32 s55, s2, 0x10001
    s_mul_i32 s55, s55, 0x180
    s_add_u32 s38, s54, s55
    s_lshl_b32 s41, s36, 11
    s_min_u32 s41, s41, 0x1600
    s_mul_i32 s54, s35, 14
    s_sub_u32 s54, s54, 3
    s_lshr_b32 s55, s41, 4
    v_add_u32 v99, s55, v60
    v_mul_u32_u24 v97, 0xaab, v99
    v_lshrrev_b32 v97, 16, v97
    v_mul_u32_u24 v98, 24, v97
    v_sub_u32 v96, v99, v98
    v_and_or_b32 v98, 2, v97, 64
    v_xor_b32 v96, v96, v98
    v_add_u32 v97, s54, v97
    v_add_u32 v99, 64, v99
    s_mul_i32 s51, s34, 0x24c000
    s_add_u32 s51, s51, s38
    s_mul_i32 s55, s46, 0x222000
    s_add_u32 s56, s51, s55
    s_mul_i32 s42, s46, 0xfffac000
    s_add_u32 s42, s42, 0x2a000
    s_waitcnt lgkmcnt(0)
    buffer_load_dword v188, v189, s[8:11], s53 offen
    buffer_load_ushort v196, v199, s[16:19], s58 offen
    buffer_load_ushort v197, v199, s[16:19], s58 offen offset:128
    buffer_load_ushort v198, v199, s[16:19], s58 offen offset:256
    buffer_load_dwordx4 v251, s[8:11], s57 offen lds
    s_movk_i32 s53, 0x6f
    v_med3_i32 v97, v97, 0, s53
    v_mul_u32_u24 v97, 0x300, v97
    v_lshl_add_u32 v246, v96, 4, v97
    v_mul_u32_u24 v97, 0xaab, v99
    buffer_load_dwordx4 v252, s[8:11], s57 offen offset:1024 lds
    v_lshrrev_b32 v97, 16, v97
    v_mul_u32_u24 v98, 24, v97
    v_sub_u32 v96, v99, v98
    v_and_b32 v98, 2, v97
    v_xor_b32 v96, v96, v98
    v_add_u32 v97, s54, v97
    v_med3_i32 v97, v97, 0, s53
    buffer_load_dwordx4 v253, s[8:11], s57 offen offset:2048 lds
    v_mul_u32_u24 v97, 0x300, v97
    v_lshl_add_u32 v247, v96, 4, v97
    s_sub_u32 s4, s4, 0x400
    s_subb_u32 s5, s5, 0
    s_mul_i32 s55, s46, 7
    s_cmp_eq_u32 s34, s55
    s_cselect_b32 s43, 5, -3
    s_cselect_b32 s45, 0, -1
    s_cselect_b32 s47, 1, 0
    s_mul_i32 s43, s43, s42
    s_add_u32 s43, s43, s56
    s_mul_i32 s45, s45, s42
    s_add_u32 s45, s45, s56
    s_add_u32 s44, s43, s42
    s_add_u32 m0, s41, 0
    s_add_u32 s57, s49, 0x9180
    buffer_load_dwordx4 v246, s[4:7], s43 offen lds
    s_and_b32 s52, s52, 0x1e000
    v_lshrrev_b32 v61, 4, v60
    v_and_b32 v62, 7, v60
    v_bfe_u32 v63, v60, 3, 1
    v_bfe_u32 v96, v60, 2, 2
    v_and_b32 v97, 3, v60
    v_and_b32 v103, 1, v61
    buffer_load_dwordx4 v247, s[4:7], s43 offen offset:1024 lds
    s_add_u32 m0, s41, 0x1e40
    v_lshl_add_u32 v99, v61, 3, v96
    v_lshl_add_u32 v99, v103, 2, v99
    v_lshl_add_u32 v101, v97, 3, s50
    s_movk_i32 s27, 0x60
    v_mad_u32_u24 v254, v99, s27, v101
    v_xor_b32 v99, 4, v99
    v_mad_u32_u24 v255, v99, s27, v101
    buffer_load_dwordx4 v246, s[4:7], s44 offen lds
    v_mul_u32_u24 v102, 0x1e40, v63
    v_and_b32 v98, 2, v60
    v_xor_b32 v98, v98, v61
    v_lshlrev_b32 v98, 4, v98
    v_mul_u32_u24 v100, 0x180, v62
    v_add3_u32 v224, v98, v100, v102
    v_mul_u32_u24 v99, 0x1e40, v96
    buffer_load_dwordx4 v247, s[4:7], s44 offen offset:1024 lds
    s_add_u32 m0, s41, 0x3c80
    v_mul_u32_u24 v227, 0x180, v97
    v_add3_u32 v227, v227, v98, v99
    s_cmp_eq_u32 s35, 0
    s_cselect_b32 s29, 3, 0
    s_cselect_b32 s30, -3, -2
    s_mul_i32 s32, s36, 0xf00
    s_add_u32 s32, s32, 0xf200
    s_mov_b32 s40, 0x140
    s_lshl_b32 s31, s36, 10
    s_add_u32 s31, s31, 0x12e40
    v_mul_u32_u24 v119, 13, v60
    buffer_load_dwordx4 v246, s[4:7], s45 offen lds
    v_lshrrev_b32 v119, 8, v119
    v_mul_u32_u24 v118, 20, v119
    v_sub_u32 v118, v60, v118
    v_add_u32 v120, -11, v118
    v_max_i32 v120, 0, v120
    v_mul_u32_u24 v121, 11, v120
    v_lshrrev_b32 v121, 5, v121
    buffer_load_dwordx4 v247, s[4:7], s45 offen offset:1024 lds
    s_add_u32 m0, s41, 0x5ac0
    v_mul_u32_u24 v122, 3, v121
    v_sub_u32 v120, v120, v122
    v_lshlrev_b32 v120, 2, v120
    v_sub_u32 v121, v120, v121
    v_cmp_lt_u32 vcc, 10, v118
    v_add_u32 v121, s29, v121
    v_add_u32 v120, s30, v120
    buffer_load_dwordx4 v246, s[4:7], s56 offen lds
    v_add_u32 v122, -3, v118
    v_cndmask_b32 v121, v118, v121, vcc
    v_cndmask_b32 v120, v122, v120, vcc
    v_cmp_gt_u32 s[60:61], 7, v120
    v_add_u32 v120, 1, v120
    v_cmp_gt_u32 s[62:63], 7, v120
    v_add_u32 v120, 1, v120
    buffer_load_dwordx4 v247, s[4:7], s56 offen offset:1024 lds
    s_add_u32 m0, s50, 0x3000
    s_add_u32 s56, s56, s42
    v_cmp_gt_u32 s[64:65], 7, v120
    v_add_u32 v120, 1, v120
    v_cmp_gt_u32 s[66:67], 7, v120
    s_cmp_eq_u32 s46, 0
    s_cselect_b32 s28, 13, -13
    s_cselect_b32 s69, 0, 39
    v_add_u32 v119, 2, v119
    v_mad_i32_i24 v121, v119, s28, v121
    buffer_load_dwordx4 v251, s[8:11], s57 offen lds
    s_lshl4_add_u32 s69, s69, s31
    v_lshl_add_u32 v121, v121, 2, s69
    s_mul_i32 s69, s28, 12
    v_add_u32 v118, s69, v121
    v_add_u32 v119, s69, v118
    s_lshl_b32 s69, s28, 3
    v_add_u32 v122, s69, v119
    v_lshl_add_u32 v123, v60, 4, s32
    v_lshl_add_u32 v125, v60, 2, s31
    buffer_load_dwordx4 v252, s[8:11], s57 offen offset:1024 lds
    s_mov_b32 s68, 0x3fb8aa3b
    v_mul_u32_u24 v74, 0x180, v76
    v_lshl_add_u32 v192, v77, 4, v74
    v_mul_u32_u24 v74, 0x180, v78
    v_lshl_add_u32 v193, v79, 4, v74
    v_mul_u32_u24 v74, 0x180, v80
    v_lshl_add_u32 v194, v81, 4, v74
    v_and_b32 v74, 16, v78
    buffer_load_dwordx4 v253, s[8:11], s57 offen offset:2048 lds
    s_add_u32 s57, s49, 0x12180
    v_mul_u32_u24 v74, 0x300, v74
    v_add_u32 v195, v74, v193
    v_add_u32 v98, 3, v62
    v_and_b32 v98, 2, v98
    v_xor_b32 v98, v98, v61
    v_lshl_add_u32 v98, v98, 4, v100
    v_add_u32 v225, v98, v102
    v_xor_b32 v99, 1, v63
    v_mul_u32_u24 v99, 0xd3c0, v99
    v_add_u32 v226, v98, v99
    s_mov_b32 s37, 0x3e553b95
    s_cmp_eq_u32 s35, 7
    s_cselect_b32 s33, 2, 64
    v_lshrrev_b32 v184, 1, v61
    v_lshl_add_u32 v185, v63, 1, v184
    v_lshlrev_b32 v232, 2, v185
    v_lshl_add_u32 v185, v63, 2, v61
    v_lshlrev_b32 v233, 2, v185
    v_sub_u32 v184, v184, v63
    v_mul_i32_i24 v184, 0x140, v184
    s_sub_u32 s24, s32, 0x140
    v_add_u32 v184, s24, v184
    v_lshl_add_u32 v185, v103, 2, 3
    v_cmp_gt_u32 vcc, s29, v62
    v_sub_u32 v186, v185, v62
    v_min_u32 v187, 10, v186
    v_mad_u32_u24 v190, v62, 3, v103
    v_add_u32 v191, 11, v190
    v_cndmask_b32 v187, v187, v191, vcc
    v_lshl_add_u32 v228, v187, 4, v184
    v_add_u32 v186, 8, v186
    v_min_u32 v187, 10, v186
    v_lshl_add_u32 v186, v103, 4, v62
    v_cmp_gt_u32 vcc, s29, v186
    v_add_u32 v191, 13, v190
    v_min_u32 v186, 5, v62
    v_cndmask_b32 v187, v187, v191, vcc
    v_lshl_add_u32 v229, v187, 4, v184
    v_cmp_lt_u32 vcc, s33, v186
    v_sub_u32 v187, v185, v186
    v_min_u32 v187, 10, v187
    v_mad_u32_u24 v190, v186, 3, 2
    v_add_u32 v191, v190, v103
    v_cndmask_b32 v187, v187, v191, vcc
    v_lshl_add_u32 v230, v187, 4, v184
    v_sub_u32 v187, 11, v186
    v_min_u32 v187, 10, v187
    v_add_u32 v191, 2, v190
    v_cndmask_b32 v187, v187, v191, vcc
    v_lshl_add_u32 v231, v187, 4, s32
    v_mov_b32 v96, 0x3f803f80
    v_accvgpr_write_b32 a216, v96
    v_accvgpr_write_b32 a217, v96
    v_accvgpr_write_b32 a218, v96
    v_accvgpr_write_b32 a219, v96
    v_mov_b32 v236, 1.0
    s_mov_b32 s69, 0x32104321
    s_and_b32 s24, s36, 1
    s_lshr_b32 s27, s36, 1
    v_lshlrev_b32 v167, 4, v60
    s_mul_i32 s25, s27, 0xc00
    s_add_u32 s25, s25, 0x12e00
    s_lshl_b32 s26, s24, 11
    s_add_u32 s26, s26, s25
    v_add_u32 v237, s26, v167
    s_lshl3_add_u32 s26, s24, s25
    s_add_u32 s26, s26, 0x400
    v_add_u32 v238, s26, v167
    s_mul_i32 s25, s24, 0x1800
    s_add_u32 s26, s25, 0x12e00
    v_add_u32 v239, s26, v167
    s_sub_u32 s25, 0x14600, s25
    v_add_u32 v240, s25, v167
    v_lshrrev_b32 v167, 2, v60
    v_and_b32 v165, 3, v60
    v_and_b32 v166, 2, v61
    v_lshlrev_b32 v166, 1, v166
    v_xor_b32 v167, v167, v166
    v_mul_u32_u24 v167, 0x60, v167
    v_lshl_add_u32 v108, v165, 4, v167
    v_lshrrev_b32 v166, 1, v165
    v_mul_u32_u24 v166, 0xba0, v166
    s_mul_i32 s26, s27, 0x1800
    s_add_u32 s26, s26, 0x15e40
    v_add3_u32 v109, v108, v166, s26
    s_lshl_b32 s25, s24, 5
    v_bfrev_b32 v166, v165
    v_lshrrev_b32 v166, 27, v166
    v_add3_u32 v86, v167, v166, s50
    v_lshlrev_b32 v167, 7, v61
    v_lshl_add_u32 v167, v62, 4, v167
    v_lshl_add_u32 v166, v63, 9, v167
    v_add_u32 v87, s50, v166
    v_lshl_add_u32 v167, v63, 10, v167
    s_add_u32 s26, s26, 0x7c0
    v_add_u32 v242, s26, v167
    s_lshl_b32 s26, s24, 10
    s_add_u32 s26, s26, s50
    v_add_u32 v241, s26, v167
    v_xor_b32 v167, s46, v63
    v_mul_u32_u24 v167, 0x2a000, v167
    v_mul_u32_u24 v166, 0x300, v62
    v_lshl_add_u32 v167, v61, 4, v167
    v_cmp_lt_u32 vcc, 5, v62
    v_add_u32 v167, v167, v166
    v_add_u32 v166, 0x1800, v167
    v_bfrev_b32 v168, 1
    v_cndmask_b32 v166, v166, v168, vcc
    s_sub_u32 s59, 0, s24
    s_mov_b32 vcc_lo, s59
    s_mov_b32 vcc_hi, s59
    v_cndmask_b32 v168, v167, v166, vcc
    v_cndmask_b32 v169, v166, v167, vcc
    s_mov_b32 vcc_lo, s59
    s_mov_b32 vcc_hi, s59
    s_mul_i32 s26, s27, 0xc0
    s_add_u32 s26, s26, 64
    v_add_u32 v244, s26, v168
    s_lshl_b32 s48, s42, 1
    s_mov_b64 exec, 0
    s_cmp_eq_u32 s36, 0
    s_cbranch_scc1 L_pg1
    s_cmp_eq_u32 s36, 1
    s_cbranch_scc1 L_pg2
    s_cmp_eq_u32 s36, 2
    s_cbranch_scc1 L_pg3
    s_branch L_pg4
    .p2align 12
L_back:
    s_mov_b64 exec, -1
    s_add_u32 m0, s50, 0x6000
    s_waitcnt vmcnt(11)
    ds_read_b64_tr_b16 a[0:1], v254
    ds_read_b64_tr_b16 a[2:3], v255
    ds_read_b64_tr_b16 a[4:5], v254 offset:32
    ds_read_b64_tr_b16 a[6:7], v255 offset:32
    ds_read_b64_tr_b16 a[8:9], v254 offset:64
    ds_read_b64_tr_b16 a[10:11], v255 offset:64
    s_waitcnt vmcnt(3)
    s_barrier
    buffer_load_dwordx4 v251, s[8:11], s57 offen lds
    buffer_load_dwordx4 v252, s[8:11], s57 offen offset:1024 lds
    ds_read_b128 a[236:239], v224
    ds_read_b128 a[240:243], v224 offset:3072
    ds_read_b128 a[244:247], v224 offset:15488
    ds_read_b128 a[248:251], v224 offset:18560
    ds_read_b128 a[252:255], v227 offset:6144
    buffer_load_dwordx4 v253, s[8:11], s57 offen offset:2048 lds
    s_add_u32 s57, s49, 0x1b180
    s_add_u32 m0, s50, 0x9000
    ds_read_b128 a[220:223], v224 offset:64
    ds_read_b128 a[224:227], v224 offset:3136
    ds_read_b128 a[228:231], v224 offset:15552
    ds_read_b128 a[232:235], v224 offset:18624
    buffer_load_dwordx4 v251, s[8:11], s57 offen lds
    s_waitcnt lgkmcnt(8)
    v_mfma_f32_16x16x32_bf16 v[12:15], a[0:3], a[236:239], 0
    v_mfma_f32_16x16x32_bf16 v[16:19], a[4:7], a[236:239], 0
    v_mfma_f32_16x16x32_bf16 v[20:23], a[8:11], a[236:239], 0
    s_waitcnt vmcnt(4) lgkmcnt(7)
    ds_read_b64_tr_b16 a[12:13], v254 offset:12288
    ds_read_b64_tr_b16 a[14:15], v255 offset:12288
    v_mfma_f32_16x16x32_bf16 v[36:39], a[0:3], a[240:243], 0
    ds_read_b64_tr_b16 a[16:17], v254 offset:12320
    ds_read_b64_tr_b16 a[18:19], v255 offset:12320
    v_mfma_f32_16x16x32_bf16 v[40:43], a[4:7], a[240:243], 0
    buffer_load_dwordx4 v252, s[8:11], s57 offen offset:1024 lds
    v_mfma_f32_16x16x32_bf16 v[44:47], a[8:11], a[240:243], 0
    s_waitcnt lgkmcnt(8)
    ds_read_b64_tr_b16 a[20:21], v254 offset:12352
    ds_read_b64_tr_b16 a[22:23], v255 offset:12352
    v_mfma_f32_16x16x32_bf16 v[132:135], a[0:3], a[244:247], 0
    ds_read_b128 a[236:239], v227 offset:6208
    ds_read_b128 a[240:243], v224 offset:128
    v_mfma_f32_16x16x32_bf16 v[136:139], a[4:7], a[244:247], 0
    v_mfma_f32_16x16x32_bf16 v[140:143], a[8:11], a[244:247], 0
    buffer_load_dwordx4 v253, s[8:11], s57 offen offset:2048 lds
    v_mfma_f32_16x16x32_bf16 v[220:223], a[0:3], a[248:251], 0
    s_add_u32 s57, s49, 0x24180
    ds_read_b128 a[244:247], v224 offset:3200
    s_add_u32 m0, s50, 0xc000
    v_mfma_f32_16x16x32_bf16 v[216:219], a[4:7], a[248:251], 0
    v_mfma_f32_16x16x32_bf16 v[212:215], a[8:11], a[248:251], 0
    ds_read_b128 a[248:251], v224 offset:15616
    v_mfma_f32_16x16x32_bf16 v[208:211], a[0:3], a[252:255], 0
    buffer_load_dwordx4 v251, s[8:11], s57 offen lds
    v_mfma_f32_16x16x32_bf16 v[204:207], a[4:7], a[252:255], 0
    v_mfma_f32_16x16x32_bf16 v[200:203], a[8:11], a[252:255], 0
    s_waitcnt lgkmcnt(5)
    ds_read_b128 a[252:255], v224 offset:18688
    v_mfma_f32_16x16x32_bf16 v[12:15], a[12:15], a[220:223], v[12:15]
    v_mfma_f32_16x16x32_bf16 v[16:19], a[16:19], a[220:223], v[16:19]
    s_waitcnt lgkmcnt(4)
    buffer_load_dwordx4 v252, s[8:11], s57 offen offset:1024 lds
    v_mfma_f32_16x16x32_bf16 v[20:23], a[20:23], a[220:223], v[20:23]
    ds_read_b128 a[220:223], v227 offset:6272
    v_mfma_f32_16x16x32_bf16 v[36:39], a[12:15], a[224:227], v[36:39]
    v_mfma_f32_16x16x32_bf16 v[40:43], a[16:19], a[224:227], v[40:43]
    v_mfma_f32_16x16x32_bf16 v[44:47], a[20:23], a[224:227], v[44:47]
    ds_read_b128 a[224:227], v224 offset:192
    v_mfma_f32_16x16x32_bf16 v[132:135], a[12:15], a[228:231], v[132:135]
    buffer_load_dwordx4 v253, s[8:11], s57 offen offset:2048 lds
    v_mfma_f32_16x16x32_bf16 v[136:139], a[16:19], a[228:231], v[136:139]
    s_add_u32 s57, s49, 0x2d180
    s_add_u32 m0, s50, 0xf000
    v_lshlrev_b32 v196, 16, v196
    v_mfma_f32_16x16x32_bf16 v[140:143], a[20:23], a[228:231], v[140:143]
    s_and_b32 s72, s60, 0xfff00000
    ds_read_b128 a[228:231], v224 offset:3264
    v_mul_f32 v196, s68, v196
    v_mfma_f32_16x16x32_bf16 v[220:223], a[12:15], a[232:235], v[220:223]
    s_and_b32 s70, s62, 0xfff00000
    ds_write_b32 v125, v196
    v_mfma_f32_16x16x32_bf16 v[216:219], a[16:19], a[232:235], v[216:219]
    buffer_load_dwordx4 v251, s[8:11], s57 offen lds
    v_mfma_f32_16x16x32_bf16 v[212:215], a[20:23], a[232:235], v[212:215]
    ds_read_b128 a[232:235], v224 offset:15680
    v_lshlrev_b32 v197, 16, v197
    v_mfma_f32_16x16x32_bf16 v[208:211], a[12:15], a[236:239], v[208:211]
    v_mul_f32 v197, s68, v197
    v_lshlrev_b32 v198, 16, v198
    v_mfma_f32_16x16x32_bf16 v[204:207], a[16:19], a[236:239], v[204:207]
    ds_write_b32 v125, v197 offset:256
    v_mfma_f32_16x16x32_bf16 v[200:203], a[20:23], a[236:239], v[200:203]
    s_waitcnt vmcnt(7)
    buffer_load_dwordx4 v252, s[8:11], s57 offen offset:1024 lds
    ds_read_b128 a[236:239], v224 offset:18752
    v_mul_f32 v198, s68, v198
    ds_write_b32 v125, v198 offset:512
    v_mov_b32 v124, 0xf149f2ca
    s_mov_b32 s68, 0x760007
    ds_read_b64_tr_b16 a[24:25], v254 offset:24576
    ds_read_b64_tr_b16 a[26:27], v255 offset:24576
    ds_read_b64_tr_b16 a[28:29], v254 offset:24608
    ds_read_b64_tr_b16 a[30:31], v255 offset:24608
    ds_read_b64_tr_b16 a[32:33], v254 offset:24640
    s_cmp_eq_u32 s47, 1
    s_cmov_b32 s68, 0x760097
    buffer_load_dwordx4 v253, s[8:11], s57 offen offset:2048 lds
    s_add_u32 m0, s41, 0x7900
    ds_read_b64_tr_b16 a[34:35], v255 offset:24640
    s_add_u32 s57, s49, 0x300
    ds_read2_b32 v[144:145], v121 offset0:0 offset1:1
    ds_read2_b32 v[146:147], v121 offset0:2 offset1:3
    ds_read2_b32 v[148:149], v118 offset0:0 offset1:1
    ds_read2_b32 v[150:151], v118 offset0:2 offset1:3
    ds_read2_b32 v[152:153], v119 offset0:0 offset1:1
    ds_read2_b32 v[154:155], v119 offset0:2 offset1:3
    ds_read2_b32 v[156:157], v122 offset0:0 offset1:1
    ds_read2_b32 v[158:159], v122 offset0:2 offset1:3
    buffer_load_dwordx4 v246, s[4:7], s56 offen lds
    s_waitcnt lgkmcnt(12)
    v_mfma_f32_16x16x32_bf16 v[12:15], a[24:27], a[240:243], v[12:15]
    s_waitcnt lgkmcnt(10)
    v_mfma_f32_16x16x32_bf16 v[16:19], a[28:31], a[240:243], v[16:19]
    s_waitcnt lgkmcnt(8)
    v_mfma_f32_16x16x32_bf16 v[20:23], a[32:35], a[240:243], v[20:23]
    s_waitcnt vmcnt(7)
    buffer_load_dwordx4 v247, s[4:7], s56 offen offset:1024 lds
    v_mfma_f32_16x16x32_bf16 v[36:39], a[24:27], a[244:247], v[36:39]
    s_add_u32 s56, s56, s42
    ds_read_b64_tr_b16 a[36:37], v254 offset:36864
    ds_read_b64_tr_b16 a[38:39], v255 offset:36864
    v_mfma_f32_16x16x32_bf16 v[40:43], a[28:31], a[244:247], v[40:43]
    s_add_u32 m0, s41, 0x9740
    ds_read_b64_tr_b16 a[40:41], v254 offset:36896
    ds_read_b64_tr_b16 a[42:43], v255 offset:36896
    v_mfma_f32_16x16x32_bf16 v[44:47], a[32:35], a[244:247], v[44:47]
    ds_read_b64_tr_b16 a[44:45], v254 offset:36928
    ds_read_b64_tr_b16 a[46:47], v255 offset:36928
    v_mfma_f32_16x16x32_bf16 v[132:135], a[24:27], a[248:251], v[132:135]
    buffer_load_dwordx4 v246, s[4:7], s56 offen lds
    v_mfma_f32_16x16x32_bf16 v[136:139], a[28:31], a[248:251], v[136:139]
    ds_read_b128 a[240:243], v227 offset:6336
    ds_read_b128 a[244:247], v224 offset:256
    v_mfma_f32_16x16x32_bf16 v[140:143], a[32:35], a[248:251], v[140:143]
    s_waitcnt lgkmcnt(8)
    ds_read_b128 a[248:251], v224 offset:3328
    v_cndmask_b32 v148, v124, v148, s[60:61]
    v_mfma_f32_16x16x32_bf16 v[220:223], a[24:27], a[252:255], v[220:223]
    s_and_b32 s61, s61, 0xfffffff
    v_cndmask_b32 v149, v124, v149, s[62:63]
    v_cndmask_b32 v150, v124, v150, s[64:65]
    v_mfma_f32_16x16x32_bf16 v[216:219], a[28:31], a[252:255], v[216:219]
    s_and_b32 s63, s63, 0xfffffff
    buffer_load_dwordx4 v247, s[4:7], s56 offen offset:1024 lds
    v_mfma_f32_16x16x32_bf16 v[212:215], a[32:35], a[252:255], v[212:215]
    s_add_u32 s56, s56, s42
    ds_read_b128 a[252:255], v224 offset:15744
    v_cndmask_b32 v151, v124, v151, s[66:67]
    v_mfma_f32_16x16x32_bf16 v[208:211], a[24:27], a[220:223], v[208:211]
    s_add_u32 m0, s41, 0xb580
    v_cndmask_b32 v156, v124, v156, s[60:61]
    v_cndmask_b32 v157, v124, v157, s[62:63]
    v_mfma_f32_16x16x32_bf16 v[204:207], a[28:31], a[220:223], v[204:207]
    s_and_b32 s65, s65, 0xfffffff
    v_cndmask_b32 v158, v124, v158, s[64:65]
    s_and_b32 s67, s67, 0xfffffff
    v_mfma_f32_16x16x32_bf16 v[200:203], a[32:35], a[220:223], v[200:203]
    s_mov_b32 s73, s61
    ds_read_b128 a[220:223], v224 offset:18816
    v_cndmask_b32 v159, v124, v159, s[66:67]
    s_waitcnt lgkmcnt(5)
    v_mfma_f32_16x16x32_bf16 v[12:15], a[36:39], a[224:227], v[12:15]
    s_mov_b32 s71, s63
    buffer_load_dwordx4 v246, s[4:7], s56 offen lds
    v_mfma_f32_16x16x32_bf16 v[16:19], a[40:43], a[224:227], v[16:19]
    s_and_b32 s61, s61, 0xff
    s_waitcnt vmcnt(8)
    ds_read_b64_tr_b16 a[48:49], v254 offset:49152
    ds_read_b64_tr_b16 a[50:51], v255 offset:49152
    v_mfma_f32_16x16x32_bf16 v[20:23], a[44:47], a[224:227], v[20:23]
    s_and_b32 s63, s63, 0xff
    ds_read_b64_tr_b16 a[52:53], v254 offset:49184
    ds_read_b64_tr_b16 a[54:55], v255 offset:49184
    v_mfma_f32_16x16x32_bf16 v[36:39], a[36:39], a[228:231], v[36:39]
    ds_read_b64_tr_b16 a[56:57], v254 offset:49216
    ds_read_b64_tr_b16 a[58:59], v255 offset:49216
    v_mfma_f32_16x16x32_bf16 v[40:43], a[40:43], a[228:231], v[40:43]
    buffer_load_dwordx4 v247, s[4:7], s56 offen offset:1024 lds
    v_mfma_f32_16x16x32_bf16 v[44:47], a[44:47], a[228:231], v[44:47]
    s_add_u32 s56, s56, s42
    ds_read_b128 a[224:227], v227 offset:6400
    ds_read_b128 a[228:231], v224 offset:320
    v_mfma_f32_16x16x32_bf16 v[132:135], a[36:39], a[232:235], v[132:135]
    s_add_u32 m0, s41, 0xd3c0
    v_cndmask_b32 v144, v124, v144, s[72:73]
    v_cndmask_b32 v145, v124, v145, s[70:71]
    v_mfma_f32_16x16x32_bf16 v[136:139], a[40:43], a[232:235], v[136:139]
    s_and_b32 s72, s64, 0xfff00000
    v_cndmask_b32 v152, v124, v152, s[60:61]
    v_cndmask_b32 v153, v124, v153, s[62:63]
    v_mfma_f32_16x16x32_bf16 v[140:143], a[44:47], a[232:235], v[140:143]
    s_mov_b32 s73, s65
    buffer_load_dwordx4 v246, s[4:7], s56 offen lds
    v_mfma_f32_16x16x32_bf16 v[220:223], a[36:39], a[236:239], v[220:223]
    s_and_b32 s70, s66, 0xfff00000
    ds_read_b128 a[232:235], v224 offset:3392
    v_cndmask_b32 v146, v124, v146, s[72:73]
    v_mfma_f32_16x16x32_bf16 v[216:219], a[40:43], a[236:239], v[216:219]
    s_mov_b32 s71, s67
    v_cndmask_b32 v147, v124, v147, s[70:71]
    s_and_b32 s65, s65, 0xff
    v_mfma_f32_16x16x32_bf16 v[212:215], a[44:47], a[236:239], v[212:215]
    s_and_b32 s67, s67, 0xff
    ds_read_b128 a[236:239], v224 offset:15808
    v_cndmask_b32 v154, v124, v154, s[64:65]
    s_waitcnt lgkmcnt(6)
    v_mfma_f32_16x16x32_bf16 v[208:211], a[36:39], a[240:243], v[208:211]
    s_mov_b32 s60, 0x2222
    buffer_load_dwordx4 v247, s[4:7], s56 offen offset:1024 lds
    v_mfma_f32_16x16x32_bf16 v[204:207], a[40:43], a[240:243], v[204:207]
    s_add_u32 m0, s50, 0
    s_waitcnt vmcnt(8)
    ds_read_b64_tr_b16 a[60:61], v254 offset:61440
    ds_read_b64_tr_b16 a[62:63], v255 offset:61440
    v_mfma_f32_16x16x32_bf16 v[200:203], a[44:47], a[240:243], v[200:203]
    s_add_u32 s56, s56, s42
    ds_read_b64_tr_b16 a[64:65], v254 offset:61472
    ds_read_b64_tr_b16 a[66:67], v255 offset:61472
    v_mfma_f32_16x16x32_bf16 v[12:15], a[48:51], a[244:247], v[12:15]
    s_cmp_eq_u32 s47, 1
    s_cmov_b32 s60, 0xbbbb
    ds_read_b64_tr_b16 a[68:69], v254 offset:61504
    v_mfma_f32_16x16x32_bf16 v[16:19], a[52:55], a[244:247], v[16:19]
    s_mov_b32 s61, 0x4444
    ds_read_b64_tr_b16 a[70:71], v255 offset:61504
    ds_read_b128 a[240:243], v224 offset:18880
    s_waitcnt lgkmcnt(9)
    v_mfma_f32_16x16x32_bf16 v[20:23], a[56:59], a[244:247], v[20:23]
    s_cmp_eq_u32 s47, 1
    s_cmov_b32 s61, 0x4241
    ds_read_b128 a[244:247], v227 offset:6464
    v_mfma_f32_16x16x32_bf16 v[36:39], a[48:51], a[248:251], v[36:39]
    s_mov_b32 s62, 0x8808
    buffer_load_dword v188, v189, s[12:15], s52 offen
    v_mfma_f32_16x16x32_bf16 v[40:43], a[52:55], a[248:251], v[40:43]
    s_cmp_eq_u32 s47, 1
    s_cmov_b32 s62, 0x8898
    v_bfe_u32 v234, s60, v232, 4
    v_mfma_f32_16x16x32_bf16 v[44:47], a[56:59], a[248:251], v[44:47]
    s_mov_b32 s63, 0x32104321
    buffer_load_dwordx4 v251, s[8:11], s57 offen lds
    v_mfma_f32_16x16x32_bf16 v[132:135], a[48:51], a[252:255], v[132:135]
    s_cmp_eq_u32 s47, 1
    s_cmov_b32 s63, 0x30a940ba
    v_mad_u32_u24 v235, v234, s40, v228
    v_mfma_f32_16x16x32_bf16 v[136:139], a[52:55], a[252:255], v[136:139]
    s_mov_b32 s64, 0x76540765
    buffer_load_dwordx4 v252, s[8:11], s57 offen offset:1024 lds
    v_mfma_f32_16x16x32_bf16 v[140:143], a[56:59], a[252:255], v[140:143]
    s_cmp_eq_u32 s47, 1
    s_cmov_b32 s64, 0x76549765
    v_mad_u32_u24 v234, v234, s40, v229
    v_mfma_f32_16x16x32_bf16 v[220:223], a[48:51], a[220:223], v[220:223]
    s_mov_b32 s65, 0x2222
    v_cndmask_b32 v155, v124, v155, s[66:67]
    s_cmp_eq_u32 s47, 1
    s_cmov_b32 s65, 0x2221
    v_mfma_f32_16x16x32_bf16 v[216:219], a[52:55], a[220:223], v[216:219]
    s_mov_b32 s66, 0x10002100
    ds_write_b128 v123, v[144:147]
    v_mfma_f32_16x16x32_bf16 v[212:215], a[56:59], a[220:223], v[212:215]
    s_cmp_eq_u32 s47, 1
    s_cmov_b32 s66, 0x10002000
    s_mov_b32 s67, 0x54326543
    v_mfma_f32_16x16x32_bf16 v[208:211], a[48:51], a[224:227], v[208:211]
    s_mov_b32 s70, 0x76540765
    buffer_load_dwordx4 v253, s[8:11], s57 offen offset:2048 lds
    v_mfma_f32_16x16x32_bf16 v[204:207], a[52:55], a[224:227], v[204:207]
    s_add_u32 s57, s49, 0x9300
    ds_write_b128 v123, v[148:151] offset:960
    v_mfma_f32_16x16x32_bf16 v[200:203], a[56:59], a[224:227], v[200:203]
    s_add_u32 m0, s50, 0x3000
    ds_write_b128 v123, v[152:155] offset:1920
    s_waitcnt lgkmcnt(3)
    v_mfma_f32_16x16x32_bf16 v[12:15], a[60:63], a[228:231], v[12:15]
    s_mov_b32 s71, 0x10002100
    buffer_load_dwordx4 v251, s[8:11], s57 offen lds
    v_mfma_f32_16x16x32_bf16 v[16:19], a[64:67], a[228:231], v[16:19]
    s_mov_b32 s72, 0x760007
    ds_write_b128 v123, v[156:159] offset:2880
    v_mfma_f32_16x16x32_bf16 v[20:23], a[68:71], a[228:231], v[20:23]
    s_add_u32 s52, s25, s50
    buffer_load_dwordx4 v252, s[8:11], s57 offen offset:1024 lds
    v_mfma_f32_16x16x32_bf16 v[36:39], a[60:63], a[232:235], v[36:39]
    s_add_u32 s25, s25, s49
    v_cvt_pk_bf16_f32 v0, v12, v13
    v_cvt_pk_bf16_f32 v1, v14, v15
    v_mfma_f32_16x16x32_bf16 v[40:43], a[64:67], a[232:235], v[40:43]
    v_cvt_pk_bf16_f32 v2, v16, v17
    v_cvt_pk_bf16_f32 v3, v18, v19
    v_mfma_f32_16x16x32_bf16 v[44:47], a[68:71], a[232:235], v[44:47]
    v_cvt_pk_bf16_f32 v4, v20, v21
    v_cvt_pk_bf16_f32 v5, v22, v23
    v_mfma_f32_16x16x32_bf16 v[132:135], a[60:63], a[236:239], v[132:135]
    buffer_load_dwordx4 v253, s[8:11], s57 offen offset:2048 lds
    v_mfma_f32_16x16x32_bf16 v[136:139], a[64:67], a[236:239], v[136:139]
    s_add_u32 s57, s49, 0x12300
    v_cvt_pk_bf16_f32 v24, v36, v37
    v_cvt_pk_bf16_f32 v25, v38, v39
    v_mfma_f32_16x16x32_bf16 v[140:143], a[68:71], a[236:239], v[140:143]
    s_add_u32 m0, s50, 0x6000
    v_cvt_pk_bf16_f32 v26, v40, v41
    v_cvt_pk_bf16_f32 v27, v42, v43
    v_mfma_f32_16x16x32_bf16 v[220:223], a[60:63], a[240:243], v[220:223]
    v_cvt_pk_bf16_f32 v28, v44, v45
    v_cvt_pk_bf16_f32 v29, v46, v47
    v_mfma_f32_16x16x32_bf16 v[216:219], a[64:67], a[240:243], v[216:219]
    buffer_load_dwordx4 v251, s[8:11], s57 offen lds
    v_mfma_f32_16x16x32_bf16 v[212:215], a[68:71], a[240:243], v[212:215]
    v_cvt_pk_bf16_f32 v6, v132, v133
    v_cvt_pk_bf16_f32 v7, v134, v135
    v_mfma_f32_16x16x32_bf16 v[208:211], a[60:63], a[244:247], v[208:211]
    v_cvt_pk_bf16_f32 v8, v136, v137
    v_cvt_pk_bf16_f32 v9, v138, v139
    v_mfma_f32_16x16x32_bf16 v[204:207], a[64:67], a[244:247], v[204:207]
    v_cvt_pk_bf16_f32 v10, v140, v141
    v_cvt_pk_bf16_f32 v11, v142, v143
    v_mfma_f32_16x16x32_bf16 v[200:203], a[68:71], a[244:247], v[200:203]
    s_waitcnt vmcnt(12)
    buffer_load_dwordx4 v252, s[8:11], s57 offen offset:1024 lds
    v_cvt_pk_bf16_f32 v30, v220, v221
    v_cvt_pk_bf16_f32 v31, v222, v223
    v_cvt_pk_bf16_f32 v32, v216, v217
    v_cvt_pk_bf16_f32 v33, v218, v219
    v_cvt_pk_bf16_f32 v34, v212, v213
    v_cvt_pk_bf16_f32 v35, v214, v215
    v_cvt_pk_bf16_f32 v48, v208, v209
    v_cvt_pk_bf16_f32 v49, v210, v211
    v_cvt_pk_bf16_f32 v50, v204, v205
    v_cvt_pk_bf16_f32 v51, v206, v207
    v_cvt_pk_bf16_f32 v52, v200, v201
    v_cvt_pk_bf16_f32 v53, v202, v203
    ds_read_b128 v[144:147], v235
    buffer_load_dwordx4 v253, s[8:11], s57 offen offset:2048 lds
    s_add_u32 s57, s49, 0x1b300
    s_add_u32 m0, s50, 0x9000
    ds_read_b128 v[148:151], v234
    v_bfe_u32 v234, s61, v232, 4
    v_mad_u32_u24 v235, v234, s40, v229
    ds_read_b128 v[152:155], v235
    v_mad_u32_u24 v234, v234, s40, v228
    v_add_u32 v108, s52, v108
    v_add_u32 v243, s25, v168
    ds_read_b128 v[156:159], v234
    buffer_load_dwordx4 v251, s[8:11], s57 offen lds
    v_bfe_u32 v234, s62, v232, 4
    v_mad_u32_u24 v235, v234, s40, v229
    v_mad_u32_u24 v234, v234, s40, v228
    v_add_u32 v245, s25, v169
    s_mul_i32 s25, s35, 0x2a00
    s_add_u32 s51, s51, s25
    s_mul_i32 s25, s46, 0x1f8000
    s_add_u32 s51, s51, s25
    s_lshl_b32 s25, s36, 2
    s_add_u32 s25, s25, 0x27e00
    s_barrier
    ds_read_b128 a[248:251], v224 offset:30976
    ds_read_b128 a[252:255], v224 offset:31040
    ds_read_b128 a[220:223], v224 offset:31104
    buffer_load_dwordx4 v252, s[8:11], s57 offen offset:1024 lds
    ds_read_b128 a[224:227], v224 offset:31168
    ds_read_b128 a[228:231], v224 offset:31232
    ds_read_b128 a[232:235], v224 offset:31296
    ds_read_b128 a[236:239], v224 offset:34048
    buffer_load_dwordx4 v253, s[8:11], s57 offen offset:2048 lds
    s_add_u32 s57, s49, 0x24300
    ds_read_b128 a[240:243], v224 offset:34112
    s_add_u32 m0, s50, 0xc000
    s_nop 0
    ds_read_b128 a[244:247], v224 offset:34176
    s_waitcnt lgkmcnt(8)
    v_mfma_f32_16x16x32_bf16 v[180:183], a[0:3], a[248:251], 0
    s_waitcnt lgkmcnt(7)
    v_mfma_f32_16x16x32_bf16 v[180:183], a[12:15], a[252:255], v[180:183]
    buffer_load_dwordx4 v251, s[8:11], s57 offen lds
    v_mfma_f32_16x16x32_bf16 v[176:179], a[4:7], a[248:251], 0
    v_mfma_f32_16x16x32_bf16 v[176:179], a[16:19], a[252:255], v[176:179]
    v_mfma_f32_16x16x32_bf16 v[172:175], a[8:11], a[248:251], 0
    ds_read_b128 a[248:251], v224 offset:34240
    v_mfma_f32_16x16x32_bf16 v[172:175], a[20:23], a[252:255], v[172:175]
    s_waitcnt lgkmcnt(5)
    ds_read_b128 a[252:255], v224 offset:34304
    v_mfma_f32_16x16x32_bf16 v[180:183], a[24:27], a[220:223], v[180:183]
    buffer_load_dwordx4 v252, s[8:11], s57 offen offset:1024 lds
    v_mfma_f32_16x16x32_bf16 v[180:183], a[36:39], a[224:227], v[180:183]
    v_mfma_f32_16x16x32_bf16 v[176:179], a[28:31], a[220:223], v[176:179]
    s_waitcnt vmcnt(15)
    v_mfma_f32_16x16x32_bf16 v[176:179], a[40:43], a[224:227], v[176:179]
    s_barrier
    v_mfma_f32_16x16x32_bf16 v[172:175], a[32:35], a[220:223], v[172:175]
    ds_read_b128 a[220:223], v224 offset:34368
    v_mfma_f32_16x16x32_bf16 v[172:175], a[44:47], a[224:227], v[172:175]
    ds_read_b128 a[224:227], v224 offset:46464
    v_mfma_f32_16x16x32_bf16 v[180:183], a[48:51], a[228:231], v[180:183]
    s_waitcnt lgkmcnt(4)
    buffer_load_dwordx4 v253, s[8:11], s57 offen offset:2048 lds
    v_mfma_f32_16x16x32_bf16 v[180:183], a[60:63], a[232:235], v[180:183]
    s_add_u32 s57, s49, 0x2d300
    s_add_u32 m0, s50, 0xf000
    v_mfma_f32_16x16x32_bf16 v[176:179], a[52:55], a[228:231], v[176:179]
    buffer_load_dwordx4 v251, s[8:11], s57 offen lds
    v_mfma_f32_16x16x32_bf16 v[176:179], a[64:67], a[232:235], v[176:179]
    v_mfma_f32_16x16x32_bf16 v[172:175], a[56:59], a[228:231], v[172:175]
    ds_read_b128 a[228:231], v224 offset:46528
    v_mfma_f32_16x16x32_bf16 v[172:175], a[68:71], a[232:235], v[172:175]
    v_cvt_pk_bf16_f32 v12, v180, v181
    v_cvt_pk_bf16_f32 v13, v182, v183
    v_mfma_f32_16x16x32_bf16 v[220:223], a[0:3], a[236:239], 0
    ds_read_b128 a[232:235], v224 offset:46592
    v_mfma_f32_16x16x32_bf16 v[220:223], a[12:15], a[240:243], v[220:223]
    v_cvt_pk_bf16_f32 v14, v176, v177
    v_cvt_pk_bf16_f32 v15, v178, v179
    v_mfma_f32_16x16x32_bf16 v[216:219], a[4:7], a[236:239], 0
    v_cvt_pk_bf16_f32 v16, v172, v173
    v_cvt_pk_bf16_f32 v17, v174, v175
    v_mfma_f32_16x16x32_bf16 v[216:219], a[16:19], a[240:243], v[216:219]
    buffer_load_dwordx4 v252, s[8:11], s57 offen offset:1024 lds
    v_mfma_f32_16x16x32_bf16 v[212:215], a[8:11], a[236:239], 0
    ds_read_b128 a[236:239], v224 offset:46656
    v_mfma_f32_16x16x32_bf16 v[212:215], a[20:23], a[240:243], v[212:215]
    ds_read_b128 a[240:243], v224 offset:46720
    v_mfma_f32_16x16x32_bf16 v[220:223], a[24:27], a[244:247], v[220:223]
    s_waitcnt lgkmcnt(4)
    buffer_load_dwordx4 v253, s[8:11], s57 offen offset:2048 lds
    v_mfma_f32_16x16x32_bf16 v[220:223], a[36:39], a[248:251], v[220:223]
    s_add_u32 s57, s49, 0
    s_add_u32 m0, s50, 0
    v_mfma_f32_16x16x32_bf16 v[216:219], a[28:31], a[244:247], v[216:219]
    v_mfma_f32_16x16x32_bf16 v[216:219], a[40:43], a[248:251], v[216:219]
    s_waitcnt vmcnt(15)
    ds_read_b64_tr_b16 a[72:73], v254
    ds_read_b64_tr_b16 a[74:75], v255
    v_mfma_f32_16x16x32_bf16 v[212:215], a[32:35], a[244:247], v[212:215]
    ds_read_b128 a[244:247], v224 offset:46784
    ds_read_b64_tr_b16 a[76:77], v254 offset:32
    v_mfma_f32_16x16x32_bf16 v[212:215], a[44:47], a[248:251], v[212:215]
    ds_read_b128 a[248:251], v224 offset:49536
    v_mfma_f32_16x16x32_bf16 v[220:223], a[48:51], a[252:255], v[220:223]
    ds_read_b64_tr_b16 a[78:79], v255 offset:32
    ds_read_b64_tr_b16 a[80:81], v254 offset:64
    v_mfma_f32_16x16x32_bf16 v[220:223], a[60:63], a[220:223], v[220:223]
    ds_read_b64_tr_b16 a[82:83], v255 offset:64
    v_mfma_f32_16x16x32_bf16 v[216:219], a[52:55], a[252:255], v[216:219]
    v_mfma_f32_16x16x32_bf16 v[216:219], a[64:67], a[220:223], v[216:219]
    v_mfma_f32_16x16x32_bf16 v[212:215], a[56:59], a[252:255], v[212:215]
    ds_read_b128 a[252:255], v224 offset:49600
    v_mfma_f32_16x16x32_bf16 v[212:215], a[68:71], a[220:223], v[212:215]
    ds_read_b128 a[220:223], v224 offset:49664
    v_mfma_f32_16x16x32_bf16 v[208:211], a[0:3], a[224:227], 0
    s_waitcnt lgkmcnt(9)
    v_cvt_pk_bf16_f32 v36, v220, v221
    v_cvt_pk_bf16_f32 v37, v222, v223
    v_mfma_f32_16x16x32_bf16 v[208:211], a[12:15], a[228:231], v[208:211]
    v_cvt_pk_bf16_f32 v38, v216, v217
    v_cvt_pk_bf16_f32 v39, v218, v219
    v_mfma_f32_16x16x32_bf16 v[204:207], a[4:7], a[224:227], 0
    v_cvt_pk_bf16_f32 v40, v212, v213
    v_cvt_pk_bf16_f32 v41, v214, v215
    v_mfma_f32_16x16x32_bf16 v[204:207], a[16:19], a[228:231], v[204:207]
    s_waitcnt lgkmcnt(2)
    buffer_load_dwordx4 v251, s[8:11], s57 offen lds
    v_mfma_f32_16x16x32_bf16 v[200:203], a[8:11], a[224:227], 0
    s_waitcnt vmcnt(13)
    ds_read_b128 a[224:227], v224 offset:49728
    ds_read_b64_tr_b16 a[84:85], v254 offset:12288
    v_mfma_f32_16x16x32_bf16 v[200:203], a[20:23], a[228:231], v[200:203]
    ds_read_b128 a[228:231], v224 offset:49792
    v_mfma_f32_16x16x32_bf16 v[208:211], a[24:27], a[232:235], v[208:211]
    buffer_load_dwordx4 v252, s[8:11], s57 offen offset:1024 lds
    v_mfma_f32_16x16x32_bf16 v[208:211], a[36:39], a[236:239], v[208:211]
    ds_read_b64_tr_b16 a[86:87], v255 offset:12288
    ds_read_b64_tr_b16 a[88:89], v254 offset:12320
    v_mfma_f32_16x16x32_bf16 v[204:207], a[28:31], a[232:235], v[204:207]
    buffer_load_dwordx4 v253, s[8:11], s57 offen offset:2048 lds
    v_mfma_f32_16x16x32_bf16 v[204:207], a[40:43], a[236:239], v[204:207]
    s_add_u32 s57, s49, 0x9000
    ds_read_b64_tr_b16 a[90:91], v255 offset:12320
    ds_read_b64_tr_b16 a[92:93], v254 offset:12352
    v_mfma_f32_16x16x32_bf16 v[200:203], a[32:35], a[232:235], v[200:203]
    s_add_u32 m0, s50, 0x3000
    ds_read_b128 a[232:235], v224 offset:49856
    ds_read_b64_tr_b16 a[94:95], v255 offset:12352
    v_mfma_f32_16x16x32_bf16 v[200:203], a[44:47], a[236:239], v[200:203]
    ds_read_b128 a[236:239], v227 offset:37120
    v_mfma_f32_16x16x32_bf16 v[208:211], a[48:51], a[240:243], v[208:211]
    v_mfma_f32_16x16x32_bf16 v[208:211], a[60:63], a[244:247], v[208:211]
    v_mfma_f32_16x16x32_bf16 v[204:207], a[52:55], a[240:243], v[204:207]
    v_mfma_f32_16x16x32_bf16 v[204:207], a[64:67], a[244:247], v[204:207]
    s_waitcnt vmcnt(12)
    ds_read_b64_tr_b16 a[96:97], v254 offset:24576
    ds_read_b64_tr_b16 a[98:99], v255 offset:24576
    v_mfma_f32_16x16x32_bf16 v[200:203], a[56:59], a[240:243], v[200:203]
    ds_read_b128 a[240:243], v227 offset:37184
    ds_read_b64_tr_b16 a[100:101], v254 offset:24608
    v_mfma_f32_16x16x32_bf16 v[200:203], a[68:71], a[244:247], v[200:203]
    v_cvt_pk_bf16_f32 v18, v208, v209
    v_cvt_pk_bf16_f32 v19, v210, v211
    v_mfma_f32_16x16x32_bf16 v[180:183], a[0:3], a[248:251], 0
    s_waitcnt lgkmcnt(8)
    v_cvt_pk_bf16_f32 v20, v204, v205
    v_cvt_pk_bf16_f32 v21, v206, v207
    v_mfma_f32_16x16x32_bf16 v[180:183], a[12:15], a[252:255], v[180:183]
    ds_read_b128 a[244:247], v227 offset:37248
    ds_read_b64_tr_b16 a[102:103], v255 offset:24608
    v_mfma_f32_16x16x32_bf16 v[176:179], a[4:7], a[248:251], 0
    v_cvt_pk_bf16_f32 v22, v200, v201
    v_cvt_pk_bf16_f32 v23, v202, v203
    v_mfma_f32_16x16x32_bf16 v[176:179], a[16:19], a[252:255], v[176:179]
    s_waitcnt lgkmcnt(6)
    buffer_load_dwordx4 v251, s[8:11], s57 offen lds
    v_mfma_f32_16x16x32_bf16 v[172:175], a[8:11], a[248:251], 0
    ds_read_b128 a[248:251], v227 offset:37312
    ds_read_b64_tr_b16 a[104:105], v254 offset:24640
    v_mfma_f32_16x16x32_bf16 v[172:175], a[20:23], a[252:255], v[172:175]
    ds_read_b128 a[252:255], v227 offset:37376
    v_mfma_f32_16x16x32_bf16 v[180:183], a[24:27], a[220:223], v[180:183]
    buffer_load_dwordx4 v252, s[8:11], s57 offen offset:1024 lds
    v_mfma_f32_16x16x32_bf16 v[180:183], a[36:39], a[224:227], v[180:183]
    ds_read_b64_tr_b16 a[106:107], v255 offset:24640
    v_mfma_f32_16x16x32_bf16 v[176:179], a[28:31], a[220:223], v[176:179]
    s_waitcnt vmcnt(11)
    buffer_load_dwordx4 v253, s[8:11], s57 offen offset:2048 lds
    v_mfma_f32_16x16x32_bf16 v[176:179], a[40:43], a[224:227], v[176:179]
    s_add_u32 s57, s49, 0x12000
    ds_read_b64_tr_b16 a[108:109], v254 offset:36864
    ds_read_b64_tr_b16 a[110:111], v255 offset:36864
    v_mfma_f32_16x16x32_bf16 v[172:175], a[32:35], a[220:223], v[172:175]
    s_add_u32 m0, s50, 0x6000
    ds_read_b128 a[220:223], v227 offset:37440
    ds_read_b64_tr_b16 a[112:113], v254 offset:36896
    v_mfma_f32_16x16x32_bf16 v[172:175], a[44:47], a[224:227], v[172:175]
    ds_read_b128 a[224:227], v224
    v_mfma_f32_16x16x32_bf16 v[180:183], a[48:51], a[228:231], v[180:183]
    ds_read_b64_tr_b16 a[114:115], v255 offset:36896
    ds_read_b64_tr_b16 a[116:117], v254 offset:36928
    v_mfma_f32_16x16x32_bf16 v[180:183], a[60:63], a[232:235], v[180:183]
L_pg1:
    s_cbranch_execz L_pg5
    ds_read_b64_tr_b16 a[118:119], v255 offset:36928
    v_mfma_f32_16x16x32_bf16 v[176:179], a[52:55], a[228:231], v[176:179]
    v_mfma_f32_16x16x32_bf16 v[176:179], a[64:67], a[232:235], v[176:179]
    s_waitcnt lgkmcnt(8)
    buffer_load_dwordx4 v251, s[8:11], s57 offen lds
    v_mfma_f32_16x16x32_bf16 v[172:175], a[56:59], a[228:231], v[172:175]
    ds_read_b128 a[228:231], v224 offset:64
    v_mfma_f32_16x16x32_bf16 v[172:175], a[68:71], a[232:235], v[172:175]
    ds_read_b128 a[232:235], v224 offset:128
    v_cvt_pk_bf16_f32 v42, v180, v181
    v_mfma_f32_16x16x32_bf16 v[220:223], a[0:3], a[236:239], 0
    v_cvt_pk_bf16_f32 v43, v182, v183
    v_cvt_pk_bf16_f32 v44, v176, v177
    v_mfma_f32_16x16x32_bf16 v[220:223], a[12:15], a[240:243], v[220:223]
    v_cvt_pk_bf16_f32 v45, v178, v179
    v_mfma_f32_16x16x32_bf16 v[216:219], a[4:7], a[236:239], 0
    v_cvt_pk_bf16_f32 v46, v172, v173
    v_cvt_pk_bf16_f32 v47, v174, v175
    v_mfma_f32_16x16x32_bf16 v[216:219], a[16:19], a[240:243], v[216:219]
    buffer_load_dwordx4 v252, s[8:11], s57 offen offset:1024 lds
    v_mfma_f32_16x16x32_bf16 v[212:215], a[8:11], a[236:239], 0
    s_waitcnt vmcnt(11)
    ds_read_b128 a[236:239], v224 offset:192
    ds_read_b64_tr_b16 a[120:121], v254 offset:49152
    v_mfma_f32_16x16x32_bf16 v[212:215], a[20:23], a[240:243], v[212:215]
    ds_read_b128 a[240:243], v224 offset:256
    v_mfma_f32_16x16x32_bf16 v[220:223], a[24:27], a[244:247], v[220:223]
    buffer_load_dwordx4 v253, s[8:11], s57 offen offset:2048 lds
    v_mfma_f32_16x16x32_bf16 v[220:223], a[36:39], a[248:251], v[220:223]
    s_add_u32 s57, s49, 0x1b000
    ds_read_b64_tr_b16 a[122:123], v255 offset:49152
    ds_read_b64_tr_b16 a[124:125], v254 offset:49184
    v_mfma_f32_16x16x32_bf16 v[216:219], a[28:31], a[244:247], v[216:219]
    s_add_u32 m0, s50, 0x9000
    ds_read_b64_tr_b16 a[126:127], v255 offset:49184
    ds_read_b64_tr_b16 a[128:129], v254 offset:49216
    v_mfma_f32_16x16x32_bf16 v[216:219], a[40:43], a[248:251], v[216:219]
    s_waitcnt lgkmcnt(7)
    buffer_load_dwordx4 v251, s[8:11], s57 offen lds
    v_mfma_f32_16x16x32_bf16 v[212:215], a[32:35], a[244:247], v[212:215]
    ds_read_b128 a[244:247], v224 offset:320
    ds_read_b64_tr_b16 a[130:131], v255 offset:49216
    v_mfma_f32_16x16x32_bf16 v[212:215], a[44:47], a[248:251], v[212:215]
    ds_read_b128 a[248:251], v224 offset:3072
    v_mfma_f32_16x16x32_bf16 v[220:223], a[48:51], a[252:255], v[220:223]
    buffer_load_dwordx4 v252, s[8:11], s57 offen offset:1024 lds
    v_mfma_f32_16x16x32_bf16 v[220:223], a[60:63], a[220:223], v[220:223]
    v_mfma_f32_16x16x32_bf16 v[216:219], a[52:55], a[252:255], v[216:219]
    v_mfma_f32_16x16x32_bf16 v[216:219], a[64:67], a[220:223], v[216:219]
    s_waitcnt vmcnt(11)
    ds_read_b64_tr_b16 a[132:133], v254 offset:61440
    ds_read_b64_tr_b16 a[134:135], v255 offset:61440
    v_mfma_f32_16x16x32_bf16 v[212:215], a[56:59], a[252:255], v[212:215]
    ds_read_b128 a[252:255], v224 offset:3136
    ds_read_b64_tr_b16 a[136:137], v254 offset:61472
    v_mfma_f32_16x16x32_bf16 v[212:215], a[68:71], a[220:223], v[212:215]
    v_cvt_pk_bf16_f32 v54, v220, v221
    v_cvt_pk_bf16_f32 v55, v222, v223
    v_mfma_f32_16x16x32_bf16 v[208:211], a[224:227], a[72:75], 0
    v_cvt_pk_bf16_f32 v56, v216, v217
    v_cvt_pk_bf16_f32 v57, v218, v219
    v_mfma_f32_16x16x32_bf16 v[208:211], a[228:231], a[84:87], v[208:211]
    ds_read_b128 a[220:223], v224 offset:3200
    ds_read_b64_tr_b16 a[138:139], v255 offset:61472
    v_mfma_f32_16x16x32_bf16 v[204:207], a[224:227], a[76:79], 0
    v_cvt_pk_bf16_f32 v58, v212, v213
    v_cvt_pk_bf16_f32 v59, v214, v215
    v_mfma_f32_16x16x32_bf16 v[204:207], a[228:231], a[88:91], v[204:207]
    buffer_load_dwordx4 v253, s[8:11], s57 offen offset:2048 lds
    v_mfma_f32_16x16x32_bf16 v[200:203], a[224:227], a[80:83], 0
    s_add_u32 s57, s49, 0x24000
    ds_read_b128 a[224:227], v224 offset:3264
    ds_read_b64_tr_b16 a[140:141], v254 offset:61504
    v_mfma_f32_16x16x32_bf16 v[200:203], a[228:231], a[92:95], v[200:203]
    s_add_u32 m0, s50, 0xc000
    ds_read_b128 a[228:231], v224 offset:3328
    v_mfma_f32_16x16x32_bf16 v[208:211], a[232:235], a[96:99], v[208:211]
    s_waitcnt lgkmcnt(8)
    buffer_load_dwordx4 v251, s[8:11], s57 offen lds
    v_mfma_f32_16x16x32_bf16 v[208:211], a[236:239], a[108:111], v[208:211]
    ds_read_b64_tr_b16 a[142:143], v255 offset:61504
    v_mfma_f32_16x16x32_bf16 v[204:207], a[232:235], a[100:103], v[204:207]
    buffer_load_dwordx4 v252, s[8:11], s57 offen offset:1024 lds
    v_mfma_f32_16x16x32_bf16 v[204:207], a[236:239], a[112:115], v[204:207]
    s_waitcnt vmcnt(11)
    ds_read_b64_tr_b16 a[144:145], v254
    ds_read_b64_tr_b16 a[146:147], v255
    v_mfma_f32_16x16x32_bf16 v[200:203], a[232:235], a[104:107], v[200:203]
    ds_read_b128 a[232:235], v224 offset:3392
    ds_read_b64_tr_b16 a[148:149], v254 offset:32
    v_mfma_f32_16x16x32_bf16 v[200:203], a[236:239], a[116:119], v[200:203]
    ds_read_b128 a[236:239], v224 offset:15488
    v_mfma_f32_16x16x32_bf16 v[208:211], a[240:243], a[120:123], v[208:211]
    s_waitcnt lgkmcnt(9)
    buffer_load_dwordx4 v253, s[8:11], s57 offen offset:2048 lds
    v_mfma_f32_16x16x32_bf16 v[208:211], a[244:247], a[132:135], v[208:211]
    s_add_u32 s57, s49, 0x2d000
    ds_read_b64_tr_b16 a[150:151], v255 offset:32
    ds_read_b64_tr_b16 a[152:153], v254 offset:64
    v_mfma_f32_16x16x32_bf16 v[204:207], a[240:243], a[124:127], v[204:207]
    s_add_u32 m0, s50, 0xf000
    ds_read_b64_tr_b16 a[154:155], v255 offset:64
    v_mfma_f32_16x16x32_bf16 v[204:207], a[244:247], a[136:139], v[204:207]
    v_mfma_f32_16x16x32_bf16 v[200:203], a[240:243], a[128:131], v[200:203]
    s_waitcnt lgkmcnt(8)
    v_cvt_pk_bf16_f32 v66, v208, v209
    v_cvt_pk_bf16_f32 v67, v210, v211
    v_mfma_f32_16x16x32_bf16 v[200:203], a[244:247], a[140:143], v[200:203]
    ds_read_b128 a[240:243], v224 offset:15552
    ds_read_b128 a[244:247], v224 offset:15616
    v_mfma_f32_16x16x32_bf16 v[180:183], a[248:251], a[72:75], 0
    buffer_load_dwordx4 v251, s[8:11], s57 offen lds
    v_mfma_f32_16x16x32_bf16 v[180:183], a[252:255], a[84:87], v[180:183]
    v_cvt_pk_bf16_f32 v88, v204, v205
    v_cvt_pk_bf16_f32 v89, v206, v207
    v_mfma_f32_16x16x32_bf16 v[176:179], a[248:251], a[76:79], 0
    v_cvt_pk_bf16_f32 v110, v200, v201
    v_cvt_pk_bf16_f32 v111, v202, v203
    v_mfma_f32_16x16x32_bf16 v[176:179], a[252:255], a[88:91], v[176:179]
    buffer_load_dwordx4 v252, s[8:11], s57 offen offset:1024 lds
    v_mfma_f32_16x16x32_bf16 v[172:175], a[248:251], a[80:83], 0
    s_waitcnt vmcnt(11)
    ds_read_b128 a[248:251], v224 offset:15680
    ds_read_b64_tr_b16 a[156:157], v254 offset:12288
    v_mfma_f32_16x16x32_bf16 v[172:175], a[252:255], a[92:95], v[172:175]
    ds_read_b128 a[252:255], v224 offset:15744
    v_mfma_f32_16x16x32_bf16 v[180:183], a[220:223], a[96:99], v[180:183]
    ds_read_b64_tr_b16 a[158:159], v255 offset:12288
    ds_read_b64_tr_b16 a[160:161], v254 offset:12320
    v_mfma_f32_16x16x32_bf16 v[180:183], a[224:227], a[108:111], v[180:183]
    buffer_load_dwordx4 v253, s[8:11], s57 offen offset:2048 lds
    v_mfma_f32_16x16x32_bf16 v[176:179], a[220:223], a[100:103], v[176:179]
    s_add_u32 s57, s49, 0
    ds_read_b64_tr_b16 a[162:163], v255 offset:12320
    ds_read_b64_tr_b16 a[164:165], v254 offset:12352
    v_mfma_f32_16x16x32_bf16 v[176:179], a[224:227], a[112:115], v[176:179]
    s_add_u32 m0, s50, 0
    ds_read_b64_tr_b16 a[166:167], v255 offset:12352
    v_mfma_f32_16x16x32_bf16 v[172:175], a[220:223], a[104:107], v[172:175]
    ds_read_b128 a[220:223], v224 offset:15808
    v_mfma_f32_16x16x32_bf16 v[172:175], a[224:227], a[116:119], v[172:175]
    ds_read_b128 a[224:227], v224 offset:18560
    v_mfma_f32_16x16x32_bf16 v[180:183], a[228:231], a[120:123], v[180:183]
    s_waitcnt lgkmcnt(10)
    buffer_load_dwordx4 v192, s[12:15], s57 offen lds
    v_mfma_f32_16x16x32_bf16 v[180:183], a[232:235], a[132:135], v[180:183]
    v_mfma_f32_16x16x32_bf16 v[176:179], a[228:231], a[124:127], v[176:179]
    v_mfma_f32_16x16x32_bf16 v[176:179], a[232:235], a[136:139], v[176:179]
    buffer_load_dwordx4 v193, s[12:15], s57 offen offset:1024 lds
    v_mfma_f32_16x16x32_bf16 v[172:175], a[228:231], a[128:131], v[172:175]
    s_waitcnt vmcnt(11)
    ds_read_b128 a[228:231], v224 offset:18624
    ds_read_b64_tr_b16 a[168:169], v254 offset:24576
    v_mfma_f32_16x16x32_bf16 v[172:175], a[232:235], a[140:143], v[172:175]
    ds_read_b128 a[232:235], v224 offset:18688
    v_cvt_pk_bf16_f32 v68, v180, v181
    v_mfma_f32_16x16x32_bf16 v[220:223], a[236:239], a[72:75], 0
    v_cvt_pk_bf16_f32 v69, v182, v183
    v_cvt_pk_bf16_f32 v90, v176, v177
    v_mfma_f32_16x16x32_bf16 v[220:223], a[240:243], a[84:87], v[220:223]
    ds_read_b64_tr_b16 a[170:171], v255 offset:24576
    v_cvt_pk_bf16_f32 v91, v178, v179
    v_mfma_f32_16x16x32_bf16 v[216:219], a[236:239], a[76:79], 0
    v_cvt_pk_bf16_f32 v112, v172, v173
    v_cvt_pk_bf16_f32 v113, v174, v175
    v_mfma_f32_16x16x32_bf16 v[216:219], a[240:243], a[88:91], v[216:219]
    buffer_load_dwordx4 v194, s[12:15], s57 offen offset:2048 lds
    v_mfma_f32_16x16x32_bf16 v[212:215], a[236:239], a[80:83], 0
    s_add_u32 s57, s49, 0x3000
    ds_read_b128 a[236:239], v224 offset:18752
    ds_read_b64_tr_b16 a[172:173], v254 offset:24608
    v_mfma_f32_16x16x32_bf16 v[212:215], a[240:243], a[92:95], v[212:215]
    s_add_u32 m0, s50, 0x3000
    ds_read_b128 a[240:243], v224 offset:18816
    v_mfma_f32_16x16x32_bf16 v[220:223], a[244:247], a[96:99], v[220:223]
    s_waitcnt lgkmcnt(7)
    buffer_load_dwordx4 v192, s[12:15], s57 offen lds
    v_mfma_f32_16x16x32_bf16 v[220:223], a[248:251], a[108:111], v[220:223]
    ds_read_b64_tr_b16 a[174:175], v255 offset:24608
    ds_read_b64_tr_b16 a[176:177], v254 offset:24640
    v_mfma_f32_16x16x32_bf16 v[216:219], a[244:247], a[100:103], v[216:219]
    s_waitcnt vmcnt(10)
    ds_read_b64_tr_b16 a[178:179], v255 offset:24640
    ds_read_b64_tr_b16 a[180:181], v254 offset:36864
    v_mfma_f32_16x16x32_bf16 v[216:219], a[248:251], a[112:115], v[216:219]
    ds_read_b64_tr_b16 a[182:183], v255 offset:36864
    ds_read_b64_tr_b16 a[184:185], v254 offset:36896
    v_mfma_f32_16x16x32_bf16 v[212:215], a[244:247], a[104:107], v[212:215]
    ds_read_b128 a[244:247], v224 offset:18880
    ds_read_b64_tr_b16 a[186:187], v255 offset:36896
    v_mfma_f32_16x16x32_bf16 v[212:215], a[248:251], a[116:119], v[212:215]
    ds_read_b128 a[248:251], v227 offset:6144
    v_mfma_f32_16x16x32_bf16 v[220:223], a[252:255], a[120:123], v[220:223]
    buffer_load_dwordx4 v195, s[12:15], s57 offen offset:1024 lds
    v_mfma_f32_16x16x32_bf16 v[220:223], a[220:223], a[132:135], v[220:223]
    s_addk_i32 s57, 0x3000
    ds_read_b64_tr_b16 a[188:189], v254 offset:36928
    ds_read_b64_tr_b16 a[190:191], v255 offset:36928
    v_mfma_f32_16x16x32_bf16 v[216:219], a[252:255], a[124:127], v[216:219]
    buffer_load_dwordx4 v194, s[12:15], s57 offen offset:2048 lds
    v_mfma_f32_16x16x32_bf16 v[216:219], a[220:223], a[136:139], v[216:219]
    s_add_u32 s57, s49, 0x4800
    s_add_u32 m0, s50, 0x6000
    v_cvt_pk_bf16_f32 v72, v220, v221
    v_mfma_f32_16x16x32_bf16 v[212:215], a[252:255], a[128:131], v[212:215]
    ds_read_b128 a[252:255], v227 offset:6208
    v_cvt_pk_bf16_f32 v73, v222, v223
    v_mfma_f32_16x16x32_bf16 v[212:215], a[220:223], a[140:143], v[212:215]
    ds_read_b128 a[220:223], v227 offset:6272
    v_cvt_pk_bf16_f32 v94, v216, v217
    v_mfma_f32_16x16x32_bf16 v[208:211], a[224:227], a[72:75], 0
    s_waitcnt lgkmcnt(8)
    v_cvt_pk_bf16_f32 v95, v218, v219
    v_mfma_f32_16x16x32_bf16 v[208:211], a[228:231], a[84:87], v[208:211]
    buffer_load_dwordx4 v192, s[12:15], s57 offen lds
    v_mfma_f32_16x16x32_bf16 v[204:207], a[224:227], a[76:79], 0
    v_mfma_f32_16x16x32_bf16 v[204:207], a[228:231], a[88:91], v[204:207]
    v_cvt_pk_bf16_f32 v116, v212, v213
    v_cvt_pk_bf16_f32 v117, v214, v215
    v_mfma_f32_16x16x32_bf16 v[200:203], a[224:227], a[80:83], 0
    s_waitcnt vmcnt(10)
    ds_read_b128 a[224:227], v227 offset:6336
    ds_read_b64_tr_b16 a[192:193], v254 offset:49152
    v_mfma_f32_16x16x32_bf16 v[200:203], a[228:231], a[92:95], v[200:203]
    ds_read_b128 a[228:231], v227 offset:6400
    v_mfma_f32_16x16x32_bf16 v[208:211], a[232:235], a[96:99], v[208:211]
    buffer_load_dwordx4 v193, s[12:15], s57 offen offset:1024 lds
    v_mfma_f32_16x16x32_bf16 v[208:211], a[236:239], a[108:111], v[208:211]
    ds_read_b64_tr_b16 a[194:195], v255 offset:49152
    ds_read_b64_tr_b16 a[196:197], v254 offset:49184
    v_mfma_f32_16x16x32_bf16 v[204:207], a[232:235], a[100:103], v[204:207]
    ds_read_b64_tr_b16 a[198:199], v255 offset:49184
    ds_read_b64_tr_b16 a[200:201], v254 offset:49216
    v_mfma_f32_16x16x32_bf16 v[204:207], a[236:239], a[112:115], v[204:207]
    buffer_load_dwordx4 v194, s[12:15], s57 offen offset:2048 lds
    v_mfma_f32_16x16x32_bf16 v[200:203], a[232:235], a[104:107], v[200:203]
    s_add_u32 s57, s49, 0x9000
    ds_read_b128 a[232:235], v227 offset:6464
    ds_read_b64_tr_b16 a[202:203], v255 offset:49216
    v_mfma_f32_16x16x32_bf16 v[200:203], a[236:239], a[116:119], v[200:203]
    s_add_u32 m0, s50, 0x9000
    ds_read_b128 a[236:239], v225 offset:24384
    v_mfma_f32_16x16x32_bf16 v[208:211], a[240:243], a[120:123], v[208:211]
    s_waitcnt lgkmcnt(10)
    v_mfma_f32_16x16x32_bf16 v[208:211], a[244:247], a[132:135], v[208:211]
    buffer_load_dwordx4 v192, s[12:15], s57 offen lds
    v_mfma_f32_16x16x32_bf16 v[204:207], a[240:243], a[124:127], v[204:207]
    v_mfma_f32_16x16x32_bf16 v[204:207], a[244:247], a[136:139], v[204:207]
    s_waitcnt vmcnt(10)
    ds_read_b64_tr_b16 a[204:205], v254 offset:61440
    ds_read_b64_tr_b16 a[206:207], v255 offset:61440
    v_mfma_f32_16x16x32_bf16 v[200:203], a[240:243], a[128:131], v[200:203]
    ds_read_b128 a[240:243], v225 offset:24448
    ds_read_b64_tr_b16 a[208:209], v254 offset:61472
    v_mfma_f32_16x16x32_bf16 v[200:203], a[244:247], a[140:143], v[200:203]
    v_cvt_pk_bf16_f32 v70, v208, v209
    v_cvt_pk_bf16_f32 v71, v210, v211
    v_mfma_f32_16x16x32_bf16 v[180:183], a[248:251], a[72:75], 0
    v_cvt_pk_bf16_f32 v92, v204, v205
    v_cvt_pk_bf16_f32 v93, v206, v207
    v_mfma_f32_16x16x32_bf16 v[180:183], a[252:255], a[84:87], v[180:183]
    ds_read_b128 a[244:247], v225 offset:24512
    ds_read_b64_tr_b16 a[210:211], v255 offset:61472
    v_mfma_f32_16x16x32_bf16 v[176:179], a[248:251], a[76:79], 0
    v_cvt_pk_bf16_f32 v114, v200, v201
    v_cvt_pk_bf16_f32 v115, v202, v203
    v_mfma_f32_16x16x32_bf16 v[176:179], a[252:255], a[88:91], v[176:179]
    buffer_load_dwordx4 v193, s[12:15], s57 offen offset:1024 lds
    v_mfma_f32_16x16x32_bf16 v[172:175], a[248:251], a[80:83], 0
    ds_read_b128 a[248:251], v225 offset:24576
    ds_read_b64_tr_b16 a[212:213], v254 offset:61504
    v_mfma_f32_16x16x32_bf16 v[172:175], a[252:255], a[92:95], v[172:175]
    ds_read_b128 a[252:255], v225 offset:24640
    v_mfma_f32_16x16x32_bf16 v[180:183], a[220:223], a[96:99], v[180:183]
    s_waitcnt lgkmcnt(8)
    buffer_load_dwordx4 v194, s[12:15], s57 offen offset:2048 lds
    v_mfma_f32_16x16x32_bf16 v[180:183], a[224:227], a[108:111], v[180:183]
    s_add_u32 s57, s49, 0xc000
    ds_read_b64_tr_b16 a[214:215], v255 offset:61504
    s_add_u32 m0, s50, 0xc000
    v_mfma_f32_16x16x32_bf16 v[176:179], a[220:223], a[100:103], v[176:179]
    buffer_load_dwordx4 v192, s[12:15], s57 offen lds
    v_mfma_f32_16x16x32_bf16 v[176:179], a[224:227], a[112:115], v[176:179]
    v_mfma_f32_16x16x32_bf16 v[172:175], a[220:223], a[104:107], v[172:175]
    ds_read_b128 a[220:223], v225 offset:24704
    v_mfma_f32_16x16x32_bf16 v[172:175], a[224:227], a[116:119], v[172:175]
    ds_read_b128 a[224:227], v225 offset:27456
    v_mfma_f32_16x16x32_bf16 v[180:183], a[228:231], a[120:123], v[180:183]
    buffer_load_dwordx4 v195, s[12:15], s57 offen offset:1024 lds
    v_mfma_f32_16x16x32_bf16 v[180:183], a[232:235], a[132:135], v[180:183]
    s_addk_i32 s57, 0x3000
    v_mfma_f32_16x16x32_bf16 v[176:179], a[228:231], a[124:127], v[176:179]
    v_mfma_f32_16x16x32_bf16 v[176:179], a[232:235], a[136:139], v[176:179]
    v_mfma_f32_16x16x32_bf16 v[172:175], a[228:231], a[128:131], v[172:175]
    ds_read_b128 a[228:231], v225 offset:27520
    v_mfma_f32_16x16x32_bf16 v[172:175], a[232:235], a[140:143], v[172:175]
    ds_read_b128 a[232:235], v225 offset:27584
    v_mfma_f32_16x16x32_bf16 v[220:223], a[144:147], a[236:239], 0
    s_waitcnt lgkmcnt(4)
    v_cvt_pk_bf16_f32 v82, v180, v181
    v_cvt_pk_bf16_f32 v83, v182, v183
    v_mfma_f32_16x16x32_bf16 v[220:223], a[156:159], a[240:243], v[220:223]
    v_cvt_pk_bf16_f32 v104, v176, v177
    v_cvt_pk_bf16_f32 v105, v178, v179
    v_mfma_f32_16x16x32_bf16 v[216:219], a[148:151], a[236:239], 0
    v_cvt_pk_bf16_f32 v126, v172, v173
    v_cvt_pk_bf16_f32 v127, v174, v175
    v_mfma_f32_16x16x32_bf16 v[216:219], a[160:163], a[240:243], v[216:219]
    buffer_load_dwordx4 v194, s[12:15], s57 offen offset:2048 lds
    v_mfma_f32_16x16x32_bf16 v[212:215], a[152:155], a[236:239], 0
    s_add_u32 s57, s49, 0xd800
    ds_read_b128 a[236:239], v225 offset:27648
    s_add_u32 m0, s50, 0xf000
    v_mfma_f32_16x16x32_bf16 v[212:215], a[164:167], a[240:243], v[212:215]
    ds_read_b128 a[240:243], v225 offset:27712
    v_mfma_f32_16x16x32_bf16 v[220:223], a[168:171], a[244:247], v[220:223]
    buffer_load_dwordx4 v192, s[12:15], s57 offen lds
    v_mfma_f32_16x16x32_bf16 v[220:223], a[180:183], a[248:251], v[220:223]
    v_mfma_f32_16x16x32_bf16 v[216:219], a[172:175], a[244:247], v[216:219]
    buffer_load_dwordx4 v193, s[12:15], s57 offen offset:1024 lds
    v_mfma_f32_16x16x32_bf16 v[216:219], a[184:187], a[248:251], v[216:219]
    v_mfma_f32_16x16x32_bf16 v[212:215], a[176:179], a[244:247], v[212:215]
    ds_read_b128 a[244:247], v225 offset:27776
    v_mfma_f32_16x16x32_bf16 v[212:215], a[188:191], a[248:251], v[212:215]
    ds_read_b128 a[248:251], v224 offset:30976
    v_mfma_f32_16x16x32_bf16 v[220:223], a[192:195], a[252:255], v[220:223]
    s_waitcnt lgkmcnt(4)
    buffer_load_dwordx4 v194, s[12:15], s57 offen offset:2048 lds
    v_mfma_f32_16x16x32_bf16 v[220:223], a[204:207], a[220:223], v[220:223]
    s_add_u32 m0, s41, 0
    v_mfma_f32_16x16x32_bf16 v[216:219], a[196:199], a[252:255], v[216:219]
    v_mfma_f32_16x16x32_bf16 v[216:219], a[208:211], a[220:223], v[216:219]
    v_mfma_f32_16x16x32_bf16 v[212:215], a[200:203], a[252:255], v[212:215]
    ds_read_b128 a[252:255], v224 offset:31040
    v_mfma_f32_16x16x32_bf16 v[212:215], a[212:215], a[220:223], v[212:215]
    ds_read_b128 a[220:223], v224 offset:31104
    v_mfma_f32_16x16x32_bf16 v[208:211], a[144:147], a[224:227], 0
    s_waitcnt lgkmcnt(3)
    v_mul_f32 v220, s37, v220
    v_mul_f32 v221, s37, v221
    v_mfma_f32_16x16x32_bf16 v[208:211], a[156:159], a[228:231], v[208:211]
    s_barrier
    v_mul_f32 v222, s37, v222
    v_mul_f32 v223, s37, v223
    v_mfma_f32_16x16x32_bf16 v[204:207], a[148:151], a[224:227], 0
    v_cvt_pk_bf16_f32 v132, v220, v221
    v_cvt_pk_bf16_f32 v133, v222, v223
    v_mfma_f32_16x16x32_bf16 v[204:207], a[160:163], a[228:231], v[204:207]
    v_mul_f32 v216, s37, v216
    v_mul_f32 v217, s37, v217
    v_mfma_f32_16x16x32_bf16 v[200:203], a[152:155], a[224:227], 0
    v_mul_f32 v218, s37, v218
    v_mul_f32 v219, s37, v219
    v_mfma_f32_16x16x32_bf16 v[200:203], a[164:167], a[228:231], v[200:203]
    v_cvt_pk_bf16_f32 v134, v216, v217
    v_cvt_pk_bf16_f32 v135, v218, v219
    v_mfma_f32_16x16x32_bf16 v[208:211], a[168:171], a[232:235], v[208:211]
    v_mul_f32 v212, s37, v212
    v_mul_f32 v213, s37, v213
    v_mfma_f32_16x16x32_bf16 v[208:211], a[180:183], a[236:239], v[208:211]
    v_mul_f32 v214, s37, v214
    v_mul_f32 v215, s37, v215
    v_mfma_f32_16x16x32_bf16 v[144:147], v[0:3], v[132:135], v[144:147]
    v_cvt_pk_bf16_f32 v136, v212, v213
    v_cvt_pk_bf16_f32 v137, v214, v215
    v_mfma_f32_16x16x32_bf16 v[148:151], v[24:27], v[132:135], v[148:151]
    ds_read_b128 a[224:227], v224 offset:31168
    ds_read_b128 a[228:231], v224 offset:31232
    v_mfma_f32_16x16x32_bf16 v[152:155], v[30:33], v[132:135], v[152:155]
    buffer_load_dwordx4 v246, s[4:7], s56 offen lds
    v_mfma_f32_16x16x16_bf16 v[144:147], v[4:5], v[136:137], v[144:147]
    s_waitcnt vmcnt(7)
    buffer_load_dwordx4 v247, s[4:7], s56 offen offset:1024 lds
    v_mfma_f32_16x16x16_bf16 v[148:151], v[28:29], v[136:137], v[148:151]
    s_add_u32 s56, s56, s42
    ds_read_b64_tr_b16 v[164:165], v86 offset:36864
    ds_read_b64_tr_b16 v[166:167], v86 offset:38400
    v_mfma_f32_16x16x16_bf16 v[152:155], v[34:35], v[136:137], v[152:155]
    s_add_u32 m0, s41, 0x1e40
    ds_read_b64_tr_b16 v[168:169], v86 offset:36896
    ds_read_b64_tr_b16 v[170:171], v86 offset:38432
    v_mfma_f32_16x16x32_bf16 v[156:159], v[6:9], v[132:135], v[156:159]
    ds_read_b64_tr_b16 v[248:249], v86 offset:36928
    ds_read_b64_tr_b16 v[250:251], v86 offset:38464
    v_mfma_f32_16x16x32_bf16 v[204:207], a[172:175], a[232:235], v[204:207]
    buffer_load_dwordx4 v246, s[4:7], s56 offen lds
    v_mfma_f32_16x16x32_bf16 v[204:207], a[184:187], a[236:239], v[204:207]
    v_exp_f32 v144, v144
    v_mfma_f32_16x16x16_bf16 v[156:159], v[10:11], v[136:137], v[156:159]
    v_exp_f32 v145, v145
    v_mfma_f32_16x16x32_bf16 v[200:203], a[176:179], a[232:235], v[200:203]
    ds_read_b128 a[232:235], v224 offset:31296
    v_cvt_pk_bf16_f32 v160, v144, v145
    v_mfma_f32_16x16x32_bf16 v[200:203], a[188:191], a[236:239], v[200:203]
    ds_read_b128 a[236:239], v224 offset:34048
    v_mfma_f32_16x16x32_bf16 v[208:211], a[192:195], a[240:243], v[208:211]
    buffer_load_dwordx4 v247, s[4:7], s56 offen offset:1024 lds
    v_mfma_f32_16x16x32_bf16 v[208:211], a[204:207], a[244:247], v[208:211]
    s_add_u32 s56, s56, s42
    v_exp_f32 v146, v146
    v_mfma_f32_16x16x32_bf16 v[204:207], a[196:199], a[240:243], v[204:207]
    s_add_u32 m0, s41, 0x3c80
    v_exp_f32 v147, v147
    v_mfma_f32_16x16x32_bf16 v[204:207], a[208:211], a[244:247], v[204:207]
    buffer_load_dwordx4 v246, s[4:7], s56 offen lds
    v_mfma_f32_16x16x32_bf16 v[200:203], a[200:203], a[240:243], v[200:203]
    v_mul_f32 v208, s37, v208
    v_mul_f32 v209, s37, v209
    v_mfma_f32_16x16x32_bf16 v[200:203], a[212:215], a[244:247], v[200:203]
    s_waitcnt lgkmcnt(2)
    v_mul_f32 v210, s37, v210
    v_mul_f32 v211, s37, v211
    v_mfma_f32_16x16x32_bf16 v[180:183], a[248:251], a[72:75], 0
    v_cvt_pk_bf16_f32 v138, v208, v209
    v_cvt_pk_bf16_f32 v139, v210, v211
    v_mfma_f32_16x16x32_bf16 v[180:183], a[252:255], a[84:87], v[180:183]
    v_mul_f32 v204, s37, v204
    v_mul_f32 v205, s37, v205
    v_mfma_f32_16x16x32_bf16 v[176:179], a[248:251], a[76:79], 0
    v_mul_f32 v206, s37, v206
    v_mul_f32 v207, s37, v207
    v_mfma_f32_16x16x32_bf16 v[176:179], a[252:255], a[88:91], v[176:179]
    v_cvt_pk_bf16_f32 v140, v204, v205
    v_cvt_pk_bf16_f32 v141, v206, v207
    v_mfma_f32_16x16x32_bf16 v[172:175], a[248:251], a[80:83], 0
    v_mul_f32 v200, s37, v200
    v_mul_f32 v201, s37, v201
    v_mfma_f32_16x16x32_bf16 v[172:175], a[252:255], a[92:95], v[172:175]
    v_mul_f32 v202, s37, v202
    v_mul_f32 v203, s37, v203
    v_mfma_f32_16x16x32_bf16 v[180:183], a[220:223], a[96:99], v[180:183]
    v_cvt_pk_bf16_f32 v142, v200, v201
    v_cvt_pk_bf16_f32 v143, v202, v203
    v_mfma_f32_16x16x32_bf16 v[180:183], a[224:227], a[108:111], v[180:183]
    ds_read_b128 a[240:243], v224 offset:34112
    ds_read_b128 a[244:247], v224 offset:34176
    v_mfma_f32_16x16x32_bf16 v[176:179], a[220:223], a[100:103], v[176:179]
    ds_read_b128 a[248:251], v224 offset:34240
    v_cvt_pk_bf16_f32 v161, v146, v147
    v_mfma_f32_16x16x32_bf16 v[176:179], a[224:227], a[112:115], v[176:179]
    ds_read_b128 a[252:255], v224 offset:34304
    v_mfma_f32_16x16x32_bf16 v[172:175], a[220:223], a[104:107], v[172:175]
    ds_read_b128 a[220:223], v224 offset:34368
    v_mfma_f32_16x16x32_bf16 v[172:175], a[224:227], a[116:119], v[172:175]
    ds_read_b128 a[224:227], v224 offset:46464
    v_mfma_f32_16x16x32_bf16 v[180:183], a[228:231], a[120:123], v[180:183]
    s_waitcnt lgkmcnt(6)
    buffer_load_dwordx4 v247, s[4:7], s56 offen offset:1024 lds
    v_mfma_f32_16x16x32_bf16 v[180:183], a[232:235], a[132:135], v[180:183]
    s_add_u32 s56, s56, s42
    ds_read_b128 v[144:147], v228 offset:1920
    s_add_u32 m0, s41, 0x5ac0
    v_mfma_f32_16x16x32_bf16 v[176:179], a[228:231], a[124:127], v[176:179]
    buffer_load_dwordx4 v246, s[4:7], s56 offen lds
    v_mfma_f32_16x16x32_bf16 v[176:179], a[232:235], a[136:139], v[176:179]
    v_exp_f32 v148, v148
    v_mfma_f32_16x16x32_bf16 v[172:175], a[228:231], a[128:131], v[172:175]
    v_cvt_pk_bf16_f32 v74, v180, v181
    v_cvt_pk_bf16_f32 v75, v182, v183
    v_mfma_f32_16x16x32_bf16 v[172:175], a[232:235], a[140:143], v[172:175]
    ds_read_b128 a[228:231], v224 offset:46528
    ds_read_b128 a[232:235], v224 offset:46592
    v_mfma_f32_16x16x32_bf16 v[220:223], a[236:239], a[72:75], 0
    s_waitcnt lgkmcnt(7)
    v_cvt_pk_bf16_f32 v96, v176, v177
    v_cvt_pk_bf16_f32 v97, v178, v179
    v_mfma_f32_16x16x32_bf16 v[220:223], a[240:243], a[84:87], v[220:223]
    buffer_load_dwordx4 v247, s[4:7], s56 offen offset:1024 lds
    v_mfma_f32_16x16x32_bf16 v[216:219], a[236:239], a[76:79], 0
    s_add_u32 s56, s56, s42
    v_cvt_pk_bf16_f32 v118, v172, v173
    v_cvt_pk_bf16_f32 v119, v174, v175
    v_mfma_f32_16x16x32_bf16 v[216:219], a[240:243], a[88:91], v[216:219]
    s_add_u32 m0, s41, 0x7900
    v_exp_f32 v149, v149
    s_waitcnt lgkmcnt(2)
    v_mfma_f32_16x16x32_bf16 v[144:147], v[12:15], v[132:135], v[144:147]
    v_exp_f32 v150, v150
    v_mfma_f32_16x16x32_bf16 v[212:215], a[236:239], a[80:83], 0
    ds_read_b128 a[236:239], v224 offset:46656
    v_cvt_pk_bf16_f32 v162, v148, v149
    v_mfma_f32_16x16x32_bf16 v[212:215], a[240:243], a[92:95], v[212:215]
    ds_read_b128 a[240:243], v224 offset:46720
    v_mfma_f32_16x16x16_bf16 v[144:147], v[16:17], v[136:137], v[144:147]
    v_exp_f32 v151, v151
    v_mfma_f32_16x16x32_bf16 v[220:223], a[244:247], a[96:99], v[220:223]
    v_cvt_pk_bf16_f32 v163, v150, v151
    v_mfma_f32_16x16x32_bf16 v[220:223], a[248:251], a[108:111], v[220:223]
    ds_read_b128 v[148:151], v229 offset:1920
    v_mfma_f32_16x16x32_bf16 v[196:199], a[216:219], v[160:163], 0
    v_exp_f32 v152, v152
    v_mfma_f32_16x16x32_bf16 v[184:187], v[66:69], v[160:163], 0
    v_exp_f32 v153, v153
    v_mfma_f32_16x16x32_bf16 v[188:191], v[88:91], v[160:163], 0
    v_exp_f32 v154, v154
    v_mfma_f32_16x16x32_bf16 v[192:195], v[110:113], v[160:163], 0
    v_exp_f32 v155, v155
    v_mfma_f32_16x16x32_bf16 v[216:219], a[244:247], a[100:103], v[216:219]
    v_cvt_pk_bf16_f32 v160, v152, v153
    v_cvt_pk_bf16_f32 v161, v154, v155
    v_mfma_f32_16x16x32_bf16 v[216:219], a[248:251], a[112:115], v[216:219]
    ds_read_b128 v[152:155], v235
    v_bfe_u32 v235, s61, v232, 4
    v_mfma_f32_16x16x32_bf16 v[212:215], a[244:247], a[104:107], v[212:215]
    ds_read_b128 a[244:247], v224 offset:46784
    v_mad_u32_u24 v235, v235, s40, v230
    v_mfma_f32_16x16x32_bf16 v[212:215], a[248:251], a[116:119], v[212:215]
    s_waitcnt lgkmcnt(2)
    ds_read_b128 a[248:251], v224 offset:49536
    v_mfma_f32_16x16x32_bf16 v[148:151], v[36:39], v[132:135], v[148:151]
    v_exp_f32 v156, v156
    v_mfma_f32_16x16x32_bf16 v[220:223], a[252:255], a[120:123], v[220:223]
    v_exp_f32 v157, v157
    v_mfma_f32_16x16x32_bf16 v[220:223], a[220:223], a[132:135], v[220:223]
    v_exp_f32 v158, v158
    v_mfma_f32_16x16x32_bf16 v[216:219], a[252:255], a[124:127], v[216:219]
    v_exp_f32 v159, v159
    v_mfma_f32_16x16x32_bf16 v[216:219], a[220:223], a[136:139], v[216:219]
    v_cvt_pk_bf16_f32 v162, v156, v157
    v_cvt_pk_bf16_f32 v163, v158, v159
    v_mfma_f32_16x16x16_bf16 v[148:151], v[40:41], v[136:137], v[148:151]
    ds_read_b128 v[156:159], v234
    v_cvt_pk_bf16_f32 v76, v220, v221
    v_mfma_f32_16x16x32_bf16 v[196:199], a[216:219], v[160:163], v[196:199]
    v_cvt_pk_bf16_f32 v77, v222, v223
    v_bfe_u32 v234, s60, v232, 4
    v_mfma_f32_16x16x32_bf16 v[184:187], v[70:73], v[160:163], v[184:187]
    v_cvt_pk_bf16_f32 v98, v216, v217
    v_cvt_pk_bf16_f32 v99, v218, v219
    v_mfma_f32_16x16x32_bf16 v[188:191], v[92:95], v[160:163], v[188:191]
    v_mad_u32_u24 v234, v234, s40, v230
    v_mfma_f32_16x16x32_bf16 v[192:195], v[114:117], v[160:163], v[192:195]
    s_waitcnt lgkmcnt(1)
    v_exp_f32 v144, v144
    v_mfma_f32_16x16x32_bf16 v[152:155], v[42:45], v[132:135], v[152:155]
    v_exp_f32 v145, v145
    v_mfma_f32_16x16x32_bf16 v[212:215], a[252:255], a[128:131], v[212:215]
    ds_read_b128 a[252:255], v224 offset:49600
    v_cvt_pk_bf16_f32 v160, v144, v145
    v_mfma_f32_16x16x32_bf16 v[212:215], a[220:223], a[140:143], v[212:215]
    ds_read_b128 a[220:223], v224 offset:49664
    v_mfma_f32_16x16x16_bf16 v[152:155], v[46:47], v[136:137], v[152:155]
    s_waitcnt lgkmcnt(2)
    v_exp_f32 v146, v146
    v_mfma_f32_16x16x32_bf16 v[156:159], v[18:21], v[132:135], v[156:159]
    v_exp_f32 v147, v147
    v_mfma_f32_16x16x32_bf16 v[208:211], a[224:227], a[72:75], 0
    v_cvt_pk_bf16_f32 v161, v146, v147
    v_mfma_f32_16x16x32_bf16 v[208:211], a[228:231], a[84:87], v[208:211]
    v_cvt_pk_bf16_f32 v120, v212, v213
    v_cvt_pk_bf16_f32 v121, v214, v215
    v_mfma_f32_16x16x16_bf16 v[156:159], v[22:23], v[136:137], v[156:159]
L_pg2:
    s_cbranch_execz L_pg6
    ds_read_b128 v[144:147], v234
    v_bfe_u32 v234, s62, v232, 4
    v_mfma_f32_16x16x32_bf16 v[204:207], a[224:227], a[76:79], 0
    v_mad_u32_u24 v234, v234, s40, v230
    v_mfma_f32_16x16x32_bf16 v[204:207], a[228:231], a[88:91], v[204:207]
    v_exp_f32 v148, v148
    v_mfma_f32_16x16x32_bf16 v[200:203], a[224:227], a[80:83], 0
    ds_read_b128 a[224:227], v224 offset:49728
    v_mfma_f32_16x16x32_bf16 v[200:203], a[228:231], a[92:95], v[200:203]
    ds_read_b128 a[228:231], v224 offset:49792
    v_mfma_f32_16x16x32_bf16 v[208:211], a[232:235], a[96:99], v[208:211]
    v_exp_f32 v149, v149
    v_mfma_f32_16x16x32_bf16 v[208:211], a[236:239], a[108:111], v[208:211]
    s_waitcnt vmcnt(4)
    v_exp_f32 v150, v150
    v_mfma_f32_16x16x32_bf16 v[204:207], a[232:235], a[100:103], v[204:207]
    s_barrier
    ds_read_b128 v[252:255], v224 offset:320
    v_cvt_pk_bf16_f32 v162, v148, v149
    v_mfma_f32_16x16x32_bf16 v[204:207], a[236:239], a[112:115], v[204:207]
    s_waitcnt lgkmcnt(3)
    v_exp_f32 v151, v151
    v_mfma_f32_16x16x32_bf16 v[144:147], v[24:27], v[138:141], v[144:147]
    v_cvt_pk_bf16_f32 v163, v150, v151
    v_mfma_f32_16x16x32_bf16 v[200:203], a[232:235], a[104:107], v[200:203]
    ds_read_b128 a[232:235], v224 offset:49856
    ds_read_b128 v[148:151], v235
    v_mfma_f32_16x16x32_bf16 v[200:203], a[236:239], a[116:119], v[200:203]
    v_bfe_u32 v235, s63, v233, 4
    v_mad_u32_u24 v235, v235, s40, v231
    v_mfma_f32_16x16x32_bf16 v[196:199], a[216:219], v[160:163], v[196:199]
    ds_read_b128 a[236:239], v227 offset:37120
    v_mfma_f32_16x16x32_bf16 v[184:187], v[74:77], v[160:163], v[184:187]
    v_exp_f32 v152, v152
    v_mfma_f32_16x16x32_bf16 v[188:191], v[96:99], v[160:163], v[188:191]
    v_exp_f32 v153, v153
    v_mfma_f32_16x16x32_bf16 v[192:195], v[118:121], v[160:163], v[192:195]
    v_exp_f32 v154, v154
    v_mfma_f32_16x16x16_bf16 v[144:147], v[28:29], v[142:143], v[144:147]
    v_exp_f32 v155, v155
    v_mfma_f32_16x16x32_bf16 v[208:211], a[240:243], a[120:123], v[208:211]
    v_cvt_pk_bf16_f32 v160, v152, v153
    v_cvt_pk_bf16_f32 v161, v154, v155
    v_mfma_f32_16x16x32_bf16 v[208:211], a[244:247], a[132:135], v[208:211]
    ds_read_b128 v[152:155], v230 offset:1920
    v_mfma_f32_16x16x32_bf16 v[204:207], a[240:243], a[124:127], v[204:207]
    v_exp_f32 v156, v156
    v_mfma_f32_16x16x32_bf16 v[204:207], a[244:247], a[136:139], v[204:207]
    s_waitcnt lgkmcnt(2)
    v_exp_f32 v157, v157
    v_mfma_f32_16x16x32_bf16 v[148:151], v[30:33], v[138:141], v[148:151]
    v_exp_f32 v158, v158
    v_mfma_f32_16x16x32_bf16 v[200:203], a[240:243], a[128:131], v[200:203]
    v_cvt_pk_bf16_f32 v80, v208, v209
    v_cvt_pk_bf16_f32 v81, v210, v211
    v_mfma_f32_16x16x32_bf16 v[200:203], a[244:247], a[140:143], v[200:203]
    ds_read_b128 a[240:243], v227 offset:37184
    v_cvt_pk_bf16_f32 v102, v204, v205
    v_mfma_f32_16x16x16_bf16 v[148:151], v[34:35], v[142:143], v[148:151]
    ds_read_b128 a[244:247], v227 offset:37248
    v_cvt_pk_bf16_f32 v103, v206, v207
    v_mfma_f32_16x16x32_bf16 v[180:183], a[248:251], a[72:75], 0
    v_exp_f32 v159, v159
    v_mfma_f32_16x16x32_bf16 v[180:183], a[252:255], a[84:87], v[180:183]
    s_waitcnt lgkmcnt(2)
    v_cvt_pk_bf16_f32 v124, v200, v201
    v_cvt_pk_bf16_f32 v125, v202, v203
    v_mfma_f32_16x16x32_bf16 v[152:155], v[36:39], v[138:141], v[152:155]
    v_cvt_pk_bf16_f32 v162, v156, v157
    v_cvt_pk_bf16_f32 v163, v158, v159
    v_mfma_f32_16x16x32_bf16 v[176:179], a[248:251], a[76:79], 0
    ds_read_b128 v[156:159], v234
    v_bfe_u32 v234, s64, v233, 4
    v_mfma_f32_16x16x32_bf16 v[176:179], a[252:255], a[88:91], v[176:179]
    v_mad_u32_u24 v234, v234, s40, v231
    v_mfma_f32_16x16x32_bf16 v[196:199], a[216:219], v[160:163], v[196:199]
    v_exp_f32 v144, v144
    v_mfma_f32_16x16x16_bf16 v[152:155], v[40:41], v[142:143], v[152:155]
    s_waitcnt vmcnt(0)
    ds_write_b128 v87, v[164:167] offset:36864
    v_mfma_f32_16x16x32_bf16 v[172:175], a[248:251], a[80:83], 0
    ds_write_b128 v87, v[168:171] offset:37888
    v_mfma_f32_16x16x32_bf16 v[172:175], a[252:255], a[92:95], v[172:175]
    ds_write_b128 v87, v[248:251] offset:38912
    v_mfma_f32_16x16x32_bf16 v[180:183], a[220:223], a[96:99], v[180:183]
    v_rcp_f32 v197, v196
    v_mfma_f32_16x16x32_bf16 v[180:183], a[224:227], a[108:111], v[180:183]
    s_waitcnt lgkmcnt(3)
    v_max3_f32 v236, v236, v196, v197
    v_mfma_f32_16x16x32_bf16 v[156:159], v[42:45], v[138:141], v[156:159]
    v_exp_f32 v145, v145
    v_mfma_f32_16x16x32_bf16 v[176:179], a[220:223], a[100:103], v[176:179]
    v_exp_f32 v146, v146
    v_mfma_f32_16x16x32_bf16 v[176:179], a[224:227], a[112:115], v[176:179]
    v_exp_f32 v147, v147
    v_mfma_f32_16x16x32_bf16 v[172:175], a[220:223], a[104:107], v[172:175]
    v_exp_f32 v148, v148
    v_mfma_f32_16x16x32_bf16 v[172:175], a[224:227], a[116:119], v[172:175]
    v_exp_f32 v149, v149
    v_mfma_f32_16x16x16_bf16 v[156:159], v[46:47], v[142:143], v[156:159]
    ds_read_b128 a[248:251], v227 offset:37312
    ds_read_b128 a[252:255], v227 offset:37376
    v_mfma_f32_16x16x32_bf16 v[180:183], a[228:231], a[120:123], v[180:183]
    ds_read_b128 a[220:223], v227 offset:37440
    v_mfma_f32_16x16x32_bf16 v[180:183], a[232:235], a[132:135], v[180:183]
    ds_read_b128 a[224:227], v225 offset:39872
    v_mfma_f32_16x16x32_bf16 v[176:179], a[228:231], a[124:127], v[176:179]
    ds_read_b128 v[164:167], v224 offset:3264
    v_mfma_f32_16x16x32_bf16 v[176:179], a[232:235], a[136:139], v[176:179]
    ds_read_b128 v[168:171], v224 offset:3328
    v_mfma_f32_16x16x32_bf16 v[172:175], a[228:231], a[128:131], v[172:175]
    ds_read_b128 a[228:231], v225 offset:39936
    v_mfma_f32_16x16x32_bf16 v[172:175], a[232:235], a[140:143], v[172:175]
    v_cvt_pk_bf16_f32 v78, v180, v181
    v_cvt_pk_bf16_f32 v79, v182, v183
    v_mfma_f32_16x16x32_bf16 v[220:223], a[236:239], a[72:75], 0
    ds_read_b128 a[232:235], v225 offset:40000
    v_cvt_pk_bf16_f32 v100, v176, v177
    v_mfma_f32_16x16x32_bf16 v[220:223], a[240:243], a[84:87], v[220:223]
    ds_read_b128 v[248:251], v224 offset:3392
    v_cvt_pk_bf16_f32 v101, v178, v179
    v_mfma_f32_16x16x32_bf16 v[184:187], v[78:81], v[160:163], v[184:187]
    v_cvt_pk_bf16_f32 v122, v172, v173
    v_cvt_pk_bf16_f32 v123, v174, v175
    v_mfma_f32_16x16x32_bf16 v[188:191], v[100:103], v[160:163], v[188:191]
    v_exp_f32 v150, v150
    v_mfma_f32_16x16x32_bf16 v[192:195], v[122:125], v[160:163], v[192:195]
    v_cvt_pk_bf16_f32 v160, v144, v145
    v_cvt_pk_bf16_f32 v161, v146, v147
    v_mfma_f32_16x16x32_bf16 v[216:219], a[236:239], a[76:79], 0
    v_mul_f32 v184, v184, v197
    v_mul_f32 v185, v185, v197
    v_mfma_f32_16x16x32_bf16 v[216:219], a[240:243], a[88:91], v[216:219]
    v_cvt_pk_bf16_f32 v184, v184, v185
    v_mul_f32 v186, v186, v197
    v_mfma_f32_16x16x32_bf16 v[212:215], a[236:239], a[80:83], 0
    ds_read_b128 a[236:239], v225 offset:40064
    v_mul_f32 v187, v187, v197
    v_mfma_f32_16x16x32_bf16 v[212:215], a[240:243], a[92:95], v[212:215]
    ds_read_b128 a[240:243], v225 offset:40128
    v_cvt_pk_bf16_f32 v185, v186, v187
    v_mfma_f32_16x16x32_bf16 v[220:223], a[244:247], a[96:99], v[220:223]
    s_waitcnt lgkmcnt(4)
    v_mul_f32 v188, v188, v197
    v_mul_f32 v189, v189, v197
    v_mfma_f32_16x16x32_bf16 v[220:223], a[248:251], a[108:111], v[220:223]
    v_cvt_pk_bf16_f32 v186, v188, v189
    v_mul_f32 v190, v190, v197
    v_mfma_f32_16x16x32_bf16 v[216:219], a[244:247], a[100:103], v[216:219]
    v_mul_f32 v191, v191, v197
    v_cvt_pk_bf16_f32 v187, v190, v191
    v_mfma_f32_16x16x32_bf16 v[216:219], a[248:251], a[112:115], v[216:219]
    v_mul_f32 v192, v192, v197
    v_mul_f32 v193, v193, v197
    v_mfma_f32_16x16x32_bf16 v[212:215], a[244:247], a[104:107], v[212:215]
    ds_read_b128 a[244:247], v225 offset:40192
    v_cvt_pk_bf16_f32 v188, v192, v193
    v_mfma_f32_16x16x32_bf16 v[212:215], a[248:251], a[116:119], v[212:215]
    v_mul_f32 v194, v194, v197
    v_mul_f32 v195, v195, v197
    v_mfma_f32_16x16x32_bf16 v[220:223], a[252:255], a[120:123], v[220:223]
    ds_read_b128 v[144:147], v235
    v_cvt_pk_bf16_f32 v189, v194, v195
    v_mfma_f32_16x16x32_bf16 v[220:223], a[220:223], a[132:135], v[220:223]
    ds_write_b128 v237, v[184:187]
    v_mfma_f32_16x16x32_bf16 v[216:219], a[252:255], a[124:127], v[216:219]
    ds_write_b64 v238, v[188:189]
    v_mfma_f32_16x16x32_bf16 v[216:219], a[220:223], a[136:139], v[216:219]
    v_bfe_u32 v235, s65, v232, 4
    v_cvt_pk_bf16_f32 v162, v148, v149
    v_mfma_f32_16x16x32_bf16 v[212:215], a[252:255], a[128:131], v[212:215]
    v_exp_f32 v151, v151
    v_mfma_f32_16x16x32_bf16 v[212:215], a[220:223], a[140:143], v[212:215]
    v_cvt_pk_bf16_f32 v84, v220, v221
    v_cvt_pk_bf16_f32 v85, v222, v223
    v_mfma_f32_16x16x32_bf16 v[208:211], a[144:147], a[224:227], 0
    v_cvt_pk_bf16_f32 v106, v216, v217
    v_cvt_pk_bf16_f32 v107, v218, v219
    v_mfma_f32_16x16x32_bf16 v[208:211], a[156:159], a[228:231], v[208:211]
    s_waitcnt lgkmcnt(2)
    ds_read_b64_tr_b16 a[248:249], v86 offset:12288
    ds_read_b64_tr_b16 a[250:251], v86 offset:13824
    v_mfma_f32_16x16x32_bf16 v[144:147], v[48:51], v[138:141], v[144:147]
    v_cvt_pk_bf16_f32 v128, v212, v213
    v_cvt_pk_bf16_f32 v129, v214, v215
    v_mfma_f32_16x16x32_bf16 v[204:207], a[148:151], a[224:227], 0
    ds_read_b64_tr_b16 a[252:253], v86 offset:12320
    ds_read_b64_tr_b16 a[254:255], v86 offset:13856
    v_mfma_f32_16x16x32_bf16 v[204:207], a[160:163], a[228:231], v[204:207]
    ds_read_b64_tr_b16 a[220:221], v86 offset:12352
    ds_read_b64_tr_b16 a[222:223], v86 offset:13888
    v_mfma_f32_16x16x16_bf16 v[144:147], v[52:53], v[142:143], v[144:147]
    v_cvt_pk_bf16_f32 v163, v150, v151
    v_mfma_f32_16x16x32_bf16 v[200:203], a[152:155], a[224:227], 0
    ds_read_b128 v[148:151], v234
    v_mad_u32_u24 v234, v235, s40, v229
    v_mfma_f32_16x16x32_bf16 v[200:203], a[164:167], a[228:231], v[200:203]
    ds_read_b64_tr_b16 a[224:225], v86 offset:24576
    v_mad_u32_u24 v235, v235, s40, v228
    v_mfma_f32_16x16x32_bf16 v[196:199], a[216:219], v[160:163], 0
    ds_read_b64_tr_b16 a[226:227], v86 offset:26112
    ds_read_b64_tr_b16 a[228:229], v86 offset:24608
    v_mfma_f32_16x16x32_bf16 v[184:187], v[68:71], v[160:163], 0
    s_waitcnt lgkmcnt(8)
    ds_write_b128 v87, a[248:251] offset:12288
    v_mfma_f32_16x16x32_bf16 v[188:191], v[90:93], v[160:163], 0
    v_exp_f32 v152, v152
    v_mfma_f32_16x16x32_bf16 v[192:195], v[112:115], v[160:163], 0
    s_waitcnt lgkmcnt(7)
    ds_write_b128 v87, a[252:255] offset:13312
    v_mfma_f32_16x16x32_bf16 v[208:211], a[168:171], a[232:235], v[208:211]
    s_waitcnt lgkmcnt(6)
    ds_write_b128 v87, a[220:223] offset:14336
    v_mfma_f32_16x16x32_bf16 v[208:211], a[180:183], a[236:239], v[208:211]
    s_waitcnt lgkmcnt(6)
    v_exp_f32 v153, v153
    v_mfma_f32_16x16x32_bf16 v[148:151], v[54:57], v[138:141], v[148:151]
    v_exp_f32 v154, v154
    v_mfma_f32_16x16x32_bf16 v[204:207], a[172:175], a[232:235], v[204:207]
    v_exp_f32 v155, v155
    v_mfma_f32_16x16x32_bf16 v[204:207], a[184:187], a[236:239], v[204:207]
    v_cvt_pk_bf16_f32 v160, v152, v153
    v_cvt_pk_bf16_f32 v161, v154, v155
    v_mfma_f32_16x16x16_bf16 v[148:151], v[58:59], v[142:143], v[148:151]
    v_exp_f32 v156, v156
    v_mfma_f32_16x16x32_bf16 v[200:203], a[176:179], a[232:235], v[200:203]
    v_exp_f32 v157, v157
    v_mfma_f32_16x16x32_bf16 v[200:203], a[188:191], a[236:239], v[200:203]
    ds_read_b128 a[236:239], v224
    ds_read_b128 a[248:251], v224 offset:192
    v_mfma_f32_16x16x32_bf16 v[208:211], a[192:195], a[240:243], v[208:211]
    ds_read_b128 a[252:255], v224 offset:256
    v_cvt_pk_bf16_f32 v162, v156, v157
    v_mfma_f32_16x16x32_bf16 v[208:211], a[204:207], a[244:247], v[208:211]
    ds_read_b64_tr_b16 a[220:221], v108
    v_mfma_f32_16x16x32_bf16 v[204:207], a[196:199], a[240:243], v[204:207]
    ds_read_b64_tr_b16 a[222:223], v108 offset:1536
    v_mfma_f32_16x16x32_bf16 v[204:207], a[208:211], a[244:247], v[204:207]
    ds_read_b128 v[152:155], v234
    v_mfma_f32_16x16x32_bf16 v[200:203], a[200:203], a[240:243], v[200:203]
    v_exp_f32 v158, v158
    v_mfma_f32_16x16x32_bf16 v[200:203], a[212:215], a[244:247], v[200:203]
    s_waitcnt lgkmcnt(5)
    v_mul_f32 v208, s37, v208
    v_mul_f32 v209, s37, v209
    v_mul_f32 v210, s37, v210
    v_mul_f32 v211, s37, v211
    v_cvt_pk_bf16_f32 v132, v208, v209
    v_cvt_pk_bf16_f32 v133, v210, v211
    v_mul_f32 v204, s37, v204
    v_mul_f32 v205, s37, v205
    v_mfma_f32_16x16x32_bf16 v[180:183], a[0:3], a[236:239], 0
    v_mul_f32 v206, s37, v206
    v_mul_f32 v207, s37, v207
    v_mfma_f32_16x16x32_bf16 v[176:179], a[4:7], a[236:239], 0
    v_cvt_pk_bf16_f32 v134, v204, v205
    v_cvt_pk_bf16_f32 v135, v206, v207
    v_mfma_f32_16x16x32_bf16 v[172:175], a[8:11], a[236:239], 0
    v_mul_f32 v200, s37, v200
    v_mul_f32 v201, s37, v201
    v_mfma_f32_16x16x32_bf16 v[220:223], a[236:239], a[72:75], 0
    v_mul_f32 v202, s37, v202
    v_mul_f32 v203, s37, v203
    v_mfma_f32_16x16x32_bf16 v[216:219], a[236:239], a[76:79], 0
    v_cvt_pk_bf16_f32 v136, v200, v201
    v_cvt_pk_bf16_f32 v137, v202, v203
    v_mfma_f32_16x16x32_bf16 v[212:215], a[236:239], a[80:83], 0
    s_waitcnt lgkmcnt(0)
    ds_read_b128 a[240:243], v224 offset:64
    ds_read_b128 a[244:247], v224 offset:128
    v_mfma_f32_16x16x32_bf16 v[152:155], v[30:33], v[132:135], v[152:155]
    ds_read_b64_tr_b16 a[230:231], v86 offset:26144
    ds_read_b64_tr_b16 a[232:233], v86 offset:24640
    v_exp_f32 v159, v159
    ds_read_b64_tr_b16 a[234:235], v86 offset:26176
    ds_write_b128 v87, a[224:227] offset:24576
    v_cvt_pk_bf16_f32 v163, v158, v159
    v_mfma_f32_16x16x16_bf16 v[152:155], v[34:35], v[136:137], v[152:155]
    v_exp_f32 v144, v144
    v_mfma_f32_16x16x32_bf16 v[196:199], a[216:219], v[160:163], v[196:199]
    v_exp_f32 v145, v145
    v_mfma_f32_16x16x32_bf16 v[184:187], v[76:79], v[160:163], v[184:187]
    ds_read_b64_tr_b16 a[224:225], v108 offset:8
    ds_read_b64_tr_b16 a[226:227], v108 offset:1544
    v_mfma_f32_16x16x32_bf16 v[188:191], v[98:101], v[160:163], v[188:191]
    ds_read_b128 v[156:159], v235
    v_bfe_u32 v235, s62, v232, 4
    v_mfma_f32_16x16x32_bf16 v[192:195], v[120:123], v[160:163], v[192:195]
    s_waitcnt lgkmcnt(8)
    v_mad_u32_u24 v234, v235, s40, v228
    v_mad_u32_u24 v235, v235, s40, v229
    v_mfma_f32_16x16x32_bf16 v[180:183], a[12:15], a[240:243], v[180:183]
    s_waitcnt lgkmcnt(6)
    ds_write_b128 v87, a[228:231] offset:25600
    v_mfma_f32_16x16x32_bf16 v[176:179], a[16:19], a[240:243], v[176:179]
    s_waitcnt lgkmcnt(5)
    ds_write_b128 v87, a[232:235] offset:26624
    v_mfma_f32_16x16x32_bf16 v[172:175], a[20:23], a[240:243], v[172:175]
    v_exp_f32 v146, v146
    v_mfma_f32_16x16x32_bf16 v[220:223], a[240:243], a[84:87], v[220:223]
    v_exp_f32 v147, v147
    v_mfma_f32_16x16x32_bf16 v[216:219], a[240:243], a[88:91], v[216:219]
    v_cvt_pk_bf16_f32 v160, v144, v145
    v_cvt_pk_bf16_f32 v161, v146, v147
    v_mfma_f32_16x16x32_bf16 v[212:215], a[240:243], a[92:95], v[212:215]
    v_exp_f32 v148, v148
    v_mfma_f32_16x16x32_bf16 v[180:183], a[24:27], a[244:247], v[180:183]
    v_exp_f32 v149, v149
    v_mfma_f32_16x16x32_bf16 v[180:183], a[36:39], a[248:251], v[180:183]
    s_waitcnt lgkmcnt(2)
    ds_read_b64_tr_b16 a[228:229], v109
    ds_read_b64_tr_b16 a[230:231], v109 offset:1536
    v_mfma_f32_16x16x32_bf16 v[156:159], v[6:9], v[132:135], v[156:159]
    ds_read_b64_tr_b16 a[232:233], v109 offset:8
    v_cvt_pk_bf16_f32 v162, v148, v149
    v_mfma_f32_16x16x32_bf16 v[176:179], a[28:31], a[244:247], v[176:179]
    ds_read_b64_tr_b16 a[234:235], v109 offset:1544
    v_mfma_f32_16x16x32_bf16 v[176:179], a[40:43], a[248:251], v[176:179]
    ds_read_b128 v[144:147], v228 offset:1280
    v_mfma_f32_16x16x16_bf16 v[156:159], v[10:11], v[136:137], v[156:159]
    v_exp_f32 v150, v150
    v_mfma_f32_16x16x32_bf16 v[172:175], a[32:35], a[244:247], v[172:175]
    ds_read_b64_tr_b16 a[236:237], v86 offset:49152
    ds_read_b64_tr_b16 a[238:239], v86 offset:50688
    v_mfma_f32_16x16x32_bf16 v[172:175], a[44:47], a[248:251], v[172:175]
    ds_read_b64_tr_b16 a[240:241], v86 offset:49184
    ds_read_b64_tr_b16 a[242:243], v86 offset:50720
    v_mfma_f32_16x16x32_bf16 v[220:223], a[244:247], a[96:99], v[220:223]
    v_exp_f32 v151, v151
    v_mfma_f32_16x16x32_bf16 v[220:223], a[248:251], a[108:111], v[220:223]
    v_cvt_pk_bf16_f32 v163, v150, v151
    v_mfma_f32_16x16x32_bf16 v[216:219], a[244:247], a[100:103], v[216:219]
    ds_read_b128 v[148:151], v229 offset:1280
    v_mfma_f32_16x16x32_bf16 v[216:219], a[248:251], a[112:115], v[216:219]
    v_exp_f32 v152, v152
    v_mfma_f32_16x16x32_bf16 v[196:199], a[216:219], v[160:163], v[196:199]
    v_exp_f32 v153, v153
    v_mfma_f32_16x16x32_bf16 v[184:187], v[82:85], v[160:163], v[184:187]
    v_exp_f32 v154, v154
    v_mfma_f32_16x16x32_bf16 v[188:191], v[104:107], v[160:163], v[188:191]
    v_exp_f32 v155, v155
    v_mfma_f32_16x16x32_bf16 v[192:195], v[126:129], v[160:163], v[192:195]
    s_waitcnt lgkmcnt(5)
    v_cvt_pk_bf16_f32 v160, v152, v153
    v_cvt_pk_bf16_f32 v161, v154, v155
    v_mfma_f32_16x16x32_bf16 v[144:147], v[12:15], v[132:135], v[144:147]
    v_rcp_f32 v197, v196
    v_mfma_f32_16x16x32_bf16 v[212:215], a[244:247], a[104:107], v[212:215]
    v_mul_f32 v184, v184, v197
    v_mul_f32 v185, v185, v197
    v_mfma_f32_16x16x32_bf16 v[212:215], a[248:251], a[116:119], v[212:215]
    ds_read_b128 a[248:251], v224 offset:3072
    v_cvt_pk_bf16_f32 v184, v184, v185
    v_mfma_f32_16x16x16_bf16 v[144:147], v[16:17], v[136:137], v[144:147]
    s_waitcnt lgkmcnt(1)
    v_mul_f32 v186, v186, v197
    v_mul_f32 v187, v187, v197
    v_mfma_f32_16x16x32_bf16 v[148:151], v[36:39], v[132:135], v[148:151]
    v_cvt_pk_bf16_f32 v185, v186, v187
    v_mul_f32 v188, v188, v197
    v_mfma_f32_16x16x32_bf16 v[180:183], a[48:51], a[252:255], v[180:183]
    v_mul_f32 v189, v189, v197
    v_cvt_pk_bf16_f32 v186, v188, v189
    v_mfma_f32_16x16x32_bf16 v[180:183], a[60:63], v[252:255], v[180:183]
    v_mul_f32 v190, v190, v197
    v_mul_f32 v191, v191, v197
    v_mfma_f32_16x16x16_bf16 v[148:151], v[40:41], v[136:137], v[148:151]
    v_cvt_pk_bf16_f32 v187, v190, v191
    v_mul_f32 v192, v192, v197
    v_mfma_f32_16x16x32_bf16 v[176:179], a[52:55], a[252:255], v[176:179]
    v_mul_f32 v193, v193, v197
    v_cvt_pk_bf16_f32 v188, v192, v193
    v_mfma_f32_16x16x32_bf16 v[176:179], a[64:67], v[252:255], v[176:179]
    v_cvt_pk_bf16_f32 v0, v180, v181
    v_cvt_pk_bf16_f32 v1, v182, v183
    v_mfma_f32_16x16x32_bf16 v[172:175], a[56:59], a[252:255], v[172:175]
    v_mul_f32 v194, v194, v197
    v_mul_f32 v195, v195, v197
    v_mfma_f32_16x16x32_bf16 v[172:175], a[68:71], v[252:255], v[172:175]
    v_cvt_pk_bf16_f32 v189, v194, v195
    v_max3_f32 v236, v236, v196, v197
    v_mfma_f32_16x16x32_bf16 v[220:223], a[252:255], a[120:123], v[220:223]
    v_cvt_pk_bf16_f32 v2, v176, v177
    v_cvt_pk_bf16_f32 v3, v178, v179
    v_mfma_f32_16x16x32_bf16 v[220:223], v[252:255], a[132:135], v[220:223]
    ds_write_b128 v237, v[184:187] offset:6144
    v_mfma_f32_16x16x32_bf16 v[216:219], a[252:255], a[124:127], v[216:219]
    v_cvt_pk_bf16_f32 v4, v172, v173
    v_cvt_pk_bf16_f32 v5, v174, v175
    v_mfma_f32_16x16x32_bf16 v[216:219], v[252:255], a[136:139], v[216:219]
    ds_write_b64 v238, v[188:189] offset:6144
    v_mfma_f32_16x16x32_bf16 v[212:215], a[252:255], a[128:131], v[212:215]
    v_exp_f32 v156, v156
    v_mfma_f32_16x16x32_bf16 v[212:215], v[252:255], a[140:143], v[212:215]
    s_waitcnt lgkmcnt(2)
    v_cvt_pk_bf16_f32 v66, v220, v221
    v_cvt_pk_bf16_f32 v67, v222, v223
    v_mfma_f32_16x16x32_bf16 v[208:211], a[0:3], a[248:251], 0
    ds_read_b128 a[252:255], v224 offset:3136
    v_cvt_pk_bf16_f32 v88, v216, v217
    v_mfma_f32_16x16x32_bf16 v[204:207], a[4:7], a[248:251], 0
    ds_read_b128 v[252:255], v224 offset:3200
    v_cvt_pk_bf16_f32 v89, v218, v219
    v_mfma_f32_16x16x32_bf16 v[200:203], a[8:11], a[248:251], 0
    v_cvt_pk_bf16_f32 v110, v212, v213
    v_cvt_pk_bf16_f32 v111, v214, v215
    v_mfma_f32_16x16x32_bf16 v[180:183], a[248:251], a[72:75], 0
    ds_read_b128 v[152:155], v229 offset:1920
    v_mfma_f32_16x16x32_bf16 v[176:179], a[248:251], a[76:79], 0
    ds_read_b64_tr_b16 a[244:245], v86 offset:49216
    ds_read_b64_tr_b16 a[246:247], v86 offset:50752
    v_mfma_f32_16x16x32_bf16 v[172:175], a[248:251], a[80:83], 0
    s_waitcnt lgkmcnt(4)
    ds_read_b128 a[248:251], v225 offset:42944
    v_exp_f32 v157, v157
    ds_write_b128 v87, a[236:239] offset:49152
    ds_write_b128 v87, a[240:243] offset:50176
    v_mfma_f32_16x16x32_bf16 v[172:175], a[252:255], a[92:95], v[172:175]
    v_exp_f32 v158, v158
    v_mfma_f32_16x16x32_bf16 v[208:211], a[12:15], a[252:255], v[208:211]
    v_exp_f32 v159, v159
    v_mfma_f32_16x16x32_bf16 v[204:207], a[16:19], a[252:255], v[204:207]
    s_waitcnt lgkmcnt(5)
    v_cvt_pk_bf16_f32 v162, v156, v157
    v_cvt_pk_bf16_f32 v163, v158, v159
    v_mfma_f32_16x16x32_bf16 v[152:155], v[42:45], v[132:135], v[152:155]
    v_exp_f32 v144, v144
    v_mfma_f32_16x16x32_bf16 v[196:199], a[216:219], v[160:163], 0
    s_waitcnt lgkmcnt(3)
    ds_write_b128 v87, a[244:247] offset:51200
    v_mfma_f32_16x16x32_bf16 v[184:187], v[70:73], v[160:163], 0
    v_exp_f32 v145, v145
    v_mfma_f32_16x16x32_bf16 v[188:191], v[92:95], v[160:163], 0
    v_exp_f32 v146, v146
    v_mfma_f32_16x16x32_bf16 v[192:195], v[114:117], v[160:163], 0
    v_exp_f32 v147, v147
    v_mfma_f32_16x16x16_bf16 v[152:155], v[46:47], v[136:137], v[152:155]
    v_cvt_pk_bf16_f32 v160, v144, v145
    v_cvt_pk_bf16_f32 v161, v146, v147
    v_mfma_f32_16x16x32_bf16 v[200:203], a[20:23], a[252:255], v[200:203]
    ds_read_b128 v[156:159], v228 offset:1920
    v_mfma_f32_16x16x32_bf16 v[180:183], a[252:255], a[84:87], v[180:183]
    ds_read_b128 v[144:147], v234
    v_bfe_u32 v234, s65, v232, 4
    v_mfma_f32_16x16x32_bf16 v[176:179], a[252:255], a[88:91], v[176:179]
    ds_read_b128 a[252:255], v225 offset:43008
    v_mad_u32_u24 v234, v234, s40, v230
    v_mfma_f32_16x16x32_bf16 v[208:211], a[24:27], v[252:255], v[208:211]
    ds_read_b64_tr_b16 a[236:237], v86 offset:61440
    v_mfma_f32_16x16x32_bf16 v[208:211], a[36:39], v[164:167], v[208:211]
    ds_read_b64_tr_b16 a[238:239], v86 offset:62976
    ds_read_b64_tr_b16 a[240:241], v86 offset:61472
    v_mfma_f32_16x16x32_bf16 v[204:207], a[28:31], v[252:255], v[204:207]
    ds_read_b64_tr_b16 a[242:243], v86 offset:63008
    ds_read_b64_tr_b16 a[244:245], v86 offset:61504
    v_mfma_f32_16x16x32_bf16 v[204:207], a[40:43], v[164:167], v[204:207]
    ds_read_b64_tr_b16 a[246:247], v86 offset:63040
    v_mfma_f32_16x16x32_bf16 v[200:203], a[32:35], v[252:255], v[200:203]
    v_exp_f32 v148, v148
    v_mfma_f32_16x16x32_bf16 v[200:203], a[44:47], v[164:167], v[200:203]
    s_waitcnt lgkmcnt(8)
    v_exp_f32 v149, v149
    v_mfma_f32_16x16x32_bf16 v[156:159], v[18:21], v[132:135], v[156:159]
    v_exp_f32 v150, v150
    v_mfma_f32_16x16x32_bf16 v[180:183], v[252:255], a[96:99], v[180:183]
    v_exp_f32 v151, v151
    v_mfma_f32_16x16x32_bf16 v[180:183], v[164:167], a[108:111], v[180:183]
    v_cvt_pk_bf16_f32 v162, v148, v149
    v_cvt_pk_bf16_f32 v163, v150, v151
    v_mfma_f32_16x16x16_bf16 v[156:159], v[22:23], v[136:137], v[156:159]
    ds_read_b128 v[148:151], v235
    v_bfe_u32 v235, s62, v232, 4
    v_mfma_f32_16x16x32_bf16 v[196:199], a[216:219], v[160:163], v[196:199]
    v_mad_u32_u24 v235, v235, s40, v230
    v_mfma_f32_16x16x32_bf16 v[184:187], v[74:77], v[160:163], v[184:187]
    s_waitcnt lgkmcnt(4)
    ds_write_b128 v87, a[236:239] offset:61440
    v_mfma_f32_16x16x32_bf16 v[188:191], v[96:99], v[160:163], v[188:191]
    s_waitcnt lgkmcnt(2)
    ds_write_b128 v87, a[240:243] offset:62464
    v_mfma_f32_16x16x32_bf16 v[192:195], v[118:121], v[160:163], v[192:195]
    ds_write_b128 v87, a[244:247] offset:63488
    v_mfma_f32_16x16x32_bf16 v[144:147], v[0:3], v[132:135], v[144:147]
    v_exp_f32 v152, v152
    v_mfma_f32_16x16x32_bf16 v[176:179], v[252:255], a[100:103], v[176:179]
    v_exp_f32 v153, v153
    v_mfma_f32_16x16x32_bf16 v[176:179], v[164:167], a[112:115], v[176:179]
    v_exp_f32 v154, v154
    v_mfma_f32_16x16x32_bf16 v[172:175], v[252:255], a[104:107], v[172:175]
    v_exp_f32 v155, v155
    v_mfma_f32_16x16x32_bf16 v[172:175], v[164:167], a[116:119], v[172:175]
    v_cvt_pk_bf16_f32 v160, v152, v153
    v_cvt_pk_bf16_f32 v161, v154, v155
    v_mfma_f32_16x16x16_bf16 v[144:147], v[4:5], v[136:137], v[144:147]
    v_exp_f32 v156, v156
    v_mfma_f32_16x16x32_bf16 v[208:211], a[48:51], v[168:171], v[208:211]
    v_exp_f32 v157, v157
    v_mfma_f32_16x16x32_bf16 v[208:211], a[60:63], v[248:251], v[208:211]
    ds_read_b128 v[252:255], v225 offset:43072
    ds_read_b128 v[164:167], v225 offset:43136
    v_mfma_f32_16x16x32_bf16 v[204:207], a[52:55], v[168:171], v[204:207]
    ds_read_b128 v[152:155], v235
    v_bfe_u32 v235, s66, v233, 4
    v_mfma_f32_16x16x32_bf16 v[204:207], a[64:67], v[248:251], v[204:207]
    v_mad_u32_u24 v235, v235, s40, v231
    v_cvt_pk_bf16_f32 v162, v156, v157
    v_mfma_f32_16x16x32_bf16 v[200:203], a[56:59], v[168:171], v[200:203]
    v_cvt_pk_bf16_f32 v24, v208, v209
    v_cvt_pk_bf16_f32 v25, v210, v211
    v_mfma_f32_16x16x32_bf16 v[200:203], a[68:71], v[248:251], v[200:203]
    v_exp_f32 v158, v158
    v_mfma_f32_16x16x32_bf16 v[180:183], v[168:171], a[120:123], v[180:183]
    v_cvt_pk_bf16_f32 v26, v204, v205
    v_cvt_pk_bf16_f32 v27, v206, v207
    v_mfma_f32_16x16x32_bf16 v[180:183], v[248:251], a[132:135], v[180:183]
    s_waitcnt lgkmcnt(4)
    v_exp_f32 v159, v159
    v_mfma_f32_16x16x32_bf16 v[148:151], v[24:27], v[132:135], v[148:151]
    v_cvt_pk_bf16_f32 v163, v158, v159
    v_cvt_pk_bf16_f32 v28, v200, v201
    v_mfma_f32_16x16x32_bf16 v[176:179], v[168:171], a[124:127], v[176:179]
    ds_read_b128 v[156:159], v234
    v_cvt_pk_bf16_f32 v29, v202, v203
    v_mfma_f32_16x16x32_bf16 v[176:179], v[248:251], a[136:139], v[176:179]
    v_cvt_pk_bf16_f32 v68, v180, v181
    v_cvt_pk_bf16_f32 v69, v182, v183
    v_mfma_f32_16x16x32_bf16 v[196:199], a[216:219], v[160:163], v[196:199]
    v_bfe_u32 v234, s67, v233, 4
    v_mad_u32_u24 v234, v234, s40, v231
    v_mfma_f32_16x16x32_bf16 v[184:187], v[78:81], v[160:163], v[184:187]
    v_exp_f32 v144, v144
    v_mfma_f32_16x16x32_bf16 v[188:191], v[100:103], v[160:163], v[188:191]
    v_cvt_pk_bf16_f32 v90, v176, v177
    v_cvt_pk_bf16_f32 v91, v178, v179
    v_mfma_f32_16x16x32_bf16 v[192:195], v[122:125], v[160:163], v[192:195]
    v_exp_f32 v145, v145
    v_mfma_f32_16x16x16_bf16 v[148:151], v[28:29], v[136:137], v[148:151]
    v_exp_f32 v146, v146
    v_mfma_f32_16x16x32_bf16 v[172:175], v[168:171], a[128:131], v[172:175]
    ds_read_b128 v[168:171], v225 offset:43200
    v_cvt_pk_bf16_f32 v160, v144, v145
    v_mfma_f32_16x16x32_bf16 v[172:175], v[248:251], a[140:143], v[172:175]
    ds_read_b128 v[248:251], v225 offset:43264
    v_mfma_f32_16x16x32_bf16 v[220:223], a[144:147], a[248:251], 0
    v_exp_f32 v147, v147
    v_mfma_f32_16x16x32_bf16 v[220:223], a[156:159], a[252:255], v[220:223]
    v_cvt_pk_bf16_f32 v161, v146, v147
    v_mfma_f32_16x16x32_bf16 v[216:219], a[148:151], a[248:251], 0
    ds_read_b128 v[144:147], v230 offset:1280
    v_mfma_f32_16x16x32_bf16 v[216:219], a[160:163], a[252:255], v[216:219]
    v_cvt_pk_bf16_f32 v112, v172, v173
    v_cvt_pk_bf16_f32 v113, v174, v175
    v_mfma_f32_16x16x32_bf16 v[212:215], a[152:155], a[248:251], 0
    v_exp_f32 v148, v148
    v_mfma_f32_16x16x32_bf16 v[212:215], a[164:167], a[252:255], v[212:215]
    s_waitcnt lgkmcnt(3)
    v_exp_f32 v149, v149
    v_mfma_f32_16x16x32_bf16 v[220:223], a[168:171], v[252:255], v[220:223]
    v_exp_f32 v150, v150
    v_mfma_f32_16x16x32_bf16 v[220:223], a[180:183], v[164:167], v[220:223]
    s_waitcnt lgkmcnt(1)
    v_exp_f32 v151, v151
    v_mfma_f32_16x16x32_bf16 v[216:219], a[172:175], v[252:255], v[216:219]
    s_barrier
    ds_read_b128 a[236:239], v227 offset:6144
    ds_read_b128 a[240:243], v227 offset:6208
    v_mfma_f32_16x16x32_bf16 v[216:219], a[184:187], v[164:167], v[216:219]
    ds_read_b128 a[244:247], v227 offset:6272
    v_cvt_pk_bf16_f32 v162, v148, v149
    v_mfma_f32_16x16x32_bf16 v[212:215], a[176:179], v[252:255], v[212:215]
    ds_read_b128 a[248:251], v227 offset:6336
    v_cvt_pk_bf16_f32 v163, v150, v151
    v_mfma_f32_16x16x32_bf16 v[212:215], a[188:191], v[164:167], v[212:215]
    buffer_load_dwordx4 v246, s[4:7], s56 offen lds
    v_mfma_f32_16x16x32_bf16 v[196:199], a[216:219], v[160:163], v[196:199]
    ds_read_b128 a[252:255], v239
    ds_read_b128 v[252:255], v240
    v_mfma_f32_16x16x32_bf16 v[184:187], v[66:69], v[160:163], v[184:187]
    ds_read_b128 v[148:151], v230 offset:1920
    v_mfma_f32_16x16x32_bf16 v[188:191], v[88:91], v[160:163], v[188:191]
    v_mfma_f32_16x16x32_bf16 v[192:195], v[110:113], v[160:163], v[192:195]
L_pg3:
    s_cbranch_execz L_pg7
    ds_read_b128 v[164:167], v239 offset:1024
    v_mfma_f32_16x16x32_bf16 v[220:223], a[192:195], v[168:171], v[220:223]
    v_rcp_f32 v197, v196
    v_mfma_f32_16x16x32_bf16 v[220:223], a[204:207], v[248:251], v[220:223]
    v_max3_f32 v236, v236, v196, v197
    v_mul_f32 v184, v184, v197
    v_mfma_f32_16x16x32_bf16 v[216:219], a[196:199], v[168:171], v[216:219]
    v_mul_f32 v185, v185, v197
    v_cvt_pk_bf16_f32 v184, v184, v185
    v_mfma_f32_16x16x32_bf16 v[216:219], a[208:211], v[248:251], v[216:219]
    buffer_load_dwordx4 v247, s[4:7], s56 offen offset:1024 lds
    v_mfma_f32_16x16x32_bf16 v[212:215], a[200:203], v[168:171], v[212:215]
    s_add_u32 s56, s56, s42
    v_mul_f32 v220, s37, v220
    v_mul_f32 v221, s37, v221
    v_mfma_f32_16x16x32_bf16 v[212:215], a[212:215], v[248:251], v[212:215]
    s_add_u32 m0, s41, 0x9740
    v_mul_f32 v222, s37, v222
    v_mul_f32 v223, s37, v223
    s_waitcnt lgkmcnt(3)
    v_mfma_f32_16x16x32_bf16 v[208:211], a[220:223], a[252:255], 0
    v_cvt_pk_bf16_f32 v138, v220, v221
    v_cvt_pk_bf16_f32 v139, v222, v223
    v_mfma_f32_16x16x32_bf16 v[220:223], a[0:3], a[236:239], 0
    v_mul_f32 v216, s37, v216
    v_mul_f32 v217, s37, v217
    v_mfma_f32_16x16x32_bf16 v[220:223], a[12:15], a[240:243], v[220:223]
    v_mul_f32 v218, s37, v218
    v_mul_f32 v219, s37, v219
    v_mfma_f32_16x16x32_bf16 v[220:223], a[24:27], a[244:247], v[220:223]
    v_cvt_pk_bf16_f32 v140, v216, v217
    v_cvt_pk_bf16_f32 v141, v218, v219
    v_mfma_f32_16x16x32_bf16 v[220:223], a[36:39], a[248:251], v[220:223]
    v_mul_f32 v212, s37, v212
    v_mul_f32 v213, s37, v213
    v_mfma_f32_16x16x32_bf16 v[152:155], v[24:27], v[138:141], v[152:155]
    v_mul_f32 v214, s37, v214
    v_mul_f32 v215, s37, v215
    v_mfma_f32_16x16x32_bf16 v[156:159], v[30:33], v[138:141], v[156:159]
    v_cvt_pk_bf16_f32 v142, v212, v213
    v_cvt_pk_bf16_f32 v143, v214, v215
    v_mfma_f32_16x16x32_bf16 v[144:147], v[36:39], v[138:141], v[144:147]
    buffer_load_dwordx4 v246, s[4:7], s56 offen lds
    v_mfma_f32_16x16x16_bf16 v[152:155], v[28:29], v[142:143], v[152:155]
    v_mul_f32 v186, v186, v197
    v_mul_f32 v187, v187, v197
    v_mfma_f32_16x16x16_bf16 v[156:159], v[34:35], v[142:143], v[156:159]
    v_cvt_pk_bf16_f32 v185, v186, v187
    v_mul_f32 v188, v188, v197
    v_mfma_f32_16x16x16_bf16 v[144:147], v[40:41], v[142:143], v[144:147]
    s_waitcnt lgkmcnt(0)
    v_mul_f32 v189, v189, v197
    v_cvt_pk_bf16_f32 v186, v188, v189
    v_mfma_f32_16x16x32_bf16 v[148:151], v[42:45], v[138:141], v[148:151]
    v_mul_f32 v190, v190, v197
    v_mul_f32 v191, v191, v197
    v_mfma_f32_16x16x32_bf16 v[216:219], a[4:7], a[236:239], 0
    v_cvt_pk_bf16_f32 v187, v190, v191
    v_mul_f32 v192, v192, v197
    v_mfma_f32_16x16x32_bf16 v[216:219], a[16:19], a[240:243], v[216:219]
    v_mul_f32 v193, v193, v197
    v_cvt_pk_bf16_f32 v188, v192, v193
    v_mfma_f32_16x16x16_bf16 v[148:151], v[46:47], v[142:143], v[148:151]
    v_mul_f32 v194, v194, v197
    v_mul_f32 v195, v195, v197
    v_mfma_f32_16x16x32_bf16 v[212:215], a[8:11], a[236:239], 0
    ds_read_b128 a[236:239], v227 offset:6400
    v_cvt_pk_bf16_f32 v189, v194, v195
    v_mfma_f32_16x16x32_bf16 v[212:215], a[20:23], a[240:243], v[212:215]
    ds_read_b128 a[240:243], v227 offset:6464
    ds_read_b128 v[168:171], v241 offset:12288
    v_mfma_f32_16x16x32_bf16 v[216:219], a[28:31], a[244:247], v[216:219]
    buffer_load_dwordx4 v247, s[4:7], s56 offen offset:1024 lds
    v_mfma_f32_16x16x32_bf16 v[216:219], a[40:43], a[248:251], v[216:219]
    s_add_u32 s56, s56, s42
    ds_write_b128 v237, v[184:187] offset:12288
    v_mfma_f32_16x16x32_bf16 v[212:215], a[32:35], a[244:247], v[212:215]
    s_add_u32 m0, s41, 0xb580
    ds_write_b64 v238, v[188:189] offset:12288
    v_mfma_f32_16x16x32_bf16 v[212:215], a[44:47], a[248:251], v[212:215]
    v_exp_f32 v152, v152
    v_mfma_f32_16x16x32_bf16 v[200:203], a[220:223], v[252:255], 0
    v_exp_f32 v153, v153
    v_mfma_f32_16x16x32_bf16 v[204:207], a[224:227], a[252:255], 0
    s_waitcnt lgkmcnt(4)
    v_exp_f32 v154, v154
    v_mfma_f32_16x16x32_bf16 v[220:223], a[48:51], a[236:239], v[220:223]
    s_waitcnt lgkmcnt(3)
    ds_read_b128 a[244:247], v227 offset:6144
    ds_read_b128 a[248:251], v227 offset:6208
    v_mfma_f32_16x16x32_bf16 v[220:223], a[60:63], a[240:243], v[220:223]
    ds_read_b128 v[248:251], v241 offset:12800
    v_cvt_pk_bf16_f32 v160, v152, v153
    v_mfma_f32_16x16x32_bf16 v[216:219], a[52:55], a[236:239], v[216:219]
    v_exp_f32 v155, v155
    v_mfma_f32_16x16x32_bf16 v[216:219], a[64:67], a[240:243], v[216:219]
    v_cvt_pk_bf16_f32 v161, v154, v155
    v_mfma_f32_16x16x32_bf16 v[212:215], a[56:59], a[236:239], v[212:215]
    ds_read_b128 a[236:239], v227 offset:6272
    v_cvt_pk_bf16_f32 v60, v220, v221
    v_mfma_f32_16x16x32_bf16 v[212:215], a[68:71], a[240:243], v[212:215]
    ds_read_b128 a[240:243], v227 offset:6336
    v_cvt_pk_bf16_f32 v61, v222, v223
    v_mfma_f32_16x16x32_bf16 v[180:183], a[224:227], v[252:255], 0
    v_cvt_pk_bf16_f32 v62, v216, v217
    v_cvt_pk_bf16_f32 v63, v218, v219
    v_mfma_f32_16x16x32_bf16 v[176:179], a[228:231], a[252:255], 0
    ds_read_b128 v[152:155], v235
    v_bfe_u32 v235, s68, v233, 4
    v_mfma_f32_16x16x32_bf16 v[172:175], a[232:235], a[252:255], 0
    s_waitcnt lgkmcnt(5)
    v_cvt_pk_bf16_f32 v64, v212, v213
    v_cvt_pk_bf16_f32 v65, v214, v215
    v_mfma_f32_16x16x32_bf16 v[220:223], a[244:247], a[72:75], 0
    s_waitcnt lgkmcnt(4)
    ds_read_b128 a[252:255], v240 offset:1024
    v_mad_u32_u24 v235, v235, s40, v231
    v_mfma_f32_16x16x32_bf16 v[220:223], a[248:251], a[84:87], v[220:223]
    ds_read_b128 v[252:255], v239 offset:2048
    v_mfma_f32_16x16x32_bf16 v[216:219], a[244:247], a[76:79], 0
    v_exp_f32 v156, v156
    v_mfma_f32_16x16x32_bf16 v[216:219], a[248:251], a[88:91], v[216:219]
    v_exp_f32 v157, v157
    v_mfma_f32_16x16x32_bf16 v[212:215], a[244:247], a[80:83], 0
    ds_read_b128 a[244:247], v227 offset:6400
    v_cvt_pk_bf16_f32 v162, v156, v157
    v_mfma_f32_16x16x32_bf16 v[212:215], a[248:251], a[92:95], v[212:215]
    s_waitcnt lgkmcnt(5)
    ds_read_b128 a[248:251], v227 offset:6464
    v_mfma_f32_16x16x32_bf16 v[220:223], a[236:239], a[96:99], v[220:223]
    s_waitcnt lgkmcnt(5)
    v_exp_f32 v158, v158
    v_mfma_f32_16x16x32_bf16 v[220:223], a[240:243], a[108:111], v[220:223]
    s_waitcnt lgkmcnt(4)
    v_exp_f32 v159, v159
    v_mfma_f32_16x16x32_bf16 v[152:155], v[48:51], v[138:141], v[152:155]
    v_cvt_pk_bf16_f32 v163, v158, v159
    v_mfma_f32_16x16x32_bf16 v[216:219], a[236:239], a[100:103], v[216:219]
    ds_read_b128 v[156:159], v234
    v_bfe_u32 v234, s69, v233, 4
    v_mfma_f32_16x16x32_bf16 v[216:219], a[240:243], a[112:115], v[216:219]
    v_mad_u32_u24 v234, v234, s40, v231
    v_mfma_f32_16x16x32_bf16 v[196:199], a[216:219], v[160:163], 0
    v_exp_f32 v144, v144
    v_mfma_f32_16x16x32_bf16 v[184:187], v[68:71], v[160:163], 0
    v_exp_f32 v145, v145
    v_mfma_f32_16x16x32_bf16 v[188:191], v[90:93], v[160:163], 0
    v_exp_f32 v146, v146
    v_mfma_f32_16x16x32_bf16 v[192:195], v[112:115], v[160:163], 0
    v_exp_f32 v147, v147
    v_mfma_f32_16x16x16_bf16 v[152:155], v[52:53], v[142:143], v[152:155]
    v_cvt_pk_bf16_f32 v160, v144, v145
    v_cvt_pk_bf16_f32 v161, v146, v147
    v_mfma_f32_16x16x32_bf16 v[212:215], a[236:239], a[104:107], v[212:215]
    ds_read_b128 a[236:239], v226 offset:1152
    ds_read_b128 v[144:147], v235
    v_mfma_f32_16x16x32_bf16 v[212:215], a[240:243], a[116:119], v[212:215]
    s_waitcnt lgkmcnt(2)
    v_bfe_u32 v235, s70, v233, 4
    v_mad_u32_u24 v235, v235, s40, v231
    v_mfma_f32_16x16x32_bf16 v[156:159], v[54:57], v[138:141], v[156:159]
    ds_read_b128 a[240:243], v226 offset:1216
    v_mfma_f32_16x16x32_bf16 v[220:223], a[244:247], a[120:123], v[220:223]
    v_exp_f32 v148, v148
    v_mfma_f32_16x16x32_bf16 v[220:223], a[248:251], a[132:135], v[220:223]
    v_exp_f32 v149, v149
    v_mfma_f32_16x16x32_bf16 v[216:219], a[244:247], a[124:127], v[216:219]
    v_exp_f32 v150, v150
    v_mfma_f32_16x16x32_bf16 v[216:219], a[248:251], a[136:139], v[216:219]
    v_exp_f32 v151, v151
    v_mfma_f32_16x16x16_bf16 v[156:159], v[58:59], v[142:143], v[156:159]
    v_cvt_pk_bf16_f32 v162, v148, v149
    v_cvt_pk_bf16_f32 v163, v150, v151
    v_mfma_f32_16x16x32_bf16 v[212:215], a[244:247], a[128:131], v[212:215]
    v_cvt_pk_bf16_f32 v86, v220, v221
    v_cvt_pk_bf16_f32 v87, v222, v223
    v_mfma_f32_16x16x32_bf16 v[212:215], a[248:251], a[140:143], v[212:215]
    v_cvt_pk_bf16_f32 v108, v216, v217
    v_cvt_pk_bf16_f32 v109, v218, v219
    v_mfma_f32_16x16x32_bf16 v[196:199], a[216:219], v[160:163], v[196:199]
    ds_read_b128 a[244:247], v226 offset:1280
    ds_read_b128 a[248:251], v226 offset:1344
    v_mfma_f32_16x16x32_bf16 v[184:187], v[76:79], v[160:163], v[184:187]
    ds_read_b128 v[148:151], v228 offset:640
    v_mfma_f32_16x16x32_bf16 v[188:191], v[98:101], v[160:163], v[188:191]
    v_cvt_pk_bf16_f32 v130, v212, v213
    v_cvt_pk_bf16_f32 v131, v214, v215
    v_mfma_f32_16x16x32_bf16 v[192:195], v[120:123], v[160:163], v[192:195]
    s_waitcnt lgkmcnt(3)
    v_exp_f32 v152, v152
    v_mfma_f32_16x16x32_bf16 v[144:147], v[60:63], v[138:141], v[144:147]
    v_exp_f32 v153, v153
    v_mfma_f32_16x16x32_bf16 v[220:223], a[144:147], a[236:239], 0
    v_exp_f32 v154, v154
    v_mfma_f32_16x16x32_bf16 v[220:223], a[156:159], a[240:243], v[220:223]
    v_exp_f32 v155, v155
    v_mfma_f32_16x16x32_bf16 v[216:219], a[148:151], a[236:239], 0
    v_cvt_pk_bf16_f32 v160, v152, v153
    v_cvt_pk_bf16_f32 v161, v154, v155
    v_mfma_f32_16x16x32_bf16 v[216:219], a[160:163], a[240:243], v[216:219]
    ds_read_b128 v[152:155], v229 offset:640
    v_mfma_f32_16x16x16_bf16 v[144:147], v[64:65], v[142:143], v[144:147]
    v_exp_f32 v156, v156
    v_mfma_f32_16x16x32_bf16 v[212:215], a[152:155], a[236:239], 0
    ds_read_b128 a[236:239], v226 offset:1408
    v_mfma_f32_16x16x32_bf16 v[212:215], a[164:167], a[240:243], v[212:215]
    s_waitcnt lgkmcnt(3)
    ds_read_b128 a[240:243], v226 offset:1472
    v_mfma_f32_16x16x32_bf16 v[220:223], a[168:171], a[244:247], v[220:223]
    v_exp_f32 v157, v157
    v_mfma_f32_16x16x32_bf16 v[220:223], a[180:183], a[248:251], v[220:223]
    v_exp_f32 v158, v158
    v_mfma_f32_16x16x32_bf16 v[216:219], a[172:175], a[244:247], v[216:219]
    v_exp_f32 v159, v159
    v_mfma_f32_16x16x32_bf16 v[216:219], a[184:187], a[248:251], v[216:219]
    v_cvt_pk_bf16_f32 v162, v156, v157
    v_cvt_pk_bf16_f32 v163, v158, v159
    v_mfma_f32_16x16x32_bf16 v[212:215], a[176:179], a[244:247], v[212:215]
    ds_read_b128 a[244:247], v224 offset:15488
    ds_read_b128 v[156:159], v229 offset:1280
    v_mfma_f32_16x16x32_bf16 v[212:215], a[188:191], a[248:251], v[212:215]
    v_exp_f32 v144, v144
    v_mfma_f32_16x16x32_bf16 v[196:199], a[216:219], v[160:163], v[196:199]
    ds_read_b128 a[248:251], v224 offset:15552
    v_mfma_f32_16x16x32_bf16 v[184:187], v[82:85], v[160:163], v[184:187]
    v_exp_f32 v145, v145
    v_mfma_f32_16x16x32_bf16 v[188:191], v[104:107], v[160:163], v[188:191]
    v_exp_f32 v146, v146
    v_mfma_f32_16x16x32_bf16 v[192:195], v[126:129], v[160:163], v[192:195]
    s_waitcnt lgkmcnt(3)
    v_exp_f32 v147, v147
    v_mfma_f32_16x16x32_bf16 v[220:223], a[192:195], a[236:239], v[220:223]
    v_cvt_pk_bf16_f32 v160, v144, v145
    v_cvt_pk_bf16_f32 v161, v146, v147
    v_mfma_f32_16x16x32_bf16 v[220:223], a[204:207], a[240:243], v[220:223]
    ds_read_b128 v[144:147], v228 offset:1280
    v_mfma_f32_16x16x16_bf16 v[196:199], a[216:217], v[160:161], v[196:199]
    v_mfma_f32_16x16x16_bf16 v[184:187], v[86:87], v[160:161], v[184:187]
    v_mfma_f32_16x16x16_bf16 v[188:191], v[108:109], v[160:161], v[188:191]
    v_mfma_f32_16x16x16_bf16 v[192:195], v[130:131], v[160:161], v[192:195]
    v_mfma_f32_16x16x32_bf16 v[216:219], a[196:199], a[236:239], v[216:219]
    v_mfma_f32_16x16x32_bf16 v[216:219], a[208:211], a[240:243], v[216:219]
    v_mfma_f32_16x16x32_bf16 v[212:215], a[200:203], a[236:239], v[212:215]
    v_mul_f32 v220, s37, v220
    v_mul_f32 v221, s37, v221
    v_mfma_f32_16x16x32_bf16 v[212:215], a[212:215], a[240:243], v[212:215]
    v_mul_f32 v222, s37, v222
    v_mul_f32 v223, s37, v223
    v_mfma_f32_16x16x32_bf16 v[208:211], v[168:171], v[164:167], v[208:211]
    v_cvt_pk_bf16_f32 v132, v220, v221
    v_cvt_pk_bf16_f32 v133, v222, v223
    v_mfma_f32_16x16x32_bf16 v[200:203], v[168:171], a[252:255], v[200:203]
    v_mul_f32 v216, s37, v216
    v_mul_f32 v217, s37, v217
    v_mfma_f32_16x16x32_bf16 v[204:207], v[248:251], v[164:167], v[204:207]
    v_mul_f32 v218, s37, v218
    v_mul_f32 v219, s37, v219
    v_mfma_f32_16x16x32_bf16 v[180:183], v[248:251], a[252:255], v[180:183]
    s_waitcnt lgkmcnt(0)
    v_cvt_pk_bf16_f32 v134, v216, v217
    v_cvt_pk_bf16_f32 v135, v218, v219
    v_mfma_f32_16x16x32_bf16 v[220:223], a[0:3], a[244:247], 0
    v_mul_f32 v212, s37, v212
    v_mul_f32 v213, s37, v213
    v_mfma_f32_16x16x32_bf16 v[220:223], a[12:15], a[248:251], v[220:223]
    v_mul_f32 v214, s37, v214
    v_mul_f32 v215, s37, v215
    v_mfma_f32_16x16x32_bf16 v[148:151], v[12:15], v[132:135], v[148:151]
    v_cvt_pk_bf16_f32 v136, v212, v213
    v_cvt_pk_bf16_f32 v137, v214, v215
    v_mfma_f32_16x16x32_bf16 v[152:155], v[36:39], v[132:135], v[152:155]
    ds_read_b128 a[236:239], v224 offset:15616
    ds_read_b128 a[240:243], v224 offset:15680
    v_mfma_f32_16x16x32_bf16 v[156:159], v[42:45], v[132:135], v[156:159]
    v_rcp_f32 v197, v196
    v_mfma_f32_16x16x16_bf16 v[148:151], v[16:17], v[136:137], v[148:151]
    v_mul_f32 v184, v184, v197
    v_mul_f32 v185, v185, v197
    v_mfma_f32_16x16x16_bf16 v[152:155], v[40:41], v[136:137], v[152:155]
    v_cvt_pk_bf16_f32 v184, v184, v185
    v_mul_f32 v186, v186, v197
    v_mfma_f32_16x16x16_bf16 v[156:159], v[46:47], v[136:137], v[156:159]
    v_mul_f32 v187, v187, v197
    v_cvt_pk_bf16_f32 v185, v186, v187
    v_mfma_f32_16x16x32_bf16 v[144:147], v[18:21], v[132:135], v[144:147]
    v_mul_f32 v188, v188, v197
    v_mul_f32 v189, v189, v197
    v_mfma_f32_16x16x32_bf16 v[216:219], a[4:7], a[244:247], 0
    v_cvt_pk_bf16_f32 v186, v188, v189
    v_mul_f32 v190, v190, v197
    v_mfma_f32_16x16x32_bf16 v[216:219], a[16:19], a[248:251], v[216:219]
    v_mul_f32 v191, v191, v197
    v_cvt_pk_bf16_f32 v187, v190, v191
    v_mfma_f32_16x16x16_bf16 v[144:147], v[22:23], v[136:137], v[144:147]
    v_mul_f32 v192, v192, v197
    v_mul_f32 v193, v193, v197
    v_mfma_f32_16x16x32_bf16 v[212:215], a[8:11], a[244:247], 0
    ds_read_b128 a[244:247], v224 offset:15744
    v_cvt_pk_bf16_f32 v188, v192, v193
    v_mfma_f32_16x16x32_bf16 v[212:215], a[20:23], a[248:251], v[212:215]
    s_waitcnt lgkmcnt(2)
    ds_read_b128 a[248:251], v224 offset:15808
    v_mul_f32 v194, v194, v197
    v_mfma_f32_16x16x32_bf16 v[220:223], a[24:27], a[236:239], v[220:223]
    s_waitcnt lgkmcnt(2)
    v_mul_f32 v195, v195, v197
    v_cvt_pk_bf16_f32 v189, v194, v195
    v_mfma_f32_16x16x32_bf16 v[220:223], a[36:39], a[240:243], v[220:223]
    ds_read_b128 v[168:171], v242 offset:12288
    v_max3_f32 v236, v236, v196, v197
    v_mfma_f32_16x16x32_bf16 v[216:219], a[28:31], a[236:239], v[216:219]
    ds_write_b128 v237, v[184:187] offset:18432
    v_mfma_f32_16x16x32_bf16 v[216:219], a[40:43], a[240:243], v[216:219]
    ds_write_b64 v238, v[188:189] offset:18432
    v_mfma_f32_16x16x32_bf16 v[212:215], a[32:35], a[236:239], v[212:215]
    v_exp_f32 v148, v148
    v_mfma_f32_16x16x32_bf16 v[212:215], a[44:47], a[240:243], v[212:215]
    s_waitcnt lgkmcnt(4)
    v_exp_f32 v149, v149
    v_mfma_f32_16x16x32_bf16 v[220:223], a[48:51], a[244:247], v[220:223]
    s_waitcnt lgkmcnt(3)
    v_exp_f32 v150, v150
    v_mfma_f32_16x16x32_bf16 v[220:223], a[60:63], a[248:251], v[220:223]
    ds_read_b128 a[236:239], v224 offset:15488
    ds_read_b128 a[240:243], v224 offset:15552
    v_mfma_f32_16x16x32_bf16 v[216:219], a[52:55], a[244:247], v[216:219]
    ds_read_b128 v[248:251], v242 offset:12800
    v_cvt_pk_bf16_f32 v160, v148, v149
    v_mfma_f32_16x16x32_bf16 v[216:219], a[64:67], a[248:251], v[216:219]
    s_waitcnt lgkmcnt(5)
    ds_read_b128 a[252:255], v239 offset:3072
    v_mfma_f32_16x16x32_bf16 v[176:179], v[168:171], v[164:167], v[176:179]
    v_cvt_pk_bf16_f32 v6, v220, v221
    v_cvt_pk_bf16_f32 v7, v222, v223
    v_mfma_f32_16x16x32_bf16 v[212:215], a[56:59], a[244:247], v[212:215]
    ds_read_b128 a[244:247], v224 offset:15616
    ds_read_b128 v[168:171], v241 offset:24576
    v_mfma_f32_16x16x32_bf16 v[212:215], a[68:71], a[248:251], v[212:215]
    s_waitcnt lgkmcnt(5)
    v_cvt_pk_bf16_f32 v8, v216, v217
    v_cvt_pk_bf16_f32 v9, v218, v219
    ds_read_b128 a[248:251], v224 offset:15680
    v_exp_f32 v151, v151
    v_exp_f32 v152, v152
    v_cvt_pk_bf16_f32 v161, v150, v151
    ds_read_b128 v[148:151], v228 offset:1920
    v_mfma_f32_16x16x32_bf16 v[220:223], a[236:239], a[72:75], 0
    s_waitcnt lgkmcnt(6)
    v_cvt_pk_bf16_f32 v10, v212, v213
    v_cvt_pk_bf16_f32 v11, v214, v215
    v_mfma_f32_16x16x32_bf16 v[220:223], a[240:243], a[84:87], v[220:223]
    s_waitcnt lgkmcnt(5)
    v_exp_f32 v153, v153
    v_mfma_f32_16x16x32_bf16 v[172:175], v[248:251], v[164:167], v[172:175]
    ds_read_b128 v[164:167], v240 offset:2048
    ds_read_b128 v[248:251], v241 offset:25088
    v_mfma_f32_16x16x32_bf16 v[216:219], a[236:239], a[76:79], 0
    v_exp_f32 v154, v154
    v_mfma_f32_16x16x32_bf16 v[216:219], a[240:243], a[88:91], v[216:219]
    s_waitcnt lgkmcnt(4)
    v_exp_f32 v155, v155
    v_mfma_f32_16x16x32_bf16 v[208:211], v[168:171], v[252:255], v[208:211]
    v_cvt_pk_bf16_f32 v162, v152, v153
    v_cvt_pk_bf16_f32 v163, v154, v155
    v_mfma_f32_16x16x32_bf16 v[212:215], a[236:239], a[80:83], 0
    ds_read_b128 a[236:239], v224 offset:15744
    ds_read_b128 v[152:155], v229 offset:1920
    v_mfma_f32_16x16x32_bf16 v[212:215], a[240:243], a[92:95], v[212:215]
    v_exp_f32 v156, v156
    v_mfma_f32_16x16x32_bf16 v[196:199], a[216:219], v[160:163], 0
    ds_read_b128 a[240:243], v224 offset:15808
    v_mfma_f32_16x16x32_bf16 v[184:187], v[74:77], v[160:163], 0
    v_exp_f32 v157, v157
    v_mfma_f32_16x16x32_bf16 v[188:191], v[96:99], v[160:163], 0
    v_exp_f32 v158, v158
    v_mfma_f32_16x16x32_bf16 v[192:195], v[118:121], v[160:163], 0
    s_waitcnt lgkmcnt(5)
    v_exp_f32 v159, v159
    v_mfma_f32_16x16x32_bf16 v[148:151], v[0:3], v[132:135], v[148:151]
    s_waitcnt lgkmcnt(4)
    v_cvt_pk_bf16_f32 v160, v156, v157
    v_cvt_pk_bf16_f32 v161, v158, v159
    v_mfma_f32_16x16x32_bf16 v[200:203], v[168:171], v[164:167], v[200:203]
    s_waitcnt lgkmcnt(3)
    ds_read_b128 v[168:171], v242 offset:24576
    ds_read_b128 v[156:159], v229 offset:2560
    v_mfma_f32_16x16x32_bf16 v[204:207], v[248:251], v[252:255], v[204:207]
    v_exp_f32 v144, v144
    v_mfma_f32_16x16x16_bf16 v[148:151], v[4:5], v[136:137], v[148:151]
    s_waitcnt lgkmcnt(3)
    v_exp_f32 v145, v145
    v_mfma_f32_16x16x32_bf16 v[152:155], v[24:27], v[132:135], v[152:155]
    v_exp_f32 v146, v146
    v_mfma_f32_16x16x32_bf16 v[180:183], v[248:251], v[164:167], v[180:183]
    ds_read_b128 v[248:251], v242 offset:25088
    ds_read_b128 v[164:167], v239 offset:4096
    v_mfma_f32_16x16x32_bf16 v[220:223], a[244:247], a[96:99], v[220:223]
    v_exp_f32 v147, v147
    v_mfma_f32_16x16x32_bf16 v[220:223], a[248:251], a[108:111], v[220:223]
    v_cvt_pk_bf16_f32 v162, v144, v145
    v_cvt_pk_bf16_f32 v163, v146, v147
    v_mfma_f32_16x16x16_bf16 v[152:155], v[28:29], v[136:137], v[152:155]
    ds_read_b128 v[144:147], v228 offset:2560
    v_mfma_f32_16x16x32_bf16 v[196:199], a[216:219], v[160:163], v[196:199]
    v_exp_f32 v148, v148
    v_mfma_f32_16x16x32_bf16 v[184:187], v[78:81], v[160:163], v[184:187]
    v_exp_f32 v149, v149
    v_mfma_f32_16x16x32_bf16 v[188:191], v[100:103], v[160:163], v[188:191]
    v_exp_f32 v150, v150
    v_mfma_f32_16x16x32_bf16 v[192:195], v[122:125], v[160:163], v[192:195]
    s_waitcnt lgkmcnt(3)
    v_exp_f32 v151, v151
    v_mfma_f32_16x16x32_bf16 v[176:179], v[168:171], v[252:255], v[176:179]
    s_waitcnt lgkmcnt(2)
    ds_read_b128 v[168:171], v241 offset:36864
    v_cvt_pk_bf16_f32 v160, v148, v149
    v_mfma_f32_16x16x32_bf16 v[172:175], v[248:251], v[252:255], v[172:175]
    ds_read_b128 v[252:255], v240 offset:3072
    ds_read_b128 v[248:251], v241 offset:37376
    v_mfma_f32_16x16x32_bf16 v[216:219], a[244:247], a[100:103], v[216:219]
    v_cvt_pk_bf16_f32 v161, v150, v151
    v_mfma_f32_16x16x32_bf16 v[216:219], a[248:251], a[112:115], v[216:219]
    s_waitcnt lgkmcnt(3)
    ds_read_b128 v[148:151], v230 offset:640
    v_mfma_f32_16x16x32_bf16 v[144:147], v[6:9], v[132:135], v[144:147]
    v_exp_f32 v152, v152
    v_mfma_f32_16x16x32_bf16 v[212:215], a[244:247], a[104:107], v[212:215]
    ds_read_b128 a[244:247], v224 offset:18560
    v_mfma_f32_16x16x32_bf16 v[212:215], a[248:251], a[116:119], v[212:215]
    ds_read_b128 a[248:251], v224 offset:18624
    v_mfma_f32_16x16x32_bf16 v[220:223], a[236:239], a[120:123], v[220:223]
    v_exp_f32 v153, v153
    v_mfma_f32_16x16x32_bf16 v[220:223], a[240:243], a[132:135], v[220:223]
    v_exp_f32 v154, v154
    v_mfma_f32_16x16x16_bf16 v[144:147], v[10:11], v[136:137], v[144:147]
    v_exp_f32 v155, v155
    v_mfma_f32_16x16x32_bf16 v[216:219], a[236:239], a[124:127], v[216:219]
    v_cvt_pk_bf16_f32 v162, v152, v153
    v_cvt_pk_bf16_f32 v163, v154, v155
    v_mfma_f32_16x16x32_bf16 v[216:219], a[240:243], a[136:139], v[216:219]
    ds_read_b128 v[152:155], v230 offset:1280
    v_cvt_pk_bf16_f32 v72, v220, v221
    v_mfma_f32_16x16x32_bf16 v[196:199], a[216:219], v[160:163], v[196:199]
    v_cvt_pk_bf16_f32 v73, v222, v223
    v_mfma_f32_16x16x32_bf16 v[184:187], v[66:69], v[160:163], v[184:187]
    v_exp_f32 v144, v144
    v_mfma_f32_16x16x32_bf16 v[188:191], v[88:91], v[160:163], v[188:191]
    v_exp_f32 v145, v145
    v_mfma_f32_16x16x32_bf16 v[192:195], v[110:113], v[160:163], v[192:195]
    v_cvt_pk_bf16_f32 v94, v216, v217
    v_cvt_pk_bf16_f32 v95, v218, v219
    v_mfma_f32_16x16x32_bf16 v[212:215], a[236:239], a[128:131], v[212:215]
    ds_read_b128 a[236:239], v224 offset:18688
    v_cvt_pk_bf16_f32 v162, v144, v145
    v_mfma_f32_16x16x32_bf16 v[212:215], a[240:243], a[140:143], v[212:215]
    s_waitcnt lgkmcnt(2)
    ds_read_b128 a[240:243], v224 offset:18752
    v_mfma_f32_16x16x32_bf16 v[208:211], v[168:171], a[252:255], v[208:211]
    v_exp_f32 v146, v146
    v_mfma_f32_16x16x32_bf16 v[200:203], v[168:171], v[252:255], v[200:203]
    ds_read_b128 v[168:171], v242 offset:36864
    v_mfma_f32_16x16x32_bf16 v[204:207], v[248:251], a[252:255], v[204:207]
    v_exp_f32 v147, v147
    v_mfma_f32_16x16x32_bf16 v[180:183], v[248:251], v[252:255], v[180:183]
    v_cvt_pk_bf16_f32 v116, v212, v213
    v_cvt_pk_bf16_f32 v117, v214, v215
    v_mfma_f32_16x16x32_bf16 v[220:223], a[0:3], a[244:247], 0
    ds_read_b128 v[248:251], v242 offset:37376
    ds_read_b128 v[252:255], v239 offset:5120
    v_mfma_f32_16x16x32_bf16 v[220:223], a[12:15], a[248:251], v[220:223]
    v_cvt_pk_bf16_f32 v163, v146, v147
    v_mfma_f32_16x16x32_bf16 v[216:219], a[4:7], a[244:247], 0
    ds_read_b128 v[144:147], v230 offset:2560
    v_mfma_f32_16x16x32_bf16 v[216:219], a[16:19], a[248:251], v[216:219]
    v_mfma_f32_16x16x32_bf16 v[212:215], a[8:11], a[244:247], 0
    ds_read_b128 a[244:247], v224 offset:18816
    v_mfma_f32_16x16x32_bf16 v[212:215], a[20:23], a[248:251], v[212:215]
    s_waitcnt lgkmcnt(4)
    ds_read_b128 a[248:251], v224 offset:18880
    v_mfma_f32_16x16x32_bf16 v[176:179], v[168:171], a[252:255], v[176:179]
    ds_read_b128 v[168:171], v241 offset:49152
    v_mfma_f32_16x16x32_bf16 v[220:223], a[24:27], a[236:239], v[220:223]
    v_mfma_f32_16x16x32_bf16 v[220:223], a[36:39], a[240:243], v[220:223]
    s_waitcnt lgkmcnt(5)
    v_mfma_f32_16x16x32_bf16 v[172:175], v[248:251], a[252:255], v[172:175]
    ds_read_b128 a[252:255], v240 offset:4096
    ds_read_b128 v[248:251], v241 offset:49664
    v_mfma_f32_16x16x32_bf16 v[216:219], a[28:31], a[236:239], v[216:219]
    v_mfma_f32_16x16x32_bf16 v[216:219], a[40:43], a[240:243], v[216:219]
    v_mfma_f32_16x16x32_bf16 v[212:215], a[32:35], a[236:239], v[212:215]
    ds_read_b128 a[236:239], v224 offset:18560
    v_mfma_f32_16x16x32_bf16 v[212:215], a[44:47], a[240:243], v[212:215]
    s_waitcnt lgkmcnt(5)
    ds_read_b128 a[240:243], v224 offset:18624
    v_mfma_f32_16x16x32_bf16 v[220:223], a[48:51], a[244:247], v[220:223]
    s_waitcnt lgkmcnt(5)
    v_mfma_f32_16x16x32_bf16 v[220:223], a[60:63], a[248:251], v[220:223]
    v_mfma_f32_16x16x32_bf16 v[216:219], a[52:55], a[244:247], v[216:219]
    v_mfma_f32_16x16x32_bf16 v[216:219], a[64:67], a[248:251], v[216:219]
    v_mfma_f32_16x16x32_bf16 v[212:215], a[56:59], a[244:247], v[212:215]
    ds_read_b128 a[244:247], v224 offset:18688
    v_mfma_f32_16x16x32_bf16 v[212:215], a[68:71], a[248:251], v[212:215]
    s_waitcnt lgkmcnt(4)
    ds_read_b128 a[248:251], v224 offset:18752
    v_mfma_f32_16x16x32_bf16 v[208:211], v[168:171], v[164:167], v[208:211]
    v_mfma_f32_16x16x32_bf16 v[200:203], v[168:171], a[252:255], v[200:203]
    s_waitcnt lgkmcnt(4)
    v_cvt_pk_bf16_f32 v30, v220, v221
    v_cvt_pk_bf16_f32 v31, v222, v223
    v_mfma_f32_16x16x32_bf16 v[204:207], v[248:251], v[164:167], v[204:207]
    v_cvt_pk_bf16_f32 v32, v216, v217
    v_cvt_pk_bf16_f32 v33, v218, v219
    v_mfma_f32_16x16x32_bf16 v[180:183], v[248:251], a[252:255], v[180:183]
    v_cvt_pk_bf16_f32 v34, v212, v213
    v_cvt_pk_bf16_f32 v35, v214, v215
    v_mfma_f32_16x16x32_bf16 v[156:159], v[30:33], v[132:135], v[156:159]
    s_waitcnt lgkmcnt(2)
    ds_read_b128 v[168:171], v242 offset:49152
    ds_read_b128 v[248:251], v242 offset:49664
    v_mfma_f32_16x16x32_bf16 v[220:223], a[236:239], a[72:75], 0
    v_mfma_f32_16x16x32_bf16 v[220:223], a[240:243], a[84:87], v[220:223]
    v_mfma_f32_16x16x32_bf16 v[216:219], a[236:239], a[76:79], 0
    v_mfma_f32_16x16x32_bf16 v[216:219], a[240:243], a[88:91], v[216:219]
    v_mfma_f32_16x16x16_bf16 v[156:159], v[34:35], v[136:137], v[156:159]
    v_mfma_f32_16x16x32_bf16 v[212:215], a[236:239], a[80:83], 0
    ds_read_b128 a[236:239], v224 offset:18816
    v_mfma_f32_16x16x32_bf16 v[212:215], a[240:243], a[92:95], v[212:215]
    s_waitcnt lgkmcnt(3)
    ds_read_b128 a[240:243], v224 offset:18880
    v_mfma_f32_16x16x32_bf16 v[220:223], a[244:247], a[96:99], v[220:223]
    v_mfma_f32_16x16x32_bf16 v[220:223], a[248:251], a[108:111], v[220:223]
    s_waitcnt lgkmcnt(3)
    v_mfma_f32_16x16x32_bf16 v[176:179], v[168:171], v[164:167], v[176:179]
    s_waitcnt lgkmcnt(2)
    ds_read_b128 v[168:171], v241 offset:61440
    v_mfma_f32_16x16x32_bf16 v[172:175], v[248:251], v[164:167], v[172:175]
    ds_read_b128 v[164:167], v240 offset:5120
    ds_read_b128 v[248:251], v241 offset:61952
    v_mfma_f32_16x16x32_bf16 v[216:219], a[244:247], a[100:103], v[216:219]
    v_exp_f32 v156, v156
    v_mfma_f32_16x16x32_bf16 v[216:219], a[248:251], a[112:115], v[216:219]
    v_exp_f32 v157, v157
    v_mfma_f32_16x16x32_bf16 v[212:215], a[244:247], a[104:107], v[212:215]
    ds_read_b128 a[244:247], v226 offset:4224
    v_cvt_pk_bf16_f32 v160, v156, v157
    v_mfma_f32_16x16x32_bf16 v[212:215], a[248:251], a[116:119], v[212:215]
    s_waitcnt lgkmcnt(5)
    ds_read_b128 a[248:251], v226 offset:4288
    v_mfma_f32_16x16x32_bf16 v[220:223], a[236:239], a[120:123], v[220:223]
    s_waitcnt lgkmcnt(5)
    v_exp_f32 v158, v158
    v_mfma_f32_16x16x32_bf16 v[220:223], a[240:243], a[132:135], v[220:223]
    v_exp_f32 v159, v159
    v_mfma_f32_16x16x32_bf16 v[216:219], a[236:239], a[124:127], v[216:219]
    v_cvt_pk_bf16_f32 v161, v158, v159
    v_mfma_f32_16x16x32_bf16 v[216:219], a[240:243], a[136:139], v[216:219]
    ds_read_b128 v[156:159], v230 offset:1920
    v_mfma_f32_16x16x32_bf16 v[196:199], a[216:219], v[160:163], v[196:199]
    v_mfma_f32_16x16x32_bf16 v[212:215], a[236:239], a[128:131], v[212:215]
    ds_read_b128 a[236:239], v226 offset:4352
    v_cvt_pk_bf16_f32 v70, v220, v221
    v_mfma_f32_16x16x32_bf16 v[212:215], a[240:243], a[140:143], v[212:215]
    s_waitcnt lgkmcnt(4)
    ds_read_b128 a[240:243], v226 offset:4416
    v_cvt_pk_bf16_f32 v71, v222, v223
    v_mfma_f32_16x16x32_bf16 v[208:211], v[168:171], v[252:255], v[208:211]
    v_cvt_pk_bf16_f32 v92, v216, v217
    v_cvt_pk_bf16_f32 v93, v218, v219
    v_mfma_f32_16x16x32_bf16 v[184:187], v[70:73], v[160:163], v[184:187]
    v_rcp_f32 v197, v196
    v_mfma_f32_16x16x32_bf16 v[188:191], v[92:95], v[160:163], v[188:191]
    v_cvt_pk_bf16_f32 v114, v212, v213
    v_cvt_pk_bf16_f32 v115, v214, v215
    v_mfma_f32_16x16x32_bf16 v[200:203], v[168:171], v[164:167], v[200:203]
    ds_read_b128 v[168:171], v242 offset:61440
    v_cvt_pk_bf16_f32 v208, v208, v209
    v_mfma_f32_16x16x32_bf16 v[192:195], v[114:117], v[160:163], v[192:195]
    v_cvt_pk_bf16_f32 v209, v210, v211
    v_mul_f32 v184, v184, v197
    v_mfma_f32_16x16x32_bf16 v[204:207], v[248:251], v[252:255], v[204:207]
    v_mul_f32 v185, v185, v197
    v_cvt_pk_bf16_f32 v184, v184, v185
    v_mfma_f32_16x16x32_bf16 v[180:183], v[248:251], v[164:167], v[180:183]
    s_waitcnt lgkmcnt(3)
    ds_read_b128 v[248:251], v242 offset:61952
    v_cvt_pk_bf16_f32 v200, v200, v201
    v_mfma_f32_16x16x32_bf16 v[220:223], a[144:147], a[244:247], 0
    v_cvt_pk_bf16_f32 v201, v202, v203
    v_mul_f32 v186, v186, v197
    v_mfma_f32_16x16x32_bf16 v[220:223], a[156:159], a[248:251], v[220:223]
    v_cvt_pk_bf16_f32 v210, v204, v205
    v_cvt_pk_bf16_f32 v211, v206, v207
    v_mfma_f32_16x16x32_bf16 v[216:219], a[148:151], a[244:247], 0
L_pg4:
    s_cbranch_execz L_pg8
    buffer_store_dwordx4 v[208:211], v243, s[20:23], s51 offen sc0 sc1
    v_mfma_f32_16x16x32_bf16 v[216:219], a[160:163], a[248:251], v[216:219]
    s_waitcnt lgkmcnt(1)
    v_cvt_pk_bf16_f32 v202, v180, v181
    v_cvt_pk_bf16_f32 v203, v182, v183
    v_mfma_f32_16x16x32_bf16 v[176:179], v[168:171], v[252:255], v[176:179]
    v_mul_f32 v187, v187, v197
    v_cvt_pk_bf16_f32 v185, v186, v187
    v_mfma_f32_16x16x32_bf16 v[212:215], a[152:155], a[244:247], 0
    ds_read_b128 a[244:247], v226 offset:4480
    v_mul_f32 v188, v188, v197
    v_mfma_f32_16x16x32_bf16 v[212:215], a[164:167], a[248:251], v[212:215]
    s_waitcnt lgkmcnt(1)
    ds_read_b128 a[248:251], v226 offset:4544
    v_mul_f32 v189, v189, v197
    v_mfma_f32_16x16x32_bf16 v[172:175], v[248:251], v[252:255], v[172:175]
    v_cvt_pk_bf16_f32 v176, v176, v177
    v_cvt_pk_bf16_f32 v177, v178, v179
    v_mfma_f32_16x16x32_bf16 v[220:223], a[168:171], a[236:239], v[220:223]
    v_cvt_pk_bf16_f32 v186, v188, v189
    v_mul_f32 v190, v190, v197
    v_mfma_f32_16x16x32_bf16 v[220:223], a[180:183], a[240:243], v[220:223]
    v_mul_f32 v191, v191, v197
    v_cvt_pk_bf16_f32 v187, v190, v191
    v_mfma_f32_16x16x32_bf16 v[216:219], a[172:175], a[236:239], v[216:219]
    v_cvt_pk_bf16_f32 v178, v172, v173
    v_cvt_pk_bf16_f32 v179, v174, v175
    v_mfma_f32_16x16x32_bf16 v[216:219], a[184:187], a[240:243], v[216:219]
    v_mul_f32 v192, v192, v197
    v_mul_f32 v193, v193, v197
    v_mfma_f32_16x16x32_bf16 v[212:215], a[176:179], a[236:239], v[212:215]
    ds_read_b128 a[236:239], v225 offset:8896
    v_cvt_pk_bf16_f32 v188, v192, v193
    v_mfma_f32_16x16x32_bf16 v[212:215], a[188:191], a[240:243], v[212:215]
    s_waitcnt lgkmcnt(2)
    ds_read_b128 a[240:243], v225 offset:8960
    v_mul_f32 v194, v194, v197
    v_mfma_f32_16x16x32_bf16 v[220:223], a[192:195], a[244:247], v[220:223]
    s_waitcnt vmcnt(1) lgkmcnt(2)
    buffer_store_dwordx4 v[200:203], v245, s[20:23], s51 offen sc0 sc1
    v_mfma_f32_16x16x32_bf16 v[220:223], a[204:207], a[248:251], v[220:223]
    s_barrier
    v_mul_f32 v195, v195, v197
    v_cvt_pk_bf16_f32 v189, v194, v195
    v_mfma_f32_16x16x32_bf16 v[216:219], a[196:199], a[244:247], v[216:219]
    ds_read_b128 a[252:255], v239 offset:12288
    v_max3_f32 v236, v236, v196, v197
    v_mfma_f32_16x16x32_bf16 v[216:219], a[208:211], a[248:251], v[216:219]
    ds_write_b128 v237, v[184:187]
    v_mfma_f32_16x16x32_bf16 v[212:215], a[200:203], a[244:247], v[212:215]
    v_mul_f32 v220, s37, v220
    v_mul_f32 v221, s37, v221
    v_mfma_f32_16x16x32_bf16 v[212:215], a[212:215], a[248:251], v[212:215]
    s_waitcnt lgkmcnt(3)
    v_mul_f32 v222, s37, v222
    v_mul_f32 v223, s37, v223
    v_cvt_pk_bf16_f32 v138, v220, v221
    v_cvt_pk_bf16_f32 v139, v222, v223
    v_mfma_f32_16x16x32_bf16 v[220:223], a[144:147], a[236:239], 0
    s_waitcnt lgkmcnt(2)
    v_mul_f32 v216, s37, v216
    v_mul_f32 v217, s37, v217
    v_mfma_f32_16x16x32_bf16 v[220:223], a[156:159], a[240:243], v[220:223]
    v_mul_f32 v218, s37, v218
    v_mul_f32 v219, s37, v219
    v_cvt_pk_bf16_f32 v140, v216, v217
    v_cvt_pk_bf16_f32 v141, v218, v219
    v_mfma_f32_16x16x32_bf16 v[216:219], a[148:151], a[236:239], 0
    v_mul_f32 v212, s37, v212
    v_mul_f32 v213, s37, v213
    v_mfma_f32_16x16x32_bf16 v[216:219], a[160:163], a[240:243], v[216:219]
    v_mul_f32 v214, s37, v214
    v_mul_f32 v215, s37, v215
    v_mfma_f32_16x16x32_bf16 v[148:151], v[36:39], v[138:141], v[148:151]
    v_cvt_pk_bf16_f32 v142, v212, v213
    v_cvt_pk_bf16_f32 v143, v214, v215
    v_mfma_f32_16x16x32_bf16 v[152:155], v[42:45], v[138:141], v[152:155]
    ds_read_b128 a[244:247], v225 offset:9024
    ds_read_b128 a[248:251], v225 offset:9088
    v_mfma_f32_16x16x32_bf16 v[156:159], v[24:27], v[138:141], v[156:159]
    buffer_store_dwordx4 v[176:179], v244, s[20:23], s51 offen sc0 sc1
    v_mfma_f32_16x16x16_bf16 v[148:151], v[40:41], v[142:143], v[148:151]
    s_add_u32 s51, s51, s48
    ds_write_b64 v238, v[188:189]
    v_mfma_f32_16x16x16_bf16 v[152:155], v[46:47], v[142:143], v[152:155]
    v_mfma_f32_16x16x32_bf16 v[144:147], v[30:33], v[138:141], v[144:147]
    ds_read_b128 v[252:255], v240 offset:12288
    ds_read_b128 v[164:167], v239 offset:13312
    v_mfma_f32_16x16x16_bf16 v[156:159], v[28:29], v[142:143], v[156:159]
    ds_read_b128 v[168:171], v241 offset:12288
    v_mfma_f32_16x16x32_bf16 v[212:215], a[152:155], a[236:239], 0
    ds_read_b128 a[236:239], v225 offset:9152
    v_mfma_f32_16x16x32_bf16 v[212:215], a[164:167], a[240:243], v[212:215]
    ds_read_b128 a[240:243], v225 offset:9216
    v_mfma_f32_16x16x16_bf16 v[144:147], v[34:35], v[142:143], v[144:147]
    s_waitcnt lgkmcnt(7)
    ds_read_b128 v[248:251], v241 offset:12800
    v_mfma_f32_16x16x32_bf16 v[220:223], a[168:171], a[244:247], v[220:223]
    s_waitcnt lgkmcnt(7)
    v_exp_f32 v148, v148
    v_mfma_f32_16x16x32_bf16 v[220:223], a[180:183], a[248:251], v[220:223]
    v_exp_f32 v149, v149
    v_mfma_f32_16x16x32_bf16 v[216:219], a[172:175], a[244:247], v[216:219]
    v_exp_f32 v150, v150
    v_mfma_f32_16x16x32_bf16 v[216:219], a[184:187], a[248:251], v[216:219]
    buffer_load_dwordx4 v246, s[4:7], s56 offen lds
    v_mfma_f32_16x16x32_bf16 v[212:215], a[176:179], a[244:247], v[212:215]
    ds_read_b128 a[244:247], v224 offset:30976
    v_cvt_pk_bf16_f32 v160, v148, v149
    v_mfma_f32_16x16x32_bf16 v[212:215], a[188:191], a[248:251], v[212:215]
    ds_read_b128 a[248:251], v224 offset:31040
    v_mfma_f32_16x16x32_bf16 v[208:211], a[220:223], a[252:255], 0
    s_waitcnt lgkmcnt(4)
    v_exp_f32 v151, v151
    v_mfma_f32_16x16x32_bf16 v[220:223], a[192:195], a[236:239], v[220:223]
    s_waitcnt lgkmcnt(3)
    v_cvt_pk_bf16_f32 v161, v150, v151
    v_mfma_f32_16x16x32_bf16 v[220:223], a[204:207], a[240:243], v[220:223]
    ds_read_b128 v[148:151], v234
    v_bfe_u32 v234, s71, v233, 4
    v_mfma_f32_16x16x32_bf16 v[216:219], a[196:199], a[236:239], v[216:219]
    v_mad_u32_u24 v234, v234, s40, v231
    v_mfma_f32_16x16x32_bf16 v[216:219], a[208:211], a[240:243], v[216:219]
    v_exp_f32 v152, v152
    v_mfma_f32_16x16x32_bf16 v[212:215], a[200:203], a[236:239], v[212:215]
    ds_read_b128 a[236:239], v224 offset:31104
    v_mul_f32 v220, s37, v220
    v_mfma_f32_16x16x32_bf16 v[212:215], a[212:215], a[240:243], v[212:215]
    v_mul_f32 v221, s37, v221
    v_mul_f32 v222, s37, v222
    v_mfma_f32_16x16x32_bf16 v[200:203], a[220:223], v[252:255], 0
    v_mul_f32 v223, s37, v223
    v_cvt_pk_bf16_f32 v132, v220, v221
    v_mfma_f32_16x16x32_bf16 v[204:207], a[224:227], a[252:255], 0
    v_cvt_pk_bf16_f32 v133, v222, v223
    v_mul_f32 v216, s37, v216
    v_mfma_f32_16x16x32_bf16 v[180:183], a[224:227], v[252:255], 0
    v_mul_f32 v217, s37, v217
    v_mul_f32 v218, s37, v218
    v_mfma_f32_16x16x32_bf16 v[176:179], a[228:231], a[252:255], 0
    s_waitcnt lgkmcnt(1)
    v_mul_f32 v219, s37, v219
    v_cvt_pk_bf16_f32 v134, v216, v217
    v_mfma_f32_16x16x32_bf16 v[148:151], v[54:57], v[138:141], v[148:151]
    v_cvt_pk_bf16_f32 v135, v218, v219
    v_mul_f32 v212, s37, v212
    v_mfma_f32_16x16x32_bf16 v[172:175], a[232:235], a[252:255], 0
    v_mul_f32 v213, s37, v213
    v_mul_f32 v214, s37, v214
    v_mfma_f32_16x16x32_bf16 v[220:223], a[0:3], a[244:247], 0
    v_mul_f32 v215, s37, v215
    v_cvt_pk_bf16_f32 v136, v212, v213
    v_mfma_f32_16x16x32_bf16 v[220:223], a[12:15], a[248:251], v[220:223]
    ds_read_b128 a[240:243], v224 offset:31168
    v_cvt_pk_bf16_f32 v137, v214, v215
    v_mfma_f32_16x16x16_bf16 v[148:151], v[58:59], v[142:143], v[148:151]
    buffer_load_dwordx4 v247, s[4:7], s56 offen offset:1024 lds
    v_mfma_f32_16x16x32_bf16 v[216:219], a[4:7], a[244:247], 0
    s_add_u32 s56, s56, s42
    ds_read_b128 a[252:255], v240 offset:13312
    ds_read_b128 v[252:255], v239 offset:14336
    v_mfma_f32_16x16x32_bf16 v[216:219], a[16:19], a[248:251], v[216:219]
    s_add_u32 m0, s41, 0xd3c0
    v_exp_f32 v153, v153
    v_mfma_f32_16x16x32_bf16 v[212:215], a[8:11], a[244:247], 0
    ds_read_b128 a[244:247], v224 offset:31232
    v_cvt_pk_bf16_f32 v162, v152, v153
    v_mfma_f32_16x16x32_bf16 v[212:215], a[20:23], a[248:251], v[212:215]
    s_waitcnt lgkmcnt(4)
    ds_read_b128 a[248:251], v224 offset:31296
    v_mfma_f32_16x16x32_bf16 v[220:223], a[24:27], a[236:239], v[220:223]
    v_exp_f32 v154, v154
    v_mfma_f32_16x16x32_bf16 v[216:219], a[28:31], a[236:239], v[216:219]
    v_exp_f32 v155, v155
    v_mfma_f32_16x16x32_bf16 v[212:215], a[32:35], a[236:239], v[212:215]
    s_waitcnt lgkmcnt(4)
    ds_read_b128 a[236:239], v224 offset:30976
    v_cvt_pk_bf16_f32 v163, v154, v155
    v_mfma_f32_16x16x32_bf16 v[212:215], a[44:47], a[240:243], v[212:215]
    buffer_load_dwordx4 v246, s[4:7], s56 offen lds
    v_mfma_f32_16x16x32_bf16 v[196:199], a[216:219], v[160:163], 0
    ds_read_b128 v[152:155], v235
    v_bfe_u32 v235, s67, v233, 4
    v_mfma_f32_16x16x32_bf16 v[184:187], v[76:79], v[160:163], 0
    v_mad_u32_u24 v235, v235, s40, v231
    v_mfma_f32_16x16x32_bf16 v[188:191], v[98:101], v[160:163], 0
    v_exp_f32 v156, v156
    v_mfma_f32_16x16x32_bf16 v[192:195], v[120:123], v[160:163], 0
    v_exp_f32 v157, v157
    v_mfma_f32_16x16x32_bf16 v[220:223], a[36:39], a[240:243], v[220:223]
    v_exp_f32 v158, v158
    v_mfma_f32_16x16x32_bf16 v[216:219], a[40:43], a[240:243], v[216:219]
    s_waitcnt lgkmcnt(2)
    ds_read_b128 a[240:243], v224 offset:31040
    v_cvt_pk_bf16_f32 v160, v156, v157
    v_mfma_f32_16x16x32_bf16 v[220:223], a[48:51], a[244:247], v[220:223]
    v_exp_f32 v159, v159
    v_mfma_f32_16x16x32_bf16 v[220:223], a[60:63], a[248:251], v[220:223]
    buffer_load_dwordx4 v247, s[4:7], s56 offen offset:1024 lds
    v_mfma_f32_16x16x32_bf16 v[216:219], a[52:55], a[244:247], v[216:219]
    s_add_u32 s56, s56, s42
    v_cvt_pk_bf16_f32 v161, v158, v159
    s_add_u32 m0, s41, 0
    v_mfma_f32_16x16x32_bf16 v[216:219], a[64:67], a[248:251], v[216:219]
    s_waitcnt lgkmcnt(1)
    ds_read_b128 v[156:159], v229 offset:640
    v_mfma_f32_16x16x32_bf16 v[152:155], v[60:63], v[138:141], v[152:155]
    v_cvt_pk_bf16_f32 v12, v220, v221
    v_cvt_pk_bf16_f32 v13, v222, v223
    v_mfma_f32_16x16x32_bf16 v[212:215], a[56:59], a[244:247], v[212:215]
    ds_read_b128 a[244:247], v224 offset:31104
    v_mfma_f32_16x16x32_bf16 v[212:215], a[68:71], a[248:251], v[212:215]
    ds_read_b128 a[248:251], v224 offset:31168
    v_cvt_pk_bf16_f32 v14, v216, v217
    v_mfma_f32_16x16x16_bf16 v[152:155], v[64:65], v[142:143], v[152:155]
    v_cvt_pk_bf16_f32 v15, v218, v219
    v_mfma_f32_16x16x32_bf16 v[208:211], v[168:171], v[164:167], v[208:211]
    v_exp_f32 v144, v144
    v_mfma_f32_16x16x32_bf16 v[200:203], v[168:171], a[252:255], v[200:203]
    ds_read_b128 v[168:171], v242 offset:12288
    v_cvt_pk_bf16_f32 v16, v212, v213
    v_mfma_f32_16x16x32_bf16 v[204:207], v[248:251], v[164:167], v[204:207]
    v_cvt_pk_bf16_f32 v17, v214, v215
    v_mfma_f32_16x16x32_bf16 v[180:183], v[248:251], a[252:255], v[180:183]
    s_waitcnt lgkmcnt(3)
    ds_read_b128 v[248:251], v242 offset:12800
    ds_read_b128 a[252:255], v239 offset:15360
    v_mfma_f32_16x16x32_bf16 v[156:159], v[42:45], v[132:135], v[156:159]
    v_exp_f32 v145, v145
    v_mfma_f32_16x16x32_bf16 v[220:223], a[236:239], a[72:75], 0
    v_exp_f32 v146, v146
    v_mfma_f32_16x16x32_bf16 v[220:223], a[240:243], a[84:87], v[220:223]
    v_exp_f32 v147, v147
    v_mfma_f32_16x16x32_bf16 v[216:219], a[236:239], a[76:79], 0
    v_cvt_pk_bf16_f32 v162, v144, v145
    v_cvt_pk_bf16_f32 v163, v146, v147
    v_mfma_f32_16x16x32_bf16 v[216:219], a[240:243], a[88:91], v[216:219]
    ds_read_b128 v[144:147], v228 offset:640
    v_mfma_f32_16x16x32_bf16 v[196:199], a[216:219], v[160:163], v[196:199]
    v_exp_f32 v148, v148
    v_mfma_f32_16x16x32_bf16 v[184:187], v[68:71], v[160:163], v[184:187]
    v_exp_f32 v149, v149
    v_mfma_f32_16x16x32_bf16 v[188:191], v[90:93], v[160:163], v[188:191]
    v_exp_f32 v150, v150
    v_mfma_f32_16x16x32_bf16 v[192:195], v[112:115], v[160:163], v[192:195]
    v_exp_f32 v151, v151
    v_mfma_f32_16x16x16_bf16 v[156:159], v[46:47], v[136:137], v[156:159]
    s_waitcnt lgkmcnt(2)
    v_cvt_pk_bf16_f32 v160, v148, v149
    v_cvt_pk_bf16_f32 v161, v150, v151
    v_mfma_f32_16x16x32_bf16 v[176:179], v[168:171], v[164:167], v[176:179]
    ds_read_b128 v[168:171], v241 offset:24576
    ds_read_b128 v[148:151], v228 offset:1280
    v_mfma_f32_16x16x32_bf16 v[172:175], v[248:251], v[164:167], v[172:175]
    v_exp_f32 v152, v152
    v_mfma_f32_16x16x32_bf16 v[212:215], a[236:239], a[80:83], 0
    ds_read_b128 a[236:239], v224 offset:31232
    v_mfma_f32_16x16x32_bf16 v[212:215], a[240:243], a[92:95], v[212:215]
    s_waitcnt lgkmcnt(3)
    ds_read_b128 a[240:243], v224 offset:31296
    v_mfma_f32_16x16x32_bf16 v[144:147], v[18:21], v[132:135], v[144:147]
    ds_read_b128 v[164:167], v240 offset:14336
    v_mfma_f32_16x16x32_bf16 v[220:223], a[244:247], a[96:99], v[220:223]
    ds_read_b128 v[248:251], v241 offset:25088
    v_mfma_f32_16x16x32_bf16 v[220:223], a[248:251], a[108:111], v[220:223]
    v_exp_f32 v153, v153
    v_mfma_f32_16x16x32_bf16 v[216:219], a[244:247], a[100:103], v[216:219]
    v_exp_f32 v154, v154
    v_mfma_f32_16x16x32_bf16 v[216:219], a[248:251], a[112:115], v[216:219]
    v_exp_f32 v155, v155
    v_mfma_f32_16x16x16_bf16 v[144:147], v[22:23], v[136:137], v[144:147]
    s_waitcnt lgkmcnt(4)
    v_cvt_pk_bf16_f32 v162, v152, v153
    v_cvt_pk_bf16_f32 v163, v154, v155
    v_mfma_f32_16x16x32_bf16 v[148:151], v[0:3], v[132:135], v[148:151]
    ds_read_b128 v[152:155], v229 offset:1280
    v_mfma_f32_16x16x32_bf16 v[196:199], a[216:219], v[160:163], v[196:199]
    v_exp_f32 v156, v156
    v_mfma_f32_16x16x32_bf16 v[184:187], v[84:87], v[160:163], v[184:187]
    v_exp_f32 v157, v157
    v_mfma_f32_16x16x32_bf16 v[188:191], v[106:109], v[160:163], v[188:191]
    v_exp_f32 v158, v158
    v_mfma_f32_16x16x32_bf16 v[192:195], v[128:131], v[160:163], v[192:195]
    v_exp_f32 v159, v159
    v_mfma_f32_16x16x16_bf16 v[148:151], v[4:5], v[136:137], v[148:151]
    v_rcp_f32 v197, v196
    v_mfma_f32_16x16x32_bf16 v[212:215], a[244:247], a[104:107], v[212:215]
    ds_read_b128 a[244:247], v224 offset:34048
    v_mul_f32 v184, v184, v197
    v_mfma_f32_16x16x32_bf16 v[212:215], a[248:251], a[116:119], v[212:215]
    s_waitcnt lgkmcnt(2)
    ds_read_b128 a[248:251], v224 offset:34112
    v_mul_f32 v185, v185, v197
    v_mfma_f32_16x16x32_bf16 v[220:223], a[236:239], a[120:123], v[220:223]
    v_cvt_pk_bf16_f32 v184, v184, v185
    v_mul_f32 v186, v186, v197
    v_mfma_f32_16x16x32_bf16 v[220:223], a[240:243], a[132:135], v[220:223]
    s_waitcnt lgkmcnt(2)
    v_mul_f32 v187, v187, v197
    v_cvt_pk_bf16_f32 v185, v186, v187
    v_mfma_f32_16x16x32_bf16 v[152:155], v[24:27], v[132:135], v[152:155]
    v_mul_f32 v188, v188, v197
    v_mul_f32 v189, v189, v197
    v_mfma_f32_16x16x32_bf16 v[216:219], a[236:239], a[124:127], v[216:219]
    v_cvt_pk_bf16_f32 v186, v188, v189
    v_mul_f32 v190, v190, v197
    v_mfma_f32_16x16x32_bf16 v[216:219], a[240:243], a[136:139], v[216:219]
    v_cvt_pk_bf16_f32 v74, v220, v221
    v_cvt_pk_bf16_f32 v75, v222, v223
    v_mfma_f32_16x16x16_bf16 v[152:155], v[28:29], v[136:137], v[152:155]
    v_mul_f32 v191, v191, v197
    v_cvt_pk_bf16_f32 v187, v190, v191
    v_mfma_f32_16x16x32_bf16 v[212:215], a[236:239], a[128:131], v[212:215]
    ds_read_b128 a[236:239], v224 offset:34176
    v_mul_f32 v192, v192, v197
    v_mfma_f32_16x16x32_bf16 v[212:215], a[240:243], a[140:143], v[212:215]
    v_cvt_pk_bf16_f32 v96, v216, v217
    v_cvt_pk_bf16_f32 v97, v218, v219
    v_mfma_f32_16x16x32_bf16 v[208:211], v[168:171], v[252:255], v[208:211]
    ds_read_b128 a[240:243], v224 offset:34240
    v_mul_f32 v193, v193, v197
    v_mfma_f32_16x16x32_bf16 v[200:203], v[168:171], v[164:167], v[200:203]
    v_cvt_pk_bf16_f32 v188, v192, v193
    v_mul_f32 v194, v194, v197
    v_mfma_f32_16x16x32_bf16 v[204:207], v[248:251], v[252:255], v[204:207]
    v_cvt_pk_bf16_f32 v118, v212, v213
    v_cvt_pk_bf16_f32 v119, v214, v215
    v_mfma_f32_16x16x32_bf16 v[180:183], v[248:251], v[164:167], v[180:183]
    s_waitcnt lgkmcnt(2)
    v_mul_f32 v195, v195, v197
    v_cvt_pk_bf16_f32 v189, v194, v195
    v_mfma_f32_16x16x32_bf16 v[220:223], a[0:3], a[244:247], 0
    ds_read_b128 v[168:171], v242 offset:24576
    v_max3_f32 v236, v236, v196, v197
    v_mfma_f32_16x16x32_bf16 v[220:223], a[12:15], a[248:251], v[220:223]
    ds_write_b128 v237, v[184:187] offset:6144
    v_mfma_f32_16x16x32_bf16 v[216:219], a[4:7], a[244:247], 0
    ds_write_b64 v238, v[188:189] offset:6144
    v_mfma_f32_16x16x32_bf16 v[216:219], a[16:19], a[248:251], v[216:219]
    v_cvt_pk_bf16_f32 v160, v156, v157
    v_cvt_pk_bf16_f32 v161, v158, v159
    v_mfma_f32_16x16x32_bf16 v[212:215], a[8:11], a[244:247], 0
    v_exp_f32 v144, v144
    v_mfma_f32_16x16x32_bf16 v[212:215], a[20:23], a[248:251], v[212:215]
    s_waitcnt lgkmcnt(3)
    v_exp_f32 v145, v145
    v_mfma_f32_16x16x32_bf16 v[220:223], a[24:27], a[236:239], v[220:223]
    ds_read_b128 a[244:247], v224 offset:34304
    ds_read_b128 a[248:251], v224 offset:34368
    v_mfma_f32_16x16x32_bf16 v[220:223], a[36:39], a[240:243], v[220:223]
    s_waitcnt lgkmcnt(4)
    ds_read_b128 v[248:251], v242 offset:25088
    v_cvt_pk_bf16_f32 v162, v144, v145
    v_mfma_f32_16x16x32_bf16 v[176:179], v[168:171], v[252:255], v[176:179]
    ds_read_b128 v[168:171], v241 offset:36864
    v_mfma_f32_16x16x32_bf16 v[216:219], a[28:31], a[236:239], v[216:219]
    ds_read_b128 v[164:167], v239 offset:16384
    v_mfma_f32_16x16x32_bf16 v[216:219], a[40:43], a[240:243], v[216:219]
    ds_read_b128 v[156:159], v229 offset:1920
    v_mfma_f32_16x16x32_bf16 v[212:215], a[32:35], a[236:239], v[212:215]
    v_exp_f32 v146, v146
    v_mfma_f32_16x16x32_bf16 v[212:215], a[44:47], a[240:243], v[212:215]
    s_waitcnt lgkmcnt(5)
    ds_read_b128 a[236:239], v224 offset:34048
    v_exp_f32 v147, v147
    ds_read_b128 a[240:243], v224 offset:34112
    v_cvt_pk_bf16_f32 v163, v146, v147
    ds_read_b128 v[144:147], v228 offset:1920
    v_mfma_f32_16x16x32_bf16 v[220:223], a[48:51], a[244:247], v[220:223]
    s_waitcnt lgkmcnt(7)
    v_exp_f32 v148, v148
    v_mfma_f32_16x16x32_bf16 v[220:223], a[60:63], a[248:251], v[220:223]
    v_exp_f32 v149, v149
    v_mfma_f32_16x16x32_bf16 v[196:199], a[216:219], v[160:163], 0
    v_exp_f32 v150, v150
    v_mfma_f32_16x16x32_bf16 v[184:187], v[78:81], v[160:163], 0
    v_exp_f32 v151, v151
    v_mfma_f32_16x16x32_bf16 v[188:191], v[100:103], v[160:163], 0
    v_exp_f32 v152, v152
    v_mfma_f32_16x16x32_bf16 v[192:195], v[122:125], v[160:163], 0
    s_waitcnt lgkmcnt(3)
    v_cvt_pk_bf16_f32 v36, v220, v221
    v_cvt_pk_bf16_f32 v37, v222, v223
    v_mfma_f32_16x16x32_bf16 v[156:159], v[30:33], v[132:135], v[156:159]
    v_cvt_pk_bf16_f32 v160, v148, v149
    v_cvt_pk_bf16_f32 v161, v150, v151
    v_mfma_f32_16x16x32_bf16 v[172:175], v[248:251], v[252:255], v[172:175]
    ds_read_b128 v[252:255], v240 offset:15360
    ds_read_b128 v[248:251], v241 offset:37376
    v_mfma_f32_16x16x32_bf16 v[216:219], a[52:55], a[244:247], v[216:219]
    ds_read_b128 v[148:151], v228 offset:2560
    v_mfma_f32_16x16x32_bf16 v[216:219], a[64:67], a[248:251], v[216:219]
    v_exp_f32 v153, v153
    v_mfma_f32_16x16x16_bf16 v[156:159], v[34:35], v[136:137], v[156:159]
    s_waitcnt lgkmcnt(3)
    v_exp_f32 v154, v154
    v_mfma_f32_16x16x32_bf16 v[144:147], v[6:9], v[132:135], v[144:147]
    v_exp_f32 v155, v155
    v_mfma_f32_16x16x32_bf16 v[212:215], a[56:59], a[244:247], v[212:215]
    ds_read_b128 a[244:247], v224 offset:34176
    v_cvt_pk_bf16_f32 v162, v152, v153
    v_mfma_f32_16x16x32_bf16 v[212:215], a[68:71], a[248:251], v[212:215]
    v_cvt_pk_bf16_f32 v38, v216, v217
    v_cvt_pk_bf16_f32 v39, v218, v219
    v_mfma_f32_16x16x16_bf16 v[144:147], v[10:11], v[136:137], v[144:147]
    ds_read_b128 a[248:251], v224 offset:34240
    v_cvt_pk_bf16_f32 v163, v154, v155
    v_mfma_f32_16x16x32_bf16 v[208:211], v[168:171], a[252:255], v[208:211]
    ds_read_b128 v[152:155], v229 offset:2560
    v_mfma_f32_16x16x32_bf16 v[196:199], a[216:219], v[160:163], v[196:199]
    v_cvt_pk_bf16_f32 v40, v212, v213
    v_cvt_pk_bf16_f32 v41, v214, v215
    v_mfma_f32_16x16x32_bf16 v[184:187], v[66:69], v[160:163], v[184:187]
    v_exp_f32 v156, v156
    v_mfma_f32_16x16x32_bf16 v[188:191], v[88:91], v[160:163], v[188:191]
    v_exp_f32 v157, v157
    v_mfma_f32_16x16x32_bf16 v[192:195], v[110:113], v[160:163], v[192:195]
    s_waitcnt lgkmcnt(3)
    v_exp_f32 v158, v158
    v_mfma_f32_16x16x32_bf16 v[148:151], v[12:15], v[132:135], v[148:151]
    v_exp_f32 v159, v159
    v_mfma_f32_16x16x32_bf16 v[200:203], v[168:171], v[252:255], v[200:203]
    ds_read_b128 v[168:171], v242 offset:36864
    v_cvt_pk_bf16_f32 v160, v156, v157
    v_mfma_f32_16x16x32_bf16 v[204:207], v[248:251], a[252:255], v[204:207]
    v_cvt_pk_bf16_f32 v161, v158, v159
    v_mfma_f32_16x16x16_bf16 v[148:151], v[16:17], v[136:137], v[148:151]
    s_waitcnt lgkmcnt(1)
    ds_read_b128 v[156:159], v230 offset:2560
    v_mfma_f32_16x16x32_bf16 v[152:155], v[36:39], v[132:135], v[152:155]
    v_exp_f32 v144, v144
    v_mfma_f32_16x16x32_bf16 v[180:183], v[248:251], v[252:255], v[180:183]
    ds_read_b128 v[248:251], v242 offset:37376
    ds_read_b128 v[252:255], v239 offset:17408
    v_mfma_f32_16x16x32_bf16 v[220:223], a[236:239], a[72:75], 0
    v_exp_f32 v145, v145
    v_mfma_f32_16x16x32_bf16 v[220:223], a[240:243], a[84:87], v[220:223]
    v_exp_f32 v146, v146
    v_mfma_f32_16x16x16_bf16 v[152:155], v[40:41], v[136:137], v[152:155]
    v_exp_f32 v147, v147
    v_mfma_f32_16x16x32_bf16 v[216:219], a[236:239], a[76:79], 0
    v_cvt_pk_bf16_f32 v162, v144, v145
    v_cvt_pk_bf16_f32 v163, v146, v147
    v_mfma_f32_16x16x32_bf16 v[216:219], a[240:243], a[88:91], v[216:219]
    ds_read_b128 v[144:147], v230 offset:640
    v_mfma_f32_16x16x32_bf16 v[196:199], a[216:219], v[160:163], v[196:199]
    v_exp_f32 v148, v148
    v_mfma_f32_16x16x32_bf16 v[184:187], v[70:73], v[160:163], v[184:187]
    v_exp_f32 v149, v149
    v_mfma_f32_16x16x32_bf16 v[188:191], v[92:95], v[160:163], v[188:191]
    v_exp_f32 v150, v150
    v_mfma_f32_16x16x32_bf16 v[192:195], v[114:117], v[160:163], v[192:195]
    s_waitcnt lgkmcnt(3)
    v_exp_f32 v151, v151
    v_mfma_f32_16x16x32_bf16 v[176:179], v[168:171], a[252:255], v[176:179]
    s_waitcnt lgkmcnt(2)
    ds_read_b128 v[168:171], v241 offset:49152
    v_cvt_pk_bf16_f32 v160, v148, v149
    v_mfma_f32_16x16x32_bf16 v[172:175], v[248:251], a[252:255], v[172:175]
    ds_read_b128 a[252:255], v240 offset:16384
    ds_read_b128 v[248:251], v241 offset:49664
    v_mfma_f32_16x16x32_bf16 v[212:215], a[236:239], a[80:83], 0
    ds_read_b128 a[236:239], v224 offset:34304
    v_cvt_pk_bf16_f32 v161, v150, v151
    v_mfma_f32_16x16x32_bf16 v[212:215], a[240:243], a[92:95], v[212:215]
    ds_read_b128 a[240:243], v224 offset:34368
    v_mfma_f32_16x16x32_bf16 v[220:223], a[244:247], a[96:99], v[220:223]
    ds_read_b128 v[148:151], v230 offset:1280
    v_mfma_f32_16x16x32_bf16 v[220:223], a[248:251], a[108:111], v[220:223]
    v_exp_f32 v152, v152
    v_mfma_f32_16x16x32_bf16 v[216:219], a[244:247], a[100:103], v[216:219]
    v_exp_f32 v153, v153
    v_mfma_f32_16x16x32_bf16 v[216:219], a[248:251], a[112:115], v[216:219]
    v_exp_f32 v154, v154
    v_mfma_f32_16x16x32_bf16 v[212:215], a[244:247], a[104:107], v[212:215]
    ds_read_b128 a[244:247], v225 offset:11968
    v_cvt_pk_bf16_f32 v162, v152, v153
    v_mfma_f32_16x16x32_bf16 v[212:215], a[248:251], a[116:119], v[212:215]
    s_waitcnt lgkmcnt(6)
    ds_read_b128 a[248:251], v225 offset:12032
    v_mfma_f32_16x16x32_bf16 v[208:211], v[168:171], v[164:167], v[208:211]
    s_waitcnt lgkmcnt(6)
    v_exp_f32 v155, v155
    v_mfma_f32_16x16x32_bf16 v[200:203], v[168:171], a[252:255], v[200:203]
    s_waitcnt lgkmcnt(4)
    ds_read_b128 v[168:171], v242 offset:49152
    v_cvt_pk_bf16_f32 v163, v154, v155
    v_mfma_f32_16x16x32_bf16 v[220:223], a[236:239], a[120:123], v[220:223]
    s_waitcnt lgkmcnt(4)
    ds_read_b128 v[152:155], v230 offset:1920
    v_mfma_f32_16x16x32_bf16 v[220:223], a[240:243], a[132:135], v[220:223]
    v_mfma_f32_16x16x32_bf16 v[196:199], a[216:219], v[160:163], v[196:199]
    v_mfma_f32_16x16x32_bf16 v[216:219], a[236:239], a[124:127], v[216:219]
    v_mfma_f32_16x16x32_bf16 v[216:219], a[240:243], a[136:139], v[216:219]
    v_mfma_f32_16x16x32_bf16 v[212:215], a[236:239], a[128:131], v[212:215]
    ds_read_b128 a[236:239], v225 offset:12096
    v_mfma_f32_16x16x32_bf16 v[212:215], a[240:243], a[140:143], v[212:215]
    ds_read_b128 a[240:243], v225 offset:12160
    v_mfma_f32_16x16x32_bf16 v[204:207], v[248:251], v[164:167], v[204:207]
    v_cvt_pk_bf16_f32 v76, v220, v221
    v_cvt_pk_bf16_f32 v77, v222, v223
    v_mfma_f32_16x16x32_bf16 v[180:183], v[248:251], a[252:255], v[180:183]
    v_cvt_pk_bf16_f32 v98, v216, v217
    v_cvt_pk_bf16_f32 v99, v218, v219
    v_mfma_f32_16x16x32_bf16 v[184:187], v[74:77], v[160:163], v[184:187]
    v_cvt_pk_bf16_f32 v120, v212, v213
    v_cvt_pk_bf16_f32 v121, v214, v215
    v_mfma_f32_16x16x32_bf16 v[188:191], v[96:99], v[160:163], v[188:191]
    ds_read_b128 v[248:251], v242 offset:49664
    v_mfma_f32_16x16x32_bf16 v[192:195], v[118:121], v[160:163], v[192:195]
    s_waitcnt lgkmcnt(3)
    v_rcp_f32 v197, v196
    v_mfma_f32_16x16x32_bf16 v[176:179], v[168:171], v[164:167], v[176:179]
    ds_read_b128 v[168:171], v241 offset:61440
    v_mul_f32 v184, v184, v197
    v_mfma_f32_16x16x32_bf16 v[220:223], a[144:147], a[244:247], 0
    v_mul_f32 v185, v185, v197
    v_cvt_pk_bf16_f32 v184, v184, v185
    v_mfma_f32_16x16x32_bf16 v[220:223], a[156:159], a[248:251], v[220:223]
    v_mul_f32 v186, v186, v197
    v_mul_f32 v187, v187, v197
    v_mfma_f32_16x16x32_bf16 v[216:219], a[148:151], a[244:247], 0
    v_cvt_pk_bf16_f32 v185, v186, v187
    v_mul_f32 v188, v188, v197
    v_mfma_f32_16x16x32_bf16 v[216:219], a[160:163], a[248:251], v[216:219]
    v_mul_f32 v189, v189, v197
    v_cvt_pk_bf16_f32 v186, v188, v189
    v_mfma_f32_16x16x32_bf16 v[212:215], a[152:155], a[244:247], 0
    ds_read_b128 a[244:247], v225 offset:12224
    v_mul_f32 v190, v190, v197
    v_mfma_f32_16x16x32_bf16 v[212:215], a[164:167], a[248:251], v[212:215]
    s_waitcnt lgkmcnt(2)
    ds_read_b128 a[248:251], v225 offset:12288
    v_mul_f32 v191, v191, v197
    v_mfma_f32_16x16x32_bf16 v[172:175], v[248:251], v[164:167], v[172:175]
    ds_read_b128 v[164:167], v240 offset:17408
    ds_read_b128 v[248:251], v241 offset:61952
    v_mfma_f32_16x16x32_bf16 v[220:223], a[168:171], a[236:239], v[220:223]
    v_cvt_pk_bf16_f32 v187, v190, v191
    v_mul_f32 v192, v192, v197
    v_mfma_f32_16x16x32_bf16 v[220:223], a[180:183], a[240:243], v[220:223]
    v_mul_f32 v193, v193, v197
    v_cvt_pk_bf16_f32 v188, v192, v193
    v_mfma_f32_16x16x32_bf16 v[216:219], a[172:175], a[236:239], v[216:219]
    v_mul_f32 v194, v194, v197
    v_mul_f32 v195, v195, v197
    v_mfma_f32_16x16x32_bf16 v[216:219], a[184:187], a[240:243], v[216:219]
    v_cvt_pk_bf16_f32 v189, v194, v195
    v_max3_f32 v236, v236, v196, v197
    v_mfma_f32_16x16x32_bf16 v[212:215], a[176:179], a[236:239], v[212:215]
    v_mfma_f32_16x16x32_bf16 v[212:215], a[188:191], a[240:243], v[212:215]
    s_waitcnt lgkmcnt(3)
    v_mfma_f32_16x16x32_bf16 v[220:223], a[192:195], a[244:247], v[220:223]
    s_waitcnt vmcnt(0) lgkmcnt(1)
    v_mfma_f32_16x16x32_bf16 v[220:223], a[204:207], a[248:251], v[220:223]
    s_barrier
    ds_read_b128 a[236:239], v227 offset:37120
    v_mfma_f32_16x16x32_bf16 v[216:219], a[196:199], a[244:247], v[216:219]
    ds_read_b128 a[240:243], v227 offset:37184
    ds_read_b128 a[252:255], v239
    v_mfma_f32_16x16x32_bf16 v[216:219], a[208:211], a[248:251], v[216:219]
    buffer_load_dwordx4 v246, s[4:7], s56 offen lds
    v_mfma_f32_16x16x32_bf16 v[212:215], a[200:203], a[244:247], v[212:215]
    v_mul_f32 v220, s37, v220
    v_mul_f32 v221, s37, v221
    v_mfma_f32_16x16x32_bf16 v[212:215], a[212:215], a[248:251], v[212:215]
    v_mul_f32 v222, s37, v222
    v_mul_f32 v223, s37, v223
    v_mfma_f32_16x16x32_bf16 v[208:211], v[168:171], v[252:255], v[208:211]
    v_cvt_pk_bf16_f32 v138, v220, v221
    v_cvt_pk_bf16_f32 v139, v222, v223
    v_mfma_f32_16x16x32_bf16 v[200:203], v[168:171], v[164:167], v[200:203]
    s_waitcnt lgkmcnt(3)
    v_mul_f32 v216, s37, v216
    v_mul_f32 v217, s37, v217
    v_mfma_f32_16x16x32_bf16 v[204:207], v[248:251], v[252:255], v[204:207]
    v_mul_f32 v218, s37, v218
    v_mul_f32 v219, s37, v219
    v_mfma_f32_16x16x32_bf16 v[180:183], v[248:251], v[164:167], v[180:183]
    s_waitcnt lgkmcnt(2)
    v_cvt_pk_bf16_f32 v140, v216, v217
    v_cvt_pk_bf16_f32 v141, v218, v219
    v_mfma_f32_16x16x32_bf16 v[220:223], a[0:3], a[236:239], 0
    s_waitcnt lgkmcnt(1)
    v_mul_f32 v212, s37, v212
    v_mul_f32 v213, s37, v213
    v_mfma_f32_16x16x32_bf16 v[220:223], a[12:15], a[240:243], v[220:223]
    v_mul_f32 v214, s37, v214
    v_mul_f32 v215, s37, v215
    v_mfma_f32_16x16x32_bf16 v[156:159], v[36:39], v[138:141], v[156:159]
    v_cvt_pk_bf16_f32 v142, v212, v213
    v_cvt_pk_bf16_f32 v143, v214, v215
    v_mfma_f32_16x16x32_bf16 v[144:147], v[42:45], v[138:141], v[144:147]
    ds_read_b128 a[244:247], v227 offset:37248
    ds_read_b128 a[248:251], v227 offset:37312
    v_mfma_f32_16x16x32_bf16 v[148:151], v[24:27], v[138:141], v[148:151]
    ds_read_b128 v[168:171], v242 offset:61440
    v_cvt_pk_bf16_f32 v208, v208, v209
    v_mfma_f32_16x16x16_bf16 v[156:159], v[40:41], v[142:143], v[156:159]
L_pg5:
    s_cbranch_execz L_back
    ds_read_b128 v[248:251], v242 offset:61952
    v_cvt_pk_bf16_f32 v209, v210, v211
    v_mfma_f32_16x16x16_bf16 v[144:147], v[46:47], v[142:143], v[144:147]
    v_cvt_pk_bf16_f32 v210, v204, v205
    v_cvt_pk_bf16_f32 v211, v206, v207
    v_mfma_f32_16x16x16_bf16 v[148:151], v[28:29], v[142:143], v[148:151]
    buffer_store_dwordx4 v[208:211], v243, s[20:23], s51 offen sc0 sc1
    v_mfma_f32_16x16x32_bf16 v[152:155], v[30:33], v[138:141], v[152:155]
    ds_read_b128 v[164:167], v239 offset:1024
    v_cvt_pk_bf16_f32 v200, v200, v201
    v_mfma_f32_16x16x32_bf16 v[216:219], a[4:7], a[236:239], 0
    v_cvt_pk_bf16_f32 v201, v202, v203
    v_cvt_pk_bf16_f32 v202, v180, v181
    v_mfma_f32_16x16x32_bf16 v[216:219], a[16:19], a[240:243], v[216:219]
    v_cvt_pk_bf16_f32 v203, v182, v183
    v_mfma_f32_16x16x16_bf16 v[152:155], v[34:35], v[142:143], v[152:155]
    s_waitcnt lgkmcnt(2)
    ds_write_b128 v237, v[184:187] offset:12288
    v_mfma_f32_16x16x32_bf16 v[176:179], v[168:171], v[252:255], v[176:179]
    s_waitcnt lgkmcnt(2)
    ds_write_b64 v238, v[188:189] offset:12288
    v_mfma_f32_16x16x32_bf16 v[172:175], v[248:251], v[252:255], v[172:175]
    v_exp_f32 v156, v156
    v_mfma_f32_16x16x32_bf16 v[212:215], a[8:11], a[236:239], 0
    v_exp_f32 v157, v157
    v_mfma_f32_16x16x32_bf16 v[212:215], a[20:23], a[240:243], v[212:215]
    v_exp_f32 v158, v158
    v_mfma_f32_16x16x32_bf16 v[220:223], a[24:27], a[244:247], v[220:223]
    ds_read_b128 a[236:239], v227 offset:37376
    ds_read_b128 a[240:243], v227 offset:37440
    v_mfma_f32_16x16x32_bf16 v[220:223], a[36:39], a[248:251], v[220:223]
    ds_read_b128 v[252:255], v240
    v_cvt_pk_bf16_f32 v176, v176, v177
    v_mfma_f32_16x16x32_bf16 v[216:219], a[28:31], a[244:247], v[216:219]
    buffer_store_dwordx4 v[200:203], v245, s[20:23], s51 offen sc0 sc1
    v_mfma_f32_16x16x32_bf16 v[216:219], a[40:43], a[248:251], v[216:219]
    ds_read_b128 v[168:171], v241 offset:12288
    v_cvt_pk_bf16_f32 v177, v178, v179
    v_mfma_f32_16x16x32_bf16 v[212:215], a[32:35], a[244:247], v[212:215]
    ds_read_b128 a[244:247], v227 offset:37120
    v_cvt_pk_bf16_f32 v178, v172, v173
    v_mfma_f32_16x16x32_bf16 v[212:215], a[44:47], a[248:251], v[212:215]
    ds_read_b128 a[248:251], v227 offset:37184
    v_cvt_pk_bf16_f32 v179, v174, v175
    v_mfma_f32_16x16x32_bf16 v[208:211], a[220:223], a[252:255], 0
    ds_read_b128 v[248:251], v241 offset:12800
    v_cvt_pk_bf16_f32 v160, v156, v157
    v_mfma_f32_16x16x32_bf16 v[204:207], a[224:227], a[252:255], 0
    s_waitcnt lgkmcnt(6)
    v_exp_f32 v159, v159
    v_mfma_f32_16x16x32_bf16 v[220:223], a[48:51], a[236:239], v[220:223]
    s_waitcnt lgkmcnt(5)
    v_cvt_pk_bf16_f32 v161, v158, v159
    v_mfma_f32_16x16x32_bf16 v[220:223], a[60:63], a[240:243], v[220:223]
    ds_read_b128 v[156:159], v234
    v_bfe_u32 v234, s72, v233, 4
    v_mfma_f32_16x16x32_bf16 v[216:219], a[52:55], a[236:239], v[216:219]
    v_mad_u32_u24 v234, v234, s40, v231
    v_mfma_f32_16x16x32_bf16 v[216:219], a[64:67], a[240:243], v[216:219]
    v_exp_f32 v144, v144
    v_mfma_f32_16x16x32_bf16 v[212:215], a[56:59], a[236:239], v[212:215]
    ds_read_b128 a[236:239], v227 offset:37248
    v_cvt_pk_bf16_f32 v48, v220, v221
    v_mfma_f32_16x16x32_bf16 v[212:215], a[68:71], a[240:243], v[212:215]
    s_waitcnt lgkmcnt(5)
    ds_read_b128 a[240:243], v227 offset:37312
    v_cvt_pk_bf16_f32 v49, v222, v223
    v_mfma_f32_16x16x32_bf16 v[200:203], a[220:223], v[252:255], 0
    v_cvt_pk_bf16_f32 v50, v216, v217
    v_cvt_pk_bf16_f32 v51, v218, v219
    v_mfma_f32_16x16x32_bf16 v[180:183], a[224:227], v[252:255], 0
    buffer_store_dwordx4 v[176:179], v244, s[20:23], s51 offen sc0 sc1
    v_mfma_f32_16x16x32_bf16 v[172:175], a[232:235], a[252:255], 0
    s_add_u32 s51, s51, s48
    v_cvt_pk_bf16_f32 v52, v212, v213
    v_cvt_pk_bf16_f32 v53, v214, v215
    v_mfma_f32_16x16x32_bf16 v[176:179], a[228:231], a[252:255], 0
    s_waitcnt lgkmcnt(2)
    ds_read_b128 a[252:255], v240 offset:1024
    ds_read_b128 v[252:255], v239 offset:2048
    v_mfma_f32_16x16x32_bf16 v[156:159], v[54:57], v[138:141], v[156:159]
    v_exp_f32 v145, v145
    v_mfma_f32_16x16x32_bf16 v[220:223], a[244:247], a[72:75], 0
    v_exp_f32 v146, v146
    v_mfma_f32_16x16x32_bf16 v[220:223], a[248:251], a[84:87], v[220:223]
    v_exp_f32 v147, v147
    v_mfma_f32_16x16x32_bf16 v[216:219], a[244:247], a[76:79], 0
    v_cvt_pk_bf16_f32 v162, v144, v145
    v_cvt_pk_bf16_f32 v163, v146, v147
    v_mfma_f32_16x16x32_bf16 v[216:219], a[248:251], a[88:91], v[216:219]
    ds_read_b128 v[144:147], v235
    v_bfe_u32 v235, s69, v233, 4
    v_mfma_f32_16x16x32_bf16 v[196:199], a[216:219], v[160:163], 0
    v_mad_u32_u24 v235, v235, s40, v231
    v_mfma_f32_16x16x32_bf16 v[184:187], v[76:79], v[160:163], 0
    v_exp_f32 v148, v148
    v_mfma_f32_16x16x32_bf16 v[188:191], v[98:101], v[160:163], 0
    v_exp_f32 v149, v149
    v_mfma_f32_16x16x32_bf16 v[192:195], v[120:123], v[160:163], 0
    v_exp_f32 v150, v150
    v_mfma_f32_16x16x16_bf16 v[156:159], v[58:59], v[142:143], v[156:159]
    buffer_load_dwordx4 v247, s[4:7], s56 offen offset:1024 lds
    v_mfma_f32_16x16x32_bf16 v[212:215], a[244:247], a[80:83], 0
    s_add_u32 s56, s56, s42
    ds_read_b128 a[244:247], v227 offset:37376
    v_cvt_pk_bf16_f32 v160, v148, v149
    v_mfma_f32_16x16x32_bf16 v[212:215], a[248:251], a[92:95], v[212:215]
    s_add_u32 m0, s41, 0x1e40
    ds_read_b128 a[248:251], v227 offset:37440
    s_waitcnt lgkmcnt(3)
    v_mfma_f32_16x16x32_bf16 v[220:223], a[236:239], a[96:99], v[220:223]
    v_exp_f32 v151, v151
    v_mfma_f32_16x16x32_bf16 v[220:223], a[240:243], a[108:111], v[220:223]
    s_waitcnt lgkmcnt(2)
    v_cvt_pk_bf16_f32 v161, v150, v151
    v_mfma_f32_16x16x32_bf16 v[144:147], v[60:63], v[138:141], v[144:147]
    ds_read_b128 v[148:151], v234
    v_bfe_u32 v234, s70, v233, 4
    v_mfma_f32_16x16x32_bf16 v[216:219], a[236:239], a[100:103], v[216:219]
    v_mad_u32_u24 v234, v234, s40, v231
    v_mfma_f32_16x16x32_bf16 v[216:219], a[240:243], a[112:115], v[216:219]
    v_exp_f32 v152, v152
    v_mfma_f32_16x16x16_bf16 v[144:147], v[64:65], v[142:143], v[144:147]
    buffer_load_dwordx4 v246, s[4:7], s56 offen lds
    v_mfma_f32_16x16x32_bf16 v[212:215], a[236:239], a[104:107], v[212:215]
    ds_read_b128 a[236:239], v225 offset:24384
    v_mfma_f32_16x16x32_bf16 v[212:215], a[240:243], a[116:119], v[212:215]
    s_waitcnt lgkmcnt(3)
    ds_read_b128 a[240:243], v225 offset:24448
    v_mfma_f32_16x16x32_bf16 v[220:223], a[244:247], a[120:123], v[220:223]
    s_waitcnt lgkmcnt(3)
    v_exp_f32 v153, v153
    v_mfma_f32_16x16x32_bf16 v[220:223], a[248:251], a[132:135], v[220:223]
    v_exp_f32 v154, v154
    v_mfma_f32_16x16x32_bf16 v[216:219], a[244:247], a[124:127], v[216:219]
    v_exp_f32 v155, v155
    v_mfma_f32_16x16x32_bf16 v[216:219], a[248:251], a[136:139], v[216:219]
    s_waitcnt lgkmcnt(2)
    v_cvt_pk_bf16_f32 v162, v152, v153
    v_cvt_pk_bf16_f32 v163, v154, v155
    v_mfma_f32_16x16x32_bf16 v[148:151], v[48:51], v[138:141], v[148:151]
    ds_read_b128 v[152:155], v228 offset:640
    v_cvt_pk_bf16_f32 v82, v220, v221
    v_mfma_f32_16x16x32_bf16 v[196:199], a[216:219], v[160:163], v[196:199]
    v_cvt_pk_bf16_f32 v83, v222, v223
    v_mfma_f32_16x16x32_bf16 v[184:187], v[68:71], v[160:163], v[184:187]
    v_cvt_pk_bf16_f32 v104, v216, v217
    v_cvt_pk_bf16_f32 v105, v218, v219
    v_mfma_f32_16x16x32_bf16 v[188:191], v[90:93], v[160:163], v[188:191]
    buffer_load_dwordx4 v247, s[4:7], s56 offen offset:1024 lds
    v_mfma_f32_16x16x32_bf16 v[192:195], v[112:115], v[160:163], v[192:195]
    s_add_u32 s56, s56, s42
    v_exp_f32 v156, v156
    v_mfma_f32_16x16x16_bf16 v[148:151], v[52:53], v[142:143], v[148:151]
    s_add_u32 m0, s41, 0x3c80
    v_exp_f32 v157, v157
    v_mfma_f32_16x16x32_bf16 v[212:215], a[244:247], a[128:131], v[212:215]
    ds_read_b128 a[244:247], v225 offset:24512
    v_cvt_pk_bf16_f32 v160, v156, v157
    v_mfma_f32_16x16x32_bf16 v[212:215], a[248:251], a[140:143], v[212:215]
    s_waitcnt lgkmcnt(2)
    ds_read_b128 a[248:251], v225 offset:24576
    v_mfma_f32_16x16x32_bf16 v[220:223], a[144:147], a[236:239], 0
    v_exp_f32 v158, v158
    v_mfma_f32_16x16x32_bf16 v[220:223], a[156:159], a[240:243], v[220:223]
    v_exp_f32 v159, v159
    v_mfma_f32_16x16x32_bf16 v[216:219], a[148:151], a[236:239], 0
    v_cvt_pk_bf16_f32 v161, v158, v159
    v_mfma_f32_16x16x32_bf16 v[216:219], a[160:163], a[240:243], v[216:219]
    v_cvt_pk_bf16_f32 v126, v212, v213
    v_cvt_pk_bf16_f32 v127, v214, v215
    v_mfma_f32_16x16x32_bf16 v[212:215], a[152:155], a[236:239], 0
    ds_read_b128 a[236:239], v225 offset:24640
    ds_read_b128 v[156:159], v229 offset:640
    v_mfma_f32_16x16x32_bf16 v[212:215], a[164:167], a[240:243], v[212:215]
    v_exp_f32 v144, v144
    v_mfma_f32_16x16x32_bf16 v[208:211], v[168:171], v[164:167], v[208:211]
    s_waitcnt lgkmcnt(3)
    ds_read_b128 a[240:243], v225 offset:24704
    v_mfma_f32_16x16x32_bf16 v[220:223], a[168:171], a[244:247], v[220:223]
    s_waitcnt lgkmcnt(3)
    v_exp_f32 v145, v145
    v_mfma_f32_16x16x32_bf16 v[220:223], a[180:183], a[248:251], v[220:223]
    v_exp_f32 v146, v146
    v_mfma_f32_16x16x32_bf16 v[216:219], a[172:175], a[244:247], v[216:219]
    v_exp_f32 v147, v147
    v_mfma_f32_16x16x32_bf16 v[216:219], a[184:187], a[248:251], v[216:219]
    v_cvt_pk_bf16_f32 v162, v144, v145
    v_cvt_pk_bf16_f32 v163, v146, v147
    v_mfma_f32_16x16x32_bf16 v[212:215], a[176:179], a[244:247], v[212:215]
    ds_read_b128 a[244:247], v224 offset:46464
    ds_read_b128 v[144:147], v229 offset:1280
    v_mfma_f32_16x16x32_bf16 v[212:215], a[188:191], a[248:251], v[212:215]
    v_exp_f32 v148, v148
    v_mfma_f32_16x16x32_bf16 v[196:199], a[216:219], v[160:163], v[196:199]
    ds_read_b128 a[248:251], v224 offset:46528
    v_mfma_f32_16x16x32_bf16 v[184:187], v[84:87], v[160:163], v[184:187]
    v_exp_f32 v149, v149
    v_mfma_f32_16x16x32_bf16 v[188:191], v[106:109], v[160:163], v[188:191]
    v_exp_f32 v150, v150
    v_mfma_f32_16x16x32_bf16 v[192:195], v[128:131], v[160:163], v[192:195]
    s_waitcnt lgkmcnt(3)
    v_exp_f32 v151, v151
    v_mfma_f32_16x16x32_bf16 v[220:223], a[192:195], a[236:239], v[220:223]
    v_cvt_pk_bf16_f32 v160, v148, v149
    v_cvt_pk_bf16_f32 v161, v150, v151
    v_mfma_f32_16x16x32_bf16 v[220:223], a[204:207], a[240:243], v[220:223]
    ds_read_b128 v[148:151], v228 offset:1280
    v_mfma_f32_16x16x16_bf16 v[196:199], a[216:217], v[160:161], v[196:199]
    v_mfma_f32_16x16x16_bf16 v[184:187], v[82:83], v[160:161], v[184:187]
    v_mfma_f32_16x16x16_bf16 v[188:191], v[104:105], v[160:161], v[188:191]
    v_mfma_f32_16x16x16_bf16 v[192:195], v[126:127], v[160:161], v[192:195]
    v_mfma_f32_16x16x32_bf16 v[216:219], a[196:199], a[236:239], v[216:219]
    v_mfma_f32_16x16x32_bf16 v[216:219], a[208:211], a[240:243], v[216:219]
    v_mfma_f32_16x16x32_bf16 v[212:215], a[200:203], a[236:239], v[212:215]
    v_mul_f32 v220, s37, v220
    v_mul_f32 v221, s37, v221
    v_mfma_f32_16x16x32_bf16 v[212:215], a[212:215], a[240:243], v[212:215]
    v_mul_f32 v222, s37, v222
    v_mul_f32 v223, s37, v223
    v_mfma_f32_16x16x32_bf16 v[200:203], v[168:171], a[252:255], v[200:203]
    v_cvt_pk_bf16_f32 v132, v220, v221
    v_cvt_pk_bf16_f32 v133, v222, v223
    v_mfma_f32_16x16x32_bf16 v[204:207], v[248:251], v[164:167], v[204:207]
    v_mul_f32 v216, s37, v216
    v_mul_f32 v217, s37, v217
    v_mfma_f32_16x16x32_bf16 v[180:183], v[248:251], a[252:255], v[180:183]
    s_waitcnt lgkmcnt(0)
    v_mul_f32 v218, s37, v218
    v_mul_f32 v219, s37, v219
    v_mfma_f32_16x16x32_bf16 v[220:223], a[0:3], a[244:247], 0
    v_cvt_pk_bf16_f32 v134, v216, v217
    v_cvt_pk_bf16_f32 v135, v218, v219
    v_mfma_f32_16x16x32_bf16 v[220:223], a[12:15], a[248:251], v[220:223]
    v_mul_f32 v212, s37, v212
    v_mul_f32 v213, s37, v213
    v_mfma_f32_16x16x32_bf16 v[152:155], v[0:3], v[132:135], v[152:155]
    v_mul_f32 v214, s37, v214
    v_mul_f32 v215, s37, v215
    v_mfma_f32_16x16x32_bf16 v[156:159], v[24:27], v[132:135], v[156:159]
    v_cvt_pk_bf16_f32 v136, v212, v213
    v_cvt_pk_bf16_f32 v137, v214, v215
    v_mfma_f32_16x16x32_bf16 v[144:147], v[30:33], v[132:135], v[144:147]
    ds_read_b128 a[236:239], v224 offset:46592
    ds_read_b128 a[240:243], v224 offset:46656
    v_mfma_f32_16x16x16_bf16 v[152:155], v[4:5], v[136:137], v[152:155]
    v_rcp_f32 v197, v196
    v_mfma_f32_16x16x16_bf16 v[156:159], v[28:29], v[136:137], v[156:159]
    v_mul_f32 v184, v184, v197
    v_mul_f32 v185, v185, v197
    v_mfma_f32_16x16x16_bf16 v[144:147], v[34:35], v[136:137], v[144:147]
    v_cvt_pk_bf16_f32 v184, v184, v185
    v_mul_f32 v186, v186, v197
    v_mfma_f32_16x16x32_bf16 v[148:151], v[6:9], v[132:135], v[148:151]
    v_mul_f32 v187, v187, v197
    v_cvt_pk_bf16_f32 v185, v186, v187
    v_mfma_f32_16x16x32_bf16 v[216:219], a[4:7], a[244:247], 0
    v_mul_f32 v188, v188, v197
    v_mul_f32 v189, v189, v197
    v_mfma_f32_16x16x32_bf16 v[216:219], a[16:19], a[248:251], v[216:219]
    v_cvt_pk_bf16_f32 v186, v188, v189
    v_mul_f32 v190, v190, v197
    v_mfma_f32_16x16x16_bf16 v[148:151], v[10:11], v[136:137], v[148:151]
    v_mul_f32 v191, v191, v197
    v_cvt_pk_bf16_f32 v187, v190, v191
    v_mfma_f32_16x16x32_bf16 v[212:215], a[8:11], a[244:247], 0
    ds_read_b128 a[244:247], v224 offset:46720
    v_mul_f32 v192, v192, v197
    v_mfma_f32_16x16x32_bf16 v[212:215], a[20:23], a[248:251], v[212:215]
    s_waitcnt lgkmcnt(2)
    ds_read_b128 a[248:251], v224 offset:46784
    v_mul_f32 v193, v193, v197
    v_mfma_f32_16x16x32_bf16 v[220:223], a[24:27], a[236:239], v[220:223]
    s_waitcnt lgkmcnt(2)
    v_cvt_pk_bf16_f32 v188, v192, v193
    v_mul_f32 v194, v194, v197
    v_mfma_f32_16x16x32_bf16 v[220:223], a[36:39], a[240:243], v[220:223]
    v_mul_f32 v195, v195, v197
    v_cvt_pk_bf16_f32 v189, v194, v195
    v_mfma_f32_16x16x32_bf16 v[216:219], a[28:31], a[236:239], v[216:219]
    ds_read_b128 v[168:171], v242 offset:12288
    v_max3_f32 v236, v236, v196, v197
    v_mfma_f32_16x16x32_bf16 v[216:219], a[40:43], a[240:243], v[216:219]
    ds_write_b128 v237, v[184:187] offset:18432
    v_mfma_f32_16x16x32_bf16 v[212:215], a[32:35], a[236:239], v[212:215]
    ds_write_b64 v238, v[188:189] offset:18432
    v_mfma_f32_16x16x32_bf16 v[212:215], a[44:47], a[240:243], v[212:215]
    s_waitcnt lgkmcnt(4)
    v_exp_f32 v152, v152
    v_mfma_f32_16x16x32_bf16 v[220:223], a[48:51], a[244:247], v[220:223]
    s_waitcnt lgkmcnt(3)
    v_exp_f32 v153, v153
    v_mfma_f32_16x16x32_bf16 v[220:223], a[60:63], a[248:251], v[220:223]
    v_exp_f32 v154, v154
    v_mfma_f32_16x16x32_bf16 v[216:219], a[52:55], a[244:247], v[216:219]
    ds_read_b128 a[236:239], v224 offset:46464
    ds_read_b128 a[240:243], v224 offset:46528
    v_mfma_f32_16x16x32_bf16 v[216:219], a[64:67], a[248:251], v[216:219]
    s_waitcnt lgkmcnt(4)
    ds_read_b128 v[248:251], v242 offset:12800
    v_cvt_pk_bf16_f32 v160, v152, v153
    v_mfma_f32_16x16x32_bf16 v[176:179], v[168:171], v[164:167], v[176:179]
    v_cvt_pk_bf16_f32 v18, v220, v221
    v_cvt_pk_bf16_f32 v19, v222, v223
    v_mfma_f32_16x16x32_bf16 v[212:215], a[56:59], a[244:247], v[212:215]
    ds_read_b128 a[244:247], v224 offset:46592
    ds_read_b128 v[168:171], v241 offset:24576
    v_mfma_f32_16x16x32_bf16 v[212:215], a[68:71], a[248:251], v[212:215]
    s_waitcnt lgkmcnt(4)
    v_cvt_pk_bf16_f32 v20, v216, v217
    v_cvt_pk_bf16_f32 v21, v218, v219
    ds_read_b128 a[248:251], v224 offset:46656
    ds_read_b128 a[252:255], v239 offset:3072
    v_exp_f32 v155, v155
    v_exp_f32 v156, v156
    v_cvt_pk_bf16_f32 v161, v154, v155
    ds_read_b128 v[152:155], v228 offset:1920
    v_cvt_pk_bf16_f32 v22, v212, v213
    v_cvt_pk_bf16_f32 v23, v214, v215
    v_mfma_f32_16x16x32_bf16 v[220:223], a[236:239], a[72:75], 0
    s_waitcnt lgkmcnt(6)
    v_exp_f32 v157, v157
    v_mfma_f32_16x16x32_bf16 v[220:223], a[240:243], a[84:87], v[220:223]
    s_waitcnt lgkmcnt(5)
    v_exp_f32 v158, v158
    v_mfma_f32_16x16x32_bf16 v[172:175], v[248:251], v[164:167], v[172:175]
    ds_read_b128 v[164:167], v240 offset:2048
    ds_read_b128 v[248:251], v241 offset:25088
    v_mfma_f32_16x16x32_bf16 v[216:219], a[236:239], a[76:79], 0
    v_exp_f32 v159, v159
    v_mfma_f32_16x16x32_bf16 v[216:219], a[240:243], a[88:91], v[216:219]
    s_waitcnt lgkmcnt(5)
    v_cvt_pk_bf16_f32 v162, v156, v157
    v_cvt_pk_bf16_f32 v163, v158, v159
    v_mfma_f32_16x16x32_bf16 v[208:211], v[168:171], v[252:255], v[208:211]
    ds_read_b128 v[156:159], v229 offset:1920
    v_mfma_f32_16x16x32_bf16 v[196:199], a[216:219], v[160:163], 0
    v_exp_f32 v144, v144
    v_mfma_f32_16x16x32_bf16 v[184:187], v[66:69], v[160:163], 0
    v_exp_f32 v145, v145
    v_mfma_f32_16x16x32_bf16 v[188:191], v[88:91], v[160:163], 0
    v_exp_f32 v146, v146
    v_mfma_f32_16x16x32_bf16 v[192:195], v[110:113], v[160:163], 0
    s_waitcnt lgkmcnt(3)
    v_exp_f32 v147, v147
    v_mfma_f32_16x16x32_bf16 v[152:155], v[12:15], v[132:135], v[152:155]
    s_waitcnt lgkmcnt(2)
    v_cvt_pk_bf16_f32 v160, v144, v145
    v_cvt_pk_bf16_f32 v161, v146, v147
    v_mfma_f32_16x16x32_bf16 v[200:203], v[168:171], v[164:167], v[200:203]
    s_waitcnt lgkmcnt(1)
    ds_read_b128 v[168:171], v242 offset:24576
    ds_read_b128 v[144:147], v229 offset:2560
    v_mfma_f32_16x16x32_bf16 v[204:207], v[248:251], v[252:255], v[204:207]
    v_exp_f32 v148, v148
    v_mfma_f32_16x16x16_bf16 v[152:155], v[16:17], v[136:137], v[152:155]
    s_waitcnt lgkmcnt(2)
    v_exp_f32 v149, v149
    v_mfma_f32_16x16x32_bf16 v[156:159], v[36:39], v[132:135], v[156:159]
    v_exp_f32 v150, v150
    v_mfma_f32_16x16x32_bf16 v[180:183], v[248:251], v[164:167], v[180:183]
    ds_read_b128 v[248:251], v242 offset:25088
    ds_read_b128 v[164:167], v239 offset:4096
    v_mfma_f32_16x16x32_bf16 v[212:215], a[236:239], a[80:83], 0
    ds_read_b128 a[236:239], v224 offset:46720
    v_cvt_pk_bf16_f32 v162, v148, v149
    v_mfma_f32_16x16x32_bf16 v[212:215], a[240:243], a[92:95], v[212:215]
    ds_read_b128 a[240:243], v224 offset:46784
    v_mfma_f32_16x16x16_bf16 v[156:159], v[40:41], v[136:137], v[156:159]
    v_exp_f32 v151, v151
    v_mfma_f32_16x16x32_bf16 v[220:223], a[244:247], a[96:99], v[220:223]
    v_cvt_pk_bf16_f32 v163, v150, v151
    v_mfma_f32_16x16x32_bf16 v[220:223], a[248:251], a[108:111], v[220:223]
    ds_read_b128 v[148:151], v228 offset:2560
    v_mfma_f32_16x16x32_bf16 v[196:199], a[216:219], v[160:163], v[196:199]
    v_exp_f32 v152, v152
    v_mfma_f32_16x16x32_bf16 v[184:187], v[70:73], v[160:163], v[184:187]
    v_exp_f32 v153, v153
    v_mfma_f32_16x16x32_bf16 v[188:191], v[92:95], v[160:163], v[188:191]
    v_exp_f32 v154, v154
    v_mfma_f32_16x16x32_bf16 v[192:195], v[114:117], v[160:163], v[192:195]
    s_waitcnt lgkmcnt(5)
    v_exp_f32 v155, v155
    v_mfma_f32_16x16x32_bf16 v[176:179], v[168:171], v[252:255], v[176:179]
    s_waitcnt lgkmcnt(4)
    ds_read_b128 v[168:171], v241 offset:36864
    v_cvt_pk_bf16_f32 v160, v152, v153
    v_mfma_f32_16x16x32_bf16 v[172:175], v[248:251], v[252:255], v[172:175]
    ds_read_b128 v[252:255], v240 offset:3072
    ds_read_b128 v[248:251], v241 offset:37376
    v_mfma_f32_16x16x32_bf16 v[216:219], a[244:247], a[100:103], v[216:219]
    v_cvt_pk_bf16_f32 v161, v154, v155
    v_mfma_f32_16x16x32_bf16 v[216:219], a[248:251], a[112:115], v[216:219]
    s_waitcnt lgkmcnt(3)
    ds_read_b128 v[152:155], v230 offset:640
    v_mfma_f32_16x16x32_bf16 v[148:151], v[18:21], v[132:135], v[148:151]
    v_exp_f32 v156, v156
    v_mfma_f32_16x16x32_bf16 v[212:215], a[244:247], a[104:107], v[212:215]
    ds_read_b128 a[244:247], v224 offset:49536
    v_mfma_f32_16x16x32_bf16 v[212:215], a[248:251], a[116:119], v[212:215]
    ds_read_b128 a[248:251], v224 offset:49600
    v_mfma_f32_16x16x32_bf16 v[220:223], a[236:239], a[120:123], v[220:223]
    v_exp_f32 v157, v157
    v_mfma_f32_16x16x32_bf16 v[220:223], a[240:243], a[132:135], v[220:223]
    v_exp_f32 v158, v158
    v_mfma_f32_16x16x16_bf16 v[148:151], v[22:23], v[136:137], v[148:151]
    v_exp_f32 v159, v159
    v_mfma_f32_16x16x32_bf16 v[216:219], a[236:239], a[124:127], v[216:219]
    v_cvt_pk_bf16_f32 v162, v156, v157
    v_cvt_pk_bf16_f32 v163, v158, v159
    v_mfma_f32_16x16x32_bf16 v[216:219], a[240:243], a[136:139], v[216:219]
    ds_read_b128 v[156:159], v230 offset:1280
    v_cvt_pk_bf16_f32 v80, v220, v221
    v_mfma_f32_16x16x32_bf16 v[196:199], a[216:219], v[160:163], v[196:199]
    v_cvt_pk_bf16_f32 v81, v222, v223
    v_mfma_f32_16x16x32_bf16 v[184:187], v[74:77], v[160:163], v[184:187]
    v_exp_f32 v148, v148
    v_mfma_f32_16x16x32_bf16 v[188:191], v[96:99], v[160:163], v[188:191]
    v_exp_f32 v149, v149
    v_mfma_f32_16x16x32_bf16 v[192:195], v[118:121], v[160:163], v[192:195]
    v_cvt_pk_bf16_f32 v102, v216, v217
    v_cvt_pk_bf16_f32 v103, v218, v219
    v_mfma_f32_16x16x32_bf16 v[212:215], a[236:239], a[128:131], v[212:215]
    ds_read_b128 a[236:239], v224 offset:49664
    v_cvt_pk_bf16_f32 v162, v148, v149
    v_mfma_f32_16x16x32_bf16 v[212:215], a[240:243], a[140:143], v[212:215]
    s_waitcnt lgkmcnt(2)
    ds_read_b128 a[240:243], v224 offset:49728
    v_mfma_f32_16x16x32_bf16 v[208:211], v[168:171], a[252:255], v[208:211]
    v_exp_f32 v150, v150
    v_mfma_f32_16x16x32_bf16 v[200:203], v[168:171], v[252:255], v[200:203]
    ds_read_b128 v[168:171], v242 offset:36864
    v_mfma_f32_16x16x32_bf16 v[204:207], v[248:251], a[252:255], v[204:207]
    v_exp_f32 v151, v151
    v_mfma_f32_16x16x32_bf16 v[180:183], v[248:251], v[252:255], v[180:183]
    v_cvt_pk_bf16_f32 v124, v212, v213
    v_cvt_pk_bf16_f32 v125, v214, v215
    v_mfma_f32_16x16x32_bf16 v[220:223], a[0:3], a[244:247], 0
    ds_read_b128 v[248:251], v242 offset:37376
    ds_read_b128 v[252:255], v239 offset:5120
    v_mfma_f32_16x16x32_bf16 v[220:223], a[12:15], a[248:251], v[220:223]
    v_cvt_pk_bf16_f32 v163, v150, v151
    v_mfma_f32_16x16x32_bf16 v[216:219], a[4:7], a[244:247], 0
    ds_read_b128 v[148:151], v230 offset:2560
    v_mfma_f32_16x16x32_bf16 v[216:219], a[16:19], a[248:251], v[216:219]
    v_mfma_f32_16x16x32_bf16 v[212:215], a[8:11], a[244:247], 0
    ds_read_b128 a[244:247], v224 offset:49792
    v_mfma_f32_16x16x32_bf16 v[212:215], a[20:23], a[248:251], v[212:215]
    s_waitcnt lgkmcnt(4)
    ds_read_b128 a[248:251], v224 offset:49856
    v_mfma_f32_16x16x32_bf16 v[176:179], v[168:171], a[252:255], v[176:179]
    ds_read_b128 v[168:171], v241 offset:49152
    v_mfma_f32_16x16x32_bf16 v[220:223], a[24:27], a[236:239], v[220:223]
    v_mfma_f32_16x16x32_bf16 v[220:223], a[36:39], a[240:243], v[220:223]
    s_waitcnt lgkmcnt(5)
    v_mfma_f32_16x16x32_bf16 v[172:175], v[248:251], a[252:255], v[172:175]
    ds_read_b128 a[252:255], v240 offset:4096
    ds_read_b128 v[248:251], v241 offset:49664
    v_mfma_f32_16x16x32_bf16 v[216:219], a[28:31], a[236:239], v[216:219]
    v_mfma_f32_16x16x32_bf16 v[216:219], a[40:43], a[240:243], v[216:219]
    v_mfma_f32_16x16x32_bf16 v[212:215], a[32:35], a[236:239], v[212:215]
    ds_read_b128 a[236:239], v224 offset:49536
    v_mfma_f32_16x16x32_bf16 v[212:215], a[44:47], a[240:243], v[212:215]
    s_waitcnt lgkmcnt(5)
    ds_read_b128 a[240:243], v224 offset:49600
    v_mfma_f32_16x16x32_bf16 v[220:223], a[48:51], a[244:247], v[220:223]
    s_waitcnt lgkmcnt(5)
    v_mfma_f32_16x16x32_bf16 v[220:223], a[60:63], a[248:251], v[220:223]
    v_mfma_f32_16x16x32_bf16 v[216:219], a[52:55], a[244:247], v[216:219]
    v_mfma_f32_16x16x32_bf16 v[216:219], a[64:67], a[248:251], v[216:219]
    v_mfma_f32_16x16x32_bf16 v[212:215], a[56:59], a[244:247], v[212:215]
    ds_read_b128 a[244:247], v224 offset:49664
    v_mfma_f32_16x16x32_bf16 v[212:215], a[68:71], a[248:251], v[212:215]
    s_waitcnt lgkmcnt(4)
    ds_read_b128 a[248:251], v224 offset:49728
    v_mfma_f32_16x16x32_bf16 v[208:211], v[168:171], v[164:167], v[208:211]
    v_mfma_f32_16x16x32_bf16 v[200:203], v[168:171], a[252:255], v[200:203]
    s_waitcnt lgkmcnt(4)
    v_cvt_pk_bf16_f32 v42, v220, v221
    v_cvt_pk_bf16_f32 v43, v222, v223
    v_mfma_f32_16x16x32_bf16 v[204:207], v[248:251], v[164:167], v[204:207]
    v_cvt_pk_bf16_f32 v44, v216, v217
    v_cvt_pk_bf16_f32 v45, v218, v219
    v_mfma_f32_16x16x32_bf16 v[180:183], v[248:251], a[252:255], v[180:183]
    v_cvt_pk_bf16_f32 v46, v212, v213
    v_cvt_pk_bf16_f32 v47, v214, v215
    v_mfma_f32_16x16x32_bf16 v[144:147], v[42:45], v[132:135], v[144:147]
    s_waitcnt lgkmcnt(2)
    ds_read_b128 v[168:171], v242 offset:49152
    ds_read_b128 v[248:251], v242 offset:49664
    v_mfma_f32_16x16x32_bf16 v[220:223], a[236:239], a[72:75], 0
    v_mfma_f32_16x16x32_bf16 v[220:223], a[240:243], a[84:87], v[220:223]
    v_mfma_f32_16x16x32_bf16 v[216:219], a[236:239], a[76:79], 0
    v_mfma_f32_16x16x32_bf16 v[216:219], a[240:243], a[88:91], v[216:219]
    v_mfma_f32_16x16x16_bf16 v[144:147], v[46:47], v[136:137], v[144:147]
    v_mfma_f32_16x16x32_bf16 v[212:215], a[236:239], a[80:83], 0
    ds_read_b128 a[236:239], v224 offset:49792
    v_mfma_f32_16x16x32_bf16 v[212:215], a[240:243], a[92:95], v[212:215]
    s_waitcnt lgkmcnt(3)
    ds_read_b128 a[240:243], v224 offset:49856
    v_mfma_f32_16x16x32_bf16 v[220:223], a[244:247], a[96:99], v[220:223]
    v_mfma_f32_16x16x32_bf16 v[220:223], a[248:251], a[108:111], v[220:223]
    s_waitcnt lgkmcnt(3)
    v_mfma_f32_16x16x32_bf16 v[176:179], v[168:171], v[164:167], v[176:179]
    s_waitcnt lgkmcnt(2)
    ds_read_b128 v[168:171], v241 offset:61440
    v_mfma_f32_16x16x32_bf16 v[172:175], v[248:251], v[164:167], v[172:175]
    ds_read_b128 v[164:167], v240 offset:5120
    ds_read_b128 v[248:251], v241 offset:61952
    v_mfma_f32_16x16x32_bf16 v[216:219], a[244:247], a[100:103], v[216:219]
    v_exp_f32 v144, v144
    v_mfma_f32_16x16x32_bf16 v[216:219], a[248:251], a[112:115], v[216:219]
    v_exp_f32 v145, v145
    v_mfma_f32_16x16x32_bf16 v[212:215], a[244:247], a[104:107], v[212:215]
    ds_read_b128 a[244:247], v225 offset:27456
    v_cvt_pk_bf16_f32 v160, v144, v145
    v_mfma_f32_16x16x32_bf16 v[212:215], a[248:251], a[116:119], v[212:215]
    s_waitcnt lgkmcnt(5)
    ds_read_b128 a[248:251], v225 offset:27520
    v_mfma_f32_16x16x32_bf16 v[220:223], a[236:239], a[120:123], v[220:223]
    s_waitcnt lgkmcnt(5)
    v_exp_f32 v146, v146
    v_mfma_f32_16x16x32_bf16 v[220:223], a[240:243], a[132:135], v[220:223]
    v_exp_f32 v147, v147
    v_mfma_f32_16x16x32_bf16 v[216:219], a[236:239], a[124:127], v[216:219]
    v_cvt_pk_bf16_f32 v161, v146, v147
    v_mfma_f32_16x16x32_bf16 v[216:219], a[240:243], a[136:139], v[216:219]
    ds_read_b128 v[144:147], v230 offset:1920
    v_mfma_f32_16x16x32_bf16 v[196:199], a[216:219], v[160:163], v[196:199]
    v_mfma_f32_16x16x32_bf16 v[212:215], a[236:239], a[128:131], v[212:215]
    ds_read_b128 a[236:239], v225 offset:27584
    v_cvt_pk_bf16_f32 v78, v220, v221
    v_mfma_f32_16x16x32_bf16 v[212:215], a[240:243], a[140:143], v[212:215]
    s_waitcnt lgkmcnt(4)
    ds_read_b128 a[240:243], v225 offset:27648
    v_cvt_pk_bf16_f32 v79, v222, v223
    v_mfma_f32_16x16x32_bf16 v[208:211], v[168:171], v[252:255], v[208:211]
    v_cvt_pk_bf16_f32 v100, v216, v217
    v_cvt_pk_bf16_f32 v101, v218, v219
    v_mfma_f32_16x16x32_bf16 v[184:187], v[78:81], v[160:163], v[184:187]
    v_rcp_f32 v197, v196
    v_mfma_f32_16x16x32_bf16 v[188:191], v[100:103], v[160:163], v[188:191]
    v_cvt_pk_bf16_f32 v122, v212, v213
    v_cvt_pk_bf16_f32 v123, v214, v215
    v_mfma_f32_16x16x32_bf16 v[200:203], v[168:171], v[164:167], v[200:203]
    ds_read_b128 v[168:171], v242 offset:61440
    v_cvt_pk_bf16_f32 v208, v208, v209
    v_mfma_f32_16x16x32_bf16 v[192:195], v[122:125], v[160:163], v[192:195]
    v_cvt_pk_bf16_f32 v209, v210, v211
    v_mul_f32 v184, v184, v197
    v_mfma_f32_16x16x32_bf16 v[204:207], v[248:251], v[252:255], v[204:207]
    v_mul_f32 v185, v185, v197
    v_cvt_pk_bf16_f32 v184, v184, v185
    v_mfma_f32_16x16x32_bf16 v[180:183], v[248:251], v[164:167], v[180:183]
    s_waitcnt lgkmcnt(3)
    ds_read_b128 v[248:251], v242 offset:61952
    v_cvt_pk_bf16_f32 v200, v200, v201
    v_mfma_f32_16x16x32_bf16 v[220:223], a[144:147], a[244:247], 0
    v_cvt_pk_bf16_f32 v201, v202, v203
    v_mul_f32 v186, v186, v197
    v_mfma_f32_16x16x32_bf16 v[220:223], a[156:159], a[248:251], v[220:223]
    v_cvt_pk_bf16_f32 v210, v204, v205
    v_cvt_pk_bf16_f32 v211, v206, v207
    v_mfma_f32_16x16x32_bf16 v[216:219], a[148:151], a[244:247], 0
    buffer_store_dwordx4 v[208:211], v243, s[20:23], s51 offen sc0 sc1
    v_mfma_f32_16x16x32_bf16 v[216:219], a[160:163], a[248:251], v[216:219]
    s_waitcnt lgkmcnt(1)
    v_cvt_pk_bf16_f32 v202, v180, v181
    v_cvt_pk_bf16_f32 v203, v182, v183
    v_mfma_f32_16x16x32_bf16 v[176:179], v[168:171], v[252:255], v[176:179]
    v_mul_f32 v187, v187, v197
    v_cvt_pk_bf16_f32 v185, v186, v187
    v_mfma_f32_16x16x32_bf16 v[212:215], a[152:155], a[244:247], 0
    ds_read_b128 a[244:247], v225 offset:27712
    v_mul_f32 v188, v188, v197
    v_mfma_f32_16x16x32_bf16 v[212:215], a[164:167], a[248:251], v[212:215]
    s_waitcnt lgkmcnt(1)
    ds_read_b128 a[248:251], v225 offset:27776
    v_mul_f32 v189, v189, v197
    v_mfma_f32_16x16x32_bf16 v[172:175], v[248:251], v[252:255], v[172:175]
    v_cvt_pk_bf16_f32 v176, v176, v177
    v_cvt_pk_bf16_f32 v177, v178, v179
    v_mfma_f32_16x16x32_bf16 v[220:223], a[168:171], a[236:239], v[220:223]
L_pg6:
    s_cbranch_execz L_back
    v_cvt_pk_bf16_f32 v186, v188, v189
    v_mul_f32 v190, v190, v197
    v_mfma_f32_16x16x32_bf16 v[220:223], a[180:183], a[240:243], v[220:223]
    v_mul_f32 v191, v191, v197
    v_cvt_pk_bf16_f32 v187, v190, v191
    v_mfma_f32_16x16x32_bf16 v[216:219], a[172:175], a[236:239], v[216:219]
    v_cvt_pk_bf16_f32 v178, v172, v173
    v_cvt_pk_bf16_f32 v179, v174, v175
    v_mfma_f32_16x16x32_bf16 v[216:219], a[184:187], a[240:243], v[216:219]
    v_mul_f32 v192, v192, v197
    v_mul_f32 v193, v193, v197
    v_mfma_f32_16x16x32_bf16 v[212:215], a[176:179], a[236:239], v[212:215]
    ds_read_b128 a[236:239], v225 offset:39872
    v_cvt_pk_bf16_f32 v188, v192, v193
    v_mfma_f32_16x16x32_bf16 v[212:215], a[188:191], a[240:243], v[212:215]
    s_waitcnt lgkmcnt(2)
    ds_read_b128 a[240:243], v225 offset:39936
    v_mul_f32 v194, v194, v197
    v_mfma_f32_16x16x32_bf16 v[220:223], a[192:195], a[244:247], v[220:223]
    s_waitcnt vmcnt(1) lgkmcnt(2)
    buffer_store_dwordx4 v[200:203], v245, s[20:23], s51 offen sc0 sc1
    v_mfma_f32_16x16x32_bf16 v[220:223], a[204:207], a[248:251], v[220:223]
    s_barrier
    v_mul_f32 v195, v195, v197
    v_cvt_pk_bf16_f32 v189, v194, v195
    v_mfma_f32_16x16x32_bf16 v[216:219], a[196:199], a[244:247], v[216:219]
    ds_read_b128 a[252:255], v239 offset:12288
    v_max3_f32 v236, v236, v196, v197
    v_mfma_f32_16x16x32_bf16 v[216:219], a[208:211], a[248:251], v[216:219]
    ds_write_b128 v237, v[184:187]
    v_mfma_f32_16x16x32_bf16 v[212:215], a[200:203], a[244:247], v[212:215]
    v_mul_f32 v220, s37, v220
    v_mul_f32 v221, s37, v221
    v_mfma_f32_16x16x32_bf16 v[212:215], a[212:215], a[248:251], v[212:215]
    s_waitcnt lgkmcnt(3)
    v_mul_f32 v222, s37, v222
    v_mul_f32 v223, s37, v223
    v_cvt_pk_bf16_f32 v138, v220, v221
    v_cvt_pk_bf16_f32 v139, v222, v223
    v_mfma_f32_16x16x32_bf16 v[220:223], a[144:147], a[236:239], 0
    s_waitcnt lgkmcnt(2)
    v_mul_f32 v216, s37, v216
    v_mul_f32 v217, s37, v217
    v_mfma_f32_16x16x32_bf16 v[220:223], a[156:159], a[240:243], v[220:223]
    v_mul_f32 v218, s37, v218
    v_mul_f32 v219, s37, v219
    v_cvt_pk_bf16_f32 v140, v216, v217
    v_cvt_pk_bf16_f32 v141, v218, v219
    v_mfma_f32_16x16x32_bf16 v[216:219], a[148:151], a[236:239], 0
    v_mul_f32 v212, s37, v212
    v_mul_f32 v213, s37, v213
    v_mfma_f32_16x16x32_bf16 v[216:219], a[160:163], a[240:243], v[216:219]
    v_mul_f32 v214, s37, v214
    v_mul_f32 v215, s37, v215
    v_mfma_f32_16x16x32_bf16 v[152:155], v[24:27], v[138:141], v[152:155]
    v_cvt_pk_bf16_f32 v142, v212, v213
    v_cvt_pk_bf16_f32 v143, v214, v215
    v_mfma_f32_16x16x32_bf16 v[156:159], v[30:33], v[138:141], v[156:159]
    ds_read_b128 a[244:247], v225 offset:40000
    ds_read_b128 a[248:251], v225 offset:40064
    v_mfma_f32_16x16x32_bf16 v[144:147], v[36:39], v[138:141], v[144:147]
    buffer_store_dwordx4 v[176:179], v244, s[20:23], s51 offen sc0 sc1
    v_mfma_f32_16x16x16_bf16 v[152:155], v[28:29], v[142:143], v[152:155]
    s_add_u32 s51, s51, s48
    ds_write_b64 v238, v[188:189]
    v_mfma_f32_16x16x16_bf16 v[156:159], v[34:35], v[142:143], v[156:159]
    v_mfma_f32_16x16x32_bf16 v[148:151], v[42:45], v[138:141], v[148:151]
    ds_read_b128 v[252:255], v240 offset:12288
    ds_read_b128 v[164:167], v239 offset:13312
    v_mfma_f32_16x16x16_bf16 v[144:147], v[40:41], v[142:143], v[144:147]
    ds_read_b128 v[168:171], v241 offset:12288
    v_mfma_f32_16x16x32_bf16 v[212:215], a[152:155], a[236:239], 0
    ds_read_b128 a[236:239], v225 offset:40128
    v_mfma_f32_16x16x32_bf16 v[212:215], a[164:167], a[240:243], v[212:215]
    ds_read_b128 a[240:243], v225 offset:40192
    v_mfma_f32_16x16x16_bf16 v[148:151], v[46:47], v[142:143], v[148:151]
    s_waitcnt lgkmcnt(7)
    ds_read_b128 v[248:251], v241 offset:12800
    v_mfma_f32_16x16x32_bf16 v[220:223], a[168:171], a[244:247], v[220:223]
    s_waitcnt lgkmcnt(7)
    v_exp_f32 v152, v152
    v_mfma_f32_16x16x32_bf16 v[220:223], a[180:183], a[248:251], v[220:223]
    v_exp_f32 v153, v153
    v_mfma_f32_16x16x32_bf16 v[216:219], a[172:175], a[244:247], v[216:219]
    v_exp_f32 v154, v154
    v_mfma_f32_16x16x32_bf16 v[216:219], a[184:187], a[248:251], v[216:219]
    buffer_load_dwordx4 v246, s[4:7], s56 offen lds
    v_mfma_f32_16x16x32_bf16 v[212:215], a[176:179], a[244:247], v[212:215]
    ds_read_b128 a[244:247], v224
    v_cvt_pk_bf16_f32 v160, v152, v153
    v_mfma_f32_16x16x32_bf16 v[212:215], a[188:191], a[248:251], v[212:215]
    ds_read_b128 a[248:251], v224 offset:64
    v_mfma_f32_16x16x32_bf16 v[208:211], a[220:223], a[252:255], 0
    s_waitcnt lgkmcnt(4)
    v_exp_f32 v155, v155
    v_mfma_f32_16x16x32_bf16 v[220:223], a[192:195], a[236:239], v[220:223]
    s_waitcnt lgkmcnt(3)
    v_cvt_pk_bf16_f32 v161, v154, v155
    v_mfma_f32_16x16x32_bf16 v[220:223], a[204:207], a[240:243], v[220:223]
    ds_read_b128 v[152:155], v235
    v_bfe_u32 v235, s67, v233, 4
    v_mfma_f32_16x16x32_bf16 v[216:219], a[196:199], a[236:239], v[216:219]
    v_mad_u32_u24 v235, v235, s40, v231
    v_mfma_f32_16x16x32_bf16 v[216:219], a[208:211], a[240:243], v[216:219]
    v_exp_f32 v156, v156
    v_mfma_f32_16x16x32_bf16 v[212:215], a[200:203], a[236:239], v[212:215]
    ds_read_b128 a[236:239], v224 offset:128
    v_mul_f32 v220, s37, v220
    v_mfma_f32_16x16x32_bf16 v[212:215], a[212:215], a[240:243], v[212:215]
    v_mul_f32 v221, s37, v221
    v_mul_f32 v222, s37, v222
    v_mfma_f32_16x16x32_bf16 v[200:203], a[220:223], v[252:255], 0
    v_mul_f32 v223, s37, v223
    v_cvt_pk_bf16_f32 v132, v220, v221
    v_mfma_f32_16x16x32_bf16 v[204:207], a[224:227], a[252:255], 0
    v_cvt_pk_bf16_f32 v133, v222, v223
    v_mul_f32 v216, s37, v216
    v_mfma_f32_16x16x32_bf16 v[180:183], a[224:227], v[252:255], 0
    v_mul_f32 v217, s37, v217
    v_mul_f32 v218, s37, v218
    v_mfma_f32_16x16x32_bf16 v[176:179], a[228:231], a[252:255], 0
    s_waitcnt lgkmcnt(1)
    v_mul_f32 v219, s37, v219
    v_cvt_pk_bf16_f32 v134, v216, v217
    v_mfma_f32_16x16x32_bf16 v[152:155], v[60:63], v[138:141], v[152:155]
    v_cvt_pk_bf16_f32 v135, v218, v219
    v_mul_f32 v212, s37, v212
    v_mfma_f32_16x16x32_bf16 v[172:175], a[232:235], a[252:255], 0
    v_mul_f32 v213, s37, v213
    v_mul_f32 v214, s37, v214
    v_mfma_f32_16x16x32_bf16 v[220:223], a[0:3], a[244:247], 0
    v_mul_f32 v215, s37, v215
    v_cvt_pk_bf16_f32 v136, v212, v213
    v_mfma_f32_16x16x32_bf16 v[220:223], a[12:15], a[248:251], v[220:223]
    ds_read_b128 a[240:243], v224 offset:192
    v_cvt_pk_bf16_f32 v137, v214, v215
    v_mfma_f32_16x16x16_bf16 v[152:155], v[64:65], v[142:143], v[152:155]
    buffer_load_dwordx4 v247, s[4:7], s56 offen offset:1024 lds
    v_mfma_f32_16x16x32_bf16 v[216:219], a[4:7], a[244:247], 0
    s_add_u32 s56, s56, s42
    ds_read_b128 a[252:255], v240 offset:13312
    ds_read_b128 v[252:255], v239 offset:14336
    v_mfma_f32_16x16x32_bf16 v[216:219], a[16:19], a[248:251], v[216:219]
    s_add_u32 m0, s41, 0x5ac0
    v_exp_f32 v157, v157
    v_mfma_f32_16x16x32_bf16 v[212:215], a[8:11], a[244:247], 0
    ds_read_b128 a[244:247], v224 offset:256
    v_cvt_pk_bf16_f32 v162, v156, v157
    v_mfma_f32_16x16x32_bf16 v[212:215], a[20:23], a[248:251], v[212:215]
    s_waitcnt lgkmcnt(4)
    ds_read_b128 a[248:251], v224 offset:320
    v_mfma_f32_16x16x32_bf16 v[220:223], a[24:27], a[236:239], v[220:223]
    v_exp_f32 v158, v158
    v_mfma_f32_16x16x32_bf16 v[216:219], a[28:31], a[236:239], v[216:219]
    v_exp_f32 v159, v159
    v_mfma_f32_16x16x32_bf16 v[212:215], a[32:35], a[236:239], v[212:215]
    s_waitcnt lgkmcnt(4)
    ds_read_b128 a[236:239], v224
    v_cvt_pk_bf16_f32 v163, v158, v159
    v_mfma_f32_16x16x32_bf16 v[212:215], a[44:47], a[240:243], v[212:215]
    buffer_load_dwordx4 v246, s[4:7], s56 offen lds
    v_mfma_f32_16x16x32_bf16 v[196:199], a[216:219], v[160:163], 0
    ds_read_b128 v[156:159], v234
    v_bfe_u32 v234, s72, v233, 4
    v_mfma_f32_16x16x32_bf16 v[184:187], v[68:71], v[160:163], 0
    v_mad_u32_u24 v234, v234, s40, v231
    v_cndmask_b32 v246, v245, v243, vcc
    v_mfma_f32_16x16x32_bf16 v[188:191], v[90:93], v[160:163], 0
    v_exp_f32 v144, v144
    v_mfma_f32_16x16x32_bf16 v[192:195], v[112:115], v[160:163], 0
    v_exp_f32 v145, v145
    v_mfma_f32_16x16x32_bf16 v[220:223], a[36:39], a[240:243], v[220:223]
    v_exp_f32 v146, v146
    v_mfma_f32_16x16x32_bf16 v[216:219], a[40:43], a[240:243], v[216:219]
    s_waitcnt lgkmcnt(2)
    ds_read_b128 a[240:243], v224 offset:64
    v_cvt_pk_bf16_f32 v160, v144, v145
    v_mfma_f32_16x16x32_bf16 v[220:223], a[48:51], a[244:247], v[220:223]
    v_exp_f32 v147, v147
    v_mfma_f32_16x16x32_bf16 v[220:223], a[60:63], a[248:251], v[220:223]
    buffer_load_dwordx4 v247, s[4:7], s56 offen offset:1024 lds
    v_mfma_f32_16x16x32_bf16 v[216:219], a[52:55], a[244:247], v[216:219]
    v_bfrev_b32 v247, 1
    v_cvt_pk_bf16_f32 v161, v146, v147
    v_mfma_f32_16x16x32_bf16 v[216:219], a[64:67], a[248:251], v[216:219]
    s_waitcnt lgkmcnt(1)
    ds_read_b128 v[144:147], v229 offset:640
    v_mfma_f32_16x16x32_bf16 v[156:159], v[48:51], v[138:141], v[156:159]
    v_exp_f32 v148, v148
    v_mfma_f32_16x16x32_bf16 v[212:215], a[56:59], a[244:247], v[212:215]
    v_cvt_pk_bf16_f32 v0, v220, v221
    v_cvt_pk_bf16_f32 v1, v222, v223
    v_mfma_f32_16x16x32_bf16 v[212:215], a[68:71], a[248:251], v[212:215]
    ds_read_b128 a[244:247], v224 offset:128
    v_cvt_pk_bf16_f32 v2, v216, v217
    v_mfma_f32_16x16x16_bf16 v[156:159], v[52:53], v[142:143], v[156:159]
    ds_read_b128 a[248:251], v224 offset:192
    v_cvt_pk_bf16_f32 v3, v218, v219
    v_mfma_f32_16x16x32_bf16 v[208:211], v[168:171], v[164:167], v[208:211]
    v_exp_f32 v149, v149
    v_mfma_f32_16x16x32_bf16 v[200:203], v[168:171], a[252:255], v[200:203]
    v_cvt_pk_bf16_f32 v4, v212, v213
    v_cvt_pk_bf16_f32 v5, v214, v215
    v_mfma_f32_16x16x32_bf16 v[204:207], v[248:251], v[164:167], v[204:207]
    ds_read_b128 v[168:171], v242 offset:12288
    v_cvt_pk_bf16_f32 v162, v148, v149
    v_mfma_f32_16x16x32_bf16 v[180:183], v[248:251], a[252:255], v[180:183]
    s_waitcnt lgkmcnt(3)
    ds_read_b128 v[248:251], v242 offset:12800
    ds_read_b128 a[252:255], v239 offset:15360
    v_mfma_f32_16x16x32_bf16 v[144:147], v[30:33], v[132:135], v[144:147]
    v_exp_f32 v150, v150
    v_mfma_f32_16x16x32_bf16 v[220:223], a[236:239], a[72:75], 0
    v_exp_f32 v151, v151
    v_mfma_f32_16x16x32_bf16 v[220:223], a[240:243], a[84:87], v[220:223]
    v_cvt_pk_bf16_f32 v163, v150, v151
    v_mfma_f32_16x16x32_bf16 v[216:219], a[236:239], a[76:79], 0
    ds_read_b128 v[148:151], v228 offset:640
    v_mfma_f32_16x16x32_bf16 v[216:219], a[240:243], a[88:91], v[216:219]
    v_exp_f32 v152, v152
    v_mfma_f32_16x16x32_bf16 v[196:199], a[216:219], v[160:163], v[196:199]
    v_exp_f32 v153, v153
    v_mfma_f32_16x16x32_bf16 v[184:187], v[76:79], v[160:163], v[184:187]
    v_exp_f32 v154, v154
    v_mfma_f32_16x16x32_bf16 v[188:191], v[98:101], v[160:163], v[188:191]
    v_exp_f32 v155, v155
    v_mfma_f32_16x16x32_bf16 v[192:195], v[120:123], v[160:163], v[192:195]
    v_cvt_pk_bf16_f32 v160, v152, v153
    v_cvt_pk_bf16_f32 v161, v154, v155
    v_mfma_f32_16x16x16_bf16 v[144:147], v[34:35], v[136:137], v[144:147]
    ds_read_b128 v[152:155], v228 offset:1280
    v_mfma_f32_16x16x16_bf16 v[196:199], a[216:217], v[160:161], v[196:199]
    v_exp_f32 v156, v156
    v_mfma_f32_16x16x16_bf16 v[184:187], v[86:87], v[160:161], v[184:187]
    v_exp_f32 v157, v157
    v_mfma_f32_16x16x16_bf16 v[188:191], v[108:109], v[160:161], v[188:191]
    v_exp_f32 v158, v158
    v_mfma_f32_16x16x16_bf16 v[192:195], v[130:131], v[160:161], v[192:195]
    s_waitcnt lgkmcnt(1)
    v_exp_f32 v159, v159
    v_mfma_f32_16x16x32_bf16 v[148:151], v[6:9], v[132:135], v[148:151]
    v_cvt_pk_bf16_f32 v160, v156, v157
    v_cvt_pk_bf16_f32 v161, v158, v159
    v_mfma_f32_16x16x32_bf16 v[176:179], v[168:171], v[164:167], v[176:179]
    ds_read_b128 v[168:171], v241 offset:24576
    ds_read_b128 v[156:159], v229 offset:1280
    v_mfma_f32_16x16x16_bf16 v[196:199], a[216:217], v[160:161], v[196:199]
    v_exp_f32 v144, v144
    v_mfma_f32_16x16x16_bf16 v[184:187], v[82:83], v[160:161], v[184:187]
    v_exp_f32 v145, v145
    v_mfma_f32_16x16x16_bf16 v[188:191], v[104:105], v[160:161], v[188:191]
    v_exp_f32 v146, v146
    v_mfma_f32_16x16x16_bf16 v[192:195], v[126:127], v[160:161], v[192:195]
    v_exp_f32 v147, v147
    v_mfma_f32_16x16x16_bf16 v[148:151], v[10:11], v[136:137], v[148:151]
    s_waitcnt lgkmcnt(2)
    v_rcp_f32 v197, v196
    v_mfma_f32_16x16x32_bf16 v[152:155], v[12:15], v[132:135], v[152:155]
    v_mul_f32 v184, v184, v197
    v_mul_f32 v185, v185, v197
    v_mfma_f32_16x16x32_bf16 v[172:175], v[248:251], v[164:167], v[172:175]
    v_cvt_pk_bf16_f32 v184, v184, v185
    v_mul_f32 v186, v186, v197
    v_mfma_f32_16x16x32_bf16 v[212:215], a[236:239], a[80:83], 0
    ds_read_b128 a[236:239], v224 offset:256
    v_mul_f32 v187, v187, v197
    v_mfma_f32_16x16x32_bf16 v[212:215], a[240:243], a[92:95], v[212:215]
    ds_read_b128 a[240:243], v224 offset:320
    v_cvt_pk_bf16_f32 v185, v186, v187
    v_mfma_f32_16x16x16_bf16 v[152:155], v[16:17], v[136:137], v[152:155]
    s_waitcnt lgkmcnt(2)
    v_mul_f32 v188, v188, v197
    v_mul_f32 v189, v189, v197
    v_mfma_f32_16x16x32_bf16 v[156:159], v[36:39], v[132:135], v[156:159]
    v_cvt_pk_bf16_f32 v186, v188, v189
    v_mul_f32 v190, v190, v197
    v_mfma_f32_16x16x32_bf16 v[220:223], a[244:247], a[96:99], v[220:223]
    v_mul_f32 v191, v191, v197
    v_cvt_pk_bf16_f32 v187, v190, v191
    v_mfma_f32_16x16x32_bf16 v[220:223], a[248:251], a[108:111], v[220:223]
    v_mul_f32 v192, v192, v197
    v_mul_f32 v193, v193, v197
    v_mfma_f32_16x16x16_bf16 v[156:159], v[40:41], v[136:137], v[156:159]
    v_cvt_pk_bf16_f32 v188, v192, v193
    v_mul_f32 v194, v194, v197
    v_mfma_f32_16x16x32_bf16 v[216:219], a[244:247], a[100:103], v[216:219]
    v_mul_f32 v195, v195, v197
    v_cvt_pk_bf16_f32 v189, v194, v195
    v_mfma_f32_16x16x32_bf16 v[216:219], a[248:251], a[112:115], v[216:219]
    ds_read_b128 v[164:167], v240 offset:14336
    v_max3_f32 v236, v236, v196, v197
    v_mfma_f32_16x16x32_bf16 v[212:215], a[244:247], a[104:107], v[212:215]
    ds_read_b128 a[244:247], v224 offset:3072
    ds_read_b128 v[248:251], v241 offset:25088
    v_mfma_f32_16x16x32_bf16 v[212:215], a[248:251], a[116:119], v[212:215]
    s_waitcnt lgkmcnt(4)
    ds_read_b128 a[248:251], v224 offset:3136
    v_cvt_pk_bf16_f32 v160, v144, v145
    v_mfma_f32_16x16x32_bf16 v[220:223], a[236:239], a[120:123], v[220:223]
    s_waitcnt lgkmcnt(4)
    ds_write_b128 v237, v[184:187] offset:6144
    v_mfma_f32_16x16x32_bf16 v[220:223], a[240:243], a[132:135], v[220:223]
    ds_write_b64 v238, v[188:189] offset:6144
    v_mfma_f32_16x16x32_bf16 v[216:219], a[236:239], a[124:127], v[216:219]
    v_cvt_pk_bf16_f32 v161, v146, v147
    v_mfma_f32_16x16x32_bf16 v[216:219], a[240:243], a[136:139], v[216:219]
    v_exp_f32 v148, v148
    v_mfma_f32_16x16x32_bf16 v[212:215], a[236:239], a[128:131], v[212:215]
    v_exp_f32 v149, v149
    v_mfma_f32_16x16x32_bf16 v[212:215], a[240:243], a[140:143], v[212:215]
    v_cvt_pk_bf16_f32 v66, v220, v221
    v_cvt_pk_bf16_f32 v67, v222, v223
    v_mfma_f32_16x16x32_bf16 v[208:211], v[168:171], v[252:255], v[208:211]
    s_waitcnt lgkmcnt(5)
    ds_read_b128 a[236:239], v224 offset:3200
    v_cvt_pk_bf16_f32 v88, v216, v217
    v_mfma_f32_16x16x32_bf16 v[200:203], v[168:171], v[164:167], v[200:203]
    s_waitcnt lgkmcnt(4)
    ds_read_b128 a[240:243], v224 offset:3264
    v_cvt_pk_bf16_f32 v89, v218, v219
    v_mfma_f32_16x16x32_bf16 v[204:207], v[248:251], v[252:255], v[204:207]
    v_cvt_pk_bf16_f32 v110, v212, v213
    v_cvt_pk_bf16_f32 v111, v214, v215
    v_mfma_f32_16x16x32_bf16 v[180:183], v[248:251], v[164:167], v[180:183]
    ds_read_b128 v[168:171], v242 offset:24576
    ds_read_b128 v[248:251], v242 offset:25088
    v_mfma_f32_16x16x32_bf16 v[220:223], a[0:3], a[244:247], 0
    s_waitcnt lgkmcnt(6)
    ds_read_b128 v[164:167], v239 offset:16384
    v_cvt_pk_bf16_f32 v162, v148, v149
    v_mfma_f32_16x16x32_bf16 v[220:223], a[12:15], a[248:251], v[220:223]
    ds_read_b128 v[144:147], v229 offset:1920
    v_mfma_f32_16x16x32_bf16 v[216:219], a[4:7], a[244:247], 0
    v_exp_f32 v150, v150
    v_mfma_f32_16x16x32_bf16 v[216:219], a[16:19], a[248:251], v[216:219]
    v_exp_f32 v151, v151
    v_mfma_f32_16x16x32_bf16 v[212:215], a[8:11], a[244:247], 0
    ds_read_b128 a[244:247], v224 offset:3328
    v_cvt_pk_bf16_f32 v163, v150, v151
    v_mfma_f32_16x16x32_bf16 v[212:215], a[20:23], a[248:251], v[212:215]
    ds_read_b128 a[248:251], v224 offset:3392
    ds_read_b128 v[148:151], v228 offset:1920
    v_mfma_f32_16x16x32_bf16 v[196:199], a[216:219], v[160:163], 0
    v_exp_f32 v152, v152
    v_mfma_f32_16x16x32_bf16 v[184:187], v[70:73], v[160:163], 0
    v_exp_f32 v153, v153
    v_mfma_f32_16x16x32_bf16 v[188:191], v[92:95], v[160:163], 0
    v_exp_f32 v154, v154
    v_mfma_f32_16x16x32_bf16 v[192:195], v[114:117], v[160:163], 0
    s_waitcnt lgkmcnt(6)
    v_exp_f32 v155, v155
    v_mfma_f32_16x16x32_bf16 v[176:179], v[168:171], v[252:255], v[176:179]
    s_waitcnt lgkmcnt(3)
    ds_read_b128 v[168:171], v241 offset:36864
    v_cvt_pk_bf16_f32 v160, v152, v153
    v_mfma_f32_16x16x32_bf16 v[144:147], v[42:45], v[132:135], v[144:147]
    v_cvt_pk_bf16_f32 v161, v154, v155
    v_mfma_f32_16x16x32_bf16 v[172:175], v[248:251], v[252:255], v[172:175]
    ds_read_b128 v[252:255], v240 offset:15360
    ds_read_b128 v[248:251], v241 offset:37376
    v_mfma_f32_16x16x32_bf16 v[220:223], a[24:27], a[236:239], v[220:223]
    ds_read_b128 v[152:155], v228 offset:2560
    v_mfma_f32_16x16x32_bf16 v[220:223], a[36:39], a[240:243], v[220:223]
    v_exp_f32 v156, v156
    v_mfma_f32_16x16x16_bf16 v[144:147], v[46:47], v[136:137], v[144:147]
    s_waitcnt lgkmcnt(4)
    v_exp_f32 v157, v157
    v_mfma_f32_16x16x32_bf16 v[148:151], v[18:21], v[132:135], v[148:151]
    v_exp_f32 v158, v158
    v_mfma_f32_16x16x32_bf16 v[216:219], a[28:31], a[236:239], v[216:219]
    v_exp_f32 v159, v159
    v_mfma_f32_16x16x32_bf16 v[216:219], a[40:43], a[240:243], v[216:219]
    v_cvt_pk_bf16_f32 v162, v156, v157
    v_cvt_pk_bf16_f32 v163, v158, v159
    v_mfma_f32_16x16x16_bf16 v[148:151], v[22:23], v[136:137], v[148:151]
    ds_read_b128 v[156:159], v229 offset:2560
    v_mfma_f32_16x16x32_bf16 v[196:199], a[216:219], v[160:163], v[196:199]
    v_exp_f32 v144, v144
    v_mfma_f32_16x16x32_bf16 v[184:187], v[74:77], v[160:163], v[184:187]
    v_exp_f32 v145, v145
    v_mfma_f32_16x16x32_bf16 v[188:191], v[96:99], v[160:163], v[188:191]
    v_exp_f32 v146, v146
    v_mfma_f32_16x16x32_bf16 v[192:195], v[118:121], v[160:163], v[192:195]
    s_waitcnt lgkmcnt(1)
    v_exp_f32 v147, v147
    v_mfma_f32_16x16x32_bf16 v[152:155], v[0:3], v[132:135], v[152:155]
    v_cvt_pk_bf16_f32 v160, v144, v145
    v_cvt_pk_bf16_f32 v161, v146, v147
    v_mfma_f32_16x16x32_bf16 v[212:215], a[32:35], a[236:239], v[212:215]
    ds_read_b128 a[236:239], v224 offset:3072
    ds_read_b128 v[144:147], v230 offset:2560
    v_mfma_f32_16x16x32_bf16 v[212:215], a[44:47], a[240:243], v[212:215]
    v_exp_f32 v148, v148
    v_mfma_f32_16x16x16_bf16 v[152:155], v[4:5], v[136:137], v[152:155]
    ds_read_b128 a[240:243], v224 offset:3136
    v_mfma_f32_16x16x32_bf16 v[220:223], a[48:51], a[244:247], v[220:223]
    v_exp_f32 v149, v149
    v_mfma_f32_16x16x32_bf16 v[220:223], a[60:63], a[248:251], v[220:223]
    v_exp_f32 v150, v150
    v_mfma_f32_16x16x32_bf16 v[216:219], a[52:55], a[244:247], v[216:219]
    v_exp_f32 v151, v151
    v_mfma_f32_16x16x32_bf16 v[216:219], a[64:67], a[248:251], v[216:219]
    v_cvt_pk_bf16_f32 v162, v148, v149
    v_cvt_pk_bf16_f32 v163, v150, v151
    v_mfma_f32_16x16x32_bf16 v[212:215], a[56:59], a[244:247], v[212:215]
    ds_read_b128 a[244:247], v224 offset:3200
    v_cvt_pk_bf16_f32 v24, v220, v221
    v_mfma_f32_16x16x32_bf16 v[212:215], a[68:71], a[248:251], v[212:215]
    ds_read_b128 a[248:251], v224 offset:3264
    v_cvt_pk_bf16_f32 v25, v222, v223
    v_mfma_f32_16x16x32_bf16 v[196:199], a[216:219], v[160:163], v[196:199]
    v_cvt_pk_bf16_f32 v26, v216, v217
    v_cvt_pk_bf16_f32 v27, v218, v219
    v_mfma_f32_16x16x32_bf16 v[184:187], v[78:81], v[160:163], v[184:187]
    ds_read_b128 v[148:151], v230 offset:640
    v_mfma_f32_16x16x32_bf16 v[188:191], v[100:103], v[160:163], v[188:191]
    v_cvt_pk_bf16_f32 v28, v212, v213
    v_cvt_pk_bf16_f32 v29, v214, v215
    v_mfma_f32_16x16x32_bf16 v[192:195], v[122:125], v[160:163], v[192:195]
    s_waitcnt lgkmcnt(3)
    v_exp_f32 v152, v152
    v_mfma_f32_16x16x32_bf16 v[156:159], v[24:27], v[132:135], v[156:159]
    v_exp_f32 v153, v153
    v_mfma_f32_16x16x32_bf16 v[208:211], v[168:171], a[252:255], v[208:211]
    v_exp_f32 v154, v154
    v_mfma_f32_16x16x32_bf16 v[200:203], v[168:171], v[252:255], v[200:203]
    ds_read_b128 v[168:171], v242 offset:36864
    v_cvt_pk_bf16_f32 v160, v152, v153
    v_mfma_f32_16x16x16_bf16 v[156:159], v[28:29], v[136:137], v[156:159]
    v_exp_f32 v155, v155
    v_mfma_f32_16x16x32_bf16 v[204:207], v[248:251], a[252:255], v[204:207]
    v_cvt_pk_bf16_f32 v161, v154, v155
    v_mfma_f32_16x16x32_bf16 v[180:183], v[248:251], v[252:255], v[180:183]
    ds_read_b128 v[248:251], v242 offset:37376
    ds_read_b128 v[252:255], v239 offset:17408
    v_mfma_f32_16x16x32_bf16 v[220:223], a[236:239], a[72:75], 0
    ds_read_b128 v[152:155], v230 offset:1280
    v_mfma_f32_16x16x32_bf16 v[220:223], a[240:243], a[84:87], v[220:223]
    v_exp_f32 v156, v156
    v_mfma_f32_16x16x32_bf16 v[216:219], a[236:239], a[76:79], 0
    v_exp_f32 v157, v157
    v_mfma_f32_16x16x32_bf16 v[216:219], a[240:243], a[88:91], v[216:219]
    v_exp_f32 v158, v158
    v_mfma_f32_16x16x32_bf16 v[212:215], a[236:239], a[80:83], 0
    ds_read_b128 a[236:239], v224 offset:3328
    v_cvt_pk_bf16_f32 v162, v156, v157
    v_mfma_f32_16x16x32_bf16 v[212:215], a[240:243], a[92:95], v[212:215]
    s_waitcnt lgkmcnt(4)
    ds_read_b128 a[240:243], v224 offset:3392
    v_mfma_f32_16x16x32_bf16 v[176:179], v[168:171], a[252:255], v[176:179]
    ds_read_b128 v[168:171], v241 offset:49152
    v_mfma_f32_16x16x32_bf16 v[220:223], a[244:247], a[96:99], v[220:223]
    v_exp_f32 v159, v159
    v_mfma_f32_16x16x32_bf16 v[220:223], a[248:251], a[108:111], v[220:223]
    s_waitcnt lgkmcnt(5)
    v_cvt_pk_bf16_f32 v163, v158, v159
    v_mfma_f32_16x16x32_bf16 v[172:175], v[248:251], a[252:255], v[172:175]
    ds_read_b128 a[252:255], v240 offset:16384
    ds_read_b128 v[248:251], v241 offset:49664
    v_mfma_f32_16x16x32_bf16 v[196:199], a[216:219], v[160:163], v[196:199]
    ds_read_b128 v[156:159], v230 offset:1920
    v_mfma_f32_16x16x32_bf16 v[216:219], a[244:247], a[100:103], v[216:219]
    v_mfma_f32_16x16x32_bf16 v[216:219], a[248:251], a[112:115], v[216:219]
    v_mfma_f32_16x16x32_bf16 v[212:215], a[244:247], a[104:107], v[212:215]
    ds_read_b128 a[244:247], v225 offset:42944
    v_mfma_f32_16x16x32_bf16 v[212:215], a[248:251], a[116:119], v[212:215]
    s_waitcnt lgkmcnt(6)
    ds_read_b128 a[248:251], v225 offset:43008
    v_mfma_f32_16x16x32_bf16 v[220:223], a[236:239], a[120:123], v[220:223]
    s_waitcnt lgkmcnt(6)
    v_rcp_f32 v197, v196
    v_mfma_f32_16x16x32_bf16 v[220:223], a[240:243], a[132:135], v[220:223]
    v_max3_f32 v236, v236, v196, v197
    v_mfma_f32_16x16x32_bf16 v[216:219], a[236:239], a[124:127], v[216:219]
    v_mfma_f32_16x16x32_bf16 v[216:219], a[240:243], a[136:139], v[216:219]
    v_mfma_f32_16x16x32_bf16 v[212:215], a[236:239], a[128:131], v[212:215]
    ds_read_b128 a[236:239], v225 offset:43072
    v_mfma_f32_16x16x32_bf16 v[212:215], a[240:243], a[140:143], v[212:215]
    s_waitcnt lgkmcnt(4)
    ds_read_b128 a[240:243], v225 offset:43136
    v_mfma_f32_16x16x32_bf16 v[208:211], v[168:171], v[164:167], v[208:211]
    v_cvt_pk_bf16_f32 v68, v220, v221
    v_cvt_pk_bf16_f32 v69, v222, v223
    v_mfma_f32_16x16x32_bf16 v[200:203], v[168:171], a[252:255], v[200:203]
    v_cvt_pk_bf16_f32 v90, v216, v217
    v_cvt_pk_bf16_f32 v91, v218, v219
    v_mfma_f32_16x16x32_bf16 v[184:187], v[66:69], v[160:163], v[184:187]
    v_cvt_pk_bf16_f32 v112, v212, v213
    v_cvt_pk_bf16_f32 v113, v214, v215
    v_mfma_f32_16x16x32_bf16 v[188:191], v[88:91], v[160:163], v[188:191]
    ds_read_b128 v[168:171], v242 offset:49152
    v_mfma_f32_16x16x32_bf16 v[192:195], v[110:113], v[160:163], v[192:195]
    v_mfma_f32_16x16x32_bf16 v[204:207], v[248:251], v[164:167], v[204:207]
    v_mfma_f32_16x16x32_bf16 v[180:183], v[248:251], a[252:255], v[180:183]
    s_waitcnt lgkmcnt(3)
    ds_read_b128 v[248:251], v242 offset:49664
    v_mul_f32 v184, v184, v197
    v_mfma_f32_16x16x32_bf16 v[220:223], a[144:147], a[244:247], 0
    v_mul_f32 v185, v185, v197
    v_cvt_pk_bf16_f32 v184, v184, v185
    v_mfma_f32_16x16x32_bf16 v[220:223], a[156:159], a[248:251], v[220:223]
    v_mul_f32 v186, v186, v197
    v_mul_f32 v187, v187, v197
    v_mfma_f32_16x16x32_bf16 v[216:219], a[148:151], a[244:247], 0
    v_cvt_pk_bf16_f32 v185, v186, v187
    v_mul_f32 v188, v188, v197
    v_mfma_f32_16x16x32_bf16 v[216:219], a[160:163], a[248:251], v[216:219]
    v_mul_f32 v189, v189, v197
    v_cvt_pk_bf16_f32 v186, v188, v189
    v_mfma_f32_16x16x32_bf16 v[212:215], a[152:155], a[244:247], 0
    ds_read_b128 a[244:247], v225 offset:43200
    v_mul_f32 v190, v190, v197
    v_mfma_f32_16x16x32_bf16 v[212:215], a[164:167], a[248:251], v[212:215]
    s_waitcnt lgkmcnt(2)
    ds_read_b128 a[248:251], v225 offset:43264
    v_mul_f32 v191, v191, v197
    v_mfma_f32_16x16x32_bf16 v[176:179], v[168:171], v[164:167], v[176:179]
    ds_read_b128 v[168:171], v241 offset:61440
    v_cvt_pk_bf16_f32 v187, v190, v191
    v_mfma_f32_16x16x32_bf16 v[220:223], a[168:171], a[236:239], v[220:223]
    v_mul_f32 v192, v192, v197
    v_mul_f32 v193, v193, v197
    v_mfma_f32_16x16x32_bf16 v[220:223], a[180:183], a[240:243], v[220:223]
    s_waitcnt lgkmcnt(3)
    v_cvt_pk_bf16_f32 v188, v192, v193
    v_mul_f32 v194, v194, v197
    v_mfma_f32_16x16x32_bf16 v[172:175], v[248:251], v[164:167], v[172:175]
    ds_read_b128 v[164:167], v240 offset:17408
    ds_read_b128 v[248:251], v241 offset:61952
    v_mfma_f32_16x16x32_bf16 v[216:219], a[172:175], a[236:239], v[216:219]
    v_mul_f32 v195, v195, v197
    v_cvt_pk_bf16_f32 v189, v194, v195
    v_mfma_f32_16x16x32_bf16 v[216:219], a[184:187], a[240:243], v[216:219]
    v_cndmask_b32 v225, v243, v245, vcc
    v_mfma_f32_16x16x32_bf16 v[212:215], a[176:179], a[236:239], v[212:215]
    v_mfma_f32_16x16x32_bf16 v[212:215], a[188:191], a[240:243], v[212:215]
    s_waitcnt lgkmcnt(4)
    v_mfma_f32_16x16x32_bf16 v[220:223], a[192:195], a[244:247], v[220:223]
    s_waitcnt lgkmcnt(3)
    v_mfma_f32_16x16x32_bf16 v[220:223], a[204:207], a[248:251], v[220:223]
    v_mfma_f32_16x16x32_bf16 v[216:219], a[196:199], a[244:247], v[216:219]
    s_waitcnt vmcnt(0) lgkmcnt(1)
    v_mfma_f32_16x16x32_bf16 v[216:219], a[208:211], a[248:251], v[216:219]
    s_barrier
    ds_read_b128 a[236:239], v227 offset:6144
    v_mfma_f32_16x16x32_bf16 v[212:215], a[200:203], a[244:247], v[212:215]
    ds_read_b128 a[240:243], v227 offset:6208
    ds_read_b128 a[244:247], v227 offset:6272
    v_mfma_f32_16x16x32_bf16 v[212:215], a[212:215], a[248:251], v[212:215]
    v_mul_f32 v220, s37, v220
    v_mul_f32 v221, s37, v221
    v_mfma_f32_16x16x32_bf16 v[208:211], v[168:171], v[252:255], v[208:211]
    v_mul_f32 v222, s37, v222
    v_mul_f32 v223, s37, v223
    v_mfma_f32_16x16x32_bf16 v[200:203], v[168:171], v[164:167], v[200:203]
    s_waitcnt lgkmcnt(3)
    v_cvt_pk_bf16_f32 v138, v220, v221
    v_cvt_pk_bf16_f32 v139, v222, v223
    v_mfma_f32_16x16x32_bf16 v[204:207], v[248:251], v[252:255], v[204:207]
    v_mul_f32 v216, s37, v216
    v_mul_f32 v217, s37, v217
    v_mfma_f32_16x16x32_bf16 v[180:183], v[248:251], v[164:167], v[180:183]
    v_mul_f32 v218, s37, v218
    v_mul_f32 v219, s37, v219
    v_cvt_pk_bf16_f32 v140, v216, v217
    v_cvt_pk_bf16_f32 v141, v218, v219
    v_mul_f32 v212, s37, v212
    v_mul_f32 v213, s37, v213
    v_mfma_f32_16x16x32_bf16 v[144:147], v[24:27], v[138:141], v[144:147]
    v_mul_f32 v214, s37, v214
    v_mul_f32 v215, s37, v215
    v_mfma_f32_16x16x32_bf16 v[148:151], v[30:33], v[138:141], v[148:151]
    v_cvt_pk_bf16_f32 v142, v212, v213
    v_cvt_pk_bf16_f32 v143, v214, v215
    v_mfma_f32_16x16x32_bf16 v[152:155], v[36:39], v[138:141], v[152:155]
    ds_read_b128 a[248:251], v227 offset:6336
    ds_read_b128 v[168:171], v242 offset:61440
    v_mfma_f32_16x16x16_bf16 v[144:147], v[28:29], v[142:143], v[144:147]
    ds_read_b128 v[248:251], v242 offset:61952
    v_cvt_pk_bf16_f32 v208, v208, v209
    v_mfma_f32_16x16x16_bf16 v[148:151], v[34:35], v[142:143], v[148:151]
    v_cvt_pk_bf16_f32 v209, v210, v211
    v_cvt_pk_bf16_f32 v210, v204, v205
    v_mfma_f32_16x16x16_bf16 v[152:155], v[40:41], v[142:143], v[152:155]
    v_cvt_pk_bf16_f32 v211, v206, v207
    v_cvt_pk_bf16_f32 v200, v200, v201
    v_mfma_f32_16x16x32_bf16 v[156:159], v[42:45], v[138:141], v[156:159]
    s_waitcnt lgkmcnt(3)
    buffer_store_dwordx4 v[208:211], v243, s[20:23], s51 offen sc0 sc1
    v_mfma_f32_16x16x32_bf16 v[220:223], a[0:3], a[236:239], 0
    ds_read_b128 a[252:255], v239
    v_cvt_pk_bf16_f32 v201, v202, v203
    v_mfma_f32_16x16x32_bf16 v[220:223], a[12:15], a[240:243], v[220:223]
    v_cvt_pk_bf16_f32 v202, v180, v181
    v_cvt_pk_bf16_f32 v203, v182, v183
    v_mfma_f32_16x16x16_bf16 v[156:159], v[46:47], v[142:143], v[156:159]
    s_waitcnt lgkmcnt(2)
    ds_write_b128 v237, v[184:187] offset:12288
    v_mfma_f32_16x16x32_bf16 v[176:179], v[168:171], v[252:255], v[176:179]
    s_waitcnt lgkmcnt(2)
    ds_write_b64 v238, v[188:189] offset:12288
    v_mfma_f32_16x16x32_bf16 v[172:175], v[248:251], v[252:255], v[172:175]
L_pg7:
    s_cbranch_execz L_back
    v_exp_f32 v144, v144
    v_mfma_f32_16x16x32_bf16 v[216:219], a[4:7], a[236:239], 0
    v_exp_f32 v145, v145
    v_mfma_f32_16x16x32_bf16 v[216:219], a[16:19], a[240:243], v[216:219]
    v_exp_f32 v146, v146
    v_mfma_f32_16x16x32_bf16 v[212:215], a[8:11], a[236:239], 0
    ds_read_b128 a[236:239], v227 offset:6400
    v_cvt_pk_bf16_f32 v176, v176, v177
    v_mfma_f32_16x16x32_bf16 v[212:215], a[20:23], a[240:243], v[212:215]
    ds_read_b128 a[240:243], v227 offset:6464
    v_cvt_pk_bf16_f32 v177, v178, v179
    v_mfma_f32_16x16x32_bf16 v[220:223], a[24:27], a[244:247], v[220:223]
    v_cvt_pk_bf16_f32 v178, v172, v173
    v_cvt_pk_bf16_f32 v179, v174, v175
    v_mfma_f32_16x16x32_bf16 v[220:223], a[36:39], a[248:251], v[220:223]
    buffer_store_dwordx4 v[200:203], v245, s[20:23], s51 offen sc0 sc1
    v_mfma_f32_16x16x32_bf16 v[216:219], a[28:31], a[244:247], v[216:219]
    ds_read_b128 v[252:255], v240
    ds_read_b128 v[164:167], v239 offset:1024
    v_mfma_f32_16x16x32_bf16 v[216:219], a[40:43], a[248:251], v[216:219]
    ds_read_b128 v[168:171], v241 offset:12288
    v_cvt_pk_bf16_f32 v160, v144, v145
    v_mfma_f32_16x16x32_bf16 v[212:215], a[32:35], a[244:247], v[212:215]
    ds_read_b128 a[244:247], v227 offset:6144
    v_mfma_f32_16x16x32_bf16 v[212:215], a[44:47], a[248:251], v[212:215]
    s_waitcnt lgkmcnt(5)
    ds_read_b128 a[248:251], v227 offset:6208
    v_mfma_f32_16x16x32_bf16 v[220:223], a[48:51], a[236:239], v[220:223]
    s_waitcnt lgkmcnt(5)
    ds_read_b128 v[248:251], v241 offset:12800
    v_mfma_f32_16x16x32_bf16 v[220:223], a[60:63], a[240:243], v[220:223]
    v_exp_f32 v147, v147
    v_mfma_f32_16x16x32_bf16 v[216:219], a[52:55], a[236:239], v[216:219]
    v_cvt_pk_bf16_f32 v161, v146, v147
    v_mfma_f32_16x16x32_bf16 v[216:219], a[64:67], a[240:243], v[216:219]
    ds_read_b128 v[144:147], v235
    v_bfe_u32 v235, s71, v233, 4
    v_mfma_f32_16x16x32_bf16 v[212:215], a[56:59], a[236:239], v[212:215]
    ds_read_b128 a[236:239], v227 offset:6272
    v_cvt_pk_bf16_f32 v54, v220, v221
    v_mfma_f32_16x16x32_bf16 v[212:215], a[68:71], a[240:243], v[212:215]
    ds_read_b128 a[240:243], v227 offset:6336
    v_cvt_pk_bf16_f32 v55, v222, v223
    v_mfma_f32_16x16x32_bf16 v[208:211], a[220:223], a[252:255], 0
    s_waitcnt lgkmcnt(8)
    v_cvt_pk_bf16_f32 v56, v216, v217
    v_cvt_pk_bf16_f32 v57, v218, v219
    v_mfma_f32_16x16x32_bf16 v[200:203], a[220:223], v[252:255], 0
    buffer_store_dwordx4 v[176:179], v244, s[20:23], s51 offen sc0 sc1
    v_mfma_f32_16x16x32_bf16 v[204:207], a[224:227], a[252:255], 0
    s_add_u32 s51, s51, s48
    v_cvt_pk_bf16_f32 v58, v212, v213
    v_cvt_pk_bf16_f32 v59, v214, v215
    v_mfma_f32_16x16x32_bf16 v[180:183], a[224:227], v[252:255], 0
    ds_read_b128 v[252:255], v239 offset:2048
    v_mad_u32_u24 v235, v235, s40, v231
    v_mfma_f32_16x16x32_bf16 v[176:179], a[228:231], a[252:255], 0
    v_exp_f32 v148, v148
    v_mfma_f32_16x16x32_bf16 v[172:175], a[232:235], a[252:255], 0
    s_waitcnt lgkmcnt(3)
    ds_read_b128 a[252:255], v240 offset:1024
    v_mfma_f32_16x16x32_bf16 v[144:147], v[48:51], v[138:141], v[144:147]
    v_exp_f32 v149, v149
    v_mfma_f32_16x16x32_bf16 v[220:223], a[244:247], a[72:75], 0
    v_exp_f32 v150, v150
    v_mfma_f32_16x16x32_bf16 v[220:223], a[248:251], a[84:87], v[220:223]
    v_exp_f32 v151, v151
    v_mfma_f32_16x16x32_bf16 v[216:219], a[244:247], a[76:79], 0
    v_cvt_pk_bf16_f32 v162, v148, v149
    v_cvt_pk_bf16_f32 v163, v150, v151
    v_mfma_f32_16x16x32_bf16 v[216:219], a[248:251], a[88:91], v[216:219]
    ds_read_b128 v[148:151], v234
    v_bfe_u32 v234, s69, v233, 4
    v_mfma_f32_16x16x32_bf16 v[196:199], a[216:219], v[160:163], 0
    v_mad_u32_u24 v234, v234, s40, v231
    v_mfma_f32_16x16x32_bf16 v[184:187], v[68:71], v[160:163], 0
    v_exp_f32 v152, v152
    v_mfma_f32_16x16x32_bf16 v[188:191], v[90:93], v[160:163], 0
    v_exp_f32 v153, v153
    v_mfma_f32_16x16x32_bf16 v[192:195], v[112:115], v[160:163], 0
    v_exp_f32 v154, v154
    v_mfma_f32_16x16x16_bf16 v[144:147], v[52:53], v[142:143], v[144:147]
    v_exp_f32 v155, v155
    v_mfma_f32_16x16x32_bf16 v[212:215], a[244:247], a[80:83], 0
    ds_read_b128 a[244:247], v227 offset:6400
    v_cvt_pk_bf16_f32 v160, v152, v153
    v_mfma_f32_16x16x32_bf16 v[212:215], a[248:251], a[92:95], v[212:215]
    s_waitcnt lgkmcnt(2)
    ds_read_b128 a[248:251], v227 offset:6464
    v_cndmask_b32 v227, v240, v239, vcc
    v_mfma_f32_16x16x32_bf16 v[220:223], a[236:239], a[96:99], v[220:223]
    v_cvt_pk_bf16_f32 v161, v154, v155
    v_mfma_f32_16x16x32_bf16 v[220:223], a[240:243], a[108:111], v[220:223]
    s_waitcnt lgkmcnt(2)
    ds_read_b128 v[152:155], v235
    v_bfe_u32 v235, s70, v233, 4
    v_mfma_f32_16x16x32_bf16 v[148:151], v[54:57], v[138:141], v[148:151]
    v_mad_u32_u24 v235, v235, s40, v231
    v_mfma_f32_16x16x32_bf16 v[216:219], a[236:239], a[100:103], v[216:219]
    v_exp_f32 v156, v156
    v_mfma_f32_16x16x32_bf16 v[216:219], a[240:243], a[112:115], v[216:219]
    v_exp_f32 v157, v157
    v_mfma_f32_16x16x32_bf16 v[212:215], a[236:239], a[104:107], v[212:215]
    ds_read_b128 a[236:239], v226 offset:1152
    v_cvt_pk_bf16_f32 v162, v156, v157
    v_mfma_f32_16x16x32_bf16 v[212:215], a[240:243], a[116:119], v[212:215]
    ds_read_b128 a[240:243], v226 offset:1216
    v_mfma_f32_16x16x16_bf16 v[148:151], v[58:59], v[142:143], v[148:151]
    s_waitcnt lgkmcnt(4)
    v_exp_f32 v158, v158
    v_mfma_f32_16x16x32_bf16 v[220:223], a[244:247], a[120:123], v[220:223]
    s_waitcnt lgkmcnt(3)
    v_exp_f32 v159, v159
    v_mfma_f32_16x16x32_bf16 v[220:223], a[248:251], a[132:135], v[220:223]
    s_waitcnt lgkmcnt(2)
    v_cvt_pk_bf16_f32 v163, v158, v159
    v_mfma_f32_16x16x32_bf16 v[152:155], v[60:63], v[138:141], v[152:155]
    ds_read_b128 v[156:159], v228 offset:640
    v_mfma_f32_16x16x32_bf16 v[196:199], a[216:219], v[160:163], v[196:199]
    v_exp_f32 v144, v144
    v_mfma_f32_16x16x32_bf16 v[184:187], v[76:79], v[160:163], v[184:187]
    v_exp_f32 v145, v145
    v_mfma_f32_16x16x32_bf16 v[188:191], v[98:101], v[160:163], v[188:191]
    v_cvt_pk_bf16_f32 v84, v220, v221
    v_cvt_pk_bf16_f32 v85, v222, v223
    v_mfma_f32_16x16x32_bf16 v[192:195], v[120:123], v[160:163], v[192:195]
    v_exp_f32 v146, v146
    v_mfma_f32_16x16x16_bf16 v[152:155], v[64:65], v[142:143], v[152:155]
    v_exp_f32 v147, v147
    v_mfma_f32_16x16x32_bf16 v[216:219], a[244:247], a[124:127], v[216:219]
    v_cvt_pk_bf16_f32 v160, v144, v145
    v_cvt_pk_bf16_f32 v161, v146, v147
    v_mfma_f32_16x16x32_bf16 v[216:219], a[248:251], a[136:139], v[216:219]
    ds_read_b128 v[144:147], v229 offset:640
    v_mfma_f32_16x16x16_bf16 v[196:199], a[216:217], v[160:161], v[196:199]
    v_exp_f32 v148, v148
    v_mfma_f32_16x16x16_bf16 v[184:187], v[82:83], v[160:161], v[184:187]
    v_exp_f32 v149, v149
    v_mfma_f32_16x16x16_bf16 v[188:191], v[104:105], v[160:161], v[188:191]
    v_exp_f32 v150, v150
    v_mfma_f32_16x16x16_bf16 v[192:195], v[126:127], v[160:161], v[192:195]
    v_cvt_pk_bf16_f32 v106, v216, v217
    v_cvt_pk_bf16_f32 v107, v218, v219
    v_mfma_f32_16x16x32_bf16 v[212:215], a[244:247], a[128:131], v[212:215]
    ds_read_b128 a[244:247], v226 offset:1280
    v_cvt_pk_bf16_f32 v160, v148, v149
    v_mfma_f32_16x16x32_bf16 v[212:215], a[248:251], a[140:143], v[212:215]
    s_waitcnt lgkmcnt(2)
    ds_read_b128 a[248:251], v226 offset:1344
    v_mfma_f32_16x16x32_bf16 v[220:223], a[144:147], a[236:239], 0
    v_exp_f32 v151, v151
    v_mfma_f32_16x16x32_bf16 v[220:223], a[156:159], a[240:243], v[220:223]
    v_cvt_pk_bf16_f32 v161, v150, v151
    v_mfma_f32_16x16x32_bf16 v[216:219], a[148:151], a[236:239], 0
    ds_read_b128 v[148:151], v229 offset:1280
    v_mfma_f32_16x16x32_bf16 v[216:219], a[160:163], a[240:243], v[216:219]
    v_cvt_pk_bf16_f32 v128, v212, v213
    v_cvt_pk_bf16_f32 v129, v214, v215
    v_mfma_f32_16x16x32_bf16 v[212:215], a[152:155], a[236:239], 0
    ds_read_b128 a[236:239], v226 offset:1408
    v_mfma_f32_16x16x32_bf16 v[212:215], a[164:167], a[240:243], v[212:215]
    ds_read_b128 a[240:243], v226 offset:1472
    v_mfma_f32_16x16x32_bf16 v[208:211], v[168:171], v[164:167], v[208:211]
    s_waitcnt lgkmcnt(4)
    v_exp_f32 v152, v152
    v_mfma_f32_16x16x32_bf16 v[220:223], a[168:171], a[244:247], v[220:223]
    s_waitcnt lgkmcnt(3)
    v_exp_f32 v153, v153
    v_mfma_f32_16x16x32_bf16 v[220:223], a[180:183], a[248:251], v[220:223]
    v_exp_f32 v154, v154
    v_mfma_f32_16x16x32_bf16 v[216:219], a[172:175], a[244:247], v[216:219]
    v_exp_f32 v155, v155
    v_mfma_f32_16x16x32_bf16 v[216:219], a[184:187], a[248:251], v[216:219]
    v_cvt_pk_bf16_f32 v162, v152, v153
    v_cvt_pk_bf16_f32 v163, v154, v155
    v_mfma_f32_16x16x32_bf16 v[212:215], a[176:179], a[244:247], v[212:215]
    ds_read_b128 a[244:247], v224 offset:15488
    ds_read_b128 v[152:155], v228 offset:1280
    v_mfma_f32_16x16x32_bf16 v[212:215], a[188:191], a[248:251], v[212:215]
    v_mfma_f32_16x16x32_bf16 v[196:199], a[216:219], v[160:163], v[196:199]
    ds_read_b128 a[248:251], v224 offset:15552
    v_mfma_f32_16x16x32_bf16 v[184:187], v[84:87], v[160:163], v[184:187]
    v_mfma_f32_16x16x32_bf16 v[188:191], v[106:109], v[160:163], v[188:191]
    v_mfma_f32_16x16x32_bf16 v[192:195], v[128:131], v[160:163], v[192:195]
    s_waitcnt lgkmcnt(3)
    v_mfma_f32_16x16x32_bf16 v[220:223], a[192:195], a[236:239], v[220:223]
    v_mfma_f32_16x16x32_bf16 v[220:223], a[204:207], a[240:243], v[220:223]
    v_mfma_f32_16x16x32_bf16 v[216:219], a[196:199], a[236:239], v[216:219]
    v_mfma_f32_16x16x32_bf16 v[216:219], a[208:211], a[240:243], v[216:219]
    v_rcp_f32 v197, v196
    v_mfma_f32_16x16x32_bf16 v[212:215], a[200:203], a[236:239], v[212:215]
    ds_read_b128 a[236:239], v224 offset:15616
    v_mul_f32 v184, v184, v197
    v_mfma_f32_16x16x32_bf16 v[212:215], a[212:215], a[240:243], v[212:215]
    ds_read_b128 a[240:243], v224 offset:15680
    v_mul_f32 v220, s37, v220
    v_mfma_f32_16x16x32_bf16 v[200:203], v[168:171], a[252:255], v[200:203]
    v_mul_f32 v221, s37, v221
    v_mul_f32 v222, s37, v222
    v_mfma_f32_16x16x32_bf16 v[204:207], v[248:251], v[164:167], v[204:207]
    v_mul_f32 v223, s37, v223
    v_cvt_pk_bf16_f32 v132, v220, v221
    v_mfma_f32_16x16x32_bf16 v[180:183], v[248:251], a[252:255], v[180:183]
    s_waitcnt lgkmcnt(2)
    v_cvt_pk_bf16_f32 v133, v222, v223
    v_mul_f32 v216, s37, v216
    v_mfma_f32_16x16x32_bf16 v[220:223], a[0:3], a[244:247], 0
    v_mul_f32 v217, s37, v217
    v_mul_f32 v218, s37, v218
    v_mfma_f32_16x16x32_bf16 v[220:223], a[12:15], a[248:251], v[220:223]
    v_mul_f32 v219, s37, v219
    v_cvt_pk_bf16_f32 v134, v216, v217
    v_cvt_pk_bf16_f32 v135, v218, v219
    v_mfma_f32_16x16x32_bf16 v[216:219], a[4:7], a[244:247], 0
    v_mul_f32 v212, s37, v212
    v_mul_f32 v213, s37, v213
    v_mfma_f32_16x16x32_bf16 v[216:219], a[16:19], a[248:251], v[216:219]
    v_mul_f32 v214, s37, v214
    v_mul_f32 v215, s37, v215
    v_mfma_f32_16x16x32_bf16 v[156:159], v[12:15], v[132:135], v[156:159]
    v_cvt_pk_bf16_f32 v136, v212, v213
    v_cvt_pk_bf16_f32 v137, v214, v215
    v_mfma_f32_16x16x32_bf16 v[144:147], v[36:39], v[132:135], v[144:147]
    v_mul_f32 v185, v185, v197
    v_cvt_pk_bf16_f32 v184, v184, v185
    v_mfma_f32_16x16x32_bf16 v[148:151], v[42:45], v[132:135], v[148:151]
    v_mul_f32 v186, v186, v197
    v_mul_f32 v187, v187, v197
    v_mfma_f32_16x16x16_bf16 v[156:159], v[16:17], v[136:137], v[156:159]
    v_cvt_pk_bf16_f32 v185, v186, v187
    v_mul_f32 v188, v188, v197
    v_mfma_f32_16x16x16_bf16 v[144:147], v[40:41], v[136:137], v[144:147]
    v_mul_f32 v189, v189, v197
    v_cvt_pk_bf16_f32 v186, v188, v189
    v_mfma_f32_16x16x16_bf16 v[148:151], v[46:47], v[136:137], v[148:151]
    v_mul_f32 v190, v190, v197
    v_mul_f32 v191, v191, v197
    v_mfma_f32_16x16x32_bf16 v[152:155], v[18:21], v[132:135], v[152:155]
    v_cvt_pk_bf16_f32 v187, v190, v191
    v_mul_f32 v192, v192, v197
    v_mfma_f32_16x16x32_bf16 v[212:215], a[8:11], a[244:247], 0
    ds_read_b128 a[244:247], v224 offset:15744
    v_mul_f32 v193, v193, v197
    v_mfma_f32_16x16x32_bf16 v[212:215], a[20:23], a[248:251], v[212:215]
    ds_read_b128 a[248:251], v224 offset:15808
    v_cvt_pk_bf16_f32 v188, v192, v193
    v_mfma_f32_16x16x16_bf16 v[152:155], v[22:23], v[136:137], v[152:155]
    s_waitcnt lgkmcnt(2)
    v_mul_f32 v194, v194, v197
    v_mul_f32 v195, v195, v197
    v_mfma_f32_16x16x32_bf16 v[220:223], a[24:27], a[236:239], v[220:223]
    v_cvt_pk_bf16_f32 v189, v194, v195
    v_max3_f32 v236, v236, v196, v197
    v_mfma_f32_16x16x32_bf16 v[220:223], a[36:39], a[240:243], v[220:223]
    ds_write_b128 v237, v[184:187] offset:18432
    v_mfma_f32_16x16x32_bf16 v[216:219], a[28:31], a[236:239], v[216:219]
    ds_write_b64 v238, v[188:189] offset:18432
    v_mfma_f32_16x16x32_bf16 v[216:219], a[40:43], a[240:243], v[216:219]
    v_exp_f32 v156, v156
    v_mfma_f32_16x16x32_bf16 v[212:215], a[32:35], a[236:239], v[212:215]
    v_exp_f32 v157, v157
    v_mfma_f32_16x16x32_bf16 v[212:215], a[44:47], a[240:243], v[212:215]
    s_waitcnt lgkmcnt(3)
    v_exp_f32 v158, v158
    v_mfma_f32_16x16x32_bf16 v[220:223], a[48:51], a[244:247], v[220:223]
    s_waitcnt lgkmcnt(2)
    ds_read_b128 a[236:239], v224 offset:15488
    ds_read_b128 a[240:243], v224 offset:15552
    v_mfma_f32_16x16x32_bf16 v[220:223], a[60:63], a[248:251], v[220:223]
    ds_read_b128 v[168:171], v242 offset:12288
    v_cvt_pk_bf16_f32 v160, v156, v157
    v_mfma_f32_16x16x32_bf16 v[216:219], a[52:55], a[244:247], v[216:219]
    ds_read_b128 v[248:251], v242 offset:12800
    v_mfma_f32_16x16x32_bf16 v[216:219], a[64:67], a[248:251], v[216:219]
    ds_read_b128 a[252:255], v239 offset:3072
    v_mfma_f32_16x16x32_bf16 v[212:215], a[56:59], a[244:247], v[212:215]
    ds_read_b128 a[244:247], v224 offset:15616
    v_cvt_pk_bf16_f32 v6, v220, v221
    v_mfma_f32_16x16x32_bf16 v[212:215], a[68:71], a[248:251], v[212:215]
    s_waitcnt lgkmcnt(5)
    v_cvt_pk_bf16_f32 v7, v222, v223
    ds_read_b128 a[248:251], v224 offset:15680
    v_exp_f32 v159, v159
    v_cvt_pk_bf16_f32 v8, v216, v217
    v_cvt_pk_bf16_f32 v9, v218, v219
    v_cvt_pk_bf16_f32 v161, v158, v159
    ds_read_b128 v[156:159], v228 offset:1920
    v_mfma_f32_16x16x32_bf16 v[220:223], a[236:239], a[72:75], 0
    s_waitcnt lgkmcnt(6)
    v_cvt_pk_bf16_f32 v10, v212, v213
    v_cvt_pk_bf16_f32 v11, v214, v215
    v_mfma_f32_16x16x32_bf16 v[220:223], a[240:243], a[84:87], v[220:223]
    s_waitcnt lgkmcnt(5)
    v_exp_f32 v144, v144
    v_mfma_f32_16x16x32_bf16 v[176:179], v[168:171], v[164:167], v[176:179]
    s_waitcnt lgkmcnt(4)
    ds_read_b128 v[168:171], v241 offset:24576
    v_mfma_f32_16x16x32_bf16 v[172:175], v[248:251], v[164:167], v[172:175]
    ds_read_b128 v[164:167], v240 offset:2048
    ds_read_b128 v[248:251], v241 offset:25088
    v_mfma_f32_16x16x32_bf16 v[216:219], a[236:239], a[76:79], 0
    v_exp_f32 v145, v145
    v_mfma_f32_16x16x32_bf16 v[216:219], a[240:243], a[88:91], v[216:219]
    v_exp_f32 v146, v146
    v_mfma_f32_16x16x32_bf16 v[212:215], a[236:239], a[80:83], 0
    ds_read_b128 a[236:239], v224 offset:15744
    v_cvt_pk_bf16_f32 v162, v144, v145
    v_mfma_f32_16x16x32_bf16 v[212:215], a[240:243], a[92:95], v[212:215]
    s_waitcnt lgkmcnt(5)
    ds_read_b128 a[240:243], v224 offset:15808
    v_mfma_f32_16x16x32_bf16 v[220:223], a[244:247], a[96:99], v[220:223]
    v_exp_f32 v147, v147
    v_mfma_f32_16x16x32_bf16 v[220:223], a[248:251], a[108:111], v[220:223]
    s_waitcnt lgkmcnt(5)
    v_cvt_pk_bf16_f32 v163, v146, v147
    v_mfma_f32_16x16x32_bf16 v[156:159], v[0:3], v[132:135], v[156:159]
    ds_read_b128 v[144:147], v229 offset:1920
    v_mfma_f32_16x16x32_bf16 v[196:199], a[216:219], v[160:163], 0
    v_exp_f32 v148, v148
    v_mfma_f32_16x16x32_bf16 v[184:187], v[74:77], v[160:163], 0
    v_exp_f32 v149, v149
    v_mfma_f32_16x16x32_bf16 v[188:191], v[96:99], v[160:163], 0
    v_exp_f32 v150, v150
    v_mfma_f32_16x16x32_bf16 v[192:195], v[118:121], v[160:163], 0
    v_exp_f32 v151, v151
    v_mfma_f32_16x16x16_bf16 v[156:159], v[4:5], v[136:137], v[156:159]
    s_waitcnt lgkmcnt(3)
    v_mov_b32 v5, s25
    v_cvt_pk_bf16_f32 v160, v148, v149
    v_mfma_f32_16x16x32_bf16 v[208:211], v[168:171], v[252:255], v[208:211]
    v_cvt_pk_bf16_f32 v161, v150, v151
    v_mfma_f32_16x16x32_bf16 v[200:203], v[168:171], v[164:167], v[200:203]
    ds_read_b128 v[168:171], v242 offset:24576
    ds_read_b128 v[148:151], v229 offset:2560
    v_mfma_f32_16x16x32_bf16 v[204:207], v[248:251], v[252:255], v[204:207]
    s_waitcnt lgkmcnt(2)
    v_exp_f32 v152, v152
    v_mfma_f32_16x16x32_bf16 v[144:147], v[24:27], v[132:135], v[144:147]
    v_exp_f32 v153, v153
    v_mfma_f32_16x16x32_bf16 v[180:183], v[248:251], v[164:167], v[180:183]
    ds_read_b128 v[248:251], v242 offset:25088
    ds_read_b128 v[164:167], v239 offset:4096
    v_mfma_f32_16x16x32_bf16 v[216:219], a[244:247], a[100:103], v[216:219]
    v_exp_f32 v154, v154
    v_mfma_f32_16x16x32_bf16 v[216:219], a[248:251], a[112:115], v[216:219]
    v_exp_f32 v155, v155
    v_mfma_f32_16x16x16_bf16 v[144:147], v[28:29], v[136:137], v[144:147]
    v_cvt_pk_bf16_f32 v162, v152, v153
    v_cvt_pk_bf16_f32 v163, v154, v155
    v_mfma_f32_16x16x32_bf16 v[212:215], a[244:247], a[104:107], v[212:215]
    ds_read_b128 a[244:247], v224 offset:18560
    ds_read_b128 v[152:155], v228 offset:2560
    v_mfma_f32_16x16x32_bf16 v[212:215], a[248:251], a[116:119], v[212:215]
    v_exp_f32 v156, v156
    v_mfma_f32_16x16x32_bf16 v[196:199], a[216:219], v[160:163], v[196:199]
    ds_read_b128 a[248:251], v224 offset:18624
    v_mfma_f32_16x16x32_bf16 v[184:187], v[78:81], v[160:163], v[184:187]
    v_exp_f32 v157, v157
    v_mfma_f32_16x16x32_bf16 v[188:191], v[100:103], v[160:163], v[188:191]
    v_exp_f32 v158, v158
    v_mfma_f32_16x16x32_bf16 v[192:195], v[122:125], v[160:163], v[192:195]
    s_waitcnt lgkmcnt(5)
    v_exp_f32 v159, v159
    v_mfma_f32_16x16x32_bf16 v[176:179], v[168:171], v[252:255], v[176:179]
    s_waitcnt lgkmcnt(4)
    ds_read_b128 v[168:171], v241 offset:36864
    v_cvt_pk_bf16_f32 v160, v156, v157
    v_mfma_f32_16x16x32_bf16 v[172:175], v[248:251], v[252:255], v[172:175]
    ds_read_b128 v[252:255], v240 offset:3072
    ds_read_b128 v[248:251], v241 offset:37376
    v_mfma_f32_16x16x32_bf16 v[220:223], a[236:239], a[120:123], v[220:223]
    v_cvt_pk_bf16_f32 v161, v158, v159
    v_mfma_f32_16x16x32_bf16 v[220:223], a[240:243], a[132:135], v[220:223]
    s_waitcnt lgkmcnt(4)
    ds_read_b128 v[156:159], v230 offset:640
    v_mfma_f32_16x16x32_bf16 v[152:155], v[6:9], v[132:135], v[152:155]
    v_exp_f32 v144, v144
    v_mfma_f32_16x16x32_bf16 v[216:219], a[236:239], a[124:127], v[216:219]
    v_exp_f32 v145, v145
    v_mfma_f32_16x16x32_bf16 v[216:219], a[240:243], a[136:139], v[216:219]
    v_exp_f32 v146, v146
    v_mfma_f32_16x16x32_bf16 v[212:215], a[236:239], a[128:131], v[212:215]
    v_cvt_pk_bf16_f32 v72, v220, v221
    v_cvt_pk_bf16_f32 v73, v222, v223
    v_mfma_f32_16x16x32_bf16 v[212:215], a[240:243], a[140:143], v[212:215]
    ds_read_b128 a[236:239], v224 offset:18688
    ds_read_b128 a[240:243], v224 offset:18752
    v_mfma_f32_16x16x16_bf16 v[152:155], v[10:11], v[136:137], v[152:155]
    s_waitcnt lgkmcnt(5)
    v_cvt_pk_bf16_f32 v94, v216, v217
    v_cvt_pk_bf16_f32 v95, v218, v219
    v_mfma_f32_16x16x32_bf16 v[208:211], v[168:171], a[252:255], v[208:211]
    s_waitcnt lgkmcnt(4)
    v_exp_f32 v147, v147
    v_mfma_f32_16x16x32_bf16 v[200:203], v[168:171], v[252:255], v[200:203]
    s_waitcnt lgkmcnt(3)
    v_cvt_pk_bf16_f32 v116, v212, v213
    v_cvt_pk_bf16_f32 v117, v214, v215
    v_mfma_f32_16x16x32_bf16 v[204:207], v[248:251], a[252:255], v[204:207]
    ds_read_b128 v[168:171], v242 offset:36864
    v_cvt_pk_bf16_f32 v162, v144, v145
    v_mfma_f32_16x16x32_bf16 v[180:183], v[248:251], v[252:255], v[180:183]
    ds_read_b128 v[248:251], v242 offset:37376
    ds_read_b128 v[252:255], v239 offset:5120
    v_mfma_f32_16x16x32_bf16 v[220:223], a[0:3], a[244:247], 0
    ds_read_b128 a[0:3], v241 offset:12288
    v_cvt_pk_bf16_f32 v163, v146, v147
    v_mfma_f32_16x16x32_bf16 v[220:223], a[12:15], a[248:251], v[220:223]
    ds_read_b128 a[12:15], v242 offset:12800
    v_mov_b32 v6, 0x27e00
    v_mfma_f32_16x16x32_bf16 v[196:199], a[216:219], v[160:163], v[196:199]
    ds_read_b128 v[144:147], v230 offset:1280
    v_mfma_f32_16x16x32_bf16 v[184:187], v[66:69], v[160:163], v[184:187]
    v_exp_f32 v152, v152
    v_mfma_f32_16x16x32_bf16 v[188:191], v[88:91], v[160:163], v[188:191]
    v_exp_f32 v153, v153
    v_mfma_f32_16x16x32_bf16 v[192:195], v[110:113], v[160:163], v[192:195]
    v_exp_f32 v154, v154
    v_mfma_f32_16x16x32_bf16 v[216:219], a[4:7], a[244:247], 0
    ds_read_b128 a[4:7], v241 offset:12800
    v_cvt_pk_bf16_f32 v162, v152, v153
    v_mfma_f32_16x16x32_bf16 v[216:219], a[16:19], a[248:251], v[216:219]
    s_waitcnt lgkmcnt(6)
    ds_read_b128 a[16:19], v241 offset:24576
    v_mfma_f32_16x16x32_bf16 v[176:179], v[168:171], a[252:255], v[176:179]
    s_waitcnt lgkmcnt(6)
    ds_read_b128 v[168:171], v242 offset:61440
    v_mfma_f32_16x16x32_bf16 v[172:175], v[248:251], a[252:255], v[172:175]
    ds_read_b128 a[252:255], v240 offset:4096
    ds_read_b128 v[248:251], v242 offset:61952
    v_mfma_f32_16x16x32_bf16 v[212:215], a[8:11], a[244:247], 0
    ds_read_b128 a[244:247], v224 offset:18816
    v_mfma_f32_16x16x32_bf16 v[212:215], a[20:23], a[248:251], v[212:215]
    ds_read_b128 a[248:251], v224 offset:18880
    v_mfma_f32_16x16x32_bf16 v[220:223], a[24:27], a[236:239], v[220:223]
    ds_read_b128 a[8:11], v242 offset:12288
    v_mfma_f32_16x16x32_bf16 v[220:223], a[36:39], a[240:243], v[220:223]
    ds_read_b128 a[20:23], v241 offset:25088
    v_mfma_f32_16x16x32_bf16 v[216:219], a[28:31], a[236:239], v[216:219]
    ds_read_b128 a[24:27], v242 offset:24576
    v_mfma_f32_16x16x32_bf16 v[216:219], a[40:43], a[240:243], v[216:219]
    ds_read_b128 a[28:31], v242 offset:25088
    v_mfma_f32_16x16x32_bf16 v[212:215], a[32:35], a[236:239], v[212:215]
    ds_read_b128 a[236:239], v224 offset:18560
    v_mfma_f32_16x16x32_bf16 v[212:215], a[44:47], a[240:243], v[212:215]
    s_waitcnt lgkmcnt(6)
    ds_read_b128 a[240:243], v224 offset:18624
    v_exp_f32 v155, v155
    s_nop 0
    ds_read_b128 a[32:35], v241 offset:36864
    v_cvt_pk_bf16_f32 v163, v154, v155
    v_mfma_f32_16x16x32_bf16 v[220:223], a[48:51], a[244:247], v[220:223]
    s_waitcnt lgkmcnt(7)
    ds_read_b128 a[36:39], v241 offset:37376
    v_mfma_f32_16x16x32_bf16 v[220:223], a[60:63], a[248:251], v[220:223]
    ds_read_b128 a[40:43], v242 offset:36864
    v_mfma_f32_16x16x32_bf16 v[216:219], a[52:55], a[244:247], v[216:219]
    ds_read_b128 a[44:47], v242 offset:37376
    v_mfma_f32_16x16x32_bf16 v[216:219], a[64:67], a[248:251], v[216:219]
    ds_read_b128 a[48:51], v241 offset:49152
    v_mfma_f32_16x16x32_bf16 v[212:215], a[56:59], a[244:247], v[212:215]
    ds_read_b128 a[244:247], v224 offset:18688
    v_mfma_f32_16x16x32_bf16 v[212:215], a[68:71], a[248:251], v[212:215]
    s_waitcnt lgkmcnt(7)
    v_cvt_pk_bf16_f32 v30, v220, v221
    v_cvt_pk_bf16_f32 v31, v222, v223
    v_mfma_f32_16x16x32_bf16 v[220:223], a[236:239], a[72:75], 0
    s_waitcnt lgkmcnt(6)
    ds_read_b128 a[248:251], v224 offset:18752
    v_cvt_pk_bf16_f32 v32, v216, v217
    v_mfma_f32_16x16x32_bf16 v[220:223], a[240:243], a[84:87], v[220:223]
    v_cvt_pk_bf16_f32 v33, v218, v219
    v_mfma_f32_16x16x32_bf16 v[216:219], a[236:239], a[76:79], 0
    v_cvt_pk_bf16_f32 v34, v212, v213
    v_cvt_pk_bf16_f32 v35, v214, v215
    v_mfma_f32_16x16x32_bf16 v[216:219], a[240:243], a[88:91], v[216:219]
    ds_read_b128 a[52:55], v241 offset:49664
    ds_read_b128 a[56:59], v242 offset:49152
    v_mfma_f32_16x16x32_bf16 v[148:151], v[30:33], v[132:135], v[148:151]
    ds_read_b128 a[60:63], v242 offset:49664
    v_mfma_f32_16x16x32_bf16 v[212:215], a[236:239], a[80:83], 0
    ds_read_b128 a[236:239], v224 offset:18816
    v_mfma_f32_16x16x32_bf16 v[212:215], a[240:243], a[92:95], v[212:215]
    ds_read_b128 a[240:243], v224 offset:18880
    v_cndmask_b32 v224, v239, v240, vcc
    v_mfma_f32_16x16x16_bf16 v[148:151], v[34:35], v[136:137], v[148:151]
    s_waitcnt lgkmcnt(7)
    ds_read_b128 a[64:67], v241 offset:61440
    v_mfma_f32_16x16x32_bf16 v[208:211], a[48:51], v[164:167], v[208:211]
    ds_read_b128 a[68:71], v241 offset:61952
    v_mfma_f32_16x16x32_bf16 v[200:203], a[48:51], a[252:255], v[200:203]
    s_waitcnt lgkmcnt(8)
    ds_read_b128 v[152:155], v230 offset:2560
    v_mfma_f32_16x16x32_bf16 v[220:223], a[244:247], a[96:99], v[220:223]
    s_waitcnt lgkmcnt(8)
    v_mfma_f32_16x16x32_bf16 v[220:223], a[248:251], a[108:111], v[220:223]
    s_waitcnt lgkmcnt(7)
    v_mfma_f32_16x16x32_bf16 v[204:207], a[52:55], v[164:167], v[204:207]
    v_exp_f32 v148, v148
    v_mfma_f32_16x16x32_bf16 v[180:183], a[52:55], a[252:255], v[180:183]
    s_waitcnt lgkmcnt(6)
    v_exp_f32 v149, v149
    v_mfma_f32_16x16x32_bf16 v[176:179], a[56:59], v[164:167], v[176:179]
    s_waitcnt lgkmcnt(5)
    v_exp_f32 v150, v150
    v_mfma_f32_16x16x32_bf16 v[172:175], a[60:63], v[164:167], v[172:175]
    ds_read_b128 v[164:167], v240 offset:5120
    v_cvt_pk_bf16_f32 v160, v148, v149
    v_mfma_f32_16x16x32_bf16 v[216:219], a[244:247], a[100:103], v[216:219]
    v_exp_f32 v151, v151
    v_mfma_f32_16x16x32_bf16 v[216:219], a[248:251], a[112:115], v[216:219]
    v_cvt_pk_bf16_f32 v161, v150, v151
    v_mfma_f32_16x16x32_bf16 v[212:215], a[244:247], a[104:107], v[212:215]
    ds_read_b128 a[244:247], v226 offset:4224
    ds_read_b128 v[148:151], v230 offset:1920
    v_mfma_f32_16x16x32_bf16 v[212:215], a[248:251], a[116:119], v[212:215]
    v_mfma_f32_16x16x32_bf16 v[196:199], a[216:219], v[160:163], v[196:199]
    s_waitcnt lgkmcnt(3)
    ds_read_b128 a[248:251], v226 offset:4288
    v_mfma_f32_16x16x32_bf16 v[220:223], a[236:239], a[120:123], v[220:223]
    v_mfma_f32_16x16x32_bf16 v[220:223], a[240:243], a[132:135], v[220:223]
    s_waitcnt lgkmcnt(3)
    v_mfma_f32_16x16x32_bf16 v[216:219], a[236:239], a[124:127], v[216:219]
    s_barrier
    ds_read_b128 a[252:255], v239 offset:12288
    v_mfma_f32_16x16x32_bf16 v[216:219], a[240:243], a[136:139], v[216:219]
    v_mfma_f32_16x16x32_bf16 v[212:215], a[236:239], a[128:131], v[212:215]
    ds_read_b128 a[236:239], v226 offset:4352
    v_mfma_f32_16x16x32_bf16 v[212:215], a[240:243], a[140:143], v[212:215]
    ds_read_b128 a[240:243], v226 offset:4416
    v_cvt_pk_bf16_f32 v70, v220, v221
    v_mfma_f32_16x16x32_bf16 v[208:211], a[64:67], v[252:255], v[208:211]
    v_cvt_pk_bf16_f32 v71, v222, v223
    v_mfma_f32_16x16x32_bf16 v[200:203], a[64:67], v[164:167], v[200:203]
    v_cvt_pk_bf16_f32 v92, v216, v217
    v_cvt_pk_bf16_f32 v93, v218, v219
    v_mfma_f32_16x16x32_bf16 v[184:187], v[70:73], v[160:163], v[184:187]
    v_cvt_pk_bf16_f32 v114, v212, v213
    v_cvt_pk_bf16_f32 v115, v214, v215
    v_mfma_f32_16x16x32_bf16 v[188:191], v[92:95], v[160:163], v[188:191]
    v_cvt_pk_bf16_f32 v208, v208, v209
    v_cvt_pk_bf16_f32 v209, v210, v211
    v_mfma_f32_16x16x32_bf16 v[192:195], v[114:117], v[160:163], v[192:195]
    v_cvt_pk_bf16_f32 v200, v200, v201
    v_cvt_pk_bf16_f32 v201, v202, v203
    v_mfma_f32_16x16x32_bf16 v[204:207], a[68:71], v[252:255], v[204:207]
    v_rcp_f32 v197, v196
    v_mfma_f32_16x16x32_bf16 v[180:183], a[68:71], v[164:167], v[180:183]
    v_mul_f32 v184, v184, v197
    v_mul_f32 v185, v185, v197
    v_mfma_f32_16x16x32_bf16 v[176:179], v[168:171], v[252:255], v[176:179]
    v_cvt_pk_bf16_f32 v184, v184, v185
    v_mul_f32 v186, v186, v197
    v_mfma_f32_16x16x32_bf16 v[172:175], v[248:251], v[252:255], v[172:175]
    s_waitcnt lgkmcnt(1)
    v_cvt_pk_bf16_f32 v210, v204, v205
    v_cvt_pk_bf16_f32 v211, v206, v207
    v_mfma_f32_16x16x32_bf16 v[220:223], a[144:147], a[244:247], 0
    buffer_store_dwordx4 v[208:211], v243, s[20:23], s51 offen sc0 sc1
    v_mfma_f32_16x16x32_bf16 v[220:223], a[156:159], a[248:251], v[220:223]
    v_cvt_pk_bf16_f32 v202, v180, v181
    v_cvt_pk_bf16_f32 v203, v182, v183
    v_mfma_f32_16x16x32_bf16 v[216:219], a[148:151], a[244:247], 0
    v_cvt_pk_bf16_f32 v176, v176, v177
    v_cvt_pk_bf16_f32 v177, v178, v179
    v_mfma_f32_16x16x32_bf16 v[216:219], a[160:163], a[248:251], v[216:219]
    v_cvt_pk_bf16_f32 v178, v172, v173
    v_cvt_pk_bf16_f32 v179, v174, v175
    v_mfma_f32_16x16x32_bf16 v[212:215], a[152:155], a[244:247], 0
    ds_read_b128 a[244:247], v226 offset:4480
    v_mul_f32 v187, v187, v197
    v_mfma_f32_16x16x32_bf16 v[212:215], a[164:167], a[248:251], v[212:215]
    ds_read_b128 a[248:251], v226 offset:4544
    v_cvt_pk_bf16_f32 v185, v186, v187
    v_mfma_f32_16x16x32_bf16 v[220:223], a[168:171], a[236:239], v[220:223]
    s_waitcnt lgkmcnt(2)
    v_mul_f32 v188, v188, v197
    v_mul_f32 v189, v189, v197
    v_mfma_f32_16x16x32_bf16 v[220:223], a[180:183], a[240:243], v[220:223]
    v_cvt_pk_bf16_f32 v186, v188, v189
    v_mul_f32 v190, v190, v197
    v_mfma_f32_16x16x32_bf16 v[216:219], a[172:175], a[236:239], v[216:219]
L_pg8:
    s_cbranch_execz L_back
    v_mul_f32 v191, v191, v197
    v_cvt_pk_bf16_f32 v187, v190, v191
    v_mfma_f32_16x16x32_bf16 v[216:219], a[184:187], a[240:243], v[216:219]
    v_mul_f32 v192, v192, v197
    v_mul_f32 v193, v193, v197
    v_mfma_f32_16x16x32_bf16 v[212:215], a[176:179], a[236:239], v[212:215]
    v_cvt_pk_bf16_f32 v188, v192, v193
    v_mul_f32 v194, v194, v197
    v_mfma_f32_16x16x32_bf16 v[212:215], a[188:191], a[240:243], v[212:215]
    v_mul_f32 v195, v195, v197
    v_cvt_pk_bf16_f32 v189, v194, v195
    v_mfma_f32_16x16x32_bf16 v[208:211], a[220:223], a[252:255], 0
    s_waitcnt lgkmcnt(1)
    buffer_store_dwordx4 v[200:203], v245, s[20:23], s51 offen sc0 sc1
    v_mfma_f32_16x16x32_bf16 v[220:223], a[192:195], a[244:247], v[220:223]
    s_waitcnt lgkmcnt(0)
    ds_read_b128 v[252:255], v240 offset:12288
    v_max3_f32 v236, v236, v196, v197
    v_mfma_f32_16x16x32_bf16 v[220:223], a[204:207], a[248:251], v[220:223]
    ds_write_b128 v237, v[184:187]
    v_mfma_f32_16x16x32_bf16 v[216:219], a[196:199], a[244:247], v[216:219]
    ds_write_b64 v238, v[188:189]
    v_mfma_f32_16x16x32_bf16 v[216:219], a[208:211], a[248:251], v[216:219]
    v_cndmask_b32 v226, v244, v247, vcc
    v_cndmask_b32 v247, v247, v244, vcc
    v_mfma_f32_16x16x32_bf16 v[212:215], a[200:203], a[244:247], v[212:215]
    v_mfma_f32_16x16x32_bf16 v[212:215], a[212:215], a[248:251], v[212:215]
    v_mul_f32 v220, s37, v220
    v_mul_f32 v221, s37, v221
    v_mfma_f32_16x16x32_bf16 v[204:207], a[224:227], a[252:255], 0
    v_mul_f32 v222, s37, v222
    v_mul_f32 v223, s37, v223
    v_mfma_f32_16x16x32_bf16 v[172:175], a[232:235], a[252:255], 0
    s_waitcnt lgkmcnt(2)
    v_cvt_pk_bf16_f32 v138, v220, v221
    v_cvt_pk_bf16_f32 v139, v222, v223
    v_mfma_f32_16x16x32_bf16 v[200:203], a[220:223], v[252:255], 0
    v_mul_f32 v216, s37, v216
    v_mul_f32 v217, s37, v217
    v_mfma_f32_16x16x32_bf16 v[180:183], a[224:227], v[252:255], 0
    v_mul_f32 v218, s37, v218
    v_mul_f32 v219, s37, v219
    v_cvt_pk_bf16_f32 v140, v216, v217
    v_cvt_pk_bf16_f32 v141, v218, v219
    v_mul_f32 v212, s37, v212
    v_mul_f32 v213, s37, v213
    v_mfma_f32_16x16x32_bf16 v[156:159], v[36:39], v[138:141], v[156:159]
    v_mul_f32 v214, s37, v214
    v_mul_f32 v215, s37, v215
    v_mfma_f32_16x16x32_bf16 v[144:147], v[42:45], v[138:141], v[144:147]
    v_cvt_pk_bf16_f32 v142, v212, v213
    v_cvt_pk_bf16_f32 v143, v214, v215
    v_mfma_f32_16x16x32_bf16 v[148:151], v[24:27], v[138:141], v[148:151]
    buffer_store_dwordx4 v[176:179], v244, s[20:23], s51 offen sc0 sc1
    v_mfma_f32_16x16x16_bf16 v[156:159], v[40:41], v[142:143], v[156:159]
    s_add_u32 s51, s51, s48
    ds_read_b128 v[164:167], v239 offset:13312
    ds_read_b128 v[252:255], v239 offset:14336
    v_mfma_f32_16x16x16_bf16 v[144:147], v[46:47], v[142:143], v[144:147]
    s_waitcnt lgkmcnt(2)
    s_barrier
    ds_read_b128 v[168:171], v242 offset:61440
    v_mfma_f32_16x16x16_bf16 v[148:151], v[28:29], v[142:143], v[148:151]
    ds_read_b128 v[248:251], v242 offset:61952
    v_mfma_f32_16x16x32_bf16 v[152:155], v[30:33], v[138:141], v[152:155]
    v_exp_f32 v156, v156
    v_mfma_f32_16x16x32_bf16 v[176:179], a[228:231], a[252:255], 0
    ds_read_b128 a[252:255], v240 offset:13312
    v_exp_f32 v157, v157
    v_exp_f32 v158, v158
    v_exp_f32 v159, v159
    v_mfma_f32_16x16x16_bf16 v[152:155], v[34:35], v[142:143], v[152:155]
    s_waitcnt lgkmcnt(4)
    v_cvt_pk_bf16_f32 v160, v156, v157
    v_cvt_pk_bf16_f32 v161, v158, v159
    ds_read_b128 v[156:159], v234
    v_exp_f32 v144, v144
    v_mfma_f32_16x16x32_bf16 v[208:211], a[0:3], v[164:167], v[208:211]
    v_exp_f32 v145, v145
    v_mfma_f32_16x16x32_bf16 v[204:207], a[4:7], v[164:167], v[204:207]
    v_exp_f32 v146, v146
    v_mfma_f32_16x16x32_bf16 v[176:179], a[8:11], v[164:167], v[176:179]
    v_exp_f32 v147, v147
    v_mfma_f32_16x16x32_bf16 v[172:175], a[12:15], v[164:167], v[172:175]
    s_waitcnt lgkmcnt(1)
    ds_read_b128 v[164:167], v240 offset:14336
    v_cvt_pk_bf16_f32 v162, v144, v145
    v_mfma_f32_16x16x32_bf16 v[200:203], a[0:3], a[252:255], v[200:203]
    v_cvt_pk_bf16_f32 v163, v146, v147
    v_mfma_f32_16x16x32_bf16 v[180:183], a[4:7], a[252:255], v[180:183]
    ds_read_b128 v[144:147], v235
    v_mfma_f32_16x16x32_bf16 v[196:199], a[216:219], v[160:163], 0
    ds_read_b128 a[252:255], v239 offset:15360
    v_mfma_f32_16x16x32_bf16 v[184:187], v[76:79], v[160:163], 0
    v_exp_f32 v148, v148
    v_mfma_f32_16x16x32_bf16 v[188:191], v[98:101], v[160:163], 0
    v_exp_f32 v149, v149
    v_mfma_f32_16x16x32_bf16 v[192:195], v[120:123], v[160:163], 0
    s_waitcnt lgkmcnt(3)
    v_exp_f32 v150, v150
    v_mfma_f32_16x16x32_bf16 v[156:159], v[48:51], v[138:141], v[156:159]
    v_exp_f32 v151, v151
    v_mfma_f32_16x16x32_bf16 v[208:211], a[16:19], v[252:255], v[208:211]
    s_waitcnt lgkmcnt(2)
    v_cvt_pk_bf16_f32 v160, v148, v149
    v_cvt_pk_bf16_f32 v161, v150, v151
    v_mfma_f32_16x16x32_bf16 v[200:203], a[16:19], v[164:167], v[200:203]
    v_exp_f32 v152, v152
    v_mfma_f32_16x16x16_bf16 v[156:159], v[52:53], v[142:143], v[156:159]
    s_waitcnt lgkmcnt(1)
    v_exp_f32 v153, v153
    v_mfma_f32_16x16x32_bf16 v[144:147], v[54:57], v[138:141], v[144:147]
    v_exp_f32 v154, v154
    v_mfma_f32_16x16x32_bf16 v[204:207], a[20:23], v[252:255], v[204:207]
    v_exp_f32 v155, v155
    v_mfma_f32_16x16x32_bf16 v[180:183], a[20:23], v[164:167], v[180:183]
    ds_read_b128 v[164:167], v239 offset:16384
    v_cvt_pk_bf16_f32 v162, v152, v153
    v_mfma_f32_16x16x16_bf16 v[144:147], v[58:59], v[142:143], v[144:147]
    v_cvt_pk_bf16_f32 v163, v154, v155
    v_mfma_f32_16x16x32_bf16 v[176:179], a[24:27], v[252:255], v[176:179]
    v_exp_f32 v156, v156
    v_mfma_f32_16x16x32_bf16 v[196:199], a[216:219], v[160:163], v[196:199]
    v_exp_f32 v157, v157
    v_mfma_f32_16x16x32_bf16 v[184:187], v[68:71], v[160:163], v[184:187]
    v_exp_f32 v158, v158
    v_mfma_f32_16x16x32_bf16 v[188:191], v[90:93], v[160:163], v[188:191]
    v_exp_f32 v159, v159
    v_mfma_f32_16x16x32_bf16 v[192:195], v[112:115], v[160:163], v[192:195]
    v_cvt_pk_bf16_f32 v160, v156, v157
    v_cvt_pk_bf16_f32 v161, v158, v159
    v_mfma_f32_16x16x32_bf16 v[172:175], a[28:31], v[252:255], v[172:175]
    s_waitcnt lgkmcnt(1)
    ds_read_b128 v[252:255], v240 offset:15360
    v_mfma_f32_16x16x32_bf16 v[208:211], a[32:35], a[252:255], v[208:211]
    v_exp_f32 v144, v144
    v_mfma_f32_16x16x32_bf16 v[204:207], a[36:39], a[252:255], v[204:207]
    v_exp_f32 v145, v145
    v_mfma_f32_16x16x32_bf16 v[176:179], a[40:43], a[252:255], v[176:179]
    v_exp_f32 v146, v146
    v_mfma_f32_16x16x32_bf16 v[172:175], a[44:47], a[252:255], v[172:175]
    s_waitcnt lgkmcnt(1)
    ds_read_b128 a[252:255], v240 offset:16384
    v_cvt_pk_bf16_f32 v162, v144, v145
    v_mfma_f32_16x16x32_bf16 v[208:211], a[48:51], v[164:167], v[208:211]
    v_exp_f32 v147, v147
    v_mfma_f32_16x16x32_bf16 v[204:207], a[52:55], v[164:167], v[204:207]
    v_cvt_pk_bf16_f32 v163, v146, v147
    v_mfma_f32_16x16x32_bf16 v[176:179], a[56:59], v[164:167], v[176:179]
    v_mfma_f32_16x16x32_bf16 v[172:175], a[60:63], v[164:167], v[172:175]
    ds_read_b128 v[164:167], v240 offset:17408
    v_mfma_f32_16x16x32_bf16 v[196:199], a[216:219], v[160:163], v[196:199]
    v_mfma_f32_16x16x32_bf16 v[184:187], v[82:85], v[160:163], v[184:187]
    v_mfma_f32_16x16x32_bf16 v[188:191], v[104:107], v[160:163], v[188:191]
    v_mfma_f32_16x16x32_bf16 v[192:195], v[126:129], v[160:163], v[192:195]
    s_waitcnt lgkmcnt(2)
    v_mfma_f32_16x16x32_bf16 v[200:203], a[32:35], v[252:255], v[200:203]
    v_mfma_f32_16x16x32_bf16 v[180:183], a[36:39], v[252:255], v[180:183]
    s_waitcnt lgkmcnt(1)
    ds_read_b128 v[252:255], v239 offset:17408
    v_mfma_f32_16x16x32_bf16 v[200:203], a[48:51], a[252:255], v[200:203]
    v_mfma_f32_16x16x32_bf16 v[180:183], a[52:55], a[252:255], v[180:183]
    s_waitcnt lgkmcnt(1)
    ds_read_b128 a[252:255], v224
    v_mfma_f32_16x16x32_bf16 v[200:203], a[64:67], v[164:167], v[200:203]
    v_rcp_f32 v197, v196
    v_mfma_f32_16x16x32_bf16 v[180:183], a[68:71], v[164:167], v[180:183]
    s_waitcnt lgkmcnt(1)
    ds_read_b128 v[164:167], v224 offset:2048
    v_mul_f32 v184, v184, v197
    v_mul_f32 v185, v185, v197
    v_cvt_pk_bf16_f32 v184, v184, v185
    v_mul_f32 v186, v186, v197
    v_mul_f32 v187, v187, v197
    v_cvt_pk_bf16_f32 v200, v200, v201
    v_cvt_pk_bf16_f32 v201, v202, v203
    v_cvt_pk_bf16_f32 v202, v180, v181
    v_cvt_pk_bf16_f32 v203, v182, v183
    buffer_store_dwordx4 v[200:203], v245, s[20:23], s51 offen sc0 sc1
    v_mfma_f32_16x16x32_bf16 v[208:211], a[64:67], v[252:255], v[208:211]
    v_cvt_pk_bf16_f32 v185, v186, v187
    v_mul_f32 v188, v188, v197
    v_mfma_f32_16x16x32_bf16 v[204:207], a[68:71], v[252:255], v[204:207]
    v_mul_f32 v189, v189, v197
    v_cvt_pk_bf16_f32 v186, v188, v189
    v_mfma_f32_16x16x32_bf16 v[176:179], v[168:171], v[252:255], v[176:179]
    ds_read_b128 v[168:171], v242 offset:61440
    v_mul_f32 v190, v190, v197
    v_mfma_f32_16x16x32_bf16 v[172:175], v[248:251], v[252:255], v[172:175]
    s_waitcnt lgkmcnt(2)
    ds_read_b128 v[252:255], v224 offset:1024
    v_cvt_pk_bf16_f32 v208, v208, v209
    v_mfma_f32_16x16x32_bf16 v[200:203], a[228:231], a[252:255], 0
    ds_read_b128 v[248:251], v242 offset:61952
    v_cvt_pk_bf16_f32 v209, v210, v211
    v_mfma_f32_16x16x32_bf16 v[180:183], a[232:235], a[252:255], 0
    v_cvt_pk_bf16_f32 v210, v204, v205
    v_cvt_pk_bf16_f32 v211, v206, v207
    v_mfma_f32_16x16x32_bf16 v[204:207], a[224:227], a[252:255], 0
    s_waitcnt lgkmcnt(1)
    v_cvt_pk_bf16_f32 v176, v176, v177
    v_cvt_pk_bf16_f32 v177, v178, v179
    v_cvt_pk_bf16_f32 v178, v172, v173
    v_cvt_pk_bf16_f32 v179, v174, v175
    v_mul_f32 v191, v191, v197
    v_cvt_pk_bf16_f32 v187, v190, v191
    v_mul_f32 v192, v192, v197
    v_mul_f32 v193, v193, v197
    v_cvt_pk_bf16_f32 v188, v192, v193
    v_mul_f32 v194, v194, v197
    v_mul_f32 v195, v195, v197
    v_cvt_pk_bf16_f32 v189, v194, v195
    v_max3_f32 v236, v236, v196, v197
    ds_write_b128 v237, v[184:187] offset:6144
    v_mfma_f32_16x16x32_bf16 v[204:207], a[4:7], v[252:255], v[204:207]
    buffer_store_dwordx4 v[208:211], v243, s[20:23], s51 offen sc0 sc1
    v_mfma_f32_16x16x32_bf16 v[200:203], a[8:11], v[252:255], v[200:203]
    ds_write_b64 v238, v[188:189] offset:6144
    v_mfma_f32_16x16x32_bf16 v[208:211], a[220:223], a[252:255], 0
    v_cmp_lt_f32 vcc, 0x53800000, v236
    v_mfma_f32_16x16x32_bf16 v[208:211], a[0:3], v[252:255], v[208:211]
    v_mfma_f32_16x16x32_bf16 v[180:183], a[12:15], v[252:255], v[180:183]
    s_or_b32 s24, vcc_lo, vcc_hi
    ds_read_b128 a[252:255], v224 offset:3072
    ds_read_b128 v[252:255], v224 offset:4096
    v_mfma_f32_16x16x32_bf16 v[208:211], a[16:19], v[164:167], v[208:211]
    v_mov_b32 v4, s24
    v_mfma_f32_16x16x32_bf16 v[204:207], a[20:23], v[164:167], v[204:207]
    ds_write_b32 v5, v4
    v_mfma_f32_16x16x32_bf16 v[200:203], a[24:27], v[164:167], v[200:203]
    v_mfma_f32_16x16x32_bf16 v[180:183], a[28:31], v[164:167], v[180:183]
    s_waitcnt lgkmcnt(2)
    ds_read_b128 v[164:167], v224 offset:5120
    buffer_store_dwordx4 v[176:179], v244, s[20:23], s51 offen sc0 sc1
    v_mfma_f32_16x16x32_bf16 v[208:211], a[32:35], a[252:255], v[208:211]
    s_add_u32 s51, s51, s48
    v_mfma_f32_16x16x32_bf16 v[204:207], a[36:39], a[252:255], v[204:207]
    s_waitcnt lgkmcnt(1)
    v_mfma_f32_16x16x32_bf16 v[200:203], a[40:43], a[252:255], v[200:203]
    s_barrier
    ds_read_b128 v[0:3], v6
    v_mfma_f32_16x16x32_bf16 v[180:183], a[44:47], a[252:255], v[180:183]
    ds_read_b128 a[252:255], v227
    v_mfma_f32_16x16x32_bf16 v[208:211], a[48:51], v[252:255], v[208:211]
    v_mfma_f32_16x16x32_bf16 v[204:207], a[52:55], v[252:255], v[204:207]
    v_mfma_f32_16x16x32_bf16 v[200:203], a[56:59], v[252:255], v[200:203]
    v_mfma_f32_16x16x32_bf16 v[180:183], a[60:63], v[252:255], v[180:183]
    s_waitcnt lgkmcnt(2)
    ds_read_b128 v[252:255], v227 offset:1024
    v_mfma_f32_16x16x32_bf16 v[208:211], a[64:67], v[164:167], v[208:211]
    v_mfma_f32_16x16x32_bf16 v[204:207], a[68:71], v[164:167], v[204:207]
    v_mfma_f32_16x16x32_bf16 v[200:203], v[168:171], v[164:167], v[200:203]
    s_waitcnt lgkmcnt(2)
    ds_read_b128 v[168:171], v242 offset:61440
    v_or3_b32 v0, v0, v1, v2
    v_mfma_f32_16x16x32_bf16 v[180:183], v[248:251], v[164:167], v[180:183]
    s_waitcnt lgkmcnt(2)
    ds_read_b128 v[164:167], v227 offset:2048
    ds_read_b128 v[248:251], v242 offset:61952
    v_mfma_f32_16x16x32_bf16 v[176:179], a[220:223], a[252:255], 0
    v_cvt_pk_bf16_f32 v208, v208, v209
    v_cvt_pk_bf16_f32 v209, v210, v211
    v_mfma_f32_16x16x32_bf16 v[172:175], a[224:227], a[252:255], 0
    v_cvt_pk_bf16_f32 v210, v204, v205
    v_cvt_pk_bf16_f32 v211, v206, v207
    v_mfma_f32_16x16x32_bf16 v[204:207], a[232:235], a[252:255], 0
    s_waitcnt lgkmcnt(3)
    buffer_store_dwordx4 v[208:211], v225, s[20:23], s51 offen sc0 sc1
    v_mfma_f32_16x16x32_bf16 v[176:179], a[0:3], v[252:255], v[176:179]
    v_cvt_pk_bf16_f32 v200, v200, v201
    v_cvt_pk_bf16_f32 v201, v202, v203
    v_mfma_f32_16x16x32_bf16 v[208:211], a[228:231], a[252:255], 0
    v_cvt_pk_bf16_f32 v202, v180, v181
    v_cvt_pk_bf16_f32 v203, v182, v183
    v_mfma_f32_16x16x32_bf16 v[172:175], a[4:7], v[252:255], v[172:175]
    ds_read_b128 a[252:255], v227 offset:3072
    v_or_b32 v0, v0, v3
    v_mfma_f32_16x16x32_bf16 v[208:211], a[8:11], v[252:255], v[208:211]
    v_readfirstlane_b32 s24, v0
    v_mfma_f32_16x16x32_bf16 v[204:207], a[12:15], v[252:255], v[204:207]
    s_waitcnt lgkmcnt(2)
    ds_read_b128 v[252:255], v227 offset:4096
    v_mfma_f32_16x16x32_bf16 v[176:179], a[16:19], v[164:167], v[176:179]
    v_mfma_f32_16x16x32_bf16 v[172:175], a[20:23], v[164:167], v[172:175]
    v_mfma_f32_16x16x32_bf16 v[208:211], a[24:27], v[164:167], v[208:211]
    v_mfma_f32_16x16x32_bf16 v[204:207], a[28:31], v[164:167], v[204:207]
    s_waitcnt lgkmcnt(1)
    ds_read_b128 v[164:167], v227 offset:5120
    v_mfma_f32_16x16x32_bf16 v[176:179], a[32:35], a[252:255], v[176:179]
    buffer_store_dwordx4 v[200:203], v226, s[20:23], s51 offen sc0 sc1
    v_mfma_f32_16x16x32_bf16 v[172:175], a[36:39], a[252:255], v[172:175]
    v_mfma_f32_16x16x32_bf16 v[208:211], a[40:43], a[252:255], v[208:211]
    v_mfma_f32_16x16x32_bf16 v[204:207], a[44:47], a[252:255], v[204:207]
    s_waitcnt lgkmcnt(1)
    v_mfma_f32_16x16x32_bf16 v[176:179], a[48:51], v[252:255], v[176:179]
    v_mfma_f32_16x16x32_bf16 v[172:175], a[52:55], v[252:255], v[172:175]
    v_mfma_f32_16x16x32_bf16 v[208:211], a[56:59], v[252:255], v[208:211]
    v_mfma_f32_16x16x32_bf16 v[204:207], a[60:63], v[252:255], v[204:207]
    s_waitcnt lgkmcnt(0)
    v_mfma_f32_16x16x32_bf16 v[176:179], a[64:67], v[164:167], v[176:179]
    v_mfma_f32_16x16x32_bf16 v[172:175], a[68:71], v[164:167], v[172:175]
    v_mfma_f32_16x16x32_bf16 v[208:211], v[168:171], v[164:167], v[208:211]
    v_mfma_f32_16x16x32_bf16 v[204:207], v[248:251], v[164:167], v[204:207]
    s_nop 4
    v_cvt_pk_bf16_f32 v176, v176, v177
    v_cvt_pk_bf16_f32 v177, v178, v179
    v_cvt_pk_bf16_f32 v178, v172, v173
    v_cvt_pk_bf16_f32 v179, v174, v175
    buffer_store_dwordx4 v[176:179], v246, s[20:23], s51 offen sc0 sc1
    v_cvt_pk_bf16_f32 v208, v208, v209
    v_cvt_pk_bf16_f32 v209, v210, v211
    v_cvt_pk_bf16_f32 v210, v204, v205
    v_cvt_pk_bf16_f32 v211, v206, v207
    buffer_store_dwordx4 v[208:211], v247, s[20:23], s51 offen sc0 sc1
    s_nop 1
    s_cmp_lg_u32 s24, 0
    s_cbranch_scc1 L_safe
L_exit:
    s_endpgm
L_end:
L_safe:
    s_waitcnt vmcnt(0) lgkmcnt(0)
    s_barrier
    v_mbcnt_lo_u32_b32 v0, -1, 0
    v_mbcnt_hi_u32_b32 v0, -1, v0
    s_lshl_b32 s24, s36, 6
    v_add_u32 v0, s24, v0
    s_load_dwordx2 s[8:9], s[0:1], 8
    s_load_dwordx2 s[4:5], s[0:1], 0
    s_load_dwordx2 s[16:17], s[0:1], 24
    s_load_dwordx2 s[12:13], s[0:1], 16
    s_load_dwordx2 s[20:21], s[0:1], 32
    v_lshrrev_b32 v74, 6, v0
    v_and_b32 v60, 63, v0
    v_readfirstlane_b32 s36, v74
    v_mul_u32_u24 v76, 0x2aab, v60
    v_lshrrev_b32 v76, 16, v76
    v_mul_u32_u24 v74, 6, v76
    v_sub_u32 v77, v60, v74
    v_lshrrev_b32 v74, 1, v76
    v_and_b32 v74, 4, v74
    v_xor_b32 v76, v76, v74
    v_mul_u32_u24 v74, 0x480, v76
    v_lshl_add_u32 v251, v77, 4, v74
    v_add_u32 v79, 64, v60
    v_mul_u32_u24 v78, 0x2aab, v79
    v_lshrrev_b32 v78, 16, v78
    v_mul_u32_u24 v74, 6, v78
    v_sub_u32 v79, v60, v74
    v_lshrrev_b32 v74, 1, v78
    v_and_b32 v74, 4, v74
    v_xor_b32 v78, v78, v74
    v_mul_u32_u24 v74, 0x480, v78
    v_lshl_add_u32 v252, v79, 4, v74
    v_add_u32 v81, 0x80, v60
    v_mul_u32_u24 v80, 0x2aab, v81
    v_lshrrev_b32 v80, 16, v80
    v_mul_u32_u24 v74, 6, v80
    v_sub_u32 v81, v60, v74
    v_lshrrev_b32 v74, 1, v80
    v_and_b32 v74, 4, v74
    v_xor_b32 v80, v80, v74
    v_mul_u32_u24 v74, 0x480, v80
    v_lshl_add_u32 v253, v81, 4, v74
    s_mul_i32 s49, s36, 0x60
    s_mul_i32 s50, s36, 0xc00
    s_add_u32 s50, s50, 0x15e00
    s_mov_b32 s10, 0x36000
    s_mov_b32 s11, 0x20000
    s_mov_b32 s6, 0x1260400
    s_mov_b32 s7, 0x20000
    s_mov_b32 s18, 0x548
    s_mov_b32 s19, 0x20000
    s_mov_b32 s14, 0x12000
    s_mov_b32 s15, 0x20000
    s_mov_b32 s22, 0x1260000
    s_mov_b32 s23, 0x20000
    s_mul_i32 s58, s36, 0x152
    v_lshlrev_b32 v199, 1, v60
    s_add_u32 s57, s49, 0x180
    s_add_u32 m0, s50, 0
    s_bfe_u32 s35, s2, 0x30003
    s_lshr_b32 s55, s2, 6
    s_and_b32 s54, s2, 1
    s_lshl2_add_u32 s34, s54, s55
    s_and_b32 s46, s55, 1
    s_bfe_u32 s54, s2, 0x10002
    s_mul_i32 s54, s54, 0x15000
    s_bfe_u32 s55, s2, 0x10001
    s_mul_i32 s55, s55, 0x180
    s_add_u32 s38, s54, s55
    s_lshl_b32 s41, s36, 11
    s_min_u32 s41, s41, 0x1600
    s_mul_i32 s54, s35, 14
    s_sub_u32 s54, s54, 3
    s_movk_i32 s53, 0x6f
    s_lshr_b32 s55, s41, 4
    v_add_u32 v99, s55, v60
    v_mul_u32_u24 v97, 0xaab, v99
    v_lshrrev_b32 v97, 16, v97
    v_mul_u32_u24 v98, 24, v97
    v_sub_u32 v96, v99, v98
    v_and_or_b32 v98, 2, v97, 64
    v_xor_b32 v96, v96, v98
    v_add_u32 v97, s54, v97
    v_med3_i32 v97, v97, 0, s53
    v_mul_u32_u24 v97, 0x300, v97
    v_lshl_add_u32 v246, v96, 4, v97
    v_add_u32 v99, 64, v99
    v_mul_u32_u24 v97, 0xaab, v99
    v_lshrrev_b32 v97, 16, v97
    v_mul_u32_u24 v98, 24, v97
    v_sub_u32 v96, v99, v98
    v_and_b32 v98, 2, v97
    v_xor_b32 v96, v96, v98
    s_waitcnt lgkmcnt(0)
    buffer_load_ushort v196, v199, s[16:19], s58 offen
    buffer_load_ushort v197, v199, s[16:19], s58 offen offset:128
    buffer_load_ushort v198, v199, s[16:19], s58 offen offset:256
    buffer_load_dwordx4 v251, s[8:11], s57 offen lds
    v_add_u32 v97, s54, v97
    v_med3_i32 v97, v97, 0, s53
    v_mul_u32_u24 v97, 0x300, v97
    buffer_load_dwordx4 v252, s[8:11], s57 offen offset:1024 lds
    v_lshl_add_u32 v247, v96, 4, v97
    s_sub_u32 s4, s4, 0x400
    s_subb_u32 s5, s5, 0
    s_mul_i32 s51, s34, 0x24c000
    s_add_u32 s51, s51, s38
    s_mul_i32 s55, s46, 0x222000
    s_add_u32 s56, s51, s55
    s_mul_i32 s42, s46, 0xfffac000
    s_add_u32 s42, s42, 0x2a000
    s_mul_i32 s55, s46, 7
    s_cmp_eq_u32 s34, s55
    s_cselect_b32 s43, 5, -3
    s_cselect_b32 s45, 0, -1
    s_cselect_b32 s47, 1, 0
    buffer_load_dwordx4 v253, s[8:11], s57 offen offset:2048 lds
    s_mul_i32 s43, s43, s42
    s_add_u32 s43, s43, s56
    s_mul_i32 s45, s45, s42
    s_add_u32 s45, s45, s56
    s_add_u32 s44, s43, s42
    s_add_u32 m0, s41, 0
    s_add_u32 s57, s49, 0x9180
    v_lshrrev_b32 v61, 4, v60
    v_and_b32 v62, 7, v60
    v_bfe_u32 v63, v60, 3, 1
    v_bfe_u32 v96, v60, 2, 2
    buffer_load_dwordx4 v246, s[4:7], s43 offen lds
    v_and_b32 v97, 3, v60
    v_and_b32 v103, 1, v61
    v_lshl_add_u32 v99, v61, 3, v96
    v_lshl_add_u32 v99, v103, 2, v99
    v_lshl_add_u32 v101, v97, 3, s50
    s_movk_i32 s27, 0x60
    v_mad_u32_u24 v254, v99, s27, v101
    v_xor_b32 v99, 4, v99
    buffer_load_dwordx4 v247, s[4:7], s43 offen offset:1024 lds
    s_add_u32 m0, s41, 0x1e40
    v_mad_u32_u24 v255, v99, s27, v101
    v_mul_u32_u24 v102, 0x1e40, v63
    v_and_b32 v98, 2, v60
    v_xor_b32 v98, v98, v61
    v_lshlrev_b32 v98, 4, v98
    v_mul_u32_u24 v100, 0x180, v62
    v_add3_u32 v224, v98, v100, v102
    buffer_load_dwordx4 v246, s[4:7], s44 offen lds
    v_mul_u32_u24 v99, 0x1e40, v96
    v_mul_u32_u24 v227, 0x180, v97
    v_add3_u32 v227, v227, v98, v99
    s_cmp_eq_u32 s35, 0
    s_cselect_b32 s29, 3, 0
    s_cselect_b32 s30, -3, -2
    s_mul_i32 s32, s36, 0xf00
    s_add_u32 s32, s32, 0xf200
    s_mov_b32 s40, 0x140
    s_lshl_b32 s31, s36, 10
    buffer_load_dwordx4 v247, s[4:7], s44 offen offset:1024 lds
    s_add_u32 m0, s41, 0x3c80
    s_add_u32 s31, s31, 0x12e40
    v_mul_u32_u24 v119, 13, v60
    v_lshrrev_b32 v119, 8, v119
    v_mul_u32_u24 v118, 20, v119
    v_sub_u32 v118, v60, v118
    v_add_u32 v120, -11, v118
    v_max_i32 v120, 0, v120
    v_mul_u32_u24 v121, 11, v120
    buffer_load_dwordx4 v246, s[4:7], s45 offen lds
    v_lshrrev_b32 v121, 5, v121
    v_mul_u32_u24 v122, 3, v121
    v_sub_u32 v120, v120, v122
    v_lshlrev_b32 v120, 2, v120
    v_sub_u32 v121, v120, v121
    v_cmp_lt_u32 vcc, 10, v118
    v_add_u32 v121, s29, v121
    v_add_u32 v120, s30, v120
    buffer_load_dwordx4 v247, s[4:7], s45 offen offset:1024 lds
    s_add_u32 m0, s41, 0x5ac0
    v_add_u32 v122, -3, v118
    v_cndmask_b32 v121, v118, v121, vcc
    v_cndmask_b32 v120, v122, v120, vcc
    v_cmp_gt_u32 s[60:61], 7, v120
    v_add_u32 v120, 1, v120
    v_cmp_gt_u32 s[62:63], 7, v120
    v_add_u32 v120, 1, v120
    buffer_load_dwordx4 v246, s[4:7], s56 offen lds
    v_cmp_gt_u32 s[64:65], 7, v120
    v_add_u32 v120, 1, v120
    v_cmp_gt_u32 s[66:67], 7, v120
    s_cmp_eq_u32 s46, 0
    s_cselect_b32 s28, 13, -13
    s_cselect_b32 s69, 0, 39
    v_add_u32 v119, 2, v119
    v_mad_i32_i24 v121, v119, s28, v121
    buffer_load_dwordx4 v247, s[4:7], s56 offen offset:1024 lds
    s_add_u32 m0, s50, 0x3000
    s_add_u32 s56, s56, s42
    s_lshl4_add_u32 s69, s69, s31
    v_lshl_add_u32 v121, v121, 2, s69
    s_mul_i32 s69, s28, 12
    v_add_u32 v118, s69, v121
    v_add_u32 v119, s69, v118
    s_lshl_b32 s69, s28, 3
    v_add_u32 v122, s69, v119
    v_lshl_add_u32 v123, v60, 4, s32
    buffer_load_dwordx4 v251, s[8:11], s57 offen lds
    v_lshl_add_u32 v125, v60, 2, s31
    s_mov_b32 s68, 0x40ddb3d7
    v_mov_b32 v124, 0xf149f2ca
    s_and_b32 s72, s60, 0xfff00000
    s_and_b32 s70, s62, 0xfff00000
    v_mul_u32_u24 v74, 0x180, v76
    v_lshl_add_u32 v192, v77, 4, v74
    v_mul_u32_u24 v74, 0x180, v78
    v_lshl_add_u32 v193, v79, 4, v74
    buffer_load_dwordx4 v252, s[8:11], s57 offen offset:1024 lds
    v_mul_u32_u24 v74, 0x180, v80
    v_lshl_add_u32 v194, v81, 4, v74
    v_and_b32 v74, 16, v78
    v_mul_u32_u24 v74, 0x300, v74
    v_add_u32 v195, v74, v193
    v_add_u32 v98, 3, v62
    v_and_b32 v98, 2, v98
    buffer_load_dwordx4 v253, s[8:11], s57 offen offset:2048 lds
    s_add_u32 s57, s49, 0x12180
    s_add_u32 m0, s50, 0x6000
    v_xor_b32 v98, v98, v61
    v_lshl_add_u32 v98, v98, 4, v100
    v_add_u32 v225, v98, v102
    v_xor_b32 v99, 1, v63
    v_mul_u32_u24 v99, 0xd3c0, v99
    v_add_u32 v226, v98, v99
    s_mov_b32 s37, 0x3e553b95
    s_cmp_eq_u32 s35, 7
    s_cselect_b32 s33, 2, 64
    v_lshrrev_b32 v184, 1, v61
    v_lshl_add_u32 v185, v63, 1, v184
    v_lshlrev_b32 v232, 2, v185
    v_lshl_add_u32 v185, v63, 2, v61
    v_lshlrev_b32 v233, 2, v185
    v_sub_u32 v184, v184, v63
    v_mul_i32_i24 v184, 0x140, v184
    s_sub_u32 s24, s32, 0x140
    v_add_u32 v184, s24, v184
    v_lshl_add_u32 v185, v103, 2, 3
    v_cmp_gt_u32 vcc, s29, v62
    v_sub_u32 v186, v185, v62
    v_min_u32 v187, 10, v186
    v_mad_u32_u24 v190, v62, 3, v103
    v_add_u32 v191, 11, v190
    v_cndmask_b32 v187, v187, v191, vcc
    v_lshl_add_u32 v228, v187, 4, v184
    v_add_u32 v186, 8, v186
    v_min_u32 v187, 10, v186
    v_lshl_add_u32 v186, v103, 4, v62
    v_cmp_gt_u32 vcc, s29, v186
    v_add_u32 v191, 13, v190
    v_min_u32 v186, 5, v62
    v_cndmask_b32 v187, v187, v191, vcc
    v_lshl_add_u32 v229, v187, 4, v184
    v_cmp_lt_u32 vcc, s33, v186
    v_sub_u32 v187, v185, v186
    v_min_u32 v187, 10, v187
    v_mad_u32_u24 v190, v186, 3, 2
    v_add_u32 v191, v190, v103
    v_cndmask_b32 v187, v187, v191, vcc
    v_lshl_add_u32 v230, v187, 4, v184
    v_sub_u32 v187, 11, v186
    v_min_u32 v187, 10, v187
    v_add_u32 v191, 2, v190
    v_cndmask_b32 v187, v187, v191, vcc
    v_lshl_add_u32 v231, v187, 4, s32
    v_mov_b32 v96, 0x3f803f80
    v_accvgpr_write_b32 a216, v96
    v_accvgpr_write_b32 a217, v96
    v_accvgpr_write_b32 a218, v96
    v_accvgpr_write_b32 a219, v96
    s_mov_b32 s69, 0x32104321
    s_and_b32 s24, s36, 1
    s_lshr_b32 s27, s36, 1
    v_lshlrev_b32 v99, 4, v60
    s_mul_i32 s25, s27, 0xc00
    s_add_u32 s25, s25, 0x12e00
    s_lshl_b32 s26, s24, 11
    s_add_u32 s26, s26, s25
    v_add_u32 v237, s26, v99
    s_lshl3_add_u32 s26, s24, s25
    s_add_u32 s26, s26, 0x400
    v_add_u32 v238, s26, v99
    s_mul_i32 s25, s24, 0x1800
    s_add_u32 s26, s25, 0x12e00
    v_add_u32 v239, s26, v99
    s_sub_u32 s25, 0x14600, s25
    v_add_u32 v240, s25, v99
    v_lshrrev_b32 v99, 2, v60
    v_and_b32 v97, 3, v60
    v_and_b32 v98, 2, v61
    v_lshlrev_b32 v98, 1, v98
    v_xor_b32 v99, v99, v98
    v_mul_u32_u24 v99, 0x60, v99
    v_lshl_add_u32 v108, v97, 4, v99
    v_lshrrev_b32 v98, 1, v97
    v_mul_u32_u24 v98, 0xba0, v98
    s_mul_i32 s26, s27, 0x1800
    s_add_u32 s26, s26, 0x15e40
    v_add3_u32 v109, v108, v98, s26
    s_lshl_b32 s25, s24, 5
    s_add_u32 s52, s25, s50
    v_add_u32 v108, s52, v108
    v_bfrev_b32 v98, v97
    v_lshrrev_b32 v98, 27, v98
    v_add3_u32 v86, v99, v98, s50
    v_lshlrev_b32 v99, 7, v61
    v_lshl_add_u32 v99, v62, 4, v99
    v_lshl_add_u32 v98, v63, 9, v99
    v_add_u32 v87, s50, v98
    v_lshl_add_u32 v99, v63, 10, v99
    s_add_u32 s26, s26, 0x7c0
    v_add_u32 v242, s26, v99
    s_lshl_b32 s26, s24, 10
    s_add_u32 s26, s26, s50
    v_add_u32 v241, s26, v99
    v_xor_b32 v99, s46, v63
    v_mul_u32_u24 v99, 0x2a000, v99
    v_mul_u32_u24 v98, 0x300, v62
    v_lshl_add_u32 v99, v61, 4, v99
    v_cmp_lt_u32 vcc, 5, v62
    v_add_u32 v99, v99, v98
    v_add_u32 v98, 0x1800, v99
    v_bfrev_b32 v100, 1
    v_cndmask_b32 v98, v98, v100, vcc
    s_sub_u32 s59, 0, s24
    s_mov_b32 vcc_lo, s59
    s_mov_b32 vcc_hi, s59
    v_cndmask_b32 v100, v99, v98, vcc
    v_cndmask_b32 v101, v98, v99, vcc
    s_mov_b32 vcc_lo, s59
    s_mov_b32 vcc_hi, s59
    s_add_u32 s25, s25, s49
    v_add_u32 v243, s25, v100
    v_add_u32 v245, s25, v101
    s_mul_i32 s26, s27, 0xc0
    s_add_u32 s26, s26, 64
    v_add_u32 v244, s26, v100
    s_mul_i32 s25, s35, 0x2a00
    s_add_u32 s51, s51, s25
    s_mul_i32 s25, s46, 0x1f8000
    s_add_u32 s51, s51, s25
    s_lshl_b32 s48, s42, 1
    s_waitcnt vmcnt(16)
    v_lshlrev_b32 v196, 16, v196
    v_mul_f32 v196, s68, v196
    ds_write_b32 v125, v196
    s_waitcnt vmcnt(15)
    v_lshlrev_b32 v197, 16, v197
    v_mul_f32 v197, s68, v197
    ds_write_b32 v125, v197 offset:256
    s_waitcnt vmcnt(14)
    v_lshlrev_b32 v198, 16, v198
    v_mul_f32 v198, s68, v198
    ds_write_b32 v125, v198 offset:512
    s_mov_b32 s68, 0x760007
    s_cmp_eq_u32 s47, 1
    s_cmov_b32 s68, 0x760097
    ds_read2_b32 v[144:145], v121 offset0:0 offset1:1
    ds_read2_b32 v[146:147], v121 offset0:2 offset1:3
    ds_read2_b32 v[148:149], v118 offset0:0 offset1:1
    ds_read2_b32 v[150:151], v118 offset0:2 offset1:3
    ds_read2_b32 v[152:153], v119 offset0:0 offset1:1
    ds_read2_b32 v[154:155], v119 offset0:2 offset1:3
    ds_read2_b32 v[156:157], v122 offset0:0 offset1:1
    ds_read2_b32 v[158:159], v122 offset0:2 offset1:3
    s_waitcnt lgkmcnt(5)
    v_cndmask_b32 v148, v124, v148, s[60:61]
    s_waitcnt vmcnt(11)
    ds_read_b64_tr_b16 a[0:1], v254
    ds_read_b64_tr_b16 a[2:3], v255
    ds_read_b64_tr_b16 a[4:5], v254 offset:32
    ds_read_b64_tr_b16 a[6:7], v255 offset:32
    ds_read_b64_tr_b16 a[8:9], v254 offset:64
    v_cndmask_b32 v149, v124, v149, s[62:63]
    ds_read_b64_tr_b16 a[10:11], v255 offset:64
    s_waitcnt lgkmcnt(8)
    v_cndmask_b32 v150, v124, v150, s[64:65]
    v_cndmask_b32 v151, v124, v151, s[66:67]
    s_and_b32 s61, s61, 0xfffffff
    s_waitcnt lgkmcnt(6)
    v_cndmask_b32 v156, v124, v156, s[60:61]
    s_and_b32 s63, s63, 0xfffffff
    v_cndmask_b32 v157, v124, v157, s[62:63]
    s_and_b32 s65, s65, 0xfffffff
    v_cndmask_b32 v158, v124, v158, s[64:65]
    s_and_b32 s67, s67, 0xfffffff
    v_cndmask_b32 v159, v124, v159, s[66:67]
    s_mov_b32 s73, s61
    v_cndmask_b32 v144, v124, v144, s[72:73]
    s_mov_b32 s71, s63
    v_cndmask_b32 v145, v124, v145, s[70:71]
    s_and_b32 s72, s64, 0xfff00000
    s_mov_b32 s73, s65
    v_cndmask_b32 v146, v124, v146, s[72:73]
    s_and_b32 s70, s66, 0xfff00000
    s_mov_b32 s71, s67
    v_cndmask_b32 v147, v124, v147, s[70:71]
    s_and_b32 s61, s61, 0xff
    v_cndmask_b32 v152, v124, v152, s[60:61]
    s_and_b32 s63, s63, 0xff
    v_cndmask_b32 v153, v124, v153, s[62:63]
    s_and_b32 s65, s65, 0xff
    v_cndmask_b32 v154, v124, v154, s[64:65]
    s_and_b32 s67, s67, 0xff
    v_cndmask_b32 v155, v124, v155, s[66:67]
    ds_write_b128 v123, v[144:147]
    ds_write_b128 v123, v[148:151] offset:960
    ds_write_b128 v123, v[152:155] offset:1920
    ds_write_b128 v123, v[156:159] offset:2880
    s_mov_b32 s60, 0x2222
    s_cmp_eq_u32 s47, 1
    s_cmov_b32 s60, 0xbbbb
    v_bfe_u32 v234, s60, v232, 4
    v_mad_u32_u24 v235, v234, s40, v228
    v_mad_u32_u24 v234, v234, s40, v229
    s_mov_b32 s61, 0x4444
    s_cmp_eq_u32 s47, 1
    s_cmov_b32 s61, 0x4241
    v_bfe_u32 v250, s61, v232, 4
    s_mov_b32 s62, 0x8808
    s_cmp_eq_u32 s47, 1
    s_cmov_b32 s62, 0x8898
    s_mov_b32 s63, 0x32104321
    s_cmp_eq_u32 s47, 1
    s_cmov_b32 s63, 0x30a940ba
    s_mov_b32 s64, 0x76540765
    s_cmp_eq_u32 s47, 1
    s_cmov_b32 s64, 0x76549765
    s_mov_b32 s65, 0x2222
    s_cmp_eq_u32 s47, 1
    s_cmov_b32 s65, 0x2221
    s_mov_b32 s66, 0x10002100
    s_cmp_eq_u32 s47, 1
    s_cmov_b32 s66, 0x10002000
    s_mov_b32 s67, 0x54326543
    s_mov_b32 s70, 0x76540765
    s_mov_b32 s71, 0x10002100
    s_mov_b32 s72, 0x760007
    ds_read_b128 v[144:147], v235
    v_bfe_u32 v235, s62, v232, 4
    ds_read_b128 v[148:151], v234
    v_mad_u32_u24 v234, v250, s40, v229
    v_mad_u32_u24 v250, v250, s40, v228
    ds_read_b128 v[152:155], v234
    v_bfe_u32 v234, s60, v232, 4
    v_mad_u32_u24 v234, v234, s40, v230
    ds_read_b128 v[156:159], v250
    v_mad_u32_u24 v250, v235, s40, v229
    v_mad_u32_u24 v235, v235, s40, v228
    ds_read_b128 v[160:163], v228 offset:1920
    s_waitcnt vmcnt(3)
    s_barrier
    buffer_load_dwordx4 v251, s[8:11], s57 offen lds
    buffer_load_dwordx4 v252, s[8:11], s57 offen offset:1024 lds
    ds_read_b128 a[236:239], v224
    ds_read_b128 a[240:243], v224 offset:64
    ds_read_b128 a[244:247], v224 offset:128
    ds_read_b128 a[248:251], v224 offset:192
    buffer_load_dwordx4 v253, s[8:11], s57 offen offset:2048 lds
    s_add_u32 s57, s49, 0x1b180
    s_add_u32 m0, s50, 0x9000
    ds_read_b128 a[252:255], v224 offset:256
    ds_read_b128 a[220:223], v224 offset:320
    ds_read_b128 a[224:227], v224 offset:3072
    ds_read_b128 a[228:231], v224 offset:3136
    ds_read_b128 a[232:235], v224 offset:3200
    buffer_load_dwordx4 v251, s[8:11], s57 offen lds
    s_waitcnt lgkmcnt(8)
    v_mfma_f32_16x16x32_bf16 v[220:223], a[0:3], a[236:239], 0
    ds_read_b128 v[164:167], v229 offset:1920
    v_mfma_f32_16x16x32_bf16 v[216:219], a[4:7], a[236:239], 0
    ds_read_b128 v[168:171], v250
    v_bfe_u32 v250, s62, v232, 4
    v_mfma_f32_16x16x32_bf16 v[212:215], a[8:11], a[236:239], 0
    s_waitcnt vmcnt(4) lgkmcnt(4)
    v_mad_u32_u24 v250, v250, s40, v230
    ds_read_b128 a[236:239], v224 offset:3264
    buffer_load_dwordx4 v252, s[8:11], s57 offen offset:1024 lds
    ds_read_b64_tr_b16 a[12:13], v254 offset:12288
    ds_read_b64_tr_b16 a[14:15], v255 offset:12288
    ds_read_b64_tr_b16 a[16:17], v254 offset:12320
    ds_read_b64_tr_b16 a[18:19], v255 offset:12320
    v_mfma_f32_16x16x32_bf16 v[208:211], a[0:3], a[224:227], 0
    ds_read_b64_tr_b16 a[20:21], v254 offset:12352
    ds_read_b64_tr_b16 a[22:23], v255 offset:12352
    v_mfma_f32_16x16x32_bf16 v[204:207], a[4:7], a[224:227], 0
    ds_read_b128 v[172:175], v235
    v_bfe_u32 v235, s61, v232, 4
    v_mfma_f32_16x16x32_bf16 v[200:203], a[8:11], a[224:227], 0
    s_waitcnt lgkmcnt(5)
    buffer_load_dwordx4 v253, s[8:11], s57 offen offset:2048 lds
    s_add_u32 s57, s49, 0x24180
    s_add_u32 m0, s50, 0xc000
    ds_read_b128 a[224:227], v224 offset:15680
    v_mad_u32_u24 v235, v235, s40, v230
    buffer_load_dwordx4 v251, s[8:11], s57 offen lds
    v_mfma_f32_16x16x32_bf16 v[220:223], a[12:15], a[240:243], v[220:223]
    s_waitcnt lgkmcnt(4)
    v_mfma_f32_16x16x32_bf16 v[216:219], a[16:19], a[240:243], v[216:219]
    s_waitcnt lgkmcnt(2)
    v_mfma_f32_16x16x32_bf16 v[212:215], a[20:23], a[240:243], v[212:215]
    ds_read_b128 a[240:243], v224 offset:3328
    v_mfma_f32_16x16x32_bf16 v[208:211], a[12:15], a[228:231], v[208:211]
    buffer_load_dwordx4 v252, s[8:11], s57 offen offset:1024 lds
    v_mfma_f32_16x16x32_bf16 v[204:207], a[16:19], a[228:231], v[204:207]
    v_mfma_f32_16x16x32_bf16 v[200:203], a[20:23], a[228:231], v[200:203]
    s_waitcnt vmcnt(5)
    ds_read_b128 a[228:231], v224 offset:15744
    buffer_load_dwordx4 v253, s[8:11], s57 offen offset:2048 lds
    s_add_u32 s57, s49, 0x2d180
    s_add_u32 m0, s50, 0xf000
    s_nop 0
    buffer_load_dwordx4 v251, s[8:11], s57 offen lds
    buffer_load_dwordx4 v252, s[8:11], s57 offen offset:1024 lds
    ds_read_b64_tr_b16 a[24:25], v254 offset:24576
    ds_read_b64_tr_b16 a[26:27], v255 offset:24576
    ds_read_b64_tr_b16 a[28:29], v254 offset:24608
    ds_read_b64_tr_b16 a[30:31], v255 offset:24608
    ds_read_b64_tr_b16 a[32:33], v254 offset:24640
    ds_read_b64_tr_b16 a[34:35], v255 offset:24640
    buffer_load_dwordx4 v253, s[8:11], s57 offen offset:2048 lds
    s_add_u32 m0, s41, 0x7900
    s_add_u32 s57, s49, 0x300
    buffer_load_dwordx4 v246, s[4:7], s56 offen lds
    s_waitcnt lgkmcnt(4)
    v_mfma_f32_16x16x32_bf16 v[220:223], a[24:27], a[244:247], v[220:223]
    s_waitcnt lgkmcnt(2)
    v_mfma_f32_16x16x32_bf16 v[216:219], a[28:31], a[244:247], v[216:219]
    s_waitcnt lgkmcnt(0)
    v_mfma_f32_16x16x32_bf16 v[212:215], a[32:35], a[244:247], v[212:215]
    ds_read_b128 a[244:247], v224 offset:3392
    v_mfma_f32_16x16x32_bf16 v[208:211], a[24:27], a[232:235], v[208:211]
    s_waitcnt vmcnt(7)
    buffer_load_dwordx4 v247, s[4:7], s56 offen offset:1024 lds
    v_mfma_f32_16x16x32_bf16 v[204:207], a[28:31], a[232:235], v[204:207]
    s_add_u32 s56, s56, s42
    ds_read_b64_tr_b16 a[36:37], v254 offset:36864
    ds_read_b64_tr_b16 a[38:39], v255 offset:36864
    v_mfma_f32_16x16x32_bf16 v[200:203], a[32:35], a[232:235], v[200:203]
    s_add_u32 m0, s41, 0x9740
    ds_read_b128 a[232:235], v224 offset:15808
    ds_read_b64_tr_b16 a[40:41], v254 offset:36896
    ds_read_b64_tr_b16 a[42:43], v255 offset:36896
    ds_read_b64_tr_b16 a[44:45], v254 offset:36928
    ds_read_b64_tr_b16 a[46:47], v255 offset:36928
    buffer_load_dwordx4 v246, s[4:7], s56 offen lds
    buffer_load_dwordx4 v247, s[4:7], s56 offen offset:1024 lds
    s_add_u32 s56, s56, s42
    s_add_u32 m0, s41, 0xb580
    s_waitcnt lgkmcnt(5)
    v_mfma_f32_16x16x32_bf16 v[220:223], a[36:39], a[248:251], v[220:223]
    v_mfma_f32_16x16x32_bf16 v[208:211], a[36:39], a[236:239], v[208:211]
    s_waitcnt lgkmcnt(2)
    v_mfma_f32_16x16x32_bf16 v[216:219], a[40:43], a[248:251], v[216:219]
    s_waitcnt lgkmcnt(0)
    v_mfma_f32_16x16x32_bf16 v[212:215], a[44:47], a[248:251], v[212:215]
    buffer_load_dwordx4 v246, s[4:7], s56 offen lds
    v_mfma_f32_16x16x32_bf16 v[204:207], a[40:43], a[236:239], v[204:207]
    s_waitcnt vmcnt(8)
    ds_read_b128 a[248:251], v224 offset:15488
    ds_read_b64_tr_b16 a[48:49], v254 offset:49152
    v_mfma_f32_16x16x32_bf16 v[200:203], a[44:47], a[236:239], v[200:203]
    ds_read_b128 a[236:239], v224 offset:18560
    ds_read_b64_tr_b16 a[50:51], v255 offset:49152
    ds_read_b64_tr_b16 a[52:53], v254 offset:49184
    ds_read_b64_tr_b16 a[54:55], v255 offset:49184
    buffer_load_dwordx4 v247, s[4:7], s56 offen offset:1024 lds
    s_add_u32 s56, s56, s42
    s_add_u32 m0, s41, 0xd3c0
    ds_read_b64_tr_b16 a[56:57], v254 offset:49216
    ds_read_b64_tr_b16 a[58:59], v255 offset:49216
    buffer_load_dwordx4 v246, s[4:7], s56 offen lds
    s_waitcnt lgkmcnt(4)
    v_mfma_f32_16x16x32_bf16 v[220:223], a[48:51], a[252:255], v[220:223]
    s_waitcnt lgkmcnt(2)
    v_mfma_f32_16x16x32_bf16 v[216:219], a[52:55], a[252:255], v[216:219]
    s_waitcnt vmcnt(7) lgkmcnt(0)
    buffer_load_dwordx4 v247, s[4:7], s56 offen offset:1024 lds
    v_mfma_f32_16x16x32_bf16 v[212:215], a[56:59], a[252:255], v[212:215]
    s_add_u32 m0, s50, 0
    ds_read_b128 a[252:255], v224 offset:15552
    ds_read_b64_tr_b16 a[60:61], v254 offset:61440
    v_mfma_f32_16x16x32_bf16 v[208:211], a[48:51], a[240:243], v[208:211]
    s_add_u32 s56, s56, s42
    ds_read_b64_tr_b16 a[62:63], v255 offset:61440
    ds_read_b64_tr_b16 a[64:65], v254 offset:61472
    v_mfma_f32_16x16x32_bf16 v[204:207], a[52:55], a[240:243], v[204:207]
    ds_read_b64_tr_b16 a[66:67], v255 offset:61472
    ds_read_b64_tr_b16 a[68:69], v254 offset:61504
    v_mfma_f32_16x16x32_bf16 v[200:203], a[56:59], a[240:243], v[200:203]
    s_waitcnt lgkmcnt(3)
    ds_read_b128 a[240:243], v224 offset:18624
    buffer_load_dwordx4 v251, s[8:11], s57 offen lds
    ds_read_b64_tr_b16 a[70:71], v255 offset:61504
    buffer_load_dwordx4 v252, s[8:11], s57 offen offset:1024 lds
    v_mfma_f32_16x16x32_bf16 v[220:223], a[60:63], a[220:223], v[220:223]
    s_waitcnt lgkmcnt(3)
    v_mfma_f32_16x16x32_bf16 v[216:219], a[64:67], a[220:223], v[216:219]
    v_mfma_f32_16x16x32_bf16 v[208:211], a[60:63], a[244:247], v[208:211]
    s_waitcnt lgkmcnt(0)
    v_mfma_f32_16x16x32_bf16 v[212:215], a[68:71], a[220:223], v[212:215]
    ds_read_b128 a[220:223], v224 offset:15616
    v_mfma_f32_16x16x32_bf16 v[204:207], a[64:67], a[244:247], v[204:207]
    buffer_load_dwordx4 v253, s[8:11], s57 offen offset:2048 lds
    v_mfma_f32_16x16x32_bf16 v[200:203], a[68:71], a[244:247], v[200:203]
    s_add_u32 s57, s49, 0x9300
    v_cvt_pk_bf16_f32 v0, v220, v221
    v_cvt_pk_bf16_f32 v1, v222, v223
    v_mfma_f32_16x16x32_bf16 v[220:223], a[0:3], a[248:251], 0
    s_add_u32 m0, s50, 0x3000
    v_cvt_pk_bf16_f32 v2, v216, v217
    v_cvt_pk_bf16_f32 v3, v218, v219
    v_mfma_f32_16x16x32_bf16 v[220:223], a[12:15], a[252:255], v[220:223]
    v_cvt_pk_bf16_f32 v4, v212, v213
    v_cvt_pk_bf16_f32 v5, v214, v215
    v_mfma_f32_16x16x32_bf16 v[216:219], a[4:7], a[248:251], 0
    v_cvt_pk_bf16_f32 v24, v208, v209
    v_cvt_pk_bf16_f32 v25, v210, v211
    v_mfma_f32_16x16x32_bf16 v[216:219], a[16:19], a[252:255], v[216:219]
    v_cvt_pk_bf16_f32 v26, v204, v205
    v_cvt_pk_bf16_f32 v27, v206, v207
    v_mfma_f32_16x16x32_bf16 v[212:215], a[8:11], a[248:251], 0
    v_cvt_pk_bf16_f32 v28, v200, v201
    v_cvt_pk_bf16_f32 v29, v202, v203
    v_mfma_f32_16x16x32_bf16 v[212:215], a[20:23], a[252:255], v[212:215]
    s_waitcnt lgkmcnt(0)
    ds_read_b128 a[244:247], v224 offset:18688
    ds_read_b128 a[248:251], v224 offset:18752
    v_mfma_f32_16x16x32_bf16 v[220:223], a[24:27], a[220:223], v[220:223]
    ds_read_b128 a[252:255], v224 offset:18816
    v_mfma_f32_16x16x32_bf16 v[220:223], a[36:39], a[224:227], v[220:223]
    buffer_load_dwordx4 v251, s[8:11], s57 offen lds
    v_mfma_f32_16x16x32_bf16 v[216:219], a[28:31], a[220:223], v[216:219]
    buffer_load_dwordx4 v252, s[8:11], s57 offen offset:1024 lds
    v_mfma_f32_16x16x32_bf16 v[216:219], a[40:43], a[224:227], v[216:219]
    v_mfma_f32_16x16x32_bf16 v[212:215], a[32:35], a[220:223], v[212:215]
    ds_read_b128 a[220:223], v224 offset:18880
    v_mfma_f32_16x16x32_bf16 v[212:215], a[44:47], a[224:227], v[212:215]
    ds_read_b128 a[224:227], v227 offset:6144
    v_mfma_f32_16x16x32_bf16 v[220:223], a[48:51], a[228:231], v[220:223]
    buffer_load_dwordx4 v253, s[8:11], s57 offen offset:2048 lds
    v_mfma_f32_16x16x32_bf16 v[220:223], a[60:63], a[232:235], v[220:223]
    s_add_u32 s57, s49, 0x12300
    s_add_u32 m0, s50, 0x6000
    v_mfma_f32_16x16x32_bf16 v[216:219], a[52:55], a[228:231], v[216:219]
    v_mfma_f32_16x16x32_bf16 v[216:219], a[64:67], a[232:235], v[216:219]
    v_mfma_f32_16x16x32_bf16 v[212:215], a[56:59], a[228:231], v[212:215]
    ds_read_b128 a[228:231], v227 offset:6208
    v_mfma_f32_16x16x32_bf16 v[212:215], a[68:71], a[232:235], v[212:215]
    ds_read_b128 a[232:235], v227 offset:6272
    v_cvt_pk_bf16_f32 v6, v220, v221
    v_mfma_f32_16x16x32_bf16 v[208:211], a[0:3], a[236:239], 0
    v_cvt_pk_bf16_f32 v7, v222, v223
    v_mfma_f32_16x16x32_bf16 v[208:211], a[12:15], a[240:243], v[208:211]
    v_cvt_pk_bf16_f32 v8, v216, v217
    v_cvt_pk_bf16_f32 v9, v218, v219
    v_mfma_f32_16x16x32_bf16 v[204:207], a[4:7], a[236:239], 0
    v_cvt_pk_bf16_f32 v10, v212, v213
    v_cvt_pk_bf16_f32 v11, v214, v215
    v_mfma_f32_16x16x32_bf16 v[204:207], a[16:19], a[240:243], v[204:207]
    buffer_load_dwordx4 v251, s[8:11], s57 offen lds
    v_mfma_f32_16x16x32_bf16 v[200:203], a[8:11], a[236:239], 0
    ds_read_b128 a[236:239], v227 offset:6336
    v_mfma_f32_16x16x32_bf16 v[200:203], a[20:23], a[240:243], v[200:203]
    s_waitcnt lgkmcnt(3)
    ds_read_b128 a[240:243], v227 offset:6400
    v_mfma_f32_16x16x32_bf16 v[208:211], a[24:27], a[244:247], v[208:211]
    buffer_load_dwordx4 v252, s[8:11], s57 offen offset:1024 lds
    v_mfma_f32_16x16x32_bf16 v[208:211], a[36:39], a[248:251], v[208:211]
    v_mfma_f32_16x16x32_bf16 v[204:207], a[28:31], a[244:247], v[204:207]
    buffer_load_dwordx4 v253, s[8:11], s57 offen offset:2048 lds
    v_mfma_f32_16x16x32_bf16 v[204:207], a[40:43], a[248:251], v[204:207]
    s_add_u32 s57, s49, 0x1b300
    s_add_u32 m0, s50, 0x9000
    v_mfma_f32_16x16x32_bf16 v[200:203], a[32:35], a[244:247], v[200:203]
    ds_read_b128 a[244:247], v227 offset:6464
    v_mfma_f32_16x16x32_bf16 v[200:203], a[44:47], a[248:251], v[200:203]
    v_mfma_f32_16x16x32_bf16 v[208:211], a[48:51], a[252:255], v[208:211]
    s_waitcnt vmcnt(13)
    buffer_load_dwordx4 v251, s[8:11], s57 offen lds
    v_mfma_f32_16x16x32_bf16 v[208:211], a[60:63], a[220:223], v[208:211]
    s_barrier
    ds_read_b128 a[248:251], v224 offset:30976
    v_mfma_f32_16x16x32_bf16 v[204:207], a[52:55], a[252:255], v[204:207]
    v_mfma_f32_16x16x32_bf16 v[204:207], a[64:67], a[220:223], v[204:207]
    v_mfma_f32_16x16x32_bf16 v[200:203], a[56:59], a[252:255], v[200:203]
    ds_read_b128 a[252:255], v224 offset:31040
    v_mfma_f32_16x16x32_bf16 v[200:203], a[68:71], a[220:223], v[200:203]
    ds_read_b128 a[220:223], v224 offset:31104
    v_cvt_pk_bf16_f32 v30, v208, v209
    v_mfma_f32_16x16x32_bf16 v[220:223], a[0:3], a[224:227], 0
    s_waitcnt lgkmcnt(4)
    v_cvt_pk_bf16_f32 v31, v210, v211
    v_mfma_f32_16x16x32_bf16 v[220:223], a[12:15], a[228:231], v[220:223]
    v_cvt_pk_bf16_f32 v32, v204, v205
    v_cvt_pk_bf16_f32 v33, v206, v207
    v_mfma_f32_16x16x32_bf16 v[216:219], a[4:7], a[224:227], 0
    v_cvt_pk_bf16_f32 v34, v200, v201
    v_cvt_pk_bf16_f32 v35, v202, v203
    v_mfma_f32_16x16x32_bf16 v[216:219], a[16:19], a[228:231], v[216:219]
    buffer_load_dwordx4 v252, s[8:11], s57 offen offset:1024 lds
    v_mfma_f32_16x16x32_bf16 v[212:215], a[8:11], a[224:227], 0
    ds_read_b128 a[224:227], v224 offset:31168
    v_mfma_f32_16x16x32_bf16 v[212:215], a[20:23], a[228:231], v[212:215]
    ds_read_b128 a[228:231], v224 offset:31232
    v_mfma_f32_16x16x32_bf16 v[220:223], a[24:27], a[232:235], v[220:223]
    buffer_load_dwordx4 v253, s[8:11], s57 offen offset:2048 lds
    v_mfma_f32_16x16x32_bf16 v[220:223], a[36:39], a[236:239], v[220:223]
    s_add_u32 s57, s49, 0x24300
    s_add_u32 m0, s50, 0xc000
    v_mfma_f32_16x16x32_bf16 v[216:219], a[28:31], a[232:235], v[216:219]
    buffer_load_dwordx4 v251, s[8:11], s57 offen lds
    v_mfma_f32_16x16x32_bf16 v[216:219], a[40:43], a[236:239], v[216:219]
    v_mfma_f32_16x16x32_bf16 v[212:215], a[32:35], a[232:235], v[212:215]
    ds_read_b128 a[232:235], v224 offset:31296
    v_mfma_f32_16x16x32_bf16 v[212:215], a[44:47], a[236:239], v[212:215]
    s_waitcnt vmcnt(13)
    ds_read_b128 a[236:239], v224 offset:34048
    s_barrier
    v_mfma_f32_16x16x32_bf16 v[220:223], a[48:51], a[240:243], v[220:223]
    s_waitcnt lgkmcnt(4)
    buffer_load_dwordx4 v252, s[8:11], s57 offen offset:1024 lds
    v_mfma_f32_16x16x32_bf16 v[220:223], a[60:63], a[244:247], v[220:223]
    v_mfma_f32_16x16x32_bf16 v[216:219], a[52:55], a[240:243], v[216:219]
    v_mfma_f32_16x16x32_bf16 v[216:219], a[64:67], a[244:247], v[216:219]
    v_mfma_f32_16x16x32_bf16 v[212:215], a[56:59], a[240:243], v[212:215]
    ds_read_b128 a[240:243], v224 offset:34112
    v_mfma_f32_16x16x32_bf16 v[212:215], a[68:71], a[244:247], v[212:215]
    ds_read_b128 a[244:247], v224 offset:34176
    v_mfma_f32_16x16x32_bf16 v[208:211], a[0:3], a[248:251], 0
    buffer_load_dwordx4 v253, s[8:11], s57 offen offset:2048 lds
    v_mfma_f32_16x16x32_bf16 v[208:211], a[12:15], a[252:255], v[208:211]
    s_add_u32 s57, s49, 0x2d300
    v_cvt_pk_bf16_f32 v48, v220, v221
    v_cvt_pk_bf16_f32 v49, v222, v223
    v_mfma_f32_16x16x32_bf16 v[204:207], a[4:7], a[248:251], 0
    s_add_u32 m0, s50, 0xf000
    v_cvt_pk_bf16_f32 v50, v216, v217
    v_cvt_pk_bf16_f32 v51, v218, v219
    v_mfma_f32_16x16x32_bf16 v[204:207], a[16:19], a[252:255], v[204:207]
    v_cvt_pk_bf16_f32 v52, v212, v213
    v_cvt_pk_bf16_f32 v53, v214, v215
    v_mfma_f32_16x16x32_bf16 v[200:203], a[8:11], a[248:251], 0
    ds_read_b128 a[248:251], v224 offset:34240
    v_mfma_f32_16x16x32_bf16 v[200:203], a[20:23], a[252:255], v[200:203]
    s_waitcnt vmcnt(12)
    ds_read_b128 a[252:255], v224 offset:34304
    ds_read_b64_tr_b16 a[72:73], v254
    v_mfma_f32_16x16x32_bf16 v[208:211], a[24:27], a[220:223], v[208:211]
    s_waitcnt lgkmcnt(5)
    buffer_load_dwordx4 v251, s[8:11], s57 offen lds
    v_mfma_f32_16x16x32_bf16 v[208:211], a[36:39], a[224:227], v[208:211]
    buffer_load_dwordx4 v252, s[8:11], s57 offen offset:1024 lds
    v_mfma_f32_16x16x32_bf16 v[204:207], a[28:31], a[220:223], v[204:207]
    ds_read_b64_tr_b16 a[74:75], v255
    ds_read_b64_tr_b16 a[76:77], v254 offset:32
    v_mfma_f32_16x16x32_bf16 v[204:207], a[40:43], a[224:227], v[204:207]
    ds_read_b64_tr_b16 a[78:79], v255 offset:32
    ds_read_b64_tr_b16 a[80:81], v254 offset:64
    v_mfma_f32_16x16x32_bf16 v[200:203], a[32:35], a[220:223], v[200:203]
    ds_read_b128 a[220:223], v224 offset:34368
    ds_read_b64_tr_b16 a[82:83], v255 offset:64
    v_mfma_f32_16x16x32_bf16 v[200:203], a[44:47], a[224:227], v[200:203]
    ds_read_b128 a[224:227], v224 offset:46464
    v_mfma_f32_16x16x32_bf16 v[208:211], a[48:51], a[228:231], v[208:211]
    buffer_load_dwordx4 v253, s[8:11], s57 offen offset:2048 lds
    v_mfma_f32_16x16x32_bf16 v[208:211], a[60:63], a[232:235], v[208:211]
    s_add_u32 s57, s49, 0
    s_add_u32 m0, s50, 0
    v_mfma_f32_16x16x32_bf16 v[204:207], a[52:55], a[228:231], v[204:207]
    v_mfma_f32_16x16x32_bf16 v[204:207], a[64:67], a[232:235], v[204:207]
    v_mfma_f32_16x16x32_bf16 v[200:203], a[56:59], a[228:231], v[200:203]
    ds_read_b128 a[228:231], v224 offset:46528
    v_mfma_f32_16x16x32_bf16 v[200:203], a[68:71], a[232:235], v[200:203]
    ds_read_b128 a[232:235], v224 offset:46592
    v_cvt_pk_bf16_f32 v12, v208, v209
    v_mfma_f32_16x16x32_bf16 v[220:223], a[0:3], a[236:239], 0
    s_waitcnt vmcnt(12) lgkmcnt(6)
    ds_read_b64_tr_b16 a[84:85], v254 offset:12288
    v_cvt_pk_bf16_f32 v13, v210, v211
    v_mfma_f32_16x16x32_bf16 v[220:223], a[12:15], a[240:243], v[220:223]
    v_cvt_pk_bf16_f32 v14, v204, v205
    v_cvt_pk_bf16_f32 v15, v206, v207
    v_mfma_f32_16x16x32_bf16 v[216:219], a[4:7], a[236:239], 0
    v_cvt_pk_bf16_f32 v16, v200, v201
    v_cvt_pk_bf16_f32 v17, v202, v203
    v_mfma_f32_16x16x32_bf16 v[216:219], a[16:19], a[240:243], v[216:219]
    s_waitcnt lgkmcnt(3)
    buffer_load_dwordx4 v251, s[8:11], s57 offen lds
    v_mfma_f32_16x16x32_bf16 v[212:215], a[8:11], a[236:239], 0
    ds_read_b128 a[236:239], v224 offset:46656
    ds_read_b64_tr_b16 a[86:87], v255 offset:12288
    v_mfma_f32_16x16x32_bf16 v[212:215], a[20:23], a[240:243], v[212:215]
    ds_read_b128 a[240:243], v224 offset:46720
    v_mfma_f32_16x16x32_bf16 v[220:223], a[24:27], a[244:247], v[220:223]
    buffer_load_dwordx4 v252, s[8:11], s57 offen offset:1024 lds
    v_mfma_f32_16x16x32_bf16 v[220:223], a[36:39], a[248:251], v[220:223]
    ds_read_b64_tr_b16 a[88:89], v254 offset:12320
    ds_read_b64_tr_b16 a[90:91], v255 offset:12320
    v_mfma_f32_16x16x32_bf16 v[216:219], a[28:31], a[244:247], v[216:219]
    buffer_load_dwordx4 v253, s[8:11], s57 offen offset:2048 lds
    v_mfma_f32_16x16x32_bf16 v[216:219], a[40:43], a[248:251], v[216:219]
    s_add_u32 s57, s49, 0x9000
    ds_read_b64_tr_b16 a[92:93], v254 offset:12352
    ds_read_b64_tr_b16 a[94:95], v255 offset:12352
    v_mfma_f32_16x16x32_bf16 v[212:215], a[32:35], a[244:247], v[212:215]
    s_add_u32 m0, s50, 0x3000
    ds_read_b128 a[244:247], v224 offset:46784
    v_mfma_f32_16x16x32_bf16 v[212:215], a[44:47], a[248:251], v[212:215]
    s_waitcnt vmcnt(12)
    ds_read_b128 a[248:251], v224 offset:49536
    ds_read_b64_tr_b16 a[96:97], v254 offset:24576
    v_mfma_f32_16x16x32_bf16 v[220:223], a[48:51], a[252:255], v[220:223]
    ds_read_b64_tr_b16 a[98:99], v255 offset:24576
    ds_read_b64_tr_b16 a[100:101], v254 offset:24608
    v_mfma_f32_16x16x32_bf16 v[220:223], a[60:63], a[220:223], v[220:223]
    ds_read_b64_tr_b16 a[102:103], v255 offset:24608
    ds_read_b64_tr_b16 a[104:105], v254 offset:24640
    v_mfma_f32_16x16x32_bf16 v[216:219], a[52:55], a[252:255], v[216:219]
    ds_read_b64_tr_b16 a[106:107], v255 offset:24640
    v_mfma_f32_16x16x32_bf16 v[216:219], a[64:67], a[220:223], v[216:219]
    v_mfma_f32_16x16x32_bf16 v[212:215], a[56:59], a[252:255], v[212:215]
    ds_read_b128 a[252:255], v224 offset:49600
    v_mfma_f32_16x16x32_bf16 v[212:215], a[68:71], a[220:223], v[212:215]
    v_cvt_pk_bf16_f32 v36, v220, v221
    v_cvt_pk_bf16_f32 v37, v222, v223
    v_mfma_f32_16x16x32_bf16 v[208:211], a[0:3], a[224:227], 0
    s_waitcnt lgkmcnt(10)
    ds_read_b128 a[220:223], v224 offset:49664
    v_mfma_f32_16x16x32_bf16 v[208:211], a[12:15], a[228:231], v[208:211]
    v_cvt_pk_bf16_f32 v38, v216, v217
    v_cvt_pk_bf16_f32 v39, v218, v219
    v_mfma_f32_16x16x32_bf16 v[204:207], a[4:7], a[224:227], 0
    v_cvt_pk_bf16_f32 v40, v212, v213
    v_cvt_pk_bf16_f32 v41, v214, v215
    v_mfma_f32_16x16x32_bf16 v[204:207], a[16:19], a[228:231], v[204:207]
    s_waitcnt lgkmcnt(7)
    buffer_load_dwordx4 v251, s[8:11], s57 offen lds
    v_mfma_f32_16x16x32_bf16 v[200:203], a[8:11], a[224:227], 0
    ds_read_b128 a[224:227], v224 offset:49728
    v_mfma_f32_16x16x32_bf16 v[200:203], a[20:23], a[228:231], v[200:203]
    s_waitcnt vmcnt(10)
    ds_read_b128 a[228:231], v224 offset:49792
    ds_read_b64_tr_b16 a[108:109], v254 offset:36864
    v_mfma_f32_16x16x32_bf16 v[208:211], a[24:27], a[232:235], v[208:211]
    buffer_load_dwordx4 v252, s[8:11], s57 offen offset:1024 lds
    v_mfma_f32_16x16x32_bf16 v[208:211], a[36:39], a[236:239], v[208:211]
    ds_read_b64_tr_b16 a[110:111], v255 offset:36864
    ds_read_b64_tr_b16 a[112:113], v254 offset:36896
    v_mfma_f32_16x16x32_bf16 v[204:207], a[28:31], a[232:235], v[204:207]
    buffer_load_dwordx4 v253, s[8:11], s57 offen offset:2048 lds
    v_mfma_f32_16x16x32_bf16 v[204:207], a[40:43], a[236:239], v[204:207]
    s_add_u32 s57, s49, 0x12000
    ds_read_b64_tr_b16 a[114:115], v255 offset:36896
    ds_read_b64_tr_b16 a[116:117], v254 offset:36928
    v_mfma_f32_16x16x32_bf16 v[200:203], a[32:35], a[232:235], v[200:203]
    s_add_u32 m0, s50, 0x6000
    ds_read_b128 a[232:235], v224 offset:49856
    ds_read_b64_tr_b16 a[118:119], v255 offset:36928
    v_mfma_f32_16x16x32_bf16 v[200:203], a[44:47], a[236:239], v[200:203]
    ds_read_b128 a[236:239], v227 offset:37120
    v_mfma_f32_16x16x32_bf16 v[208:211], a[48:51], a[240:243], v[208:211]
    s_waitcnt lgkmcnt(10)
    buffer_load_dwordx4 v251, s[8:11], s57 offen lds
    v_mfma_f32_16x16x32_bf16 v[208:211], a[60:63], a[244:247], v[208:211]
    v_mfma_f32_16x16x32_bf16 v[204:207], a[52:55], a[240:243], v[204:207]
    v_mfma_f32_16x16x32_bf16 v[204:207], a[64:67], a[244:247], v[204:207]
    v_mfma_f32_16x16x32_bf16 v[200:203], a[56:59], a[240:243], v[200:203]
    ds_read_b128 a[240:243], v227 offset:37184
    v_mfma_f32_16x16x32_bf16 v[200:203], a[68:71], a[244:247], v[200:203]
    s_waitcnt vmcnt(10)
    ds_read_b128 a[244:247], v227 offset:37248
    ds_read_b64_tr_b16 a[120:121], v254 offset:49152
    v_mfma_f32_16x16x32_bf16 v[220:223], a[0:3], a[248:251], 0
    v_cvt_pk_bf16_f32 v18, v208, v209
    v_cvt_pk_bf16_f32 v19, v210, v211
    v_mfma_f32_16x16x32_bf16 v[220:223], a[12:15], a[252:255], v[220:223]
    v_cvt_pk_bf16_f32 v20, v204, v205
    v_cvt_pk_bf16_f32 v21, v206, v207
    v_mfma_f32_16x16x32_bf16 v[216:219], a[4:7], a[248:251], 0
    v_cvt_pk_bf16_f32 v22, v200, v201
    v_cvt_pk_bf16_f32 v23, v202, v203
    v_mfma_f32_16x16x32_bf16 v[216:219], a[16:19], a[252:255], v[216:219]
    buffer_load_dwordx4 v252, s[8:11], s57 offen offset:1024 lds
    v_mfma_f32_16x16x32_bf16 v[212:215], a[8:11], a[248:251], 0
    ds_read_b128 a[248:251], v227 offset:37312
    ds_read_b64_tr_b16 a[122:123], v255 offset:49152
    v_mfma_f32_16x16x32_bf16 v[212:215], a[20:23], a[252:255], v[212:215]
    ds_read_b128 a[252:255], v227 offset:37376
    v_mfma_f32_16x16x32_bf16 v[220:223], a[24:27], a[220:223], v[220:223]
    s_waitcnt lgkmcnt(6)
    buffer_load_dwordx4 v253, s[8:11], s57 offen offset:2048 lds
    v_mfma_f32_16x16x32_bf16 v[220:223], a[36:39], a[224:227], v[220:223]
    s_add_u32 s57, s49, 0x1b000
    ds_read_b64_tr_b16 a[124:125], v254 offset:49184
    ds_read_b64_tr_b16 a[126:127], v255 offset:49184
    v_mfma_f32_16x16x32_bf16 v[216:219], a[28:31], a[220:223], v[216:219]
    s_add_u32 m0, s50, 0x9000
    ds_read_b64_tr_b16 a[128:129], v254 offset:49216
    ds_read_b64_tr_b16 a[130:131], v255 offset:49216
    v_mfma_f32_16x16x32_bf16 v[216:219], a[40:43], a[224:227], v[216:219]
    buffer_load_dwordx4 v251, s[8:11], s57 offen lds
    v_mfma_f32_16x16x32_bf16 v[212:215], a[32:35], a[220:223], v[212:215]
    ds_read_b128 a[220:223], v227 offset:37440
    v_mfma_f32_16x16x32_bf16 v[212:215], a[44:47], a[224:227], v[212:215]
    s_waitcnt vmcnt(10)
    ds_read_b128 a[224:227], v224
    ds_read_b64_tr_b16 a[132:133], v254 offset:61440
    v_mfma_f32_16x16x32_bf16 v[220:223], a[48:51], a[228:231], v[220:223]
    buffer_load_dwordx4 v252, s[8:11], s57 offen offset:1024 lds
    v_mfma_f32_16x16x32_bf16 v[220:223], a[60:63], a[232:235], v[220:223]
    ds_read_b64_tr_b16 a[134:135], v255 offset:61440
    ds_read_b64_tr_b16 a[136:137], v254 offset:61472
    v_mfma_f32_16x16x32_bf16 v[216:219], a[52:55], a[228:231], v[216:219]
    ds_read_b64_tr_b16 a[138:139], v255 offset:61472
    ds_read_b64_tr_b16 a[140:141], v254 offset:61504
    v_mfma_f32_16x16x32_bf16 v[216:219], a[64:67], a[232:235], v[216:219]
    ds_read_b64_tr_b16 a[142:143], v255 offset:61504
    v_mfma_f32_16x16x32_bf16 v[212:215], a[56:59], a[228:231], v[212:215]
    v_cvt_pk_bf16_f32 v42, v220, v221
    v_cvt_pk_bf16_f32 v43, v222, v223
    v_mfma_f32_16x16x32_bf16 v[212:215], a[68:71], a[232:235], v[212:215]
    ds_read_b128 a[228:231], v224 offset:64
    ds_read_b128 a[232:235], v224 offset:128
    v_mfma_f32_16x16x32_bf16 v[208:211], a[0:3], a[236:239], 0
    s_waitcnt lgkmcnt(10)
    v_cvt_pk_bf16_f32 v44, v216, v217
    v_cvt_pk_bf16_f32 v45, v218, v219
    v_mfma_f32_16x16x32_bf16 v[208:211], a[12:15], a[240:243], v[208:211]
    buffer_load_dwordx4 v253, s[8:11], s57 offen offset:2048 lds
    v_mfma_f32_16x16x32_bf16 v[204:207], a[4:7], a[236:239], 0
    s_add_u32 s57, s49, 0x24000
    v_cvt_pk_bf16_f32 v46, v212, v213
    v_cvt_pk_bf16_f32 v47, v214, v215
    v_mfma_f32_16x16x32_bf16 v[204:207], a[16:19], a[240:243], v[204:207]
    s_add_u32 m0, s50, 0xc000
    v_mfma_f32_16x16x32_bf16 v[200:203], a[8:11], a[236:239], 0
    ds_read_b128 a[236:239], v224 offset:192
    v_mfma_f32_16x16x32_bf16 v[200:203], a[20:23], a[240:243], v[200:203]
    s_waitcnt vmcnt(9)
    ds_read_b128 a[240:243], v224 offset:256
    ds_read_b64_tr_b16 a[144:145], v254
    v_mfma_f32_16x16x32_bf16 v[208:211], a[24:27], a[244:247], v[208:211]
    buffer_load_dwordx4 v251, s[8:11], s57 offen lds
    v_mfma_f32_16x16x32_bf16 v[208:211], a[36:39], a[248:251], v[208:211]
    buffer_load_dwordx4 v252, s[8:11], s57 offen offset:1024 lds
    v_mfma_f32_16x16x32_bf16 v[204:207], a[28:31], a[244:247], v[204:207]
    ds_read_b64_tr_b16 a[146:147], v255
    ds_read_b64_tr_b16 a[148:149], v254 offset:32
    v_mfma_f32_16x16x32_bf16 v[204:207], a[40:43], a[248:251], v[204:207]
    ds_read_b64_tr_b16 a[150:151], v255 offset:32
    ds_read_b64_tr_b16 a[152:153], v254 offset:64
    v_mfma_f32_16x16x32_bf16 v[200:203], a[32:35], a[244:247], v[200:203]
    ds_read_b128 a[244:247], v224 offset:320
    ds_read_b64_tr_b16 a[154:155], v255 offset:64
    v_mfma_f32_16x16x32_bf16 v[200:203], a[44:47], a[248:251], v[200:203]
    ds_read_b128 a[248:251], v224 offset:3072
    v_mfma_f32_16x16x32_bf16 v[208:211], a[48:51], a[252:255], v[208:211]
    s_waitcnt lgkmcnt(10)
    buffer_load_dwordx4 v253, s[8:11], s57 offen offset:2048 lds
    v_mfma_f32_16x16x32_bf16 v[208:211], a[60:63], a[220:223], v[208:211]
    s_add_u32 s57, s49, 0x2d000
    s_add_u32 m0, s50, 0xf000
    v_mfma_f32_16x16x32_bf16 v[204:207], a[52:55], a[252:255], v[204:207]
    v_mfma_f32_16x16x32_bf16 v[204:207], a[64:67], a[220:223], v[204:207]
    buffer_load_dwordx4 v251, s[8:11], s57 offen lds
    v_mfma_f32_16x16x32_bf16 v[200:203], a[56:59], a[252:255], v[200:203]
    ds_read_b128 a[252:255], v224 offset:3136
    v_mfma_f32_16x16x32_bf16 v[200:203], a[68:71], a[220:223], v[200:203]
    v_cvt_pk_bf16_f32 v54, v208, v209
    v_cvt_pk_bf16_f32 v55, v210, v211
    v_mfma_f32_16x16x32_bf16 v[220:223], a[224:227], a[72:75], 0
    ds_read_b128 a[220:223], v224 offset:3200
    v_cvt_pk_bf16_f32 v56, v204, v205
    v_mfma_f32_16x16x32_bf16 v[220:223], a[228:231], a[84:87], v[220:223]
    s_waitcnt vmcnt(10)
    ds_read_b64_tr_b16 a[156:157], v254 offset:12288
    v_cvt_pk_bf16_f32 v57, v206, v207
    v_mfma_f32_16x16x32_bf16 v[216:219], a[224:227], a[76:79], 0
    v_cvt_pk_bf16_f32 v58, v200, v201
    v_cvt_pk_bf16_f32 v59, v202, v203
    v_mfma_f32_16x16x32_bf16 v[216:219], a[228:231], a[88:91], v[216:219]
    buffer_load_dwordx4 v252, s[8:11], s57 offen offset:1024 lds
    v_mfma_f32_16x16x32_bf16 v[212:215], a[224:227], a[80:83], 0
    ds_read_b128 a[224:227], v224 offset:3264
    ds_read_b64_tr_b16 a[158:159], v255 offset:12288
    v_mfma_f32_16x16x32_bf16 v[212:215], a[228:231], a[92:95], v[212:215]
    ds_read_b128 a[228:231], v224 offset:3328
    v_mfma_f32_16x16x32_bf16 v[220:223], a[232:235], a[96:99], v[220:223]
    s_waitcnt lgkmcnt(6)
    buffer_load_dwordx4 v253, s[8:11], s57 offen offset:2048 lds
    v_mfma_f32_16x16x32_bf16 v[220:223], a[236:239], a[108:111], v[220:223]
    s_add_u32 s57, s49, 0
    ds_read_b64_tr_b16 a[160:161], v254 offset:12320
    ds_read_b64_tr_b16 a[162:163], v255 offset:12320
    v_mfma_f32_16x16x32_bf16 v[216:219], a[232:235], a[100:103], v[216:219]
    s_add_u32 m0, s50, 0
    ds_read_b64_tr_b16 a[164:165], v254 offset:12352
    ds_read_b64_tr_b16 a[166:167], v255 offset:12352
    v_mfma_f32_16x16x32_bf16 v[216:219], a[236:239], a[112:115], v[216:219]
    v_mfma_f32_16x16x32_bf16 v[212:215], a[232:235], a[104:107], v[212:215]
    ds_read_b128 a[232:235], v224 offset:3392
    v_mfma_f32_16x16x32_bf16 v[212:215], a[236:239], a[116:119], v[212:215]
    s_waitcnt vmcnt(9)
    ds_read_b128 a[236:239], v224 offset:15488
    ds_read_b64_tr_b16 a[168:169], v254 offset:24576
    v_mfma_f32_16x16x32_bf16 v[220:223], a[240:243], a[120:123], v[220:223]
    buffer_load_dwordx4 v192, s[12:15], s57 offen lds
    v_mfma_f32_16x16x32_bf16 v[220:223], a[244:247], a[132:135], v[220:223]
    ds_read_b64_tr_b16 a[170:171], v255 offset:24576
    ds_read_b64_tr_b16 a[172:173], v254 offset:24608
    v_mfma_f32_16x16x32_bf16 v[216:219], a[240:243], a[124:127], v[216:219]
    buffer_load_dwordx4 v193, s[12:15], s57 offen offset:1024 lds
    v_mfma_f32_16x16x32_bf16 v[216:219], a[244:247], a[136:139], v[216:219]
    ds_read_b64_tr_b16 a[174:175], v255 offset:24608
    ds_read_b64_tr_b16 a[176:177], v254 offset:24640
    v_mfma_f32_16x16x32_bf16 v[212:215], a[240:243], a[128:131], v[212:215]
    v_cvt_pk_bf16_f32 v66, v220, v221
    v_cvt_pk_bf16_f32 v67, v222, v223
    v_mfma_f32_16x16x32_bf16 v[212:215], a[244:247], a[140:143], v[212:215]
    ds_read_b128 a[240:243], v224 offset:15552
    ds_read_b128 a[244:247], v224 offset:15616
    v_mfma_f32_16x16x32_bf16 v[208:211], a[248:251], a[72:75], 0
    s_waitcnt lgkmcnt(9)
    v_cvt_pk_bf16_f32 v88, v216, v217
    v_cvt_pk_bf16_f32 v89, v218, v219
    v_mfma_f32_16x16x32_bf16 v[208:211], a[252:255], a[84:87], v[208:211]
    buffer_load_dwordx4 v194, s[12:15], s57 offen offset:2048 lds
    v_mfma_f32_16x16x32_bf16 v[204:207], a[248:251], a[76:79], 0
    s_add_u32 s57, s49, 0x3000
    v_cvt_pk_bf16_f32 v110, v212, v213
    v_cvt_pk_bf16_f32 v111, v214, v215
    v_mfma_f32_16x16x32_bf16 v[204:207], a[252:255], a[88:91], v[204:207]
    s_add_u32 m0, s50, 0x3000
    ds_read_b64_tr_b16 a[178:179], v255 offset:24640
    v_mfma_f32_16x16x32_bf16 v[200:203], a[248:251], a[80:83], 0
    ds_read_b128 a[248:251], v224 offset:15680
    v_mfma_f32_16x16x32_bf16 v[200:203], a[252:255], a[92:95], v[200:203]
    s_waitcnt vmcnt(9)
    ds_read_b128 a[252:255], v224 offset:15744
    ds_read_b64_tr_b16 a[180:181], v254 offset:36864
    v_mfma_f32_16x16x32_bf16 v[208:211], a[220:223], a[96:99], v[208:211]
    buffer_load_dwordx4 v192, s[12:15], s57 offen lds
    v_mfma_f32_16x16x32_bf16 v[208:211], a[224:227], a[108:111], v[208:211]
    ds_read_b64_tr_b16 a[182:183], v255 offset:36864
    ds_read_b64_tr_b16 a[184:185], v254 offset:36896
    v_mfma_f32_16x16x32_bf16 v[204:207], a[220:223], a[100:103], v[204:207]
    ds_read_b64_tr_b16 a[186:187], v255 offset:36896
    ds_read_b64_tr_b16 a[188:189], v254 offset:36928
    v_mfma_f32_16x16x32_bf16 v[204:207], a[224:227], a[112:115], v[204:207]
    buffer_load_dwordx4 v195, s[12:15], s57 offen offset:1024 lds
    v_mfma_f32_16x16x32_bf16 v[200:203], a[220:223], a[104:107], v[200:203]
    s_addk_i32 s57, 0x3000
    ds_read_b128 a[220:223], v224 offset:15808
    ds_read_b64_tr_b16 a[190:191], v255 offset:36928
    v_mfma_f32_16x16x32_bf16 v[200:203], a[224:227], a[116:119], v[200:203]
    ds_read_b128 a[224:227], v224 offset:18560
    v_mfma_f32_16x16x32_bf16 v[208:211], a[228:231], a[120:123], v[208:211]
    s_waitcnt lgkmcnt(10)
    v_mfma_f32_16x16x32_bf16 v[208:211], a[232:235], a[132:135], v[208:211]
    buffer_load_dwordx4 v194, s[12:15], s57 offen offset:2048 lds
    v_mfma_f32_16x16x32_bf16 v[204:207], a[228:231], a[124:127], v[204:207]
    s_add_u32 s57, s49, 0x4800
    s_add_u32 m0, s50, 0x6000
    v_mfma_f32_16x16x32_bf16 v[204:207], a[232:235], a[136:139], v[204:207]
    v_mfma_f32_16x16x32_bf16 v[200:203], a[228:231], a[128:131], v[200:203]
    ds_read_b128 a[228:231], v224 offset:18624
    v_mfma_f32_16x16x32_bf16 v[200:203], a[232:235], a[140:143], v[200:203]
    v_cvt_pk_bf16_f32 v68, v208, v209
    v_cvt_pk_bf16_f32 v69, v210, v211
    v_mfma_f32_16x16x32_bf16 v[220:223], a[236:239], a[72:75], 0
    s_waitcnt vmcnt(9)
    ds_read_b128 a[232:235], v224 offset:18688
    ds_read_b64_tr_b16 a[192:193], v254 offset:49152
    v_mfma_f32_16x16x32_bf16 v[220:223], a[240:243], a[84:87], v[220:223]
    v_cvt_pk_bf16_f32 v90, v204, v205
    v_cvt_pk_bf16_f32 v91, v206, v207
    v_mfma_f32_16x16x32_bf16 v[216:219], a[236:239], a[76:79], 0
    v_cvt_pk_bf16_f32 v112, v200, v201
    v_cvt_pk_bf16_f32 v113, v202, v203
    v_mfma_f32_16x16x32_bf16 v[216:219], a[240:243], a[88:91], v[216:219]
    buffer_load_dwordx4 v192, s[12:15], s57 offen lds
    v_mfma_f32_16x16x32_bf16 v[212:215], a[236:239], a[80:83], 0
    ds_read_b128 a[236:239], v224 offset:18752
    ds_read_b64_tr_b16 a[194:195], v255 offset:49152
    v_mfma_f32_16x16x32_bf16 v[212:215], a[240:243], a[92:95], v[212:215]
    ds_read_b128 a[240:243], v224 offset:18816
    v_mfma_f32_16x16x32_bf16 v[220:223], a[244:247], a[96:99], v[220:223]
    s_waitcnt lgkmcnt(6)
    buffer_load_dwordx4 v193, s[12:15], s57 offen offset:1024 lds
    v_mfma_f32_16x16x32_bf16 v[220:223], a[248:251], a[108:111], v[220:223]
    ds_read_b64_tr_b16 a[196:197], v254 offset:49184
    ds_read_b64_tr_b16 a[198:199], v255 offset:49184
    v_mfma_f32_16x16x32_bf16 v[216:219], a[244:247], a[100:103], v[216:219]
    buffer_load_dwordx4 v194, s[12:15], s57 offen offset:2048 lds
    v_mfma_f32_16x16x32_bf16 v[216:219], a[248:251], a[112:115], v[216:219]
    s_add_u32 s57, s49, 0x9000
    ds_read_b64_tr_b16 a[200:201], v254 offset:49216
    ds_read_b64_tr_b16 a[202:203], v255 offset:49216
    v_mfma_f32_16x16x32_bf16 v[212:215], a[244:247], a[104:107], v[212:215]
    s_add_u32 m0, s50, 0x9000
    ds_read_b128 a[244:247], v224 offset:18880
    v_mfma_f32_16x16x32_bf16 v[212:215], a[248:251], a[116:119], v[212:215]
    s_waitcnt vmcnt(9)
    ds_read_b128 a[248:251], v227 offset:6144
    ds_read_b64_tr_b16 a[204:205], v254 offset:61440
    v_mfma_f32_16x16x32_bf16 v[220:223], a[252:255], a[120:123], v[220:223]
    buffer_load_dwordx4 v192, s[12:15], s57 offen lds
    v_mfma_f32_16x16x32_bf16 v[220:223], a[220:223], a[132:135], v[220:223]
    ds_read_b64_tr_b16 a[206:207], v255 offset:61440
    ds_read_b64_tr_b16 a[208:209], v254 offset:61472
    v_mfma_f32_16x16x32_bf16 v[216:219], a[252:255], a[124:127], v[216:219]
    ds_read_b64_tr_b16 a[210:211], v255 offset:61472
    ds_read_b64_tr_b16 a[212:213], v254 offset:61504
    v_mfma_f32_16x16x32_bf16 v[216:219], a[220:223], a[136:139], v[216:219]
    ds_read_b64_tr_b16 a[214:215], v255 offset:61504
    v_mfma_f32_16x16x32_bf16 v[212:215], a[252:255], a[128:131], v[212:215]
    v_cvt_pk_bf16_f32 v72, v220, v221
    v_cvt_pk_bf16_f32 v73, v222, v223
    v_mfma_f32_16x16x32_bf16 v[212:215], a[220:223], a[140:143], v[212:215]
    ds_read_b128 a[252:255], v227 offset:6208
    ds_read_b128 a[220:223], v227 offset:6272
    v_mfma_f32_16x16x32_bf16 v[208:211], a[224:227], a[72:75], 0
    s_waitcnt lgkmcnt(11)
    v_cvt_pk_bf16_f32 v94, v216, v217
    v_cvt_pk_bf16_f32 v95, v218, v219
    v_mfma_f32_16x16x32_bf16 v[208:211], a[228:231], a[84:87], v[208:211]
    buffer_load_dwordx4 v193, s[12:15], s57 offen offset:1024 lds
    v_mfma_f32_16x16x32_bf16 v[204:207], a[224:227], a[76:79], 0
    v_cvt_pk_bf16_f32 v116, v212, v213
    v_cvt_pk_bf16_f32 v117, v214, v215
    v_mfma_f32_16x16x32_bf16 v[204:207], a[228:231], a[88:91], v[204:207]
    buffer_load_dwordx4 v194, s[12:15], s57 offen offset:2048 lds
    v_mfma_f32_16x16x32_bf16 v[200:203], a[224:227], a[80:83], 0
    s_add_u32 s57, s49, 0xc000
    ds_read_b128 a[224:227], v227 offset:6336
    s_add_u32 m0, s50, 0xc000
    v_mfma_f32_16x16x32_bf16 v[200:203], a[228:231], a[92:95], v[200:203]
    ds_read_b128 a[228:231], v227 offset:6400
    v_mfma_f32_16x16x32_bf16 v[208:211], a[232:235], a[96:99], v[208:211]
    v_mfma_f32_16x16x32_bf16 v[208:211], a[236:239], a[108:111], v[208:211]
    s_waitcnt lgkmcnt(4)
    buffer_load_dwordx4 v192, s[12:15], s57 offen lds
    v_mfma_f32_16x16x32_bf16 v[204:207], a[232:235], a[100:103], v[204:207]
    v_mfma_f32_16x16x32_bf16 v[204:207], a[236:239], a[112:115], v[204:207]
    v_mfma_f32_16x16x32_bf16 v[200:203], a[232:235], a[104:107], v[200:203]
    ds_read_b128 a[232:235], v227 offset:6464
    v_mfma_f32_16x16x32_bf16 v[200:203], a[236:239], a[116:119], v[200:203]
    ds_read_b128 a[236:239], v225 offset:24384
    v_mfma_f32_16x16x32_bf16 v[208:211], a[240:243], a[120:123], v[208:211]
    buffer_load_dwordx4 v195, s[12:15], s57 offen offset:1024 lds
    v_mfma_f32_16x16x32_bf16 v[208:211], a[244:247], a[132:135], v[208:211]
    s_addk_i32 s57, 0x3000
    v_mfma_f32_16x16x32_bf16 v[204:207], a[240:243], a[124:127], v[204:207]
    v_mfma_f32_16x16x32_bf16 v[204:207], a[244:247], a[136:139], v[204:207]
    v_mfma_f32_16x16x32_bf16 v[200:203], a[240:243], a[128:131], v[200:203]
    ds_read_b128 a[240:243], v225 offset:24448
    v_mfma_f32_16x16x32_bf16 v[200:203], a[244:247], a[140:143], v[200:203]
    ds_read_b128 a[244:247], v225 offset:24512
    v_mfma_f32_16x16x32_bf16 v[220:223], a[248:251], a[72:75], 0
    s_waitcnt lgkmcnt(4)
    v_cvt_pk_bf16_f32 v70, v208, v209
    v_cvt_pk_bf16_f32 v71, v210, v211
    v_mfma_f32_16x16x32_bf16 v[220:223], a[252:255], a[84:87], v[220:223]
    v_cvt_pk_bf16_f32 v92, v204, v205
    v_cvt_pk_bf16_f32 v93, v206, v207
    v_mfma_f32_16x16x32_bf16 v[216:219], a[248:251], a[76:79], 0
    v_cvt_pk_bf16_f32 v114, v200, v201
    v_cvt_pk_bf16_f32 v115, v202, v203
    v_mfma_f32_16x16x32_bf16 v[216:219], a[252:255], a[88:91], v[216:219]
    buffer_load_dwordx4 v194, s[12:15], s57 offen offset:2048 lds
    v_mfma_f32_16x16x32_bf16 v[212:215], a[248:251], a[80:83], 0
    s_add_u32 s57, s49, 0xd800
    ds_read_b128 a[248:251], v225 offset:24576
    s_add_u32 m0, s50, 0xf000
    v_mfma_f32_16x16x32_bf16 v[212:215], a[252:255], a[92:95], v[212:215]
    ds_read_b128 a[252:255], v225 offset:24640
    v_mfma_f32_16x16x32_bf16 v[220:223], a[220:223], a[96:99], v[220:223]
    buffer_load_dwordx4 v192, s[12:15], s57 offen lds
    v_mfma_f32_16x16x32_bf16 v[220:223], a[224:227], a[108:111], v[220:223]
    v_mfma_f32_16x16x32_bf16 v[216:219], a[220:223], a[100:103], v[216:219]
    buffer_load_dwordx4 v193, s[12:15], s57 offen offset:1024 lds
    v_mfma_f32_16x16x32_bf16 v[216:219], a[224:227], a[112:115], v[216:219]
    v_mfma_f32_16x16x32_bf16 v[212:215], a[220:223], a[104:107], v[212:215]
    ds_read_b128 a[220:223], v225 offset:24704
    v_mfma_f32_16x16x32_bf16 v[212:215], a[224:227], a[116:119], v[212:215]
    ds_read_b128 a[224:227], v225 offset:27456
    v_mfma_f32_16x16x32_bf16 v[220:223], a[228:231], a[120:123], v[220:223]
    s_waitcnt lgkmcnt(4)
    buffer_load_dwordx4 v194, s[12:15], s57 offen offset:2048 lds
    v_mfma_f32_16x16x32_bf16 v[220:223], a[232:235], a[132:135], v[220:223]
    s_add_u32 m0, s41, 0
    v_mfma_f32_16x16x32_bf16 v[216:219], a[228:231], a[124:127], v[216:219]
    v_mfma_f32_16x16x32_bf16 v[216:219], a[232:235], a[136:139], v[216:219]
    v_mfma_f32_16x16x32_bf16 v[212:215], a[228:231], a[128:131], v[212:215]
    ds_read_b128 a[228:231], v225 offset:27520
    v_mfma_f32_16x16x32_bf16 v[212:215], a[232:235], a[140:143], v[212:215]
    ds_read_b128 a[232:235], v225 offset:27584
    v_mfma_f32_16x16x32_bf16 v[208:211], a[144:147], a[236:239], 0
    v_cvt_pk_bf16_f32 v82, v220, v221
    v_cvt_pk_bf16_f32 v83, v222, v223
    v_mfma_f32_16x16x32_bf16 v[208:211], a[156:159], a[240:243], v[208:211]
    v_cvt_pk_bf16_f32 v104, v216, v217
    v_cvt_pk_bf16_f32 v105, v218, v219
    v_mfma_f32_16x16x32_bf16 v[204:207], a[148:151], a[236:239], 0
    v_cvt_pk_bf16_f32 v126, v212, v213
    v_cvt_pk_bf16_f32 v127, v214, v215
    v_mfma_f32_16x16x32_bf16 v[204:207], a[160:163], a[240:243], v[204:207]
    v_mfma_f32_16x16x32_bf16 v[200:203], a[152:155], a[236:239], 0
    ds_read_b128 a[236:239], v225 offset:27648
    v_mfma_f32_16x16x32_bf16 v[200:203], a[164:167], a[240:243], v[200:203]
    ds_read_b128 a[240:243], v225 offset:27712
    v_mfma_f32_16x16x32_bf16 v[208:211], a[168:171], a[244:247], v[208:211]
    s_waitcnt lgkmcnt(4)
    v_mfma_f32_16x16x32_bf16 v[208:211], a[180:183], a[248:251], v[208:211]
    v_mfma_f32_16x16x32_bf16 v[204:207], a[172:175], a[244:247], v[204:207]
    v_mfma_f32_16x16x32_bf16 v[204:207], a[184:187], a[248:251], v[204:207]
    v_mfma_f32_16x16x32_bf16 v[200:203], a[176:179], a[244:247], v[200:203]
    ds_read_b128 a[244:247], v225 offset:27776
    v_mfma_f32_16x16x32_bf16 v[200:203], a[188:191], a[248:251], v[200:203]
    ds_read_b128 a[248:251], v224 offset:30976
    v_mfma_f32_16x16x32_bf16 v[208:211], a[192:195], a[252:255], v[208:211]
    v_mfma_f32_16x16x32_bf16 v[208:211], a[204:207], a[220:223], v[208:211]
    v_mfma_f32_16x16x32_bf16 v[204:207], a[196:199], a[252:255], v[204:207]
    v_mfma_f32_16x16x32_bf16 v[204:207], a[208:211], a[220:223], v[204:207]
    v_mfma_f32_16x16x32_bf16 v[200:203], a[200:203], a[252:255], v[200:203]
    ds_read_b128 a[252:255], v224 offset:31040
    v_mfma_f32_16x16x32_bf16 v[200:203], a[212:215], a[220:223], v[200:203]
    s_waitcnt lgkmcnt(2)
    ds_read_b128 a[220:223], v224 offset:31104
    v_mfma_f32_16x16x32_bf16 v[220:223], a[144:147], a[224:227], 0
    s_barrier
    v_cvt_pk_bf16_f32 v132, v208, v209
    v_mfma_f32_16x16x32_bf16 v[220:223], a[156:159], a[228:231], v[220:223]
    v_cvt_pk_bf16_f32 v133, v210, v211
    v_cvt_pk_bf16_f32 v134, v204, v205
    v_mfma_f32_16x16x32_bf16 v[216:219], a[148:151], a[224:227], 0
    v_cvt_pk_bf16_f32 v135, v206, v207
    v_cvt_pk_bf16_f32 v136, v200, v201
    v_mfma_f32_16x16x32_bf16 v[216:219], a[160:163], a[228:231], v[216:219]
    v_cvt_pk_bf16_f32 v137, v202, v203
    v_mfma_f32_16x16x32_bf16 v[144:147], v[0:3], v[132:135], v[144:147]
    buffer_load_dwordx4 v246, s[4:7], s56 offen lds
    v_mfma_f32_16x16x32_bf16 v[148:151], v[24:27], v[132:135], v[148:151]
    buffer_load_dwordx4 v247, s[4:7], s56 offen offset:1024 lds
    v_mfma_f32_16x16x32_bf16 v[152:155], v[30:33], v[132:135], v[152:155]
    s_add_u32 s56, s56, s42
    s_add_u32 m0, s41, 0x1e40
    v_mfma_f32_16x16x16_bf16 v[144:147], v[4:5], v[136:137], v[144:147]
    v_mfma_f32_16x16x32_bf16 v[156:159], v[6:9], v[132:135], v[156:159]
    v_mfma_f32_16x16x16_bf16 v[148:151], v[28:29], v[136:137], v[148:151]
    buffer_load_dwordx4 v246, s[4:7], s56 offen lds
    v_mfma_f32_16x16x16_bf16 v[152:155], v[34:35], v[136:137], v[152:155]
    v_mfma_f32_16x16x32_bf16 v[160:163], v[12:15], v[132:135], v[160:163]
    v_mfma_f32_16x16x32_bf16 v[164:167], v[36:39], v[132:135], v[164:167]
    v_mfma_f32_16x16x32_bf16 v[168:171], v[42:45], v[132:135], v[168:171]
    buffer_load_dwordx4 v247, s[4:7], s56 offen offset:1024 lds
    v_mfma_f32_16x16x16_bf16 v[156:159], v[10:11], v[136:137], v[156:159]
    s_add_u32 s56, s56, s42
    v_max3_f32 v248, v144, v145, v146
    v_max3_f32 v249, v147, v148, v149
    v_mfma_f32_16x16x16_bf16 v[160:163], v[16:17], v[136:137], v[160:163]
    s_add_u32 m0, s41, 0x3c80
    v_max3_f32 v248, v248, v150, v151
    v_max3_f32 v249, v249, v152, v153
    v_mfma_f32_16x16x16_bf16 v[164:167], v[40:41], v[136:137], v[164:167]
    v_max3_f32 v248, v248, v154, v155
    v_max3_f32 v249, v249, v156, v157
    v_mfma_f32_16x16x16_bf16 v[168:171], v[46:47], v[136:137], v[168:171]
    buffer_load_dwordx4 v246, s[4:7], s56 offen lds
    v_mfma_f32_16x16x32_bf16 v[172:175], v[18:21], v[132:135], v[172:175]
    v_max3_f32 v248, v248, v158, v159
    v_max3_f32 v249, v249, v160, v161
    v_mfma_f32_16x16x32_bf16 v[212:215], a[152:155], a[224:227], 0
    ds_read_b128 a[224:227], v224 offset:31168
    v_max3_f32 v248, v248, v162, v163
    v_mfma_f32_16x16x32_bf16 v[212:215], a[164:167], a[228:231], v[212:215]
    ds_read_b128 a[228:231], v224 offset:31232
    v_max3_f32 v249, v249, v164, v165
    v_mfma_f32_16x16x16_bf16 v[172:175], v[22:23], v[136:137], v[172:175]
    v_max3_f32 v248, v248, v166, v167
    v_max3_f32 v249, v249, v168, v169
    v_mfma_f32_16x16x32_bf16 v[220:223], a[168:171], a[232:235], v[220:223]
    buffer_load_dwordx4 v247, s[4:7], s56 offen offset:1024 lds
    v_mfma_f32_16x16x32_bf16 v[220:223], a[180:183], a[236:239], v[220:223]
    s_add_u32 s56, s56, s42
    v_max3_f32 v248, v248, v170, v171
    s_add_u32 m0, s41, 0x5ac0
    v_mfma_f32_16x16x32_bf16 v[216:219], a[172:175], a[232:235], v[216:219]
    v_max3_f32 v249, v249, v172, v173
    v_max3_f32 v248, v248, v174, v175
    v_mfma_f32_16x16x32_bf16 v[216:219], a[184:187], a[236:239], v[216:219]
    v_max_f32 v248, v248, v249
    v_mov_b32 v249, v248
    v_mfma_f32_16x16x32_bf16 v[212:215], a[176:179], a[232:235], v[212:215]
    ds_read_b128 a[232:235], v224 offset:31296
    v_mfma_f32_16x16x32_bf16 v[212:215], a[188:191], a[236:239], v[212:215]
    ds_read_b128 a[236:239], v224 offset:34048
    v_mfma_f32_16x16x32_bf16 v[220:223], a[192:195], a[240:243], v[220:223]
    buffer_load_dwordx4 v246, s[4:7], s56 offen lds
    v_mfma_f32_16x16x32_bf16 v[220:223], a[204:207], a[244:247], v[220:223]
    v_permlane16_swap_b32 v248, v249
    v_mfma_f32_16x16x32_bf16 v[216:219], a[196:199], a[240:243], v[216:219]
    buffer_load_dwordx4 v247, s[4:7], s56 offen offset:1024 lds
    v_mfma_f32_16x16x32_bf16 v[216:219], a[208:211], a[244:247], v[216:219]
    s_add_u32 s56, s56, s42
    v_max_f32 v248, v248, v249
    v_mov_b32 v249, v248
    v_mfma_f32_16x16x32_bf16 v[212:215], a[200:203], a[240:243], v[212:215]
    s_add_u32 m0, s41, 0x7900
    v_cvt_pk_bf16_f32 v138, v220, v221
    v_cvt_pk_bf16_f32 v139, v222, v223
    v_mfma_f32_16x16x32_bf16 v[212:215], a[212:215], a[244:247], v[212:215]
    s_waitcnt lgkmcnt(2)
    v_cvt_pk_bf16_f32 v140, v216, v217
    v_cvt_pk_bf16_f32 v141, v218, v219
    v_mfma_f32_16x16x32_bf16 v[208:211], a[248:251], a[72:75], 0
    ds_read_b128 a[240:243], v224 offset:34112
    ds_read_b128 a[244:247], v224 offset:34176
    v_mfma_f32_16x16x32_bf16 v[208:211], a[252:255], a[84:87], v[208:211]
    v_permlane32_swap_b32 v248, v249
    v_mfma_f32_16x16x32_bf16 v[204:207], a[248:251], a[76:79], 0
    v_cvt_pk_bf16_f32 v142, v212, v213
    v_cvt_pk_bf16_f32 v143, v214, v215
    v_mfma_f32_16x16x32_bf16 v[204:207], a[252:255], a[88:91], v[204:207]
    v_max_f32 v248, v248, v249
    v_mul_f32 v236, s37, v248
    v_mfma_f32_16x16x32_bf16 v[200:203], a[248:251], a[80:83], 0
    ds_read_b128 a[248:251], v224 offset:34240
    v_fma_f32 v144, v144, s37, -v236
    v_mfma_f32_16x16x32_bf16 v[200:203], a[252:255], a[92:95], v[200:203]
    ds_read_b128 a[252:255], v224 offset:34304
    v_fma_f32 v145, v145, s37, -v236
    v_mfma_f32_16x16x32_bf16 v[208:211], a[220:223], a[96:99], v[208:211]
    v_fma_f32 v146, v146, s37, -v236
    v_fma_f32 v147, v147, s37, -v236
    v_mfma_f32_16x16x32_bf16 v[208:211], a[224:227], a[108:111], v[208:211]
    v_exp_f32 v144, v144
    v_mfma_f32_16x16x32_bf16 v[204:207], a[220:223], a[100:103], v[204:207]
    v_exp_f32 v145, v145
    v_mfma_f32_16x16x32_bf16 v[204:207], a[224:227], a[112:115], v[204:207]
    v_exp_f32 v146, v146
    v_mfma_f32_16x16x32_bf16 v[200:203], a[220:223], a[104:107], v[200:203]
    ds_read_b128 a[220:223], v224 offset:34368
    v_cvt_pk_bf16_f32 v176, v144, v145
    v_mfma_f32_16x16x32_bf16 v[200:203], a[224:227], a[116:119], v[200:203]
    ds_read_b128 a[224:227], v224 offset:46464
    v_fma_f32 v148, v148, s37, -v236
    v_mfma_f32_16x16x32_bf16 v[208:211], a[228:231], a[120:123], v[208:211]
    s_waitcnt lgkmcnt(4)
    v_exp_f32 v147, v147
    v_mfma_f32_16x16x32_bf16 v[208:211], a[232:235], a[132:135], v[208:211]
    v_cvt_pk_bf16_f32 v177, v146, v147
    v_fma_f32 v149, v149, s37, -v236
    v_mfma_f32_16x16x32_bf16 v[204:207], a[228:231], a[124:127], v[204:207]
    ds_read_b128 v[144:147], v234
    v_bfe_u32 v234, s63, v233, 4
    v_mfma_f32_16x16x32_bf16 v[204:207], a[232:235], a[136:139], v[204:207]
    v_mad_u32_u24 v234, v234, s40, v231
    v_fma_f32 v150, v150, s37, -v236
    v_mfma_f32_16x16x32_bf16 v[200:203], a[228:231], a[128:131], v[200:203]
    v_cvt_pk_bf16_f32 v74, v208, v209
    v_cvt_pk_bf16_f32 v75, v210, v211
    v_mfma_f32_16x16x32_bf16 v[200:203], a[232:235], a[140:143], v[200:203]
    ds_read_b128 a[228:231], v224 offset:46528
    ds_read_b128 a[232:235], v224 offset:46592
    v_mfma_f32_16x16x32_bf16 v[220:223], a[236:239], a[72:75], 0
    v_cvt_pk_bf16_f32 v96, v204, v205
    v_cvt_pk_bf16_f32 v97, v206, v207
    v_mfma_f32_16x16x32_bf16 v[220:223], a[240:243], a[84:87], v[220:223]
    v_fma_f32 v151, v151, s37, -v236
    v_fma_f32 v152, v152, s37, -v236
    v_mfma_f32_16x16x32_bf16 v[216:219], a[236:239], a[76:79], 0
    v_cvt_pk_bf16_f32 v118, v200, v201
    v_cvt_pk_bf16_f32 v119, v202, v203
    v_mfma_f32_16x16x32_bf16 v[216:219], a[240:243], a[88:91], v[216:219]
    v_exp_f32 v148, v148
    v_mfma_f32_16x16x32_bf16 v[212:215], a[236:239], a[80:83], 0
    ds_read_b128 a[236:239], v224 offset:46656
    v_fma_f32 v153, v153, s37, -v236
    v_mfma_f32_16x16x32_bf16 v[212:215], a[240:243], a[92:95], v[212:215]
    s_waitcnt lgkmcnt(3)
    ds_read_b128 a[240:243], v224 offset:46720
    v_fma_f32 v154, v154, s37, -v236
    v_mfma_f32_16x16x32_bf16 v[144:147], v[24:27], v[138:141], v[144:147]
    v_exp_f32 v149, v149
    v_mfma_f32_16x16x32_bf16 v[220:223], a[244:247], a[96:99], v[220:223]
    v_exp_f32 v150, v150
    v_mfma_f32_16x16x32_bf16 v[220:223], a[248:251], a[108:111], v[220:223]
    v_exp_f32 v151, v151
    v_mfma_f32_16x16x32_bf16 v[216:219], a[244:247], a[100:103], v[216:219]
    v_cvt_pk_bf16_f32 v178, v148, v149
    v_cvt_pk_bf16_f32 v179, v150, v151
    v_mfma_f32_16x16x32_bf16 v[216:219], a[248:251], a[112:115], v[216:219]
    ds_read_b128 v[148:151], v235
    v_bfe_u32 v235, s64, v233, 4
    v_mfma_f32_16x16x32_bf16 v[196:199], a[216:219], v[176:179], 0
    v_mad_u32_u24 v235, v235, s40, v231
    v_fma_f32 v155, v155, s37, -v236
    v_mfma_f32_16x16x32_bf16 v[184:187], v[66:69], v[176:179], 0
    v_exp_f32 v152, v152
    v_mfma_f32_16x16x32_bf16 v[188:191], v[88:91], v[176:179], 0
    v_exp_f32 v153, v153
    v_mfma_f32_16x16x32_bf16 v[192:195], v[110:113], v[176:179], 0
    v_exp_f32 v154, v154
    v_mfma_f32_16x16x16_bf16 v[144:147], v[28:29], v[142:143], v[144:147]
    v_exp_f32 v155, v155
    v_mfma_f32_16x16x32_bf16 v[212:215], a[244:247], a[104:107], v[212:215]
    ds_read_b128 a[244:247], v224 offset:46784
    v_cvt_pk_bf16_f32 v180, v152, v153
    v_mfma_f32_16x16x32_bf16 v[212:215], a[248:251], a[116:119], v[212:215]
    s_waitcnt vmcnt(20)
    ds_read_b64_tr_b16 a[248:249], v86 offset:12288
    ds_read_b64_tr_b16 a[250:251], v86 offset:13824
    v_mfma_f32_16x16x32_bf16 v[220:223], a[252:255], a[120:123], v[220:223]
    v_cvt_pk_bf16_f32 v181, v154, v155
    v_fma_f32 v156, v156, s37, -v236
    v_mfma_f32_16x16x32_bf16 v[220:223], a[220:223], a[132:135], v[220:223]
    s_waitcnt lgkmcnt(3)
    ds_read_b128 v[152:155], v230 offset:1920
    v_fma_f32 v157, v157, s37, -v236
    v_mfma_f32_16x16x32_bf16 v[148:151], v[30:33], v[138:141], v[148:151]
    v_fma_f32 v158, v158, s37, -v236
    v_fma_f32 v159, v159, s37, -v236
    v_mfma_f32_16x16x32_bf16 v[216:219], a[252:255], a[124:127], v[216:219]
    v_exp_f32 v156, v156
    v_mfma_f32_16x16x32_bf16 v[216:219], a[220:223], a[136:139], v[216:219]
    v_cvt_pk_bf16_f32 v76, v220, v221
    v_cvt_pk_bf16_f32 v77, v222, v223
    v_mfma_f32_16x16x16_bf16 v[148:151], v[34:35], v[142:143], v[148:151]
    v_exp_f32 v157, v157
    v_mfma_f32_16x16x32_bf16 v[212:215], a[252:255], a[128:131], v[212:215]
    ds_read_b64_tr_b16 a[252:253], v86 offset:12320
    ds_read_b64_tr_b16 a[254:255], v86 offset:13856
    v_mfma_f32_16x16x32_bf16 v[212:215], a[220:223], a[140:143], v[212:215]
    v_cvt_pk_bf16_f32 v98, v216, v217
    v_cvt_pk_bf16_f32 v99, v218, v219
    v_mfma_f32_16x16x32_bf16 v[208:211], a[224:227], a[72:75], 0
    ds_read_b64_tr_b16 a[220:221], v86 offset:12352
    ds_read_b64_tr_b16 a[222:223], v86 offset:13888
    v_mfma_f32_16x16x32_bf16 v[208:211], a[228:231], a[84:87], v[208:211]
    s_waitcnt vmcnt(4) lgkmcnt(4)
    v_exp_f32 v158, v158
    v_mfma_f32_16x16x32_bf16 v[152:155], v[36:39], v[138:141], v[152:155]
    s_barrier
    v_cvt_pk_bf16_f32 v120, v212, v213
    v_cvt_pk_bf16_f32 v121, v214, v215
    v_mfma_f32_16x16x32_bf16 v[204:207], a[224:227], a[76:79], 0
    ds_read_b128 v[252:255], v224 offset:320
    v_cvt_pk_bf16_f32 v182, v156, v157
    v_mfma_f32_16x16x32_bf16 v[204:207], a[228:231], a[88:91], v[204:207]
    v_exp_f32 v159, v159
    v_mfma_f32_16x16x16_bf16 v[152:155], v[40:41], v[142:143], v[152:155]
    v_cvt_pk_bf16_f32 v183, v158, v159
    v_fma_f32 v160, v160, s37, -v236
    v_mfma_f32_16x16x32_bf16 v[200:203], a[224:227], a[80:83], 0
    ds_read_b128 a[224:227], v224 offset:49536
    ds_read_b128 v[156:159], v250
    v_mfma_f32_16x16x32_bf16 v[200:203], a[228:231], a[92:95], v[200:203]
    v_bfe_u32 v250, s65, v232, 4
    v_fma_f32 v161, v161, s37, -v236
    v_mfma_f32_16x16x32_bf16 v[196:199], a[216:219], v[180:183], v[196:199]
    ds_read_b128 a[228:231], v224 offset:49600
    v_fma_f32 v162, v162, s37, -v236
    v_mfma_f32_16x16x32_bf16 v[184:187], v[70:73], v[180:183], v[184:187]
    v_fma_f32 v163, v163, s37, -v236
    v_fma_f32 v164, v164, s37, -v236
    v_mfma_f32_16x16x32_bf16 v[188:191], v[92:95], v[180:183], v[188:191]
    v_exp_f32 v160, v160
    v_mfma_f32_16x16x32_bf16 v[192:195], v[114:117], v[180:183], v[192:195]
    v_exp_f32 v161, v161
    v_mfma_f32_16x16x32_bf16 v[208:211], a[232:235], a[96:99], v[208:211]
    v_exp_f32 v162, v162
    v_mfma_f32_16x16x32_bf16 v[208:211], a[236:239], a[108:111], v[208:211]
    v_exp_f32 v163, v163
    v_mfma_f32_16x16x32_bf16 v[204:207], a[232:235], a[100:103], v[204:207]
    v_cvt_pk_bf16_f32 v176, v160, v161
    v_cvt_pk_bf16_f32 v177, v162, v163
    v_mfma_f32_16x16x32_bf16 v[204:207], a[236:239], a[112:115], v[204:207]
    s_waitcnt lgkmcnt(1)
    ds_read_b128 v[160:163], v234
    v_mad_u32_u24 v234, v250, s40, v229
    v_mfma_f32_16x16x32_bf16 v[156:159], v[42:45], v[138:141], v[156:159]
    v_mad_u32_u24 v250, v250, s40, v228
    v_fma_f32 v165, v165, s37, -v236
    v_mfma_f32_16x16x32_bf16 v[200:203], a[232:235], a[104:107], v[200:203]
    ds_read_b128 a[232:235], v224 offset:49664
    v_fma_f32 v166, v166, s37, -v236
    v_mfma_f32_16x16x32_bf16 v[200:203], a[236:239], a[116:119], v[200:203]
    ds_read_b128 a[236:239], v224 offset:49728
    v_fma_f32 v167, v167, s37, -v236
    v_mfma_f32_16x16x16_bf16 v[156:159], v[46:47], v[142:143], v[156:159]
    s_waitcnt vmcnt(0)
    ds_write_b128 v87, a[248:251] offset:12288
    v_mfma_f32_16x16x32_bf16 v[208:211], a[240:243], a[120:123], v[208:211]
    ds_write_b128 v87, a[252:255] offset:13312
    v_mfma_f32_16x16x32_bf16 v[208:211], a[244:247], a[132:135], v[208:211]
    s_waitcnt lgkmcnt(4)
    ds_write_b128 v87, a[220:223] offset:14336
    v_mfma_f32_16x16x32_bf16 v[160:163], v[48:51], v[138:141], v[160:163]
    v_exp_f32 v164, v164
    v_mfma_f32_16x16x32_bf16 v[204:207], a[240:243], a[124:127], v[204:207]
    v_exp_f32 v165, v165
    v_mfma_f32_16x16x32_bf16 v[204:207], a[244:247], a[136:139], v[204:207]
    v_exp_f32 v166, v166
    v_mfma_f32_16x16x32_bf16 v[200:203], a[240:243], a[128:131], v[200:203]
    v_cvt_pk_bf16_f32 v80, v208, v209
    v_cvt_pk_bf16_f32 v81, v210, v211
    v_mfma_f32_16x16x32_bf16 v[200:203], a[244:247], a[140:143], v[200:203]
    v_exp_f32 v167, v167
    v_mfma_f32_16x16x16_bf16 v[160:163], v[52:53], v[142:143], v[160:163]
    v_cvt_pk_bf16_f32 v178, v164, v165
    v_cvt_pk_bf16_f32 v102, v204, v205
    v_mfma_f32_16x16x32_bf16 v[220:223], a[224:227], a[72:75], 0
    v_cvt_pk_bf16_f32 v103, v206, v207
    v_cvt_pk_bf16_f32 v179, v166, v167
    v_mfma_f32_16x16x32_bf16 v[220:223], a[228:231], a[84:87], v[220:223]
    v_cvt_pk_bf16_f32 v124, v200, v201
    v_cvt_pk_bf16_f32 v125, v202, v203
    v_mfma_f32_16x16x32_bf16 v[196:199], a[216:219], v[176:179], v[196:199]
    ds_read_b128 a[240:243], v224 offset:49792
    ds_read_b128 a[244:247], v224 offset:49856
    v_mfma_f32_16x16x32_bf16 v[184:187], v[74:77], v[176:179], v[184:187]
    ds_read_b128 v[164:167], v235
    v_bfe_u32 v235, s62, v232, 4
    v_mfma_f32_16x16x32_bf16 v[188:191], v[96:99], v[176:179], v[188:191]
    v_fma_f32 v168, v168, s37, -v236
    v_fma_f32 v169, v169, s37, -v236
    v_mfma_f32_16x16x32_bf16 v[192:195], v[118:121], v[176:179], v[192:195]
    ds_read_b64_tr_b16 a[248:249], v86 offset:24576
    ds_read_b64_tr_b16 a[250:251], v86 offset:26112
    v_mfma_f32_16x16x32_bf16 v[216:219], a[224:227], a[76:79], 0
    ds_read_b64_tr_b16 a[252:253], v86 offset:24608
    ds_read_b64_tr_b16 a[254:255], v86 offset:26144
    v_mfma_f32_16x16x32_bf16 v[216:219], a[228:231], a[88:91], v[216:219]
    ds_read_b64_tr_b16 a[220:221], v86 offset:24640
    ds_read_b64_tr_b16 a[222:223], v86 offset:26176
    v_mfma_f32_16x16x32_bf16 v[212:215], a[224:227], a[80:83], 0
    ds_read_b128 a[224:227], v225 offset:39872
    v_fma_f32 v170, v170, s37, -v236
    v_mfma_f32_16x16x32_bf16 v[212:215], a[228:231], a[92:95], v[212:215]
    s_waitcnt lgkmcnt(11)
    ds_read_b128 a[228:231], v225 offset:39936
    v_fma_f32 v171, v171, s37, -v236
    v_mfma_f32_16x16x32_bf16 v[220:223], a[232:235], a[96:99], v[220:223]
    v_exp_f32 v168, v168
    v_mfma_f32_16x16x32_bf16 v[220:223], a[236:239], a[108:111], v[220:223]
    v_exp_f32 v169, v169
    v_mfma_f32_16x16x32_bf16 v[216:219], a[232:235], a[100:103], v[216:219]
    v_exp_f32 v170, v170
    v_mfma_f32_16x16x32_bf16 v[216:219], a[236:239], a[112:115], v[216:219]
    s_waitcnt lgkmcnt(8)
    v_exp_f32 v171, v171
    v_mfma_f32_16x16x32_bf16 v[164:167], v[54:57], v[138:141], v[164:167]
    s_waitcnt lgkmcnt(6)
    ds_write_b128 v87, a[248:251] offset:24576
    v_mfma_f32_16x16x32_bf16 v[212:215], a[232:235], a[104:107], v[212:215]
    s_waitcnt lgkmcnt(5)
    ds_write_b128 v87, a[252:255] offset:25600
    v_mfma_f32_16x16x32_bf16 v[212:215], a[236:239], a[116:119], v[212:215]
    s_waitcnt lgkmcnt(4)
    ds_write_b128 v87, a[220:223] offset:26624
    v_mfma_f32_16x16x32_bf16 v[220:223], a[240:243], a[120:123], v[220:223]
    v_cvt_pk_bf16_f32 v180, v168, v169
    v_cvt_pk_bf16_f32 v181, v170, v171
    v_mfma_f32_16x16x32_bf16 v[220:223], a[244:247], a[132:135], v[220:223]
    v_fma_f32 v172, v172, s37, -v236
    v_fma_f32 v173, v173, s37, -v236
    v_mfma_f32_16x16x16_bf16 v[164:167], v[58:59], v[142:143], v[164:167]
    v_fma_f32 v174, v174, s37, -v236
    v_fma_f32 v175, v175, s37, -v236
    v_mfma_f32_16x16x32_bf16 v[216:219], a[240:243], a[124:127], v[216:219]
    v_exp_f32 v172, v172
    v_mfma_f32_16x16x32_bf16 v[216:219], a[244:247], a[136:139], v[216:219]
    v_cvt_pk_bf16_f32 v78, v220, v221
    v_cvt_pk_bf16_f32 v79, v222, v223
    v_mfma_f32_16x16x32_bf16 v[212:215], a[240:243], a[128:131], v[212:215]
    v_exp_f32 v173, v173
    v_mfma_f32_16x16x32_bf16 v[212:215], a[244:247], a[140:143], v[212:215]
    s_waitcnt lgkmcnt(3)
    v_exp_f32 v174, v174
    v_mfma_f32_16x16x32_bf16 v[208:211], a[144:147], a[224:227], 0
    ds_read_b128 a[232:235], v225 offset:40000
    v_cvt_pk_bf16_f32 v100, v216, v217
    v_mfma_f32_16x16x32_bf16 v[208:211], a[156:159], a[228:231], v[208:211]
    ds_read_b128 a[236:239], v225 offset:40064
    v_cvt_pk_bf16_f32 v101, v218, v219
    v_mfma_f32_16x16x32_bf16 v[204:207], a[148:151], a[224:227], 0
    v_cvt_pk_bf16_f32 v122, v212, v213
    v_cvt_pk_bf16_f32 v123, v214, v215
    v_mfma_f32_16x16x32_bf16 v[204:207], a[160:163], a[228:231], v[204:207]
    ds_read_b128 a[240:243], v225 offset:40128
    ds_read_b128 a[244:247], v225 offset:40192
    v_mfma_f32_16x16x32_bf16 v[200:203], a[152:155], a[224:227], 0
    ds_read_b128 a[248:251], v227 offset:37120
    v_cvt_pk_bf16_f32 v182, v172, v173
    v_mfma_f32_16x16x32_bf16 v[200:203], a[164:167], a[228:231], v[200:203]
    ds_read_b128 a[252:255], v227 offset:37184
    v_exp_f32 v175, v175
    v_max3_f32 v248, v144, v145, v146
    ds_read_b128 a[220:223], v227 offset:37248
    v_cvt_pk_bf16_f32 v183, v174, v175
    ds_read_b128 a[224:227], v227 offset:37312
    v_max3_f32 v249, v147, v148, v149
    v_mfma_f32_16x16x32_bf16 v[196:199], a[216:219], v[180:183], v[196:199]
    ds_read_b128 a[228:231], v227 offset:37376
    v_max3_f32 v248, v248, v150, v151
    v_mfma_f32_16x16x32_bf16 v[184:187], v[78:81], v[180:183], v[184:187]
    ds_read_b128 v[168:171], v234
    v_bfe_u32 v234, s62, v232, 4
    v_mfma_f32_16x16x32_bf16 v[188:191], v[100:103], v[180:183], v[188:191]
    ds_read_b128 v[172:175], v250
    v_mad_u32_u24 v250, v235, s40, v228
    v_mfma_f32_16x16x32_bf16 v[192:195], v[122:125], v[180:183], v[192:195]
    s_waitcnt lgkmcnt(9)
    v_rcp_f32 v197, v196
    v_mfma_f32_16x16x32_bf16 v[208:211], a[168:171], a[232:235], v[208:211]
    v_mul_f32 v184, v184, v197
    v_mul_f32 v185, v185, v197
    v_mfma_f32_16x16x32_bf16 v[208:211], a[180:183], a[236:239], v[208:211]
    v_cvt_pk_bf16_f32 v184, v184, v185
    v_mul_f32 v186, v186, v197
    v_mfma_f32_16x16x32_bf16 v[204:207], a[172:175], a[232:235], v[204:207]
    v_mul_f32 v187, v187, v197
    v_cvt_pk_bf16_f32 v185, v186, v187
    v_mfma_f32_16x16x32_bf16 v[204:207], a[184:187], a[236:239], v[204:207]
    v_mul_f32 v188, v188, v197
    v_mul_f32 v189, v189, v197
    v_mfma_f32_16x16x32_bf16 v[200:203], a[176:179], a[232:235], v[200:203]
    ds_read_b128 a[232:235], v227 offset:37440
    v_cvt_pk_bf16_f32 v186, v188, v189
    v_mfma_f32_16x16x32_bf16 v[200:203], a[188:191], a[236:239], v[200:203]
    s_waitcnt lgkmcnt(4)
    v_mul_f32 v190, v190, v197
    v_mul_f32 v191, v191, v197
    v_mfma_f32_16x16x32_bf16 v[208:211], a[192:195], a[240:243], v[208:211]
    v_cvt_pk_bf16_f32 v187, v190, v191
    v_mul_f32 v192, v192, v197
    v_mfma_f32_16x16x32_bf16 v[208:211], a[204:207], a[244:247], v[208:211]
    v_mul_f32 v193, v193, v197
    v_cvt_pk_bf16_f32 v188, v192, v193
    v_mfma_f32_16x16x32_bf16 v[204:207], a[196:199], a[240:243], v[204:207]
    v_mul_f32 v194, v194, v197
    v_mul_f32 v195, v195, v197
    v_mfma_f32_16x16x32_bf16 v[204:207], a[208:211], a[244:247], v[204:207]
    v_cvt_pk_bf16_f32 v189, v194, v195
    v_mad_u32_u24 v235, v235, s40, v229
    v_mfma_f32_16x16x32_bf16 v[200:203], a[200:203], a[240:243], v[200:203]
    v_cvt_pk_bf16_f32 v132, v208, v209
    v_cvt_pk_bf16_f32 v133, v210, v211
    v_mfma_f32_16x16x32_bf16 v[200:203], a[212:215], a[244:247], v[200:203]
    ds_write_b128 v237, v[184:187]
    v_mfma_f32_16x16x32_bf16 v[220:223], a[248:251], a[72:75], 0
    v_cvt_pk_bf16_f32 v134, v204, v205
    v_cvt_pk_bf16_f32 v135, v206, v207
    v_mfma_f32_16x16x32_bf16 v[220:223], a[252:255], a[84:87], v[220:223]
    s_waitcnt lgkmcnt(1)
    ds_write_b64 v238, v[188:189]
    v_mfma_f32_16x16x32_bf16 v[168:171], v[30:33], v[132:135], v[168:171]
    v_mad_u32_u24 v234, v234, s40, v230
    v_cvt_pk_bf16_f32 v136, v200, v201
    v_mfma_f32_16x16x32_bf16 v[172:175], v[6:9], v[132:135], v[172:175]
    v_cvt_pk_bf16_f32 v137, v202, v203
    v_max3_f32 v249, v249, v152, v153
    v_mfma_f32_16x16x32_bf16 v[216:219], a[248:251], a[76:79], 0
    ds_read_b64_tr_b16 a[236:237], v86 offset:36864
    ds_read_b64_tr_b16 a[238:239], v86 offset:38400
    v_mfma_f32_16x16x32_bf16 v[216:219], a[252:255], a[88:91], v[216:219]
    ds_read_b64_tr_b16 a[240:241], v86 offset:36896
    ds_read_b64_tr_b16 a[242:243], v86 offset:38432
    v_mfma_f32_16x16x16_bf16 v[168:171], v[34:35], v[136:137], v[168:171]
    ds_read_b64_tr_b16 a[244:245], v86 offset:36928
    ds_read_b64_tr_b16 a[246:247], v86 offset:38464
    v_mfma_f32_16x16x16_bf16 v[172:175], v[10:11], v[136:137], v[172:175]
    v_max3_f32 v248, v248, v154, v155
    v_max3_f32 v249, v249, v156, v157
    v_mfma_f32_16x16x32_bf16 v[212:215], a[248:251], a[80:83], 0
    ds_read_b64_tr_b16 a[248:249], v86 offset:49152
    ds_read_b64_tr_b16 a[250:251], v86 offset:50688
    v_mfma_f32_16x16x32_bf16 v[212:215], a[252:255], a[92:95], v[212:215]
    ds_read_b64_tr_b16 a[252:253], v86 offset:49184
    ds_read_b64_tr_b16 a[254:255], v86 offset:50720
    v_mfma_f32_16x16x32_bf16 v[220:223], a[220:223], a[96:99], v[220:223]
    v_max3_f32 v248, v248, v158, v159
    v_max3_f32 v249, v249, v160, v161
    v_mfma_f32_16x16x32_bf16 v[220:223], a[224:227], a[108:111], v[220:223]
    v_max3_f32 v248, v248, v162, v163
    v_max3_f32 v249, v249, v164, v165
    v_mfma_f32_16x16x32_bf16 v[216:219], a[220:223], a[100:103], v[216:219]
    s_waitcnt lgkmcnt(8)
    ds_write_b128 v87, a[236:239] offset:36864
    v_mfma_f32_16x16x32_bf16 v[216:219], a[224:227], a[112:115], v[216:219]
    s_waitcnt lgkmcnt(7)
    ds_write_b128 v87, a[240:243] offset:37888
    v_mfma_f32_16x16x32_bf16 v[212:215], a[220:223], a[104:107], v[212:215]
    s_waitcnt lgkmcnt(6)
    ds_write_b128 v87, a[244:247] offset:38912
    v_mfma_f32_16x16x32_bf16 v[212:215], a[224:227], a[116:119], v[212:215]
    v_max3_f32 v248, v248, v166, v167
    v_max_f32 v248, v248, v249
    v_mfma_f32_16x16x32_bf16 v[220:223], a[228:231], a[120:123], v[220:223]
    v_mov_b32 v249, v248
    v_mfma_f32_16x16x32_bf16 v[220:223], a[232:235], a[132:135], v[220:223]
    v_mfma_f32_16x16x32_bf16 v[216:219], a[228:231], a[124:127], v[216:219]
    v_permlane16_swap_b32 v248, v249
    v_mfma_f32_16x16x32_bf16 v[216:219], a[232:235], a[136:139], v[216:219]
    v_max_f32 v248, v248, v249
    v_mov_b32 v249, v248
    v_mfma_f32_16x16x32_bf16 v[212:215], a[228:231], a[128:131], v[212:215]
    v_mfma_f32_16x16x32_bf16 v[212:215], a[232:235], a[140:143], v[212:215]
    s_waitcnt lgkmcnt(3)
    v_permlane32_swap_b32 v248, v249
    v_cvt_pk_bf16_f32 v84, v220, v221
    v_cvt_pk_bf16_f32 v85, v222, v223
    ds_read_b128 a[236:239], v224
    v_cvt_pk_bf16_f32 v106, v216, v217
    v_cvt_pk_bf16_f32 v107, v218, v219
    ds_read_b128 a[240:243], v224 offset:64
    ds_read_b128 a[244:247], v224 offset:128
    v_cvt_pk_bf16_f32 v128, v212, v213
    v_cvt_pk_bf16_f32 v129, v214, v215
    ds_read_b64_tr_b16 a[220:221], v86 offset:49216
    ds_read_b64_tr_b16 a[222:223], v86 offset:50752
    ds_write_b128 v87, a[248:251] offset:49152
    ds_write_b128 v87, a[252:255] offset:50176
    v_max_f32 v248, v248, v249
    v_mul_f32 v236, s37, v248
    v_fma_f32 v144, v144, s37, -v236
    v_fma_f32 v145, v145, s37, -v236
    v_fma_f32 v146, v146, s37, -v236
    v_fma_f32 v147, v147, s37, -v236
    v_exp_f32 v144, v144
    v_exp_f32 v145, v145
    s_waitcnt lgkmcnt(6)
    v_mfma_f32_16x16x32_bf16 v[208:211], a[0:3], a[236:239], 0
    s_waitcnt lgkmcnt(5)
    v_exp_f32 v146, v146
    v_mfma_f32_16x16x32_bf16 v[208:211], a[12:15], a[240:243], v[208:211]
    v_exp_f32 v147, v147
    v_mfma_f32_16x16x32_bf16 v[204:207], a[4:7], a[236:239], 0
    v_cvt_pk_bf16_f32 v176, v144, v145
    v_cvt_pk_bf16_f32 v177, v146, v147
    v_mfma_f32_16x16x32_bf16 v[204:207], a[16:19], a[240:243], v[204:207]
    ds_read_b128 a[248:251], v224 offset:192
    ds_read_b128 a[252:255], v224 offset:256
    v_mfma_f32_16x16x32_bf16 v[200:203], a[8:11], a[236:239], 0
    ds_read_b128 v[144:147], v228 offset:1280
    v_fma_f32 v148, v148, s37, -v236
    v_mfma_f32_16x16x32_bf16 v[200:203], a[20:23], a[240:243], v[200:203]
    v_fma_f32 v149, v149, s37, -v236
    v_fma_f32 v150, v150, s37, -v236
    v_mfma_f32_16x16x32_bf16 v[220:223], a[236:239], a[72:75], 0
    s_waitcnt lgkmcnt(5)
    ds_write_b128 v87, a[220:223] offset:51200
    v_mfma_f32_16x16x32_bf16 v[220:223], a[240:243], a[84:87], v[220:223]
    v_fma_f32 v151, v151, s37, -v236
    v_fma_f32 v152, v152, s37, -v236
    v_mfma_f32_16x16x32_bf16 v[216:219], a[236:239], a[76:79], 0
    v_exp_f32 v148, v148
    v_mfma_f32_16x16x32_bf16 v[216:219], a[240:243], a[88:91], v[216:219]
    v_exp_f32 v149, v149
    v_mfma_f32_16x16x32_bf16 v[212:215], a[236:239], a[80:83], 0
    ds_read_b128 a[236:239], v224 offset:3072
    ds_read_b64_tr_b16 a[220:221], v108
    v_mfma_f32_16x16x32_bf16 v[212:215], a[240:243], a[92:95], v[212:215]
    ds_read_b128 a[240:243], v224 offset:3136
    v_cvt_pk_bf16_f32 v178, v148, v149
    v_mfma_f32_16x16x32_bf16 v[208:211], a[24:27], a[244:247], v[208:211]
    s_waitcnt lgkmcnt(6)
    ds_read_b64_tr_b16 a[222:223], v108 offset:1536
    v_fma_f32 v153, v153, s37, -v236
    v_mfma_f32_16x16x32_bf16 v[208:211], a[36:39], a[248:251], v[208:211]
    s_waitcnt lgkmcnt(5)
    ds_read_b64_tr_b16 a[224:225], v86 offset:61440
    v_fma_f32 v154, v154, s37, -v236
    v_mfma_f32_16x16x32_bf16 v[144:147], v[12:15], v[132:135], v[144:147]
    ds_read_b64_tr_b16 a[226:227], v86 offset:62976
    ds_read_b64_tr_b16 a[228:229], v86 offset:61472
    v_mfma_f32_16x16x32_bf16 v[204:207], a[28:31], a[244:247], v[204:207]
    ds_read_b64_tr_b16 a[230:231], v86 offset:63008
    ds_read_b64_tr_b16 a[232:233], v86 offset:61504
    v_mfma_f32_16x16x32_bf16 v[204:207], a[40:43], a[248:251], v[204:207]
    ds_read_b64_tr_b16 a[234:235], v86 offset:63040
    v_fma_f32 v155, v155, s37, -v236
    v_mfma_f32_16x16x16_bf16 v[144:147], v[16:17], v[136:137], v[144:147]
    v_exp_f32 v150, v150
    v_mfma_f32_16x16x32_bf16 v[200:203], a[32:35], a[244:247], v[200:203]
    v_exp_f32 v151, v151
    v_mfma_f32_16x16x32_bf16 v[200:203], a[44:47], a[248:251], v[200:203]
    v_cvt_pk_bf16_f32 v179, v150, v151
    v_fma_f32 v156, v156, s37, -v236
    v_mfma_f32_16x16x32_bf16 v[220:223], a[244:247], a[96:99], v[220:223]
    ds_read_b128 v[148:151], v229 offset:1280
    v_fma_f32 v157, v157, s37, -v236
    v_mfma_f32_16x16x32_bf16 v[220:223], a[248:251], a[108:111], v[220:223]
    v_exp_f32 v152, v152
    v_mfma_f32_16x16x32_bf16 v[196:199], a[216:219], v[176:179], 0
    s_waitcnt lgkmcnt(5)
    ds_write_b128 v87, a[224:227] offset:61440
    v_mfma_f32_16x16x32_bf16 v[184:187], v[68:71], v[176:179], 0
    s_waitcnt lgkmcnt(4)
    ds_write_b128 v87, a[228:231] offset:62464
    v_mfma_f32_16x16x32_bf16 v[188:191], v[90:93], v[176:179], 0
    s_waitcnt lgkmcnt(3)
    ds_write_b128 v87, a[232:235] offset:63488
    v_mfma_f32_16x16x32_bf16 v[192:195], v[112:115], v[176:179], 0
    v_exp_f32 v153, v153
    v_mfma_f32_16x16x32_bf16 v[216:219], a[244:247], a[100:103], v[216:219]
    v_exp_f32 v154, v154
    v_mfma_f32_16x16x32_bf16 v[216:219], a[248:251], a[112:115], v[216:219]
    s_waitcnt lgkmcnt(3)
    v_exp_f32 v155, v155
    v_mfma_f32_16x16x32_bf16 v[148:151], v[36:39], v[132:135], v[148:151]
    v_cvt_pk_bf16_f32 v180, v152, v153
    v_cvt_pk_bf16_f32 v181, v154, v155
    v_mfma_f32_16x16x32_bf16 v[212:215], a[244:247], a[104:107], v[212:215]
    v_fma_f32 v158, v158, s37, -v236
    v_fma_f32 v159, v159, s37, -v236
    v_mfma_f32_16x16x32_bf16 v[212:215], a[248:251], a[116:119], v[212:215]
    v_exp_f32 v156, v156
    v_mfma_f32_16x16x16_bf16 v[148:151], v[40:41], v[136:137], v[148:151]
    v_exp_f32 v157, v157
    v_mfma_f32_16x16x32_bf16 v[208:211], a[48:51], a[252:255], v[208:211]
    ds_read_b128 a[244:247], v224 offset:3200
    ds_read_b128 a[248:251], v224 offset:3264
    v_mfma_f32_16x16x32_bf16 v[208:211], a[60:63], v[252:255], v[208:211]
    ds_read_b64_tr_b16 a[224:225], v108 offset:8
    v_cvt_pk_bf16_f32 v182, v156, v157
    v_mfma_f32_16x16x32_bf16 v[204:207], a[52:55], a[252:255], v[204:207]
    ds_read_b64_tr_b16 a[226:227], v108 offset:1544
    v_fma_f32 v160, v160, s37, -v236
    v_mfma_f32_16x16x32_bf16 v[204:207], a[64:67], v[252:255], v[204:207]
    ds_read_b64_tr_b16 a[228:229], v109
    v_fma_f32 v161, v161, s37, -v236
    v_mfma_f32_16x16x32_bf16 v[200:203], a[56:59], a[252:255], v[200:203]
    v_cvt_pk_bf16_f32 v0, v208, v209
    v_cvt_pk_bf16_f32 v1, v210, v211
    v_mfma_f32_16x16x32_bf16 v[200:203], a[68:71], v[252:255], v[200:203]
    ds_read_b64_tr_b16 a[230:231], v109 offset:1536
    ds_read_b64_tr_b16 a[232:233], v109 offset:8
    v_mfma_f32_16x16x32_bf16 v[220:223], a[252:255], a[120:123], v[220:223]
    v_cvt_pk_bf16_f32 v2, v204, v205
    v_cvt_pk_bf16_f32 v3, v206, v207
    v_mfma_f32_16x16x32_bf16 v[220:223], v[252:255], a[132:135], v[220:223]
    ds_read_b64_tr_b16 a[234:235], v109 offset:1544
    ds_read_b128 v[152:155], v229 offset:1920
    v_mfma_f32_16x16x32_bf16 v[216:219], a[252:255], a[124:127], v[216:219]
    v_cvt_pk_bf16_f32 v4, v200, v201
    v_cvt_pk_bf16_f32 v5, v202, v203
    v_mfma_f32_16x16x32_bf16 v[216:219], v[252:255], a[136:139], v[216:219]
    v_exp_f32 v158, v158
    v_mfma_f32_16x16x32_bf16 v[212:215], a[252:255], a[128:131], v[212:215]
    v_cvt_pk_bf16_f32 v66, v220, v221
    v_cvt_pk_bf16_f32 v67, v222, v223
    v_mfma_f32_16x16x32_bf16 v[212:215], v[252:255], a[140:143], v[212:215]
    ds_read_b128 a[252:255], v224 offset:3328
    ds_read_b128 v[252:255], v224 offset:3392
    v_mfma_f32_16x16x32_bf16 v[208:211], a[0:3], a[236:239], 0
    v_cvt_pk_bf16_f32 v88, v216, v217
    v_cvt_pk_bf16_f32 v89, v218, v219
    v_mfma_f32_16x16x32_bf16 v[208:211], a[12:15], a[240:243], v[208:211]
    v_exp_f32 v159, v159
    v_mfma_f32_16x16x32_bf16 v[204:207], a[4:7], a[236:239], 0
    v_cvt_pk_bf16_f32 v110, v212, v213
    v_cvt_pk_bf16_f32 v111, v214, v215
    v_mfma_f32_16x16x32_bf16 v[204:207], a[16:19], a[240:243], v[204:207]
    v_cvt_pk_bf16_f32 v183, v158, v159
    v_fma_f32 v162, v162, s37, -v236
    v_mfma_f32_16x16x32_bf16 v[200:203], a[8:11], a[236:239], 0
    ds_read_b128 v[156:159], v228 offset:1920
    v_fma_f32 v163, v163, s37, -v236
    v_mfma_f32_16x16x32_bf16 v[200:203], a[20:23], a[240:243], v[200:203]
    v_exp_f32 v160, v160
    v_mfma_f32_16x16x32_bf16 v[196:199], a[216:219], v[180:183], v[196:199]
    v_exp_f32 v161, v161
    v_mfma_f32_16x16x32_bf16 v[184:187], v[76:79], v[180:183], v[184:187]
    v_exp_f32 v162, v162
    v_mfma_f32_16x16x32_bf16 v[188:191], v[98:101], v[180:183], v[188:191]
    v_exp_f32 v163, v163
    v_mfma_f32_16x16x32_bf16 v[192:195], v[120:123], v[180:183], v[192:195]
    s_waitcnt lgkmcnt(2)
    v_cvt_pk_bf16_f32 v176, v160, v161
    v_cvt_pk_bf16_f32 v177, v162, v163
    v_mfma_f32_16x16x32_bf16 v[152:155], v[42:45], v[132:135], v[152:155]
    ds_read_b128 v[160:163], v250
    v_bfe_u32 v250, s66, v233, 4
    v_mfma_f32_16x16x32_bf16 v[220:223], a[236:239], a[72:75], 0
    v_mad_u32_u24 v250, v250, s40, v231
    v_fma_f32 v164, v164, s37, -v236
    v_mfma_f32_16x16x32_bf16 v[220:223], a[240:243], a[84:87], v[220:223]
    v_fma_f32 v165, v165, s37, -v236
    v_fma_f32 v166, v166, s37, -v236
    v_mfma_f32_16x16x16_bf16 v[152:155], v[46:47], v[136:137], v[152:155]
    s_waitcnt lgkmcnt(1)
    v_fma_f32 v167, v167, s37, -v236
    v_max3_f32 v248, v168, v169, v170
    v_mfma_f32_16x16x32_bf16 v[156:159], v[18:21], v[132:135], v[156:159]
    v_exp_f32 v164, v164
    v_mfma_f32_16x16x32_bf16 v[216:219], a[236:239], a[76:79], 0
    v_exp_f32 v165, v165
    v_mfma_f32_16x16x32_bf16 v[216:219], a[240:243], a[88:91], v[216:219]
    v_exp_f32 v166, v166
    v_mfma_f32_16x16x32_bf16 v[212:215], a[236:239], a[80:83], 0
    ds_read_b128 a[236:239], v225 offset:42944
    v_cvt_pk_bf16_f32 v178, v164, v165
    v_mfma_f32_16x16x32_bf16 v[212:215], a[240:243], a[92:95], v[212:215]
    ds_read_b128 a[240:243], v225 offset:43008
    v_max3_f32 v249, v171, v172, v173
    v_mfma_f32_16x16x16_bf16 v[156:159], v[22:23], v[136:137], v[156:159]
    s_waitcnt lgkmcnt(2)
    v_exp_f32 v167, v167
    v_mfma_f32_16x16x32_bf16 v[160:163], v[0:3], v[132:135], v[160:163]
    v_cvt_pk_bf16_f32 v179, v166, v167
    v_max3_f32 v248, v248, v174, v175
    v_mfma_f32_16x16x32_bf16 v[208:211], a[24:27], a[244:247], v[208:211]
    ds_read_b128 v[164:167], v235
    v_bfe_u32 v235, s65, v232, 4
    v_mfma_f32_16x16x32_bf16 v[208:211], a[36:39], a[248:251], v[208:211]
    v_mad_u32_u24 v235, v235, s40, v230
    v_max3_f32 v249, v249, v144, v145
    v_mfma_f32_16x16x32_bf16 v[196:199], a[216:219], v[176:179], v[196:199]
    v_max3_f32 v248, v248, v146, v147
    v_max3_f32 v249, v249, v148, v149
    v_mfma_f32_16x16x32_bf16 v[184:187], v[82:85], v[176:179], v[184:187]
    v_max3_f32 v248, v248, v150, v151
    v_max3_f32 v249, v249, v152, v153
    v_mfma_f32_16x16x32_bf16 v[188:191], v[104:107], v[176:179], v[188:191]
    v_max3_f32 v248, v248, v154, v155
    v_max3_f32 v249, v249, v156, v157
    v_mfma_f32_16x16x32_bf16 v[192:195], v[126:129], v[176:179], v[192:195]
    v_rcp_f32 v197, v196
    v_mfma_f32_16x16x16_bf16 v[160:163], v[4:5], v[136:137], v[160:163]
    v_mul_f32 v184, v184, v197
    v_mul_f32 v185, v185, v197
    v_mfma_f32_16x16x32_bf16 v[204:207], a[28:31], a[244:247], v[204:207]
    v_cvt_pk_bf16_f32 v184, v184, v185
    v_mul_f32 v186, v186, v197
    v_mfma_f32_16x16x32_bf16 v[204:207], a[40:43], a[248:251], v[204:207]
    v_mul_f32 v187, v187, v197
    v_cvt_pk_bf16_f32 v185, v186, v187
    v_mfma_f32_16x16x32_bf16 v[200:203], a[32:35], a[244:247], v[200:203]
    v_mul_f32 v188, v188, v197
    v_mul_f32 v189, v189, v197
    v_mfma_f32_16x16x32_bf16 v[200:203], a[44:47], a[248:251], v[200:203]
    v_cvt_pk_bf16_f32 v186, v188, v189
    v_mul_f32 v190, v190, v197
    v_mfma_f32_16x16x32_bf16 v[220:223], a[244:247], a[96:99], v[220:223]
    v_mul_f32 v191, v191, v197
    v_cvt_pk_bf16_f32 v187, v190, v191
    v_mfma_f32_16x16x32_bf16 v[220:223], a[248:251], a[108:111], v[220:223]
    v_mul_f32 v192, v192, v197
    v_mul_f32 v193, v193, v197
    v_mfma_f32_16x16x32_bf16 v[216:219], a[244:247], a[100:103], v[216:219]
    v_cvt_pk_bf16_f32 v188, v192, v193
    v_mul_f32 v194, v194, v197
    v_mfma_f32_16x16x32_bf16 v[216:219], a[248:251], a[112:115], v[216:219]
    v_mul_f32 v195, v195, v197
    v_cvt_pk_bf16_f32 v189, v194, v195
    v_mfma_f32_16x16x32_bf16 v[212:215], a[244:247], a[104:107], v[212:215]
    ds_read_b128 a[244:247], v225 offset:43072
    v_max3_f32 v248, v248, v158, v159
    v_mfma_f32_16x16x32_bf16 v[212:215], a[248:251], a[116:119], v[212:215]
    ds_read_b128 a[248:251], v225 offset:43136
    v_max3_f32 v249, v249, v160, v161
    v_mfma_f32_16x16x32_bf16 v[208:211], a[48:51], a[252:255], v[208:211]
    ds_write_b128 v237, v[184:187] offset:6144
    v_mfma_f32_16x16x32_bf16 v[208:211], a[60:63], v[252:255], v[208:211]
    ds_write_b64 v238, v[188:189] offset:6144
    v_mfma_f32_16x16x32_bf16 v[204:207], a[52:55], a[252:255], v[204:207]
    v_max3_f32 v248, v248, v162, v163
    v_mfma_f32_16x16x32_bf16 v[204:207], a[64:67], v[252:255], v[204:207]
    v_mfma_f32_16x16x32_bf16 v[200:203], a[56:59], a[252:255], v[200:203]
    v_mfma_f32_16x16x32_bf16 v[200:203], a[68:71], v[252:255], v[200:203]
    v_mfma_f32_16x16x32_bf16 v[220:223], a[252:255], a[120:123], v[220:223]
    v_mfma_f32_16x16x32_bf16 v[220:223], v[252:255], a[132:135], v[220:223]
    v_cvt_pk_bf16_f32 v24, v208, v209
    v_cvt_pk_bf16_f32 v25, v210, v211
    v_mfma_f32_16x16x32_bf16 v[216:219], a[252:255], a[124:127], v[216:219]
    v_mfma_f32_16x16x32_bf16 v[216:219], v[252:255], a[136:139], v[216:219]
    v_cvt_pk_bf16_f32 v26, v204, v205
    v_cvt_pk_bf16_f32 v27, v206, v207
    v_mfma_f32_16x16x32_bf16 v[212:215], a[252:255], a[128:131], v[212:215]
    v_cvt_pk_bf16_f32 v28, v200, v201
    v_cvt_pk_bf16_f32 v29, v202, v203
    v_mfma_f32_16x16x32_bf16 v[212:215], v[252:255], a[140:143], v[212:215]
    s_waitcnt lgkmcnt(2)
    v_cvt_pk_bf16_f32 v68, v220, v221
    v_cvt_pk_bf16_f32 v69, v222, v223
    v_mfma_f32_16x16x32_bf16 v[164:167], v[24:27], v[132:135], v[164:167]
    v_cvt_pk_bf16_f32 v90, v216, v217
    v_cvt_pk_bf16_f32 v91, v218, v219
    v_mfma_f32_16x16x32_bf16 v[208:211], a[144:147], a[236:239], 0
    ds_read_b128 a[252:255], v225 offset:43200
    ds_read_b128 v[252:255], v225 offset:43264
    v_mfma_f32_16x16x32_bf16 v[208:211], a[156:159], a[240:243], v[208:211]
    v_cvt_pk_bf16_f32 v112, v212, v213
    v_cvt_pk_bf16_f32 v113, v214, v215
    v_mfma_f32_16x16x16_bf16 v[164:167], v[28:29], v[136:137], v[164:167]
    v_mfma_f32_16x16x32_bf16 v[204:207], a[148:151], a[236:239], 0
    v_mfma_f32_16x16x32_bf16 v[204:207], a[160:163], a[240:243], v[204:207]
    v_mfma_f32_16x16x32_bf16 v[200:203], a[152:155], a[236:239], 0
    ds_read_b128 a[236:239], v226 offset:1152
    v_mfma_f32_16x16x32_bf16 v[200:203], a[164:167], a[240:243], v[200:203]
    ds_read_b128 a[240:243], v226 offset:1216
    v_mfma_f32_16x16x32_bf16 v[208:211], a[168:171], a[244:247], v[208:211]
    v_mfma_f32_16x16x32_bf16 v[208:211], a[180:183], a[248:251], v[208:211]
    v_max3_f32 v249, v249, v164, v165
    v_max3_f32 v248, v248, v166, v167
    v_mfma_f32_16x16x32_bf16 v[204:207], a[172:175], a[244:247], v[204:207]
    s_waitcnt lgkmcnt(2)
    v_max_f32 v248, v248, v249
    v_mov_b32 v249, v248
    v_mfma_f32_16x16x32_bf16 v[204:207], a[184:187], a[248:251], v[204:207]
    s_barrier
    buffer_load_dwordx4 v246, s[4:7], s56 offen lds
    v_mfma_f32_16x16x32_bf16 v[200:203], a[176:179], a[244:247], v[200:203]
    ds_read_b128 a[244:247], v226 offset:1280
    v_mfma_f32_16x16x32_bf16 v[200:203], a[188:191], a[248:251], v[200:203]
    ds_read_b128 a[248:251], v226 offset:1344
    v_mfma_f32_16x16x32_bf16 v[208:211], a[192:195], a[252:255], v[208:211]
    v_permlane16_swap_b32 v248, v249
    v_mfma_f32_16x16x32_bf16 v[208:211], a[204:207], v[252:255], v[208:211]
    v_max_f32 v248, v248, v249
    v_mov_b32 v249, v248
    v_mfma_f32_16x16x32_bf16 v[204:207], a[196:199], a[252:255], v[204:207]
    v_mfma_f32_16x16x32_bf16 v[204:207], a[208:211], v[252:255], v[204:207]
    v_permlane32_swap_b32 v248, v249
    v_mfma_f32_16x16x32_bf16 v[200:203], a[200:203], a[252:255], v[200:203]
    ds_read_b128 a[252:255], v226 offset:1408
    v_max_f32 v248, v248, v249
    v_mfma_f32_16x16x32_bf16 v[200:203], a[212:215], v[252:255], v[200:203]
    s_waitcnt lgkmcnt(3)
    v_cvt_pk_bf16_f32 v138, v208, v209
    v_cvt_pk_bf16_f32 v139, v210, v211
    v_mfma_f32_16x16x32_bf16 v[220:223], a[144:147], a[236:239], 0
    v_cvt_pk_bf16_f32 v140, v204, v205
    v_cvt_pk_bf16_f32 v141, v206, v207
    v_mfma_f32_16x16x32_bf16 v[220:223], a[156:159], a[240:243], v[220:223]
    ds_read_b128 v[252:255], v226 offset:1472
    v_mul_f32 v236, s37, v248
    v_mfma_f32_16x16x32_bf16 v[216:219], a[148:151], a[236:239], 0
    v_cvt_pk_bf16_f32 v142, v200, v201
    v_cvt_pk_bf16_f32 v143, v202, v203
    v_mfma_f32_16x16x32_bf16 v[216:219], a[160:163], a[240:243], v[216:219]
    buffer_load_dwordx4 v247, s[4:7], s56 offen offset:1024 lds
    v_mfma_f32_16x16x32_bf16 v[212:215], a[152:155], a[236:239], 0
    s_add_u32 s56, s56, s42
    ds_read_b128 a[236:239], v227 offset:6144
    v_fma_f32 v168, v168, s37, -v236
    v_mfma_f32_16x16x32_bf16 v[212:215], a[164:167], a[240:243], v[212:215]
    s_add_u32 m0, s41, 0x9740
    ds_read_b128 a[240:243], v227 offset:6208
    v_fma_f32 v169, v169, s37, -v236
    s_waitcnt lgkmcnt(4)
    v_mfma_f32_16x16x32_bf16 v[220:223], a[168:171], a[244:247], v[220:223]
    v_fma_f32 v170, v170, s37, -v236
    v_fma_f32 v171, v171, s37, -v236
    v_mfma_f32_16x16x32_bf16 v[220:223], a[180:183], a[248:251], v[220:223]
    v_exp_f32 v168, v168
    v_mfma_f32_16x16x32_bf16 v[216:219], a[172:175], a[244:247], v[216:219]
    v_exp_f32 v169, v169
    v_mfma_f32_16x16x32_bf16 v[216:219], a[184:187], a[248:251], v[216:219]
    v_exp_f32 v170, v170
    v_mfma_f32_16x16x32_bf16 v[212:215], a[176:179], a[244:247], v[212:215]
    ds_read_b128 a[244:247], v227 offset:6272
    v_cvt_pk_bf16_f32 v180, v168, v169
    v_mfma_f32_16x16x32_bf16 v[212:215], a[188:191], a[248:251], v[212:215]
    s_waitcnt lgkmcnt(3)
    ds_read_b128 a[248:251], v227 offset:6336
    v_fma_f32 v172, v172, s37, -v236
    v_mfma_f32_16x16x32_bf16 v[220:223], a[192:195], a[252:255], v[220:223]
    buffer_load_dwordx4 v246, s[4:7], s56 offen lds
    v_mfma_f32_16x16x32_bf16 v[220:223], a[204:207], v[252:255], v[220:223]
    v_exp_f32 v171, v171
    v_mfma_f32_16x16x32_bf16 v[216:219], a[196:199], a[252:255], v[216:219]
    v_cvt_pk_bf16_f32 v181, v170, v171
    v_fma_f32 v173, v173, s37, -v236
    v_mfma_f32_16x16x32_bf16 v[216:219], a[208:211], v[252:255], v[216:219]
    ds_read_b128 v[168:171], v234
    v_bfe_u32 v234, s67, v233, 4
    v_mfma_f32_16x16x32_bf16 v[212:215], a[200:203], a[252:255], v[212:215]
    v_cvt_pk_bf16_f32 v132, v220, v221
    v_cvt_pk_bf16_f32 v133, v222, v223
    v_mfma_f32_16x16x32_bf16 v[212:215], a[212:215], v[252:255], v[212:215]
    s_waitcnt lgkmcnt(3)
    ds_read_b128 a[252:255], v227 offset:6400
    ds_read_b128 v[252:255], v227 offset:6464
    v_mfma_f32_16x16x32_bf16 v[208:211], a[0:3], a[236:239], 0
    v_cvt_pk_bf16_f32 v134, v216, v217
    v_cvt_pk_bf16_f32 v135, v218, v219
    v_mfma_f32_16x16x32_bf16 v[208:211], a[12:15], a[240:243], v[208:211]
    v_mad_u32_u24 v234, v234, s40, v231
    v_fma_f32 v174, v174, s37, -v236
    v_mfma_f32_16x16x32_bf16 v[204:207], a[4:7], a[236:239], 0
    v_cvt_pk_bf16_f32 v136, v212, v213
    v_cvt_pk_bf16_f32 v137, v214, v215
    v_mfma_f32_16x16x32_bf16 v[204:207], a[16:19], a[240:243], v[204:207]
    buffer_load_dwordx4 v247, s[4:7], s56 offen offset:1024 lds
    v_mfma_f32_16x16x32_bf16 v[200:203], a[8:11], a[236:239], 0
    s_add_u32 s56, s56, s42
    v_fma_f32 v175, v175, s37, -v236
    v_fma_f32 v144, v144, s37, -v236
    v_mfma_f32_16x16x32_bf16 v[200:203], a[20:23], a[240:243], v[200:203]
    s_add_u32 m0, s41, 0xb580
    v_exp_f32 v172, v172
    s_waitcnt lgkmcnt(2)
    v_mfma_f32_16x16x32_bf16 v[168:171], v[24:27], v[138:141], v[168:171]
    v_exp_f32 v173, v173
    v_mfma_f32_16x16x32_bf16 v[220:223], a[236:239], a[72:75], 0
    v_exp_f32 v174, v174
    v_mfma_f32_16x16x32_bf16 v[220:223], a[240:243], a[84:87], v[220:223]
    v_exp_f32 v175, v175
    v_mfma_f32_16x16x32_bf16 v[216:219], a[236:239], a[76:79], 0
    v_cvt_pk_bf16_f32 v182, v172, v173
    v_cvt_pk_bf16_f32 v183, v174, v175
    v_mfma_f32_16x16x32_bf16 v[216:219], a[240:243], a[88:91], v[216:219]
    ds_read_b128 v[172:175], v235
    v_bfe_u32 v235, s68, v233, 4
    v_mfma_f32_16x16x32_bf16 v[196:199], a[216:219], v[180:183], 0
    v_mad_u32_u24 v235, v235, s40, v231
    v_fma_f32 v145, v145, s37, -v236
    v_mfma_f32_16x16x32_bf16 v[184:187], v[70:73], v[180:183], 0
    v_fma_f32 v146, v146, s37, -v236
    v_fma_f32 v147, v147, s37, -v236
    v_mfma_f32_16x16x32_bf16 v[188:191], v[92:95], v[180:183], 0
    v_exp_f32 v144, v144
    v_mfma_f32_16x16x32_bf16 v[192:195], v[114:117], v[180:183], 0
    v_exp_f32 v145, v145
    v_mfma_f32_16x16x16_bf16 v[168:171], v[28:29], v[142:143], v[168:171]
    v_exp_f32 v146, v146
    v_mfma_f32_16x16x32_bf16 v[212:215], a[236:239], a[80:83], 0
    ds_read_b128 a[236:239], v239
    v_cvt_pk_bf16_f32 v176, v144, v145
    v_mfma_f32_16x16x32_bf16 v[212:215], a[240:243], a[92:95], v[212:215]
    ds_read_b128 a[240:243], v240
    v_fma_f32 v148, v148, s37, -v236
    v_mfma_f32_16x16x32_bf16 v[208:211], a[24:27], a[244:247], v[208:211]
    v_exp_f32 v147, v147
    v_mfma_f32_16x16x32_bf16 v[208:211], a[36:39], a[248:251], v[208:211]
    s_waitcnt lgkmcnt(2)
    v_cvt_pk_bf16_f32 v177, v146, v147
    v_fma_f32 v149, v149, s37, -v236
    v_mfma_f32_16x16x32_bf16 v[172:175], v[30:33], v[138:141], v[172:175]
    ds_read_b128 v[144:147], v230 offset:1280
    v_fma_f32 v150, v150, s37, -v236
    v_mfma_f32_16x16x32_bf16 v[204:207], a[28:31], a[244:247], v[204:207]
    v_fma_f32 v151, v151, s37, -v236
    v_fma_f32 v152, v152, s37, -v236
    v_mfma_f32_16x16x32_bf16 v[204:207], a[40:43], a[248:251], v[204:207]
    v_exp_f32 v148, v148
    v_mfma_f32_16x16x16_bf16 v[172:175], v[34:35], v[142:143], v[172:175]
    v_exp_f32 v149, v149
    v_mfma_f32_16x16x32_bf16 v[200:203], a[32:35], a[244:247], v[200:203]
    v_exp_f32 v150, v150
    v_mfma_f32_16x16x32_bf16 v[200:203], a[44:47], a[248:251], v[200:203]
    v_exp_f32 v151, v151
    v_mfma_f32_16x16x32_bf16 v[220:223], a[244:247], a[96:99], v[220:223]
    v_cvt_pk_bf16_f32 v178, v148, v149
    v_cvt_pk_bf16_f32 v179, v150, v151
    v_mfma_f32_16x16x32_bf16 v[220:223], a[248:251], a[108:111], v[220:223]
    ds_read_b128 v[148:151], v230 offset:1920
    v_fma_f32 v153, v153, s37, -v236
    v_mfma_f32_16x16x32_bf16 v[196:199], a[216:219], v[176:179], v[196:199]
    v_fma_f32 v154, v154, s37, -v236
    v_fma_f32 v155, v155, s37, -v236
    v_mfma_f32_16x16x32_bf16 v[184:187], v[74:77], v[176:179], v[184:187]
    v_exp_f32 v152, v152
    v_mfma_f32_16x16x32_bf16 v[188:191], v[96:99], v[176:179], v[188:191]
    v_exp_f32 v153, v153
    v_mfma_f32_16x16x32_bf16 v[192:195], v[118:121], v[176:179], v[192:195]
    s_waitcnt lgkmcnt(1)
    v_exp_f32 v154, v154
    v_mfma_f32_16x16x32_bf16 v[144:147], v[36:39], v[138:141], v[144:147]
    v_exp_f32 v155, v155
    v_mfma_f32_16x16x32_bf16 v[216:219], a[244:247], a[100:103], v[216:219]
    v_cvt_pk_bf16_f32 v180, v152, v153
    v_cvt_pk_bf16_f32 v181, v154, v155
    v_mfma_f32_16x16x32_bf16 v[216:219], a[248:251], a[112:115], v[216:219]
    ds_read_b128 v[152:155], v250
    v_bfe_u32 v250, s69, v233, 4
    v_mfma_f32_16x16x16_bf16 v[144:147], v[40:41], v[142:143], v[144:147]
    s_waitcnt lgkmcnt(1)
    v_mad_u32_u24 v250, v250, s40, v231
    v_fma_f32 v156, v156, s37, -v236
    v_mfma_f32_16x16x32_bf16 v[148:151], v[42:45], v[138:141], v[148:151]
    v_fma_f32 v157, v157, s37, -v236
    v_fma_f32 v158, v158, s37, -v236
    v_mfma_f32_16x16x32_bf16 v[212:215], a[244:247], a[104:107], v[212:215]
    ds_read_b128 a[244:247], v239 offset:1024
    v_fma_f32 v159, v159, s37, -v236
    v_mfma_f32_16x16x32_bf16 v[212:215], a[248:251], a[116:119], v[212:215]
    ds_read_b128 a[248:251], v240 offset:1024
    v_fma_f32 v160, v160, s37, -v236
    v_mfma_f32_16x16x16_bf16 v[148:151], v[46:47], v[142:143], v[148:151]
    v_exp_f32 v156, v156
    v_mfma_f32_16x16x32_bf16 v[208:211], a[48:51], a[252:255], v[208:211]
    v_exp_f32 v157, v157
    v_mfma_f32_16x16x32_bf16 v[208:211], a[60:63], v[252:255], v[208:211]
    v_exp_f32 v158, v158
    v_mfma_f32_16x16x32_bf16 v[204:207], a[52:55], a[252:255], v[204:207]
    v_exp_f32 v159, v159
    v_mfma_f32_16x16x32_bf16 v[204:207], a[64:67], v[252:255], v[204:207]
    s_waitcnt lgkmcnt(2)
    v_cvt_pk_bf16_f32 v182, v156, v157
    v_cvt_pk_bf16_f32 v183, v158, v159
    v_mfma_f32_16x16x32_bf16 v[152:155], v[48:51], v[138:141], v[152:155]
    ds_read_b128 v[156:159], v234
    v_cvt_pk_bf16_f32 v60, v208, v209
    v_mfma_f32_16x16x32_bf16 v[196:199], a[216:219], v[180:183], v[196:199]
    v_cvt_pk_bf16_f32 v61, v210, v211
    v_bfe_u32 v234, s70, v233, 4
    v_mfma_f32_16x16x32_bf16 v[184:187], v[78:81], v[180:183], v[184:187]
    v_cvt_pk_bf16_f32 v62, v204, v205
    v_cvt_pk_bf16_f32 v63, v206, v207
    v_mfma_f32_16x16x32_bf16 v[188:191], v[100:103], v[180:183], v[188:191]
    v_mad_u32_u24 v234, v234, s40, v231
    v_fma_f32 v161, v161, s37, -v236
    v_mfma_f32_16x16x32_bf16 v[192:195], v[122:125], v[180:183], v[192:195]
    v_fma_f32 v162, v162, s37, -v236
    v_fma_f32 v163, v163, s37, -v236
    v_mfma_f32_16x16x16_bf16 v[152:155], v[52:53], v[142:143], v[152:155]
    v_exp_f32 v160, v160
    v_mfma_f32_16x16x32_bf16 v[200:203], a[56:59], a[252:255], v[200:203]
    v_exp_f32 v161, v161
    v_mfma_f32_16x16x32_bf16 v[200:203], a[68:71], v[252:255], v[200:203]
    v_exp_f32 v162, v162
    v_mfma_f32_16x16x32_bf16 v[220:223], a[252:255], a[120:123], v[220:223]
    v_exp_f32 v163, v163
    v_mfma_f32_16x16x32_bf16 v[220:223], v[252:255], a[132:135], v[220:223]
    s_waitcnt lgkmcnt(0)
    v_cvt_pk_bf16_f32 v176, v160, v161
    v_cvt_pk_bf16_f32 v177, v162, v163
    v_mfma_f32_16x16x32_bf16 v[156:159], v[54:57], v[138:141], v[156:159]
    ds_read_b128 v[160:163], v235
    v_cvt_pk_bf16_f32 v64, v200, v201
    v_mfma_f32_16x16x32_bf16 v[216:219], a[252:255], a[124:127], v[216:219]
    v_cvt_pk_bf16_f32 v65, v202, v203
    v_bfe_u32 v235, s71, v233, 4
    v_mfma_f32_16x16x32_bf16 v[216:219], v[252:255], a[136:139], v[216:219]
    v_cvt_pk_bf16_f32 v86, v220, v221
    v_cvt_pk_bf16_f32 v87, v222, v223
    v_mfma_f32_16x16x16_bf16 v[156:159], v[58:59], v[142:143], v[156:159]
    v_mad_u32_u24 v235, v235, s40, v231
    v_fma_f32 v164, v164, s37, -v236
    v_mfma_f32_16x16x32_bf16 v[212:215], a[252:255], a[128:131], v[212:215]
    ds_read_b128 a[252:255], v241 offset:12288
    v_fma_f32 v165, v165, s37, -v236
    v_mfma_f32_16x16x32_bf16 v[212:215], v[252:255], a[140:143], v[212:215]
    v_cvt_pk_bf16_f32 v108, v216, v217
    v_cvt_pk_bf16_f32 v109, v218, v219
    v_mfma_f32_16x16x32_bf16 v[208:211], a[220:223], a[236:239], 0
    ds_read_b128 v[252:255], v241 offset:12800
    v_fma_f32 v166, v166, s37, -v236
    v_mfma_f32_16x16x32_bf16 v[200:203], a[220:223], a[240:243], 0
    v_fma_f32 v167, v167, s37, -v236
    v_max3_f32 v248, v168, v169, v170
    v_mfma_f32_16x16x32_bf16 v[204:207], a[224:227], a[236:239], 0
    s_waitcnt lgkmcnt(2)
    v_cvt_pk_bf16_f32 v130, v212, v213
    v_cvt_pk_bf16_f32 v131, v214, v215
    v_mfma_f32_16x16x32_bf16 v[160:163], v[60:63], v[138:141], v[160:163]
    v_exp_f32 v164, v164
    v_mfma_f32_16x16x32_bf16 v[220:223], a[224:227], a[240:243], 0
    ds_read_b128 a[240:243], v242 offset:12800
    v_max3_f32 v249, v171, v172, v173
    v_mfma_f32_16x16x32_bf16 v[216:219], a[228:231], a[236:239], 0
    v_exp_f32 v165, v165
    v_mfma_f32_16x16x16_bf16 v[160:163], v[64:65], v[142:143], v[160:163]
    v_exp_f32 v166, v166
    v_mfma_f32_16x16x32_bf16 v[212:215], a[232:235], a[236:239], 0
    s_waitcnt lgkmcnt(2)
    ds_read_b128 a[236:239], v242 offset:12288
    v_cvt_pk_bf16_f32 v178, v164, v165
    v_mfma_f32_16x16x32_bf16 v[208:211], a[252:255], a[244:247], v[208:211]
    v_exp_f32 v167, v167
    v_mfma_f32_16x16x32_bf16 v[200:203], a[252:255], a[248:251], v[200:203]
    s_waitcnt lgkmcnt(2)
    ds_read_b128 a[252:255], v241 offset:24576
    v_cvt_pk_bf16_f32 v179, v166, v167
    v_mfma_f32_16x16x32_bf16 v[204:207], v[252:255], a[244:247], v[204:207]
    ds_read_b128 v[164:167], v228 offset:640
    v_max3_f32 v248, v248, v174, v175
    v_mfma_f32_16x16x32_bf16 v[196:199], a[216:219], v[176:179], v[196:199]
    v_max3_f32 v249, v249, v144, v145
    v_max3_f32 v248, v248, v146, v147
    v_mfma_f32_16x16x32_bf16 v[184:187], v[66:69], v[176:179], v[184:187]
    v_max3_f32 v249, v249, v148, v149
    v_max3_f32 v248, v248, v150, v151
    v_mfma_f32_16x16x32_bf16 v[188:191], v[88:91], v[176:179], v[188:191]
    v_max3_f32 v249, v249, v152, v153
    v_max3_f32 v248, v248, v154, v155
    v_mfma_f32_16x16x32_bf16 v[192:195], v[110:113], v[176:179], v[192:195]
    v_rcp_f32 v197, v196
    v_mfma_f32_16x16x32_bf16 v[220:223], v[252:255], a[248:251], v[220:223]
    s_waitcnt lgkmcnt(2)
    ds_read_b128 a[248:251], v240 offset:2048
    ds_read_b128 v[252:255], v241 offset:25088
    v_mfma_f32_16x16x32_bf16 v[216:219], a[236:239], a[244:247], v[216:219]
    ds_read_b128 a[236:239], v242 offset:24576
    v_mul_f32 v184, v184, v197
    v_mfma_f32_16x16x32_bf16 v[212:215], a[240:243], a[244:247], v[212:215]
    s_waitcnt lgkmcnt(3)
    ds_read_b128 a[244:247], v239 offset:2048
    v_mul_f32 v185, v185, v197
    v_cvt_pk_bf16_f32 v184, v184, v185
    v_mul_f32 v186, v186, v197
    ds_read_b128 a[240:243], v242 offset:25088
    v_mfma_f32_16x16x32_bf16 v[164:167], v[12:15], v[132:135], v[164:167]
    v_mul_f32 v187, v187, v197
    v_cvt_pk_bf16_f32 v185, v186, v187
    v_mul_f32 v188, v188, v197
    v_mul_f32 v189, v189, v197
    v_cvt_pk_bf16_f32 v186, v188, v189
    v_mul_f32 v190, v190, v197
    v_mfma_f32_16x16x16_bf16 v[164:167], v[16:17], v[136:137], v[164:167]
    s_waitcnt lgkmcnt(4)
    v_mul_f32 v191, v191, v197
    v_cvt_pk_bf16_f32 v187, v190, v191
    v_mul_f32 v192, v192, v197
    v_mul_f32 v193, v193, v197
    v_cvt_pk_bf16_f32 v188, v192, v193
    v_mul_f32 v194, v194, v197
    v_mul_f32 v195, v195, v197
    v_mfma_f32_16x16x32_bf16 v[200:203], a[252:255], a[248:251], v[200:203]
    s_waitcnt lgkmcnt(3)
    v_cvt_pk_bf16_f32 v189, v194, v195
    v_max3_f32 v249, v249, v156, v157
    v_mfma_f32_16x16x32_bf16 v[220:223], v[252:255], a[248:251], v[220:223]
    s_waitcnt lgkmcnt(1)
    ds_read_b128 a[248:251], v240 offset:3072
    ds_write_b128 v237, v[184:187] offset:12288
    v_mfma_f32_16x16x32_bf16 v[208:211], a[252:255], a[244:247], v[208:211]
    ds_write_b64 v238, v[188:189] offset:12288
    v_mfma_f32_16x16x32_bf16 v[204:207], v[252:255], a[244:247], v[204:207]
    v_max3_f32 v248, v248, v158, v159
    v_max3_f32 v249, v249, v160, v161
    v_mfma_f32_16x16x32_bf16 v[216:219], a[236:239], a[244:247], v[216:219]
    s_waitcnt lgkmcnt(3)
    v_max3_f32 v248, v248, v162, v163
    v_max_f32 v248, v248, v249
    v_mfma_f32_16x16x32_bf16 v[212:215], a[240:243], a[244:247], v[212:215]
    v_mov_b32 v249, v248
    s_nop 1
    ds_read_b128 a[244:247], v239 offset:3072
    ds_read_b128 a[252:255], v241 offset:36864
    v_permlane16_swap_b32 v248, v249
    ds_read_b128 v[252:255], v241 offset:37376
    v_max_f32 v248, v248, v249
    ds_read_b128 a[236:239], v242 offset:36864
    v_mov_b32 v249, v248
    ds_read_b128 a[240:243], v242 offset:37376
    s_nop 0
    v_permlane32_swap_b32 v248, v249
    v_max_f32 v248, v248, v249
    v_mul_f32 v236, s37, v248
    v_fma_f32 v168, v168, s37, -v236
    v_fma_f32 v169, v169, s37, -v236
    v_fma_f32 v170, v170, s37, -v236
    v_fma_f32 v171, v171, s37, -v236
    v_exp_f32 v168, v168
    v_exp_f32 v169, v169
    v_exp_f32 v170, v170
    v_exp_f32 v171, v171
    v_cvt_pk_bf16_f32 v180, v168, v169
    v_cvt_pk_bf16_f32 v181, v170, v171
    ds_read_b128 v[168:171], v229 offset:640
    s_waitcnt lgkmcnt(4)
    v_mfma_f32_16x16x32_bf16 v[208:211], a[252:255], a[244:247], v[208:211]
    v_fma_f32 v172, v172, s37, -v236
    v_fma_f32 v173, v173, s37, -v236
    v_mfma_f32_16x16x32_bf16 v[200:203], a[252:255], a[248:251], v[200:203]
    s_waitcnt lgkmcnt(3)
    ds_read_b128 a[252:255], v241 offset:49152
    v_fma_f32 v174, v174, s37, -v236
    v_mfma_f32_16x16x32_bf16 v[204:207], v[252:255], a[244:247], v[204:207]
    v_fma_f32 v175, v175, s37, -v236
    v_fma_f32 v144, v144, s37, -v236
    v_mfma_f32_16x16x32_bf16 v[220:223], v[252:255], a[248:251], v[220:223]
    s_waitcnt lgkmcnt(3)
    ds_read_b128 a[248:251], v240 offset:4096
    ds_read_b128 v[252:255], v241 offset:49664
    v_mfma_f32_16x16x32_bf16 v[216:219], a[236:239], a[244:247], v[216:219]
    s_waitcnt lgkmcnt(4)
    ds_read_b128 a[236:239], v242 offset:49152
    v_fma_f32 v145, v145, s37, -v236
    v_mfma_f32_16x16x32_bf16 v[212:215], a[240:243], a[244:247], v[212:215]
    s_waitcnt lgkmcnt(4)
    ds_read_b128 a[244:247], v239 offset:4096
    v_exp_f32 v172, v172
    v_exp_f32 v173, v173
    ds_read_b128 a[240:243], v242 offset:49664
    v_exp_f32 v174, v174
    v_exp_f32 v175, v175
    v_mfma_f32_16x16x32_bf16 v[168:171], v[36:39], v[132:135], v[168:171]
    v_cvt_pk_bf16_f32 v182, v172, v173
    v_cvt_pk_bf16_f32 v183, v174, v175
    ds_read_b128 v[172:175], v229 offset:1280
    v_fma_f32 v146, v146, s37, -v236
    v_mfma_f32_16x16x32_bf16 v[196:199], a[216:219], v[180:183], 0
    v_fma_f32 v147, v147, s37, -v236
    v_fma_f32 v148, v148, s37, -v236
    v_mfma_f32_16x16x32_bf16 v[184:187], v[68:71], v[180:183], 0
    v_exp_f32 v144, v144
    v_mfma_f32_16x16x32_bf16 v[188:191], v[90:93], v[180:183], 0
    v_exp_f32 v145, v145
    v_mfma_f32_16x16x32_bf16 v[192:195], v[112:115], v[180:183], 0
    v_exp_f32 v146, v146
    v_mfma_f32_16x16x16_bf16 v[168:171], v[40:41], v[136:137], v[168:171]
    s_waitcnt lgkmcnt(2)
    v_exp_f32 v147, v147
    v_mfma_f32_16x16x32_bf16 v[208:211], a[252:255], a[244:247], v[208:211]
    v_cvt_pk_bf16_f32 v176, v144, v145
    v_cvt_pk_bf16_f32 v177, v146, v147
    v_mfma_f32_16x16x32_bf16 v[200:203], a[252:255], a[248:251], v[200:203]
    ds_read_b128 a[252:255], v241 offset:61440
    ds_read_b128 v[144:147], v228 offset:1280
    v_mfma_f32_16x16x32_bf16 v[204:207], v[252:255], a[244:247], v[204:207]
    s_waitcnt lgkmcnt(2)
    v_fma_f32 v149, v149, s37, -v236
    v_fma_f32 v150, v150, s37, -v236
    v_mfma_f32_16x16x32_bf16 v[172:175], v[42:45], v[132:135], v[172:175]
    v_fma_f32 v151, v151, s37, -v236
    v_fma_f32 v152, v152, s37, -v236
    v_mfma_f32_16x16x32_bf16 v[220:223], v[252:255], a[248:251], v[220:223]
    ds_read_b128 a[248:251], v240 offset:5120
    ds_read_b128 v[252:255], v241 offset:61952
    v_mfma_f32_16x16x32_bf16 v[216:219], a[236:239], a[244:247], v[216:219]
    ds_read_b128 a[236:239], v242 offset:61440
    v_fma_f32 v153, v153, s37, -v236
    v_mfma_f32_16x16x16_bf16 v[172:175], v[46:47], v[136:137], v[172:175]
    v_exp_f32 v148, v148
    v_mfma_f32_16x16x32_bf16 v[212:215], a[240:243], a[244:247], v[212:215]
    ds_read_b128 a[244:247], v239 offset:5120
    ds_read_b128 a[240:243], v242 offset:61952
    v_exp_f32 v149, v149
    v_exp_f32 v150, v150
    v_exp_f32 v151, v151
    v_cvt_pk_bf16_f32 v178, v148, v149
    v_cvt_pk_bf16_f32 v179, v150, v151
    ds_read_b128 v[148:151], v228 offset:1920
    v_fma_f32 v154, v154, s37, -v236
    v_mfma_f32_16x16x32_bf16 v[196:199], a[216:219], v[176:179], v[196:199]
    v_fma_f32 v155, v155, s37, -v236
    v_fma_f32 v156, v156, s37, -v236
    v_mfma_f32_16x16x32_bf16 v[184:187], v[76:79], v[176:179], v[184:187]
    v_exp_f32 v152, v152
    v_mfma_f32_16x16x32_bf16 v[188:191], v[98:101], v[176:179], v[188:191]
    v_exp_f32 v153, v153
    v_mfma_f32_16x16x32_bf16 v[192:195], v[120:123], v[176:179], v[192:195]
    s_waitcnt lgkmcnt(5)
    v_exp_f32 v154, v154
    v_mfma_f32_16x16x32_bf16 v[144:147], v[18:21], v[132:135], v[144:147]
    s_waitcnt lgkmcnt(2)
    v_exp_f32 v155, v155
    v_mfma_f32_16x16x32_bf16 v[208:211], a[252:255], a[244:247], v[208:211]
    v_cvt_pk_bf16_f32 v180, v152, v153
    v_cvt_pk_bf16_f32 v181, v154, v155
    v_mfma_f32_16x16x32_bf16 v[200:203], a[252:255], a[248:251], v[200:203]
    ds_read_b128 a[252:255], v224 offset:15616
    ds_read_b128 v[152:155], v229 offset:1920
    v_mfma_f32_16x16x16_bf16 v[144:147], v[22:23], v[136:137], v[144:147]
    s_waitcnt lgkmcnt(2)
    v_fma_f32 v157, v157, s37, -v236
    v_fma_f32 v158, v158, s37, -v236
    v_mfma_f32_16x16x32_bf16 v[148:151], v[0:3], v[132:135], v[148:151]
    v_cvt_pk_bf16_f32 v208, v208, v209
    v_cvt_pk_bf16_f32 v209, v210, v211
    v_mfma_f32_16x16x32_bf16 v[204:207], v[252:255], a[244:247], v[204:207]
    v_cvt_pk_bf16_f32 v200, v200, v201
    v_cvt_pk_bf16_f32 v201, v202, v203
    v_mfma_f32_16x16x32_bf16 v[220:223], v[252:255], a[248:251], v[220:223]
    ds_read_b128 a[248:251], v224 offset:15552
    ds_read_b128 v[252:255], v224 offset:15680
    v_mfma_f32_16x16x16_bf16 v[148:151], v[4:5], v[136:137], v[148:151]
    v_fma_f32 v159, v159, s37, -v236
    v_fma_f32 v160, v160, s37, -v236
    v_mfma_f32_16x16x32_bf16 v[216:219], a[236:239], a[244:247], v[216:219]
    ds_read_b128 a[236:239], v224 offset:15744
    v_cvt_pk_bf16_f32 v210, v204, v205
    v_mfma_f32_16x16x32_bf16 v[212:215], a[240:243], a[244:247], v[212:215]
    s_waitcnt lgkmcnt(3)
    ds_read_b128 a[244:247], v224 offset:15488
    ds_read_b128 a[240:243], v224 offset:15808
    v_cvt_pk_bf16_f32 v211, v206, v207
    buffer_store_dwordx4 v[208:211], v243, s[20:23], s51 offen sc0 sc1
    v_mfma_f32_16x16x32_bf16 v[152:155], v[24:27], v[132:135], v[152:155]
    v_cvt_pk_bf16_f32 v202, v220, v221
    v_cvt_pk_bf16_f32 v203, v222, v223
    v_cvt_pk_bf16_f32 v216, v216, v217
    v_cvt_pk_bf16_f32 v217, v218, v219
    v_cvt_pk_bf16_f32 v218, v212, v213
    v_cvt_pk_bf16_f32 v219, v214, v215
    v_mfma_f32_16x16x16_bf16 v[152:155], v[28:29], v[136:137], v[152:155]
    s_waitcnt lgkmcnt(1)
    v_exp_f32 v156, v156
    v_exp_f32 v157, v157
    v_exp_f32 v158, v158
    v_exp_f32 v159, v159
    v_cvt_pk_bf16_f32 v182, v156, v157
    v_cvt_pk_bf16_f32 v183, v158, v159
    ds_read_b128 v[156:159], v229 offset:2560
    v_mfma_f32_16x16x32_bf16 v[208:211], a[0:3], a[244:247], 0
    v_fma_f32 v161, v161, s37, -v236
    v_fma_f32 v162, v162, s37, -v236
    v_mfma_f32_16x16x32_bf16 v[208:211], a[12:15], a[248:251], v[208:211]
    v_fma_f32 v163, v163, s37, -v236
    v_max3_f32 v248, v164, v165, v166
    v_mfma_f32_16x16x32_bf16 v[196:199], a[216:219], v[180:183], v[196:199]
    v_exp_f32 v160, v160
    v_mfma_f32_16x16x32_bf16 v[184:187], v[82:85], v[180:183], v[184:187]
    v_exp_f32 v161, v161
    v_mfma_f32_16x16x32_bf16 v[188:191], v[104:107], v[180:183], v[188:191]
    v_exp_f32 v162, v162
    v_mfma_f32_16x16x32_bf16 v[192:195], v[126:129], v[180:183], v[192:195]
    buffer_store_dwordx4 v[200:203], v245, s[20:23], s51 offen sc0 sc1
    v_mfma_f32_16x16x32_bf16 v[204:207], a[4:7], a[244:247], 0
    v_exp_f32 v163, v163
    v_mfma_f32_16x16x32_bf16 v[204:207], a[16:19], a[248:251], v[204:207]
    v_cvt_pk_bf16_f32 v176, v160, v161
    v_cvt_pk_bf16_f32 v177, v162, v163
    v_mfma_f32_16x16x32_bf16 v[200:203], a[8:11], a[244:247], 0
    ds_read_b128 v[160:163], v228 offset:2560
    v_max3_f32 v249, v167, v168, v169
    v_mfma_f32_16x16x32_bf16 v[200:203], a[20:23], a[248:251], v[200:203]
    v_max3_f32 v248, v248, v170, v171
    v_max3_f32 v249, v249, v172, v173
    v_mfma_f32_16x16x16_bf16 v[196:199], a[216:217], v[176:177], v[196:199]
    v_max3_f32 v248, v248, v174, v175
    v_max3_f32 v249, v249, v144, v145
    v_mfma_f32_16x16x16_bf16 v[184:187], v[86:87], v[176:177], v[184:187]
    v_max3_f32 v248, v248, v146, v147
    v_max3_f32 v249, v249, v148, v149
    v_mfma_f32_16x16x16_bf16 v[188:191], v[108:109], v[176:177], v[188:191]
    v_max3_f32 v248, v248, v150, v151
    v_max3_f32 v249, v249, v152, v153
    v_mfma_f32_16x16x16_bf16 v[192:195], v[130:131], v[176:177], v[192:195]
    v_rcp_f32 v197, v196
    v_mfma_f32_16x16x32_bf16 v[220:223], a[244:247], a[72:75], 0
    v_mul_f32 v184, v184, v197
    v_mul_f32 v185, v185, v197
    v_mfma_f32_16x16x32_bf16 v[220:223], a[248:251], a[84:87], v[220:223]
    v_cvt_pk_bf16_f32 v184, v184, v185
    v_mul_f32 v186, v186, v197
    v_mfma_f32_16x16x32_bf16 v[212:215], a[244:247], a[80:83], 0
    v_mul_f32 v187, v187, v197
    v_cvt_pk_bf16_f32 v185, v186, v187
    v_mfma_f32_16x16x32_bf16 v[212:215], a[248:251], a[92:95], v[212:215]
    buffer_store_dwordx4 v[216:219], v244, s[20:23], s51 offen sc0 sc1
    v_mfma_f32_16x16x32_bf16 v[208:211], a[24:27], a[252:255], v[208:211]
    s_add_u32 s51, s51, s48
    v_mul_f32 v188, v188, v197
    v_mul_f32 v189, v189, v197
    v_mfma_f32_16x16x32_bf16 v[208:211], a[36:39], v[252:255], v[208:211]
    v_cvt_pk_bf16_f32 v186, v188, v189
    v_mul_f32 v190, v190, v197
    v_mfma_f32_16x16x32_bf16 v[216:219], a[244:247], a[76:79], 0
    ds_read_b128 a[244:247], v224 offset:18560
    v_mul_f32 v191, v191, v197
    v_mfma_f32_16x16x32_bf16 v[216:219], a[248:251], a[88:91], v[216:219]
    ds_read_b128 a[248:251], v224 offset:18624
    v_cvt_pk_bf16_f32 v187, v190, v191
    v_mfma_f32_16x16x32_bf16 v[204:207], a[28:31], a[252:255], v[204:207]
    v_mul_f32 v192, v192, v197
    v_mul_f32 v193, v193, v197
    v_mfma_f32_16x16x32_bf16 v[204:207], a[40:43], v[252:255], v[204:207]
    v_cvt_pk_bf16_f32 v188, v192, v193
    v_mul_f32 v194, v194, v197
    v_mfma_f32_16x16x32_bf16 v[200:203], a[32:35], a[252:255], v[200:203]
    v_mul_f32 v195, v195, v197
    v_cvt_pk_bf16_f32 v189, v194, v195
    v_mfma_f32_16x16x32_bf16 v[200:203], a[44:47], v[252:255], v[200:203]
    ds_write_b128 v237, v[184:187] offset:18432
    v_mfma_f32_16x16x32_bf16 v[220:223], a[252:255], a[96:99], v[220:223]
    ds_write_b64 v238, v[188:189] offset:18432
    v_mfma_f32_16x16x32_bf16 v[220:223], v[252:255], a[108:111], v[220:223]
    v_max3_f32 v248, v248, v154, v155
    v_mfma_f32_16x16x32_bf16 v[216:219], a[252:255], a[100:103], v[216:219]
    v_mfma_f32_16x16x32_bf16 v[216:219], v[252:255], a[112:115], v[216:219]
    v_mfma_f32_16x16x32_bf16 v[212:215], a[252:255], a[104:107], v[212:215]
    ds_read_b128 a[252:255], v224 offset:18688
    v_mfma_f32_16x16x32_bf16 v[212:215], v[252:255], a[116:119], v[212:215]
    ds_read_b128 v[252:255], v224 offset:18752
    v_mfma_f32_16x16x32_bf16 v[208:211], a[48:51], a[236:239], v[208:211]
    s_waitcnt lgkmcnt(4)
    v_mfma_f32_16x16x32_bf16 v[208:211], a[60:63], a[240:243], v[208:211]
    v_mfma_f32_16x16x32_bf16 v[204:207], a[52:55], a[236:239], v[204:207]
    v_mfma_f32_16x16x32_bf16 v[204:207], a[64:67], a[240:243], v[204:207]
    v_mfma_f32_16x16x32_bf16 v[200:203], a[56:59], a[236:239], v[200:203]
    v_mfma_f32_16x16x32_bf16 v[200:203], a[68:71], a[240:243], v[200:203]
    v_mfma_f32_16x16x32_bf16 v[220:223], a[236:239], a[120:123], v[220:223]
    v_mfma_f32_16x16x32_bf16 v[220:223], a[240:243], a[132:135], v[220:223]
    v_mfma_f32_16x16x32_bf16 v[216:219], a[236:239], a[124:127], v[216:219]
    v_mfma_f32_16x16x32_bf16 v[216:219], a[240:243], a[136:139], v[216:219]
    v_cvt_pk_bf16_f32 v6, v208, v209
    v_cvt_pk_bf16_f32 v7, v210, v211
    v_mfma_f32_16x16x32_bf16 v[212:215], a[236:239], a[128:131], v[212:215]
    v_cvt_pk_bf16_f32 v8, v204, v205
    v_cvt_pk_bf16_f32 v9, v206, v207
    v_mfma_f32_16x16x32_bf16 v[212:215], a[240:243], a[140:143], v[212:215]
    v_cvt_pk_bf16_f32 v10, v200, v201
    v_cvt_pk_bf16_f32 v11, v202, v203
    v_mfma_f32_16x16x32_bf16 v[160:163], v[6:9], v[132:135], v[160:163]
    v_cvt_pk_bf16_f32 v72, v220, v221
    v_cvt_pk_bf16_f32 v73, v222, v223
    v_mfma_f32_16x16x32_bf16 v[208:211], a[0:3], a[244:247], 0
    v_cvt_pk_bf16_f32 v94, v216, v217
    v_cvt_pk_bf16_f32 v95, v218, v219
    v_mfma_f32_16x16x32_bf16 v[208:211], a[12:15], a[248:251], v[208:211]
    v_cvt_pk_bf16_f32 v116, v212, v213
    v_cvt_pk_bf16_f32 v117, v214, v215
    v_mfma_f32_16x16x16_bf16 v[160:163], v[10:11], v[136:137], v[160:163]
    ds_read_b128 a[236:239], v224 offset:18816
    ds_read_b128 a[240:243], v224 offset:18880
    v_mfma_f32_16x16x32_bf16 v[204:207], a[4:7], a[244:247], 0
    v_mfma_f32_16x16x32_bf16 v[204:207], a[16:19], a[248:251], v[204:207]
    v_mfma_f32_16x16x32_bf16 v[200:203], a[8:11], a[244:247], 0
    v_mfma_f32_16x16x32_bf16 v[200:203], a[20:23], a[248:251], v[200:203]
    v_mfma_f32_16x16x32_bf16 v[220:223], a[244:247], a[72:75], 0
    v_mfma_f32_16x16x32_bf16 v[220:223], a[248:251], a[84:87], v[220:223]
    v_mfma_f32_16x16x32_bf16 v[216:219], a[244:247], a[76:79], 0
    v_mfma_f32_16x16x32_bf16 v[216:219], a[248:251], a[88:91], v[216:219]
    v_mfma_f32_16x16x32_bf16 v[212:215], a[244:247], a[80:83], 0
    ds_read_b128 a[244:247], v226 offset:4224
    v_mfma_f32_16x16x32_bf16 v[212:215], a[248:251], a[92:95], v[212:215]
    s_waitcnt lgkmcnt(2)
    ds_read_b128 a[248:251], v226 offset:4288
    v_mfma_f32_16x16x32_bf16 v[208:211], a[24:27], a[252:255], v[208:211]
    v_mfma_f32_16x16x32_bf16 v[208:211], a[36:39], v[252:255], v[208:211]
    v_mfma_f32_16x16x32_bf16 v[204:207], a[28:31], a[252:255], v[204:207]
    v_mfma_f32_16x16x32_bf16 v[204:207], a[40:43], v[252:255], v[204:207]
    v_mfma_f32_16x16x32_bf16 v[200:203], a[32:35], a[252:255], v[200:203]
    v_mfma_f32_16x16x32_bf16 v[200:203], a[44:47], v[252:255], v[200:203]
    v_mfma_f32_16x16x32_bf16 v[220:223], a[252:255], a[96:99], v[220:223]
    v_mfma_f32_16x16x32_bf16 v[220:223], v[252:255], a[108:111], v[220:223]
    v_mfma_f32_16x16x32_bf16 v[216:219], a[252:255], a[100:103], v[216:219]
    v_mfma_f32_16x16x32_bf16 v[216:219], v[252:255], a[112:115], v[216:219]
    v_mfma_f32_16x16x32_bf16 v[212:215], a[252:255], a[104:107], v[212:215]
    ds_read_b128 a[252:255], v226 offset:4352
    v_mfma_f32_16x16x32_bf16 v[212:215], v[252:255], a[116:119], v[212:215]
    ds_read_b128 v[252:255], v226 offset:4416
    v_mfma_f32_16x16x32_bf16 v[208:211], a[48:51], a[236:239], v[208:211]
    s_waitcnt lgkmcnt(2)
    v_mfma_f32_16x16x32_bf16 v[208:211], a[60:63], a[240:243], v[208:211]
    v_mfma_f32_16x16x32_bf16 v[204:207], a[52:55], a[236:239], v[204:207]
    v_mfma_f32_16x16x32_bf16 v[204:207], a[64:67], a[240:243], v[204:207]
    v_mfma_f32_16x16x32_bf16 v[200:203], a[56:59], a[236:239], v[200:203]
    v_mfma_f32_16x16x32_bf16 v[200:203], a[68:71], a[240:243], v[200:203]
    v_mfma_f32_16x16x32_bf16 v[220:223], a[236:239], a[120:123], v[220:223]
    v_mfma_f32_16x16x32_bf16 v[220:223], a[240:243], a[132:135], v[220:223]
    v_mfma_f32_16x16x32_bf16 v[216:219], a[236:239], a[124:127], v[216:219]
    v_mfma_f32_16x16x32_bf16 v[216:219], a[240:243], a[136:139], v[216:219]
    v_cvt_pk_bf16_f32 v30, v208, v209
    v_cvt_pk_bf16_f32 v31, v210, v211
    v_mfma_f32_16x16x32_bf16 v[212:215], a[236:239], a[128:131], v[212:215]
    v_cvt_pk_bf16_f32 v32, v204, v205
    v_cvt_pk_bf16_f32 v33, v206, v207
    v_mfma_f32_16x16x32_bf16 v[212:215], a[240:243], a[140:143], v[212:215]
    v_cvt_pk_bf16_f32 v34, v200, v201
    v_cvt_pk_bf16_f32 v35, v202, v203
    v_mfma_f32_16x16x32_bf16 v[156:159], v[30:33], v[132:135], v[156:159]
    v_cvt_pk_bf16_f32 v70, v220, v221
    v_cvt_pk_bf16_f32 v71, v222, v223
    v_mfma_f32_16x16x32_bf16 v[208:211], a[144:147], a[244:247], 0
    v_cvt_pk_bf16_f32 v92, v216, v217
    v_cvt_pk_bf16_f32 v93, v218, v219
    v_mfma_f32_16x16x32_bf16 v[208:211], a[156:159], a[248:251], v[208:211]
    v_cvt_pk_bf16_f32 v114, v212, v213
    v_cvt_pk_bf16_f32 v115, v214, v215
    v_mfma_f32_16x16x16_bf16 v[156:159], v[34:35], v[136:137], v[156:159]
    ds_read_b128 a[236:239], v226 offset:4480
    ds_read_b128 a[240:243], v226 offset:4544
    v_mfma_f32_16x16x32_bf16 v[204:207], a[148:151], a[244:247], 0
    v_mfma_f32_16x16x32_bf16 v[204:207], a[160:163], a[248:251], v[204:207]
    v_mfma_f32_16x16x32_bf16 v[200:203], a[152:155], a[244:247], 0
    ds_read_b128 a[244:247], v225 offset:8896
    v_mfma_f32_16x16x32_bf16 v[200:203], a[164:167], a[248:251], v[200:203]
    s_waitcnt lgkmcnt(3)
    ds_read_b128 a[248:251], v225 offset:8960
    v_max3_f32 v249, v249, v156, v157
    v_mfma_f32_16x16x32_bf16 v[208:211], a[168:171], a[252:255], v[208:211]
    v_max3_f32 v248, v248, v158, v159
    v_max3_f32 v249, v249, v160, v161
    v_mfma_f32_16x16x32_bf16 v[208:211], a[180:183], v[252:255], v[208:211]
    v_max3_f32 v248, v248, v162, v163
    v_max_f32 v248, v248, v249
    v_mfma_f32_16x16x32_bf16 v[204:207], a[172:175], a[252:255], v[204:207]
    v_mov_b32 v249, v248
    v_mfma_f32_16x16x32_bf16 v[204:207], a[184:187], v[252:255], v[204:207]
    v_mfma_f32_16x16x32_bf16 v[200:203], a[176:179], a[252:255], v[200:203]
    s_waitcnt vmcnt(3) lgkmcnt(2)
    ds_read_b128 a[252:255], v225 offset:9024
    s_barrier
    v_mfma_f32_16x16x32_bf16 v[200:203], a[188:191], v[252:255], v[200:203]
    ds_read_b128 v[252:255], v225 offset:9088
    v_mfma_f32_16x16x32_bf16 v[208:211], a[192:195], a[236:239], v[208:211]
    buffer_load_dwordx4 v246, s[4:7], s56 offen lds
    v_mfma_f32_16x16x32_bf16 v[208:211], a[204:207], a[240:243], v[208:211]
    v_permlane16_swap_b32 v248, v249
    v_mfma_f32_16x16x32_bf16 v[204:207], a[196:199], a[236:239], v[204:207]
    v_max_f32 v248, v248, v249
    v_mov_b32 v249, v248
    v_mfma_f32_16x16x32_bf16 v[204:207], a[208:211], a[240:243], v[204:207]
    v_mfma_f32_16x16x32_bf16 v[200:203], a[200:203], a[236:239], v[200:203]
    ds_read_b128 a[236:239], v225 offset:9152
    v_mfma_f32_16x16x32_bf16 v[200:203], a[212:215], a[240:243], v[200:203]
    s_waitcnt lgkmcnt(3)
    v_cvt_pk_bf16_f32 v138, v208, v209
    v_cvt_pk_bf16_f32 v139, v210, v211
    v_mfma_f32_16x16x32_bf16 v[220:223], a[144:147], a[244:247], 0
    ds_read_b128 a[240:243], v225 offset:9216
    v_mfma_f32_16x16x32_bf16 v[220:223], a[156:159], a[248:251], v[220:223]
    v_cvt_pk_bf16_f32 v140, v204, v205
    v_cvt_pk_bf16_f32 v141, v206, v207
    v_mfma_f32_16x16x32_bf16 v[216:219], a[148:151], a[244:247], 0
    v_cvt_pk_bf16_f32 v142, v200, v201
    v_cvt_pk_bf16_f32 v143, v202, v203
    v_mfma_f32_16x16x32_bf16 v[216:219], a[160:163], a[248:251], v[216:219]
    buffer_load_dwordx4 v247, s[4:7], s56 offen offset:1024 lds
    v_mfma_f32_16x16x32_bf16 v[212:215], a[152:155], a[244:247], 0
    s_add_u32 s56, s56, s42
    ds_read_b128 a[244:247], v239 offset:12288
    s_add_u32 m0, s41, 0xd3c0
    v_mfma_f32_16x16x32_bf16 v[212:215], a[164:167], a[248:251], v[212:215]
    s_waitcnt lgkmcnt(3)
    ds_read_b128 a[248:251], v240 offset:12288
    v_mfma_f32_16x16x32_bf16 v[220:223], a[168:171], a[252:255], v[220:223]
    v_permlane32_swap_b32 v248, v249
    v_mfma_f32_16x16x32_bf16 v[220:223], a[180:183], v[252:255], v[220:223]
    v_max_f32 v248, v248, v249
    v_mul_f32 v236, s37, v248
    v_mfma_f32_16x16x32_bf16 v[216:219], a[172:175], a[252:255], v[216:219]
    v_fma_f32 v164, v164, s37, -v236
    v_fma_f32 v165, v165, s37, -v236
    v_mfma_f32_16x16x32_bf16 v[216:219], a[184:187], v[252:255], v[216:219]
    v_fma_f32 v166, v166, s37, -v236
    v_fma_f32 v167, v167, s37, -v236
    v_mfma_f32_16x16x32_bf16 v[212:215], a[176:179], a[252:255], v[212:215]
    ds_read_b128 a[252:255], v239 offset:13312
    v_fma_f32 v168, v168, s37, -v236
    v_mfma_f32_16x16x32_bf16 v[212:215], a[188:191], v[252:255], v[212:215]
    s_waitcnt lgkmcnt(3)
    buffer_load_dwordx4 v246, s[4:7], s56 offen lds
    v_mfma_f32_16x16x32_bf16 v[220:223], a[192:195], a[236:239], v[220:223]
    ds_read_b128 v[252:255], v240 offset:13312
    v_fma_f32 v169, v169, s37, -v236
    v_mfma_f32_16x16x32_bf16 v[220:223], a[204:207], a[240:243], v[220:223]
    v_exp_f32 v164, v164
    v_mfma_f32_16x16x32_bf16 v[216:219], a[196:199], a[236:239], v[216:219]
    v_exp_f32 v165, v165
    v_mfma_f32_16x16x32_bf16 v[216:219], a[208:211], a[240:243], v[216:219]
    v_exp_f32 v166, v166
    v_mfma_f32_16x16x32_bf16 v[212:215], a[200:203], a[236:239], v[212:215]
    ds_read_b128 a[236:239], v241 offset:12288
    v_cvt_pk_bf16_f32 v180, v164, v165
    v_mfma_f32_16x16x32_bf16 v[212:215], a[212:215], a[240:243], v[212:215]
    s_waitcnt lgkmcnt(3)
    v_cvt_pk_bf16_f32 v132, v220, v221
    v_cvt_pk_bf16_f32 v133, v222, v223
    v_mfma_f32_16x16x32_bf16 v[208:211], a[220:223], a[244:247], 0
    v_cvt_pk_bf16_f32 v134, v216, v217
    v_cvt_pk_bf16_f32 v135, v218, v219
    v_mfma_f32_16x16x32_bf16 v[200:203], a[220:223], a[248:251], 0
    buffer_load_dwordx4 v247, s[4:7], s56 offen offset:1024 lds
    v_mfma_f32_16x16x32_bf16 v[204:207], a[224:227], a[244:247], 0
    s_add_u32 s56, s56, s42
    v_cvt_pk_bf16_f32 v136, v212, v213
    v_cvt_pk_bf16_f32 v137, v214, v215
    v_mfma_f32_16x16x32_bf16 v[220:223], a[224:227], a[248:251], 0
    s_add_u32 m0, s41, 0
    ds_read_b128 a[240:243], v241 offset:12800
    ds_read_b128 a[248:251], v242 offset:12800
    v_mfma_f32_16x16x32_bf16 v[216:219], a[228:231], a[244:247], 0
    v_exp_f32 v167, v167
    v_mfma_f32_16x16x32_bf16 v[212:215], a[232:235], a[244:247], 0
    s_waitcnt lgkmcnt(2)
    ds_read_b128 a[244:247], v242 offset:12288
    v_cvt_pk_bf16_f32 v181, v166, v167
    ds_read_b128 v[164:167], v230 offset:640
    v_mfma_f32_16x16x32_bf16 v[208:211], a[236:239], a[252:255], v[208:211]
    v_fma_f32 v170, v170, s37, -v236
    v_fma_f32 v171, v171, s37, -v236
    v_mfma_f32_16x16x32_bf16 v[200:203], a[236:239], v[252:255], v[200:203]
    s_waitcnt lgkmcnt(3)
    ds_read_b128 a[236:239], v241 offset:24576
    v_exp_f32 v168, v168
    v_exp_f32 v169, v169
    v_exp_f32 v170, v170
    v_exp_f32 v171, v171
    v_cvt_pk_bf16_f32 v182, v168, v169
    v_cvt_pk_bf16_f32 v183, v170, v171
    ds_read_b128 v[168:171], v230 offset:1280
    v_mfma_f32_16x16x32_bf16 v[204:207], a[240:243], a[252:255], v[204:207]
    v_fma_f32 v172, v172, s37, -v236
    v_fma_f32 v173, v173, s37, -v236
    v_mfma_f32_16x16x32_bf16 v[196:199], a[216:219], v[180:183], 0
    v_fma_f32 v174, v174, s37, -v236
    v_fma_f32 v175, v175, s37, -v236
    v_mfma_f32_16x16x32_bf16 v[184:187], v[74:77], v[180:183], 0
    v_exp_f32 v172, v172
    v_mfma_f32_16x16x32_bf16 v[188:191], v[96:99], v[180:183], 0
    v_exp_f32 v173, v173
    v_mfma_f32_16x16x32_bf16 v[192:195], v[118:121], v[180:183], 0
    s_waitcnt lgkmcnt(2)
    v_exp_f32 v174, v174
    v_mfma_f32_16x16x32_bf16 v[164:167], v[36:39], v[138:141], v[164:167]
    v_exp_f32 v175, v175
    v_mfma_f32_16x16x32_bf16 v[220:223], a[240:243], v[252:255], v[220:223]
    ds_read_b128 v[252:255], v240 offset:14336
    ds_read_b128 a[240:243], v241 offset:25088
    v_mfma_f32_16x16x32_bf16 v[216:219], a[244:247], a[252:255], v[216:219]
    ds_read_b128 a[244:247], v242 offset:24576
    v_cvt_pk_bf16_f32 v176, v172, v173
    v_mfma_f32_16x16x16_bf16 v[164:167], v[40:41], v[142:143], v[164:167]
    s_waitcnt lgkmcnt(3)
    v_cvt_pk_bf16_f32 v177, v174, v175
    v_fma_f32 v144, v144, s37, -v236
    v_mfma_f32_16x16x32_bf16 v[168:171], v[42:45], v[138:141], v[168:171]
    ds_read_b128 v[172:175], v230 offset:1920
    v_fma_f32 v145, v145, s37, -v236
    v_mfma_f32_16x16x32_bf16 v[212:215], a[248:251], a[252:255], v[212:215]
    ds_read_b128 a[252:255], v239 offset:14336
    v_fma_f32 v146, v146, s37, -v236
    ds_read_b128 a[248:251], v242 offset:25088
    v_mfma_f32_16x16x16_bf16 v[168:171], v[46:47], v[142:143], v[168:171]
    s_waitcnt lgkmcnt(5)
    v_fma_f32 v147, v147, s37, -v236
    v_exp_f32 v144, v144
    v_exp_f32 v145, v145
    v_exp_f32 v146, v146
    v_exp_f32 v147, v147
    v_mfma_f32_16x16x32_bf16 v[200:203], a[236:239], v[252:255], v[200:203]
    s_waitcnt lgkmcnt(4)
    v_cvt_pk_bf16_f32 v178, v144, v145
    v_cvt_pk_bf16_f32 v179, v146, v147
    v_mfma_f32_16x16x32_bf16 v[220:223], a[240:243], v[252:255], v[220:223]
    ds_read_b128 v[252:255], v240 offset:15360
    ds_read_b128 v[144:147], v230 offset:2560
    v_mfma_f32_16x16x32_bf16 v[196:199], a[216:219], v[176:179], v[196:199]
    v_fma_f32 v148, v148, s37, -v236
    v_fma_f32 v149, v149, s37, -v236
    v_mfma_f32_16x16x32_bf16 v[184:187], v[78:81], v[176:179], v[184:187]
    v_fma_f32 v150, v150, s37, -v236
    v_fma_f32 v151, v151, s37, -v236
    v_mfma_f32_16x16x32_bf16 v[188:191], v[100:103], v[176:179], v[188:191]
    v_exp_f32 v148, v148
    v_mfma_f32_16x16x32_bf16 v[192:195], v[122:125], v[176:179], v[192:195]
    s_waitcnt lgkmcnt(4)
    v_exp_f32 v149, v149
    v_mfma_f32_16x16x32_bf16 v[172:175], v[24:27], v[138:141], v[172:175]
    s_waitcnt lgkmcnt(3)
    v_exp_f32 v150, v150
    v_mfma_f32_16x16x32_bf16 v[208:211], a[236:239], a[252:255], v[208:211]
    ds_read_b128 a[236:239], v241 offset:36864
    v_cvt_pk_bf16_f32 v180, v148, v149
    v_mfma_f32_16x16x32_bf16 v[204:207], a[240:243], a[252:255], v[204:207]
    ds_read_b128 a[240:243], v241 offset:37376
    v_fma_f32 v152, v152, s37, -v236
    v_mfma_f32_16x16x16_bf16 v[172:175], v[28:29], v[142:143], v[172:175]
    v_exp_f32 v151, v151
    v_mfma_f32_16x16x32_bf16 v[216:219], a[244:247], a[252:255], v[216:219]
    s_waitcnt lgkmcnt(2)
    ds_read_b128 a[244:247], v242 offset:36864
    v_cvt_pk_bf16_f32 v181, v150, v151
    v_mfma_f32_16x16x32_bf16 v[144:147], v[30:33], v[138:141], v[144:147]
    ds_read_b128 v[148:151], v250
    v_bfe_u32 v250, s67, v233, 4
    v_mfma_f32_16x16x32_bf16 v[212:215], a[248:251], a[252:255], v[212:215]
    ds_read_b128 a[252:255], v239 offset:15360
    v_mad_u32_u24 v250, v250, s40, v231
    ds_read_b128 a[248:251], v242 offset:37376
    v_mfma_f32_16x16x16_bf16 v[144:147], v[34:35], v[142:143], v[144:147]
    s_waitcnt lgkmcnt(5)
    v_fma_f32 v153, v153, s37, -v236
    v_fma_f32 v154, v154, s37, -v236
    v_fma_f32 v155, v155, s37, -v236
    v_exp_f32 v152, v152
    v_mfma_f32_16x16x32_bf16 v[200:203], a[236:239], v[252:255], v[200:203]
    s_waitcnt lgkmcnt(4)
    v_exp_f32 v153, v153
    v_mfma_f32_16x16x32_bf16 v[220:223], a[240:243], v[252:255], v[220:223]
    ds_read_b128 v[252:255], v240 offset:16384
    v_exp_f32 v154, v154
    v_exp_f32 v155, v155
    v_cvt_pk_bf16_f32 v182, v152, v153
    v_cvt_pk_bf16_f32 v183, v154, v155
    ds_read_b128 v[152:155], v234
    v_bfe_u32 v234, s72, v233, 4
    v_mfma_f32_16x16x32_bf16 v[196:199], a[216:219], v[180:183], v[196:199]
    v_mad_u32_u24 v234, v234, s40, v231
    v_fma_f32 v156, v156, s37, -v236
    v_mfma_f32_16x16x32_bf16 v[184:187], v[66:69], v[180:183], v[184:187]
    v_fma_f32 v157, v157, s37, -v236
    v_fma_f32 v158, v158, s37, -v236
    v_mfma_f32_16x16x32_bf16 v[188:191], v[88:91], v[180:183], v[188:191]
    v_fma_f32 v159, v159, s37, -v236
    v_fma_f32 v160, v160, s37, -v236
    v_mfma_f32_16x16x32_bf16 v[192:195], v[110:113], v[180:183], v[192:195]
    s_waitcnt lgkmcnt(3)
    v_exp_f32 v156, v156
    v_mfma_f32_16x16x32_bf16 v[148:151], v[54:57], v[138:141], v[148:151]
    v_exp_f32 v157, v157
    v_mfma_f32_16x16x32_bf16 v[208:211], a[236:239], a[252:255], v[208:211]
    ds_read_b128 a[236:239], v241 offset:49152
    v_cvt_pk_bf16_f32 v176, v156, v157
    v_mfma_f32_16x16x32_bf16 v[204:207], a[240:243], a[252:255], v[204:207]
    ds_read_b128 a[240:243], v241 offset:49664
    v_fma_f32 v161, v161, s37, -v236
    v_mfma_f32_16x16x16_bf16 v[148:151], v[58:59], v[142:143], v[148:151]
    s_waitcnt lgkmcnt(2)
    v_exp_f32 v158, v158
    v_mfma_f32_16x16x32_bf16 v[152:155], v[60:63], v[138:141], v[152:155]
    v_exp_f32 v159, v159
    v_mfma_f32_16x16x32_bf16 v[216:219], a[244:247], a[252:255], v[216:219]
    ds_read_b128 a[244:247], v242 offset:49152
    v_cvt_pk_bf16_f32 v177, v158, v159
    v_mfma_f32_16x16x32_bf16 v[212:215], a[248:251], a[252:255], v[212:215]
    ds_read_b128 a[252:255], v239 offset:16384
    ds_read_b128 a[248:251], v242 offset:49664
    v_mfma_f32_16x16x16_bf16 v[152:155], v[64:65], v[142:143], v[152:155]
    s_waitcnt lgkmcnt(4)
    ds_read_b128 v[156:159], v229 offset:640
    v_fma_f32 v162, v162, s37, -v236
    v_fma_f32 v163, v163, s37, -v236
    v_exp_f32 v160, v160
    v_exp_f32 v161, v161
    v_exp_f32 v162, v162
    v_mfma_f32_16x16x32_bf16 v[200:203], a[236:239], v[252:255], v[200:203]
    s_waitcnt lgkmcnt(4)
    v_exp_f32 v163, v163
    v_mfma_f32_16x16x32_bf16 v[220:223], a[240:243], v[252:255], v[220:223]
    ds_read_b128 v[252:255], v240 offset:17408
    v_cvt_pk_bf16_f32 v178, v160, v161
    v_cvt_pk_bf16_f32 v179, v162, v163
    ds_read_b128 v[160:163], v228 offset:640
    v_max3_f32 v248, v164, v165, v166
    v_mfma_f32_16x16x32_bf16 v[196:199], a[216:219], v[176:179], v[196:199]
    v_max3_f32 v249, v167, v168, v169
    v_max3_f32 v248, v248, v170, v171
    v_mfma_f32_16x16x32_bf16 v[184:187], v[70:73], v[176:179], v[184:187]
    v_max3_f32 v249, v249, v172, v173
    v_max3_f32 v248, v248, v174, v175
    v_mfma_f32_16x16x32_bf16 v[188:191], v[92:95], v[176:179], v[188:191]
    v_max3_f32 v249, v249, v144, v145
    v_max3_f32 v248, v248, v146, v147
    v_mfma_f32_16x16x32_bf16 v[192:195], v[114:117], v[176:179], v[192:195]
    s_waitcnt lgkmcnt(2)
    v_rcp_f32 v197, v196
    v_mfma_f32_16x16x32_bf16 v[156:159], v[42:45], v[132:135], v[156:159]
    v_mul_f32 v184, v184, v197
    v_mul_f32 v185, v185, v197
    v_mfma_f32_16x16x32_bf16 v[208:211], a[236:239], a[252:255], v[208:211]
    ds_read_b128 a[236:239], v241 offset:61440
    v_cvt_pk_bf16_f32 v184, v184, v185
    v_mfma_f32_16x16x32_bf16 v[204:207], a[240:243], a[252:255], v[204:207]
    ds_read_b128 a[240:243], v241 offset:61952
    v_mul_f32 v186, v186, v197
    v_mfma_f32_16x16x16_bf16 v[156:159], v[46:47], v[136:137], v[156:159]
    s_waitcnt lgkmcnt(2)
    v_mul_f32 v187, v187, v197
    v_cvt_pk_bf16_f32 v185, v186, v187
    v_mfma_f32_16x16x32_bf16 v[160:163], v[18:21], v[132:135], v[160:163]
    v_mul_f32 v188, v188, v197
    v_mul_f32 v189, v189, v197
    v_mfma_f32_16x16x32_bf16 v[216:219], a[244:247], a[252:255], v[216:219]
    ds_read_b128 a[244:247], v242 offset:61440
    v_cvt_pk_bf16_f32 v186, v188, v189
    v_mfma_f32_16x16x32_bf16 v[212:215], a[248:251], a[252:255], v[212:215]
    ds_read_b128 a[252:255], v239 offset:17408
    ds_read_b128 a[248:251], v242 offset:61952
    v_mfma_f32_16x16x16_bf16 v[160:163], v[22:23], v[136:137], v[160:163]
    s_waitcnt lgkmcnt(4)
    v_mul_f32 v190, v190, v197
    v_mul_f32 v191, v191, v197
    v_cvt_pk_bf16_f32 v187, v190, v191
    v_mul_f32 v192, v192, v197
    v_mul_f32 v193, v193, v197
    v_cvt_pk_bf16_f32 v188, v192, v193
    v_mul_f32 v194, v194, v197
    v_mul_f32 v195, v195, v197
    v_mfma_f32_16x16x32_bf16 v[200:203], a[236:239], v[252:255], v[200:203]
    s_waitcnt lgkmcnt(3)
    v_cvt_pk_bf16_f32 v189, v194, v195
    v_max3_f32 v249, v249, v148, v149
    v_mfma_f32_16x16x32_bf16 v[220:223], a[240:243], v[252:255], v[220:223]
    s_waitcnt lgkmcnt(1)
    ds_read_b128 v[252:255], v224 offset:31040
    ds_write_b128 v237, v[184:187]
    ds_write_b64 v238, v[188:189]
    v_max3_f32 v248, v248, v150, v151
    v_max3_f32 v249, v249, v152, v153
    v_cvt_pk_bf16_f32 v200, v200, v201
    v_cvt_pk_bf16_f32 v201, v202, v203
    v_max3_f32 v248, v248, v154, v155
    v_mfma_f32_16x16x32_bf16 v[208:211], a[236:239], a[252:255], v[208:211]
    v_cvt_pk_bf16_f32 v202, v220, v221
    v_cvt_pk_bf16_f32 v203, v222, v223
    v_mfma_f32_16x16x32_bf16 v[204:207], a[240:243], a[252:255], v[204:207]
    buffer_store_dwordx4 v[200:203], v245, s[20:23], s51 offen sc0 sc1
    v_mfma_f32_16x16x32_bf16 v[216:219], a[244:247], a[252:255], v[216:219]
    s_waitcnt lgkmcnt(3)
    ds_read_b128 a[236:239], v224 offset:31104
    ds_read_b128 a[240:243], v224 offset:31168
    v_mfma_f32_16x16x32_bf16 v[212:215], a[248:251], a[252:255], v[212:215]
    ds_read_b128 a[252:255], v224 offset:30976
    v_cvt_pk_bf16_f32 v208, v208, v209
    v_cvt_pk_bf16_f32 v209, v210, v211
    v_cvt_pk_bf16_f32 v210, v204, v205
    ds_read_b128 a[244:247], v224 offset:31232
    v_cvt_pk_bf16_f32 v211, v206, v207
    ds_read_b128 a[248:251], v224 offset:31296
    v_cvt_pk_bf16_f32 v216, v216, v217
    v_cvt_pk_bf16_f32 v217, v218, v219
    v_cvt_pk_bf16_f32 v218, v212, v213
    v_cvt_pk_bf16_f32 v219, v214, v215
    v_max_f32 v248, v248, v249
    v_mov_b32 v249, v248
    s_nop 1
    v_permlane16_swap_b32 v248, v249
    v_max_f32 v248, v248, v249
    v_mov_b32 v249, v248
    s_nop 1
    v_permlane32_swap_b32 v248, v249
    v_max_f32 v248, v248, v249
    v_mul_f32 v236, s37, v248
    v_fma_f32 v164, v164, s37, -v236
    v_fma_f32 v165, v165, s37, -v236
    v_fma_f32 v166, v166, s37, -v236
    v_fma_f32 v167, v167, s37, -v236
    v_exp_f32 v164, v164
    v_exp_f32 v165, v165
    s_waitcnt lgkmcnt(2)
    v_mfma_f32_16x16x32_bf16 v[204:207], a[4:7], a[252:255], 0
    buffer_store_dwordx4 v[208:211], v243, s[20:23], s51 offen sc0 sc1
    v_mfma_f32_16x16x32_bf16 v[204:207], a[16:19], v[252:255], v[204:207]
    v_exp_f32 v166, v166
    v_mfma_f32_16x16x32_bf16 v[208:211], a[0:3], a[252:255], 0
    v_exp_f32 v167, v167
    v_mfma_f32_16x16x32_bf16 v[208:211], a[12:15], v[252:255], v[208:211]
    v_cvt_pk_bf16_f32 v180, v164, v165
    v_cvt_pk_bf16_f32 v181, v166, v167
    v_mfma_f32_16x16x32_bf16 v[200:203], a[8:11], a[252:255], 0
    ds_read_b128 v[164:167], v228 offset:1280
    v_fma_f32 v168, v168, s37, -v236
    v_mfma_f32_16x16x32_bf16 v[200:203], a[20:23], v[252:255], v[200:203]
    v_fma_f32 v169, v169, s37, -v236
    v_fma_f32 v170, v170, s37, -v236
    v_mfma_f32_16x16x32_bf16 v[220:223], a[252:255], a[72:75], 0
    v_fma_f32 v171, v171, s37, -v236
    v_fma_f32 v172, v172, s37, -v236
    v_mfma_f32_16x16x32_bf16 v[220:223], v[252:255], a[84:87], v[220:223]
    v_exp_f32 v168, v168
    v_mfma_f32_16x16x32_bf16 v[212:215], a[252:255], a[80:83], 0
    v_exp_f32 v169, v169
    v_mfma_f32_16x16x32_bf16 v[212:215], v[252:255], a[92:95], v[212:215]
    v_exp_f32 v170, v170
    v_mfma_f32_16x16x32_bf16 v[208:211], a[24:27], a[236:239], v[208:211]
    v_exp_f32 v171, v171
    v_mfma_f32_16x16x32_bf16 v[208:211], a[36:39], a[240:243], v[208:211]
    v_cvt_pk_bf16_f32 v182, v168, v169
    v_cvt_pk_bf16_f32 v183, v170, v171
    v_mfma_f32_16x16x32_bf16 v[204:207], a[28:31], a[236:239], v[204:207]
    buffer_store_dwordx4 v[216:219], v244, s[20:23], s51 offen sc0 sc1
    v_mfma_f32_16x16x32_bf16 v[204:207], a[40:43], a[240:243], v[204:207]
    s_add_u32 s51, s51, s48
    ds_read_b128 v[168:171], v229 offset:1280
    v_fma_f32 v173, v173, s37, -v236
    v_mfma_f32_16x16x32_bf16 v[196:199], a[216:219], v[180:183], 0
    v_fma_f32 v174, v174, s37, -v236
    v_fma_f32 v175, v175, s37, -v236
    v_mfma_f32_16x16x32_bf16 v[184:187], v[76:79], v[180:183], 0
    v_exp_f32 v172, v172
    v_mfma_f32_16x16x32_bf16 v[188:191], v[98:101], v[180:183], 0
    v_exp_f32 v173, v173
    v_mfma_f32_16x16x32_bf16 v[192:195], v[120:123], v[180:183], 0
    s_waitcnt lgkmcnt(1)
    v_exp_f32 v174, v174
    v_mfma_f32_16x16x32_bf16 v[164:167], v[0:3], v[132:135], v[164:167]
    v_exp_f32 v175, v175
    v_mfma_f32_16x16x32_bf16 v[216:219], a[252:255], a[76:79], 0
    ds_read_b128 a[252:255], v224 offset:34048
    v_cvt_pk_bf16_f32 v176, v172, v173
    v_mfma_f32_16x16x32_bf16 v[216:219], v[252:255], a[88:91], v[216:219]
    ds_read_b128 v[252:255], v224 offset:34112
    v_cvt_pk_bf16_f32 v177, v174, v175
    v_mfma_f32_16x16x16_bf16 v[164:167], v[4:5], v[136:137], v[164:167]
    s_waitcnt lgkmcnt(2)
    ds_read_b128 v[172:175], v229 offset:1920
    v_fma_f32 v144, v144, s37, -v236
    v_mfma_f32_16x16x32_bf16 v[168:171], v[24:27], v[132:135], v[168:171]
    v_fma_f32 v145, v145, s37, -v236
    v_fma_f32 v146, v146, s37, -v236
    v_mfma_f32_16x16x32_bf16 v[200:203], a[32:35], a[236:239], v[200:203]
    v_fma_f32 v147, v147, s37, -v236
    v_fma_f32 v148, v148, s37, -v236
    v_mfma_f32_16x16x32_bf16 v[200:203], a[44:47], a[240:243], v[200:203]
    v_exp_f32 v144, v144
    v_mfma_f32_16x16x16_bf16 v[168:171], v[28:29], v[136:137], v[168:171]
    v_exp_f32 v145, v145
    v_mfma_f32_16x16x32_bf16 v[220:223], a[236:239], a[96:99], v[220:223]
    v_exp_f32 v146, v146
    v_mfma_f32_16x16x32_bf16 v[220:223], a[240:243], a[108:111], v[220:223]
    v_exp_f32 v147, v147
    v_mfma_f32_16x16x32_bf16 v[216:219], a[236:239], a[100:103], v[216:219]
    v_cvt_pk_bf16_f32 v178, v144, v145
    v_cvt_pk_bf16_f32 v179, v146, v147
    v_mfma_f32_16x16x32_bf16 v[216:219], a[240:243], a[112:115], v[216:219]
    ds_read_b128 v[144:147], v228 offset:1920
    v_fma_f32 v149, v149, s37, -v236
    v_mfma_f32_16x16x32_bf16 v[196:199], a[216:219], v[176:179], v[196:199]
    v_fma_f32 v150, v150, s37, -v236
    v_fma_f32 v151, v151, s37, -v236
    v_mfma_f32_16x16x32_bf16 v[184:187], v[68:71], v[176:179], v[184:187]
    v_exp_f32 v148, v148
    v_mfma_f32_16x16x32_bf16 v[188:191], v[90:93], v[176:179], v[188:191]
    v_exp_f32 v149, v149
    v_mfma_f32_16x16x32_bf16 v[192:195], v[112:115], v[176:179], v[192:195]
    s_waitcnt lgkmcnt(1)
    v_exp_f32 v150, v150
    v_mfma_f32_16x16x32_bf16 v[172:175], v[30:33], v[132:135], v[172:175]
    v_exp_f32 v151, v151
    v_mfma_f32_16x16x32_bf16 v[212:215], a[236:239], a[104:107], v[212:215]
    ds_read_b128 a[236:239], v224 offset:34176
    v_cvt_pk_bf16_f32 v180, v148, v149
    v_mfma_f32_16x16x32_bf16 v[212:215], a[240:243], a[116:119], v[212:215]
    ds_read_b128 a[240:243], v224 offset:34240
    v_cvt_pk_bf16_f32 v181, v150, v151
    v_mfma_f32_16x16x16_bf16 v[172:175], v[34:35], v[136:137], v[172:175]
    s_waitcnt lgkmcnt(2)
    ds_read_b128 v[148:151], v228 offset:2560
    v_fma_f32 v152, v152, s37, -v236
    v_mfma_f32_16x16x32_bf16 v[144:147], v[6:9], v[132:135], v[144:147]
    v_fma_f32 v153, v153, s37, -v236
    v_fma_f32 v154, v154, s37, -v236
    v_mfma_f32_16x16x32_bf16 v[208:211], a[48:51], a[244:247], v[208:211]
    v_fma_f32 v155, v155, s37, -v236
    v_max3_f32 v248, v156, v157, v158
    v_mfma_f32_16x16x32_bf16 v[208:211], a[60:63], a[248:251], v[208:211]
    v_exp_f32 v152, v152
    v_mfma_f32_16x16x16_bf16 v[144:147], v[10:11], v[136:137], v[144:147]
    v_exp_f32 v153, v153
    v_mfma_f32_16x16x32_bf16 v[204:207], a[52:55], a[244:247], v[204:207]
    v_exp_f32 v154, v154
    v_mfma_f32_16x16x32_bf16 v[204:207], a[64:67], a[248:251], v[204:207]
    v_exp_f32 v155, v155
    v_mfma_f32_16x16x32_bf16 v[200:203], a[56:59], a[244:247], v[200:203]
    v_cvt_pk_bf16_f32 v12, v208, v209
    v_cvt_pk_bf16_f32 v13, v210, v211
    v_mfma_f32_16x16x32_bf16 v[200:203], a[68:71], a[248:251], v[200:203]
    v_cvt_pk_bf16_f32 v182, v152, v153
    v_cvt_pk_bf16_f32 v183, v154, v155
    v_mfma_f32_16x16x32_bf16 v[220:223], a[244:247], a[120:123], v[220:223]
    v_cvt_pk_bf16_f32 v14, v204, v205
    v_cvt_pk_bf16_f32 v15, v206, v207
    v_mfma_f32_16x16x32_bf16 v[220:223], a[248:251], a[132:135], v[220:223]
    ds_read_b128 v[152:155], v229 offset:2560
    v_max3_f32 v249, v159, v160, v161
    v_mfma_f32_16x16x32_bf16 v[196:199], a[216:219], v[180:183], v[196:199]
    v_cvt_pk_bf16_f32 v16, v200, v201
    v_cvt_pk_bf16_f32 v17, v202, v203
    v_mfma_f32_16x16x32_bf16 v[184:187], v[84:87], v[180:183], v[184:187]
    v_max3_f32 v248, v248, v162, v163
    v_max3_f32 v249, v249, v164, v165
    v_mfma_f32_16x16x32_bf16 v[188:191], v[106:109], v[180:183], v[188:191]
    v_cvt_pk_bf16_f32 v74, v220, v221
    v_cvt_pk_bf16_f32 v75, v222, v223
    v_mfma_f32_16x16x32_bf16 v[192:195], v[128:131], v[180:183], v[192:195]
    s_waitcnt lgkmcnt(1)
    v_rcp_f32 v197, v196
    v_mfma_f32_16x16x32_bf16 v[148:151], v[12:15], v[132:135], v[148:151]
    v_mul_f32 v184, v184, v197
    v_mul_f32 v185, v185, v197
    v_mfma_f32_16x16x32_bf16 v[216:219], a[244:247], a[124:127], v[216:219]
    v_cvt_pk_bf16_f32 v184, v184, v185
    v_mul_f32 v186, v186, v197
    v_mfma_f32_16x16x32_bf16 v[216:219], a[248:251], a[136:139], v[216:219]
    v_mul_f32 v187, v187, v197
    v_cvt_pk_bf16_f32 v185, v186, v187
    v_mfma_f32_16x16x16_bf16 v[148:151], v[16:17], v[136:137], v[148:151]
    v_mul_f32 v188, v188, v197
    v_mul_f32 v189, v189, v197
    v_mfma_f32_16x16x32_bf16 v[212:215], a[244:247], a[128:131], v[212:215]
    ds_read_b128 a[244:247], v224 offset:34304
    v_cvt_pk_bf16_f32 v186, v188, v189
    v_mfma_f32_16x16x32_bf16 v[212:215], a[248:251], a[140:143], v[212:215]
    v_cvt_pk_bf16_f32 v96, v216, v217
    v_cvt_pk_bf16_f32 v97, v218, v219
    v_mfma_f32_16x16x32_bf16 v[208:211], a[0:3], a[252:255], 0
    ds_read_b128 a[248:251], v224 offset:34368
    v_mul_f32 v190, v190, v197
    v_mfma_f32_16x16x32_bf16 v[208:211], a[12:15], v[252:255], v[208:211]
    v_mul_f32 v191, v191, v197
    v_cvt_pk_bf16_f32 v187, v190, v191
    v_mfma_f32_16x16x32_bf16 v[204:207], a[4:7], a[252:255], 0
    v_cvt_pk_bf16_f32 v118, v212, v213
    v_cvt_pk_bf16_f32 v119, v214, v215
    v_mfma_f32_16x16x32_bf16 v[204:207], a[16:19], v[252:255], v[204:207]
    v_mul_f32 v192, v192, v197
    v_mul_f32 v193, v193, v197
    v_mfma_f32_16x16x32_bf16 v[200:203], a[8:11], a[252:255], 0
    v_cvt_pk_bf16_f32 v188, v192, v193
    v_mul_f32 v194, v194, v197
    v_mfma_f32_16x16x32_bf16 v[200:203], a[20:23], v[252:255], v[200:203]
    v_mul_f32 v195, v195, v197
    v_cvt_pk_bf16_f32 v189, v194, v195
    v_mfma_f32_16x16x32_bf16 v[220:223], a[252:255], a[72:75], 0
    ds_write_b128 v237, v[184:187] offset:6144
    v_mfma_f32_16x16x32_bf16 v[220:223], v[252:255], a[84:87], v[220:223]
    ds_write_b64 v238, v[188:189] offset:6144
    v_mfma_f32_16x16x32_bf16 v[216:219], a[252:255], a[76:79], 0
    v_max3_f32 v248, v248, v166, v167
    v_max3_f32 v249, v249, v168, v169
    v_mfma_f32_16x16x32_bf16 v[216:219], v[252:255], a[88:91], v[216:219]
    v_max3_f32 v248, v248, v170, v171
    v_max3_f32 v249, v249, v172, v173
    v_mfma_f32_16x16x32_bf16 v[212:215], a[252:255], a[80:83], 0
    v_max3_f32 v248, v248, v174, v175
    v_max3_f32 v249, v249, v144, v145
    v_mfma_f32_16x16x32_bf16 v[212:215], v[252:255], a[92:95], v[212:215]
    ds_read_b128 a[252:255], v225 offset:11968
    ds_read_b128 v[252:255], v225 offset:12032
    v_mfma_f32_16x16x32_bf16 v[208:211], a[24:27], a[236:239], v[208:211]
    v_max3_f32 v248, v248, v146, v147
    v_max3_f32 v249, v249, v148, v149
    v_mfma_f32_16x16x32_bf16 v[208:211], a[36:39], a[240:243], v[208:211]
    v_max3_f32 v248, v248, v150, v151
    v_mfma_f32_16x16x32_bf16 v[204:207], a[28:31], a[236:239], v[204:207]
    v_mfma_f32_16x16x32_bf16 v[204:207], a[40:43], a[240:243], v[204:207]
    v_mfma_f32_16x16x32_bf16 v[200:203], a[32:35], a[236:239], v[200:203]
    v_mfma_f32_16x16x32_bf16 v[200:203], a[44:47], a[240:243], v[200:203]
    v_mfma_f32_16x16x32_bf16 v[220:223], a[236:239], a[96:99], v[220:223]
    v_mfma_f32_16x16x32_bf16 v[220:223], a[240:243], a[108:111], v[220:223]
    v_mfma_f32_16x16x32_bf16 v[216:219], a[236:239], a[100:103], v[216:219]
    v_mfma_f32_16x16x32_bf16 v[216:219], a[240:243], a[112:115], v[216:219]
    v_mfma_f32_16x16x32_bf16 v[212:215], a[236:239], a[104:107], v[212:215]
    ds_read_b128 a[236:239], v225 offset:12096
    v_mfma_f32_16x16x32_bf16 v[212:215], a[240:243], a[116:119], v[212:215]
    s_waitcnt lgkmcnt(1)
    ds_read_b128 a[240:243], v225 offset:12160
    v_mfma_f32_16x16x32_bf16 v[208:211], a[48:51], a[244:247], v[208:211]
    v_mfma_f32_16x16x32_bf16 v[208:211], a[60:63], a[248:251], v[208:211]
    v_mfma_f32_16x16x32_bf16 v[204:207], a[52:55], a[244:247], v[204:207]
    v_mfma_f32_16x16x32_bf16 v[204:207], a[64:67], a[248:251], v[204:207]
    v_mfma_f32_16x16x32_bf16 v[200:203], a[56:59], a[244:247], v[200:203]
    v_mfma_f32_16x16x32_bf16 v[200:203], a[68:71], a[248:251], v[200:203]
    v_mfma_f32_16x16x32_bf16 v[220:223], a[244:247], a[120:123], v[220:223]
    v_mfma_f32_16x16x32_bf16 v[220:223], a[248:251], a[132:135], v[220:223]
    v_mfma_f32_16x16x32_bf16 v[216:219], a[244:247], a[124:127], v[216:219]
    v_mfma_f32_16x16x32_bf16 v[216:219], a[248:251], a[136:139], v[216:219]
    v_cvt_pk_bf16_f32 v36, v208, v209
    v_cvt_pk_bf16_f32 v37, v210, v211
    v_mfma_f32_16x16x32_bf16 v[212:215], a[244:247], a[128:131], v[212:215]
    v_cvt_pk_bf16_f32 v38, v204, v205
    v_cvt_pk_bf16_f32 v39, v206, v207
    v_mfma_f32_16x16x32_bf16 v[212:215], a[248:251], a[140:143], v[212:215]
    v_cvt_pk_bf16_f32 v40, v200, v201
    v_cvt_pk_bf16_f32 v41, v202, v203
    v_mfma_f32_16x16x32_bf16 v[152:155], v[36:39], v[132:135], v[152:155]
    v_cvt_pk_bf16_f32 v76, v220, v221
    v_cvt_pk_bf16_f32 v77, v222, v223
    v_mfma_f32_16x16x32_bf16 v[208:211], a[144:147], a[252:255], 0
    v_cvt_pk_bf16_f32 v98, v216, v217
    v_cvt_pk_bf16_f32 v99, v218, v219
    v_mfma_f32_16x16x32_bf16 v[208:211], a[156:159], v[252:255], v[208:211]
    v_cvt_pk_bf16_f32 v120, v212, v213
    v_cvt_pk_bf16_f32 v121, v214, v215
    v_mfma_f32_16x16x16_bf16 v[152:155], v[40:41], v[136:137], v[152:155]
    ds_read_b128 a[244:247], v225 offset:12224
    ds_read_b128 a[248:251], v225 offset:12288
    v_mfma_f32_16x16x32_bf16 v[204:207], a[148:151], a[252:255], 0
    v_mfma_f32_16x16x32_bf16 v[204:207], a[160:163], v[252:255], v[204:207]
    v_mfma_f32_16x16x32_bf16 v[200:203], a[152:155], a[252:255], 0
    ds_read_b128 a[252:255], v225 offset:24384
    v_mfma_f32_16x16x32_bf16 v[200:203], a[164:167], v[252:255], v[200:203]
    s_waitcnt lgkmcnt(3)
    ds_read_b128 v[252:255], v225 offset:24448
    v_max3_f32 v249, v249, v152, v153
    v_mfma_f32_16x16x32_bf16 v[208:211], a[168:171], a[236:239], v[208:211]
    v_max3_f32 v248, v248, v154, v155
    v_max_f32 v248, v248, v249
    v_mfma_f32_16x16x32_bf16 v[208:211], a[180:183], a[240:243], v[208:211]
    v_mov_b32 v249, v248
    v_mfma_f32_16x16x32_bf16 v[204:207], a[172:175], a[236:239], v[204:207]
    v_mfma_f32_16x16x32_bf16 v[204:207], a[184:187], a[240:243], v[204:207]
    v_permlane16_swap_b32 v248, v249
    v_mfma_f32_16x16x32_bf16 v[200:203], a[176:179], a[236:239], v[200:203]
    s_waitcnt vmcnt(3) lgkmcnt(2)
    ds_read_b128 a[236:239], v225 offset:24512
    v_max_f32 v248, v248, v249
    v_mfma_f32_16x16x32_bf16 v[200:203], a[188:191], a[240:243], v[200:203]
    s_barrier
    ds_read_b128 a[240:243], v225 offset:24576
    v_mov_b32 v249, v248
    v_mfma_f32_16x16x32_bf16 v[208:211], a[192:195], a[244:247], v[208:211]
    buffer_load_dwordx4 v246, s[4:7], s56 offen lds
    v_mfma_f32_16x16x32_bf16 v[208:211], a[204:207], a[248:251], v[208:211]
    v_permlane32_swap_b32 v248, v249
    v_mfma_f32_16x16x32_bf16 v[204:207], a[196:199], a[244:247], v[204:207]
    v_max_f32 v248, v248, v249
    v_mul_f32 v236, s37, v248
    v_mfma_f32_16x16x32_bf16 v[204:207], a[208:211], a[248:251], v[204:207]
    v_fma_f32 v156, v156, s37, -v236
    v_fma_f32 v157, v157, s37, -v236
    v_mfma_f32_16x16x32_bf16 v[200:203], a[200:203], a[244:247], v[200:203]
    v_cvt_pk_bf16_f32 v138, v208, v209
    v_cvt_pk_bf16_f32 v139, v210, v211
    v_mfma_f32_16x16x32_bf16 v[200:203], a[212:215], a[248:251], v[200:203]
    s_waitcnt lgkmcnt(2)
    ds_read_b128 a[244:247], v225 offset:24640
    ds_read_b128 a[248:251], v225 offset:24704
    v_mfma_f32_16x16x32_bf16 v[220:223], a[144:147], a[252:255], 0
    v_cvt_pk_bf16_f32 v140, v204, v205
    v_cvt_pk_bf16_f32 v141, v206, v207
    v_mfma_f32_16x16x32_bf16 v[220:223], a[156:159], v[252:255], v[220:223]
    v_fma_f32 v158, v158, s37, -v236
    v_fma_f32 v159, v159, s37, -v236
    v_mfma_f32_16x16x32_bf16 v[216:219], a[148:151], a[252:255], 0
    v_cvt_pk_bf16_f32 v142, v200, v201
    v_cvt_pk_bf16_f32 v143, v202, v203
    v_mfma_f32_16x16x32_bf16 v[216:219], a[160:163], v[252:255], v[216:219]
    buffer_load_dwordx4 v247, s[4:7], s56 offen offset:1024 lds
    v_mfma_f32_16x16x32_bf16 v[212:215], a[152:155], a[252:255], 0
    s_add_u32 s56, s56, s42
    ds_read_b128 a[252:255], v227 offset:37120
    v_fma_f32 v160, v160, s37, -v236
    v_mfma_f32_16x16x32_bf16 v[212:215], a[164:167], v[252:255], v[212:215]
    s_add_u32 m0, s41, 0x1e40
    ds_read_b128 v[252:255], v227 offset:37184
    v_fma_f32 v161, v161, s37, -v236
    s_waitcnt lgkmcnt(4)
    v_mfma_f32_16x16x32_bf16 v[220:223], a[168:171], a[236:239], v[220:223]
    v_exp_f32 v156, v156
    v_mfma_f32_16x16x32_bf16 v[220:223], a[180:183], a[240:243], v[220:223]
    v_exp_f32 v157, v157
    v_mfma_f32_16x16x32_bf16 v[216:219], a[172:175], a[236:239], v[216:219]
    v_exp_f32 v158, v158
    v_mfma_f32_16x16x32_bf16 v[216:219], a[184:187], a[240:243], v[216:219]
    v_exp_f32 v159, v159
    v_mfma_f32_16x16x32_bf16 v[212:215], a[176:179], a[236:239], v[212:215]
    ds_read_b128 a[236:239], v227 offset:37248
    v_cvt_pk_bf16_f32 v176, v156, v157
    v_mfma_f32_16x16x32_bf16 v[212:215], a[188:191], a[240:243], v[212:215]
    s_waitcnt lgkmcnt(3)
    ds_read_b128 a[240:243], v227 offset:37312
    v_cvt_pk_bf16_f32 v177, v158, v159
    v_mfma_f32_16x16x32_bf16 v[220:223], a[192:195], a[244:247], v[220:223]
    buffer_load_dwordx4 v246, s[4:7], s56 offen lds
    v_mfma_f32_16x16x32_bf16 v[220:223], a[204:207], a[248:251], v[220:223]
    ds_read_b128 v[156:159], v230 offset:2560
    v_fma_f32 v162, v162, s37, -v236
    v_mfma_f32_16x16x32_bf16 v[216:219], a[196:199], a[244:247], v[216:219]
    v_fma_f32 v163, v163, s37, -v236
    v_fma_f32 v164, v164, s37, -v236
    v_mfma_f32_16x16x32_bf16 v[216:219], a[208:211], a[248:251], v[216:219]
    v_exp_f32 v160, v160
    v_mfma_f32_16x16x32_bf16 v[212:215], a[200:203], a[244:247], v[212:215]
    v_cvt_pk_bf16_f32 v132, v220, v221
    v_cvt_pk_bf16_f32 v133, v222, v223
    v_mfma_f32_16x16x32_bf16 v[212:215], a[212:215], a[248:251], v[212:215]
    s_waitcnt lgkmcnt(3)
    ds_read_b128 a[244:247], v227 offset:37376
    ds_read_b128 a[248:251], v227 offset:37440
    v_mfma_f32_16x16x32_bf16 v[208:211], a[0:3], a[252:255], 0
    v_cvt_pk_bf16_f32 v134, v216, v217
    v_cvt_pk_bf16_f32 v135, v218, v219
    v_mfma_f32_16x16x32_bf16 v[208:211], a[12:15], v[252:255], v[208:211]
    v_exp_f32 v161, v161
    v_mfma_f32_16x16x32_bf16 v[204:207], a[4:7], a[252:255], 0
    v_cvt_pk_bf16_f32 v136, v212, v213
    v_cvt_pk_bf16_f32 v137, v214, v215
    v_mfma_f32_16x16x32_bf16 v[204:207], a[16:19], v[252:255], v[204:207]
    s_waitcnt lgkmcnt(2)
    buffer_load_dwordx4 v247, s[4:7], s56 offen offset:1024 lds
    v_mfma_f32_16x16x32_bf16 v[156:159], v[36:39], v[138:141], v[156:159]
    s_add_u32 s56, s56, s42
    v_exp_f32 v162, v162
    v_mfma_f32_16x16x32_bf16 v[200:203], a[8:11], a[252:255], 0
    s_add_u32 m0, s41, 0x3c80
    v_exp_f32 v163, v163
    v_mfma_f32_16x16x32_bf16 v[200:203], a[20:23], v[252:255], v[200:203]
    v_cvt_pk_bf16_f32 v178, v160, v161
    v_cvt_pk_bf16_f32 v179, v162, v163
    v_mfma_f32_16x16x16_bf16 v[156:159], v[40:41], v[142:143], v[156:159]
    ds_read_b128 v[160:163], v230 offset:640
    v_fma_f32 v165, v165, s37, -v236
    v_mfma_f32_16x16x32_bf16 v[196:199], a[216:219], v[176:179], 0
    v_fma_f32 v166, v166, s37, -v236
    v_fma_f32 v167, v167, s37, -v236
    v_mfma_f32_16x16x32_bf16 v[184:187], v[78:81], v[176:179], 0
    v_exp_f32 v164, v164
    v_mfma_f32_16x16x32_bf16 v[188:191], v[100:103], v[176:179], 0
    v_exp_f32 v165, v165
    v_mfma_f32_16x16x32_bf16 v[192:195], v[122:125], v[176:179], 0
    v_exp_f32 v166, v166
    v_mfma_f32_16x16x32_bf16 v[220:223], a[252:255], a[72:75], 0
    v_exp_f32 v167, v167
    v_mfma_f32_16x16x32_bf16 v[220:223], v[252:255], a[84:87], v[220:223]
    v_cvt_pk_bf16_f32 v180, v164, v165
    v_cvt_pk_bf16_f32 v181, v166, v167
    v_mfma_f32_16x16x32_bf16 v[216:219], a[252:255], a[76:79], 0
    ds_read_b128 v[164:167], v230 offset:1280
    v_fma_f32 v168, v168, s37, -v236
    v_mfma_f32_16x16x32_bf16 v[216:219], v[252:255], a[88:91], v[216:219]
    s_waitcnt lgkmcnt(1)
    v_fma_f32 v169, v169, s37, -v236
    v_fma_f32 v170, v170, s37, -v236
    v_mfma_f32_16x16x32_bf16 v[160:163], v[42:45], v[138:141], v[160:163]
    v_fma_f32 v171, v171, s37, -v236
    v_fma_f32 v172, v172, s37, -v236
    v_mfma_f32_16x16x32_bf16 v[212:215], a[252:255], a[80:83], 0
    ds_read_b128 a[252:255], v239
    v_fma_f32 v173, v173, s37, -v236
    v_mfma_f32_16x16x32_bf16 v[212:215], v[252:255], a[92:95], v[212:215]
    ds_read_b128 v[252:255], v240
    v_fma_f32 v174, v174, s37, -v236
    v_mfma_f32_16x16x16_bf16 v[160:163], v[46:47], v[142:143], v[160:163]
    v_exp_f32 v168, v168
    v_mfma_f32_16x16x32_bf16 v[208:211], a[24:27], a[236:239], v[208:211]
    v_exp_f32 v169, v169
    v_mfma_f32_16x16x32_bf16 v[208:211], a[36:39], a[240:243], v[208:211]
    v_exp_f32 v170, v170
    v_mfma_f32_16x16x32_bf16 v[204:207], a[28:31], a[236:239], v[204:207]
    v_exp_f32 v171, v171
    v_mfma_f32_16x16x32_bf16 v[204:207], a[40:43], a[240:243], v[204:207]
    s_waitcnt lgkmcnt(2)
    v_cvt_pk_bf16_f32 v182, v168, v169
    v_cvt_pk_bf16_f32 v183, v170, v171
    v_mfma_f32_16x16x32_bf16 v[164:167], v[24:27], v[138:141], v[164:167]
    ds_read_b128 v[168:171], v230 offset:1920
    v_fma_f32 v175, v175, s37, -v236
    v_mfma_f32_16x16x32_bf16 v[196:199], a[216:219], v[180:183], v[196:199]
    v_exp_f32 v172, v172
    v_mfma_f32_16x16x32_bf16 v[184:187], v[66:69], v[180:183], v[184:187]
    v_exp_f32 v173, v173
    v_mfma_f32_16x16x32_bf16 v[188:191], v[88:91], v[180:183], v[188:191]
    v_exp_f32 v174, v174
    v_mfma_f32_16x16x32_bf16 v[192:195], v[110:113], v[180:183], v[192:195]
    v_exp_f32 v175, v175
    v_mfma_f32_16x16x16_bf16 v[164:167], v[28:29], v[142:143], v[164:167]
    v_cvt_pk_bf16_f32 v176, v172, v173
    v_cvt_pk_bf16_f32 v177, v174, v175
    v_mfma_f32_16x16x32_bf16 v[200:203], a[32:35], a[236:239], v[200:203]
    ds_read_b128 v[172:175], v235
    v_bfe_u32 v235, s69, v233, 4
    v_mfma_f32_16x16x32_bf16 v[200:203], a[44:47], a[240:243], v[200:203]
    v_mad_u32_u24 v235, v235, s40, v231
    v_fma_f32 v144, v144, s37, -v236
    v_mfma_f32_16x16x32_bf16 v[220:223], a[236:239], a[96:99], v[220:223]
    v_fma_f32 v145, v145, s37, -v236
    v_fma_f32 v146, v146, s37, -v236
    v_mfma_f32_16x16x32_bf16 v[220:223], a[240:243], a[108:111], v[220:223]
    s_waitcnt lgkmcnt(1)
    v_fma_f32 v147, v147, s37, -v236
    v_fma_f32 v148, v148, s37, -v236
    v_mfma_f32_16x16x32_bf16 v[168:171], v[30:33], v[138:141], v[168:171]
    v_exp_f32 v144, v144
    v_mfma_f32_16x16x32_bf16 v[216:219], a[236:239], a[100:103], v[216:219]
    v_exp_f32 v145, v145
    v_mfma_f32_16x16x32_bf16 v[216:219], a[240:243], a[112:115], v[216:219]
    v_exp_f32 v146, v146
    v_mfma_f32_16x16x32_bf16 v[212:215], a[236:239], a[104:107], v[212:215]
    ds_read_b128 a[236:239], v239 offset:1024
    v_cvt_pk_bf16_f32 v178, v144, v145
    v_mfma_f32_16x16x32_bf16 v[212:215], a[240:243], a[116:119], v[212:215]
    ds_read_b128 a[240:243], v240 offset:1024
    v_fma_f32 v149, v149, s37, -v236
    v_mfma_f32_16x16x16_bf16 v[168:171], v[34:35], v[142:143], v[168:171]
    s_waitcnt lgkmcnt(2)
    v_exp_f32 v147, v147
    v_mfma_f32_16x16x32_bf16 v[172:175], v[54:57], v[138:141], v[172:175]
    v_cvt_pk_bf16_f32 v179, v146, v147
    v_fma_f32 v150, v150, s37, -v236
    v_mfma_f32_16x16x32_bf16 v[208:211], a[48:51], a[244:247], v[208:211]
    ds_read_b128 v[144:147], v250
    v_bfe_u32 v250, s70, v233, 4
    v_mfma_f32_16x16x32_bf16 v[208:211], a[60:63], a[248:251], v[208:211]
    v_mad_u32_u24 v250, v250, s40, v231
    v_fma_f32 v151, v151, s37, -v236
    v_mfma_f32_16x16x32_bf16 v[196:199], a[216:219], v[176:179], v[196:199]
    v_exp_f32 v148, v148
    v_mfma_f32_16x16x32_bf16 v[184:187], v[70:73], v[176:179], v[184:187]
    v_exp_f32 v149, v149
    v_mfma_f32_16x16x32_bf16 v[188:191], v[92:95], v[176:179], v[188:191]
    v_exp_f32 v150, v150
    v_mfma_f32_16x16x32_bf16 v[192:195], v[114:117], v[176:179], v[192:195]
    v_cvt_pk_bf16_f32 v48, v208, v209
    v_cvt_pk_bf16_f32 v49, v210, v211
    v_mfma_f32_16x16x16_bf16 v[172:175], v[58:59], v[142:143], v[172:175]
    v_exp_f32 v151, v151
    v_mfma_f32_16x16x32_bf16 v[204:207], a[52:55], a[244:247], v[204:207]
    v_cvt_pk_bf16_f32 v180, v148, v149
    v_cvt_pk_bf16_f32 v181, v150, v151
    v_mfma_f32_16x16x32_bf16 v[204:207], a[64:67], a[248:251], v[204:207]
    s_waitcnt lgkmcnt(0)
    ds_read_b128 v[148:151], v234
    v_bfe_u32 v234, s67, v233, 4
    v_mfma_f32_16x16x32_bf16 v[144:147], v[60:63], v[138:141], v[144:147]
    v_mad_u32_u24 v234, v234, s40, v231
    v_fma_f32 v152, v152, s37, -v236
    v_mfma_f32_16x16x32_bf16 v[200:203], a[56:59], a[244:247], v[200:203]
    v_fma_f32 v153, v153, s37, -v236
    v_fma_f32 v154, v154, s37, -v236
    v_mfma_f32_16x16x32_bf16 v[200:203], a[68:71], a[248:251], v[200:203]
    v_cvt_pk_bf16_f32 v50, v204, v205
    v_cvt_pk_bf16_f32 v51, v206, v207
    v_mfma_f32_16x16x16_bf16 v[144:147], v[64:65], v[142:143], v[144:147]
    v_fma_f32 v155, v155, s37, -v236
    v_max3_f32 v248, v156, v157, v158
    v_mfma_f32_16x16x32_bf16 v[220:223], a[244:247], a[120:123], v[220:223]
    v_exp_f32 v152, v152
    v_mfma_f32_16x16x32_bf16 v[220:223], a[248:251], a[132:135], v[220:223]
    v_cvt_pk_bf16_f32 v52, v200, v201
    v_cvt_pk_bf16_f32 v53, v202, v203
    v_mfma_f32_16x16x32_bf16 v[216:219], a[244:247], a[124:127], v[216:219]
    v_exp_f32 v153, v153
    v_mfma_f32_16x16x32_bf16 v[216:219], a[248:251], a[136:139], v[216:219]
    s_waitcnt lgkmcnt(0)
    v_exp_f32 v154, v154
    v_mfma_f32_16x16x32_bf16 v[148:151], v[48:51], v[138:141], v[148:151]
    v_exp_f32 v155, v155
    v_mfma_f32_16x16x32_bf16 v[212:215], a[244:247], a[128:131], v[212:215]
    v_cvt_pk_bf16_f32 v82, v220, v221
    v_cvt_pk_bf16_f32 v83, v222, v223
    v_mfma_f32_16x16x32_bf16 v[212:215], a[248:251], a[140:143], v[212:215]
    ds_read_b128 a[244:247], v241 offset:12288
    v_cvt_pk_bf16_f32 v104, v216, v217
    v_mfma_f32_16x16x16_bf16 v[148:151], v[52:53], v[142:143], v[148:151]
    ds_read_b128 a[248:251], v241 offset:12800
    v_cvt_pk_bf16_f32 v105, v218, v219
    v_mfma_f32_16x16x32_bf16 v[208:211], a[220:223], a[252:255], 0
    v_cvt_pk_bf16_f32 v182, v152, v153
    v_cvt_pk_bf16_f32 v183, v154, v155
    v_mfma_f32_16x16x32_bf16 v[200:203], a[220:223], v[252:255], 0
    v_cvt_pk_bf16_f32 v126, v212, v213
    v_cvt_pk_bf16_f32 v127, v214, v215
    v_mfma_f32_16x16x32_bf16 v[196:199], a[216:219], v[180:183], v[196:199]
    ds_read_b128 v[152:155], v228 offset:640
    v_max3_f32 v249, v159, v160, v161
    v_mfma_f32_16x16x32_bf16 v[184:187], v[74:77], v[180:183], v[184:187]
    v_max3_f32 v248, v248, v162, v163
    v_max3_f32 v249, v249, v164, v165
    v_mfma_f32_16x16x32_bf16 v[188:191], v[96:99], v[180:183], v[188:191]
    v_max3_f32 v248, v248, v166, v167
    v_max3_f32 v249, v249, v168, v169
    v_mfma_f32_16x16x32_bf16 v[192:195], v[118:121], v[180:183], v[192:195]
    v_rcp_f32 v197, v196
    v_mfma_f32_16x16x32_bf16 v[204:207], a[224:227], a[252:255], 0
    v_mul_f32 v184, v184, v197
    v_mul_f32 v185, v185, v197
    v_mfma_f32_16x16x32_bf16 v[220:223], a[224:227], v[252:255], 0
    ds_read_b128 v[252:255], v242 offset:12800
    v_cvt_pk_bf16_f32 v184, v184, v185
    v_mfma_f32_16x16x32_bf16 v[216:219], a[228:231], a[252:255], 0
    v_mul_f32 v186, v186, v197
    v_mul_f32 v187, v187, v197
    v_mfma_f32_16x16x32_bf16 v[212:215], a[232:235], a[252:255], 0
    s_waitcnt lgkmcnt(2)
    ds_read_b128 a[252:255], v242 offset:12288
    v_cvt_pk_bf16_f32 v185, v186, v187
    v_mfma_f32_16x16x32_bf16 v[208:211], a[244:247], a[236:239], v[208:211]
    s_waitcnt lgkmcnt(2)
    v_mul_f32 v188, v188, v197
    v_mul_f32 v189, v189, v197
    v_mfma_f32_16x16x32_bf16 v[152:155], v[0:3], v[132:135], v[152:155]
    v_cvt_pk_bf16_f32 v186, v188, v189
    v_mul_f32 v190, v190, v197
    v_mfma_f32_16x16x32_bf16 v[200:203], a[244:247], a[240:243], v[200:203]
    ds_read_b128 a[244:247], v241 offset:24576
    v_mul_f32 v191, v191, v197
    v_mfma_f32_16x16x32_bf16 v[204:207], a[248:251], a[236:239], v[204:207]
    v_cvt_pk_bf16_f32 v187, v190, v191
    v_mul_f32 v192, v192, v197
    v_mfma_f32_16x16x16_bf16 v[152:155], v[4:5], v[136:137], v[152:155]
    v_mul_f32 v193, v193, v197
    v_cvt_pk_bf16_f32 v188, v192, v193
    v_mfma_f32_16x16x32_bf16 v[220:223], a[248:251], a[240:243], v[220:223]
    s_waitcnt lgkmcnt(2)
    ds_read_b128 a[240:243], v240 offset:2048
    ds_read_b128 a[248:251], v241 offset:25088
    v_mfma_f32_16x16x32_bf16 v[212:215], v[252:255], a[236:239], v[212:215]
    s_waitcnt lgkmcnt(3)
    ds_read_b128 v[252:255], v242 offset:25088
    v_mul_f32 v194, v194, v197
    v_mul_f32 v195, v195, v197
    v_cvt_pk_bf16_f32 v189, v194, v195
    v_mfma_f32_16x16x32_bf16 v[216:219], a[252:255], a[236:239], v[216:219]
    s_waitcnt lgkmcnt(2)
    ds_read_b128 a[236:239], v239 offset:2048
    v_max3_f32 v248, v248, v170, v171
    ds_read_b128 a[252:255], v242 offset:24576
    v_max3_f32 v249, v249, v172, v173
    ds_write_b128 v237, v[184:187] offset:12288
    ds_write_b64 v238, v[188:189] offset:12288
    v_max3_f32 v248, v248, v174, v175
    v_max3_f32 v249, v249, v144, v145
    v_max3_f32 v248, v248, v146, v147
    v_max3_f32 v249, v249, v148, v149
    v_max3_f32 v248, v248, v150, v151
    v_max_f32 v248, v248, v249
    v_mfma_f32_16x16x32_bf16 v[200:203], a[244:247], a[240:243], v[200:203]
    s_waitcnt lgkmcnt(3)
    v_mov_b32 v249, v248
    v_mfma_f32_16x16x32_bf16 v[220:223], a[248:251], a[240:243], v[220:223]
    s_nop 0
    v_permlane16_swap_b32 v248, v249
    ds_read_b128 a[240:243], v240 offset:3072
    v_mfma_f32_16x16x32_bf16 v[208:211], a[244:247], a[236:239], v[208:211]
    ds_read_b128 a[244:247], v241 offset:36864
    v_max_f32 v248, v248, v249
    v_mfma_f32_16x16x32_bf16 v[204:207], a[248:251], a[236:239], v[204:207]
    s_waitcnt lgkmcnt(4)
    ds_read_b128 a[248:251], v241 offset:37376
    v_mov_b32 v249, v248
    v_mfma_f32_16x16x32_bf16 v[216:219], a[252:255], a[236:239], v[216:219]
    ds_read_b128 a[252:255], v242 offset:36864
    v_mfma_f32_16x16x32_bf16 v[212:215], v[252:255], a[236:239], v[212:215]
    s_waitcnt lgkmcnt(2)
    ds_read_b128 a[236:239], v239 offset:3072
    ds_read_b128 v[252:255], v242 offset:37376
    v_permlane32_swap_b32 v248, v249
    v_max_f32 v248, v248, v249
    v_mul_f32 v236, s37, v248
    v_fma_f32 v156, v156, s37, -v236
    v_fma_f32 v157, v157, s37, -v236
    v_fma_f32 v158, v158, s37, -v236
    v_fma_f32 v159, v159, s37, -v236
    v_exp_f32 v156, v156
    v_exp_f32 v157, v157
    v_exp_f32 v158, v158
    v_exp_f32 v159, v159
    v_cvt_pk_bf16_f32 v176, v156, v157
    v_cvt_pk_bf16_f32 v177, v158, v159
    ds_read_b128 v[156:159], v229 offset:640
    v_mfma_f32_16x16x32_bf16 v[200:203], a[244:247], a[240:243], v[200:203]
    s_waitcnt lgkmcnt(4)
    v_fma_f32 v160, v160, s37, -v236
    v_fma_f32 v161, v161, s37, -v236
    v_mfma_f32_16x16x32_bf16 v[220:223], a[248:251], a[240:243], v[220:223]
    s_waitcnt lgkmcnt(2)
    ds_read_b128 a[240:243], v240 offset:4096
    v_fma_f32 v162, v162, s37, -v236
    v_fma_f32 v163, v163, s37, -v236
    v_exp_f32 v160, v160
    v_mfma_f32_16x16x32_bf16 v[208:211], a[244:247], a[236:239], v[208:211]
    ds_read_b128 a[244:247], v241 offset:49152
    v_fma_f32 v164, v164, s37, -v236
    v_mfma_f32_16x16x32_bf16 v[204:207], a[248:251], a[236:239], v[204:207]
    ds_read_b128 a[248:251], v241 offset:49664
    v_fma_f32 v165, v165, s37, -v236
    v_mfma_f32_16x16x32_bf16 v[216:219], a[252:255], a[236:239], v[216:219]
    s_waitcnt lgkmcnt(4)
    ds_read_b128 a[252:255], v242 offset:49152
    v_fma_f32 v166, v166, s37, -v236
    v_mfma_f32_16x16x32_bf16 v[212:215], v[252:255], a[236:239], v[212:215]
    s_waitcnt lgkmcnt(4)
    ds_read_b128 a[236:239], v239 offset:4096
    ds_read_b128 v[252:255], v242 offset:49664
    v_exp_f32 v161, v161
    v_exp_f32 v162, v162
    v_exp_f32 v163, v163
    v_mfma_f32_16x16x32_bf16 v[156:159], v[24:27], v[132:135], v[156:159]
    v_cvt_pk_bf16_f32 v178, v160, v161
    v_cvt_pk_bf16_f32 v179, v162, v163
    ds_read_b128 v[160:163], v229 offset:1280
    v_fma_f32 v167, v167, s37, -v236
    v_mfma_f32_16x16x32_bf16 v[196:199], a[216:219], v[176:179], 0
    v_exp_f32 v164, v164
    v_mfma_f32_16x16x32_bf16 v[184:187], v[76:79], v[176:179], 0
    v_exp_f32 v165, v165
    v_mfma_f32_16x16x32_bf16 v[188:191], v[98:101], v[176:179], 0
    v_exp_f32 v166, v166
    v_mfma_f32_16x16x32_bf16 v[192:195], v[120:123], v[176:179], 0
    v_exp_f32 v167, v167
    v_mfma_f32_16x16x16_bf16 v[156:159], v[28:29], v[136:137], v[156:159]
    s_waitcnt lgkmcnt(2)
    v_cvt_pk_bf16_f32 v180, v164, v165
    v_cvt_pk_bf16_f32 v181, v166, v167
    v_mfma_f32_16x16x32_bf16 v[208:211], a[244:247], a[236:239], v[208:211]
    ds_read_b128 v[164:167], v228 offset:1280
    v_fma_f32 v168, v168, s37, -v236
    v_mfma_f32_16x16x32_bf16 v[200:203], a[244:247], a[240:243], v[200:203]
    ds_read_b128 a[244:247], v241 offset:61440
    v_fma_f32 v169, v169, s37, -v236
    v_mfma_f32_16x16x32_bf16 v[204:207], a[248:251], a[236:239], v[204:207]
    s_waitcnt lgkmcnt(2)
    v_fma_f32 v170, v170, s37, -v236
    v_fma_f32 v171, v171, s37, -v236
    v_mfma_f32_16x16x32_bf16 v[160:163], v[30:33], v[132:135], v[160:163]
    v_exp_f32 v168, v168
    v_mfma_f32_16x16x32_bf16 v[220:223], a[248:251], a[240:243], v[220:223]
    ds_read_b128 a[240:243], v240 offset:5120
    ds_read_b128 a[248:251], v241 offset:61952
    v_mfma_f32_16x16x32_bf16 v[216:219], a[252:255], a[236:239], v[216:219]
    ds_read_b128 a[252:255], v242 offset:61440
    v_fma_f32 v172, v172, s37, -v236
    v_mfma_f32_16x16x16_bf16 v[160:163], v[34:35], v[136:137], v[160:163]
    v_exp_f32 v169, v169
    v_mfma_f32_16x16x32_bf16 v[212:215], v[252:255], a[236:239], v[212:215]
    s_waitcnt lgkmcnt(4)
    ds_read_b128 a[236:239], v239 offset:5120
    ds_read_b128 v[252:255], v242 offset:61952
    v_exp_f32 v170, v170
    v_exp_f32 v171, v171
    v_mfma_f32_16x16x32_bf16 v[164:167], v[6:9], v[132:135], v[164:167]
    v_cvt_pk_bf16_f32 v182, v168, v169
    v_cvt_pk_bf16_f32 v183, v170, v171
    ds_read_b128 v[168:171], v228 offset:1920
    v_fma_f32 v173, v173, s37, -v236
    v_mfma_f32_16x16x32_bf16 v[196:199], a[216:219], v[180:183], v[196:199]
    v_fma_f32 v174, v174, s37, -v236
    v_fma_f32 v175, v175, s37, -v236
    v_mfma_f32_16x16x32_bf16 v[184:187], v[68:71], v[180:183], v[184:187]
    v_exp_f32 v172, v172
    v_mfma_f32_16x16x32_bf16 v[188:191], v[90:93], v[180:183], v[188:191]
    v_exp_f32 v173, v173
    v_mfma_f32_16x16x32_bf16 v[192:195], v[112:115], v[180:183], v[192:195]
    v_exp_f32 v174, v174
    v_mfma_f32_16x16x16_bf16 v[164:167], v[10:11], v[136:137], v[164:167]
    s_waitcnt lgkmcnt(2)
    v_exp_f32 v175, v175
    v_mfma_f32_16x16x32_bf16 v[208:211], a[244:247], a[236:239], v[208:211]
    v_cvt_pk_bf16_f32 v176, v172, v173
    v_cvt_pk_bf16_f32 v177, v174, v175
    v_mfma_f32_16x16x32_bf16 v[200:203], a[244:247], a[240:243], v[200:203]
    ds_read_b128 a[244:247], v224 offset:46592
    ds_read_b128 v[172:175], v229 offset:1920
    v_mfma_f32_16x16x32_bf16 v[204:207], a[248:251], a[236:239], v[204:207]
    s_waitcnt lgkmcnt(2)
    v_fma_f32 v144, v144, s37, -v236
    v_fma_f32 v145, v145, s37, -v236
    v_mfma_f32_16x16x32_bf16 v[168:171], v[12:15], v[132:135], v[168:171]
    v_cvt_pk_bf16_f32 v208, v208, v209
    v_cvt_pk_bf16_f32 v209, v210, v211
    v_mfma_f32_16x16x32_bf16 v[220:223], a[248:251], a[240:243], v[220:223]
    ds_read_b128 a[240:243], v224 offset:46528
    ds_read_b128 a[248:251], v224 offset:46656
    v_mfma_f32_16x16x32_bf16 v[216:219], a[252:255], a[236:239], v[216:219]
    ds_read_b128 a[252:255], v224 offset:46720
    v_cvt_pk_bf16_f32 v210, v204, v205
    v_mfma_f32_16x16x16_bf16 v[168:171], v[16:17], v[136:137], v[168:171]
    v_cvt_pk_bf16_f32 v211, v206, v207
    v_cvt_pk_bf16_f32 v200, v200, v201
    v_mfma_f32_16x16x32_bf16 v[212:215], v[252:255], a[236:239], v[212:215]
    s_waitcnt lgkmcnt(3)
    ds_read_b128 a[236:239], v224 offset:46464
    ds_read_b128 v[252:255], v224 offset:46784
    buffer_store_dwordx4 v[208:211], v243, s[20:23], s51 offen sc0 sc1
    v_cvt_pk_bf16_f32 v201, v202, v203
    v_cvt_pk_bf16_f32 v202, v220, v221
    v_cvt_pk_bf16_f32 v203, v222, v223
    v_cvt_pk_bf16_f32 v216, v216, v217
    v_cvt_pk_bf16_f32 v217, v218, v219
    v_cvt_pk_bf16_f32 v218, v212, v213
    v_cvt_pk_bf16_f32 v219, v214, v215
    v_mfma_f32_16x16x32_bf16 v[172:175], v[36:39], v[132:135], v[172:175]
    v_fma_f32 v146, v146, s37, -v236
    v_fma_f32 v147, v147, s37, -v236
    v_exp_f32 v144, v144
    v_exp_f32 v145, v145
    v_exp_f32 v146, v146
    v_exp_f32 v147, v147
    v_mfma_f32_16x16x16_bf16 v[172:175], v[40:41], v[136:137], v[172:175]
    s_waitcnt lgkmcnt(1)
    v_cvt_pk_bf16_f32 v178, v144, v145
    v_cvt_pk_bf16_f32 v179, v146, v147
    ds_read_b128 v[144:147], v229 offset:2560
    v_mfma_f32_16x16x32_bf16 v[208:211], a[0:3], a[236:239], 0
    v_fma_f32 v148, v148, s37, -v236
    v_fma_f32 v149, v149, s37, -v236
    v_mfma_f32_16x16x32_bf16 v[208:211], a[12:15], a[240:243], v[208:211]
    v_fma_f32 v150, v150, s37, -v236
    v_fma_f32 v151, v151, s37, -v236
    v_mfma_f32_16x16x32_bf16 v[196:199], a[216:219], v[176:179], v[196:199]
    v_exp_f32 v148, v148
    v_mfma_f32_16x16x32_bf16 v[184:187], v[84:87], v[176:179], v[184:187]
    v_exp_f32 v149, v149
    v_mfma_f32_16x16x32_bf16 v[188:191], v[106:109], v[176:179], v[188:191]
    buffer_store_dwordx4 v[200:203], v245, s[20:23], s51 offen sc0 sc1
    v_mfma_f32_16x16x32_bf16 v[192:195], v[128:131], v[176:179], v[192:195]
    v_exp_f32 v150, v150
    v_mfma_f32_16x16x32_bf16 v[204:207], a[4:7], a[236:239], 0
    v_exp_f32 v151, v151
    v_mfma_f32_16x16x32_bf16 v[204:207], a[16:19], a[240:243], v[204:207]
    v_cvt_pk_bf16_f32 v180, v148, v149
    v_cvt_pk_bf16_f32 v181, v150, v151
    v_mfma_f32_16x16x32_bf16 v[200:203], a[8:11], a[236:239], 0
    ds_read_b128 v[148:151], v228 offset:2560
    v_max3_f32 v248, v152, v153, v154
    v_mfma_f32_16x16x32_bf16 v[200:203], a[20:23], a[240:243], v[200:203]
    v_max3_f32 v249, v155, v156, v157
    v_max3_f32 v248, v248, v158, v159
    v_mfma_f32_16x16x16_bf16 v[196:199], a[216:217], v[180:181], v[196:199]
    v_max3_f32 v249, v249, v160, v161
    v_max3_f32 v248, v248, v162, v163
    v_mfma_f32_16x16x16_bf16 v[184:187], v[82:83], v[180:181], v[184:187]
    v_max3_f32 v249, v249, v164, v165
    v_max3_f32 v248, v248, v166, v167
    v_mfma_f32_16x16x16_bf16 v[188:191], v[104:105], v[180:181], v[188:191]
    v_max3_f32 v249, v249, v168, v169
    v_max3_f32 v248, v248, v170, v171
    v_mfma_f32_16x16x16_bf16 v[192:195], v[126:127], v[180:181], v[192:195]
    v_rcp_f32 v197, v196
    v_mfma_f32_16x16x32_bf16 v[220:223], a[236:239], a[72:75], 0
    v_mul_f32 v184, v184, v197
    v_mul_f32 v185, v185, v197
    v_mfma_f32_16x16x32_bf16 v[220:223], a[240:243], a[84:87], v[220:223]
    v_cvt_pk_bf16_f32 v184, v184, v185
    v_mul_f32 v186, v186, v197
    v_mfma_f32_16x16x32_bf16 v[212:215], a[236:239], a[80:83], 0
    buffer_store_dwordx4 v[216:219], v244, s[20:23], s51 offen sc0 sc1
    v_mfma_f32_16x16x32_bf16 v[212:215], a[240:243], a[92:95], v[212:215]
    s_add_u32 s51, s51, s48
    v_mul_f32 v187, v187, v197
    v_cvt_pk_bf16_f32 v185, v186, v187
    v_mfma_f32_16x16x32_bf16 v[216:219], a[236:239], a[76:79], 0
    ds_read_b128 a[236:239], v224 offset:49536
    v_mul_f32 v188, v188, v197
    v_mfma_f32_16x16x32_bf16 v[216:219], a[240:243], a[88:91], v[216:219]
    ds_read_b128 a[240:243], v224 offset:49600
    v_mul_f32 v189, v189, v197
    v_mfma_f32_16x16x32_bf16 v[208:211], a[24:27], a[244:247], v[208:211]
    v_cvt_pk_bf16_f32 v186, v188, v189
    v_mul_f32 v190, v190, v197
    v_mfma_f32_16x16x32_bf16 v[208:211], a[36:39], a[248:251], v[208:211]
    v_mul_f32 v191, v191, v197
    v_cvt_pk_bf16_f32 v187, v190, v191
    v_mfma_f32_16x16x32_bf16 v[204:207], a[28:31], a[244:247], v[204:207]
    v_mul_f32 v192, v192, v197
    v_mul_f32 v193, v193, v197
    v_mfma_f32_16x16x32_bf16 v[204:207], a[40:43], a[248:251], v[204:207]
    v_cvt_pk_bf16_f32 v188, v192, v193
    v_mul_f32 v194, v194, v197
    v_mfma_f32_16x16x32_bf16 v[200:203], a[32:35], a[244:247], v[200:203]
    v_mul_f32 v195, v195, v197
    v_cvt_pk_bf16_f32 v189, v194, v195
    v_mfma_f32_16x16x32_bf16 v[200:203], a[44:47], a[248:251], v[200:203]
    ds_write_b128 v237, v[184:187] offset:18432
    v_mfma_f32_16x16x32_bf16 v[220:223], a[244:247], a[96:99], v[220:223]
    ds_write_b64 v238, v[188:189] offset:18432
    v_mfma_f32_16x16x32_bf16 v[220:223], a[248:251], a[108:111], v[220:223]
    v_max3_f32 v249, v249, v172, v173
    v_max3_f32 v248, v248, v174, v175
    v_mfma_f32_16x16x32_bf16 v[216:219], a[244:247], a[100:103], v[216:219]
    v_mfma_f32_16x16x32_bf16 v[216:219], a[248:251], a[112:115], v[216:219]
    v_mfma_f32_16x16x32_bf16 v[212:215], a[244:247], a[104:107], v[212:215]
    ds_read_b128 a[244:247], v224 offset:49664
    v_mfma_f32_16x16x32_bf16 v[212:215], a[248:251], a[116:119], v[212:215]
    ds_read_b128 a[248:251], v224 offset:49728
    v_mfma_f32_16x16x32_bf16 v[208:211], a[48:51], a[252:255], v[208:211]
    s_waitcnt lgkmcnt(4)
    v_mfma_f32_16x16x32_bf16 v[208:211], a[60:63], v[252:255], v[208:211]
    v_mfma_f32_16x16x32_bf16 v[204:207], a[52:55], a[252:255], v[204:207]
    v_mfma_f32_16x16x32_bf16 v[204:207], a[64:67], v[252:255], v[204:207]
    v_mfma_f32_16x16x32_bf16 v[200:203], a[56:59], a[252:255], v[200:203]
    v_mfma_f32_16x16x32_bf16 v[200:203], a[68:71], v[252:255], v[200:203]
    v_mfma_f32_16x16x32_bf16 v[220:223], a[252:255], a[120:123], v[220:223]
    v_mfma_f32_16x16x32_bf16 v[220:223], v[252:255], a[132:135], v[220:223]
    v_mfma_f32_16x16x32_bf16 v[216:219], a[252:255], a[124:127], v[216:219]
    v_mfma_f32_16x16x32_bf16 v[216:219], v[252:255], a[136:139], v[216:219]
    v_cvt_pk_bf16_f32 v18, v208, v209
    v_cvt_pk_bf16_f32 v19, v210, v211
    v_mfma_f32_16x16x32_bf16 v[212:215], a[252:255], a[128:131], v[212:215]
    v_cvt_pk_bf16_f32 v20, v204, v205
    v_cvt_pk_bf16_f32 v21, v206, v207
    v_mfma_f32_16x16x32_bf16 v[212:215], v[252:255], a[140:143], v[212:215]
    v_cvt_pk_bf16_f32 v22, v200, v201
    v_cvt_pk_bf16_f32 v23, v202, v203
    v_mfma_f32_16x16x32_bf16 v[148:151], v[18:21], v[132:135], v[148:151]
    v_cvt_pk_bf16_f32 v80, v220, v221
    v_cvt_pk_bf16_f32 v81, v222, v223
    v_mfma_f32_16x16x32_bf16 v[208:211], a[0:3], a[236:239], 0
    v_cvt_pk_bf16_f32 v102, v216, v217
    v_cvt_pk_bf16_f32 v103, v218, v219
    v_mfma_f32_16x16x32_bf16 v[208:211], a[12:15], a[240:243], v[208:211]
    v_cvt_pk_bf16_f32 v124, v212, v213
    v_cvt_pk_bf16_f32 v125, v214, v215
    v_mfma_f32_16x16x16_bf16 v[148:151], v[22:23], v[136:137], v[148:151]
    ds_read_b128 a[252:255], v224 offset:49792
    ds_read_b128 v[252:255], v224 offset:49856
    v_mfma_f32_16x16x32_bf16 v[204:207], a[4:7], a[236:239], 0
    v_mfma_f32_16x16x32_bf16 v[204:207], a[16:19], a[240:243], v[204:207]
    v_mfma_f32_16x16x32_bf16 v[200:203], a[8:11], a[236:239], 0
    v_mfma_f32_16x16x32_bf16 v[200:203], a[20:23], a[240:243], v[200:203]
    v_mfma_f32_16x16x32_bf16 v[220:223], a[236:239], a[72:75], 0
    v_mfma_f32_16x16x32_bf16 v[220:223], a[240:243], a[84:87], v[220:223]
    v_mfma_f32_16x16x32_bf16 v[216:219], a[236:239], a[76:79], 0
    v_mfma_f32_16x16x32_bf16 v[216:219], a[240:243], a[88:91], v[216:219]
    v_mfma_f32_16x16x32_bf16 v[212:215], a[236:239], a[80:83], 0
    ds_read_b128 a[236:239], v225 offset:27456
    v_mfma_f32_16x16x32_bf16 v[212:215], a[240:243], a[92:95], v[212:215]
    s_waitcnt lgkmcnt(2)
    ds_read_b128 a[240:243], v225 offset:27520
    v_mfma_f32_16x16x32_bf16 v[208:211], a[24:27], a[244:247], v[208:211]
    v_mfma_f32_16x16x32_bf16 v[208:211], a[36:39], a[248:251], v[208:211]
    v_mfma_f32_16x16x32_bf16 v[204:207], a[28:31], a[244:247], v[204:207]
    v_mfma_f32_16x16x32_bf16 v[204:207], a[40:43], a[248:251], v[204:207]
    v_mfma_f32_16x16x32_bf16 v[200:203], a[32:35], a[244:247], v[200:203]
    v_mfma_f32_16x16x32_bf16 v[200:203], a[44:47], a[248:251], v[200:203]
    v_mfma_f32_16x16x32_bf16 v[220:223], a[244:247], a[96:99], v[220:223]
    v_mfma_f32_16x16x32_bf16 v[220:223], a[248:251], a[108:111], v[220:223]
    v_mfma_f32_16x16x32_bf16 v[216:219], a[244:247], a[100:103], v[216:219]
    v_mfma_f32_16x16x32_bf16 v[216:219], a[248:251], a[112:115], v[216:219]
    v_mfma_f32_16x16x32_bf16 v[212:215], a[244:247], a[104:107], v[212:215]
    ds_read_b128 a[244:247], v225 offset:27584
    v_mfma_f32_16x16x32_bf16 v[212:215], a[248:251], a[116:119], v[212:215]
    ds_read_b128 a[248:251], v225 offset:27648
    v_mfma_f32_16x16x32_bf16 v[208:211], a[48:51], a[252:255], v[208:211]
    s_waitcnt lgkmcnt(2)
    v_mfma_f32_16x16x32_bf16 v[208:211], a[60:63], v[252:255], v[208:211]
    v_mfma_f32_16x16x32_bf16 v[204:207], a[52:55], a[252:255], v[204:207]
    v_mfma_f32_16x16x32_bf16 v[204:207], a[64:67], v[252:255], v[204:207]
    v_mfma_f32_16x16x32_bf16 v[200:203], a[56:59], a[252:255], v[200:203]
    v_mfma_f32_16x16x32_bf16 v[200:203], a[68:71], v[252:255], v[200:203]
    v_mfma_f32_16x16x32_bf16 v[220:223], a[252:255], a[120:123], v[220:223]
    v_mfma_f32_16x16x32_bf16 v[220:223], v[252:255], a[132:135], v[220:223]
    v_mfma_f32_16x16x32_bf16 v[216:219], a[252:255], a[124:127], v[216:219]
    v_mfma_f32_16x16x32_bf16 v[216:219], v[252:255], a[136:139], v[216:219]
    v_cvt_pk_bf16_f32 v42, v208, v209
    v_cvt_pk_bf16_f32 v43, v210, v211
    v_mfma_f32_16x16x32_bf16 v[212:215], a[252:255], a[128:131], v[212:215]
    v_cvt_pk_bf16_f32 v44, v204, v205
    v_cvt_pk_bf16_f32 v45, v206, v207
    v_mfma_f32_16x16x32_bf16 v[212:215], v[252:255], a[140:143], v[212:215]
    v_cvt_pk_bf16_f32 v46, v200, v201
    v_cvt_pk_bf16_f32 v47, v202, v203
    v_mfma_f32_16x16x32_bf16 v[144:147], v[42:45], v[132:135], v[144:147]
    v_cvt_pk_bf16_f32 v78, v220, v221
    v_cvt_pk_bf16_f32 v79, v222, v223
    v_mfma_f32_16x16x32_bf16 v[208:211], a[144:147], a[236:239], 0
    v_cvt_pk_bf16_f32 v100, v216, v217
    v_cvt_pk_bf16_f32 v101, v218, v219
    v_mfma_f32_16x16x32_bf16 v[208:211], a[156:159], a[240:243], v[208:211]
    v_cvt_pk_bf16_f32 v122, v212, v213
    v_cvt_pk_bf16_f32 v123, v214, v215
    v_mfma_f32_16x16x16_bf16 v[144:147], v[46:47], v[136:137], v[144:147]
    ds_read_b128 a[252:255], v225 offset:27712
    ds_read_b128 v[252:255], v225 offset:27776
    v_mfma_f32_16x16x32_bf16 v[204:207], a[148:151], a[236:239], 0
    v_mfma_f32_16x16x32_bf16 v[204:207], a[160:163], a[240:243], v[204:207]
    v_mfma_f32_16x16x32_bf16 v[200:203], a[152:155], a[236:239], 0
    ds_read_b128 a[236:239], v225 offset:39872
    v_mfma_f32_16x16x32_bf16 v[200:203], a[164:167], a[240:243], v[200:203]
    s_waitcnt lgkmcnt(3)
    ds_read_b128 a[240:243], v225 offset:39936
    v_max3_f32 v249, v249, v144, v145
    v_mfma_f32_16x16x32_bf16 v[208:211], a[168:171], a[244:247], v[208:211]
    v_max3_f32 v248, v248, v146, v147
    v_max3_f32 v249, v249, v148, v149
    v_mfma_f32_16x16x32_bf16 v[208:211], a[180:183], a[248:251], v[208:211]
    v_max3_f32 v248, v248, v150, v151
    v_max_f32 v248, v248, v249
    v_mfma_f32_16x16x32_bf16 v[204:207], a[172:175], a[244:247], v[204:207]
    v_mov_b32 v249, v248
    v_mfma_f32_16x16x32_bf16 v[204:207], a[184:187], a[248:251], v[204:207]
    v_mfma_f32_16x16x32_bf16 v[200:203], a[176:179], a[244:247], v[200:203]
    s_waitcnt vmcnt(3) lgkmcnt(2)
    ds_read_b128 a[244:247], v225 offset:40000
    s_barrier
    v_mfma_f32_16x16x32_bf16 v[200:203], a[188:191], a[248:251], v[200:203]
    ds_read_b128 a[248:251], v225 offset:40064
    v_mfma_f32_16x16x32_bf16 v[208:211], a[192:195], a[252:255], v[208:211]
    buffer_load_dwordx4 v246, s[4:7], s56 offen lds
    v_mfma_f32_16x16x32_bf16 v[208:211], a[204:207], v[252:255], v[208:211]
    v_permlane16_swap_b32 v248, v249
    v_mfma_f32_16x16x32_bf16 v[204:207], a[196:199], a[252:255], v[204:207]
    v_max_f32 v248, v248, v249
    v_mov_b32 v249, v248
    v_mfma_f32_16x16x32_bf16 v[204:207], a[208:211], v[252:255], v[204:207]
    v_mfma_f32_16x16x32_bf16 v[200:203], a[200:203], a[252:255], v[200:203]
    ds_read_b128 a[252:255], v225 offset:40128
    v_mfma_f32_16x16x32_bf16 v[200:203], a[212:215], v[252:255], v[200:203]
    s_waitcnt lgkmcnt(3)
    v_cvt_pk_bf16_f32 v138, v208, v209
    v_cvt_pk_bf16_f32 v139, v210, v211
    v_mfma_f32_16x16x32_bf16 v[220:223], a[144:147], a[236:239], 0
    ds_read_b128 v[252:255], v225 offset:40192
    v_mfma_f32_16x16x32_bf16 v[220:223], a[156:159], a[240:243], v[220:223]
    v_cvt_pk_bf16_f32 v140, v204, v205
    v_cvt_pk_bf16_f32 v141, v206, v207
    v_mfma_f32_16x16x32_bf16 v[216:219], a[148:151], a[236:239], 0
    v_cvt_pk_bf16_f32 v142, v200, v201
    v_cvt_pk_bf16_f32 v143, v202, v203
    v_mfma_f32_16x16x32_bf16 v[216:219], a[160:163], a[240:243], v[216:219]
    buffer_load_dwordx4 v247, s[4:7], s56 offen offset:1024 lds
    v_mfma_f32_16x16x32_bf16 v[212:215], a[152:155], a[236:239], 0
    s_add_u32 s56, s56, s42
    ds_read_b128 a[236:239], v239 offset:12288
    s_add_u32 m0, s41, 0x5ac0
    v_mfma_f32_16x16x32_bf16 v[212:215], a[164:167], a[240:243], v[212:215]
    s_waitcnt lgkmcnt(3)
    ds_read_b128 a[240:243], v240 offset:12288
    v_mfma_f32_16x16x32_bf16 v[220:223], a[168:171], a[244:247], v[220:223]
    v_permlane32_swap_b32 v248, v249
    v_mfma_f32_16x16x32_bf16 v[220:223], a[180:183], a[248:251], v[220:223]
    v_max_f32 v248, v248, v249
    v_mul_f32 v236, s37, v248
    v_mfma_f32_16x16x32_bf16 v[216:219], a[172:175], a[244:247], v[216:219]
    v_fma_f32 v152, v152, s37, -v236
    v_fma_f32 v153, v153, s37, -v236
    v_mfma_f32_16x16x32_bf16 v[216:219], a[184:187], a[248:251], v[216:219]
    v_fma_f32 v154, v154, s37, -v236
    v_fma_f32 v155, v155, s37, -v236
    v_mfma_f32_16x16x32_bf16 v[212:215], a[176:179], a[244:247], v[212:215]
    ds_read_b128 a[244:247], v239 offset:13312
    v_fma_f32 v156, v156, s37, -v236
    v_mfma_f32_16x16x32_bf16 v[212:215], a[188:191], a[248:251], v[212:215]
    s_waitcnt lgkmcnt(3)
    buffer_load_dwordx4 v246, s[4:7], s56 offen lds
    v_mfma_f32_16x16x32_bf16 v[220:223], a[192:195], a[252:255], v[220:223]
    ds_read_b128 a[248:251], v240 offset:13312
    v_cndmask_b32 v246, v245, v243, vcc
    v_mfma_f32_16x16x32_bf16 v[220:223], a[204:207], v[252:255], v[220:223]
    v_exp_f32 v152, v152
    v_mfma_f32_16x16x32_bf16 v[216:219], a[196:199], a[252:255], v[216:219]
    v_exp_f32 v153, v153
    v_mfma_f32_16x16x32_bf16 v[216:219], a[208:211], v[252:255], v[216:219]
    v_exp_f32 v154, v154
    v_mfma_f32_16x16x32_bf16 v[212:215], a[200:203], a[252:255], v[212:215]
    ds_read_b128 a[252:255], v241 offset:12288
    v_cvt_pk_bf16_f32 v176, v152, v153
    v_mfma_f32_16x16x32_bf16 v[212:215], a[212:215], v[252:255], v[212:215]
    s_waitcnt lgkmcnt(3)
    v_cvt_pk_bf16_f32 v132, v220, v221
    v_cvt_pk_bf16_f32 v133, v222, v223
    v_mfma_f32_16x16x32_bf16 v[208:211], a[220:223], a[236:239], 0
    v_cvt_pk_bf16_f32 v134, v216, v217
    v_cvt_pk_bf16_f32 v135, v218, v219
    v_mfma_f32_16x16x32_bf16 v[200:203], a[220:223], a[240:243], 0
    buffer_load_dwordx4 v247, s[4:7], s56 offen offset:1024 lds
    v_mfma_f32_16x16x32_bf16 v[204:207], a[224:227], a[236:239], 0
    v_cvt_pk_bf16_f32 v136, v212, v213
    v_cvt_pk_bf16_f32 v137, v214, v215
    v_mfma_f32_16x16x32_bf16 v[220:223], a[224:227], a[240:243], 0
    ds_read_b128 v[252:255], v241 offset:12800
    ds_read_b128 a[240:243], v242 offset:12800
    v_mfma_f32_16x16x32_bf16 v[216:219], a[228:231], a[236:239], 0
    v_bfrev_b32 v247, 1
    v_fma_f32 v157, v157, s37, -v236
    v_mfma_f32_16x16x32_bf16 v[212:215], a[232:235], a[236:239], 0
    s_waitcnt lgkmcnt(2)
    ds_read_b128 a[236:239], v242 offset:12288
    v_exp_f32 v155, v155
    v_fma_f32 v158, v158, s37, -v236
    v_mfma_f32_16x16x32_bf16 v[208:211], a[252:255], a[244:247], v[208:211]
    v_cvt_pk_bf16_f32 v177, v154, v155
    v_fma_f32 v159, v159, s37, -v236
    v_mfma_f32_16x16x32_bf16 v[200:203], a[252:255], a[248:251], v[200:203]
    s_waitcnt lgkmcnt(2)
    ds_read_b128 a[252:255], v241 offset:24576
    ds_read_b128 v[152:155], v230 offset:640
    v_exp_f32 v156, v156
    v_exp_f32 v157, v157
    v_exp_f32 v158, v158
    v_exp_f32 v159, v159
    v_cvt_pk_bf16_f32 v178, v156, v157
    v_cvt_pk_bf16_f32 v179, v158, v159
    ds_read_b128 v[156:159], v230 offset:1280
    v_mfma_f32_16x16x32_bf16 v[204:207], v[252:255], a[244:247], v[204:207]
    v_fma_f32 v160, v160, s37, -v236
    v_fma_f32 v161, v161, s37, -v236
    v_mfma_f32_16x16x32_bf16 v[196:199], a[216:219], v[176:179], 0
    v_fma_f32 v162, v162, s37, -v236
    v_fma_f32 v163, v163, s37, -v236
    v_mfma_f32_16x16x32_bf16 v[184:187], v[66:69], v[176:179], 0
    v_exp_f32 v160, v160
    v_mfma_f32_16x16x32_bf16 v[188:191], v[88:91], v[176:179], 0
    v_exp_f32 v161, v161
    v_mfma_f32_16x16x32_bf16 v[192:195], v[110:113], v[176:179], 0
    v_exp_f32 v162, v162
    v_mfma_f32_16x16x32_bf16 v[220:223], v[252:255], a[248:251], v[220:223]
    s_waitcnt lgkmcnt(1)
    ds_read_b128 a[248:251], v240 offset:14336
    ds_read_b128 v[252:255], v241 offset:25088
    v_mfma_f32_16x16x32_bf16 v[152:155], v[24:27], v[138:141], v[152:155]
    v_exp_f32 v163, v163
    v_mfma_f32_16x16x32_bf16 v[216:219], a[236:239], a[244:247], v[216:219]
    ds_read_b128 a[236:239], v242 offset:24576
    v_cvt_pk_bf16_f32 v180, v160, v161
    v_mfma_f32_16x16x32_bf16 v[212:215], a[240:243], a[244:247], v[212:215]
    ds_read_b128 a[244:247], v239 offset:14336
    ds_read_b128 a[240:243], v242 offset:25088
    v_mfma_f32_16x16x16_bf16 v[152:155], v[28:29], v[142:143], v[152:155]
    s_waitcnt lgkmcnt(5)
    v_cvt_pk_bf16_f32 v181, v162, v163
    v_fma_f32 v164, v164, s37, -v236
    v_mfma_f32_16x16x32_bf16 v[156:159], v[30:33], v[138:141], v[156:159]
    ds_read_b128 v[160:163], v230 offset:1920
    v_fma_f32 v165, v165, s37, -v236
    v_fma_f32 v166, v166, s37, -v236
    v_fma_f32 v167, v167, s37, -v236
    v_exp_f32 v164, v164
    v_exp_f32 v165, v165
    v_mfma_f32_16x16x16_bf16 v[156:159], v[34:35], v[142:143], v[156:159]
    s_waitcnt lgkmcnt(5)
    v_exp_f32 v166, v166
    v_mfma_f32_16x16x32_bf16 v[200:203], a[252:255], a[248:251], v[200:203]
    s_waitcnt lgkmcnt(4)
    v_exp_f32 v167, v167
    v_mfma_f32_16x16x32_bf16 v[220:223], v[252:255], a[248:251], v[220:223]
    s_waitcnt lgkmcnt(2)
    ds_read_b128 a[248:251], v240 offset:15360
    v_cvt_pk_bf16_f32 v182, v164, v165
    v_cvt_pk_bf16_f32 v183, v166, v167
    ds_read_b128 v[164:167], v230 offset:2560
    v_mfma_f32_16x16x32_bf16 v[208:211], a[252:255], a[244:247], v[208:211]
    ds_read_b128 a[252:255], v241 offset:36864
    v_fma_f32 v168, v168, s37, -v236
    v_mfma_f32_16x16x32_bf16 v[196:199], a[216:219], v[180:183], v[196:199]
    v_fma_f32 v169, v169, s37, -v236
    v_fma_f32 v170, v170, s37, -v236
    v_mfma_f32_16x16x32_bf16 v[184:187], v[70:73], v[180:183], v[184:187]
    v_fma_f32 v171, v171, s37, -v236
    v_fma_f32 v172, v172, s37, -v236
    v_mfma_f32_16x16x32_bf16 v[188:191], v[92:95], v[180:183], v[188:191]
    v_exp_f32 v168, v168
    v_mfma_f32_16x16x32_bf16 v[192:195], v[114:117], v[180:183], v[192:195]
    s_waitcnt lgkmcnt(3)
    v_exp_f32 v169, v169
    v_mfma_f32_16x16x32_bf16 v[160:163], v[36:39], v[138:141], v[160:163]
    v_exp_f32 v170, v170
    v_mfma_f32_16x16x32_bf16 v[204:207], v[252:255], a[244:247], v[204:207]
    ds_read_b128 v[252:255], v241 offset:37376
    v_cvt_pk_bf16_f32 v176, v168, v169
    v_mfma_f32_16x16x32_bf16 v[216:219], a[236:239], a[244:247], v[216:219]
    ds_read_b128 a[236:239], v242 offset:36864
    v_fma_f32 v173, v173, s37, -v236
    v_mfma_f32_16x16x16_bf16 v[160:163], v[40:41], v[142:143], v[160:163]
    s_waitcnt lgkmcnt(3)
    v_exp_f32 v171, v171
    v_mfma_f32_16x16x32_bf16 v[164:167], v[42:45], v[138:141], v[164:167]
    v_cvt_pk_bf16_f32 v177, v170, v171
    v_fma_f32 v174, v174, s37, -v236
    v_mfma_f32_16x16x32_bf16 v[212:215], a[240:243], a[244:247], v[212:215]
    s_waitcnt lgkmcnt(2)
    ds_read_b128 a[244:247], v239 offset:15360
    ds_read_b128 a[240:243], v242 offset:37376
    v_mfma_f32_16x16x32_bf16 v[200:203], a[252:255], a[248:251], v[200:203]
    ds_read_b128 v[168:171], v235
    v_bfe_u32 v235, s72, v233, 4
    v_mfma_f32_16x16x16_bf16 v[164:167], v[46:47], v[142:143], v[164:167]
    s_waitcnt lgkmcnt(4)
    v_mad_u32_u24 v235, v235, s40, v231
    v_fma_f32 v175, v175, s37, -v236
    v_exp_f32 v172, v172
    v_exp_f32 v173, v173
    v_exp_f32 v174, v174
    v_mfma_f32_16x16x32_bf16 v[220:223], v[252:255], a[248:251], v[220:223]
    ds_read_b128 a[248:251], v240 offset:16384
    v_exp_f32 v175, v175
    v_cvt_pk_bf16_f32 v178, v172, v173
    v_cvt_pk_bf16_f32 v179, v174, v175
    ds_read_b128 v[172:175], v250
    v_bfe_u32 v250, s71, v233, 4
    v_mfma_f32_16x16x32_bf16 v[196:199], a[216:219], v[176:179], v[196:199]
    v_mad_u32_u24 v250, v250, s40, v231
    v_fma_f32 v144, v144, s37, -v236
    v_mfma_f32_16x16x32_bf16 v[184:187], v[74:77], v[176:179], v[184:187]
    v_fma_f32 v145, v145, s37, -v236
    v_fma_f32 v146, v146, s37, -v236
    v_mfma_f32_16x16x32_bf16 v[188:191], v[96:99], v[176:179], v[188:191]
    v_fma_f32 v147, v147, s37, -v236
    v_fma_f32 v148, v148, s37, -v236
    v_mfma_f32_16x16x32_bf16 v[192:195], v[118:121], v[176:179], v[192:195]
    s_waitcnt lgkmcnt(2)
    v_exp_f32 v144, v144
    v_mfma_f32_16x16x32_bf16 v[168:171], v[60:63], v[138:141], v[168:171]
    v_exp_f32 v145, v145
    v_mfma_f32_16x16x32_bf16 v[208:211], a[252:255], a[244:247], v[208:211]
    ds_read_b128 a[252:255], v241 offset:49152
    v_cvt_pk_bf16_f32 v180, v144, v145
    v_mfma_f32_16x16x32_bf16 v[204:207], v[252:255], a[244:247], v[204:207]
    ds_read_b128 v[252:255], v241 offset:49664
    v_fma_f32 v149, v149, s37, -v236
    v_mfma_f32_16x16x16_bf16 v[168:171], v[64:65], v[142:143], v[168:171]
    s_waitcnt lgkmcnt(2)
    v_exp_f32 v146, v146
    v_mfma_f32_16x16x32_bf16 v[172:175], v[48:51], v[138:141], v[172:175]
    v_exp_f32 v147, v147
    v_mfma_f32_16x16x32_bf16 v[216:219], a[236:239], a[244:247], v[216:219]
    ds_read_b128 a[236:239], v242 offset:49152
    v_cvt_pk_bf16_f32 v181, v146, v147
    v_mfma_f32_16x16x32_bf16 v[212:215], a[240:243], a[244:247], v[212:215]
    ds_read_b128 a[244:247], v239 offset:16384
    ds_read_b128 a[240:243], v242 offset:49664
    v_mfma_f32_16x16x16_bf16 v[172:175], v[52:53], v[142:143], v[172:175]
    s_waitcnt lgkmcnt(4)
    ds_read_b128 v[144:147], v229 offset:640
    v_fma_f32 v150, v150, s37, -v236
    v_fma_f32 v151, v151, s37, -v236
    v_exp_f32 v148, v148
    v_exp_f32 v149, v149
    v_exp_f32 v150, v150
    v_mfma_f32_16x16x32_bf16 v[200:203], a[252:255], a[248:251], v[200:203]
    s_waitcnt lgkmcnt(4)
    v_exp_f32 v151, v151
    v_mfma_f32_16x16x32_bf16 v[220:223], v[252:255], a[248:251], v[220:223]
    ds_read_b128 a[248:251], v240 offset:17408
    v_cvt_pk_bf16_f32 v182, v148, v149
    v_cvt_pk_bf16_f32 v183, v150, v151
    ds_read_b128 v[148:151], v228 offset:640
    v_max3_f32 v248, v152, v153, v154
    v_mfma_f32_16x16x32_bf16 v[196:199], a[216:219], v[180:183], v[196:199]
    v_max3_f32 v249, v155, v156, v157
    v_max3_f32 v248, v248, v158, v159
    v_mfma_f32_16x16x32_bf16 v[184:187], v[78:81], v[180:183], v[184:187]
    v_max3_f32 v249, v249, v160, v161
    v_max3_f32 v248, v248, v162, v163
    v_mfma_f32_16x16x32_bf16 v[188:191], v[100:103], v[180:183], v[188:191]
    v_max3_f32 v249, v249, v164, v165
    v_max3_f32 v248, v248, v166, v167
    v_mfma_f32_16x16x32_bf16 v[192:195], v[122:125], v[180:183], v[192:195]
    s_waitcnt lgkmcnt(2)
    v_rcp_f32 v197, v196
    v_mfma_f32_16x16x32_bf16 v[144:147], v[30:33], v[132:135], v[144:147]
    v_mul_f32 v184, v184, v197
    v_mul_f32 v185, v185, v197
    v_mfma_f32_16x16x32_bf16 v[208:211], a[252:255], a[244:247], v[208:211]
    ds_read_b128 a[252:255], v241 offset:61440
    v_cvt_pk_bf16_f32 v184, v184, v185
    v_mfma_f32_16x16x32_bf16 v[204:207], v[252:255], a[244:247], v[204:207]
    ds_read_b128 v[252:255], v241 offset:61952
    v_mul_f32 v186, v186, v197
    v_mfma_f32_16x16x16_bf16 v[144:147], v[34:35], v[136:137], v[144:147]
    s_waitcnt lgkmcnt(2)
    v_mul_f32 v187, v187, v197
    v_cvt_pk_bf16_f32 v185, v186, v187
    v_mfma_f32_16x16x32_bf16 v[148:151], v[6:9], v[132:135], v[148:151]
    v_mul_f32 v188, v188, v197
    v_mul_f32 v189, v189, v197
    v_mfma_f32_16x16x32_bf16 v[216:219], a[236:239], a[244:247], v[216:219]
    ds_read_b128 a[236:239], v242 offset:61440
    v_cvt_pk_bf16_f32 v186, v188, v189
    v_mfma_f32_16x16x32_bf16 v[212:215], a[240:243], a[244:247], v[212:215]
    ds_read_b128 a[244:247], v239 offset:17408
    ds_read_b128 a[240:243], v242 offset:61952
    v_mfma_f32_16x16x16_bf16 v[148:151], v[10:11], v[136:137], v[148:151]
    s_waitcnt lgkmcnt(4)
    v_mul_f32 v190, v190, v197
    v_mul_f32 v191, v191, v197
    v_cvt_pk_bf16_f32 v187, v190, v191
    v_mul_f32 v192, v192, v197
    v_mul_f32 v193, v193, v197
    v_cvt_pk_bf16_f32 v188, v192, v193
    v_mul_f32 v194, v194, v197
    v_mul_f32 v195, v195, v197
    v_mfma_f32_16x16x32_bf16 v[200:203], a[252:255], a[248:251], v[200:203]
    s_waitcnt lgkmcnt(3)
    v_cvt_pk_bf16_f32 v189, v194, v195
    v_max3_f32 v249, v249, v168, v169
    v_mfma_f32_16x16x32_bf16 v[220:223], v[252:255], a[248:251], v[220:223]
    s_waitcnt lgkmcnt(1)
    ds_read_b128 a[248:251], v224 offset:64
    ds_write_b128 v237, v[184:187]
    ds_write_b64 v238, v[188:189]
    v_max3_f32 v248, v248, v170, v171
    v_max3_f32 v249, v249, v172, v173
    v_cvt_pk_bf16_f32 v200, v200, v201
    v_cvt_pk_bf16_f32 v201, v202, v203
    v_max3_f32 v248, v248, v174, v175
    v_mfma_f32_16x16x32_bf16 v[208:211], a[252:255], a[244:247], v[208:211]
    v_cvt_pk_bf16_f32 v202, v220, v221
    v_cvt_pk_bf16_f32 v203, v222, v223
    v_mfma_f32_16x16x32_bf16 v[204:207], v[252:255], a[244:247], v[204:207]
    buffer_store_dwordx4 v[200:203], v245, s[20:23], s51 offen sc0 sc1
    v_mfma_f32_16x16x32_bf16 v[216:219], a[236:239], a[244:247], v[216:219]
    s_waitcnt lgkmcnt(3)
    ds_read_b128 a[252:255], v224 offset:128
    ds_read_b128 v[252:255], v224 offset:192
    v_mfma_f32_16x16x32_bf16 v[212:215], a[240:243], a[244:247], v[212:215]
    ds_read_b128 a[244:247], v224
    v_cvt_pk_bf16_f32 v208, v208, v209
    v_cvt_pk_bf16_f32 v209, v210, v211
    v_cvt_pk_bf16_f32 v210, v204, v205
    ds_read_b128 a[236:239], v224 offset:256
    v_cvt_pk_bf16_f32 v211, v206, v207
    ds_read_b128 a[240:243], v224 offset:320
    v_cvt_pk_bf16_f32 v216, v216, v217
    v_cvt_pk_bf16_f32 v217, v218, v219
    v_cvt_pk_bf16_f32 v218, v212, v213
    v_cvt_pk_bf16_f32 v219, v214, v215
    v_max_f32 v248, v248, v249
    v_mov_b32 v249, v248
    s_nop 1
    v_permlane16_swap_b32 v248, v249
    v_max_f32 v248, v248, v249
    v_mov_b32 v249, v248
    s_nop 1
    v_permlane32_swap_b32 v248, v249
    v_max_f32 v248, v248, v249
    v_mul_f32 v236, s37, v248
    v_fma_f32 v152, v152, s37, -v236
    v_fma_f32 v153, v153, s37, -v236
    v_fma_f32 v154, v154, s37, -v236
    v_fma_f32 v155, v155, s37, -v236
    v_exp_f32 v152, v152
    v_exp_f32 v153, v153
    s_waitcnt lgkmcnt(2)
    v_mfma_f32_16x16x32_bf16 v[204:207], a[4:7], a[244:247], 0
    buffer_store_dwordx4 v[208:211], v243, s[20:23], s51 offen sc0 sc1
    v_mfma_f32_16x16x32_bf16 v[204:207], a[16:19], a[248:251], v[204:207]
    v_exp_f32 v154, v154
    v_mfma_f32_16x16x32_bf16 v[208:211], a[0:3], a[244:247], 0
    v_exp_f32 v155, v155
    v_mfma_f32_16x16x32_bf16 v[208:211], a[12:15], a[248:251], v[208:211]
    v_cvt_pk_bf16_f32 v176, v152, v153
    v_cvt_pk_bf16_f32 v177, v154, v155
    v_mfma_f32_16x16x32_bf16 v[200:203], a[8:11], a[244:247], 0
    ds_read_b128 v[152:155], v228 offset:1280
    v_fma_f32 v156, v156, s37, -v236
    v_mfma_f32_16x16x32_bf16 v[200:203], a[20:23], a[248:251], v[200:203]
    v_fma_f32 v157, v157, s37, -v236
    v_fma_f32 v158, v158, s37, -v236
    v_mfma_f32_16x16x32_bf16 v[220:223], a[244:247], a[72:75], 0
    v_fma_f32 v159, v159, s37, -v236
    v_fma_f32 v160, v160, s37, -v236
    v_mfma_f32_16x16x32_bf16 v[220:223], a[248:251], a[84:87], v[220:223]
    v_exp_f32 v156, v156
    v_mfma_f32_16x16x32_bf16 v[212:215], a[244:247], a[80:83], 0
    v_exp_f32 v157, v157
    v_mfma_f32_16x16x32_bf16 v[212:215], a[248:251], a[92:95], v[212:215]
    v_exp_f32 v158, v158
    v_mfma_f32_16x16x32_bf16 v[208:211], a[24:27], a[252:255], v[208:211]
    v_exp_f32 v159, v159
    v_mfma_f32_16x16x32_bf16 v[208:211], a[36:39], v[252:255], v[208:211]
    v_cvt_pk_bf16_f32 v178, v156, v157
    v_cvt_pk_bf16_f32 v179, v158, v159
    v_mfma_f32_16x16x32_bf16 v[204:207], a[28:31], a[252:255], v[204:207]
    buffer_store_dwordx4 v[216:219], v244, s[20:23], s51 offen sc0 sc1
    v_mfma_f32_16x16x32_bf16 v[204:207], a[40:43], v[252:255], v[204:207]
    s_add_u32 s51, s51, s48
    ds_read_b128 v[156:159], v229 offset:1280
    v_fma_f32 v161, v161, s37, -v236
    v_mfma_f32_16x16x32_bf16 v[196:199], a[216:219], v[176:179], 0
    v_fma_f32 v162, v162, s37, -v236
    v_fma_f32 v163, v163, s37, -v236
    v_mfma_f32_16x16x32_bf16 v[184:187], v[68:71], v[176:179], 0
    v_exp_f32 v160, v160
    v_mfma_f32_16x16x32_bf16 v[188:191], v[90:93], v[176:179], 0
    v_exp_f32 v161, v161
    v_mfma_f32_16x16x32_bf16 v[192:195], v[112:115], v[176:179], 0
    s_waitcnt lgkmcnt(1)
    v_exp_f32 v162, v162
    v_mfma_f32_16x16x32_bf16 v[152:155], v[12:15], v[132:135], v[152:155]
    v_exp_f32 v163, v163
    v_mfma_f32_16x16x32_bf16 v[216:219], a[244:247], a[76:79], 0
    ds_read_b128 a[244:247], v224 offset:3072
    v_cvt_pk_bf16_f32 v180, v160, v161
    v_mfma_f32_16x16x32_bf16 v[216:219], a[248:251], a[88:91], v[216:219]
    ds_read_b128 a[248:251], v224 offset:3136
    v_cvt_pk_bf16_f32 v181, v162, v163
    v_mfma_f32_16x16x16_bf16 v[152:155], v[16:17], v[136:137], v[152:155]
    s_waitcnt lgkmcnt(2)
    ds_read_b128 v[160:163], v229 offset:1920
    v_fma_f32 v164, v164, s37, -v236
    v_mfma_f32_16x16x32_bf16 v[156:159], v[36:39], v[132:135], v[156:159]
    v_fma_f32 v165, v165, s37, -v236
    v_fma_f32 v166, v166, s37, -v236
    v_mfma_f32_16x16x32_bf16 v[200:203], a[32:35], a[252:255], v[200:203]
    v_fma_f32 v167, v167, s37, -v236
    v_fma_f32 v168, v168, s37, -v236
    v_mfma_f32_16x16x32_bf16 v[200:203], a[44:47], v[252:255], v[200:203]
    v_exp_f32 v164, v164
    v_mfma_f32_16x16x16_bf16 v[156:159], v[40:41], v[136:137], v[156:159]
    v_exp_f32 v165, v165
    v_mfma_f32_16x16x32_bf16 v[220:223], a[252:255], a[96:99], v[220:223]
    v_exp_f32 v166, v166
    v_mfma_f32_16x16x32_bf16 v[220:223], v[252:255], a[108:111], v[220:223]
    v_exp_f32 v167, v167
    v_mfma_f32_16x16x32_bf16 v[216:219], a[252:255], a[100:103], v[216:219]
    v_cvt_pk_bf16_f32 v182, v164, v165
    v_cvt_pk_bf16_f32 v183, v166, v167
    v_mfma_f32_16x16x32_bf16 v[216:219], v[252:255], a[112:115], v[216:219]
    ds_read_b128 v[164:167], v228 offset:1920
    v_fma_f32 v169, v169, s37, -v236
    v_mfma_f32_16x16x32_bf16 v[196:199], a[216:219], v[180:183], v[196:199]
    v_fma_f32 v170, v170, s37, -v236
    v_fma_f32 v171, v171, s37, -v236
    v_mfma_f32_16x16x32_bf16 v[184:187], v[76:79], v[180:183], v[184:187]
    v_exp_f32 v168, v168
    v_mfma_f32_16x16x32_bf16 v[188:191], v[98:101], v[180:183], v[188:191]
    v_exp_f32 v169, v169
    v_mfma_f32_16x16x32_bf16 v[192:195], v[120:123], v[180:183], v[192:195]
    s_waitcnt lgkmcnt(1)
    v_exp_f32 v170, v170
    v_mfma_f32_16x16x32_bf16 v[160:163], v[42:45], v[132:135], v[160:163]
    v_exp_f32 v171, v171
    v_mfma_f32_16x16x32_bf16 v[212:215], a[252:255], a[104:107], v[212:215]
    ds_read_b128 a[252:255], v224 offset:3200
    v_cvt_pk_bf16_f32 v176, v168, v169
    v_mfma_f32_16x16x32_bf16 v[212:215], v[252:255], a[116:119], v[212:215]
    ds_read_b128 v[252:255], v224 offset:3264
    v_cvt_pk_bf16_f32 v177, v170, v171
    v_mfma_f32_16x16x16_bf16 v[160:163], v[46:47], v[136:137], v[160:163]
    ds_read_b128 v[168:171], v228 offset:2560
    v_fma_f32 v172, v172, s37, -v236
    v_mfma_f32_16x16x16_bf16 v[196:199], a[216:217], v[176:177], v[196:199]
    v_fma_f32 v173, v173, s37, -v236
    v_fma_f32 v174, v174, s37, -v236
    v_mfma_f32_16x16x16_bf16 v[184:187], v[86:87], v[176:177], v[184:187]
    v_fma_f32 v175, v175, s37, -v236
    v_max3_f32 v248, v144, v145, v146
    v_mfma_f32_16x16x16_bf16 v[188:191], v[108:109], v[176:177], v[188:191]
    v_exp_f32 v172, v172
    v_mfma_f32_16x16x16_bf16 v[192:195], v[130:131], v[176:177], v[192:195]
    s_waitcnt lgkmcnt(3)
    v_exp_f32 v173, v173
    v_mfma_f32_16x16x32_bf16 v[164:167], v[18:21], v[132:135], v[164:167]
    v_exp_f32 v174, v174
    v_mfma_f32_16x16x32_bf16 v[208:211], a[48:51], a[236:239], v[208:211]
    v_exp_f32 v175, v175
    v_mfma_f32_16x16x32_bf16 v[208:211], a[60:63], a[240:243], v[208:211]
    v_cvt_pk_bf16_f32 v180, v172, v173
    v_cvt_pk_bf16_f32 v181, v174, v175
    v_mfma_f32_16x16x16_bf16 v[164:167], v[22:23], v[136:137], v[164:167]
    ds_read_b128 v[172:175], v229 offset:2560
    v_max3_f32 v249, v147, v148, v149
    v_mfma_f32_16x16x16_bf16 v[196:199], a[216:217], v[180:181], v[196:199]
    v_max3_f32 v248, v248, v150, v151
    v_max3_f32 v249, v249, v152, v153
    v_mfma_f32_16x16x16_bf16 v[184:187], v[82:83], v[180:181], v[184:187]
    v_cvt_pk_bf16_f32 v0, v208, v209
    v_cvt_pk_bf16_f32 v1, v210, v211
    v_mfma_f32_16x16x16_bf16 v[188:191], v[104:105], v[180:181], v[188:191]
    v_max3_f32 v248, v248, v154, v155
    v_max3_f32 v249, v249, v156, v157
    v_mfma_f32_16x16x16_bf16 v[192:195], v[126:127], v[180:181], v[192:195]
    v_rcp_f32 v197, v196
    v_mfma_f32_16x16x32_bf16 v[204:207], a[52:55], a[236:239], v[204:207]
    v_mul_f32 v184, v184, v197
    v_mul_f32 v185, v185, v197
    v_mfma_f32_16x16x32_bf16 v[204:207], a[64:67], a[240:243], v[204:207]
    v_cvt_pk_bf16_f32 v184, v184, v185
    v_mul_f32 v186, v186, v197
    v_mfma_f32_16x16x32_bf16 v[200:203], a[56:59], a[236:239], v[200:203]
    v_mul_f32 v187, v187, v197
    v_cvt_pk_bf16_f32 v185, v186, v187
    v_mfma_f32_16x16x32_bf16 v[200:203], a[68:71], a[240:243], v[200:203]
    v_mul_f32 v188, v188, v197
    v_mul_f32 v189, v189, v197
    v_mfma_f32_16x16x32_bf16 v[220:223], a[236:239], a[120:123], v[220:223]
    v_cvt_pk_bf16_f32 v2, v204, v205
    v_cvt_pk_bf16_f32 v3, v206, v207
    v_mfma_f32_16x16x32_bf16 v[220:223], a[240:243], a[132:135], v[220:223]
    s_waitcnt lgkmcnt(0)
    v_cvt_pk_bf16_f32 v186, v188, v189
    v_mul_f32 v190, v190, v197
    v_mfma_f32_16x16x32_bf16 v[168:171], v[0:3], v[132:135], v[168:171]
    v_cvt_pk_bf16_f32 v4, v200, v201
    v_cvt_pk_bf16_f32 v5, v202, v203
    v_mfma_f32_16x16x32_bf16 v[216:219], a[236:239], a[124:127], v[216:219]
    v_mul_f32 v191, v191, v197
    v_cvt_pk_bf16_f32 v187, v190, v191
    v_mfma_f32_16x16x32_bf16 v[216:219], a[240:243], a[136:139], v[216:219]
    v_cvt_pk_bf16_f32 v66, v220, v221
    v_cvt_pk_bf16_f32 v67, v222, v223
    v_mfma_f32_16x16x16_bf16 v[168:171], v[4:5], v[136:137], v[168:171]
    v_mul_f32 v192, v192, v197
    v_mul_f32 v193, v193, v197
    v_mfma_f32_16x16x32_bf16 v[212:215], a[236:239], a[128:131], v[212:215]
    ds_read_b128 a[236:239], v224 offset:3328
    v_cvt_pk_bf16_f32 v188, v192, v193
    v_mfma_f32_16x16x32_bf16 v[212:215], a[240:243], a[140:143], v[212:215]
    v_cvt_pk_bf16_f32 v88, v216, v217
    v_cvt_pk_bf16_f32 v89, v218, v219
    v_mfma_f32_16x16x32_bf16 v[208:211], a[0:3], a[244:247], 0
    ds_read_b128 a[240:243], v224 offset:3392
    v_mul_f32 v194, v194, v197
    v_mfma_f32_16x16x32_bf16 v[208:211], a[12:15], a[248:251], v[208:211]
    v_mul_f32 v195, v195, v197
    v_cvt_pk_bf16_f32 v189, v194, v195
    v_mfma_f32_16x16x32_bf16 v[204:207], a[4:7], a[244:247], 0
    v_cvt_pk_bf16_f32 v110, v212, v213
    v_cvt_pk_bf16_f32 v111, v214, v215
    v_mfma_f32_16x16x32_bf16 v[204:207], a[16:19], a[248:251], v[204:207]
    ds_write_b128 v237, v[184:187] offset:6144
    v_mfma_f32_16x16x32_bf16 v[200:203], a[8:11], a[244:247], 0
    ds_write_b64 v238, v[188:189] offset:6144
    v_mfma_f32_16x16x32_bf16 v[200:203], a[20:23], a[248:251], v[200:203]
    v_max3_f32 v248, v248, v158, v159
    v_max3_f32 v249, v249, v160, v161
    v_mfma_f32_16x16x32_bf16 v[220:223], a[244:247], a[72:75], 0
    v_max3_f32 v248, v248, v162, v163
    v_max3_f32 v249, v249, v164, v165
    v_mfma_f32_16x16x32_bf16 v[220:223], a[248:251], a[84:87], v[220:223]
    v_max3_f32 v248, v248, v166, v167
    v_max3_f32 v249, v249, v168, v169
    v_mfma_f32_16x16x32_bf16 v[216:219], a[244:247], a[76:79], 0
    v_max3_f32 v248, v248, v170, v171
    v_mfma_f32_16x16x32_bf16 v[216:219], a[248:251], a[88:91], v[216:219]
    v_mfma_f32_16x16x32_bf16 v[212:215], a[244:247], a[80:83], 0
    ds_read_b128 a[244:247], v225 offset:42944
    v_mfma_f32_16x16x32_bf16 v[212:215], a[248:251], a[92:95], v[212:215]
    ds_read_b128 a[248:251], v225 offset:43008
    v_mfma_f32_16x16x32_bf16 v[208:211], a[24:27], a[252:255], v[208:211]
    v_mfma_f32_16x16x32_bf16 v[208:211], a[36:39], v[252:255], v[208:211]
    v_mfma_f32_16x16x32_bf16 v[204:207], a[28:31], a[252:255], v[204:207]
    s_waitcnt vmcnt(3) lgkmcnt(2)
    v_mfma_f32_16x16x32_bf16 v[204:207], a[40:43], v[252:255], v[204:207]
    s_barrier
    v_mfma_f32_16x16x32_bf16 v[200:203], a[32:35], a[252:255], v[200:203]
    v_mfma_f32_16x16x32_bf16 v[200:203], a[44:47], v[252:255], v[200:203]
    v_mfma_f32_16x16x32_bf16 v[220:223], a[252:255], a[96:99], v[220:223]
    v_mfma_f32_16x16x32_bf16 v[220:223], v[252:255], a[108:111], v[220:223]
    v_mfma_f32_16x16x32_bf16 v[216:219], a[252:255], a[100:103], v[216:219]
    v_mfma_f32_16x16x32_bf16 v[216:219], v[252:255], a[112:115], v[216:219]
    v_mfma_f32_16x16x32_bf16 v[212:215], a[252:255], a[104:107], v[212:215]
    ds_read_b128 a[252:255], v225 offset:43072
    v_mfma_f32_16x16x32_bf16 v[212:215], v[252:255], a[116:119], v[212:215]
    ds_read_b128 v[252:255], v225 offset:43136
    v_mfma_f32_16x16x32_bf16 v[208:211], a[48:51], a[236:239], v[208:211]
    v_mfma_f32_16x16x32_bf16 v[208:211], a[60:63], a[240:243], v[208:211]
    v_mfma_f32_16x16x32_bf16 v[204:207], a[52:55], a[236:239], v[204:207]
    v_mfma_f32_16x16x32_bf16 v[204:207], a[64:67], a[240:243], v[204:207]
    v_mfma_f32_16x16x32_bf16 v[200:203], a[56:59], a[236:239], v[200:203]
    v_mfma_f32_16x16x32_bf16 v[200:203], a[68:71], a[240:243], v[200:203]
    v_mfma_f32_16x16x32_bf16 v[220:223], a[236:239], a[120:123], v[220:223]
    v_mfma_f32_16x16x32_bf16 v[220:223], a[240:243], a[132:135], v[220:223]
    v_mfma_f32_16x16x32_bf16 v[216:219], a[236:239], a[124:127], v[216:219]
    v_mfma_f32_16x16x32_bf16 v[216:219], a[240:243], a[136:139], v[216:219]
    v_cvt_pk_bf16_f32 v24, v208, v209
    v_cvt_pk_bf16_f32 v25, v210, v211
    v_mfma_f32_16x16x32_bf16 v[212:215], a[236:239], a[128:131], v[212:215]
    v_cvt_pk_bf16_f32 v26, v204, v205
    v_cvt_pk_bf16_f32 v27, v206, v207
    v_mfma_f32_16x16x32_bf16 v[212:215], a[240:243], a[140:143], v[212:215]
    v_cvt_pk_bf16_f32 v28, v200, v201
    v_cvt_pk_bf16_f32 v29, v202, v203
    v_mfma_f32_16x16x32_bf16 v[172:175], v[24:27], v[132:135], v[172:175]
    s_waitcnt lgkmcnt(0)
    v_cvt_pk_bf16_f32 v68, v220, v221
    v_cvt_pk_bf16_f32 v69, v222, v223
    v_mfma_f32_16x16x32_bf16 v[208:211], a[144:147], a[244:247], 0
    v_cvt_pk_bf16_f32 v90, v216, v217
    v_cvt_pk_bf16_f32 v91, v218, v219
    v_mfma_f32_16x16x32_bf16 v[208:211], a[156:159], a[248:251], v[208:211]
    v_cvt_pk_bf16_f32 v112, v212, v213
    v_cvt_pk_bf16_f32 v113, v214, v215
    v_mfma_f32_16x16x16_bf16 v[172:175], v[28:29], v[136:137], v[172:175]
    ds_read_b128 a[236:239], v225 offset:43200
    ds_read_b128 a[240:243], v225 offset:43264
    v_mfma_f32_16x16x32_bf16 v[204:207], a[148:151], a[244:247], 0
    v_cndmask_b32 v225, v243, v245, vcc
    v_mfma_f32_16x16x32_bf16 v[204:207], a[160:163], a[248:251], v[204:207]
    v_mfma_f32_16x16x32_bf16 v[200:203], a[152:155], a[244:247], 0
    ds_read_b128 a[244:247], v226 offset:1152
    v_mfma_f32_16x16x32_bf16 v[200:203], a[164:167], a[248:251], v[200:203]
    ds_read_b128 a[248:251], v226 offset:1216
    v_max3_f32 v249, v249, v172, v173
    v_mfma_f32_16x16x32_bf16 v[208:211], a[168:171], a[252:255], v[208:211]
    v_max3_f32 v248, v248, v174, v175
    v_max_f32 v248, v248, v249
    v_mfma_f32_16x16x32_bf16 v[208:211], a[180:183], v[252:255], v[208:211]
    v_mov_b32 v249, v248
    v_mfma_f32_16x16x32_bf16 v[204:207], a[172:175], a[252:255], v[204:207]
    v_mfma_f32_16x16x32_bf16 v[204:207], a[184:187], v[252:255], v[204:207]
    v_permlane16_swap_b32 v248, v249
    v_mfma_f32_16x16x32_bf16 v[200:203], a[176:179], a[252:255], v[200:203]
    ds_read_b128 a[252:255], v226 offset:1280
    v_max_f32 v248, v248, v249
    v_mfma_f32_16x16x32_bf16 v[200:203], a[188:191], v[252:255], v[200:203]
    s_waitcnt lgkmcnt(4)
    ds_read_b128 v[252:255], v226 offset:1344
    v_mov_b32 v249, v248
    v_mfma_f32_16x16x32_bf16 v[208:211], a[192:195], a[236:239], v[208:211]
    s_waitcnt lgkmcnt(4)
    v_mfma_f32_16x16x32_bf16 v[208:211], a[204:207], a[240:243], v[208:211]
    v_permlane32_swap_b32 v248, v249
    v_mfma_f32_16x16x32_bf16 v[204:207], a[196:199], a[236:239], v[204:207]
    v_max_f32 v248, v248, v249
    v_mul_f32 v236, s37, v248
    v_mfma_f32_16x16x32_bf16 v[204:207], a[208:211], a[240:243], v[204:207]
    v_fma_f32 v144, v144, s37, -v236
    v_fma_f32 v145, v145, s37, -v236
    v_mfma_f32_16x16x32_bf16 v[200:203], a[200:203], a[236:239], v[200:203]
    v_cvt_pk_bf16_f32 v138, v208, v209
    v_cvt_pk_bf16_f32 v139, v210, v211
    v_mfma_f32_16x16x32_bf16 v[200:203], a[212:215], a[240:243], v[200:203]
    s_waitcnt lgkmcnt(2)
    ds_read_b128 a[236:239], v226 offset:1408
    ds_read_b128 a[240:243], v226 offset:1472
    v_mfma_f32_16x16x32_bf16 v[220:223], a[144:147], a[244:247], 0
    v_cvt_pk_bf16_f32 v140, v204, v205
    v_cvt_pk_bf16_f32 v141, v206, v207
    v_mfma_f32_16x16x32_bf16 v[220:223], a[156:159], a[248:251], v[220:223]
    v_fma_f32 v146, v146, s37, -v236
    v_fma_f32 v147, v147, s37, -v236
    v_mfma_f32_16x16x32_bf16 v[216:219], a[148:151], a[244:247], 0
    v_cvt_pk_bf16_f32 v142, v200, v201
    v_cvt_pk_bf16_f32 v143, v202, v203
    v_mfma_f32_16x16x32_bf16 v[216:219], a[160:163], a[248:251], v[216:219]
    v_exp_f32 v144, v144
    v_mfma_f32_16x16x32_bf16 v[212:215], a[152:155], a[244:247], 0
    ds_read_b128 a[244:247], v227 offset:6144
    v_fma_f32 v148, v148, s37, -v236
    v_mfma_f32_16x16x32_bf16 v[212:215], a[164:167], a[248:251], v[212:215]
    s_waitcnt lgkmcnt(3)
    ds_read_b128 a[248:251], v227 offset:6208
    v_fma_f32 v149, v149, s37, -v236
    v_mfma_f32_16x16x32_bf16 v[220:223], a[168:171], a[252:255], v[220:223]
    v_exp_f32 v145, v145
    v_mfma_f32_16x16x32_bf16 v[220:223], a[180:183], v[252:255], v[220:223]
    v_exp_f32 v146, v146
    v_mfma_f32_16x16x32_bf16 v[216:219], a[172:175], a[252:255], v[216:219]
    v_exp_f32 v147, v147
    v_mfma_f32_16x16x32_bf16 v[216:219], a[184:187], v[252:255], v[216:219]
    v_cvt_pk_bf16_f32 v176, v144, v145
    v_cvt_pk_bf16_f32 v177, v146, v147
    v_mfma_f32_16x16x32_bf16 v[212:215], a[176:179], a[252:255], v[212:215]
    ds_read_b128 a[252:255], v227 offset:6272
    ds_read_b128 v[144:147], v230 offset:2560
    v_mfma_f32_16x16x32_bf16 v[212:215], a[188:191], v[252:255], v[212:215]
    s_waitcnt lgkmcnt(4)
    v_fma_f32 v150, v150, s37, -v236
    v_fma_f32 v151, v151, s37, -v236
    v_mfma_f32_16x16x32_bf16 v[220:223], a[192:195], a[236:239], v[220:223]
    ds_read_b128 v[252:255], v227 offset:6336
    v_fma_f32 v152, v152, s37, -v236
    v_mfma_f32_16x16x32_bf16 v[220:223], a[204:207], a[240:243], v[220:223]
    v_exp_f32 v148, v148
    v_mfma_f32_16x16x32_bf16 v[216:219], a[196:199], a[236:239], v[216:219]
    v_exp_f32 v149, v149
    v_mfma_f32_16x16x32_bf16 v[216:219], a[208:211], a[240:243], v[216:219]
    v_exp_f32 v150, v150
    v_mfma_f32_16x16x32_bf16 v[212:215], a[200:203], a[236:239], v[212:215]
    ds_read_b128 a[236:239], v227 offset:6400
    v_cvt_pk_bf16_f32 v178, v148, v149
    v_mfma_f32_16x16x32_bf16 v[212:215], a[212:215], a[240:243], v[212:215]
    s_waitcnt lgkmcnt(4)
    v_cvt_pk_bf16_f32 v132, v220, v221
    v_cvt_pk_bf16_f32 v133, v222, v223
    v_mfma_f32_16x16x32_bf16 v[208:211], a[0:3], a[244:247], 0
    v_cvt_pk_bf16_f32 v134, v216, v217
    v_cvt_pk_bf16_f32 v135, v218, v219
    v_mfma_f32_16x16x32_bf16 v[208:211], a[12:15], a[248:251], v[208:211]
    s_waitcnt lgkmcnt(2)
    ds_read_b128 a[240:243], v227 offset:6464
    v_cndmask_b32 v227, v240, v239, vcc
    v_mfma_f32_16x16x32_bf16 v[144:147], v[24:27], v[138:141], v[144:147]
    v_cvt_pk_bf16_f32 v136, v212, v213
    v_cvt_pk_bf16_f32 v137, v214, v215
    v_mfma_f32_16x16x32_bf16 v[204:207], a[4:7], a[244:247], 0
    v_exp_f32 v151, v151
    v_mfma_f32_16x16x32_bf16 v[204:207], a[16:19], a[248:251], v[204:207]
    v_cvt_pk_bf16_f32 v179, v150, v151
    v_fma_f32 v153, v153, s37, -v236
    v_mfma_f32_16x16x16_bf16 v[144:147], v[28:29], v[142:143], v[144:147]
    ds_read_b128 v[148:151], v230 offset:640
    v_fma_f32 v154, v154, s37, -v236
    v_mfma_f32_16x16x32_bf16 v[196:199], a[216:219], v[176:179], 0
    v_fma_f32 v155, v155, s37, -v236
    v_fma_f32 v156, v156, s37, -v236
    v_mfma_f32_16x16x32_bf16 v[184:187], v[70:73], v[176:179], 0
    v_exp_f32 v152, v152
    v_mfma_f32_16x16x32_bf16 v[188:191], v[92:95], v[176:179], 0
    v_exp_f32 v153, v153
    v_mfma_f32_16x16x32_bf16 v[192:195], v[114:117], v[176:179], 0
    v_exp_f32 v154, v154
    v_mfma_f32_16x16x32_bf16 v[200:203], a[8:11], a[244:247], 0
    v_exp_f32 v155, v155
    v_mfma_f32_16x16x32_bf16 v[200:203], a[20:23], a[248:251], v[200:203]
    v_cvt_pk_bf16_f32 v180, v152, v153
    v_cvt_pk_bf16_f32 v181, v154, v155
    v_mfma_f32_16x16x32_bf16 v[220:223], a[244:247], a[72:75], 0
    ds_read_b128 v[152:155], v230 offset:1280
    v_fma_f32 v157, v157, s37, -v236
    v_mfma_f32_16x16x32_bf16 v[220:223], a[248:251], a[84:87], v[220:223]
    s_waitcnt lgkmcnt(1)
    v_fma_f32 v158, v158, s37, -v236
    v_fma_f32 v159, v159, s37, -v236
    v_mfma_f32_16x16x32_bf16 v[148:151], v[30:33], v[138:141], v[148:151]
    v_exp_f32 v156, v156
    v_mfma_f32_16x16x32_bf16 v[216:219], a[244:247], a[76:79], 0
    v_exp_f32 v157, v157
    v_mfma_f32_16x16x32_bf16 v[216:219], a[248:251], a[88:91], v[216:219]
    v_exp_f32 v158, v158
    v_mfma_f32_16x16x32_bf16 v[212:215], a[244:247], a[80:83], 0
    ds_read_b128 a[244:247], v239
    v_cvt_pk_bf16_f32 v182, v156, v157
    v_mfma_f32_16x16x32_bf16 v[212:215], a[248:251], a[92:95], v[212:215]
    ds_read_b128 a[248:251], v240
    v_fma_f32 v160, v160, s37, -v236
    v_mfma_f32_16x16x16_bf16 v[148:151], v[34:35], v[142:143], v[148:151]
    v_exp_f32 v159, v159
    v_mfma_f32_16x16x32_bf16 v[208:211], a[24:27], a[252:255], v[208:211]
    v_cvt_pk_bf16_f32 v183, v158, v159
    v_fma_f32 v161, v161, s37, -v236
    v_mfma_f32_16x16x32_bf16 v[208:211], a[36:39], v[252:255], v[208:211]
    ds_read_b128 v[156:159], v230 offset:1920
    v_fma_f32 v162, v162, s37, -v236
    v_mfma_f32_16x16x32_bf16 v[196:199], a[216:219], v[180:183], v[196:199]
    v_fma_f32 v163, v163, s37, -v236
    v_fma_f32 v164, v164, s37, -v236
    v_mfma_f32_16x16x32_bf16 v[184:187], v[74:77], v[180:183], v[184:187]
    v_exp_f32 v160, v160
    v_mfma_f32_16x16x32_bf16 v[188:191], v[96:99], v[180:183], v[188:191]
    v_exp_f32 v161, v161
    v_mfma_f32_16x16x32_bf16 v[192:195], v[118:121], v[180:183], v[192:195]
    s_waitcnt lgkmcnt(3)
    v_exp_f32 v162, v162
    v_mfma_f32_16x16x32_bf16 v[152:155], v[36:39], v[138:141], v[152:155]
    v_exp_f32 v163, v163
    v_mfma_f32_16x16x32_bf16 v[204:207], a[28:31], a[252:255], v[204:207]
    v_cvt_pk_bf16_f32 v176, v160, v161
    v_cvt_pk_bf16_f32 v177, v162, v163
    v_mfma_f32_16x16x32_bf16 v[204:207], a[40:43], v[252:255], v[204:207]
    ds_read_b128 v[160:163], v234
    v_bfe_u32 v234, s69, v233, 4
    v_mfma_f32_16x16x16_bf16 v[152:155], v[40:41], v[142:143], v[152:155]
    s_waitcnt lgkmcnt(1)
    v_mad_u32_u24 v234, v234, s40, v231
    v_fma_f32 v165, v165, s37, -v236
    v_mfma_f32_16x16x32_bf16 v[156:159], v[42:45], v[138:141], v[156:159]
    v_fma_f32 v166, v166, s37, -v236
    v_fma_f32 v167, v167, s37, -v236
    v_mfma_f32_16x16x32_bf16 v[200:203], a[32:35], a[252:255], v[200:203]
    v_exp_f32 v164, v164
    v_mfma_f32_16x16x32_bf16 v[200:203], a[44:47], v[252:255], v[200:203]
    v_exp_f32 v165, v165
    v_mfma_f32_16x16x16_bf16 v[156:159], v[46:47], v[142:143], v[156:159]
    v_exp_f32 v166, v166
    v_mfma_f32_16x16x32_bf16 v[220:223], a[252:255], a[96:99], v[220:223]
    v_exp_f32 v167, v167
    v_mfma_f32_16x16x32_bf16 v[220:223], v[252:255], a[108:111], v[220:223]
    v_cvt_pk_bf16_f32 v178, v164, v165
    v_cvt_pk_bf16_f32 v179, v166, v167
    v_mfma_f32_16x16x32_bf16 v[216:219], a[252:255], a[100:103], v[216:219]
    ds_read_b128 v[164:167], v235
    v_bfe_u32 v235, s70, v233, 4
    v_mfma_f32_16x16x32_bf16 v[216:219], v[252:255], a[112:115], v[216:219]
    v_mad_u32_u24 v235, v235, s40, v231
    v_fma_f32 v168, v168, s37, -v236
    v_mfma_f32_16x16x32_bf16 v[196:199], a[216:219], v[176:179], v[196:199]
    v_fma_f32 v169, v169, s37, -v236
    v_fma_f32 v170, v170, s37, -v236
    v_mfma_f32_16x16x32_bf16 v[184:187], v[78:81], v[176:179], v[184:187]
    v_fma_f32 v171, v171, s37, -v236
    v_fma_f32 v172, v172, s37, -v236
    v_mfma_f32_16x16x32_bf16 v[188:191], v[100:103], v[176:179], v[188:191]
    v_exp_f32 v168, v168
    v_mfma_f32_16x16x32_bf16 v[192:195], v[122:125], v[176:179], v[192:195]
    s_waitcnt lgkmcnt(1)
    v_exp_f32 v169, v169
    v_mfma_f32_16x16x32_bf16 v[160:163], v[48:51], v[138:141], v[160:163]
    v_exp_f32 v170, v170
    v_mfma_f32_16x16x32_bf16 v[212:215], a[252:255], a[104:107], v[212:215]
    ds_read_b128 a[252:255], v239 offset:1024
    v_cvt_pk_bf16_f32 v180, v168, v169
    v_mfma_f32_16x16x32_bf16 v[212:215], v[252:255], a[116:119], v[212:215]
    ds_read_b128 v[252:255], v240 offset:1024
    v_fma_f32 v173, v173, s37, -v236
    v_mfma_f32_16x16x16_bf16 v[160:163], v[52:53], v[142:143], v[160:163]
    v_exp_f32 v171, v171
    v_mfma_f32_16x16x32_bf16 v[208:211], a[48:51], a[236:239], v[208:211]
    v_cvt_pk_bf16_f32 v181, v170, v171
    v_fma_f32 v174, v174, s37, -v236
    v_mfma_f32_16x16x32_bf16 v[208:211], a[60:63], a[240:243], v[208:211]
    ds_read_b128 v[168:171], v250
    v_fma_f32 v175, v175, s37, -v236
    v_mfma_f32_16x16x32_bf16 v[204:207], a[52:55], a[236:239], v[204:207]
    v_exp_f32 v172, v172
    v_mfma_f32_16x16x32_bf16 v[204:207], a[64:67], a[240:243], v[204:207]
    v_exp_f32 v173, v173
    v_mfma_f32_16x16x32_bf16 v[200:203], a[56:59], a[236:239], v[200:203]
    v_exp_f32 v174, v174
    v_mfma_f32_16x16x32_bf16 v[200:203], a[68:71], a[240:243], v[200:203]
    v_cvt_pk_bf16_f32 v54, v208, v209
    v_cvt_pk_bf16_f32 v55, v210, v211
    v_mfma_f32_16x16x32_bf16 v[220:223], a[236:239], a[120:123], v[220:223]
    v_exp_f32 v175, v175
    v_mfma_f32_16x16x32_bf16 v[220:223], a[240:243], a[132:135], v[220:223]
    v_cvt_pk_bf16_f32 v56, v204, v205
    v_cvt_pk_bf16_f32 v57, v206, v207
    v_mfma_f32_16x16x32_bf16 v[216:219], a[236:239], a[124:127], v[216:219]
    v_cvt_pk_bf16_f32 v58, v200, v201
    v_cvt_pk_bf16_f32 v59, v202, v203
    v_mfma_f32_16x16x32_bf16 v[216:219], a[240:243], a[136:139], v[216:219]
    s_waitcnt lgkmcnt(1)
    v_cvt_pk_bf16_f32 v182, v172, v173
    v_cvt_pk_bf16_f32 v183, v174, v175
    v_mfma_f32_16x16x32_bf16 v[164:167], v[54:57], v[138:141], v[164:167]
    v_cvt_pk_bf16_f32 v84, v220, v221
    v_cvt_pk_bf16_f32 v85, v222, v223
    v_mfma_f32_16x16x32_bf16 v[196:199], a[216:219], v[180:183], v[196:199]
    ds_read_b128 v[172:175], v228 offset:640
    v_max3_f32 v248, v144, v145, v146
    v_mfma_f32_16x16x32_bf16 v[184:187], v[66:69], v[180:183], v[184:187]
    v_cvt_pk_bf16_f32 v106, v216, v217
    v_cvt_pk_bf16_f32 v107, v218, v219
    v_mfma_f32_16x16x32_bf16 v[188:191], v[88:91], v[180:183], v[188:191]
    v_max3_f32 v249, v147, v148, v149
    v_max3_f32 v248, v248, v150, v151
    v_mfma_f32_16x16x32_bf16 v[192:195], v[110:113], v[180:183], v[192:195]
    v_rcp_f32 v197, v196
    v_mfma_f32_16x16x16_bf16 v[164:167], v[58:59], v[142:143], v[164:167]
    s_waitcnt lgkmcnt(1)
    v_mul_f32 v184, v184, v197
    v_mul_f32 v185, v185, v197
    v_mfma_f32_16x16x32_bf16 v[168:171], v[60:63], v[138:141], v[168:171]
    v_cvt_pk_bf16_f32 v184, v184, v185
    v_mul_f32 v186, v186, v197
    v_mfma_f32_16x16x32_bf16 v[212:215], a[236:239], a[128:131], v[212:215]
    ds_read_b128 a[236:239], v241 offset:12288
    v_mul_f32 v187, v187, v197
    v_mfma_f32_16x16x32_bf16 v[212:215], a[240:243], a[140:143], v[212:215]
    ds_read_b128 a[240:243], v241 offset:12800
    v_cvt_pk_bf16_f32 v185, v186, v187
    v_mfma_f32_16x16x16_bf16 v[168:171], v[64:65], v[142:143], v[168:171]
    s_waitcnt lgkmcnt(2)
    v_mul_f32 v188, v188, v197
    v_mul_f32 v189, v189, v197
    v_mfma_f32_16x16x32_bf16 v[172:175], v[12:15], v[132:135], v[172:175]
    v_cvt_pk_bf16_f32 v186, v188, v189
    v_mul_f32 v190, v190, v197
    v_mfma_f32_16x16x32_bf16 v[208:211], a[220:223], a[244:247], 0
    v_cvt_pk_bf16_f32 v128, v212, v213
    v_cvt_pk_bf16_f32 v129, v214, v215
    v_mfma_f32_16x16x32_bf16 v[200:203], a[220:223], a[248:251], 0
    v_mul_f32 v191, v191, v197
    v_cvt_pk_bf16_f32 v187, v190, v191
    v_mfma_f32_16x16x16_bf16 v[172:175], v[16:17], v[136:137], v[172:175]
    v_mul_f32 v192, v192, v197
    v_mul_f32 v193, v193, v197
    v_mfma_f32_16x16x32_bf16 v[204:207], a[224:227], a[244:247], 0
    v_cvt_pk_bf16_f32 v188, v192, v193
    v_mul_f32 v194, v194, v197
    v_mfma_f32_16x16x32_bf16 v[220:223], a[224:227], a[248:251], 0
    ds_read_b128 a[248:251], v242 offset:12800
    v_mul_f32 v195, v195, v197
    v_mfma_f32_16x16x32_bf16 v[216:219], a[228:231], a[244:247], 0
    v_cvt_pk_bf16_f32 v189, v194, v195
    v_max3_f32 v249, v249, v152, v153
    v_mfma_f32_16x16x32_bf16 v[212:215], a[232:235], a[244:247], 0
    s_waitcnt lgkmcnt(2)
    ds_read_b128 a[244:247], v242 offset:12288
    v_max3_f32 v248, v248, v154, v155
    v_mfma_f32_16x16x32_bf16 v[208:211], a[236:239], a[252:255], v[208:211]
    ds_write_b128 v237, v[184:187] offset:12288
    v_mfma_f32_16x16x32_bf16 v[200:203], a[236:239], v[252:255], v[200:203]
    s_waitcnt lgkmcnt(3)
    ds_write_b64 v238, v[188:189] offset:12288
    v_mfma_f32_16x16x32_bf16 v[204:207], a[240:243], a[252:255], v[204:207]
    v_max3_f32 v249, v249, v156, v157
    v_max3_f32 v248, v248, v158, v159
    v_mfma_f32_16x16x32_bf16 v[220:223], a[240:243], v[252:255], v[220:223]
    s_waitcnt lgkmcnt(3)
    v_max3_f32 v249, v249, v160, v161
    v_max3_f32 v248, v248, v162, v163
    v_max3_f32 v249, v249, v164, v165
    v_max3_f32 v248, v248, v166, v167
    v_mfma_f32_16x16x32_bf16 v[212:215], a[248:251], a[252:255], v[212:215]
    s_waitcnt lgkmcnt(2)
    v_max3_f32 v249, v249, v168, v169
    v_max3_f32 v248, v248, v170, v171
    ds_read_b128 v[252:255], v240 offset:2048
    ds_read_b128 a[236:239], v241 offset:24576
    v_mfma_f32_16x16x32_bf16 v[216:219], a[244:247], a[252:255], v[216:219]
    s_waitcnt lgkmcnt(0)
    ds_read_b128 a[252:255], v239 offset:2048
    v_max_f32 v248, v248, v249
    v_mov_b32 v249, v248
    s_nop 1
    ds_read_b128 a[240:243], v241 offset:25088
    v_permlane16_swap_b32 v248, v249
    ds_read_b128 a[244:247], v242 offset:24576
    v_max_f32 v248, v248, v249
    ds_read_b128 a[248:251], v242 offset:25088
    v_mov_b32 v249, v248
    s_nop 1
    v_permlane32_swap_b32 v248, v249
    v_max_f32 v248, v248, v249
    v_mul_f32 v236, s37, v248
    v_fma_f32 v144, v144, s37, -v236
    v_fma_f32 v145, v145, s37, -v236
    v_fma_f32 v146, v146, s37, -v236
    v_fma_f32 v147, v147, s37, -v236
    v_exp_f32 v144, v144
    v_exp_f32 v145, v145
    v_exp_f32 v146, v146
    v_mfma_f32_16x16x32_bf16 v[200:203], a[236:239], v[252:255], v[200:203]
    s_waitcnt lgkmcnt(3)
    v_exp_f32 v147, v147
    v_mfma_f32_16x16x32_bf16 v[208:211], a[236:239], a[252:255], v[208:211]
    s_waitcnt lgkmcnt(2)
    ds_read_b128 a[236:239], v241 offset:36864
    v_cvt_pk_bf16_f32 v176, v144, v145
    v_mfma_f32_16x16x32_bf16 v[204:207], a[240:243], a[252:255], v[204:207]
    v_cvt_pk_bf16_f32 v177, v146, v147
    v_fma_f32 v148, v148, s37, -v236
    v_mfma_f32_16x16x32_bf16 v[220:223], a[240:243], v[252:255], v[220:223]
    s_waitcnt lgkmcnt(2)
    ds_read_b128 v[252:255], v240 offset:3072
    ds_read_b128 a[240:243], v241 offset:37376
    v_mfma_f32_16x16x32_bf16 v[216:219], a[244:247], a[252:255], v[216:219]
    s_waitcnt lgkmcnt(3)
    ds_read_b128 a[244:247], v242 offset:36864
    v_fma_f32 v149, v149, s37, -v236
    v_mfma_f32_16x16x32_bf16 v[212:215], a[248:251], a[252:255], v[212:215]
    ds_read_b128 a[252:255], v239 offset:3072
    v_fma_f32 v150, v150, s37, -v236
    v_fma_f32 v151, v151, s37, -v236
    v_exp_f32 v148, v148
    ds_read_b128 a[248:251], v242 offset:37376
    ds_read_b128 v[144:147], v229 offset:640
    v_exp_f32 v149, v149
    v_exp_f32 v150, v150
    v_exp_f32 v151, v151
    v_cvt_pk_bf16_f32 v178, v148, v149
    v_cvt_pk_bf16_f32 v179, v150, v151
    ds_read_b128 v[148:151], v229 offset:1280
    v_fma_f32 v152, v152, s37, -v236
    v_mfma_f32_16x16x32_bf16 v[196:199], a[216:219], v[176:179], 0
    v_fma_f32 v153, v153, s37, -v236
    v_fma_f32 v154, v154, s37, -v236
    v_mfma_f32_16x16x32_bf16 v[184:187], v[68:71], v[176:179], 0
    v_fma_f32 v155, v155, s37, -v236
    v_fma_f32 v156, v156, s37, -v236
    v_mfma_f32_16x16x32_bf16 v[188:191], v[90:93], v[176:179], 0
    v_exp_f32 v152, v152
    v_mfma_f32_16x16x32_bf16 v[192:195], v[112:115], v[176:179], 0
    s_waitcnt lgkmcnt(3)
    v_exp_f32 v153, v153
    v_mfma_f32_16x16x32_bf16 v[208:211], a[236:239], a[252:255], v[208:211]
    v_exp_f32 v154, v154
    v_mfma_f32_16x16x32_bf16 v[200:203], a[236:239], v[252:255], v[200:203]
    ds_read_b128 a[236:239], v241 offset:49152
    v_cvt_pk_bf16_f32 v180, v152, v153
    v_mfma_f32_16x16x32_bf16 v[204:207], a[240:243], a[252:255], v[204:207]
    s_waitcnt lgkmcnt(2)
    v_exp_f32 v155, v155
    v_mfma_f32_16x16x32_bf16 v[144:147], v[36:39], v[132:135], v[144:147]
    s_waitcnt lgkmcnt(1)
    v_cvt_pk_bf16_f32 v181, v154, v155
    v_fma_f32 v157, v157, s37, -v236
    v_mfma_f32_16x16x32_bf16 v[148:151], v[42:45], v[132:135], v[148:151]
    ds_read_b128 v[152:155], v228 offset:1280
    v_fma_f32 v158, v158, s37, -v236
    v_mfma_f32_16x16x32_bf16 v[220:223], a[240:243], v[252:255], v[220:223]
    ds_read_b128 v[252:255], v240 offset:4096
    v_fma_f32 v159, v159, s37, -v236
    v_mfma_f32_16x16x16_bf16 v[144:147], v[40:41], v[136:137], v[144:147]
    ds_read_b128 a[240:243], v241 offset:49664
    v_fma_f32 v160, v160, s37, -v236
    v_mfma_f32_16x16x16_bf16 v[148:151], v[46:47], v[136:137], v[148:151]
    v_exp_f32 v156, v156
    v_mfma_f32_16x16x32_bf16 v[216:219], a[244:247], a[252:255], v[216:219]
    ds_read_b128 a[244:247], v242 offset:49152
    v_fma_f32 v161, v161, s37, -v236
    v_mfma_f32_16x16x32_bf16 v[212:215], a[248:251], a[252:255], v[212:215]
    ds_read_b128 a[252:255], v239 offset:4096
    ds_read_b128 a[248:251], v242 offset:49664
    v_exp_f32 v157, v157
    v_exp_f32 v158, v158
    v_exp_f32 v159, v159
    v_cvt_pk_bf16_f32 v182, v156, v157
    v_cvt_pk_bf16_f32 v183, v158, v159
    ds_read_b128 v[156:159], v228 offset:1920
    v_fma_f32 v162, v162, s37, -v236
    v_mfma_f32_16x16x32_bf16 v[196:199], a[216:219], v[180:183], v[196:199]
    v_fma_f32 v163, v163, s37, -v236
    v_fma_f32 v164, v164, s37, -v236
    v_mfma_f32_16x16x32_bf16 v[184:187], v[76:79], v[180:183], v[184:187]
    v_exp_f32 v160, v160
    v_mfma_f32_16x16x32_bf16 v[188:191], v[98:101], v[180:183], v[188:191]
    v_exp_f32 v161, v161
    v_mfma_f32_16x16x32_bf16 v[192:195], v[120:123], v[180:183], v[192:195]
    s_waitcnt lgkmcnt(4)
    v_exp_f32 v162, v162
    v_mfma_f32_16x16x32_bf16 v[152:155], v[18:21], v[132:135], v[152:155]
    s_waitcnt lgkmcnt(2)
    v_exp_f32 v163, v163
    v_mfma_f32_16x16x32_bf16 v[208:211], a[236:239], a[252:255], v[208:211]
    v_cvt_pk_bf16_f32 v176, v160, v161
    v_cvt_pk_bf16_f32 v177, v162, v163
    v_mfma_f32_16x16x32_bf16 v[200:203], a[236:239], v[252:255], v[200:203]
    ds_read_b128 a[236:239], v241 offset:61440
    ds_read_b128 v[160:163], v229 offset:1920
    v_mfma_f32_16x16x16_bf16 v[196:199], a[216:217], v[176:177], v[196:199]
    v_fma_f32 v165, v165, s37, -v236
    v_fma_f32 v166, v166, s37, -v236
    v_mfma_f32_16x16x16_bf16 v[184:187], v[82:83], v[176:177], v[184:187]
    v_fma_f32 v167, v167, s37, -v236
    v_fma_f32 v168, v168, s37, -v236
    v_mfma_f32_16x16x16_bf16 v[188:191], v[104:105], v[176:177], v[188:191]
    v_exp_f32 v164, v164
    v_mfma_f32_16x16x16_bf16 v[192:195], v[126:127], v[176:177], v[192:195]
    v_exp_f32 v165, v165
    v_mfma_f32_16x16x16_bf16 v[152:155], v[22:23], v[136:137], v[152:155]
    s_waitcnt lgkmcnt(2)
    v_exp_f32 v166, v166
    v_mfma_f32_16x16x32_bf16 v[156:159], v[0:3], v[132:135], v[156:159]
    v_exp_f32 v167, v167
    v_mfma_f32_16x16x32_bf16 v[204:207], a[240:243], a[252:255], v[204:207]
    v_cvt_pk_bf16_f32 v180, v164, v165
    v_cvt_pk_bf16_f32 v181, v166, v167
    v_mfma_f32_16x16x32_bf16 v[220:223], a[240:243], v[252:255], v[220:223]
    ds_read_b128 v[252:255], v240 offset:5120
    ds_read_b128 a[240:243], v241 offset:61952
    v_mfma_f32_16x16x16_bf16 v[156:159], v[4:5], v[136:137], v[156:159]
    s_waitcnt lgkmcnt(2)
    ds_read_b128 v[164:167], v229 offset:2560
    v_fma_f32 v169, v169, s37, -v236
    v_mfma_f32_16x16x32_bf16 v[160:163], v[24:27], v[132:135], v[160:163]
    v_fma_f32 v170, v170, s37, -v236
    v_fma_f32 v171, v171, s37, -v236
    v_mfma_f32_16x16x32_bf16 v[216:219], a[244:247], a[252:255], v[216:219]
    ds_read_b128 a[244:247], v242 offset:61440
    v_max3_f32 v248, v172, v173, v174
    v_mfma_f32_16x16x32_bf16 v[212:215], a[248:251], a[252:255], v[212:215]
    ds_read_b128 a[252:255], v239 offset:5120
    v_max3_f32 v249, v175, v144, v145
    v_mfma_f32_16x16x16_bf16 v[160:163], v[28:29], v[136:137], v[160:163]
    s_waitcnt lgkmcnt(4)
    ds_read_b128 a[248:251], v242 offset:61952
    v_exp_f32 v168, v168
    v_exp_f32 v169, v169
    v_exp_f32 v170, v170
    v_exp_f32 v171, v171
    v_cvt_pk_bf16_f32 v182, v168, v169
    v_cvt_pk_bf16_f32 v183, v170, v171
    ds_read_b128 v[168:171], v228 offset:2560
    v_mfma_f32_16x16x32_bf16 v[200:203], a[236:239], v[252:255], v[200:203]
    v_max3_f32 v248, v248, v146, v147
    v_max3_f32 v249, v249, v148, v149
    v_mfma_f32_16x16x32_bf16 v[196:199], a[216:219], v[180:183], v[196:199]
    v_max3_f32 v248, v248, v150, v151
    v_max3_f32 v249, v249, v152, v153
    v_mfma_f32_16x16x32_bf16 v[184:187], v[84:87], v[180:183], v[184:187]
    v_max3_f32 v248, v248, v154, v155
    v_max3_f32 v249, v249, v156, v157
    v_mfma_f32_16x16x32_bf16 v[188:191], v[106:109], v[180:183], v[188:191]
    v_cvt_pk_bf16_f32 v200, v200, v201
    v_cvt_pk_bf16_f32 v201, v202, v203
    v_mfma_f32_16x16x32_bf16 v[192:195], v[128:131], v[180:183], v[192:195]
    s_waitcnt lgkmcnt(2)
    v_rcp_f32 v197, v196
    v_mfma_f32_16x16x32_bf16 v[208:211], a[236:239], a[252:255], v[208:211]
    ds_read_b128 a[236:239], v224 offset:15616
    v_mul_f32 v184, v184, v197
    v_mfma_f32_16x16x32_bf16 v[204:207], a[240:243], a[252:255], v[204:207]
    v_mul_f32 v185, v185, v197
    v_cvt_pk_bf16_f32 v184, v184, v185
    v_mfma_f32_16x16x32_bf16 v[220:223], a[240:243], v[252:255], v[220:223]
    ds_read_b128 v[252:255], v224 offset:15552
    ds_read_b128 a[240:243], v224 offset:15680
    v_mfma_f32_16x16x32_bf16 v[216:219], a[244:247], a[252:255], v[216:219]
    s_waitcnt lgkmcnt(4)
    ds_read_b128 a[244:247], v224 offset:15744
    v_cvt_pk_bf16_f32 v208, v208, v209
    v_mfma_f32_16x16x32_bf16 v[212:215], a[248:251], a[252:255], v[212:215]
    ds_read_b128 a[252:255], v224 offset:15488
    v_cvt_pk_bf16_f32 v209, v210, v211
    v_cvt_pk_bf16_f32 v210, v204, v205
    v_cvt_pk_bf16_f32 v211, v206, v207
    ds_read_b128 a[248:251], v224 offset:15808
    buffer_store_dwordx4 v[208:211], v243, s[20:23], s51 offen sc0 sc1
    v_cvt_pk_bf16_f32 v202, v220, v221
    v_cvt_pk_bf16_f32 v203, v222, v223
    v_cvt_pk_bf16_f32 v216, v216, v217
    v_cvt_pk_bf16_f32 v217, v218, v219
    v_cvt_pk_bf16_f32 v218, v212, v213
    v_cvt_pk_bf16_f32 v219, v214, v215
    v_mul_f32 v186, v186, v197
    v_mul_f32 v187, v187, v197
    v_cvt_pk_bf16_f32 v185, v186, v187
    v_mul_f32 v188, v188, v197
    v_mul_f32 v189, v189, v197
    v_cvt_pk_bf16_f32 v186, v188, v189
    v_mul_f32 v190, v190, v197
    v_mul_f32 v191, v191, v197
    v_cvt_pk_bf16_f32 v187, v190, v191
    v_mul_f32 v192, v192, v197
    v_mul_f32 v193, v193, v197
    v_cvt_pk_bf16_f32 v188, v192, v193
    v_mul_f32 v194, v194, v197
    v_mul_f32 v195, v195, v197
    v_cvt_pk_bf16_f32 v189, v194, v195
    ds_write_b128 v237, v[184:187] offset:18432
    s_waitcnt lgkmcnt(2)
    v_mfma_f32_16x16x32_bf16 v[208:211], a[0:3], a[252:255], 0
    ds_write_b64 v238, v[188:189] offset:18432
    v_mfma_f32_16x16x32_bf16 v[208:211], a[12:15], v[252:255], v[208:211]
    v_max3_f32 v248, v248, v158, v159
    v_max3_f32 v249, v249, v160, v161
    v_mfma_f32_16x16x32_bf16 v[204:207], a[4:7], a[252:255], 0
    v_max3_f32 v248, v248, v162, v163
    v_mfma_f32_16x16x32_bf16 v[204:207], a[16:19], v[252:255], v[204:207]
    buffer_store_dwordx4 v[200:203], v245, s[20:23], s51 offen sc0 sc1
    v_mfma_f32_16x16x32_bf16 v[220:223], a[252:255], a[72:75], 0
    v_mfma_f32_16x16x32_bf16 v[220:223], v[252:255], a[84:87], v[220:223]
    v_mfma_f32_16x16x32_bf16 v[200:203], a[8:11], a[252:255], 0
    v_mfma_f32_16x16x32_bf16 v[200:203], a[20:23], v[252:255], v[200:203]
    v_mfma_f32_16x16x32_bf16 v[212:215], a[252:255], a[80:83], 0
    v_mfma_f32_16x16x32_bf16 v[212:215], v[252:255], a[92:95], v[212:215]
    v_mfma_f32_16x16x32_bf16 v[208:211], a[24:27], a[236:239], v[208:211]
    s_waitcnt lgkmcnt(0)
    v_mfma_f32_16x16x32_bf16 v[208:211], a[36:39], a[240:243], v[208:211]
    s_barrier
    v_mfma_f32_16x16x32_bf16 v[204:207], a[28:31], a[236:239], v[204:207]
    v_mfma_f32_16x16x32_bf16 v[204:207], a[40:43], a[240:243], v[204:207]
    v_mfma_f32_16x16x32_bf16 v[200:203], a[32:35], a[236:239], v[200:203]
    v_mfma_f32_16x16x32_bf16 v[200:203], a[44:47], a[240:243], v[200:203]
    buffer_store_dwordx4 v[216:219], v244, s[20:23], s51 offen sc0 sc1
    v_mfma_f32_16x16x32_bf16 v[220:223], a[236:239], a[96:99], v[220:223]
    s_add_u32 s51, s51, s48
    v_mfma_f32_16x16x32_bf16 v[220:223], a[240:243], a[108:111], v[220:223]
    v_mfma_f32_16x16x32_bf16 v[216:219], a[252:255], a[76:79], 0
    ds_read_b128 a[252:255], v224 offset:18560
    v_mfma_f32_16x16x32_bf16 v[216:219], v[252:255], a[88:91], v[216:219]
    ds_read_b128 v[252:255], v224 offset:18624
    v_mfma_f32_16x16x32_bf16 v[216:219], a[236:239], a[100:103], v[216:219]
    v_mfma_f32_16x16x32_bf16 v[216:219], a[240:243], a[112:115], v[216:219]
    v_mfma_f32_16x16x32_bf16 v[212:215], a[236:239], a[104:107], v[212:215]
    ds_read_b128 a[236:239], v224 offset:18688
    v_mfma_f32_16x16x32_bf16 v[212:215], a[240:243], a[116:119], v[212:215]
    ds_read_b128 a[240:243], v224 offset:18752
    v_mfma_f32_16x16x32_bf16 v[208:211], a[48:51], a[244:247], v[208:211]
    v_mfma_f32_16x16x32_bf16 v[208:211], a[60:63], a[248:251], v[208:211]
    v_mfma_f32_16x16x32_bf16 v[204:207], a[52:55], a[244:247], v[204:207]
    v_mfma_f32_16x16x32_bf16 v[204:207], a[64:67], a[248:251], v[204:207]
    v_mfma_f32_16x16x32_bf16 v[200:203], a[56:59], a[244:247], v[200:203]
    v_mfma_f32_16x16x32_bf16 v[200:203], a[68:71], a[248:251], v[200:203]
    v_mfma_f32_16x16x32_bf16 v[220:223], a[244:247], a[120:123], v[220:223]
    v_mfma_f32_16x16x32_bf16 v[220:223], a[248:251], a[132:135], v[220:223]
    v_mfma_f32_16x16x32_bf16 v[216:219], a[244:247], a[124:127], v[216:219]
    v_mfma_f32_16x16x32_bf16 v[216:219], a[248:251], a[136:139], v[216:219]
    v_cvt_pk_bf16_f32 v6, v208, v209
    v_cvt_pk_bf16_f32 v7, v210, v211
    v_mfma_f32_16x16x32_bf16 v[212:215], a[244:247], a[128:131], v[212:215]
    v_cvt_pk_bf16_f32 v8, v204, v205
    v_cvt_pk_bf16_f32 v9, v206, v207
    v_mfma_f32_16x16x32_bf16 v[212:215], a[248:251], a[140:143], v[212:215]
    v_cvt_pk_bf16_f32 v10, v200, v201
    v_cvt_pk_bf16_f32 v11, v202, v203
    v_mfma_f32_16x16x32_bf16 v[168:171], v[6:9], v[132:135], v[168:171]
    s_waitcnt lgkmcnt(0)
    v_cvt_pk_bf16_f32 v72, v220, v221
    v_cvt_pk_bf16_f32 v73, v222, v223
    v_mfma_f32_16x16x32_bf16 v[208:211], a[0:3], a[252:255], 0
    v_cvt_pk_bf16_f32 v94, v216, v217
    v_cvt_pk_bf16_f32 v95, v218, v219
    v_mfma_f32_16x16x32_bf16 v[208:211], a[12:15], v[252:255], v[208:211]
    v_cvt_pk_bf16_f32 v116, v212, v213
    v_cvt_pk_bf16_f32 v117, v214, v215
    v_mfma_f32_16x16x16_bf16 v[168:171], v[10:11], v[136:137], v[168:171]
    ds_read_b128 a[244:247], v224 offset:18816
    ds_read_b128 a[248:251], v224 offset:18880
    v_mfma_f32_16x16x32_bf16 v[204:207], a[4:7], a[252:255], 0
    ds_read_b128 a[0:3], v241 offset:12288
    v_cndmask_b32 v224, v239, v240, vcc
    v_mfma_f32_16x16x32_bf16 v[204:207], a[16:19], v[252:255], v[204:207]
    ds_read_b128 a[4:7], v241 offset:12800
    v_mfma_f32_16x16x32_bf16 v[200:203], a[8:11], a[252:255], 0
    ds_read_b128 a[8:11], v242 offset:12288
    v_mfma_f32_16x16x32_bf16 v[200:203], a[20:23], v[252:255], v[200:203]
    ds_read_b128 a[12:15], v242 offset:12800
    v_mfma_f32_16x16x32_bf16 v[220:223], a[252:255], a[72:75], 0
    ds_read_b128 a[16:19], v241 offset:24576
    v_mfma_f32_16x16x32_bf16 v[220:223], v[252:255], a[84:87], v[220:223]
    ds_read_b128 a[20:23], v241 offset:25088
    v_mfma_f32_16x16x32_bf16 v[216:219], a[252:255], a[76:79], 0
    v_mfma_f32_16x16x32_bf16 v[216:219], v[252:255], a[88:91], v[216:219]
    v_mfma_f32_16x16x32_bf16 v[212:215], a[252:255], a[80:83], 0
    ds_read_b128 a[252:255], v226 offset:4224
    v_mfma_f32_16x16x32_bf16 v[212:215], v[252:255], a[92:95], v[212:215]
    ds_read_b128 v[252:255], v226 offset:4288
    v_mfma_f32_16x16x32_bf16 v[208:211], a[24:27], a[236:239], v[208:211]
    ds_read_b128 a[24:27], v242 offset:24576
    v_mfma_f32_16x16x32_bf16 v[208:211], a[36:39], a[240:243], v[208:211]
    ds_read_b128 a[36:39], v241 offset:37376
    v_mfma_f32_16x16x32_bf16 v[204:207], a[28:31], a[236:239], v[204:207]
    ds_read_b128 a[28:31], v242 offset:25088
    v_mfma_f32_16x16x32_bf16 v[204:207], a[40:43], a[240:243], v[204:207]
    ds_read_b128 a[40:43], v242 offset:36864
    v_mfma_f32_16x16x32_bf16 v[200:203], a[32:35], a[236:239], v[200:203]
    ds_read_b128 a[32:35], v241 offset:36864
    v_mfma_f32_16x16x32_bf16 v[200:203], a[44:47], a[240:243], v[200:203]
    ds_read_b128 a[44:47], v242 offset:37376
    v_mfma_f32_16x16x32_bf16 v[220:223], a[236:239], a[96:99], v[220:223]
    v_mfma_f32_16x16x32_bf16 v[220:223], a[240:243], a[108:111], v[220:223]
    v_mfma_f32_16x16x32_bf16 v[216:219], a[236:239], a[100:103], v[216:219]
    v_mfma_f32_16x16x32_bf16 v[216:219], a[240:243], a[112:115], v[216:219]
    v_mfma_f32_16x16x32_bf16 v[212:215], a[236:239], a[104:107], v[212:215]
    ds_read_b128 a[236:239], v226 offset:4352
    v_mfma_f32_16x16x32_bf16 v[212:215], a[240:243], a[116:119], v[212:215]
    s_waitcnt lgkmcnt(5)
    ds_read_b128 a[240:243], v226 offset:4416
    v_mfma_f32_16x16x32_bf16 v[208:211], a[48:51], a[244:247], v[208:211]
    ds_read_b128 a[48:51], v241 offset:49152
    v_mfma_f32_16x16x32_bf16 v[208:211], a[60:63], a[248:251], v[208:211]
    ds_read_b128 a[60:63], v242 offset:49664
    v_mfma_f32_16x16x32_bf16 v[204:207], a[52:55], a[244:247], v[204:207]
    ds_read_b128 a[52:55], v241 offset:49664
    v_mfma_f32_16x16x32_bf16 v[204:207], a[64:67], a[248:251], v[204:207]
    ds_read_b128 a[64:67], v241 offset:61440
    v_mfma_f32_16x16x32_bf16 v[200:203], a[56:59], a[244:247], v[200:203]
    ds_read_b128 a[56:59], v242 offset:49152
    v_mfma_f32_16x16x32_bf16 v[200:203], a[68:71], a[248:251], v[200:203]
    v_cvt_pk_bf16_f32 v30, v208, v209
    v_cvt_pk_bf16_f32 v31, v210, v211
    v_mfma_f32_16x16x32_bf16 v[220:223], a[244:247], a[120:123], v[220:223]
    ds_read_b128 a[68:71], v241 offset:61952
    v_cvt_pk_bf16_f32 v32, v204, v205
    v_mfma_f32_16x16x32_bf16 v[220:223], a[248:251], a[132:135], v[220:223]
    v_cvt_pk_bf16_f32 v33, v206, v207
    v_mfma_f32_16x16x32_bf16 v[216:219], a[244:247], a[124:127], v[216:219]
    v_cvt_pk_bf16_f32 v34, v200, v201
    v_cvt_pk_bf16_f32 v35, v202, v203
    v_mfma_f32_16x16x32_bf16 v[216:219], a[248:251], a[136:139], v[216:219]
    v_mfma_f32_16x16x32_bf16 v[164:167], v[30:33], v[132:135], v[164:167]
    v_mfma_f32_16x16x32_bf16 v[212:215], a[244:247], a[128:131], v[212:215]
    ds_read_b128 a[244:247], v226 offset:4480
    v_cvt_pk_bf16_f32 v70, v220, v221
    v_mfma_f32_16x16x32_bf16 v[212:215], a[248:251], a[140:143], v[212:215]
    ds_read_b128 a[248:251], v226 offset:4544
    v_cvt_pk_bf16_f32 v71, v222, v223
    v_mfma_f32_16x16x16_bf16 v[164:167], v[34:35], v[136:137], v[164:167]
    v_cvt_pk_bf16_f32 v92, v216, v217
    v_cvt_pk_bf16_f32 v93, v218, v219
    v_mfma_f32_16x16x32_bf16 v[208:211], a[144:147], a[252:255], 0
    v_cndmask_b32 v226, v244, v247, vcc
    v_cndmask_b32 v247, v247, v244, vcc
    v_mfma_f32_16x16x32_bf16 v[208:211], a[156:159], v[252:255], v[208:211]
    v_cvt_pk_bf16_f32 v114, v212, v213
    v_cvt_pk_bf16_f32 v115, v214, v215
    v_mfma_f32_16x16x32_bf16 v[204:207], a[148:151], a[252:255], 0
    v_max3_f32 v249, v249, v164, v165
    v_max3_f32 v248, v248, v166, v167
    v_mfma_f32_16x16x32_bf16 v[204:207], a[160:163], v[252:255], v[204:207]
    v_max3_f32 v249, v249, v168, v169
    v_max3_f32 v248, v248, v170, v171
    v_mfma_f32_16x16x32_bf16 v[200:203], a[152:155], a[252:255], 0
    ds_read_b128 a[252:255], v239 offset:12288
    v_max_f32 v248, v248, v249
    v_mfma_f32_16x16x32_bf16 v[200:203], a[164:167], v[252:255], v[200:203]
    s_waitcnt lgkmcnt(3)
    ds_read_b128 v[252:255], v240 offset:12288
    v_mov_b32 v249, v248
    v_mfma_f32_16x16x32_bf16 v[208:211], a[168:171], a[236:239], v[208:211]
    v_mfma_f32_16x16x32_bf16 v[208:211], a[180:183], a[240:243], v[208:211]
    v_permlane16_swap_b32 v248, v249
    v_mfma_f32_16x16x32_bf16 v[204:207], a[172:175], a[236:239], v[204:207]
    v_max_f32 v248, v248, v249
    v_mov_b32 v249, v248
    v_mfma_f32_16x16x32_bf16 v[204:207], a[184:187], a[240:243], v[204:207]
    v_mfma_f32_16x16x32_bf16 v[200:203], a[176:179], a[236:239], v[200:203]
    ds_read_b128 a[236:239], v239 offset:13312
    v_mfma_f32_16x16x32_bf16 v[200:203], a[188:191], a[240:243], v[200:203]
    s_waitcnt lgkmcnt(3)
    ds_read_b128 a[240:243], v240 offset:13312
    v_mfma_f32_16x16x32_bf16 v[208:211], a[192:195], a[244:247], v[208:211]
    v_permlane32_swap_b32 v248, v249
    v_mfma_f32_16x16x32_bf16 v[208:211], a[204:207], a[248:251], v[208:211]
    v_max_f32 v248, v248, v249
    v_mul_f32 v236, s37, v248
    v_mfma_f32_16x16x32_bf16 v[204:207], a[196:199], a[244:247], v[204:207]
    v_fma_f32 v172, v172, s37, -v236
    v_fma_f32 v173, v173, s37, -v236
    v_mfma_f32_16x16x32_bf16 v[204:207], a[208:211], a[248:251], v[204:207]
    v_fma_f32 v174, v174, s37, -v236
    v_fma_f32 v175, v175, s37, -v236
    v_mfma_f32_16x16x32_bf16 v[200:203], a[200:203], a[244:247], v[200:203]
    v_cvt_pk_bf16_f32 v138, v208, v209
    v_cvt_pk_bf16_f32 v139, v210, v211
    v_mfma_f32_16x16x32_bf16 v[200:203], a[212:215], a[248:251], v[200:203]
    s_waitcnt lgkmcnt(2)
    ds_read_b128 a[244:247], v239 offset:14336
    ds_read_b128 a[248:251], v240 offset:14336
    v_mfma_f32_16x16x32_bf16 v[220:223], a[220:223], a[252:255], 0
    v_cvt_pk_bf16_f32 v140, v204, v205
    v_cvt_pk_bf16_f32 v141, v206, v207
    v_mfma_f32_16x16x32_bf16 v[212:215], a[220:223], v[252:255], 0
    v_exp_f32 v172, v172
    v_mfma_f32_16x16x32_bf16 v[216:219], a[224:227], a[252:255], 0
    v_cvt_pk_bf16_f32 v142, v200, v201
    v_cvt_pk_bf16_f32 v143, v202, v203
    v_mfma_f32_16x16x32_bf16 v[208:211], a[224:227], v[252:255], 0
    ds_read_b128 v[252:255], v240 offset:15360
    v_fma_f32 v144, v144, s37, -v236
    v_mfma_f32_16x16x32_bf16 v[204:207], a[228:231], a[252:255], 0
    v_exp_f32 v173, v173
    v_mfma_f32_16x16x32_bf16 v[200:203], a[232:235], a[252:255], 0
    s_waitcnt lgkmcnt(3)
    ds_read_b128 a[252:255], v239 offset:15360
    v_cvt_pk_bf16_f32 v176, v172, v173
    v_mfma_f32_16x16x32_bf16 v[220:223], a[0:3], a[236:239], v[220:223]
    v_exp_f32 v174, v174
    v_mfma_f32_16x16x32_bf16 v[212:215], a[0:3], a[240:243], v[212:215]
    v_exp_f32 v175, v175
    v_mfma_f32_16x16x32_bf16 v[216:219], a[4:7], a[236:239], v[216:219]
    v_cvt_pk_bf16_f32 v177, v174, v175
    v_fma_f32 v145, v145, s37, -v236
    v_mfma_f32_16x16x32_bf16 v[208:211], a[4:7], a[240:243], v[208:211]
    ds_read_b128 a[240:243], v240 offset:16384
    ds_read_b128 v[172:175], v230 offset:640
    v_mfma_f32_16x16x32_bf16 v[204:207], a[8:11], a[236:239], v[204:207]
    v_fma_f32 v146, v146, s37, -v236
    v_fma_f32 v147, v147, s37, -v236
    v_mfma_f32_16x16x32_bf16 v[200:203], a[12:15], a[236:239], v[200:203]
    s_waitcnt lgkmcnt(4)
    ds_read_b128 a[236:239], v239 offset:16384
    v_fma_f32 v148, v148, s37, -v236
    v_mfma_f32_16x16x32_bf16 v[220:223], a[16:19], a[244:247], v[220:223]
    v_exp_f32 v144, v144
    v_mfma_f32_16x16x32_bf16 v[212:215], a[16:19], a[248:251], v[212:215]
    v_exp_f32 v145, v145
    v_mfma_f32_16x16x32_bf16 v[216:219], a[20:23], a[244:247], v[216:219]
    v_exp_f32 v146, v146
    v_mfma_f32_16x16x32_bf16 v[208:211], a[20:23], a[248:251], v[208:211]
    ds_read_b128 a[248:251], v240 offset:17408
    v_cvt_pk_bf16_f32 v178, v144, v145
    v_mfma_f32_16x16x32_bf16 v[204:207], a[24:27], a[244:247], v[204:207]
    v_exp_f32 v147, v147
    v_mfma_f32_16x16x32_bf16 v[200:203], a[28:31], a[244:247], v[200:203]
    s_waitcnt lgkmcnt(4)
    ds_read_b128 a[244:247], v239 offset:17408
    v_cvt_pk_bf16_f32 v179, v146, v147
    v_mfma_f32_16x16x32_bf16 v[220:223], a[32:35], a[252:255], v[220:223]
    ds_read_b128 v[144:147], v230 offset:1280
    v_fma_f32 v149, v149, s37, -v236
    v_mfma_f32_16x16x32_bf16 v[196:199], a[216:219], v[176:179], 0
    v_fma_f32 v150, v150, s37, -v236
    v_fma_f32 v151, v151, s37, -v236
    v_mfma_f32_16x16x32_bf16 v[184:187], v[74:77], v[176:179], 0
    v_exp_f32 v148, v148
    v_mfma_f32_16x16x32_bf16 v[188:191], v[96:99], v[176:179], 0
    v_exp_f32 v149, v149
    v_mfma_f32_16x16x32_bf16 v[192:195], v[118:121], v[176:179], 0
    s_waitcnt lgkmcnt(3)
    v_exp_f32 v150, v150
    v_mfma_f32_16x16x32_bf16 v[172:175], v[36:39], v[138:141], v[172:175]
    v_exp_f32 v151, v151
    v_mfma_f32_16x16x32_bf16 v[212:215], a[32:35], v[252:255], v[212:215]
    v_cvt_pk_bf16_f32 v180, v148, v149
    v_cvt_pk_bf16_f32 v181, v150, v151
    v_mfma_f32_16x16x32_bf16 v[216:219], a[36:39], a[252:255], v[216:219]
    ds_read_b128 v[148:151], v230 offset:1920
    v_fma_f32 v152, v152, s37, -v236
    v_mfma_f32_16x16x16_bf16 v[172:175], v[40:41], v[142:143], v[172:175]
    s_waitcnt lgkmcnt(1)
    v_fma_f32 v153, v153, s37, -v236
    v_fma_f32 v154, v154, s37, -v236
    v_mfma_f32_16x16x32_bf16 v[144:147], v[42:45], v[138:141], v[144:147]
    v_fma_f32 v155, v155, s37, -v236
    v_fma_f32 v156, v156, s37, -v236
    v_mfma_f32_16x16x32_bf16 v[208:211], a[36:39], v[252:255], v[208:211]
    ds_read_b128 v[252:255], v242 offset:61952
    v_fma_f32 v157, v157, s37, -v236
    v_mfma_f32_16x16x32_bf16 v[204:207], a[40:43], a[252:255], v[204:207]
    v_exp_f32 v152, v152
    v_mfma_f32_16x16x16_bf16 v[144:147], v[46:47], v[142:143], v[144:147]
    v_exp_f32 v153, v153
    v_mfma_f32_16x16x32_bf16 v[200:203], a[44:47], a[252:255], v[200:203]
    ds_read_b128 a[252:255], v242 offset:61440
    v_cvt_pk_bf16_f32 v182, v152, v153
    v_mfma_f32_16x16x32_bf16 v[220:223], a[48:51], a[236:239], v[220:223]
    v_exp_f32 v154, v154
    v_mfma_f32_16x16x32_bf16 v[212:215], a[48:51], a[240:243], v[212:215]
    s_waitcnt lgkmcnt(2)
    v_exp_f32 v155, v155
    v_mfma_f32_16x16x32_bf16 v[148:151], v[24:27], v[138:141], v[148:151]
    v_cvt_pk_bf16_f32 v183, v154, v155
    v_fma_f32 v158, v158, s37, -v236
    v_mfma_f32_16x16x32_bf16 v[216:219], a[52:55], a[236:239], v[216:219]
    ds_read_b128 v[152:155], v230 offset:2560
    v_fma_f32 v159, v159, s37, -v236
    v_mfma_f32_16x16x32_bf16 v[196:199], a[216:219], v[180:183], v[196:199]
    v_exp_f32 v156, v156
    v_mfma_f32_16x16x32_bf16 v[184:187], v[78:81], v[180:183], v[184:187]
    v_exp_f32 v157, v157
    v_mfma_f32_16x16x32_bf16 v[188:191], v[100:103], v[180:183], v[188:191]
    v_exp_f32 v158, v158
    v_mfma_f32_16x16x32_bf16 v[192:195], v[122:125], v[180:183], v[192:195]
    v_exp_f32 v159, v159
    v_mfma_f32_16x16x16_bf16 v[148:151], v[28:29], v[142:143], v[148:151]
    v_cvt_pk_bf16_f32 v176, v156, v157
    v_cvt_pk_bf16_f32 v177, v158, v159
    v_mfma_f32_16x16x32_bf16 v[208:211], a[52:55], a[240:243], v[208:211]
    ds_read_b128 v[156:159], v234
    v_fma_f32 v160, v160, s37, -v236
    v_mfma_f32_16x16x32_bf16 v[204:207], a[56:59], a[236:239], v[204:207]
    v_fma_f32 v161, v161, s37, -v236
    v_fma_f32 v162, v162, s37, -v236
    v_mfma_f32_16x16x32_bf16 v[200:203], a[60:63], a[236:239], v[200:203]
    s_waitcnt lgkmcnt(1)
    v_fma_f32 v163, v163, s37, -v236
    v_fma_f32 v164, v164, s37, -v236
    v_mfma_f32_16x16x32_bf16 v[152:155], v[30:33], v[138:141], v[152:155]
    v_exp_f32 v160, v160
    v_mfma_f32_16x16x32_bf16 v[220:223], a[64:67], a[244:247], v[220:223]
    v_exp_f32 v161, v161
    v_mfma_f32_16x16x32_bf16 v[212:215], a[64:67], a[248:251], v[212:215]
    v_exp_f32 v162, v162
    v_mfma_f32_16x16x32_bf16 v[216:219], a[68:71], a[244:247], v[216:219]
    v_exp_f32 v163, v163
    v_mfma_f32_16x16x16_bf16 v[152:155], v[34:35], v[142:143], v[152:155]
    v_cvt_pk_bf16_f32 v178, v160, v161
    v_cvt_pk_bf16_f32 v179, v162, v163
    v_mfma_f32_16x16x32_bf16 v[208:211], a[68:71], a[248:251], v[208:211]
    ds_read_b128 v[160:163], v235
    v_cvt_pk_bf16_f32 v220, v220, v221
    v_mfma_f32_16x16x32_bf16 v[196:199], a[216:219], v[176:179], v[196:199]
    v_cvt_pk_bf16_f32 v221, v222, v223
    v_cvt_pk_bf16_f32 v222, v216, v217
    v_mfma_f32_16x16x32_bf16 v[184:187], v[66:69], v[176:179], v[184:187]
    v_cvt_pk_bf16_f32 v223, v218, v219
    v_cvt_pk_bf16_f32 v212, v212, v213
    v_mfma_f32_16x16x32_bf16 v[188:191], v[88:91], v[176:179], v[188:191]
    buffer_store_dwordx4 v[220:223], v243, s[20:23], s51 offen sc0 sc1
    v_mfma_f32_16x16x32_bf16 v[192:195], v[110:113], v[176:179], v[192:195]
    s_waitcnt lgkmcnt(1)
    v_cvt_pk_bf16_f32 v213, v214, v215
    v_cvt_pk_bf16_f32 v214, v208, v209
    v_mfma_f32_16x16x32_bf16 v[156:159], v[48:51], v[138:141], v[156:159]
    v_cvt_pk_bf16_f32 v215, v210, v211
    v_fma_f32 v165, v165, s37, -v236
    v_mfma_f32_16x16x32_bf16 v[204:207], a[252:255], a[244:247], v[204:207]
    v_fma_f32 v166, v166, s37, -v236
    v_fma_f32 v167, v167, s37, -v236
    v_mfma_f32_16x16x32_bf16 v[200:203], v[252:255], a[244:247], v[200:203]
    v_exp_f32 v164, v164
    v_mfma_f32_16x16x16_bf16 v[156:159], v[52:53], v[142:143], v[156:159]
    s_waitcnt lgkmcnt(0)
    v_exp_f32 v165, v165
    v_mfma_f32_16x16x32_bf16 v[160:163], v[54:57], v[138:141], v[160:163]
    v_exp_f32 v166, v166
    v_cvt_pk_bf16_f32 v204, v204, v205
    v_cvt_pk_bf16_f32 v205, v206, v207
    v_exp_f32 v167, v167
    v_cvt_pk_bf16_f32 v206, v200, v201
    v_cvt_pk_bf16_f32 v207, v202, v203
    v_mfma_f32_16x16x16_bf16 v[160:163], v[58:59], v[142:143], v[160:163]
    v_cvt_pk_bf16_f32 v180, v164, v165
    v_cvt_pk_bf16_f32 v181, v166, v167
    v_fma_f32 v168, v168, s37, -v236
    v_fma_f32 v169, v169, s37, -v236
    v_fma_f32 v170, v170, s37, -v236
    v_fma_f32 v171, v171, s37, -v236
    v_exp_f32 v168, v168
    v_exp_f32 v169, v169
    v_exp_f32 v170, v170
    buffer_store_dwordx4 v[212:215], v245, s[20:23], s51 offen sc0 sc1
    v_exp_f32 v171, v171
    v_cvt_pk_bf16_f32 v182, v168, v169
    v_cvt_pk_bf16_f32 v183, v170, v171
    v_max3_f32 v248, v172, v173, v174
    v_max3_f32 v249, v175, v144, v145
    v_mfma_f32_16x16x32_bf16 v[196:199], a[216:219], v[180:183], v[196:199]
    v_max3_f32 v248, v248, v146, v147
    v_max3_f32 v249, v249, v148, v149
    v_mfma_f32_16x16x32_bf16 v[184:187], v[70:73], v[180:183], v[184:187]
    v_max3_f32 v248, v248, v150, v151
    v_max3_f32 v249, v249, v152, v153
    v_mfma_f32_16x16x32_bf16 v[188:191], v[92:95], v[180:183], v[188:191]
    v_max3_f32 v248, v248, v154, v155
    v_max3_f32 v249, v249, v156, v157
    v_mfma_f32_16x16x32_bf16 v[192:195], v[114:117], v[180:183], v[192:195]
    v_rcp_f32 v197, v196
    v_max3_f32 v248, v248, v158, v159
    v_mul_f32 v184, v184, v197
    v_mul_f32 v185, v185, v197
    v_cvt_pk_bf16_f32 v184, v184, v185
    v_mul_f32 v186, v186, v197
    v_mul_f32 v187, v187, v197
    v_cvt_pk_bf16_f32 v185, v186, v187
    v_mul_f32 v188, v188, v197
    v_mul_f32 v189, v189, v197
    v_cvt_pk_bf16_f32 v186, v188, v189
    v_mul_f32 v190, v190, v197
    v_mul_f32 v191, v191, v197
    v_cvt_pk_bf16_f32 v187, v190, v191
    v_mul_f32 v192, v192, v197
    v_mul_f32 v193, v193, v197
    v_cvt_pk_bf16_f32 v188, v192, v193
    v_mul_f32 v194, v194, v197
    v_mul_f32 v195, v195, v197
    v_cvt_pk_bf16_f32 v189, v194, v195
    ds_write_b128 v237, v[184:187]
    buffer_store_dwordx4 v[204:207], v244, s[20:23], s51 offen sc0 sc1
    ds_write_b64 v238, v[188:189]
    s_add_u32 s51, s51, s48
    v_max3_f32 v249, v249, v160, v161
    v_max3_f32 v248, v248, v162, v163
    v_max_f32 v248, v248, v249
    v_mov_b32 v249, v248
    s_nop 1
    v_permlane16_swap_b32 v248, v249
    v_max_f32 v248, v248, v249
    v_mov_b32 v249, v248
    s_nop 1
    v_permlane32_swap_b32 v248, v249
    v_max_f32 v248, v248, v249
    v_mul_f32 v236, s37, v248
    v_fma_f32 v172, v172, s37, -v236
    v_fma_f32 v173, v173, s37, -v236
    v_fma_f32 v174, v174, s37, -v236
    v_fma_f32 v175, v175, s37, -v236
    v_exp_f32 v172, v172
    v_exp_f32 v173, v173
    v_exp_f32 v174, v174
    v_exp_f32 v175, v175
    v_cvt_pk_bf16_f32 v176, v172, v173
    v_cvt_pk_bf16_f32 v177, v174, v175
    v_fma_f32 v144, v144, s37, -v236
    v_fma_f32 v145, v145, s37, -v236
    v_fma_f32 v146, v146, s37, -v236
    v_fma_f32 v147, v147, s37, -v236
    v_exp_f32 v144, v144
    v_exp_f32 v145, v145
    s_waitcnt lgkmcnt(0)
    s_barrier
    ds_read_b128 a[236:239], v224
    ds_read_b128 a[240:243], v224 offset:1024
    v_exp_f32 v146, v146
    ds_read_b128 a[244:247], v224 offset:2048
    v_exp_f32 v147, v147
    ds_read_b128 a[248:251], v224 offset:3072
    ds_read_b128 a[252:255], v224 offset:4096
    v_cvt_pk_bf16_f32 v178, v144, v145
    v_cvt_pk_bf16_f32 v179, v146, v147
    v_fma_f32 v148, v148, s37, -v236
    ds_read_b128 v[252:255], v224 offset:5120
    v_mfma_f32_16x16x32_bf16 v[196:199], a[216:219], v[176:179], 0
    v_fma_f32 v149, v149, s37, -v236
    v_fma_f32 v150, v150, s37, -v236
    v_mfma_f32_16x16x32_bf16 v[184:187], v[76:79], v[176:179], 0
    v_fma_f32 v151, v151, s37, -v236
    v_fma_f32 v152, v152, s37, -v236
    v_mfma_f32_16x16x32_bf16 v[188:191], v[98:101], v[176:179], 0
    v_exp_f32 v148, v148
    v_mfma_f32_16x16x32_bf16 v[192:195], v[120:123], v[176:179], 0
    s_waitcnt lgkmcnt(5)
    v_exp_f32 v149, v149
    v_mfma_f32_16x16x32_bf16 v[220:223], a[220:223], a[236:239], 0
    v_exp_f32 v150, v150
    v_mfma_f32_16x16x32_bf16 v[216:219], a[224:227], a[236:239], 0
    v_exp_f32 v151, v151
    v_mfma_f32_16x16x32_bf16 v[212:215], a[228:231], a[236:239], 0
    v_cvt_pk_bf16_f32 v180, v148, v149
    v_cvt_pk_bf16_f32 v181, v150, v151
    v_mfma_f32_16x16x32_bf16 v[208:211], a[232:235], a[236:239], 0
    s_waitcnt lgkmcnt(3)
    ds_read_b128 a[236:239], v242 offset:61440
    v_fma_f32 v153, v153, s37, -v236
    v_mfma_f32_16x16x32_bf16 v[220:223], a[0:3], a[240:243], v[220:223]
    v_fma_f32 v154, v154, s37, -v236
    v_fma_f32 v155, v155, s37, -v236
    v_mfma_f32_16x16x32_bf16 v[216:219], a[4:7], a[240:243], v[216:219]
    v_exp_f32 v152, v152
    v_mfma_f32_16x16x32_bf16 v[212:215], a[8:11], a[240:243], v[212:215]
    v_exp_f32 v153, v153
    v_mfma_f32_16x16x32_bf16 v[208:211], a[12:15], a[240:243], v[208:211]
    ds_read_b128 a[240:243], v242 offset:61952
    v_cvt_pk_bf16_f32 v182, v152, v153
    v_mfma_f32_16x16x32_bf16 v[220:223], a[16:19], a[244:247], v[220:223]
    v_exp_f32 v154, v154
    v_mfma_f32_16x16x32_bf16 v[216:219], a[20:23], a[244:247], v[216:219]
    v_exp_f32 v155, v155
    v_mfma_f32_16x16x32_bf16 v[212:215], a[24:27], a[244:247], v[212:215]
    v_cvt_pk_bf16_f32 v183, v154, v155
    v_fma_f32 v156, v156, s37, -v236
    v_mfma_f32_16x16x32_bf16 v[208:211], a[28:31], a[244:247], v[208:211]
    v_fma_f32 v157, v157, s37, -v236
    v_fma_f32 v158, v158, s37, -v236
    v_mfma_f32_16x16x32_bf16 v[196:199], a[216:219], v[180:183], v[196:199]
    v_fma_f32 v159, v159, s37, -v236
    v_fma_f32 v160, v160, s37, -v236
    v_mfma_f32_16x16x32_bf16 v[184:187], v[68:71], v[180:183], v[184:187]
    v_exp_f32 v156, v156
    v_mfma_f32_16x16x32_bf16 v[188:191], v[90:93], v[180:183], v[188:191]
    v_exp_f32 v157, v157
    v_mfma_f32_16x16x32_bf16 v[192:195], v[112:115], v[180:183], v[192:195]
    s_waitcnt lgkmcnt(1)
    v_exp_f32 v158, v158
    v_mfma_f32_16x16x32_bf16 v[220:223], a[32:35], a[248:251], v[220:223]
    v_exp_f32 v159, v159
    v_mfma_f32_16x16x32_bf16 v[216:219], a[36:39], a[248:251], v[216:219]
    v_cvt_pk_bf16_f32 v176, v156, v157
    v_cvt_pk_bf16_f32 v177, v158, v159
    v_mfma_f32_16x16x32_bf16 v[212:215], a[40:43], a[248:251], v[212:215]
    v_fma_f32 v161, v161, s37, -v236
    v_fma_f32 v162, v162, s37, -v236
    v_mfma_f32_16x16x32_bf16 v[208:211], a[44:47], a[248:251], v[208:211]
    v_fma_f32 v163, v163, s37, -v236
    v_mfma_f32_16x16x32_bf16 v[220:223], a[48:51], a[252:255], v[220:223]
    v_exp_f32 v160, v160
    v_mfma_f32_16x16x32_bf16 v[216:219], a[52:55], a[252:255], v[216:219]
    v_exp_f32 v161, v161
    v_mfma_f32_16x16x32_bf16 v[212:215], a[56:59], a[252:255], v[212:215]
    v_exp_f32 v162, v162
    v_mfma_f32_16x16x32_bf16 v[208:211], a[60:63], a[252:255], v[208:211]
    v_exp_f32 v163, v163
    v_mfma_f32_16x16x32_bf16 v[220:223], a[64:67], v[252:255], v[220:223]
    v_cvt_pk_bf16_f32 v178, v160, v161
    v_cvt_pk_bf16_f32 v179, v162, v163
    v_mfma_f32_16x16x32_bf16 v[216:219], a[68:71], v[252:255], v[216:219]
    v_mfma_f32_16x16x32_bf16 v[212:215], a[236:239], v[252:255], v[212:215]
    v_mfma_f32_16x16x32_bf16 v[196:199], a[216:219], v[176:179], v[196:199]
    v_mfma_f32_16x16x32_bf16 v[184:187], v[82:85], v[176:179], v[184:187]
    v_mfma_f32_16x16x32_bf16 v[188:191], v[104:107], v[176:179], v[188:191]
    v_mfma_f32_16x16x32_bf16 v[192:195], v[126:129], v[176:179], v[192:195]
    s_waitcnt lgkmcnt(0)
    v_cvt_pk_bf16_f32 v220, v220, v221
    v_cvt_pk_bf16_f32 v221, v222, v223
    v_mfma_f32_16x16x32_bf16 v[208:211], a[240:243], v[252:255], v[208:211]
    v_cvt_pk_bf16_f32 v222, v216, v217
    v_cvt_pk_bf16_f32 v223, v218, v219
    buffer_store_dwordx4 v[220:223], v225, s[20:23], s51 offen sc0 sc1
    v_cvt_pk_bf16_f32 v212, v212, v213
    v_cvt_pk_bf16_f32 v213, v214, v215
    v_rcp_f32 v197, v196
    s_nop 0
    v_mul_f32 v184, v184, v197
    v_cvt_pk_bf16_f32 v214, v208, v209
    v_cvt_pk_bf16_f32 v215, v210, v211
    v_mul_f32 v185, v185, v197
    v_cvt_pk_bf16_f32 v184, v184, v185
    v_mul_f32 v186, v186, v197
    v_mul_f32 v187, v187, v197
    v_cvt_pk_bf16_f32 v185, v186, v187
    v_mul_f32 v188, v188, v197
    v_mul_f32 v189, v189, v197
    v_cvt_pk_bf16_f32 v186, v188, v189
    v_mul_f32 v190, v190, v197
    v_mul_f32 v191, v191, v197
    v_cvt_pk_bf16_f32 v187, v190, v191
    v_mul_f32 v192, v192, v197
    v_mul_f32 v193, v193, v197
    v_cvt_pk_bf16_f32 v188, v192, v193
    v_mul_f32 v194, v194, v197
    v_mul_f32 v195, v195, v197
    v_cvt_pk_bf16_f32 v189, v194, v195
    ds_write_b128 v237, v[184:187] offset:6144
    ds_write_b64 v238, v[188:189] offset:6144
    buffer_store_dwordx4 v[212:215], v226, s[20:23], s51 offen sc0 sc1
    s_waitcnt lgkmcnt(0)
    s_barrier
    ds_read_b128 a[244:247], v227
    ds_read_b128 a[248:251], v227 offset:1024
    ds_read_b128 a[252:255], v227 offset:2048
    ds_read_b128 v[252:255], v227 offset:3072
    ds_read_b128 a[236:239], v227 offset:4096
    ds_read_b128 a[240:243], v227 offset:5120
    s_waitcnt lgkmcnt(5)
    v_mfma_f32_16x16x32_bf16 v[204:207], a[220:223], a[244:247], 0
    v_mfma_f32_16x16x32_bf16 v[200:203], a[224:227], a[244:247], 0
    v_mfma_f32_16x16x32_bf16 v[220:223], a[228:231], a[244:247], 0
    v_mfma_f32_16x16x32_bf16 v[216:219], a[232:235], a[244:247], 0
    s_waitcnt lgkmcnt(3)
    ds_read_b128 a[244:247], v242 offset:61440
    v_mfma_f32_16x16x32_bf16 v[204:207], a[0:3], a[248:251], v[204:207]
    v_mfma_f32_16x16x32_bf16 v[200:203], a[4:7], a[248:251], v[200:203]
    v_mfma_f32_16x16x32_bf16 v[220:223], a[8:11], a[248:251], v[220:223]
    v_mfma_f32_16x16x32_bf16 v[216:219], a[12:15], a[248:251], v[216:219]
    ds_read_b128 a[248:251], v242 offset:61952
    v_mfma_f32_16x16x32_bf16 v[204:207], a[16:19], a[252:255], v[204:207]
    v_mfma_f32_16x16x32_bf16 v[200:203], a[20:23], a[252:255], v[200:203]
    v_mfma_f32_16x16x32_bf16 v[220:223], a[24:27], a[252:255], v[220:223]
    v_mfma_f32_16x16x32_bf16 v[216:219], a[28:31], a[252:255], v[216:219]
    s_waitcnt lgkmcnt(2)
    v_mfma_f32_16x16x32_bf16 v[204:207], a[32:35], v[252:255], v[204:207]
    v_mfma_f32_16x16x32_bf16 v[200:203], a[36:39], v[252:255], v[200:203]
    v_mfma_f32_16x16x32_bf16 v[220:223], a[40:43], v[252:255], v[220:223]
    v_mfma_f32_16x16x32_bf16 v[216:219], a[44:47], v[252:255], v[216:219]
    v_mfma_f32_16x16x32_bf16 v[204:207], a[48:51], a[236:239], v[204:207]
    v_mfma_f32_16x16x32_bf16 v[200:203], a[52:55], a[236:239], v[200:203]
    v_mfma_f32_16x16x32_bf16 v[220:223], a[56:59], a[236:239], v[220:223]
    v_mfma_f32_16x16x32_bf16 v[216:219], a[60:63], a[236:239], v[216:219]
    v_mfma_f32_16x16x32_bf16 v[204:207], a[64:67], a[240:243], v[204:207]
    v_mfma_f32_16x16x32_bf16 v[200:203], a[68:71], a[240:243], v[200:203]
    s_waitcnt lgkmcnt(0)
    v_mfma_f32_16x16x32_bf16 v[220:223], a[244:247], a[240:243], v[220:223]
    v_mfma_f32_16x16x32_bf16 v[216:219], a[248:251], a[240:243], v[216:219]
    s_nop 4
    v_cvt_pk_bf16_f32 v204, v204, v205
    v_cvt_pk_bf16_f32 v205, v206, v207
    v_cvt_pk_bf16_f32 v206, v200, v201
    v_cvt_pk_bf16_f32 v207, v202, v203
    buffer_store_dwordx4 v[204:207], v246, s[20:23], s51 offen sc0 sc1
    v_cvt_pk_bf16_f32 v220, v220, v221
    v_cvt_pk_bf16_f32 v221, v222, v223
    v_cvt_pk_bf16_f32 v222, v216, v217
    v_cvt_pk_bf16_f32 v223, v218, v219
    buffer_store_dwordx4 v[220:223], v247, s[20:23], s51 offen sc0 sc1
    s_endpgm
.section .rodata,"a"
.p2align 6
.amdhsa_kernel standalone__neighborhood_dinat__vision_kernel
  .amdhsa_next_free_vgpr 512
  .amdhsa_next_free_sgpr 102
  .amdhsa_accum_offset 256
  .amdhsa_group_segment_fixed_size 0
  .amdhsa_kernarg_size 56
  .amdhsa_user_sgpr_count 2
  .amdhsa_user_sgpr_kernarg_segment_ptr 1
  .amdhsa_system_sgpr_workgroup_id_x 1
.end_amdhsa_kernel
```

```asm
; @launch grid=(256,1,1) block=(256,1,1) lds=163344
.amdgcn_target "amdgcn-amd-amdhsa--gfx950"
.text
.globl standalone__neighborhood_dinat__vision_kernel
.p2align 8
.type standalone__neighborhood_dinat__vision_kernel,@function
standalone__neighborhood_dinat__vision_kernel:
    s_cmp_ge_u32 s2, 256
    s_cbranch_scc1 L_exit
L_go:
    s_load_dwordx2 s[8:9], s[0:1], 8
    s_load_dwordx2 s[4:5], s[0:1], 0
    s_load_dwordx2 s[16:17], s[0:1], 24
    s_load_dwordx2 s[12:13], s[0:1], 16
    s_load_dwordx2 s[20:21], s[0:1], 32
    s_getpc_b64 s[24:25]
    s_mov_b32 s26, L_end-L_go-64
    s_mov_b32 s27, 0x20000
    s_lshl_b32 s52, s2, 10
    v_lshlrev_b32 v189, 5, v0
    s_and_b32 s53, s52, 0xe000
    buffer_load_dword v188, v189, s[24:27], s53 offen
    v_lshrrev_b32 v74, 6, v0
    v_and_b32 v60, 63, v0
    v_readfirstlane_b32 s36, v74
    v_mul_u32_u24 v76, 0x2aab, v60
    v_lshrrev_b32 v76, 16, v76
    v_mul_u32_u24 v74, 6, v76
    v_sub_u32 v77, v60, v74
    v_lshrrev_b32 v74, 1, v76
    v_and_b32 v74, 4, v74
    v_xor_b32 v76, v76, v74
    v_mul_u32_u24 v74, 0x480, v76
    v_lshl_add_u32 v251, v77, 4, v74
    v_add_u32 v79, 64, v60
    v_mul_u32_u24 v78, 0x2aab, v79
    v_lshrrev_b32 v78, 16, v78
    v_mul_u32_u24 v74, 6, v78
    v_sub_u32 v79, v60, v74
    v_lshrrev_b32 v74, 1, v78
    v_and_b32 v74, 4, v74
    v_xor_b32 v78, v78, v74
    v_mul_u32_u24 v74, 0x480, v78
    v_lshl_add_u32 v252, v79, 4, v74
    v_add_u32 v81, 0x80, v60
    v_mul_u32_u24 v80, 0x2aab, v81
    v_lshrrev_b32 v80, 16, v80
    v_mul_u32_u24 v74, 6, v80
    v_sub_u32 v81, v60, v74
    v_lshrrev_b32 v74, 1, v80
    v_and_b32 v74, 4, v74
    v_xor_b32 v80, v80, v74
    v_mul_u32_u24 v74, 0x480, v80
    v_lshl_add_u32 v253, v81, 4, v74
    s_mul_i32 s49, s36, 0x60
    s_mul_i32 s50, s36, 0xc00
    s_add_u32 s50, s50, 0x15e00
    s_mov_b32 s10, 0x36000
    s_mov_b32 s11, 0x20000
    s_mov_b32 s6, 0x1260400
    s_mov_b32 s7, 0x20000
    s_mov_b32 s18, 0x548
    s_mov_b32 s19, 0x20000
    s_mov_b32 s14, 0x12000
    s_mov_b32 s15, 0x20000
    s_mov_b32 s22, 0x1260000
    s_mov_b32 s23, 0x20000
    s_and_b32 s53, s52, 0x3e000
    s_mul_i32 s58, s36, 0x152
    v_lshlrev_b32 v199, 1, v60
    s_add_u32 s57, s49, 0x180
    s_add_u32 m0, s50, 0
    s_bfe_u32 s35, s2, 0x30003
    s_lshr_b32 s55, s2, 6
    s_and_b32 s54, s2, 1
    s_lshl2_add_u32 s34, s54, s55
    s_and_b32 s46, s55, 1
    s_bfe_u32 s54, s2, 0x10002
    s_mul_i32 s54, s54, 0x15000
    s_bfe_u32 s55, s2, 0x10001
    s_mul_i32 s55, s55, 0x180
    s_add_u32 s38, s54, s55
    s_lshl_b32 s41, s36, 11
    s_min_u32 s41, s41, 0x1600
    s_mul_i32 s54, s35, 14
    s_sub_u32 s54, s54, 3
    s_lshr_b32 s55, s41, 4
    v_add_u32 v99, s55, v60
    v_mov_b32 v100, 0x8000
    v_mul_u32_u24 v97, 0xaab, v99
    v_lshrrev_b32 v97, 16, v97
    v_mul_u32_u24 v98, 24, v97
    v_sub_u32 v96, v99, v98
    v_and_or_b32 v98, 2, v97, 64
    v_xor_b32 v96, v96, v98
    v_add_u32 v97, s54, v97
    v_add_u32 v99, 64, v99
    s_mul_i32 s51, s34, 0x24c000
    s_add_u32 s51, s51, s38
    s_mul_i32 s55, s46, 0x222000
    s_add_u32 s56, s51, s55
    s_waitcnt lgkmcnt(0)
    buffer_load_dword v188, v189, s[8:11], s53 offen
    buffer_load_ushort v196, v199, s[16:19], s58 offen
    buffer_load_ushort v197, v199, s[16:19], s58 offen offset:128
    buffer_load_ushort v198, v199, s[16:19], s58 offen offset:256
    buffer_load_dwordx4 v251, s[8:11], s57 offen lds
    s_movk_i32 s53, 0x6f
    v_cmp_lt_u32 vcc, s53, v97
    s_sub_u32 s4, s4, 0x400
    s_subb_u32 s5, s5, 0
    s_mul_i32 s42, s46, 0xfffac000
    v_cndmask_b32 v97, v97, v100, vcc
    buffer_load_dwordx4 v252, s[8:11], s57 offen offset:1024 lds
    v_mul_u32_u24 v97, 0x300, v97
    v_lshl_add_u32 v246, v96, 4, v97
    v_mul_u32_u24 v97, 0xaab, v99
    v_lshrrev_b32 v97, 16, v97
    v_mul_u32_u24 v98, 24, v97
    v_sub_u32 v96, v99, v98
    v_and_b32 v98, 2, v97
    v_xor_b32 v96, v96, v98
    buffer_load_dwordx4 v253, s[8:11], s57 offen offset:2048 lds
    v_add_u32 v97, s54, v97
    v_cmp_lt_u32 vcc, s53, v97
    s_add_u32 s42, s42, 0x2a000
    s_mul_i32 s55, s46, 7
    v_cndmask_b32 v97, v97, v100, vcc
    v_mul_u32_u24 v97, 0x300, v97
    v_lshl_add_u32 v247, v96, 4, v97
    s_cmp_eq_u32 s34, s55
    s_cselect_b32 s43, 5, -3
    s_cselect_b32 s45, 0, -1
    s_cselect_b32 s47, 1, 0
    s_mul_i32 s43, s43, s42
    s_add_u32 s43, s43, s56
    s_mul_i32 s45, s45, s42
    s_add_u32 s45, s45, s56
    s_add_u32 s44, s43, s42
    s_cmp_eq_u32 s47, 1
    s_cmov_b32 s45, 0x2000000
    s_add_u32 m0, s41, 0
    s_add_u32 s57, s49, 0x9180
    buffer_load_dwordx4 v246, s[4:7], s43 offen lds
    s_and_b32 s52, s52, 0x1e000
    v_lshrrev_b32 v61, 4, v60
    buffer_load_dwordx4 v247, s[4:7], s43 offen offset:1024 lds
    s_add_u32 m0, s41, 0x1e40
    v_and_b32 v62, 7, v60
    v_bfe_u32 v63, v60, 3, 1
    v_bfe_u32 v96, v60, 2, 2
    v_and_b32 v97, 3, v60
    v_and_b32 v103, 1, v61
    v_lshl_add_u32 v99, v61, 3, v96
    v_lshl_add_u32 v99, v103, 2, v99
    buffer_load_dwordx4 v246, s[4:7], s44 offen lds
    v_lshl_add_u32 v101, v97, 3, s50
    s_movk_i32 s27, 0x60
    v_mad_u32_u24 v254, v99, s27, v101
    v_xor_b32 v99, 4, v99
    v_mad_u32_u24 v255, v99, s27, v101
    v_mul_u32_u24 v102, 0x1e40, v63
    v_and_b32 v98, 2, v60
    v_xor_b32 v98, v98, v61
    buffer_load_dwordx4 v247, s[4:7], s44 offen offset:1024 lds
    s_add_u32 m0, s41, 0x3c80
    v_lshlrev_b32 v98, 4, v98
    v_mul_u32_u24 v100, 0x180, v62
    v_add3_u32 v224, v98, v100, v102
    v_mul_u32_u24 v99, 0x1e40, v96
    v_mul_u32_u24 v227, 0x180, v97
    v_add3_u32 v227, v227, v98, v99
    s_cmp_eq_u32 s35, 0
    s_cselect_b32 s29, 3, 0
    s_cselect_b32 s30, -3, -2
    buffer_load_dwordx4 v246, s[4:7], s45 offen lds
    s_mul_i32 s32, s36, 0xf00
    s_add_u32 s32, s32, 0xf200
    s_mov_b32 s40, 0x140
    s_lshl_b32 s31, s36, 10
    s_add_u32 s31, s31, 0x12e40
    v_mul_u32_u24 v119, 13, v60
    v_lshrrev_b32 v119, 8, v119
    v_mul_u32_u24 v118, 20, v119
    v_sub_u32 v118, v60, v118
    v_add_u32 v120, -11, v118
    buffer_load_dwordx4 v247, s[4:7], s45 offen offset:1024 lds
    s_add_u32 m0, s41, 0x5ac0
    v_max_i32 v120, 0, v120
    v_mul_u32_u24 v121, 11, v120
    v_lshrrev_b32 v121, 5, v121
    v_mul_u32_u24 v122, 3, v121
    v_sub_u32 v120, v120, v122
    v_lshlrev_b32 v120, 2, v120
    v_sub_u32 v121, v120, v121
    buffer_load_dwordx4 v246, s[4:7], s56 offen lds
    v_cmp_lt_u32 vcc, 10, v118
    v_add_u32 v121, s29, v121
    v_add_u32 v120, s30, v120
    v_add_u32 v122, -3, v118
    v_cndmask_b32 v121, v118, v121, vcc
    v_cndmask_b32 v120, v122, v120, vcc
    v_cmp_gt_u32 s[60:61], 7, v120
    buffer_load_dwordx4 v247, s[4:7], s56 offen offset:1024 lds
    s_add_u32 m0, s50, 0x3000
    s_add_u32 s56, s56, s42
    v_add_u32 v120, 1, v120
    v_cmp_gt_u32 s[62:63], 7, v120
    v_add_u32 v120, 1, v120
    v_cmp_gt_u32 s[64:65], 7, v120
    v_add_u32 v120, 1, v120
    v_cmp_gt_u32 s[66:67], 7, v120
    s_cmp_eq_u32 s46, 0
    s_cselect_b32 s28, 13, -13
    s_cselect_b32 s69, 0, 39
    buffer_load_dwordx4 v251, s[8:11], s57 offen lds
    v_add_u32 v119, 2, v119
    v_mad_i32_i24 v121, v119, s28, v121
    s_lshl4_add_u32 s69, s69, s31
    v_lshl_add_u32 v121, v121, 2, s69
    s_mul_i32 s69, s28, 12
    v_add_u32 v118, s69, v121
    v_add_u32 v119, s69, v118
    s_lshl_b32 s69, s28, 3
    v_add_u32 v122, s69, v119
    buffer_load_dwordx4 v252, s[8:11], s57 offen offset:1024 lds
    v_lshl_add_u32 v123, v60, 4, s32
    v_lshl_add_u32 v125, v60, 2, s31
    s_mov_b32 s68, 0x3fb8aa3b
    v_mul_u32_u24 v74, 0x180, v76
    v_lshl_add_u32 v192, v77, 4, v74
    v_mul_u32_u24 v74, 0x180, v78
    v_lshl_add_u32 v193, v79, 4, v74
    v_mul_u32_u24 v74, 0x180, v80
    buffer_load_dwordx4 v253, s[8:11], s57 offen offset:2048 lds
    s_add_u32 s57, s49, 0x12180
    v_lshl_add_u32 v194, v81, 4, v74
    v_and_b32 v74, 16, v78
    v_mul_u32_u24 v74, 0x300, v74
    v_add_u32 v195, v74, v193
    v_add_u32 v98, 3, v62
    v_and_b32 v98, 2, v98
    v_xor_b32 v98, v98, v61
    v_lshl_add_u32 v98, v98, 4, v100
    v_add_u32 v225, v98, v102
    v_xor_b32 v99, 1, v63
    v_mul_u32_u24 v99, 0xd3c0, v99
    v_add_u32 v226, v98, v99
    s_mov_b32 s37, 0x3e553b95
    s_cmp_eq_u32 s35, 7
    s_cselect_b32 s33, 2, 64
    v_lshrrev_b32 v184, 1, v61
    v_lshl_add_u32 v185, v63, 1, v184
    v_lshlrev_b32 v232, 2, v185
    v_lshl_add_u32 v185, v63, 2, v61
    v_lshlrev_b32 v233, 2, v185
    v_sub_u32 v184, v184, v63
    v_mul_i32_i24 v184, 0x140, v184
    s_sub_u32 s24, s32, 0x140
    v_add_u32 v184, s24, v184
    v_lshl_add_u32 v185, v103, 2, 3
    v_cmp_gt_u32 vcc, s29, v62
    v_sub_u32 v186, v185, v62
    v_min_u32 v187, 10, v186
    v_mad_u32_u24 v190, v62, 3, v103
    v_add_u32 v191, 11, v190
    v_cndmask_b32 v187, v187, v191, vcc
    v_lshl_add_u32 v228, v187, 4, v184
    v_add_u32 v186, 8, v186
    v_min_u32 v187, 10, v186
    v_lshl_add_u32 v186, v103, 4, v62
    v_cmp_gt_u32 vcc, s29, v186
    v_add_u32 v191, 13, v190
    v_min_u32 v186, 5, v62
    v_cndmask_b32 v187, v187, v191, vcc
    v_lshl_add_u32 v229, v187, 4, v184
    v_cmp_lt_u32 vcc, s33, v186
    v_sub_u32 v187, v185, v186
    v_min_u32 v187, 10, v187
    v_mad_u32_u24 v190, v186, 3, 2
    v_add_u32 v191, v190, v103
    v_cndmask_b32 v185, v187, v191, vcc
    v_sub_u32 v187, 11, v186
    v_min_u32 v187, 10, v187
    v_add_u32 v191, 2, v190
    v_cndmask_b32 v187, v187, v191, vcc
    v_cmp_lt_u32 vcc, 5, v62
    v_mul_u32_u24 v191, 10, v103
    v_mov_b32 v190, 10
    v_cndmask_b32 v185, v185, v191, vcc
    v_cndmask_b32 v187, v187, v190, vcc
    v_lshl_add_u32 v230, v185, 4, v184
    v_lshl_add_u32 v231, v187, 4, s32
    v_mov_b32 v96, 0x3f803f80
    v_cmp_eq_u32 vcc, 0, v97
    v_mov_b32 v236, 1.0
    s_mov_b32 s69, 0x32104321
    v_cndmask_b32 v96, 0, v96, vcc
    v_accvgpr_write_b32 a216, v96
    v_accvgpr_write_b32 a217, v96
    v_accvgpr_write_b32 a218, v96
    v_accvgpr_write_b32 a219, v96
    s_and_b32 s24, s36, 1
    s_lshr_b32 s27, s36, 1
    v_lshlrev_b32 v163, 4, v60
    s_mul_i32 s25, s27, 0xc00
    s_add_u32 s25, s25, 0x12e00
    s_lshl_b32 s26, s24, 11
    s_add_u32 s26, s26, s25
    v_add_u32 v237, s26, v163
    s_lshl3_add_u32 s26, s24, s25
    s_add_u32 s26, s26, 0x400
    v_add_u32 v238, s26, v163
    s_mul_i32 s25, s24, 0x1800
    s_add_u32 s26, s25, 0x12e00
    v_add_u32 v239, s26, v163
    s_sub_u32 s25, 0x14600, s25
    v_add_u32 v240, s25, v163
    v_lshrrev_b32 v163, 2, v60
    v_and_b32 v161, 3, v60
    v_and_b32 v162, 2, v61
    v_lshlrev_b32 v162, 1, v162
    v_xor_b32 v163, v163, v162
    v_mul_u32_u24 v163, 0x60, v163
    v_lshl_add_u32 v108, v161, 4, v163
    v_lshrrev_b32 v162, 1, v161
    v_mul_u32_u24 v162, 0xba0, v162
    s_mul_i32 s26, s27, 0x1800
    s_add_u32 s26, s26, 0x15e40
    v_add3_u32 v109, v108, v162, s26
    s_lshl_b32 s25, s24, 5
    v_bfrev_b32 v162, v161
    v_lshrrev_b32 v162, 27, v162
    v_add3_u32 v86, v163, v162, s50
    v_lshlrev_b32 v163, 7, v61
    v_lshl_add_u32 v163, v62, 4, v163
    v_lshl_add_u32 v162, v63, 9, v163
    v_add_u32 v87, s50, v162
    v_lshl_add_u32 v163, v63, 10, v163
    s_add_u32 s26, s26, 0x7c0
    v_add_u32 v242, s26, v163
    s_lshl_b32 s26, s24, 10
    s_add_u32 s26, s26, s50
    v_add_u32 v241, s26, v163
    v_xor_b32 v163, s46, v63
    v_mul_u32_u24 v163, 0x2a000, v163
    v_mul_u32_u24 v162, 0x300, v62
    v_lshl_add_u32 v163, v61, 4, v163
    v_cmp_lt_u32 vcc, 5, v62
    v_add_u32 v163, v163, v162
    v_add_u32 v162, 0x1800, v163
    v_bfrev_b32 v164, 1
    v_cndmask_b32 v162, v162, v164, vcc
    s_sub_u32 s59, 0, s24
    s_mov_b32 vcc_lo, s59
    s_mov_b32 vcc_hi, s59
    v_cndmask_b32 v164, v163, v162, vcc
    v_cndmask_b32 v165, v162, v163, vcc
    s_mov_b32 vcc_lo, s59
    s_mov_b32 vcc_hi, s59
    v_lshrrev_b32 v160, 31, v164
    v_lshl_add_u32 v239, v160, 20, v239
    v_lshrrev_b32 v160, 31, v165
    v_lshl_add_u32 v240, v160, 20, v240
    s_mul_i32 s26, s27, 0xc0
    s_add_u32 s26, s26, 64
    v_add_u32 v244, s26, v164
    s_lshl_b32 s48, s42, 1
    s_mov_b64 exec, 0
    s_cmp_eq_u32 s36, 0
    s_cbranch_scc1 L_pg1
    s_cmp_eq_u32 s36, 1
    s_cbranch_scc1 L_pg2
    s_cmp_eq_u32 s36, 2
    s_cbranch_scc1 L_pg3
    s_branch L_pg4
    .p2align 12
L_back:
    s_mov_b64 exec, -1
    s_add_u32 m0, s50, 0x6000
    s_waitcnt vmcnt(11)
    ds_read_b64_tr_b16 a[0:1], v254
    ds_read_b64_tr_b16 a[2:3], v255
    ds_read_b64_tr_b16 a[4:5], v254 offset:32
    ds_read_b64_tr_b16 a[6:7], v255 offset:32
    ds_read_b64_tr_b16 a[8:9], v254 offset:64
    ds_read_b64_tr_b16 a[10:11], v255 offset:64
    s_waitcnt vmcnt(3)
    s_barrier
    buffer_load_dwordx4 v251, s[8:11], s57 offen lds
    buffer_load_dwordx4 v252, s[8:11], s57 offen offset:1024 lds
    ds_read_b128 a[236:239], v224
    ds_read_b128 a[240:243], v224 offset:3072
    ds_read_b128 a[244:247], v224 offset:15488
    ds_read_b128 a[248:251], v224 offset:18560
    ds_read_b128 a[252:255], v227 offset:6144
    buffer_load_dwordx4 v253, s[8:11], s57 offen offset:2048 lds
    s_add_u32 s57, s49, 0x1b180
    s_add_u32 m0, s50, 0x9000
    ds_read_b128 a[220:223], v224 offset:64
    ds_read_b128 a[224:227], v224 offset:3136
    ds_read_b128 a[228:231], v224 offset:15552
    s_waitcnt lgkmcnt(7)
    v_mfma_f32_16x16x32_bf16 v[12:15], a[0:3], a[236:239], 0
    ds_read_b128 a[232:235], v224 offset:18624
    v_mfma_f32_16x16x32_bf16 v[16:19], a[4:7], a[236:239], 0
    buffer_load_dwordx4 v251, s[8:11], s57 offen lds
    v_mfma_f32_16x16x32_bf16 v[20:23], a[8:11], a[236:239], 0
    s_waitcnt lgkmcnt(7)
    ds_read_b128 a[236:239], v227 offset:6208
    v_mfma_f32_16x16x32_bf16 v[36:39], a[0:3], a[240:243], 0
    v_mfma_f32_16x16x32_bf16 v[40:43], a[4:7], a[240:243], 0
    s_waitcnt vmcnt(4)
    ds_read_b64_tr_b16 a[12:13], v254 offset:12288
    ds_read_b64_tr_b16 a[14:15], v255 offset:12288
    v_mfma_f32_16x16x32_bf16 v[44:47], a[8:11], a[240:243], 0
    s_waitcnt lgkmcnt(7)
    buffer_load_dwordx4 v252, s[8:11], s57 offen offset:1024 lds
    v_mfma_f32_16x16x32_bf16 v[132:135], a[0:3], a[244:247], 0
    ds_read_b64_tr_b16 a[16:17], v254 offset:12320
    ds_read_b64_tr_b16 a[18:19], v255 offset:12320
    v_mfma_f32_16x16x32_bf16 v[136:139], a[4:7], a[244:247], 0
    ds_read_b64_tr_b16 a[20:21], v254 offset:12352
    ds_read_b64_tr_b16 a[22:23], v255 offset:12352
    v_mfma_f32_16x16x32_bf16 v[140:143], a[8:11], a[244:247], 0
    ds_read_b128 a[240:243], v224 offset:128
    ds_read_b128 a[244:247], v224 offset:3200
    v_mfma_f32_16x16x32_bf16 v[220:223], a[0:3], a[248:251], 0
    v_mfma_f32_16x16x32_bf16 v[216:219], a[4:7], a[248:251], 0
    buffer_load_dwordx4 v253, s[8:11], s57 offen offset:2048 lds
    v_mfma_f32_16x16x32_bf16 v[212:215], a[8:11], a[248:251], 0
    s_add_u32 s57, s49, 0x24180
    ds_read_b128 a[248:251], v224 offset:15616
    s_add_u32 m0, s50, 0xc000
    v_mfma_f32_16x16x32_bf16 v[208:211], a[0:3], a[252:255], 0
    v_mfma_f32_16x16x32_bf16 v[204:207], a[4:7], a[252:255], 0
    v_mfma_f32_16x16x32_bf16 v[200:203], a[8:11], a[252:255], 0
    s_waitcnt lgkmcnt(5)
    buffer_load_dwordx4 v251, s[8:11], s57 offen lds
    v_mfma_f32_16x16x32_bf16 v[12:15], a[12:15], a[220:223], v[12:15]
    ds_read_b128 a[252:255], v224 offset:18688
    v_mfma_f32_16x16x32_bf16 v[16:19], a[16:19], a[220:223], v[16:19]
    s_waitcnt lgkmcnt(3)
    v_mfma_f32_16x16x32_bf16 v[20:23], a[20:23], a[220:223], v[20:23]
    ds_read_b128 a[220:223], v227 offset:6272
    v_mfma_f32_16x16x32_bf16 v[36:39], a[12:15], a[224:227], v[36:39]
    buffer_load_dwordx4 v252, s[8:11], s57 offen offset:1024 lds
    v_mfma_f32_16x16x32_bf16 v[40:43], a[16:19], a[224:227], v[40:43]
    v_mfma_f32_16x16x32_bf16 v[44:47], a[20:23], a[224:227], v[44:47]
    ds_read_b128 a[224:227], v224 offset:192
    v_mfma_f32_16x16x32_bf16 v[132:135], a[12:15], a[228:231], v[132:135]
    v_mfma_f32_16x16x32_bf16 v[136:139], a[16:19], a[228:231], v[136:139]
    buffer_load_dwordx4 v253, s[8:11], s57 offen offset:2048 lds
    v_mfma_f32_16x16x32_bf16 v[140:143], a[20:23], a[228:231], v[140:143]
    s_add_u32 s57, s49, 0x2d180
    ds_read_b128 a[228:231], v224 offset:3264
    s_add_u32 m0, s50, 0xf000
    v_mfma_f32_16x16x32_bf16 v[220:223], a[12:15], a[232:235], v[220:223]
    v_lshlrev_b32 v196, 16, v196
    v_mul_f32 v196, s68, v196
    v_mfma_f32_16x16x32_bf16 v[216:219], a[16:19], a[232:235], v[216:219]
    s_and_b32 s72, s60, 0xfff00000
    ds_write_b32 v125, v196
    v_mfma_f32_16x16x32_bf16 v[212:215], a[20:23], a[232:235], v[212:215]
    s_and_b32 s70, s62, 0xfff00000
    ds_read_b128 a[232:235], v224 offset:15680
    v_lshlrev_b32 v197, 16, v197
    v_mfma_f32_16x16x32_bf16 v[208:211], a[12:15], a[236:239], v[208:211]
    buffer_load_dwordx4 v251, s[8:11], s57 offen lds
    v_mfma_f32_16x16x32_bf16 v[204:207], a[16:19], a[236:239], v[204:207]
    v_mul_f32 v197, s68, v197
    v_lshlrev_b32 v198, 16, v198
    v_mfma_f32_16x16x32_bf16 v[200:203], a[20:23], a[236:239], v[200:203]
    s_waitcnt vmcnt(7)
    ds_read_b128 a[236:239], v224 offset:18752
    ds_write_b32 v125, v197 offset:256
    v_mul_f32 v198, s68, v198
    ds_write_b32 v125, v198 offset:512
    buffer_load_dwordx4 v252, s[8:11], s57 offen offset:1024 lds
    v_mov_b32 v124, 0xf149f2ca
    ds_read2_b32 v[144:145], v121 offset0:0 offset1:1
    ds_read_b64_tr_b16 a[24:25], v254 offset:24576
    ds_read_b64_tr_b16 a[26:27], v255 offset:24576
    ds_read_b64_tr_b16 a[28:29], v254 offset:24608
    ds_read_b64_tr_b16 a[30:31], v255 offset:24608
    s_mov_b32 s68, 0x760007
    ds_read_b64_tr_b16 a[32:33], v254 offset:24640
    s_cmp_eq_u32 s47, 1
    s_cmov_b32 s68, 0x760097
    ds_read_b64_tr_b16 a[34:35], v255 offset:24640
    buffer_load_dwordx4 v253, s[8:11], s57 offen offset:2048 lds
    s_add_u32 m0, s41, 0x7900
    s_add_u32 s57, s49, 0x300
    ds_read2_b32 v[146:147], v121 offset0:2 offset1:3
    ds_read2_b32 v[148:149], v118 offset0:0 offset1:1
    ds_read2_b32 v[150:151], v118 offset0:2 offset1:3
    ds_read2_b32 v[152:153], v119 offset0:0 offset1:1
    ds_read2_b32 v[154:155], v119 offset0:2 offset1:3
    ds_read2_b32 v[156:157], v122 offset0:0 offset1:1
    ds_read2_b32 v[158:159], v122 offset0:2 offset1:3
    buffer_load_dwordx4 v246, s[4:7], s56 offen lds
    s_waitcnt lgkmcnt(11)
    v_mfma_f32_16x16x32_bf16 v[12:15], a[24:27], a[240:243], v[12:15]
    s_waitcnt lgkmcnt(9)
    v_mfma_f32_16x16x32_bf16 v[16:19], a[28:31], a[240:243], v[16:19]
    s_waitcnt lgkmcnt(7)
    v_mfma_f32_16x16x32_bf16 v[20:23], a[32:35], a[240:243], v[20:23]
    s_waitcnt lgkmcnt(4)
    ds_read_b128 a[240:243], v227 offset:6336
    v_cndmask_b32 v148, v124, v148, s[60:61]
    v_mfma_f32_16x16x32_bf16 v[36:39], a[24:27], a[244:247], v[36:39]
    s_and_b32 s61, s61, 0xfffffff
    v_cndmask_b32 v149, v124, v149, s[62:63]
    v_cndmask_b32 v150, v124, v150, s[64:65]
    v_mfma_f32_16x16x32_bf16 v[40:43], a[28:31], a[244:247], v[40:43]
    s_and_b32 s63, s63, 0xfffffff
    buffer_load_dwordx4 v247, s[4:7], s56 offen offset:1024 lds
    v_mfma_f32_16x16x32_bf16 v[44:47], a[32:35], a[244:247], v[44:47]
    s_add_u32 s56, s56, s42
    s_waitcnt vmcnt(8)
    ds_read_b64_tr_b16 a[36:37], v254 offset:36864
    ds_read_b64_tr_b16 a[38:39], v255 offset:36864
    v_mfma_f32_16x16x32_bf16 v[132:135], a[24:27], a[248:251], v[132:135]
    s_add_u32 m0, s41, 0x9740
    ds_read_b64_tr_b16 a[40:41], v254 offset:36896
    ds_read_b64_tr_b16 a[42:43], v255 offset:36896
    v_mfma_f32_16x16x32_bf16 v[136:139], a[28:31], a[248:251], v[136:139]
    s_and_b32 s65, s65, 0xfffffff
    ds_read_b64_tr_b16 a[44:45], v254 offset:36928
    ds_read_b64_tr_b16 a[46:47], v255 offset:36928
    v_mfma_f32_16x16x32_bf16 v[140:143], a[32:35], a[248:251], v[140:143]
    s_mov_b32 s73, s61
    buffer_load_dwordx4 v246, s[4:7], s56 offen lds
    v_mfma_f32_16x16x32_bf16 v[220:223], a[24:27], a[252:255], v[220:223]
    s_mov_b32 s71, s63
    ds_read_b128 a[244:247], v224 offset:256
    ds_read_b128 a[248:251], v224 offset:3328
    v_mfma_f32_16x16x32_bf16 v[216:219], a[28:31], a[252:255], v[216:219]
    s_waitcnt lgkmcnt(8)
    v_cndmask_b32 v151, v124, v151, s[66:67]
    v_cndmask_b32 v156, v124, v156, s[60:61]
    v_mfma_f32_16x16x32_bf16 v[212:215], a[32:35], a[252:255], v[212:215]
    s_and_b32 s67, s67, 0xfffffff
    ds_read_b128 a[252:255], v224 offset:15744
    v_cndmask_b32 v157, v124, v157, s[62:63]
    v_mfma_f32_16x16x32_bf16 v[208:211], a[24:27], a[220:223], v[208:211]
    s_and_b32 s61, s61, 0xff
    buffer_load_dwordx4 v247, s[4:7], s56 offen offset:1024 lds
    v_mfma_f32_16x16x32_bf16 v[204:207], a[28:31], a[220:223], v[204:207]
    s_add_u32 s56, s56, s42
    v_cndmask_b32 v158, v124, v158, s[64:65]
    v_cndmask_b32 v159, v124, v159, s[66:67]
    v_mfma_f32_16x16x32_bf16 v[200:203], a[32:35], a[220:223], v[200:203]
    s_add_u32 m0, s41, 0xb580
    ds_read_b128 a[220:223], v224 offset:18816
    v_cndmask_b32 v144, v124, v144, s[72:73]
    s_waitcnt lgkmcnt(5)
    v_mfma_f32_16x16x32_bf16 v[12:15], a[36:39], a[224:227], v[12:15]
    s_and_b32 s72, s64, 0xfff00000
    v_cndmask_b32 v145, v124, v145, s[70:71]
    v_cndmask_b32 v152, v124, v152, s[60:61]
    v_mfma_f32_16x16x32_bf16 v[16:19], a[40:43], a[224:227], v[16:19]
    s_mov_b32 s73, s65
    buffer_load_dwordx4 v246, s[4:7], s56 offen lds
    s_waitcnt lgkmcnt(4)
    v_mfma_f32_16x16x32_bf16 v[20:23], a[44:47], a[224:227], v[20:23]
    s_and_b32 s70, s66, 0xfff00000
    s_waitcnt vmcnt(8)
    ds_read_b64_tr_b16 a[48:49], v254 offset:49152
    ds_read_b64_tr_b16 a[50:51], v255 offset:49152
    v_mfma_f32_16x16x32_bf16 v[36:39], a[36:39], a[228:231], v[36:39]
    s_mov_b32 s71, s67
    ds_read_b64_tr_b16 a[52:53], v254 offset:49184
    ds_read_b64_tr_b16 a[54:55], v255 offset:49184
    v_mfma_f32_16x16x32_bf16 v[40:43], a[40:43], a[228:231], v[40:43]
    s_and_b32 s63, s63, 0xff
    ds_read_b64_tr_b16 a[56:57], v254 offset:49216
    ds_read_b64_tr_b16 a[58:59], v255 offset:49216
    v_mfma_f32_16x16x32_bf16 v[44:47], a[44:47], a[228:231], v[44:47]
    s_and_b32 s65, s65, 0xff
    ds_read_b128 a[224:227], v227 offset:6400
    ds_read_b128 a[228:231], v224 offset:320
    v_mfma_f32_16x16x32_bf16 v[132:135], a[36:39], a[232:235], v[132:135]
    s_and_b32 s67, s67, 0xff
    buffer_load_dwordx4 v247, s[4:7], s56 offen offset:1024 lds
    v_mfma_f32_16x16x32_bf16 v[136:139], a[40:43], a[232:235], v[136:139]
    s_add_u32 s56, s56, s42
    v_cndmask_b32 v146, v124, v146, s[72:73]
    v_cndmask_b32 v147, v124, v147, s[70:71]
    v_mfma_f32_16x16x32_bf16 v[140:143], a[44:47], a[232:235], v[140:143]
    s_add_u32 m0, s41, 0xd3c0
    ds_read_b128 a[232:235], v224 offset:3392
    v_cndmask_b32 v153, v124, v153, s[62:63]
    v_mfma_f32_16x16x32_bf16 v[220:223], a[36:39], a[236:239], v[220:223]
    s_mov_b32 s60, 0x2222
    v_cndmask_b32 v154, v124, v154, s[64:65]
    v_cndmask_b32 v155, v124, v155, s[66:67]
    v_mfma_f32_16x16x32_bf16 v[216:219], a[40:43], a[236:239], v[216:219]
    s_cmp_eq_u32 s47, 1
    s_cmov_b32 s60, 0xbbbb
    v_bfe_u32 v234, s60, v232, 4
    v_mfma_f32_16x16x32_bf16 v[212:215], a[44:47], a[236:239], v[212:215]
    s_mov_b32 s61, 0x4444
    buffer_load_dwordx4 v246, s[4:7], s56 offen lds
    v_mfma_f32_16x16x32_bf16 v[208:211], a[36:39], a[240:243], v[208:211]
    s_cmp_eq_u32 s47, 1
    s_cmov_b32 s61, 0x4241
    ds_read_b128 a[236:239], v224 offset:15808
    v_mfma_f32_16x16x32_bf16 v[204:207], a[40:43], a[240:243], v[204:207]
    s_mov_b32 s62, 0x8808
    v_mad_u32_u24 v235, v234, s40, v228
    v_mad_u32_u24 v234, v234, s40, v229
    v_mfma_f32_16x16x32_bf16 v[200:203], a[44:47], a[240:243], v[200:203]
    s_cmp_eq_u32 s47, 1
    s_cmov_b32 s62, 0x8898
    s_waitcnt vmcnt(7)
    ds_read_b64_tr_b16 a[60:61], v254 offset:61440
    s_waitcnt lgkmcnt(3)
    v_mfma_f32_16x16x32_bf16 v[12:15], a[48:51], a[244:247], v[12:15]
    s_mov_b32 s63, 0x32104321
    buffer_load_dwordx4 v247, s[4:7], s56 offen offset:1024 lds
    v_mfma_f32_16x16x32_bf16 v[16:19], a[52:55], a[244:247], v[16:19]
    s_add_u32 m0, s50, 0
    ds_read_b64_tr_b16 a[62:63], v255 offset:61440
    ds_read_b64_tr_b16 a[64:65], v254 offset:61472
    v_mfma_f32_16x16x32_bf16 v[20:23], a[56:59], a[244:247], v[20:23]
    s_add_u32 s56, s56, s42
    ds_read_b64_tr_b16 a[66:67], v255 offset:61472
    ds_read_b64_tr_b16 a[68:69], v254 offset:61504
    v_mfma_f32_16x16x32_bf16 v[36:39], a[48:51], a[248:251], v[36:39]
    s_cmp_eq_u32 s47, 1
    s_cmov_b32 s63, 0x30a940ba
    ds_read_b64_tr_b16 a[70:71], v255 offset:61504
    v_mfma_f32_16x16x32_bf16 v[40:43], a[52:55], a[248:251], v[40:43]
    s_mov_b32 s64, 0x76540765
    buffer_load_dword v188, v189, s[12:15], s52 offen
    v_mfma_f32_16x16x32_bf16 v[44:47], a[56:59], a[248:251], v[44:47]
    s_cmp_eq_u32 s47, 1
    s_cmov_b32 s64, 0x76549765
    ds_read_b128 a[240:243], v224 offset:18880
    v_mfma_f32_16x16x32_bf16 v[132:135], a[48:51], a[252:255], v[132:135]
    s_mov_b32 s65, 0x2222
    buffer_load_dwordx4 v251, s[8:11], s57 offen lds
    v_mfma_f32_16x16x32_bf16 v[136:139], a[52:55], a[252:255], v[136:139]
    s_cmp_eq_u32 s47, 1
    s_cmov_b32 s65, 0x2221
    ds_read_b128 a[244:247], v227 offset:6464
    v_mfma_f32_16x16x32_bf16 v[140:143], a[56:59], a[252:255], v[140:143]
    s_mov_b32 s66, 0x10002100
    ds_write_b128 v123, v[144:147]
    v_mfma_f32_16x16x32_bf16 v[220:223], a[48:51], a[220:223], v[220:223]
    s_cmp_eq_u32 s47, 1
    s_cmov_b32 s66, 0x10002000
    s_mov_b32 s67, 0x54326543
    v_mfma_f32_16x16x32_bf16 v[216:219], a[52:55], a[220:223], v[216:219]
    s_mov_b32 s70, 0x76540765
    buffer_load_dwordx4 v252, s[8:11], s57 offen offset:1024 lds
    v_mfma_f32_16x16x32_bf16 v[212:215], a[56:59], a[220:223], v[212:215]
    s_mov_b32 s71, 0x10002100
    ds_write_b128 v123, v[148:151] offset:960
    v_mfma_f32_16x16x32_bf16 v[208:211], a[48:51], a[224:227], v[208:211]
    s_mov_b32 s72, 0x760007
    buffer_load_dwordx4 v253, s[8:11], s57 offen offset:2048 lds
    v_mfma_f32_16x16x32_bf16 v[204:207], a[52:55], a[224:227], v[204:207]
    s_add_u32 s57, s49, 0x9300
    ds_write_b128 v123, v[152:155] offset:1920
    v_mfma_f32_16x16x32_bf16 v[200:203], a[56:59], a[224:227], v[200:203]
    s_add_u32 m0, s50, 0x3000
    ds_write_b128 v123, v[156:159] offset:2880
    s_waitcnt lgkmcnt(4)
    v_mfma_f32_16x16x32_bf16 v[12:15], a[60:63], a[228:231], v[12:15]
    s_add_u32 s52, s25, s50
    buffer_load_dwordx4 v251, s[8:11], s57 offen lds
    v_mfma_f32_16x16x32_bf16 v[16:19], a[64:67], a[228:231], v[16:19]
    s_add_u32 s25, s25, s49
    v_add_u32 v108, s52, v108
    v_add_u32 v243, s25, v164
    v_mfma_f32_16x16x32_bf16 v[20:23], a[68:71], a[228:231], v[20:23]
    v_add_u32 v245, s25, v165
    v_cvt_pk_bf16_f32 v0, v12, v13
    v_mfma_f32_16x16x32_bf16 v[36:39], a[60:63], a[232:235], v[36:39]
    s_mul_i32 s25, s35, 0x2a00
    buffer_load_dwordx4 v252, s[8:11], s57 offen offset:1024 lds
    v_mfma_f32_16x16x32_bf16 v[40:43], a[64:67], a[232:235], v[40:43]
    s_add_u32 s51, s51, s25
    v_cvt_pk_bf16_f32 v1, v14, v15
    v_cvt_pk_bf16_f32 v2, v16, v17
    v_mfma_f32_16x16x32_bf16 v[44:47], a[68:71], a[232:235], v[44:47]
    s_mul_i32 s25, s46, 0x1f8000
    v_cvt_pk_bf16_f32 v3, v18, v19
    v_cvt_pk_bf16_f32 v4, v20, v21
    v_mfma_f32_16x16x32_bf16 v[132:135], a[60:63], a[236:239], v[132:135]
    s_add_u32 s51, s51, s25
    v_cvt_pk_bf16_f32 v5, v22, v23
    v_cvt_pk_bf16_f32 v24, v36, v37
    v_mfma_f32_16x16x32_bf16 v[136:139], a[64:67], a[236:239], v[136:139]
    s_lshl_b32 s25, s36, 2
    v_cvt_pk_bf16_f32 v25, v38, v39
    v_cvt_pk_bf16_f32 v26, v40, v41
    v_mfma_f32_16x16x32_bf16 v[140:143], a[68:71], a[236:239], v[140:143]
    s_add_u32 s25, s25, 0x27e00
    buffer_load_dwordx4 v253, s[8:11], s57 offen offset:2048 lds
    v_mfma_f32_16x16x32_bf16 v[220:223], a[60:63], a[240:243], v[220:223]
    s_add_u32 s57, s49, 0x12300
    v_cvt_pk_bf16_f32 v27, v42, v43
    v_cvt_pk_bf16_f32 v28, v44, v45
    v_mfma_f32_16x16x32_bf16 v[216:219], a[64:67], a[240:243], v[216:219]
    s_add_u32 m0, s50, 0x6000
    v_cvt_pk_bf16_f32 v29, v46, v47
    v_cvt_pk_bf16_f32 v6, v132, v133
    v_mfma_f32_16x16x32_bf16 v[212:215], a[68:71], a[240:243], v[212:215]
    v_cvt_pk_bf16_f32 v7, v134, v135
    v_cvt_pk_bf16_f32 v8, v136, v137
    v_mfma_f32_16x16x32_bf16 v[208:211], a[60:63], a[244:247], v[208:211]
    buffer_load_dwordx4 v251, s[8:11], s57 offen lds
    v_mfma_f32_16x16x32_bf16 v[204:207], a[64:67], a[244:247], v[204:207]
    v_cvt_pk_bf16_f32 v9, v138, v139
    v_cvt_pk_bf16_f32 v10, v140, v141
    v_mfma_f32_16x16x32_bf16 v[200:203], a[68:71], a[244:247], v[200:203]
    s_waitcnt vmcnt(12)
    v_cvt_pk_bf16_f32 v11, v142, v143
    v_cvt_pk_bf16_f32 v30, v220, v221
    v_cvt_pk_bf16_f32 v31, v222, v223
    v_cvt_pk_bf16_f32 v32, v216, v217
    v_cvt_pk_bf16_f32 v33, v218, v219
    v_cvt_pk_bf16_f32 v34, v212, v213
    v_cvt_pk_bf16_f32 v35, v214, v215
    buffer_load_dwordx4 v252, s[8:11], s57 offen offset:1024 lds
    v_cvt_pk_bf16_f32 v48, v208, v209
    v_cvt_pk_bf16_f32 v49, v210, v211
    v_cvt_pk_bf16_f32 v50, v204, v205
    v_cvt_pk_bf16_f32 v51, v206, v207
    v_cvt_pk_bf16_f32 v52, v200, v201
    v_cvt_pk_bf16_f32 v53, v202, v203
    ds_read_b128 v[144:147], v235
    ds_read_b128 v[148:151], v234
    v_bfe_u32 v234, s61, v232, 4
    v_mad_u32_u24 v235, v234, s40, v229
    buffer_load_dwordx4 v253, s[8:11], s57 offen offset:2048 lds
    s_add_u32 s57, s49, 0x1b300
    s_add_u32 m0, s50, 0x9000
    ds_read_b128 v[152:155], v235
    v_mad_u32_u24 v234, v234, s40, v228
    buffer_load_dwordx4 v251, s[8:11], s57 offen lds
    s_barrier
    ds_read_b128 a[248:251], v224 offset:30976
    ds_read_b128 a[252:255], v224 offset:31040
    buffer_load_dwordx4 v252, s[8:11], s57 offen offset:1024 lds
    ds_read_b128 a[220:223], v224 offset:31104
    ds_read_b128 a[224:227], v224 offset:31168
    ds_read_b128 a[228:231], v224 offset:31232
    ds_read_b128 a[232:235], v224 offset:31296
    ds_read_b128 a[236:239], v224 offset:34048
    buffer_load_dwordx4 v253, s[8:11], s57 offen offset:2048 lds
    s_add_u32 s57, s49, 0x24300
    ds_read_b128 a[240:243], v224 offset:34112
    s_add_u32 m0, s50, 0xc000
    s_waitcnt lgkmcnt(7)
    v_mfma_f32_16x16x32_bf16 v[180:183], a[0:3], a[248:251], 0
    s_waitcnt lgkmcnt(6)
    ds_read_b128 a[244:247], v224 offset:34176
    v_mfma_f32_16x16x32_bf16 v[180:183], a[12:15], a[252:255], v[180:183]
    v_mfma_f32_16x16x32_bf16 v[176:179], a[4:7], a[248:251], 0
    v_mfma_f32_16x16x32_bf16 v[176:179], a[16:19], a[252:255], v[176:179]
    buffer_load_dwordx4 v251, s[8:11], s57 offen lds
    v_mfma_f32_16x16x32_bf16 v[172:175], a[8:11], a[248:251], 0
    ds_read_b128 a[248:251], v224 offset:34240
    v_mfma_f32_16x16x32_bf16 v[172:175], a[20:23], a[252:255], v[172:175]
    s_waitcnt lgkmcnt(5)
    ds_read_b128 a[252:255], v224 offset:34304
    v_mfma_f32_16x16x32_bf16 v[180:183], a[24:27], a[220:223], v[180:183]
    v_mfma_f32_16x16x32_bf16 v[180:183], a[36:39], a[224:227], v[180:183]
    buffer_load_dwordx4 v252, s[8:11], s57 offen offset:1024 lds
    v_mfma_f32_16x16x32_bf16 v[176:179], a[28:31], a[220:223], v[176:179]
    v_mfma_f32_16x16x32_bf16 v[176:179], a[40:43], a[224:227], v[176:179]
    v_mfma_f32_16x16x32_bf16 v[172:175], a[32:35], a[220:223], v[172:175]
    s_waitcnt vmcnt(15)
    ds_read_b128 a[220:223], v224 offset:34368
    v_mfma_f32_16x16x32_bf16 v[172:175], a[44:47], a[224:227], v[172:175]
    s_barrier
    ds_read_b128 a[224:227], v224 offset:46464
    v_mfma_f32_16x16x32_bf16 v[180:183], a[48:51], a[228:231], v[180:183]
    s_waitcnt lgkmcnt(3)
    buffer_load_dwordx4 v253, s[8:11], s57 offen offset:2048 lds
    v_mfma_f32_16x16x32_bf16 v[180:183], a[60:63], a[232:235], v[180:183]
    s_add_u32 s57, s49, 0x2d300
    s_add_u32 m0, s50, 0xf000
    v_mfma_f32_16x16x32_bf16 v[176:179], a[52:55], a[228:231], v[176:179]
    v_mfma_f32_16x16x32_bf16 v[176:179], a[64:67], a[232:235], v[176:179]
    buffer_load_dwordx4 v251, s[8:11], s57 offen lds
    v_mfma_f32_16x16x32_bf16 v[172:175], a[56:59], a[228:231], v[172:175]
    ds_read_b128 a[228:231], v224 offset:46528
    v_mfma_f32_16x16x32_bf16 v[172:175], a[68:71], a[232:235], v[172:175]
    v_cvt_pk_bf16_f32 v12, v180, v181
    v_cvt_pk_bf16_f32 v13, v182, v183
    v_mfma_f32_16x16x32_bf16 v[220:223], a[0:3], a[236:239], 0
    ds_read_b128 a[232:235], v224 offset:46592
    v_cvt_pk_bf16_f32 v14, v176, v177
    v_mfma_f32_16x16x32_bf16 v[220:223], a[12:15], a[240:243], v[220:223]
    v_cvt_pk_bf16_f32 v15, v178, v179
    v_mfma_f32_16x16x32_bf16 v[216:219], a[4:7], a[236:239], 0
    v_cvt_pk_bf16_f32 v16, v172, v173
    v_cvt_pk_bf16_f32 v17, v174, v175
    v_mfma_f32_16x16x32_bf16 v[216:219], a[16:19], a[240:243], v[216:219]
    buffer_load_dwordx4 v252, s[8:11], s57 offen offset:1024 lds
    v_mfma_f32_16x16x32_bf16 v[212:215], a[8:11], a[236:239], 0
    ds_read_b128 a[236:239], v224 offset:46656
    v_mfma_f32_16x16x32_bf16 v[212:215], a[20:23], a[240:243], v[212:215]
    ds_read_b128 a[240:243], v224 offset:46720
    v_mfma_f32_16x16x32_bf16 v[220:223], a[24:27], a[244:247], v[220:223]
    buffer_load_dwordx4 v253, s[8:11], s57 offen offset:2048 lds
    v_mfma_f32_16x16x32_bf16 v[220:223], a[36:39], a[248:251], v[220:223]
    s_add_u32 s57, s49, 0
    s_add_u32 m0, s50, 0
    v_mfma_f32_16x16x32_bf16 v[216:219], a[28:31], a[244:247], v[216:219]
    v_mfma_f32_16x16x32_bf16 v[216:219], a[40:43], a[248:251], v[216:219]
    s_waitcnt vmcnt(15)
    ds_read_b64_tr_b16 a[72:73], v254
    ds_read_b64_tr_b16 a[74:75], v255
    v_mfma_f32_16x16x32_bf16 v[212:215], a[32:35], a[244:247], v[212:215]
    ds_read_b128 a[244:247], v224 offset:46784
    ds_read_b64_tr_b16 a[76:77], v254 offset:32
    v_mfma_f32_16x16x32_bf16 v[212:215], a[44:47], a[248:251], v[212:215]
    s_waitcnt lgkmcnt(6)
    ds_read_b128 a[248:251], v224 offset:49536
    v_mfma_f32_16x16x32_bf16 v[220:223], a[48:51], a[252:255], v[220:223]
    ds_read_b64_tr_b16 a[78:79], v255 offset:32
    ds_read_b64_tr_b16 a[80:81], v254 offset:64
    v_mfma_f32_16x16x32_bf16 v[220:223], a[60:63], a[220:223], v[220:223]
    ds_read_b64_tr_b16 a[82:83], v255 offset:64
    v_mfma_f32_16x16x32_bf16 v[216:219], a[52:55], a[252:255], v[216:219]
    v_mfma_f32_16x16x32_bf16 v[216:219], a[64:67], a[220:223], v[216:219]
    v_mfma_f32_16x16x32_bf16 v[212:215], a[56:59], a[252:255], v[212:215]
    ds_read_b128 a[252:255], v224 offset:49600
    v_mfma_f32_16x16x32_bf16 v[212:215], a[68:71], a[220:223], v[212:215]
    ds_read_b128 a[220:223], v224 offset:49664
    v_mfma_f32_16x16x32_bf16 v[208:211], a[0:3], a[224:227], 0
    v_cvt_pk_bf16_f32 v36, v220, v221
    v_cvt_pk_bf16_f32 v37, v222, v223
    v_mfma_f32_16x16x32_bf16 v[208:211], a[12:15], a[228:231], v[208:211]
    v_cvt_pk_bf16_f32 v38, v216, v217
    v_cvt_pk_bf16_f32 v39, v218, v219
    v_mfma_f32_16x16x32_bf16 v[204:207], a[4:7], a[224:227], 0
    v_cvt_pk_bf16_f32 v40, v212, v213
    v_cvt_pk_bf16_f32 v41, v214, v215
    v_mfma_f32_16x16x32_bf16 v[204:207], a[16:19], a[228:231], v[204:207]
    s_waitcnt lgkmcnt(2)
    buffer_load_dwordx4 v251, s[8:11], s57 offen lds
    v_mfma_f32_16x16x32_bf16 v[200:203], a[8:11], a[224:227], 0
    s_waitcnt vmcnt(13)
    ds_read_b128 a[224:227], v224 offset:49728
    ds_read_b64_tr_b16 a[84:85], v254 offset:12288
    v_mfma_f32_16x16x32_bf16 v[200:203], a[20:23], a[228:231], v[200:203]
    ds_read_b128 a[228:231], v224 offset:49792
    v_mfma_f32_16x16x32_bf16 v[208:211], a[24:27], a[232:235], v[208:211]
    buffer_load_dwordx4 v252, s[8:11], s57 offen offset:1024 lds
    v_mfma_f32_16x16x32_bf16 v[208:211], a[36:39], a[236:239], v[208:211]
    ds_read_b64_tr_b16 a[86:87], v255 offset:12288
    ds_read_b64_tr_b16 a[88:89], v254 offset:12320
    v_mfma_f32_16x16x32_bf16 v[204:207], a[28:31], a[232:235], v[204:207]
    buffer_load_dwordx4 v253, s[8:11], s57 offen offset:2048 lds
    v_mfma_f32_16x16x32_bf16 v[204:207], a[40:43], a[236:239], v[204:207]
    s_add_u32 s57, s49, 0x9000
    ds_read_b64_tr_b16 a[90:91], v255 offset:12320
    ds_read_b64_tr_b16 a[92:93], v254 offset:12352
    v_mfma_f32_16x16x32_bf16 v[200:203], a[32:35], a[232:235], v[200:203]
    s_add_u32 m0, s50, 0x3000
    ds_read_b128 a[232:235], v224 offset:49856
    ds_read_b64_tr_b16 a[94:95], v255 offset:12352
    v_mfma_f32_16x16x32_bf16 v[200:203], a[44:47], a[236:239], v[200:203]
    ds_read_b128 a[236:239], v227 offset:37120
    v_mfma_f32_16x16x32_bf16 v[208:211], a[48:51], a[240:243], v[208:211]
    v_mfma_f32_16x16x32_bf16 v[208:211], a[60:63], a[244:247], v[208:211]
    v_mfma_f32_16x16x32_bf16 v[204:207], a[52:55], a[240:243], v[204:207]
    v_mfma_f32_16x16x32_bf16 v[204:207], a[64:67], a[244:247], v[204:207]
    s_waitcnt vmcnt(12)
    ds_read_b64_tr_b16 a[96:97], v254 offset:24576
    ds_read_b64_tr_b16 a[98:99], v255 offset:24576
    v_mfma_f32_16x16x32_bf16 v[200:203], a[56:59], a[240:243], v[200:203]
    ds_read_b128 a[240:243], v227 offset:37184
    ds_read_b64_tr_b16 a[100:101], v254 offset:24608
    v_mfma_f32_16x16x32_bf16 v[200:203], a[68:71], a[244:247], v[200:203]
    v_cvt_pk_bf16_f32 v18, v208, v209
    v_cvt_pk_bf16_f32 v19, v210, v211
    v_mfma_f32_16x16x32_bf16 v[180:183], a[0:3], a[248:251], 0
    s_waitcnt lgkmcnt(6)
    v_cvt_pk_bf16_f32 v20, v204, v205
    v_cvt_pk_bf16_f32 v21, v206, v207
    v_mfma_f32_16x16x32_bf16 v[180:183], a[12:15], a[252:255], v[180:183]
    ds_read_b128 a[244:247], v227 offset:37248
    ds_read_b64_tr_b16 a[102:103], v255 offset:24608
    v_mfma_f32_16x16x32_bf16 v[176:179], a[4:7], a[248:251], 0
    v_cvt_pk_bf16_f32 v22, v200, v201
    v_cvt_pk_bf16_f32 v23, v202, v203
    v_mfma_f32_16x16x32_bf16 v[176:179], a[16:19], a[252:255], v[176:179]
    s_waitcnt lgkmcnt(6)
    buffer_load_dwordx4 v251, s[8:11], s57 offen lds
    v_mfma_f32_16x16x32_bf16 v[172:175], a[8:11], a[248:251], 0
    ds_read_b128 a[248:251], v227 offset:37312
    ds_read_b64_tr_b16 a[104:105], v254 offset:24640
    v_mfma_f32_16x16x32_bf16 v[172:175], a[20:23], a[252:255], v[172:175]
    ds_read_b128 a[252:255], v227 offset:37376
    v_mfma_f32_16x16x32_bf16 v[180:183], a[24:27], a[220:223], v[180:183]
    buffer_load_dwordx4 v252, s[8:11], s57 offen offset:1024 lds
    v_mfma_f32_16x16x32_bf16 v[180:183], a[36:39], a[224:227], v[180:183]
    ds_read_b64_tr_b16 a[106:107], v255 offset:24640
    v_mfma_f32_16x16x32_bf16 v[176:179], a[28:31], a[220:223], v[176:179]
    s_waitcnt vmcnt(11)
    buffer_load_dwordx4 v253, s[8:11], s57 offen offset:2048 lds
    v_mfma_f32_16x16x32_bf16 v[176:179], a[40:43], a[224:227], v[176:179]
    s_add_u32 s57, s49, 0x12000
    ds_read_b64_tr_b16 a[108:109], v254 offset:36864
    ds_read_b64_tr_b16 a[110:111], v255 offset:36864
    v_mfma_f32_16x16x32_bf16 v[172:175], a[32:35], a[220:223], v[172:175]
    s_add_u32 m0, s50, 0x6000
    ds_read_b128 a[220:223], v227 offset:37440
    ds_read_b64_tr_b16 a[112:113], v254 offset:36896
    v_mfma_f32_16x16x32_bf16 v[172:175], a[44:47], a[224:227], v[172:175]
    ds_read_b128 a[224:227], v224
    v_mfma_f32_16x16x32_bf16 v[180:183], a[48:51], a[228:231], v[180:183]
    ds_read_b64_tr_b16 a[114:115], v255 offset:36896
    ds_read_b64_tr_b16 a[116:117], v254 offset:36928
    v_mfma_f32_16x16x32_bf16 v[180:183], a[60:63], a[232:235], v[180:183]
    s_waitcnt lgkmcnt(7)
    buffer_load_dwordx4 v251, s[8:11], s57 offen lds
    v_mfma_f32_16x16x32_bf16 v[176:179], a[52:55], a[228:231], v[176:179]
    ds_read_b64_tr_b16 a[118:119], v255 offset:36928
    v_mfma_f32_16x16x32_bf16 v[176:179], a[64:67], a[232:235], v[176:179]
L_pg1:
    s_cbranch_execz L_pg5
    v_mfma_f32_16x16x32_bf16 v[172:175], a[56:59], a[228:231], v[172:175]
    ds_read_b128 a[228:231], v224 offset:64
    v_mfma_f32_16x16x32_bf16 v[172:175], a[68:71], a[232:235], v[172:175]
    ds_read_b128 a[232:235], v224 offset:128
    v_cvt_pk_bf16_f32 v42, v180, v181
    v_mfma_f32_16x16x32_bf16 v[220:223], a[0:3], a[236:239], 0
    v_cvt_pk_bf16_f32 v43, v182, v183
    v_mfma_f32_16x16x32_bf16 v[220:223], a[12:15], a[240:243], v[220:223]
    v_cvt_pk_bf16_f32 v44, v176, v177
    v_cvt_pk_bf16_f32 v45, v178, v179
    v_mfma_f32_16x16x32_bf16 v[216:219], a[4:7], a[236:239], 0
    v_cvt_pk_bf16_f32 v46, v172, v173
    v_cvt_pk_bf16_f32 v47, v174, v175
    v_mfma_f32_16x16x32_bf16 v[216:219], a[16:19], a[240:243], v[216:219]
    buffer_load_dwordx4 v252, s[8:11], s57 offen offset:1024 lds
    v_mfma_f32_16x16x32_bf16 v[212:215], a[8:11], a[236:239], 0
    s_waitcnt vmcnt(11)
    ds_read_b128 a[236:239], v224 offset:192
    ds_read_b64_tr_b16 a[120:121], v254 offset:49152
    v_mfma_f32_16x16x32_bf16 v[212:215], a[20:23], a[240:243], v[212:215]
    ds_read_b128 a[240:243], v224 offset:256
    v_mfma_f32_16x16x32_bf16 v[220:223], a[24:27], a[244:247], v[220:223]
    buffer_load_dwordx4 v253, s[8:11], s57 offen offset:2048 lds
    v_mfma_f32_16x16x32_bf16 v[220:223], a[36:39], a[248:251], v[220:223]
    s_add_u32 s57, s49, 0x1b000
    ds_read_b64_tr_b16 a[122:123], v255 offset:49152
    ds_read_b64_tr_b16 a[124:125], v254 offset:49184
    v_mfma_f32_16x16x32_bf16 v[216:219], a[28:31], a[244:247], v[216:219]
    s_add_u32 m0, s50, 0x9000
    ds_read_b64_tr_b16 a[126:127], v255 offset:49184
    ds_read_b64_tr_b16 a[128:129], v254 offset:49216
    v_mfma_f32_16x16x32_bf16 v[216:219], a[40:43], a[248:251], v[216:219]
    s_waitcnt lgkmcnt(7)
    buffer_load_dwordx4 v251, s[8:11], s57 offen lds
    v_mfma_f32_16x16x32_bf16 v[212:215], a[32:35], a[244:247], v[212:215]
    ds_read_b128 a[244:247], v224 offset:320
    ds_read_b64_tr_b16 a[130:131], v255 offset:49216
    v_mfma_f32_16x16x32_bf16 v[212:215], a[44:47], a[248:251], v[212:215]
    ds_read_b128 a[248:251], v224 offset:3072
    v_mfma_f32_16x16x32_bf16 v[220:223], a[48:51], a[252:255], v[220:223]
    buffer_load_dwordx4 v252, s[8:11], s57 offen offset:1024 lds
    v_mfma_f32_16x16x32_bf16 v[220:223], a[60:63], a[220:223], v[220:223]
    v_mfma_f32_16x16x32_bf16 v[216:219], a[52:55], a[252:255], v[216:219]
    v_mfma_f32_16x16x32_bf16 v[216:219], a[64:67], a[220:223], v[216:219]
    s_waitcnt vmcnt(11)
    ds_read_b64_tr_b16 a[132:133], v254 offset:61440
    ds_read_b64_tr_b16 a[134:135], v255 offset:61440
    v_mfma_f32_16x16x32_bf16 v[212:215], a[56:59], a[252:255], v[212:215]
    ds_read_b128 a[252:255], v224 offset:3136
    ds_read_b64_tr_b16 a[136:137], v254 offset:61472
    v_mfma_f32_16x16x32_bf16 v[212:215], a[68:71], a[220:223], v[212:215]
    v_cvt_pk_bf16_f32 v54, v220, v221
    v_cvt_pk_bf16_f32 v55, v222, v223
    v_mfma_f32_16x16x32_bf16 v[208:211], a[224:227], a[72:75], 0
    v_cvt_pk_bf16_f32 v56, v216, v217
    v_cvt_pk_bf16_f32 v57, v218, v219
    v_mfma_f32_16x16x32_bf16 v[208:211], a[228:231], a[84:87], v[208:211]
    ds_read_b128 a[220:223], v224 offset:3200
    ds_read_b64_tr_b16 a[138:139], v255 offset:61472
    v_mfma_f32_16x16x32_bf16 v[204:207], a[224:227], a[76:79], 0
    v_cvt_pk_bf16_f32 v58, v212, v213
    v_cvt_pk_bf16_f32 v59, v214, v215
    v_mfma_f32_16x16x32_bf16 v[204:207], a[228:231], a[88:91], v[204:207]
    buffer_load_dwordx4 v253, s[8:11], s57 offen offset:2048 lds
    v_mfma_f32_16x16x32_bf16 v[200:203], a[224:227], a[80:83], 0
    s_add_u32 s57, s49, 0x24000
    ds_read_b128 a[224:227], v224 offset:3264
    ds_read_b64_tr_b16 a[140:141], v254 offset:61504
    v_mfma_f32_16x16x32_bf16 v[200:203], a[228:231], a[92:95], v[200:203]
    s_add_u32 m0, s50, 0xc000
    ds_read_b128 a[228:231], v224 offset:3328
    v_mfma_f32_16x16x32_bf16 v[208:211], a[232:235], a[96:99], v[208:211]
    s_waitcnt lgkmcnt(6)
    buffer_load_dwordx4 v251, s[8:11], s57 offen lds
    v_mfma_f32_16x16x32_bf16 v[208:211], a[236:239], a[108:111], v[208:211]
    ds_read_b64_tr_b16 a[142:143], v255 offset:61504
    v_mfma_f32_16x16x32_bf16 v[204:207], a[232:235], a[100:103], v[204:207]
    buffer_load_dwordx4 v252, s[8:11], s57 offen offset:1024 lds
    v_mfma_f32_16x16x32_bf16 v[204:207], a[236:239], a[112:115], v[204:207]
    s_waitcnt vmcnt(11)
    ds_read_b64_tr_b16 a[144:145], v254
    ds_read_b64_tr_b16 a[146:147], v255
    v_mfma_f32_16x16x32_bf16 v[200:203], a[232:235], a[104:107], v[200:203]
    ds_read_b128 a[232:235], v224 offset:3392
    ds_read_b64_tr_b16 a[148:149], v254 offset:32
    v_mfma_f32_16x16x32_bf16 v[200:203], a[236:239], a[116:119], v[200:203]
    ds_read_b128 a[236:239], v224 offset:15488
    v_mfma_f32_16x16x32_bf16 v[208:211], a[240:243], a[120:123], v[208:211]
    buffer_load_dwordx4 v253, s[8:11], s57 offen offset:2048 lds
    v_mfma_f32_16x16x32_bf16 v[208:211], a[244:247], a[132:135], v[208:211]
    s_add_u32 s57, s49, 0x2d000
    ds_read_b64_tr_b16 a[150:151], v255 offset:32
    ds_read_b64_tr_b16 a[152:153], v254 offset:64
    v_mfma_f32_16x16x32_bf16 v[204:207], a[240:243], a[124:127], v[204:207]
    s_add_u32 m0, s50, 0xf000
    ds_read_b64_tr_b16 a[154:155], v255 offset:64
    s_waitcnt lgkmcnt(8)
    v_mfma_f32_16x16x32_bf16 v[204:207], a[244:247], a[136:139], v[204:207]
    v_mfma_f32_16x16x32_bf16 v[200:203], a[240:243], a[128:131], v[200:203]
    v_cvt_pk_bf16_f32 v66, v208, v209
    v_cvt_pk_bf16_f32 v67, v210, v211
    v_mfma_f32_16x16x32_bf16 v[200:203], a[244:247], a[140:143], v[200:203]
    ds_read_b128 a[240:243], v224 offset:15552
    ds_read_b128 a[244:247], v224 offset:15616
    v_mfma_f32_16x16x32_bf16 v[180:183], a[248:251], a[72:75], 0
    buffer_load_dwordx4 v251, s[8:11], s57 offen lds
    v_mfma_f32_16x16x32_bf16 v[180:183], a[252:255], a[84:87], v[180:183]
    v_cvt_pk_bf16_f32 v88, v204, v205
    v_cvt_pk_bf16_f32 v89, v206, v207
    v_mfma_f32_16x16x32_bf16 v[176:179], a[248:251], a[76:79], 0
    v_cvt_pk_bf16_f32 v110, v200, v201
    v_cvt_pk_bf16_f32 v111, v202, v203
    v_mfma_f32_16x16x32_bf16 v[176:179], a[252:255], a[88:91], v[176:179]
    buffer_load_dwordx4 v252, s[8:11], s57 offen offset:1024 lds
    v_mfma_f32_16x16x32_bf16 v[172:175], a[248:251], a[80:83], 0
    s_waitcnt vmcnt(11)
    ds_read_b128 a[248:251], v224 offset:15680
    ds_read_b64_tr_b16 a[156:157], v254 offset:12288
    v_mfma_f32_16x16x32_bf16 v[172:175], a[252:255], a[92:95], v[172:175]
    ds_read_b128 a[252:255], v224 offset:15744
    v_mfma_f32_16x16x32_bf16 v[180:183], a[220:223], a[96:99], v[180:183]
    ds_read_b64_tr_b16 a[158:159], v255 offset:12288
    ds_read_b64_tr_b16 a[160:161], v254 offset:12320
    v_mfma_f32_16x16x32_bf16 v[180:183], a[224:227], a[108:111], v[180:183]
    buffer_load_dwordx4 v253, s[8:11], s57 offen offset:2048 lds
    v_mfma_f32_16x16x32_bf16 v[176:179], a[220:223], a[100:103], v[176:179]
    s_add_u32 s57, s49, 0
    ds_read_b64_tr_b16 a[162:163], v255 offset:12320
    ds_read_b64_tr_b16 a[164:165], v254 offset:12352
    v_mfma_f32_16x16x32_bf16 v[176:179], a[224:227], a[112:115], v[176:179]
    s_add_u32 m0, s50, 0
    ds_read_b64_tr_b16 a[166:167], v255 offset:12352
    v_mfma_f32_16x16x32_bf16 v[172:175], a[220:223], a[104:107], v[172:175]
    ds_read_b128 a[220:223], v224 offset:15808
    v_mfma_f32_16x16x32_bf16 v[172:175], a[224:227], a[116:119], v[172:175]
    ds_read_b128 a[224:227], v224 offset:18560
    v_mfma_f32_16x16x32_bf16 v[180:183], a[228:231], a[120:123], v[180:183]
    s_waitcnt lgkmcnt(9)
    buffer_load_dwordx4 v192, s[12:15], s57 offen lds
    v_mfma_f32_16x16x32_bf16 v[180:183], a[232:235], a[132:135], v[180:183]
    v_mfma_f32_16x16x32_bf16 v[176:179], a[228:231], a[124:127], v[176:179]
    v_mfma_f32_16x16x32_bf16 v[176:179], a[232:235], a[136:139], v[176:179]
    buffer_load_dwordx4 v193, s[12:15], s57 offen offset:1024 lds
    v_mfma_f32_16x16x32_bf16 v[172:175], a[228:231], a[128:131], v[172:175]
    s_waitcnt vmcnt(11)
    ds_read_b128 a[228:231], v224 offset:18624
    ds_read_b64_tr_b16 a[168:169], v254 offset:24576
    v_mfma_f32_16x16x32_bf16 v[172:175], a[232:235], a[140:143], v[172:175]
    ds_read_b128 a[232:235], v224 offset:18688
    v_cvt_pk_bf16_f32 v68, v180, v181
    v_mfma_f32_16x16x32_bf16 v[220:223], a[236:239], a[72:75], 0
    v_cvt_pk_bf16_f32 v69, v182, v183
    v_cvt_pk_bf16_f32 v90, v176, v177
    v_mfma_f32_16x16x32_bf16 v[220:223], a[240:243], a[84:87], v[220:223]
    ds_read_b64_tr_b16 a[170:171], v255 offset:24576
    v_cvt_pk_bf16_f32 v91, v178, v179
    v_mfma_f32_16x16x32_bf16 v[216:219], a[236:239], a[76:79], 0
    v_cvt_pk_bf16_f32 v112, v172, v173
    v_cvt_pk_bf16_f32 v113, v174, v175
    v_mfma_f32_16x16x32_bf16 v[216:219], a[240:243], a[88:91], v[216:219]
    buffer_load_dwordx4 v194, s[12:15], s57 offen offset:2048 lds
    v_mfma_f32_16x16x32_bf16 v[212:215], a[236:239], a[80:83], 0
    s_add_u32 s57, s49, 0x3000
    ds_read_b128 a[236:239], v224 offset:18752
    ds_read_b64_tr_b16 a[172:173], v254 offset:24608
    v_mfma_f32_16x16x32_bf16 v[212:215], a[240:243], a[92:95], v[212:215]
    s_add_u32 m0, s50, 0x3000
    ds_read_b128 a[240:243], v224 offset:18816
    v_mfma_f32_16x16x32_bf16 v[220:223], a[244:247], a[96:99], v[220:223]
    s_waitcnt lgkmcnt(6)
    buffer_load_dwordx4 v192, s[12:15], s57 offen lds
    v_mfma_f32_16x16x32_bf16 v[220:223], a[248:251], a[108:111], v[220:223]
    ds_read_b64_tr_b16 a[174:175], v255 offset:24608
    ds_read_b64_tr_b16 a[176:177], v254 offset:24640
    v_mfma_f32_16x16x32_bf16 v[216:219], a[244:247], a[100:103], v[216:219]
    ds_read_b64_tr_b16 a[178:179], v255 offset:24640
    v_mfma_f32_16x16x32_bf16 v[216:219], a[248:251], a[112:115], v[216:219]
    s_waitcnt vmcnt(10)
    ds_read_b64_tr_b16 a[180:181], v254 offset:36864
    ds_read_b64_tr_b16 a[182:183], v255 offset:36864
    v_mfma_f32_16x16x32_bf16 v[212:215], a[244:247], a[104:107], v[212:215]
    ds_read_b128 a[244:247], v224 offset:18880
    ds_read_b64_tr_b16 a[184:185], v254 offset:36896
    v_mfma_f32_16x16x32_bf16 v[212:215], a[248:251], a[116:119], v[212:215]
    ds_read_b128 a[248:251], v227 offset:6144
    v_mfma_f32_16x16x32_bf16 v[220:223], a[252:255], a[120:123], v[220:223]
    buffer_load_dwordx4 v195, s[12:15], s57 offen offset:1024 lds
    v_mfma_f32_16x16x32_bf16 v[220:223], a[220:223], a[132:135], v[220:223]
    s_addk_i32 s57, 0x3000
    ds_read_b64_tr_b16 a[186:187], v255 offset:36896
    ds_read_b64_tr_b16 a[188:189], v254 offset:36928
    v_mfma_f32_16x16x32_bf16 v[216:219], a[252:255], a[124:127], v[216:219]
    buffer_load_dwordx4 v194, s[12:15], s57 offen offset:2048 lds
    v_mfma_f32_16x16x32_bf16 v[216:219], a[220:223], a[136:139], v[216:219]
    s_add_u32 s57, s49, 0x4800
    ds_read_b64_tr_b16 a[190:191], v255 offset:36928
    v_cvt_pk_bf16_f32 v72, v220, v221
    v_mfma_f32_16x16x32_bf16 v[212:215], a[252:255], a[128:131], v[212:215]
    s_add_u32 m0, s50, 0x6000
    ds_read_b128 a[252:255], v227 offset:6208
    v_cvt_pk_bf16_f32 v73, v222, v223
    v_mfma_f32_16x16x32_bf16 v[212:215], a[220:223], a[140:143], v[212:215]
    v_cvt_pk_bf16_f32 v94, v216, v217
    v_cvt_pk_bf16_f32 v95, v218, v219
    v_mfma_f32_16x16x32_bf16 v[208:211], a[224:227], a[72:75], 0
    ds_read_b128 a[220:223], v227 offset:6272
    v_mfma_f32_16x16x32_bf16 v[208:211], a[228:231], a[84:87], v[208:211]
    s_waitcnt lgkmcnt(6)
    buffer_load_dwordx4 v192, s[12:15], s57 offen lds
    v_mfma_f32_16x16x32_bf16 v[204:207], a[224:227], a[76:79], 0
    v_mfma_f32_16x16x32_bf16 v[204:207], a[228:231], a[88:91], v[204:207]
    v_cvt_pk_bf16_f32 v116, v212, v213
    v_cvt_pk_bf16_f32 v117, v214, v215
    v_mfma_f32_16x16x32_bf16 v[200:203], a[224:227], a[80:83], 0
    s_waitcnt vmcnt(10)
    ds_read_b128 a[224:227], v227 offset:6336
    ds_read_b64_tr_b16 a[192:193], v254 offset:49152
    v_mfma_f32_16x16x32_bf16 v[200:203], a[228:231], a[92:95], v[200:203]
    ds_read_b128 a[228:231], v227 offset:6400
    v_mfma_f32_16x16x32_bf16 v[208:211], a[232:235], a[96:99], v[208:211]
    buffer_load_dwordx4 v193, s[12:15], s57 offen offset:1024 lds
    v_mfma_f32_16x16x32_bf16 v[208:211], a[236:239], a[108:111], v[208:211]
    ds_read_b64_tr_b16 a[194:195], v255 offset:49152
    ds_read_b64_tr_b16 a[196:197], v254 offset:49184
    v_mfma_f32_16x16x32_bf16 v[204:207], a[232:235], a[100:103], v[204:207]
    ds_read_b64_tr_b16 a[198:199], v255 offset:49184
    ds_read_b64_tr_b16 a[200:201], v254 offset:49216
    v_mfma_f32_16x16x32_bf16 v[204:207], a[236:239], a[112:115], v[204:207]
    buffer_load_dwordx4 v194, s[12:15], s57 offen offset:2048 lds
    v_mfma_f32_16x16x32_bf16 v[200:203], a[232:235], a[104:107], v[200:203]
    s_add_u32 s57, s49, 0x9000
    ds_read_b128 a[232:235], v227 offset:6464
    ds_read_b64_tr_b16 a[202:203], v255 offset:49216
    v_mfma_f32_16x16x32_bf16 v[200:203], a[236:239], a[116:119], v[200:203]
    s_add_u32 m0, s50, 0x9000
    ds_read_b128 a[236:239], v225 offset:24384
    v_mfma_f32_16x16x32_bf16 v[208:211], a[240:243], a[120:123], v[208:211]
    v_mfma_f32_16x16x32_bf16 v[208:211], a[244:247], a[132:135], v[208:211]
    s_waitcnt lgkmcnt(8)
    buffer_load_dwordx4 v192, s[12:15], s57 offen lds
    v_mfma_f32_16x16x32_bf16 v[204:207], a[240:243], a[124:127], v[204:207]
    v_mfma_f32_16x16x32_bf16 v[204:207], a[244:247], a[136:139], v[204:207]
    s_waitcnt vmcnt(10)
    ds_read_b64_tr_b16 a[204:205], v254 offset:61440
    ds_read_b64_tr_b16 a[206:207], v255 offset:61440
    v_mfma_f32_16x16x32_bf16 v[200:203], a[240:243], a[128:131], v[200:203]
    ds_read_b128 a[240:243], v225 offset:24448
    ds_read_b64_tr_b16 a[208:209], v254 offset:61472
    v_mfma_f32_16x16x32_bf16 v[200:203], a[244:247], a[140:143], v[200:203]
    v_cvt_pk_bf16_f32 v70, v208, v209
    v_cvt_pk_bf16_f32 v71, v210, v211
    v_mfma_f32_16x16x32_bf16 v[180:183], a[248:251], a[72:75], 0
    v_cvt_pk_bf16_f32 v92, v204, v205
    v_cvt_pk_bf16_f32 v93, v206, v207
    v_mfma_f32_16x16x32_bf16 v[180:183], a[252:255], a[84:87], v[180:183]
    ds_read_b128 a[244:247], v225 offset:24512
    ds_read_b64_tr_b16 a[210:211], v255 offset:61472
    v_mfma_f32_16x16x32_bf16 v[176:179], a[248:251], a[76:79], 0
    v_cvt_pk_bf16_f32 v114, v200, v201
    v_cvt_pk_bf16_f32 v115, v202, v203
    v_mfma_f32_16x16x32_bf16 v[176:179], a[252:255], a[88:91], v[176:179]
    buffer_load_dwordx4 v193, s[12:15], s57 offen offset:1024 lds
    v_mfma_f32_16x16x32_bf16 v[172:175], a[248:251], a[80:83], 0
    ds_read_b128 a[248:251], v225 offset:24576
    ds_read_b64_tr_b16 a[212:213], v254 offset:61504
    v_mfma_f32_16x16x32_bf16 v[172:175], a[252:255], a[92:95], v[172:175]
    ds_read_b128 a[252:255], v225 offset:24640
    v_mfma_f32_16x16x32_bf16 v[180:183], a[220:223], a[96:99], v[180:183]
    buffer_load_dwordx4 v194, s[12:15], s57 offen offset:2048 lds
    v_mfma_f32_16x16x32_bf16 v[180:183], a[224:227], a[108:111], v[180:183]
    s_add_u32 s57, s49, 0xc000
    ds_read_b64_tr_b16 a[214:215], v255 offset:61504
    s_add_u32 m0, s50, 0xc000
    v_mfma_f32_16x16x32_bf16 v[176:179], a[220:223], a[100:103], v[176:179]
    s_waitcnt lgkmcnt(6)
    buffer_load_dwordx4 v192, s[12:15], s57 offen lds
    v_mfma_f32_16x16x32_bf16 v[176:179], a[224:227], a[112:115], v[176:179]
    v_mfma_f32_16x16x32_bf16 v[172:175], a[220:223], a[104:107], v[172:175]
    ds_read_b128 a[220:223], v225 offset:24704
    v_mfma_f32_16x16x32_bf16 v[172:175], a[224:227], a[116:119], v[172:175]
    ds_read_b128 a[224:227], v225 offset:27456
    v_mfma_f32_16x16x32_bf16 v[180:183], a[228:231], a[120:123], v[180:183]
    buffer_load_dwordx4 v195, s[12:15], s57 offen offset:1024 lds
    v_mfma_f32_16x16x32_bf16 v[180:183], a[232:235], a[132:135], v[180:183]
    s_addk_i32 s57, 0x3000
    v_mfma_f32_16x16x32_bf16 v[176:179], a[228:231], a[124:127], v[176:179]
    v_mfma_f32_16x16x32_bf16 v[176:179], a[232:235], a[136:139], v[176:179]
    v_mfma_f32_16x16x32_bf16 v[172:175], a[228:231], a[128:131], v[172:175]
    ds_read_b128 a[228:231], v225 offset:27520
    v_mfma_f32_16x16x32_bf16 v[172:175], a[232:235], a[140:143], v[172:175]
    ds_read_b128 a[232:235], v225 offset:27584
    v_mfma_f32_16x16x32_bf16 v[220:223], a[144:147], a[236:239], 0
    v_cvt_pk_bf16_f32 v82, v180, v181
    v_cvt_pk_bf16_f32 v83, v182, v183
    v_mfma_f32_16x16x32_bf16 v[220:223], a[156:159], a[240:243], v[220:223]
    v_cvt_pk_bf16_f32 v104, v176, v177
    v_cvt_pk_bf16_f32 v105, v178, v179
    v_mfma_f32_16x16x32_bf16 v[216:219], a[148:151], a[236:239], 0
    v_cvt_pk_bf16_f32 v126, v172, v173
    v_cvt_pk_bf16_f32 v127, v174, v175
    v_mfma_f32_16x16x32_bf16 v[216:219], a[160:163], a[240:243], v[216:219]
    buffer_load_dwordx4 v194, s[12:15], s57 offen offset:2048 lds
    v_mfma_f32_16x16x32_bf16 v[212:215], a[152:155], a[236:239], 0
    s_add_u32 s57, s49, 0xd800
    ds_read_b128 a[236:239], v225 offset:27648
    s_add_u32 m0, s50, 0xf000
    v_mfma_f32_16x16x32_bf16 v[212:215], a[164:167], a[240:243], v[212:215]
    s_waitcnt lgkmcnt(3)
    ds_read_b128 a[240:243], v225 offset:27712
    v_mfma_f32_16x16x32_bf16 v[220:223], a[168:171], a[244:247], v[220:223]
    buffer_load_dwordx4 v192, s[12:15], s57 offen lds
    v_mfma_f32_16x16x32_bf16 v[220:223], a[180:183], a[248:251], v[220:223]
    v_mfma_f32_16x16x32_bf16 v[216:219], a[172:175], a[244:247], v[216:219]
    buffer_load_dwordx4 v193, s[12:15], s57 offen offset:1024 lds
    v_mfma_f32_16x16x32_bf16 v[216:219], a[184:187], a[248:251], v[216:219]
    v_mfma_f32_16x16x32_bf16 v[212:215], a[176:179], a[244:247], v[212:215]
    ds_read_b128 a[244:247], v225 offset:27776
    v_mfma_f32_16x16x32_bf16 v[212:215], a[188:191], a[248:251], v[212:215]
    ds_read_b128 a[248:251], v224 offset:30976
    v_mfma_f32_16x16x32_bf16 v[220:223], a[192:195], a[252:255], v[220:223]
    buffer_load_dwordx4 v194, s[12:15], s57 offen offset:2048 lds
    v_mfma_f32_16x16x32_bf16 v[220:223], a[204:207], a[220:223], v[220:223]
    s_add_u32 m0, s41, 0
    v_mfma_f32_16x16x32_bf16 v[216:219], a[196:199], a[252:255], v[216:219]
    v_mfma_f32_16x16x32_bf16 v[216:219], a[208:211], a[220:223], v[216:219]
    v_mfma_f32_16x16x32_bf16 v[212:215], a[200:203], a[252:255], v[212:215]
    s_waitcnt lgkmcnt(1)
    ds_read_b128 a[252:255], v224 offset:31040
    v_mfma_f32_16x16x32_bf16 v[212:215], a[212:215], a[220:223], v[212:215]
    s_barrier
    ds_read_b128 a[220:223], v224 offset:31104
    v_mul_f32 v220, s37, v220
    v_mfma_f32_16x16x32_bf16 v[208:211], a[144:147], a[224:227], 0
    v_mul_f32 v221, s37, v221
    v_mul_f32 v222, s37, v222
    v_mfma_f32_16x16x32_bf16 v[208:211], a[156:159], a[228:231], v[208:211]
    v_mul_f32 v223, s37, v223
    v_cvt_pk_bf16_f32 v132, v220, v221
    v_mfma_f32_16x16x32_bf16 v[204:207], a[148:151], a[224:227], 0
    v_cvt_pk_bf16_f32 v133, v222, v223
    v_mul_f32 v216, s37, v216
    v_mfma_f32_16x16x32_bf16 v[204:207], a[160:163], a[228:231], v[204:207]
    v_mul_f32 v217, s37, v217
    v_mul_f32 v218, s37, v218
    v_mfma_f32_16x16x32_bf16 v[200:203], a[152:155], a[224:227], 0
    v_mul_f32 v219, s37, v219
    v_cvt_pk_bf16_f32 v134, v216, v217
    v_mfma_f32_16x16x32_bf16 v[200:203], a[164:167], a[228:231], v[200:203]
    v_cvt_pk_bf16_f32 v135, v218, v219
    v_mul_f32 v212, s37, v212
    v_mfma_f32_16x16x32_bf16 v[208:211], a[168:171], a[232:235], v[208:211]
    v_mul_f32 v213, s37, v213
    v_mul_f32 v214, s37, v214
    v_mfma_f32_16x16x32_bf16 v[208:211], a[180:183], a[236:239], v[208:211]
    v_mul_f32 v215, s37, v215
    v_cvt_pk_bf16_f32 v136, v212, v213
    v_mfma_f32_16x16x32_bf16 v[144:147], v[0:3], v[132:135], v[144:147]
    ds_read_b128 a[224:227], v224 offset:31168
    v_cvt_pk_bf16_f32 v137, v214, v215
    v_mfma_f32_16x16x32_bf16 v[148:151], v[24:27], v[132:135], v[148:151]
    s_waitcnt vmcnt(6)
    ds_read_b128 a[228:231], v224 offset:31232
    ds_read_b64_tr_b16 v[160:161], v86 offset:36864
    v_mfma_f32_16x16x32_bf16 v[152:155], v[30:33], v[132:135], v[152:155]
    buffer_load_dwordx4 v246, s[4:7], s56 offen lds
    v_mfma_f32_16x16x16_bf16 v[144:147], v[4:5], v[136:137], v[144:147]
    buffer_load_dwordx4 v247, s[4:7], s56 offen offset:1024 lds
    v_mfma_f32_16x16x16_bf16 v[148:151], v[28:29], v[136:137], v[148:151]
    s_add_u32 s56, s56, s42
    ds_read_b64_tr_b16 v[162:163], v86 offset:38400
    ds_read_b64_tr_b16 v[164:165], v86 offset:36896
    v_mfma_f32_16x16x16_bf16 v[152:155], v[34:35], v[136:137], v[152:155]
    s_add_u32 m0, s41, 0x1e40
    ds_read_b64_tr_b16 v[166:167], v86 offset:38432
    ds_read_b64_tr_b16 v[168:169], v86 offset:36928
    v_mfma_f32_16x16x32_bf16 v[204:207], a[172:175], a[232:235], v[204:207]
    ds_read_b64_tr_b16 v[170:171], v86 offset:38464
    v_mfma_f32_16x16x32_bf16 v[204:207], a[184:187], a[236:239], v[204:207]
    buffer_load_dwordx4 v246, s[4:7], s56 offen lds
    v_mfma_f32_16x16x32_bf16 v[200:203], a[176:179], a[232:235], v[200:203]
    ds_read_b128 a[232:235], v224 offset:31296
    v_mfma_f32_16x16x32_bf16 v[200:203], a[188:191], a[236:239], v[200:203]
    ds_read_b128 a[236:239], v224 offset:34048
    v_mfma_f32_16x16x32_bf16 v[208:211], a[192:195], a[240:243], v[208:211]
    v_exp_f32 v144, v144
    v_mfma_f32_16x16x32_bf16 v[208:211], a[204:207], a[244:247], v[208:211]
    buffer_load_dwordx4 v247, s[4:7], s56 offen offset:1024 lds
    v_mfma_f32_16x16x32_bf16 v[204:207], a[196:199], a[240:243], v[204:207]
    s_add_u32 s56, s56, s42
    v_exp_f32 v145, v145
    v_mfma_f32_16x16x32_bf16 v[204:207], a[208:211], a[244:247], v[204:207]
    s_add_u32 m0, s41, 0x3c80
    s_waitcnt vmcnt(7)
    ds_read_b64_tr_b16 v[248:249], v86 offset:49152
    ds_read_b64_tr_b16 v[250:251], v86 offset:50688
    v_mfma_f32_16x16x32_bf16 v[200:203], a[200:203], a[240:243], v[200:203]
    v_mul_f32 v208, s37, v208
    v_mul_f32 v209, s37, v209
    v_mfma_f32_16x16x32_bf16 v[200:203], a[212:215], a[244:247], v[200:203]
    s_waitcnt lgkmcnt(4)
    v_mul_f32 v210, s37, v210
    v_mul_f32 v211, s37, v211
    v_mfma_f32_16x16x32_bf16 v[180:183], a[248:251], a[72:75], 0
    v_cvt_pk_bf16_f32 v138, v208, v209
    v_cvt_pk_bf16_f32 v139, v210, v211
    v_mfma_f32_16x16x32_bf16 v[180:183], a[252:255], a[84:87], v[180:183]
    v_mul_f32 v204, s37, v204
    v_mul_f32 v205, s37, v205
    v_mfma_f32_16x16x32_bf16 v[176:179], a[248:251], a[76:79], 0
    v_mul_f32 v206, s37, v206
    v_mul_f32 v207, s37, v207
    v_mfma_f32_16x16x32_bf16 v[176:179], a[252:255], a[88:91], v[176:179]
    v_cvt_pk_bf16_f32 v140, v204, v205
    v_cvt_pk_bf16_f32 v141, v206, v207
    v_mfma_f32_16x16x32_bf16 v[172:175], a[248:251], a[80:83], 0
    v_mul_f32 v200, s37, v200
    v_mul_f32 v201, s37, v201
    v_mfma_f32_16x16x32_bf16 v[172:175], a[252:255], a[92:95], v[172:175]
    v_mul_f32 v202, s37, v202
    v_mul_f32 v203, s37, v203
    v_mfma_f32_16x16x32_bf16 v[180:183], a[220:223], a[96:99], v[180:183]
    v_cvt_pk_bf16_f32 v142, v200, v201
    v_cvt_pk_bf16_f32 v143, v202, v203
    v_mfma_f32_16x16x32_bf16 v[180:183], a[224:227], a[108:111], v[180:183]
    ds_read_b128 a[240:243], v224 offset:34112
    ds_read_b128 a[244:247], v224 offset:34176
    v_mfma_f32_16x16x32_bf16 v[176:179], a[220:223], a[100:103], v[176:179]
    ds_read_b128 a[248:251], v224 offset:34240
    v_cvt_pk_bf16_f32 v156, v144, v145
    v_mfma_f32_16x16x32_bf16 v[176:179], a[224:227], a[112:115], v[176:179]
    ds_read_b128 a[252:255], v224 offset:34304
    v_mfma_f32_16x16x32_bf16 v[172:175], a[220:223], a[104:107], v[172:175]
    ds_read_b128 a[220:223], v224 offset:34368
    v_mfma_f32_16x16x32_bf16 v[172:175], a[224:227], a[116:119], v[172:175]
    ds_read_b128 a[224:227], v224 offset:46464
    v_mfma_f32_16x16x32_bf16 v[180:183], a[228:231], a[120:123], v[180:183]
    s_waitcnt lgkmcnt(6)
    buffer_load_dwordx4 v246, s[4:7], s56 offen lds
    v_mfma_f32_16x16x32_bf16 v[180:183], a[232:235], a[132:135], v[180:183]
    buffer_load_dwordx4 v247, s[4:7], s56 offen offset:1024 lds
    v_mfma_f32_16x16x32_bf16 v[176:179], a[228:231], a[124:127], v[176:179]
    s_add_u32 s56, s56, s42
    v_exp_f32 v146, v146
    v_mfma_f32_16x16x32_bf16 v[176:179], a[232:235], a[136:139], v[176:179]
    s_add_u32 m0, s41, 0x5ac0
    v_exp_f32 v147, v147
    v_mfma_f32_16x16x32_bf16 v[172:175], a[228:231], a[128:131], v[172:175]
    v_cvt_pk_bf16_f32 v74, v180, v181
    v_cvt_pk_bf16_f32 v75, v182, v183
    v_mfma_f32_16x16x32_bf16 v[172:175], a[232:235], a[140:143], v[172:175]
    ds_read_b128 a[228:231], v224 offset:46528
    ds_read_b128 a[232:235], v224 offset:46592
    v_mfma_f32_16x16x32_bf16 v[220:223], a[236:239], a[72:75], 0
    s_waitcnt lgkmcnt(4)
    v_cvt_pk_bf16_f32 v96, v176, v177
    v_cvt_pk_bf16_f32 v97, v178, v179
    v_mfma_f32_16x16x32_bf16 v[220:223], a[240:243], a[84:87], v[220:223]
    buffer_load_dwordx4 v246, s[4:7], s56 offen lds
    v_mfma_f32_16x16x32_bf16 v[216:219], a[236:239], a[76:79], 0
    v_cvt_pk_bf16_f32 v118, v172, v173
    v_cvt_pk_bf16_f32 v119, v174, v175
    v_mfma_f32_16x16x32_bf16 v[216:219], a[240:243], a[88:91], v[216:219]
    buffer_load_dwordx4 v247, s[4:7], s56 offen offset:1024 lds
    v_mfma_f32_16x16x32_bf16 v[212:215], a[236:239], a[80:83], 0
    s_add_u32 s56, s56, s42
    ds_read_b128 a[236:239], v224 offset:46656
    v_cvt_pk_bf16_f32 v157, v146, v147
    v_mfma_f32_16x16x32_bf16 v[212:215], a[240:243], a[92:95], v[212:215]
    s_add_u32 m0, s41, 0x7900
    ds_read_b128 a[240:243], v224 offset:46720
    ds_read_b128 v[144:147], v234
    v_mfma_f32_16x16x32_bf16 v[220:223], a[244:247], a[96:99], v[220:223]
    v_bfe_u32 v234, s62, v232, 4
    v_mad_u32_u24 v235, v234, s40, v229
    v_mfma_f32_16x16x32_bf16 v[220:223], a[248:251], a[108:111], v[220:223]
    v_mad_u32_u24 v234, v234, s40, v228
    v_mfma_f32_16x16x32_bf16 v[216:219], a[244:247], a[100:103], v[216:219]
    v_exp_f32 v148, v148
    v_mfma_f32_16x16x32_bf16 v[216:219], a[248:251], a[112:115], v[216:219]
    v_exp_f32 v149, v149
    v_mfma_f32_16x16x32_bf16 v[212:215], a[244:247], a[104:107], v[212:215]
    ds_read_b128 a[244:247], v224 offset:46784
    v_cvt_pk_bf16_f32 v158, v148, v149
    v_mfma_f32_16x16x32_bf16 v[212:215], a[248:251], a[116:119], v[212:215]
    ds_read_b128 a[248:251], v224 offset:49536
    v_mfma_f32_16x16x32_bf16 v[220:223], a[252:255], a[120:123], v[220:223]
    s_waitcnt lgkmcnt(4)
    v_exp_f32 v150, v150
    v_mfma_f32_16x16x32_bf16 v[220:223], a[220:223], a[132:135], v[220:223]
    s_waitcnt lgkmcnt(2)
    v_exp_f32 v151, v151
    v_mfma_f32_16x16x32_bf16 v[144:147], v[6:9], v[132:135], v[144:147]
    v_cvt_pk_bf16_f32 v159, v150, v151
    v_mfma_f32_16x16x32_bf16 v[216:219], a[252:255], a[124:127], v[216:219]
    ds_read_b128 v[148:151], v228 offset:1920
    v_mfma_f32_16x16x32_bf16 v[216:219], a[220:223], a[136:139], v[216:219]
    v_exp_f32 v152, v152
    v_mfma_f32_16x16x32_bf16 v[196:199], a[216:219], v[156:159], 0
    v_cvt_pk_bf16_f32 v76, v220, v221
    v_cvt_pk_bf16_f32 v77, v222, v223
    v_mfma_f32_16x16x32_bf16 v[184:187], v[66:69], v[156:159], 0
    v_exp_f32 v153, v153
    v_mfma_f32_16x16x32_bf16 v[188:191], v[88:91], v[156:159], 0
    v_exp_f32 v154, v154
    v_mfma_f32_16x16x32_bf16 v[192:195], v[110:113], v[156:159], 0
    v_cvt_pk_bf16_f32 v98, v216, v217
    v_cvt_pk_bf16_f32 v99, v218, v219
    v_mfma_f32_16x16x16_bf16 v[144:147], v[10:11], v[136:137], v[144:147]
    v_exp_f32 v155, v155
    v_mfma_f32_16x16x32_bf16 v[212:215], a[252:255], a[128:131], v[212:215]
    ds_read_b128 a[252:255], v224 offset:49600
    v_cvt_pk_bf16_f32 v156, v152, v153
    v_mfma_f32_16x16x32_bf16 v[212:215], a[220:223], a[140:143], v[212:215]
    s_waitcnt lgkmcnt(1)
    ds_read_b128 a[220:223], v224 offset:49664
    v_cvt_pk_bf16_f32 v157, v154, v155
    v_mfma_f32_16x16x32_bf16 v[148:151], v[12:15], v[132:135], v[148:151]
    ds_read_b128 v[152:155], v229 offset:1920
    v_mfma_f32_16x16x32_bf16 v[208:211], a[224:227], a[72:75], 0
    v_exp_f32 v144, v144
    v_mfma_f32_16x16x32_bf16 v[208:211], a[228:231], a[84:87], v[208:211]
    v_exp_f32 v145, v145
    v_mfma_f32_16x16x32_bf16 v[204:207], a[224:227], a[76:79], 0
    v_cvt_pk_bf16_f32 v120, v212, v213
    v_cvt_pk_bf16_f32 v121, v214, v215
    v_mfma_f32_16x16x32_bf16 v[204:207], a[228:231], a[88:91], v[204:207]
    v_exp_f32 v146, v146
    v_mfma_f32_16x16x16_bf16 v[148:151], v[16:17], v[136:137], v[148:151]
    v_exp_f32 v147, v147
    v_mfma_f32_16x16x32_bf16 v[200:203], a[224:227], a[80:83], 0
    ds_read_b128 a[224:227], v224 offset:49728
    v_cvt_pk_bf16_f32 v158, v144, v145
    v_mfma_f32_16x16x32_bf16 v[200:203], a[228:231], a[92:95], v[200:203]
    s_waitcnt lgkmcnt(1)
    ds_read_b128 a[228:231], v224 offset:49792
    v_cvt_pk_bf16_f32 v159, v146, v147
    v_mfma_f32_16x16x32_bf16 v[152:155], v[36:39], v[132:135], v[152:155]
    ds_read_b128 v[144:147], v235
    v_bfe_u32 v235, s61, v232, 4
    v_mfma_f32_16x16x32_bf16 v[196:199], a[216:219], v[156:159], v[196:199]
    v_mad_u32_u24 v235, v235, s40, v230
    v_mfma_f32_16x16x32_bf16 v[184:187], v[70:73], v[156:159], v[184:187]
    v_exp_f32 v148, v148
    v_mfma_f32_16x16x32_bf16 v[188:191], v[92:95], v[156:159], v[188:191]
    v_exp_f32 v149, v149
    v_mfma_f32_16x16x32_bf16 v[192:195], v[114:117], v[156:159], v[192:195]
    v_exp_f32 v150, v150
    v_mfma_f32_16x16x16_bf16 v[152:155], v[40:41], v[136:137], v[152:155]
    v_exp_f32 v151, v151
    v_mfma_f32_16x16x32_bf16 v[208:211], a[232:235], a[96:99], v[208:211]
    v_cvt_pk_bf16_f32 v156, v148, v149
    v_cvt_pk_bf16_f32 v157, v150, v151
    v_mfma_f32_16x16x32_bf16 v[208:211], a[236:239], a[108:111], v[208:211]
    s_waitcnt lgkmcnt(0)
    ds_read_b128 v[148:151], v234
    v_bfe_u32 v234, s60, v232, 4
    v_mfma_f32_16x16x32_bf16 v[144:147], v[42:45], v[132:135], v[144:147]
L_pg2:
    s_cbranch_execz L_pg6
    v_mad_u32_u24 v234, v234, s40, v230
    v_mfma_f32_16x16x32_bf16 v[204:207], a[232:235], a[100:103], v[204:207]
    v_exp_f32 v152, v152
    v_mfma_f32_16x16x32_bf16 v[204:207], a[236:239], a[112:115], v[204:207]
    v_exp_f32 v153, v153
    v_mfma_f32_16x16x32_bf16 v[200:203], a[232:235], a[104:107], v[200:203]
    s_waitcnt vmcnt(4)
    ds_read_b128 a[232:235], v224 offset:49856
    v_cvt_pk_bf16_f32 v158, v152, v153
    v_mfma_f32_16x16x32_bf16 v[200:203], a[236:239], a[116:119], v[200:203]
    s_barrier
    ds_read_b128 a[236:239], v227 offset:37120
    ds_read_b128 v[252:255], v224 offset:320
    v_mfma_f32_16x16x16_bf16 v[144:147], v[46:47], v[136:137], v[144:147]
    v_exp_f32 v154, v154
    v_mfma_f32_16x16x32_bf16 v[208:211], a[240:243], a[120:123], v[208:211]
    v_exp_f32 v155, v155
    v_mfma_f32_16x16x32_bf16 v[208:211], a[244:247], a[132:135], v[208:211]
    s_waitcnt lgkmcnt(3)
    v_cvt_pk_bf16_f32 v159, v154, v155
    v_mfma_f32_16x16x32_bf16 v[148:151], v[18:21], v[132:135], v[148:151]
    ds_read_b128 v[152:155], v234
    v_bfe_u32 v234, s62, v232, 4
    v_mfma_f32_16x16x32_bf16 v[196:199], a[216:219], v[156:159], v[196:199]
    v_mad_u32_u24 v234, v234, s40, v230
    v_mfma_f32_16x16x32_bf16 v[184:187], v[74:77], v[156:159], v[184:187]
    v_exp_f32 v144, v144
    v_mfma_f32_16x16x32_bf16 v[188:191], v[96:99], v[156:159], v[188:191]
    v_cvt_pk_bf16_f32 v80, v208, v209
    v_cvt_pk_bf16_f32 v81, v210, v211
    v_mfma_f32_16x16x32_bf16 v[192:195], v[118:121], v[156:159], v[192:195]
    v_exp_f32 v145, v145
    v_mfma_f32_16x16x16_bf16 v[148:151], v[22:23], v[136:137], v[148:151]
    v_exp_f32 v146, v146
    v_mfma_f32_16x16x32_bf16 v[204:207], a[240:243], a[124:127], v[204:207]
    v_exp_f32 v147, v147
    v_mfma_f32_16x16x32_bf16 v[204:207], a[244:247], a[136:139], v[204:207]
    s_waitcnt lgkmcnt(0)
    v_cvt_pk_bf16_f32 v156, v144, v145
    v_cvt_pk_bf16_f32 v157, v146, v147
    v_mfma_f32_16x16x32_bf16 v[152:155], v[24:27], v[138:141], v[152:155]
    ds_read_b128 v[144:147], v235
    v_bfe_u32 v235, s63, v233, 4
    v_mfma_f32_16x16x32_bf16 v[200:203], a[240:243], a[128:131], v[200:203]
    ds_read_b128 a[240:243], v227 offset:37184
    v_mad_u32_u24 v235, v235, s40, v231
    v_mfma_f32_16x16x32_bf16 v[200:203], a[244:247], a[140:143], v[200:203]
    v_cvt_pk_bf16_f32 v102, v204, v205
    v_cvt_pk_bf16_f32 v103, v206, v207
    v_mfma_f32_16x16x16_bf16 v[152:155], v[28:29], v[142:143], v[152:155]
    ds_read_b128 a[244:247], v227 offset:37248
    v_mfma_f32_16x16x32_bf16 v[180:183], a[248:251], a[72:75], 0
    v_exp_f32 v148, v148
    v_mfma_f32_16x16x32_bf16 v[180:183], a[252:255], a[84:87], v[180:183]
    v_exp_f32 v149, v149
    v_mfma_f32_16x16x32_bf16 v[176:179], a[248:251], a[76:79], 0
    v_cvt_pk_bf16_f32 v124, v200, v201
    v_cvt_pk_bf16_f32 v125, v202, v203
    v_mfma_f32_16x16x32_bf16 v[176:179], a[252:255], a[88:91], v[176:179]
    s_waitcnt lgkmcnt(2)
    v_exp_f32 v150, v150
    v_mfma_f32_16x16x32_bf16 v[144:147], v[30:33], v[138:141], v[144:147]
    v_exp_f32 v151, v151
    v_mfma_f32_16x16x32_bf16 v[172:175], a[248:251], a[80:83], 0
    ds_read_b128 a[248:251], v227 offset:37312
    v_cvt_pk_bf16_f32 v158, v148, v149
    v_mfma_f32_16x16x32_bf16 v[172:175], a[252:255], a[92:95], v[172:175]
    ds_read_b128 a[252:255], v227 offset:37376
    v_cvt_pk_bf16_f32 v159, v150, v151
    v_mfma_f32_16x16x16_bf16 v[144:147], v[34:35], v[142:143], v[144:147]
    ds_read_b128 v[148:151], v230 offset:1920
    v_mfma_f32_16x16x32_bf16 v[196:199], a[216:219], v[156:159], v[196:199]
    v_exp_f32 v152, v152
    v_mfma_f32_16x16x32_bf16 v[180:183], a[220:223], a[96:99], v[180:183]
    v_exp_f32 v153, v153
    v_mfma_f32_16x16x32_bf16 v[180:183], a[224:227], a[108:111], v[180:183]
    s_waitcnt vmcnt(0)
    ds_write_b128 v87, v[160:163] offset:36864
    v_mfma_f32_16x16x32_bf16 v[176:179], a[220:223], a[100:103], v[176:179]
    ds_write_b128 v87, v[164:167] offset:37888
    v_mfma_f32_16x16x32_bf16 v[176:179], a[224:227], a[112:115], v[176:179]
    s_waitcnt lgkmcnt(2)
    v_rcp_f32 v197, v196
    v_mfma_f32_16x16x32_bf16 v[148:151], v[36:39], v[138:141], v[148:151]
    v_max3_f32 v236, v236, v196, v197
    v_mfma_f32_16x16x32_bf16 v[172:175], a[220:223], a[104:107], v[172:175]
    ds_write_b128 v87, v[168:171] offset:38912
    v_mfma_f32_16x16x32_bf16 v[172:175], a[224:227], a[116:119], v[172:175]
    v_exp_f32 v154, v154
    v_mfma_f32_16x16x32_bf16 v[180:183], a[228:231], a[120:123], v[180:183]
    v_exp_f32 v155, v155
    v_mfma_f32_16x16x32_bf16 v[180:183], a[232:235], a[132:135], v[180:183]
    v_exp_f32 v144, v144
    v_mfma_f32_16x16x16_bf16 v[148:151], v[40:41], v[142:143], v[148:151]
    v_exp_f32 v145, v145
    v_mfma_f32_16x16x32_bf16 v[176:179], a[228:231], a[124:127], v[176:179]
    v_exp_f32 v146, v146
    v_mfma_f32_16x16x32_bf16 v[176:179], a[232:235], a[136:139], v[176:179]
    ds_read_b128 a[220:223], v227 offset:37440
    ds_read_b128 a[224:227], v225 offset:39872
    v_mfma_f32_16x16x32_bf16 v[172:175], a[228:231], a[128:131], v[172:175]
    v_cvt_pk_bf16_f32 v78, v180, v181
    v_cvt_pk_bf16_f32 v79, v182, v183
    v_mfma_f32_16x16x32_bf16 v[172:175], a[232:235], a[140:143], v[172:175]
    ds_read_b128 a[228:231], v225 offset:39936
    ds_read_b128 a[232:235], v225 offset:40000
    v_mfma_f32_16x16x32_bf16 v[184:187], v[78:81], v[156:159], v[184:187]
    v_cvt_pk_bf16_f32 v100, v176, v177
    v_cvt_pk_bf16_f32 v101, v178, v179
    v_mfma_f32_16x16x32_bf16 v[220:223], a[236:239], a[72:75], 0
    ds_read_b128 v[160:163], v224 offset:3328
    ds_read_b128 v[164:167], v224 offset:3392
    v_mfma_f32_16x16x32_bf16 v[220:223], a[240:243], a[84:87], v[220:223]
    v_cvt_pk_bf16_f32 v122, v172, v173
    v_cvt_pk_bf16_f32 v123, v174, v175
    v_mfma_f32_16x16x32_bf16 v[188:191], v[100:103], v[156:159], v[188:191]
    v_mul_f32 v184, v184, v197
    v_mul_f32 v185, v185, v197
    v_mfma_f32_16x16x32_bf16 v[192:195], v[122:125], v[156:159], v[192:195]
    v_cvt_pk_bf16_f32 v184, v184, v185
    v_mul_f32 v186, v186, v197
    v_mfma_f32_16x16x32_bf16 v[216:219], a[236:239], a[76:79], 0
    ds_read_b64_tr_b16 v[168:169], v86 offset:61440
    v_mul_f32 v187, v187, v197
    v_mfma_f32_16x16x32_bf16 v[216:219], a[240:243], a[88:91], v[216:219]
    v_cvt_pk_bf16_f32 v185, v186, v187
    v_mul_f32 v188, v188, v197
    v_mfma_f32_16x16x32_bf16 v[212:215], a[236:239], a[80:83], 0
    ds_read_b128 a[236:239], v225 offset:40064
    v_mul_f32 v189, v189, v197
    v_mfma_f32_16x16x32_bf16 v[212:215], a[240:243], a[92:95], v[212:215]
    ds_read_b128 a[240:243], v225 offset:40128
    v_cvt_pk_bf16_f32 v186, v188, v189
    v_mfma_f32_16x16x32_bf16 v[220:223], a[244:247], a[96:99], v[220:223]
    v_mul_f32 v190, v190, v197
    v_mul_f32 v191, v191, v197
    v_mfma_f32_16x16x32_bf16 v[220:223], a[248:251], a[108:111], v[220:223]
    v_cvt_pk_bf16_f32 v187, v190, v191
    v_mul_f32 v192, v192, v197
    v_mfma_f32_16x16x32_bf16 v[216:219], a[244:247], a[100:103], v[216:219]
    v_mul_f32 v193, v193, v197
    v_cvt_pk_bf16_f32 v188, v192, v193
    v_mfma_f32_16x16x32_bf16 v[216:219], a[248:251], a[112:115], v[216:219]
    v_mul_f32 v194, v194, v197
    v_mul_f32 v195, v195, v197
    v_mfma_f32_16x16x32_bf16 v[212:215], a[244:247], a[104:107], v[212:215]
    ds_read_b128 a[244:247], v225 offset:40192
    v_cvt_pk_bf16_f32 v189, v194, v195
    v_mfma_f32_16x16x32_bf16 v[212:215], a[248:251], a[116:119], v[212:215]
    ds_write_b128 v237, v[184:187]
    v_mfma_f32_16x16x32_bf16 v[220:223], a[252:255], a[120:123], v[220:223]
    s_waitcnt lgkmcnt(3)
    ds_write_b64 v238, v[188:189]
    v_mfma_f32_16x16x32_bf16 v[220:223], a[220:223], a[132:135], v[220:223]
    v_cvt_pk_bf16_f32 v156, v152, v153
    v_cvt_pk_bf16_f32 v157, v154, v155
    v_mfma_f32_16x16x32_bf16 v[216:219], a[252:255], a[124:127], v[216:219]
    v_exp_f32 v147, v147
    v_mfma_f32_16x16x32_bf16 v[216:219], a[220:223], a[136:139], v[216:219]
    v_cvt_pk_bf16_f32 v158, v144, v145
    v_cvt_pk_bf16_f32 v159, v146, v147
    v_mfma_f32_16x16x32_bf16 v[212:215], a[252:255], a[128:131], v[212:215]
    v_cvt_pk_bf16_f32 v84, v220, v221
    v_cvt_pk_bf16_f32 v85, v222, v223
    v_mfma_f32_16x16x32_bf16 v[212:215], a[220:223], a[140:143], v[212:215]
    ds_read_b128 v[152:155], v234
    v_bfe_u32 v234, s64, v233, 4
    v_mfma_f32_16x16x32_bf16 v[196:199], a[216:219], v[156:159], 0
    v_cvt_pk_bf16_f32 v106, v216, v217
    v_cvt_pk_bf16_f32 v107, v218, v219
    v_mfma_f32_16x16x32_bf16 v[184:187], v[68:71], v[156:159], 0
    ds_read_b128 v[144:147], v235
    v_mad_u32_u24 v234, v234, s40, v231
    v_mfma_f32_16x16x32_bf16 v[188:191], v[90:93], v[156:159], 0
    v_cvt_pk_bf16_f32 v128, v212, v213
    v_cvt_pk_bf16_f32 v129, v214, v215
    v_mfma_f32_16x16x32_bf16 v[192:195], v[112:115], v[156:159], 0
    ds_read_b64_tr_b16 a[248:249], v86 offset:12288
    v_bfe_u32 v235, s65, v232, 4
    v_mfma_f32_16x16x32_bf16 v[208:211], a[144:147], a[224:227], 0
    ds_read_b64_tr_b16 a[250:251], v86 offset:13824
    ds_read_b64_tr_b16 a[252:253], v86 offset:12320
    v_mfma_f32_16x16x32_bf16 v[208:211], a[156:159], a[228:231], v[208:211]
    ds_read_b64_tr_b16 a[254:255], v86 offset:13856
    ds_read_b64_tr_b16 a[220:221], v86 offset:12352
    v_mfma_f32_16x16x32_bf16 v[204:207], a[148:151], a[224:227], 0
    ds_read_b64_tr_b16 a[222:223], v86 offset:13888
    ds_read_b64_tr_b16 v[170:171], v86 offset:62976
    v_mfma_f32_16x16x32_bf16 v[204:207], a[160:163], a[228:231], v[204:207]
    s_waitcnt lgkmcnt(8)
    v_exp_f32 v148, v148
    v_mfma_f32_16x16x32_bf16 v[152:155], v[42:45], v[138:141], v[152:155]
    s_waitcnt lgkmcnt(7)
    v_exp_f32 v149, v149
    v_mfma_f32_16x16x32_bf16 v[144:147], v[48:51], v[138:141], v[144:147]
    v_exp_f32 v150, v150
    v_mfma_f32_16x16x32_bf16 v[200:203], a[152:155], a[224:227], 0
    s_waitcnt lgkmcnt(5)
    ds_write_b128 v87, a[248:251] offset:12288
    v_mfma_f32_16x16x32_bf16 v[200:203], a[164:167], a[228:231], v[200:203]
    s_waitcnt lgkmcnt(4)
    ds_write_b128 v87, a[252:255] offset:13312
    v_mfma_f32_16x16x16_bf16 v[152:155], v[46:47], v[142:143], v[152:155]
    s_waitcnt lgkmcnt(3)
    ds_write_b128 v87, a[220:223] offset:14336
    v_mfma_f32_16x16x16_bf16 v[144:147], v[52:53], v[142:143], v[144:147]
    v_exp_f32 v151, v151
    v_mfma_f32_16x16x32_bf16 v[208:211], a[168:171], a[232:235], v[208:211]
    v_cvt_pk_bf16_f32 v156, v148, v149
    v_cvt_pk_bf16_f32 v157, v150, v151
    v_mfma_f32_16x16x32_bf16 v[208:211], a[180:183], a[236:239], v[208:211]
    v_mfma_f32_16x16x32_bf16 v[204:207], a[172:175], a[232:235], v[204:207]
    v_exp_f32 v152, v152
    v_mfma_f32_16x16x32_bf16 v[204:207], a[184:187], a[236:239], v[204:207]
    v_exp_f32 v153, v153
    v_mfma_f32_16x16x32_bf16 v[200:203], a[176:179], a[232:235], v[200:203]
    v_exp_f32 v154, v154
    v_mfma_f32_16x16x32_bf16 v[200:203], a[188:191], a[236:239], v[200:203]
    v_exp_f32 v155, v155
    v_mfma_f32_16x16x32_bf16 v[208:211], a[192:195], a[240:243], v[208:211]
    ds_read_b128 a[236:239], v224
    ds_read_b128 a[248:251], v224 offset:192
    v_mfma_f32_16x16x32_bf16 v[208:211], a[204:207], a[244:247], v[208:211]
    ds_read_b128 a[252:255], v224 offset:256
    v_cvt_pk_bf16_f32 v158, v152, v153
    v_mfma_f32_16x16x32_bf16 v[204:207], a[196:199], a[240:243], v[204:207]
    ds_read_b128 v[148:151], v234
    v_mad_u32_u24 v234, v235, s40, v229
    v_mfma_f32_16x16x32_bf16 v[204:207], a[208:211], a[244:247], v[204:207]
    v_mad_u32_u24 v235, v235, s40, v228
    v_cvt_pk_bf16_f32 v159, v154, v155
    v_mfma_f32_16x16x32_bf16 v[200:203], a[200:203], a[240:243], v[200:203]
    v_mul_f32 v208, s37, v208
    v_mul_f32 v209, s37, v209
    v_mfma_f32_16x16x32_bf16 v[200:203], a[212:215], a[244:247], v[200:203]
    v_mul_f32 v210, s37, v210
    v_mul_f32 v211, s37, v211
    v_mfma_f32_16x16x32_bf16 v[196:199], a[216:219], v[156:159], v[196:199]
    v_cvt_pk_bf16_f32 v132, v208, v209
    v_cvt_pk_bf16_f32 v133, v210, v211
    v_mfma_f32_16x16x32_bf16 v[184:187], v[76:79], v[156:159], v[184:187]
    v_mul_f32 v204, s37, v204
    v_mul_f32 v205, s37, v205
    v_mfma_f32_16x16x32_bf16 v[188:191], v[98:101], v[156:159], v[188:191]
    v_mul_f32 v206, s37, v206
    v_mul_f32 v207, s37, v207
    v_mfma_f32_16x16x32_bf16 v[192:195], v[120:123], v[156:159], v[192:195]
    s_waitcnt lgkmcnt(2)
    v_cvt_pk_bf16_f32 v134, v204, v205
    v_cvt_pk_bf16_f32 v135, v206, v207
    v_mfma_f32_16x16x32_bf16 v[180:183], a[0:3], a[236:239], 0
    s_waitcnt lgkmcnt(0)
    v_mul_f32 v200, s37, v200
    v_mul_f32 v201, s37, v201
    v_mfma_f32_16x16x32_bf16 v[148:151], v[54:57], v[138:141], v[148:151]
    v_mul_f32 v202, s37, v202
    v_mul_f32 v203, s37, v203
    v_mfma_f32_16x16x32_bf16 v[176:179], a[4:7], a[236:239], 0
    v_cvt_pk_bf16_f32 v136, v200, v201
    v_cvt_pk_bf16_f32 v137, v202, v203
    v_mfma_f32_16x16x32_bf16 v[172:175], a[8:11], a[236:239], 0
    ds_read_b128 a[240:243], v224 offset:64
    ds_read_b128 a[244:247], v224 offset:128
    v_mfma_f32_16x16x16_bf16 v[148:151], v[58:59], v[142:143], v[148:151]
    ds_read_b64_tr_b16 a[220:221], v108
    v_mfma_f32_16x16x32_bf16 v[220:223], a[236:239], a[72:75], 0
    ds_read_b64_tr_b16 a[222:223], v108 offset:1536
    v_mfma_f32_16x16x32_bf16 v[216:219], a[236:239], a[76:79], 0
    ds_read_b128 v[152:155], v234
    v_mfma_f32_16x16x32_bf16 v[212:215], a[236:239], a[80:83], 0
    s_waitcnt lgkmcnt(4)
    v_exp_f32 v144, v144
    ds_read_b64_tr_b16 a[224:225], v86 offset:24576
    ds_read_b64_tr_b16 a[226:227], v86 offset:26112
    ds_read_b64_tr_b16 a[228:229], v86 offset:24608
    v_exp_f32 v145, v145
    ds_read_b64_tr_b16 a[230:231], v86 offset:26144
    v_mfma_f32_16x16x32_bf16 v[212:215], a[240:243], a[92:95], v[212:215]
    ds_read_b64_tr_b16 a[232:233], v86 offset:24640
    ds_read_b64_tr_b16 a[234:235], v86 offset:26176
    v_mfma_f32_16x16x32_bf16 v[180:183], a[12:15], a[240:243], v[180:183]
    ds_read_b64_tr_b16 a[236:237], v86 offset:49184
    ds_read_b64_tr_b16 a[238:239], v86 offset:50720
    v_mfma_f32_16x16x32_bf16 v[176:179], a[16:19], a[240:243], v[176:179]
    v_exp_f32 v146, v146
    v_mfma_f32_16x16x32_bf16 v[172:175], a[20:23], a[240:243], v[172:175]
    s_waitcnt lgkmcnt(8)
    v_exp_f32 v147, v147
    v_mfma_f32_16x16x32_bf16 v[152:155], v[30:33], v[132:135], v[152:155]
    v_cvt_pk_bf16_f32 v156, v144, v145
    v_cvt_pk_bf16_f32 v157, v146, v147
    v_mfma_f32_16x16x32_bf16 v[220:223], a[240:243], a[84:87], v[220:223]
    ds_read_b128 v[144:147], v235
    v_bfe_u32 v235, s62, v232, 4
    v_mfma_f32_16x16x32_bf16 v[216:219], a[240:243], a[88:91], v[216:219]
    ds_read_b64_tr_b16 a[240:241], v86 offset:49216
    v_mad_u32_u24 v234, v235, s40, v228
    v_mfma_f32_16x16x16_bf16 v[152:155], v[34:35], v[136:137], v[152:155]
    ds_read_b64_tr_b16 a[242:243], v86 offset:50752
    v_mad_u32_u24 v235, v235, s40, v229
    v_mfma_f32_16x16x32_bf16 v[180:183], a[24:27], a[244:247], v[180:183]
    s_waitcnt lgkmcnt(5)
    ds_write_b128 v87, a[224:227] offset:24576
    v_mfma_f32_16x16x32_bf16 v[180:183], a[36:39], a[248:251], v[180:183]
    ds_write_b128 v87, a[228:231] offset:25600
    v_mfma_f32_16x16x32_bf16 v[176:179], a[28:31], a[244:247], v[176:179]
    ds_write_b128 v87, a[232:235] offset:26624
    v_mfma_f32_16x16x32_bf16 v[176:179], a[40:43], a[248:251], v[176:179]
    s_waitcnt lgkmcnt(5)
    ds_write_b128 v87, v[248:251] offset:49152
    v_mfma_f32_16x16x32_bf16 v[144:147], v[6:9], v[132:135], v[144:147]
    ds_write_b128 v87, a[236:239] offset:50176
    v_mfma_f32_16x16x32_bf16 v[172:175], a[32:35], a[244:247], v[172:175]
    s_waitcnt lgkmcnt(5)
    ds_write_b128 v87, a[240:243] offset:51200
    v_mfma_f32_16x16x32_bf16 v[172:175], a[44:47], a[248:251], v[172:175]
    v_exp_f32 v148, v148
    v_mfma_f32_16x16x32_bf16 v[220:223], a[244:247], a[96:99], v[220:223]
    v_exp_f32 v149, v149
    v_mfma_f32_16x16x32_bf16 v[220:223], a[248:251], a[108:111], v[220:223]
    v_exp_f32 v150, v150
    v_mfma_f32_16x16x16_bf16 v[144:147], v[10:11], v[136:137], v[144:147]
    v_exp_f32 v151, v151
    v_mfma_f32_16x16x32_bf16 v[216:219], a[244:247], a[100:103], v[216:219]
    v_cvt_pk_bf16_f32 v158, v148, v149
    v_cvt_pk_bf16_f32 v159, v150, v151
    v_mfma_f32_16x16x32_bf16 v[216:219], a[248:251], a[112:115], v[216:219]
    v_exp_f32 v152, v152
    v_mfma_f32_16x16x32_bf16 v[196:199], a[216:219], v[156:159], v[196:199]
    v_exp_f32 v153, v153
    v_mfma_f32_16x16x32_bf16 v[184:187], v[82:85], v[156:159], v[184:187]
    v_exp_f32 v154, v154
    v_mfma_f32_16x16x32_bf16 v[188:191], v[104:107], v[156:159], v[188:191]
    v_exp_f32 v155, v155
    v_mfma_f32_16x16x32_bf16 v[192:195], v[126:129], v[156:159], v[192:195]
    v_cvt_pk_bf16_f32 v156, v152, v153
    v_cvt_pk_bf16_f32 v157, v154, v155
    v_mfma_f32_16x16x32_bf16 v[212:215], a[244:247], a[104:107], v[212:215]
    v_rcp_f32 v197, v196
    v_mfma_f32_16x16x32_bf16 v[212:215], a[248:251], a[116:119], v[212:215]
    v_mul_f32 v184, v184, v197
    v_mul_f32 v185, v185, v197
    v_mfma_f32_16x16x32_bf16 v[180:183], a[48:51], a[252:255], v[180:183]
    v_cvt_pk_bf16_f32 v184, v184, v185
    v_mul_f32 v186, v186, v197
    v_mfma_f32_16x16x32_bf16 v[180:183], a[60:63], v[252:255], v[180:183]
    v_mul_f32 v187, v187, v197
    v_cvt_pk_bf16_f32 v185, v186, v187
    v_mfma_f32_16x16x32_bf16 v[176:179], a[52:55], a[252:255], v[176:179]
    ds_read_b128 a[244:247], v224 offset:3072
    ds_read_b128 a[248:251], v224 offset:3136
    v_mfma_f32_16x16x32_bf16 v[176:179], a[64:67], v[252:255], v[176:179]
    ds_read_b128 a[240:243], v225 offset:42944
    v_mul_f32 v188, v188, v197
    v_mfma_f32_16x16x32_bf16 v[172:175], a[56:59], a[252:255], v[172:175]
    v_cvt_pk_bf16_f32 v0, v180, v181
    v_cvt_pk_bf16_f32 v1, v182, v183
    v_mfma_f32_16x16x32_bf16 v[172:175], a[68:71], v[252:255], v[172:175]
    v_mul_f32 v189, v189, v197
    v_cvt_pk_bf16_f32 v186, v188, v189
    v_mfma_f32_16x16x32_bf16 v[220:223], a[252:255], a[120:123], v[220:223]
    v_cvt_pk_bf16_f32 v2, v176, v177
    v_cvt_pk_bf16_f32 v3, v178, v179
    v_mfma_f32_16x16x32_bf16 v[220:223], v[252:255], a[132:135], v[220:223]
    v_mul_f32 v190, v190, v197
    v_mul_f32 v191, v191, v197
    v_mfma_f32_16x16x32_bf16 v[216:219], a[252:255], a[124:127], v[216:219]
    v_cvt_pk_bf16_f32 v4, v172, v173
    v_cvt_pk_bf16_f32 v5, v174, v175
    v_mfma_f32_16x16x32_bf16 v[216:219], v[252:255], a[136:139], v[216:219]
    v_cvt_pk_bf16_f32 v187, v190, v191
    v_mul_f32 v192, v192, v197
    v_mfma_f32_16x16x32_bf16 v[212:215], a[252:255], a[128:131], v[212:215]
    v_cvt_pk_bf16_f32 v66, v220, v221
    v_cvt_pk_bf16_f32 v67, v222, v223
    v_mfma_f32_16x16x32_bf16 v[212:215], v[252:255], a[140:143], v[212:215]
    s_waitcnt lgkmcnt(1)
    ds_read_b128 a[252:255], v224 offset:3200
    ds_read_b128 v[252:255], v224 offset:3264
    v_mfma_f32_16x16x32_bf16 v[208:211], a[0:3], a[244:247], 0
    v_cvt_pk_bf16_f32 v88, v216, v217
    v_cvt_pk_bf16_f32 v89, v218, v219
    v_mfma_f32_16x16x32_bf16 v[208:211], a[12:15], a[248:251], v[208:211]
    v_mul_f32 v193, v193, v197
    v_cvt_pk_bf16_f32 v188, v192, v193
    v_mfma_f32_16x16x32_bf16 v[204:207], a[4:7], a[244:247], 0
    v_cvt_pk_bf16_f32 v110, v212, v213
    v_cvt_pk_bf16_f32 v111, v214, v215
    v_mfma_f32_16x16x32_bf16 v[204:207], a[16:19], a[248:251], v[204:207]
    v_mul_f32 v194, v194, v197
    v_mul_f32 v195, v195, v197
    v_mfma_f32_16x16x32_bf16 v[200:203], a[8:11], a[244:247], 0
    v_cvt_pk_bf16_f32 v189, v194, v195
    v_max3_f32 v236, v236, v196, v197
    v_mfma_f32_16x16x32_bf16 v[200:203], a[20:23], a[248:251], v[200:203]
    ds_write_b128 v237, v[184:187] offset:6144
    v_mfma_f32_16x16x32_bf16 v[180:183], a[244:247], a[72:75], 0
    ds_write_b64 v238, v[188:189] offset:6144
    v_mfma_f32_16x16x32_bf16 v[180:183], a[248:251], a[84:87], v[180:183]
    v_exp_f32 v144, v144
    v_mfma_f32_16x16x32_bf16 v[176:179], a[244:247], a[76:79], 0
    v_exp_f32 v145, v145
    v_mfma_f32_16x16x32_bf16 v[176:179], a[248:251], a[88:91], v[176:179]
    v_exp_f32 v146, v146
    v_mfma_f32_16x16x32_bf16 v[172:175], a[244:247], a[80:83], 0
    ds_read_b128 a[244:247], v225 offset:43008
    ds_read_b64_tr_b16 a[224:225], v108 offset:8
    v_mfma_f32_16x16x32_bf16 v[172:175], a[248:251], a[92:95], v[172:175]
    s_waitcnt lgkmcnt(4)
    ds_read_b128 a[248:251], v225 offset:43072
    v_cvt_pk_bf16_f32 v158, v144, v145
    v_mfma_f32_16x16x32_bf16 v[208:211], a[24:27], a[252:255], v[208:211]
    ds_read_b64_tr_b16 a[226:227], v108 offset:1544
    v_mfma_f32_16x16x32_bf16 v[208:211], a[36:39], v[252:255], v[208:211]
    ds_read_b64_tr_b16 a[228:229], v109
    v_mfma_f32_16x16x32_bf16 v[204:207], a[28:31], a[252:255], v[204:207]
    ds_read_b64_tr_b16 a[230:231], v109 offset:1536
    v_mfma_f32_16x16x32_bf16 v[204:207], a[40:43], v[252:255], v[204:207]
    ds_read_b64_tr_b16 a[232:233], v109 offset:8
    v_mfma_f32_16x16x32_bf16 v[200:203], a[32:35], a[252:255], v[200:203]
    ds_read_b64_tr_b16 a[234:235], v109 offset:1544
    v_mfma_f32_16x16x32_bf16 v[200:203], a[44:47], v[252:255], v[200:203]
    ds_read_b128 v[148:151], v228 offset:1280
    v_mfma_f32_16x16x32_bf16 v[180:183], a[252:255], a[96:99], v[180:183]
    v_exp_f32 v147, v147
    v_mfma_f32_16x16x32_bf16 v[180:183], v[252:255], a[108:111], v[180:183]
    ds_read_b128 v[152:155], v229 offset:1280
    v_cvt_pk_bf16_f32 v159, v146, v147
    v_mfma_f32_16x16x32_bf16 v[176:179], a[252:255], a[100:103], v[176:179]
    ds_read_b128 v[144:147], v229 offset:1920
    v_mfma_f32_16x16x32_bf16 v[176:179], v[252:255], a[112:115], v[176:179]
    v_mfma_f32_16x16x32_bf16 v[196:199], a[216:219], v[156:159], 0
    ds_read_b64_tr_b16 v[248:249], v86 offset:61472
    ds_read_b64_tr_b16 v[250:251], v86 offset:63008
    v_mfma_f32_16x16x32_bf16 v[184:187], v[70:73], v[156:159], 0
    ds_read_b64_tr_b16 a[236:237], v86 offset:61504
    ds_read_b64_tr_b16 a[238:239], v86 offset:63040
    v_mfma_f32_16x16x32_bf16 v[188:191], v[92:95], v[156:159], 0
    ds_write_b128 v87, v[168:171] offset:61440
    v_mfma_f32_16x16x32_bf16 v[192:195], v[114:117], v[156:159], 0
    s_waitcnt lgkmcnt(7)
    v_mfma_f32_16x16x32_bf16 v[148:151], v[12:15], v[132:135], v[148:151]
    s_waitcnt lgkmcnt(6)
    v_mfma_f32_16x16x32_bf16 v[152:155], v[36:39], v[132:135], v[152:155]
    s_waitcnt lgkmcnt(5)
    v_mfma_f32_16x16x32_bf16 v[144:147], v[42:45], v[132:135], v[144:147]
    v_mfma_f32_16x16x32_bf16 v[172:175], a[252:255], a[104:107], v[172:175]
    ds_read_b128 a[252:255], v225 offset:43136
    v_mfma_f32_16x16x32_bf16 v[172:175], v[252:255], a[116:119], v[172:175]
    ds_read_b128 v[252:255], v225 offset:43200
    v_mfma_f32_16x16x16_bf16 v[148:151], v[16:17], v[136:137], v[148:151]
    s_waitcnt lgkmcnt(3)
    ds_write_b128 v87, v[248:251] offset:62464
    v_mfma_f32_16x16x16_bf16 v[152:155], v[40:41], v[136:137], v[152:155]
    ds_write_b128 v87, a[236:239] offset:63488
    v_mfma_f32_16x16x16_bf16 v[144:147], v[46:47], v[136:137], v[144:147]
    v_mfma_f32_16x16x32_bf16 v[208:211], a[48:51], v[160:163], v[208:211]
    v_mfma_f32_16x16x32_bf16 v[208:211], a[60:63], v[164:167], v[208:211]
    v_mfma_f32_16x16x32_bf16 v[204:207], a[52:55], v[160:163], v[204:207]
    v_mfma_f32_16x16x32_bf16 v[204:207], a[64:67], v[164:167], v[204:207]
    v_exp_f32 v148, v148
    v_mfma_f32_16x16x32_bf16 v[200:203], a[56:59], v[160:163], v[200:203]
    v_exp_f32 v149, v149
    v_mfma_f32_16x16x32_bf16 v[200:203], a[68:71], v[164:167], v[200:203]
    v_exp_f32 v150, v150
    v_mfma_f32_16x16x32_bf16 v[180:183], v[160:163], a[120:123], v[180:183]
    v_cvt_pk_bf16_f32 v24, v208, v209
    v_cvt_pk_bf16_f32 v25, v210, v211
    v_mfma_f32_16x16x32_bf16 v[180:183], v[164:167], a[132:135], v[180:183]
    v_cvt_pk_bf16_f32 v26, v204, v205
    v_cvt_pk_bf16_f32 v27, v206, v207
    v_mfma_f32_16x16x32_bf16 v[176:179], v[160:163], a[124:127], v[176:179]
    v_cvt_pk_bf16_f32 v28, v200, v201
    v_cvt_pk_bf16_f32 v29, v202, v203
    v_mfma_f32_16x16x32_bf16 v[176:179], v[164:167], a[136:139], v[176:179]
    v_exp_f32 v151, v151
    v_mfma_f32_16x16x32_bf16 v[172:175], v[160:163], a[128:131], v[172:175]
    v_cvt_pk_bf16_f32 v68, v180, v181
    v_cvt_pk_bf16_f32 v69, v182, v183
    v_mfma_f32_16x16x32_bf16 v[172:175], v[164:167], a[140:143], v[172:175]
    ds_read_b128 v[160:163], v225 offset:43264
    v_cvt_pk_bf16_f32 v156, v148, v149
    v_mfma_f32_16x16x32_bf16 v[220:223], a[144:147], a[240:243], 0
    v_cvt_pk_bf16_f32 v90, v176, v177
    v_cvt_pk_bf16_f32 v91, v178, v179
    v_mfma_f32_16x16x32_bf16 v[220:223], a[156:159], a[244:247], v[220:223]
    v_cvt_pk_bf16_f32 v157, v150, v151
    v_mfma_f32_16x16x32_bf16 v[216:219], a[148:151], a[240:243], 0
    v_cvt_pk_bf16_f32 v112, v172, v173
    v_cvt_pk_bf16_f32 v113, v174, v175
    v_mfma_f32_16x16x32_bf16 v[216:219], a[160:163], a[244:247], v[216:219]
    ds_read_b128 v[148:151], v228 offset:1920
    v_mfma_f32_16x16x32_bf16 v[212:215], a[152:155], a[240:243], 0
    v_exp_f32 v152, v152
    v_mfma_f32_16x16x32_bf16 v[212:215], a[164:167], a[244:247], v[212:215]
    s_waitcnt lgkmcnt(1)
    v_exp_f32 v153, v153
    v_mfma_f32_16x16x32_bf16 v[220:223], a[168:171], a[248:251], v[220:223]
    s_barrier
    ds_read_b128 v[164:167], v227 offset:6144
    ds_read_b128 v[168:171], v227 offset:6208
    v_mfma_f32_16x16x32_bf16 v[220:223], a[180:183], a[252:255], v[220:223]
    ds_read_b128 v[248:251], v227 offset:6272
    v_cvt_pk_bf16_f32 v158, v152, v153
    v_mfma_f32_16x16x32_bf16 v[216:219], a[172:175], a[248:251], v[216:219]
    ds_read_b128 a[236:239], v227 offset:6336
    v_mfma_f32_16x16x32_bf16 v[216:219], a[184:187], a[252:255], v[216:219]
    ds_read_b128 a[240:243], v227 offset:6400
    v_mfma_f32_16x16x32_bf16 v[212:215], a[176:179], a[248:251], v[212:215]
    ds_read_b128 a[244:247], v227 offset:6464
    v_mfma_f32_16x16x32_bf16 v[212:215], a[188:191], a[252:255], v[212:215]
    s_waitcnt lgkmcnt(6)
    buffer_load_dwordx4 v246, s[4:7], s56 offen lds
    v_mfma_f32_16x16x32_bf16 v[148:151], v[18:21], v[132:135], v[148:151]
    ds_read_b128 a[248:251], v239
    ds_read_b128 a[252:255], v240
    v_mfma_f32_16x16x32_bf16 v[220:223], a[192:195], v[252:255], v[220:223]
    v_exp_f32 v154, v154
    v_mfma_f32_16x16x32_bf16 v[220:223], a[204:207], v[160:163], v[220:223]
    v_exp_f32 v155, v155
    v_mfma_f32_16x16x16_bf16 v[148:151], v[22:23], v[136:137], v[148:151]
    v_cvt_pk_bf16_f32 v159, v154, v155
    v_mfma_f32_16x16x32_bf16 v[216:219], a[196:199], v[252:255], v[216:219]
    ds_read_b128 v[152:155], v234
    v_bfe_u32 v234, s65, v232, 4
    v_mfma_f32_16x16x32_bf16 v[216:219], a[208:211], v[160:163], v[216:219]
    v_mad_u32_u24 v234, v234, s40, v230
    v_mul_f32 v220, s37, v220
    v_mfma_f32_16x16x32_bf16 v[196:199], a[216:219], v[156:159], v[196:199]
    v_mul_f32 v221, s37, v221
    v_mul_f32 v222, s37, v222
    v_mfma_f32_16x16x32_bf16 v[184:187], v[74:77], v[156:159], v[184:187]
    v_mul_f32 v223, s37, v223
    v_cvt_pk_bf16_f32 v138, v220, v221
    v_mfma_f32_16x16x32_bf16 v[188:191], v[96:99], v[156:159], v[188:191]
    v_cvt_pk_bf16_f32 v139, v222, v223
    v_mul_f32 v216, s37, v216
    v_mfma_f32_16x16x32_bf16 v[192:195], v[118:121], v[156:159], v[192:195]
    v_mul_f32 v217, s37, v217
    v_mul_f32 v218, s37, v218
    v_mfma_f32_16x16x32_bf16 v[212:215], a[200:203], v[252:255], v[212:215]
    v_mul_f32 v219, s37, v219
    v_cvt_pk_bf16_f32 v140, v216, v217
    v_mfma_f32_16x16x32_bf16 v[212:215], a[212:215], v[160:163], v[212:215]
    s_waitcnt lgkmcnt(0)
    ds_read_b128 v[252:255], v241 offset:12288
    v_cvt_pk_bf16_f32 v141, v218, v219
    v_mfma_f32_16x16x32_bf16 v[152:155], v[0:3], v[132:135], v[152:155]
    buffer_load_dwordx4 v247, s[4:7], s56 offen offset:1024 lds
    v_mfma_f32_16x16x32_bf16 v[220:223], a[0:3], v[164:167], 0
    s_add_u32 s56, s56, s42
    ds_read_b128 v[160:163], v241 offset:12800
    s_add_u32 m0, s41, 0x9740
    v_mfma_f32_16x16x32_bf16 v[220:223], a[12:15], v[168:171], v[220:223]
    v_mul_f32 v212, s37, v212
    v_mul_f32 v213, s37, v213
    v_mfma_f32_16x16x16_bf16 v[152:155], v[4:5], v[136:137], v[152:155]
    v_mul_f32 v214, s37, v214
    v_mul_f32 v215, s37, v215
    v_mfma_f32_16x16x32_bf16 v[216:219], a[4:7], v[164:167], 0
    v_cvt_pk_bf16_f32 v142, v212, v213
    v_cvt_pk_bf16_f32 v143, v214, v215
    v_mfma_f32_16x16x32_bf16 v[216:219], a[16:19], v[168:171], v[216:219]
    v_exp_f32 v144, v144
    v_mfma_f32_16x16x32_bf16 v[212:215], a[8:11], v[164:167], 0
    v_exp_f32 v145, v145
    v_mfma_f32_16x16x32_bf16 v[212:215], a[20:23], v[168:171], v[212:215]
    v_exp_f32 v146, v146
    v_mfma_f32_16x16x32_bf16 v[220:223], a[24:27], v[248:251], v[220:223]
    buffer_load_dwordx4 v246, s[4:7], s56 offen lds
    v_mfma_f32_16x16x32_bf16 v[220:223], a[36:39], a[236:239], v[220:223]
    v_exp_f32 v147, v147
    v_mfma_f32_16x16x32_bf16 v[216:219], a[28:31], v[248:251], v[216:219]
    v_cvt_pk_bf16_f32 v156, v144, v145
    v_cvt_pk_bf16_f32 v157, v146, v147
    v_mfma_f32_16x16x32_bf16 v[216:219], a[40:43], a[236:239], v[216:219]
L_pg3:
    s_cbranch_execz L_pg7
    ds_read_b128 v[144:147], v235
    v_bfe_u32 v235, s62, v232, 4
    v_mfma_f32_16x16x32_bf16 v[212:215], a[32:35], v[248:251], v[212:215]
    v_or_b32 v232, v243, v245
    v_lshrrev_b32 v232, 31, v232
    v_mfma_f32_16x16x32_bf16 v[212:215], a[44:47], a[236:239], v[212:215]
    v_lshl_add_u32 v232, v232, 20, v226
    v_mad_u32_u24 v235, v235, s40, v230
    v_mfma_f32_16x16x32_bf16 v[220:223], a[48:51], a[240:243], v[220:223]
    v_exp_f32 v148, v148
    v_mfma_f32_16x16x32_bf16 v[220:223], a[60:63], a[244:247], v[220:223]
    v_exp_f32 v149, v149
    v_mfma_f32_16x16x32_bf16 v[216:219], a[52:55], a[240:243], v[216:219]
    buffer_load_dwordx4 v247, s[4:7], s56 offen offset:1024 lds
    v_mfma_f32_16x16x32_bf16 v[216:219], a[64:67], a[244:247], v[216:219]
    s_add_u32 s56, s56, s42
    v_exp_f32 v150, v150
    v_mfma_f32_16x16x32_bf16 v[212:215], a[56:59], a[240:243], v[212:215]
    s_add_u32 m0, s41, 0xb580
    v_cvt_pk_bf16_f32 v60, v220, v221
    v_cvt_pk_bf16_f32 v61, v222, v223
    v_mfma_f32_16x16x32_bf16 v[212:215], a[68:71], a[244:247], v[212:215]
    s_waitcnt lgkmcnt(0)
    v_exp_f32 v151, v151
    v_mfma_f32_16x16x32_bf16 v[144:147], v[24:27], v[132:135], v[144:147]
    v_cvt_pk_bf16_f32 v62, v216, v217
    v_cvt_pk_bf16_f32 v63, v218, v219
    v_mfma_f32_16x16x32_bf16 v[208:211], a[220:223], a[248:251], 0
    v_cvt_pk_bf16_f32 v158, v148, v149
    v_cvt_pk_bf16_f32 v159, v150, v151
    v_mfma_f32_16x16x32_bf16 v[200:203], a[220:223], a[252:255], 0
    v_cvt_pk_bf16_f32 v64, v212, v213
    v_cvt_pk_bf16_f32 v65, v214, v215
    v_mfma_f32_16x16x32_bf16 v[196:199], a[216:219], v[156:159], v[196:199]
    ds_read_b128 v[148:151], v235
    v_bfe_u32 v235, s66, v233, 4
    v_mfma_f32_16x16x32_bf16 v[184:187], v[78:81], v[156:159], v[184:187]
    v_mad_u32_u24 v235, v235, s40, v231
    v_mfma_f32_16x16x32_bf16 v[188:191], v[100:103], v[156:159], v[188:191]
    v_exp_f32 v152, v152
    v_mfma_f32_16x16x32_bf16 v[192:195], v[122:125], v[156:159], v[192:195]
    v_exp_f32 v153, v153
    v_mfma_f32_16x16x16_bf16 v[144:147], v[28:29], v[136:137], v[144:147]
    v_exp_f32 v154, v154
    v_mfma_f32_16x16x32_bf16 v[204:207], a[224:227], a[248:251], 0
    v_exp_f32 v155, v155
    v_mfma_f32_16x16x32_bf16 v[180:183], a[224:227], a[252:255], 0
    ds_read_b128 a[252:255], v240 offset:1024
    v_cvt_pk_bf16_f32 v156, v152, v153
    v_mfma_f32_16x16x32_bf16 v[176:179], a[228:231], a[248:251], 0
    s_waitcnt lgkmcnt(1)
    v_cvt_pk_bf16_f32 v157, v154, v155
    v_mfma_f32_16x16x32_bf16 v[148:151], v[24:27], v[138:141], v[148:151]
    ds_read_b128 v[152:155], v234
    v_bfe_u32 v234, s67, v233, 4
    v_mfma_f32_16x16x32_bf16 v[172:175], a[232:235], a[248:251], 0
    ds_read_b128 a[248:251], v239 offset:1024
    v_mad_u32_u24 v234, v234, s40, v231
    v_mfma_f32_16x16x32_bf16 v[220:223], v[164:167], a[72:75], 0
    v_exp_f32 v144, v144
    v_mfma_f32_16x16x32_bf16 v[220:223], v[168:171], a[84:87], v[220:223]
    v_exp_f32 v145, v145
    v_mfma_f32_16x16x16_bf16 v[148:151], v[28:29], v[142:143], v[148:151]
    v_exp_f32 v146, v146
    v_mfma_f32_16x16x32_bf16 v[216:219], v[164:167], a[76:79], 0
    v_exp_f32 v147, v147
    v_mfma_f32_16x16x32_bf16 v[216:219], v[168:171], a[88:91], v[216:219]
    v_cvt_pk_bf16_f32 v158, v144, v145
    v_cvt_pk_bf16_f32 v159, v146, v147
    v_mfma_f32_16x16x32_bf16 v[212:215], v[164:167], a[80:83], 0
    ds_read_b128 v[164:167], v226 offset:1152
    ds_read_b128 v[144:147], v230 offset:1280
    v_mfma_f32_16x16x32_bf16 v[212:215], v[168:171], a[92:95], v[212:215]
    v_exp_f32 v148, v148
    v_mfma_f32_16x16x32_bf16 v[196:199], a[216:219], v[156:159], v[196:199]
    ds_read_b128 v[168:171], v226 offset:1216
    v_mfma_f32_16x16x32_bf16 v[184:187], v[66:69], v[156:159], v[184:187]
    v_exp_f32 v149, v149
    v_mfma_f32_16x16x32_bf16 v[188:191], v[88:91], v[156:159], v[188:191]
    v_exp_f32 v150, v150
    v_mfma_f32_16x16x32_bf16 v[192:195], v[110:113], v[156:159], v[192:195]
    s_waitcnt lgkmcnt(3)
    v_exp_f32 v151, v151
    v_mfma_f32_16x16x32_bf16 v[152:155], v[30:33], v[138:141], v[152:155]
    v_rcp_f32 v197, v196
    v_mfma_f32_16x16x32_bf16 v[220:223], v[248:251], a[96:99], v[220:223]
    v_mul_f32 v184, v184, v197
    v_mul_f32 v185, v185, v197
    v_mfma_f32_16x16x32_bf16 v[220:223], a[236:239], a[108:111], v[220:223]
    v_cvt_pk_bf16_f32 v184, v184, v185
    v_mul_f32 v186, v186, v197
    v_mfma_f32_16x16x16_bf16 v[152:155], v[34:35], v[142:143], v[152:155]
    s_waitcnt lgkmcnt(1)
    v_mul_f32 v187, v187, v197
    v_cvt_pk_bf16_f32 v185, v186, v187
    v_mfma_f32_16x16x32_bf16 v[144:147], v[36:39], v[138:141], v[144:147]
    v_mul_f32 v188, v188, v197
    v_mul_f32 v189, v189, v197
    v_mfma_f32_16x16x32_bf16 v[216:219], v[248:251], a[100:103], v[216:219]
    v_cvt_pk_bf16_f32 v186, v188, v189
    v_mul_f32 v190, v190, v197
    v_mfma_f32_16x16x32_bf16 v[216:219], a[236:239], a[112:115], v[216:219]
    v_mul_f32 v191, v191, v197
    v_cvt_pk_bf16_f32 v187, v190, v191
    v_mfma_f32_16x16x16_bf16 v[144:147], v[40:41], v[142:143], v[144:147]
    v_mul_f32 v192, v192, v197
    v_mul_f32 v193, v193, v197
    v_mfma_f32_16x16x32_bf16 v[212:215], v[248:251], a[104:107], v[212:215]
    ds_read_b128 v[248:251], v226 offset:1280
    v_cvt_pk_bf16_f32 v188, v192, v193
    v_mfma_f32_16x16x32_bf16 v[212:215], a[236:239], a[116:119], v[212:215]
    ds_read_b128 a[236:239], v226 offset:1344
    v_mul_f32 v194, v194, v197
    v_mfma_f32_16x16x32_bf16 v[220:223], a[240:243], a[120:123], v[220:223]
    v_mul_f32 v195, v195, v197
    v_cvt_pk_bf16_f32 v189, v194, v195
    v_mfma_f32_16x16x32_bf16 v[220:223], a[244:247], a[132:135], v[220:223]
    v_max3_f32 v236, v236, v196, v197
    v_cvt_pk_bf16_f32 v156, v148, v149
    v_mfma_f32_16x16x32_bf16 v[216:219], a[240:243], a[124:127], v[216:219]
    ds_write_b128 v237, v[184:187] offset:12288
    v_mfma_f32_16x16x32_bf16 v[216:219], a[244:247], a[136:139], v[216:219]
    ds_write_b64 v238, v[188:189] offset:12288
    v_mfma_f32_16x16x32_bf16 v[212:215], a[240:243], a[128:131], v[212:215]
    v_cvt_pk_bf16_f32 v157, v150, v151
    v_cvt_pk_bf16_f32 v86, v220, v221
    v_mfma_f32_16x16x32_bf16 v[212:215], a[244:247], a[140:143], v[212:215]
    v_cvt_pk_bf16_f32 v87, v222, v223
    v_mfma_f32_16x16x32_bf16 v[220:223], a[144:147], v[164:167], 0
    s_waitcnt lgkmcnt(2)
    v_exp_f32 v152, v152
    v_mfma_f32_16x16x32_bf16 v[220:223], a[156:159], v[168:171], v[220:223]
    v_cvt_pk_bf16_f32 v108, v216, v217
    v_cvt_pk_bf16_f32 v109, v218, v219
    v_mfma_f32_16x16x32_bf16 v[216:219], a[148:151], v[164:167], 0
    ds_read_b128 a[240:243], v226 offset:1408
    v_cvt_pk_bf16_f32 v130, v212, v213
    v_mfma_f32_16x16x32_bf16 v[216:219], a[160:163], v[168:171], v[216:219]
    ds_read_b128 a[244:247], v226 offset:1472
    v_cvt_pk_bf16_f32 v131, v214, v215
    v_mfma_f32_16x16x32_bf16 v[212:215], a[152:155], v[164:167], 0
    ds_read_b128 v[164:167], v224 offset:15488
    ds_read_b128 v[148:151], v230 offset:1920
    v_mfma_f32_16x16x32_bf16 v[212:215], a[164:167], v[168:171], v[212:215]
    v_exp_f32 v153, v153
    v_mfma_f32_16x16x32_bf16 v[220:223], a[168:171], v[248:251], v[220:223]
    ds_read_b128 v[168:171], v224 offset:15552
    v_cvt_pk_bf16_f32 v158, v152, v153
    v_mfma_f32_16x16x32_bf16 v[220:223], a[180:183], a[236:239], v[220:223]
    v_exp_f32 v154, v154
    v_mfma_f32_16x16x32_bf16 v[216:219], a[172:175], v[248:251], v[216:219]
    v_exp_f32 v155, v155
    v_mfma_f32_16x16x32_bf16 v[216:219], a[184:187], a[236:239], v[216:219]
    v_cvt_pk_bf16_f32 v159, v154, v155
    v_mfma_f32_16x16x32_bf16 v[212:215], a[176:179], v[248:251], v[212:215]
    ds_read_b128 v[248:251], v224 offset:15616
    ds_read_b128 v[152:155], v235
    v_mfma_f32_16x16x32_bf16 v[212:215], a[188:191], a[236:239], v[212:215]
    v_bfe_u32 v235, s68, v233, 4
    v_mad_u32_u24 v235, v235, s40, v231
    v_mfma_f32_16x16x32_bf16 v[196:199], a[216:219], v[156:159], 0
    ds_read_b128 a[236:239], v224 offset:15680
    v_mfma_f32_16x16x32_bf16 v[184:187], v[68:71], v[156:159], 0
    v_exp_f32 v144, v144
    v_mfma_f32_16x16x32_bf16 v[188:191], v[90:93], v[156:159], 0
    v_exp_f32 v145, v145
    v_mfma_f32_16x16x32_bf16 v[192:195], v[112:115], v[156:159], 0
    s_waitcnt lgkmcnt(3)
    v_exp_f32 v146, v146
    v_mfma_f32_16x16x32_bf16 v[148:151], v[42:45], v[138:141], v[148:151]
    v_exp_f32 v147, v147
    v_mfma_f32_16x16x32_bf16 v[220:223], a[192:195], a[240:243], v[220:223]
    v_cvt_pk_bf16_f32 v156, v144, v145
    v_cvt_pk_bf16_f32 v157, v146, v147
    v_mfma_f32_16x16x32_bf16 v[220:223], a[204:207], a[244:247], v[220:223]
    ds_read_b128 v[144:147], v234
    v_bfe_u32 v234, s69, v233, 4
    v_mfma_f32_16x16x16_bf16 v[148:151], v[46:47], v[142:143], v[148:151]
    s_waitcnt lgkmcnt(2)
    v_mad_u32_u24 v234, v234, s40, v231
    v_mfma_f32_16x16x32_bf16 v[152:155], v[48:51], v[138:141], v[152:155]
    v_mfma_f32_16x16x32_bf16 v[216:219], a[196:199], a[240:243], v[216:219]
    v_mfma_f32_16x16x32_bf16 v[216:219], a[208:211], a[244:247], v[216:219]
    v_mfma_f32_16x16x32_bf16 v[212:215], a[200:203], a[240:243], v[212:215]
    v_mul_f32 v220, s37, v220
    v_mul_f32 v221, s37, v221
    v_mfma_f32_16x16x32_bf16 v[212:215], a[212:215], a[244:247], v[212:215]
    v_mul_f32 v222, s37, v222
    v_mul_f32 v223, s37, v223
    v_mfma_f32_16x16x16_bf16 v[152:155], v[52:53], v[142:143], v[152:155]
    s_waitcnt lgkmcnt(0)
    v_cvt_pk_bf16_f32 v132, v220, v221
    v_cvt_pk_bf16_f32 v133, v222, v223
    v_mfma_f32_16x16x32_bf16 v[144:147], v[54:57], v[138:141], v[144:147]
    v_mul_f32 v216, s37, v216
    v_mul_f32 v217, s37, v217
    v_mfma_f32_16x16x32_bf16 v[208:211], v[252:255], a[248:251], v[208:211]
    v_mul_f32 v218, s37, v218
    v_mul_f32 v219, s37, v219
    v_mfma_f32_16x16x32_bf16 v[200:203], v[252:255], a[252:255], v[200:203]
    v_cvt_pk_bf16_f32 v134, v216, v217
    v_cvt_pk_bf16_f32 v135, v218, v219
    v_mfma_f32_16x16x16_bf16 v[144:147], v[58:59], v[142:143], v[144:147]
    v_mul_f32 v212, s37, v212
    v_mul_f32 v213, s37, v213
    v_mfma_f32_16x16x32_bf16 v[204:207], v[160:163], a[248:251], v[204:207]
    v_mul_f32 v214, s37, v214
    v_mul_f32 v215, s37, v215
    v_mfma_f32_16x16x32_bf16 v[180:183], v[160:163], a[252:255], v[180:183]
    v_cvt_pk_bf16_f32 v136, v212, v213
    v_cvt_pk_bf16_f32 v137, v214, v215
    v_mfma_f32_16x16x32_bf16 v[220:223], a[0:3], v[164:167], 0
    ds_read_b128 a[240:243], v224 offset:15744
    ds_read_b128 a[244:247], v224 offset:15808
    v_mfma_f32_16x16x32_bf16 v[220:223], a[12:15], v[168:171], v[220:223]
    ds_read_b128 v[252:255], v242 offset:12288
    v_mfma_f32_16x16x32_bf16 v[216:219], a[4:7], v[164:167], 0
    ds_read_b128 v[160:163], v242 offset:12800
    v_mfma_f32_16x16x32_bf16 v[216:219], a[16:19], v[168:171], v[216:219]
    ds_read_b128 a[252:255], v240 offset:2048
    v_mfma_f32_16x16x32_bf16 v[212:215], a[8:11], v[164:167], 0
    v_exp_f32 v148, v148
    v_mfma_f32_16x16x32_bf16 v[212:215], a[20:23], v[168:171], v[212:215]
    v_exp_f32 v149, v149
    v_mfma_f32_16x16x32_bf16 v[220:223], a[24:27], v[248:251], v[220:223]
    v_exp_f32 v150, v150
    v_mfma_f32_16x16x32_bf16 v[220:223], a[36:39], a[236:239], v[220:223]
    v_exp_f32 v151, v151
    v_mfma_f32_16x16x32_bf16 v[216:219], a[28:31], v[248:251], v[216:219]
    v_cvt_pk_bf16_f32 v158, v148, v149
    v_cvt_pk_bf16_f32 v159, v150, v151
    v_mfma_f32_16x16x32_bf16 v[216:219], a[40:43], a[236:239], v[216:219]
    ds_read_b128 v[148:151], v235
    v_bfe_u32 v235, s70, v233, 4
    v_mfma_f32_16x16x32_bf16 v[196:199], a[216:219], v[156:159], v[196:199]
    v_mad_u32_u24 v235, v235, s40, v231
    v_mfma_f32_16x16x32_bf16 v[184:187], v[76:79], v[156:159], v[184:187]
    v_exp_f32 v152, v152
    v_mfma_f32_16x16x32_bf16 v[188:191], v[98:101], v[156:159], v[188:191]
    v_exp_f32 v153, v153
    v_mfma_f32_16x16x32_bf16 v[192:195], v[120:123], v[156:159], v[192:195]
    s_waitcnt lgkmcnt(1)
    v_exp_f32 v154, v154
    v_mfma_f32_16x16x32_bf16 v[176:179], v[252:255], a[248:251], v[176:179]
    ds_read_b128 v[252:255], v241 offset:24576
    v_cvt_pk_bf16_f32 v156, v152, v153
    v_mfma_f32_16x16x32_bf16 v[172:175], v[160:163], a[248:251], v[172:175]
    ds_read_b128 a[248:251], v239 offset:2048
    ds_read_b128 v[160:163], v241 offset:25088
    v_mfma_f32_16x16x32_bf16 v[212:215], a[32:35], v[248:251], v[212:215]
    v_exp_f32 v155, v155
    v_mfma_f32_16x16x32_bf16 v[212:215], a[44:47], a[236:239], v[212:215]
    s_waitcnt lgkmcnt(3)
    v_cvt_pk_bf16_f32 v157, v154, v155
    v_mfma_f32_16x16x32_bf16 v[148:151], v[60:63], v[138:141], v[148:151]
    ds_read_b128 v[152:155], v228 offset:640
    v_mfma_f32_16x16x32_bf16 v[220:223], a[48:51], a[240:243], v[220:223]
    v_exp_f32 v144, v144
    v_mfma_f32_16x16x32_bf16 v[220:223], a[60:63], a[244:247], v[220:223]
    v_exp_f32 v145, v145
    v_mfma_f32_16x16x32_bf16 v[216:219], a[52:55], a[240:243], v[216:219]
    v_exp_f32 v146, v146
    v_mfma_f32_16x16x32_bf16 v[216:219], a[64:67], a[244:247], v[216:219]
    v_exp_f32 v147, v147
    v_mfma_f32_16x16x16_bf16 v[148:151], v[64:65], v[142:143], v[148:151]
    v_cvt_pk_bf16_f32 v158, v144, v145
    v_cvt_pk_bf16_f32 v159, v146, v147
    v_mfma_f32_16x16x32_bf16 v[212:215], a[56:59], a[240:243], v[212:215]
    v_cvt_pk_bf16_f32 v6, v220, v221
    v_cvt_pk_bf16_f32 v7, v222, v223
    v_mfma_f32_16x16x32_bf16 v[212:215], a[68:71], a[244:247], v[212:215]
    v_cvt_pk_bf16_f32 v8, v216, v217
    v_cvt_pk_bf16_f32 v9, v218, v219
    v_mfma_f32_16x16x32_bf16 v[196:199], a[216:219], v[156:159], v[196:199]
    ds_read_b128 v[144:147], v229 offset:640
    v_mfma_f32_16x16x32_bf16 v[184:187], v[82:85], v[156:159], v[184:187]
    v_exp_f32 v148, v148
    v_mfma_f32_16x16x32_bf16 v[188:191], v[104:107], v[156:159], v[188:191]
    v_exp_f32 v149, v149
    v_mfma_f32_16x16x32_bf16 v[192:195], v[126:129], v[156:159], v[192:195]
    s_waitcnt lgkmcnt(1)
    v_cvt_pk_bf16_f32 v10, v212, v213
    v_cvt_pk_bf16_f32 v11, v214, v215
    v_mfma_f32_16x16x32_bf16 v[152:155], v[12:15], v[132:135], v[152:155]
    v_exp_f32 v150, v150
    v_mfma_f32_16x16x32_bf16 v[208:211], v[252:255], a[248:251], v[208:211]
    v_exp_f32 v151, v151
    v_mfma_f32_16x16x32_bf16 v[200:203], v[252:255], a[252:255], v[200:203]
    ds_read_b128 v[252:255], v242 offset:24576
    v_cvt_pk_bf16_f32 v156, v148, v149
    v_mfma_f32_16x16x16_bf16 v[152:155], v[16:17], v[136:137], v[152:155]
    s_waitcnt lgkmcnt(1)
    v_cvt_pk_bf16_f32 v157, v150, v151
    v_mfma_f32_16x16x32_bf16 v[144:147], v[36:39], v[132:135], v[144:147]
    ds_read_b128 v[148:151], v229 offset:1280
    v_mfma_f32_16x16x16_bf16 v[196:199], a[216:217], v[156:157], v[196:199]
    v_mfma_f32_16x16x16_bf16 v[184:187], v[86:87], v[156:157], v[184:187]
    v_mfma_f32_16x16x16_bf16 v[188:191], v[108:109], v[156:157], v[188:191]
    v_mfma_f32_16x16x16_bf16 v[192:195], v[130:131], v[156:157], v[192:195]
    v_mfma_f32_16x16x32_bf16 v[204:207], v[160:163], a[248:251], v[204:207]
    v_exp_f32 v152, v152
    v_mfma_f32_16x16x16_bf16 v[144:147], v[40:41], v[136:137], v[144:147]
    v_exp_f32 v153, v153
    v_mfma_f32_16x16x32_bf16 v[180:183], v[160:163], a[252:255], v[180:183]
    s_waitcnt lgkmcnt(0)
    v_rcp_f32 v197, v196
    v_mfma_f32_16x16x32_bf16 v[148:151], v[42:45], v[132:135], v[148:151]
    v_mul_f32 v184, v184, v197
    v_mul_f32 v185, v185, v197
    v_mfma_f32_16x16x32_bf16 v[176:179], v[252:255], a[248:251], v[176:179]
    v_cvt_pk_bf16_f32 v184, v184, v185
    v_mul_f32 v186, v186, v197
    v_mfma_f32_16x16x32_bf16 v[220:223], v[164:167], a[72:75], 0
    v_mul_f32 v187, v187, v197
    v_cvt_pk_bf16_f32 v185, v186, v187
    v_mfma_f32_16x16x32_bf16 v[220:223], v[168:171], a[84:87], v[220:223]
    v_mul_f32 v188, v188, v197
    v_mul_f32 v189, v189, v197
    v_mfma_f32_16x16x16_bf16 v[148:151], v[46:47], v[136:137], v[148:151]
    v_cvt_pk_bf16_f32 v186, v188, v189
    v_mul_f32 v190, v190, v197
    v_mfma_f32_16x16x32_bf16 v[216:219], v[164:167], a[76:79], 0
    v_mul_f32 v191, v191, v197
    v_cvt_pk_bf16_f32 v187, v190, v191
    v_mfma_f32_16x16x32_bf16 v[216:219], v[168:171], a[88:91], v[216:219]
    v_mul_f32 v192, v192, v197
    v_mul_f32 v193, v193, v197
    v_mfma_f32_16x16x32_bf16 v[212:215], v[164:167], a[80:83], 0
    ds_read_b128 v[164:167], v224 offset:18560
    v_cvt_pk_bf16_f32 v188, v192, v193
    v_mfma_f32_16x16x32_bf16 v[212:215], v[168:171], a[92:95], v[212:215]
    ds_read_b128 v[168:171], v224 offset:18624
    v_mul_f32 v194, v194, v197
    v_mfma_f32_16x16x32_bf16 v[220:223], v[248:251], a[96:99], v[220:223]
    v_mul_f32 v195, v195, v197
    v_cvt_pk_bf16_f32 v189, v194, v195
    v_mfma_f32_16x16x32_bf16 v[220:223], a[236:239], a[108:111], v[220:223]
    ds_read_b128 v[160:163], v242 offset:25088
    v_max3_f32 v236, v236, v196, v197
    v_mfma_f32_16x16x32_bf16 v[216:219], v[248:251], a[100:103], v[216:219]
    ds_write_b128 v237, v[184:187] offset:18432
    v_mfma_f32_16x16x32_bf16 v[216:219], a[236:239], a[112:115], v[216:219]
    ds_write_b64 v238, v[188:189] offset:18432
    v_mfma_f32_16x16x32_bf16 v[212:215], v[248:251], a[104:107], v[212:215]
    v_exp_f32 v154, v154
    v_mfma_f32_16x16x32_bf16 v[212:215], a[236:239], a[116:119], v[212:215]
    v_exp_f32 v155, v155
    v_mfma_f32_16x16x32_bf16 v[220:223], a[240:243], a[120:123], v[220:223]
    v_cvt_pk_bf16_f32 v156, v152, v153
    v_cvt_pk_bf16_f32 v157, v154, v155
    v_mfma_f32_16x16x32_bf16 v[220:223], a[244:247], a[132:135], v[220:223]
    s_waitcnt lgkmcnt(2)
    ds_read_b128 v[248:251], v224 offset:18688
    ds_read_b128 a[236:239], v224 offset:18752
    v_mfma_f32_16x16x32_bf16 v[172:175], v[160:163], a[248:251], v[172:175]
    ds_read_b128 a[248:251], v239 offset:3072
    v_mfma_f32_16x16x32_bf16 v[216:219], a[240:243], a[124:127], v[216:219]
    ds_read_b128 a[252:255], v240 offset:3072
    v_mfma_f32_16x16x32_bf16 v[216:219], a[244:247], a[136:139], v[216:219]
    ds_read_b128 v[252:255], v241 offset:36864
    v_cvt_pk_bf16_f32 v72, v220, v221
    v_mfma_f32_16x16x32_bf16 v[212:215], a[240:243], a[128:131], v[212:215]
    ds_read_b128 a[240:243], v224 offset:18816
    v_cvt_pk_bf16_f32 v73, v222, v223
    v_mfma_f32_16x16x32_bf16 v[212:215], a[244:247], a[140:143], v[212:215]
    ds_read_b128 a[244:247], v224 offset:18880
    v_mfma_f32_16x16x32_bf16 v[220:223], a[0:3], v[164:167], 0
    v_cvt_pk_bf16_f32 v94, v216, v217
    v_cvt_pk_bf16_f32 v95, v218, v219
    v_mfma_f32_16x16x32_bf16 v[220:223], a[12:15], v[168:171], v[220:223]
    ds_read_b128 v[160:163], v241 offset:37376
    ds_read_b128 v[152:155], v228 offset:1280
    v_mfma_f32_16x16x32_bf16 v[216:219], a[4:7], v[164:167], 0
    v_cvt_pk_bf16_f32 v116, v212, v213
    v_cvt_pk_bf16_f32 v117, v214, v215
    v_mfma_f32_16x16x32_bf16 v[216:219], a[16:19], v[168:171], v[216:219]
    v_exp_f32 v144, v144
    v_mfma_f32_16x16x32_bf16 v[212:215], a[8:11], v[164:167], 0
    v_exp_f32 v145, v145
    v_mfma_f32_16x16x32_bf16 v[212:215], a[20:23], v[168:171], v[212:215]
    s_waitcnt lgkmcnt(4)
    v_exp_f32 v146, v146
    v_mfma_f32_16x16x32_bf16 v[208:211], v[252:255], a[248:251], v[208:211]
    v_exp_f32 v147, v147
    v_mfma_f32_16x16x32_bf16 v[200:203], v[252:255], a[252:255], v[200:203]
    s_waitcnt lgkmcnt(1)
    ds_read_b128 v[252:255], v242 offset:36864
    v_cvt_pk_bf16_f32 v158, v144, v145
    v_mfma_f32_16x16x32_bf16 v[204:207], v[160:163], a[248:251], v[204:207]
    v_cvt_pk_bf16_f32 v159, v146, v147
    v_mfma_f32_16x16x32_bf16 v[180:183], v[160:163], a[252:255], v[180:183]
    ds_read_b128 v[160:163], v242 offset:37376
    ds_read_b128 a[252:255], v240 offset:4096
    v_mfma_f32_16x16x32_bf16 v[196:199], a[216:219], v[156:159], 0
    ds_read_b128 v[144:147], v228 offset:1920
    v_mfma_f32_16x16x32_bf16 v[184:187], v[74:77], v[156:159], 0
    v_exp_f32 v148, v148
    v_mfma_f32_16x16x32_bf16 v[188:191], v[96:99], v[156:159], 0
    v_exp_f32 v149, v149
    v_mfma_f32_16x16x32_bf16 v[192:195], v[118:121], v[156:159], 0
    s_waitcnt lgkmcnt(4)
    v_exp_f32 v150, v150
    v_mfma_f32_16x16x32_bf16 v[152:155], v[18:21], v[132:135], v[152:155]
    s_waitcnt lgkmcnt(3)
    v_exp_f32 v151, v151
    v_mfma_f32_16x16x32_bf16 v[176:179], v[252:255], a[248:251], v[176:179]
    s_waitcnt lgkmcnt(2)
    ds_read_b128 v[252:255], v241 offset:49152
    v_cvt_pk_bf16_f32 v156, v148, v149
    v_mfma_f32_16x16x32_bf16 v[172:175], v[160:163], a[248:251], v[172:175]
    ds_read_b128 a[248:251], v239 offset:4096
    ds_read_b128 v[160:163], v241 offset:49664
    v_mfma_f32_16x16x16_bf16 v[152:155], v[22:23], v[136:137], v[152:155]
    v_cvt_pk_bf16_f32 v157, v150, v151
    v_mfma_f32_16x16x32_bf16 v[220:223], a[24:27], v[248:251], v[220:223]
    ds_read_b128 v[148:151], v229 offset:1920
    v_mfma_f32_16x16x32_bf16 v[220:223], a[36:39], a[236:239], v[220:223]
    s_waitcnt lgkmcnt(4)
    v_mfma_f32_16x16x32_bf16 v[144:147], v[0:3], v[132:135], v[144:147]
    v_mfma_f32_16x16x32_bf16 v[216:219], a[28:31], v[248:251], v[216:219]
    v_mfma_f32_16x16x32_bf16 v[216:219], a[40:43], a[236:239], v[216:219]
    v_mfma_f32_16x16x32_bf16 v[212:215], a[32:35], v[248:251], v[212:215]
    v_exp_f32 v152, v152
    v_mfma_f32_16x16x32_bf16 v[212:215], a[44:47], a[236:239], v[212:215]
    v_exp_f32 v153, v153
    v_mfma_f32_16x16x16_bf16 v[144:147], v[4:5], v[136:137], v[144:147]
    s_waitcnt lgkmcnt(0)
    v_exp_f32 v154, v154
    v_mfma_f32_16x16x32_bf16 v[148:151], v[24:27], v[132:135], v[148:151]
    v_exp_f32 v155, v155
    v_mfma_f32_16x16x32_bf16 v[220:223], a[48:51], a[240:243], v[220:223]
    v_cvt_pk_bf16_f32 v158, v152, v153
    v_cvt_pk_bf16_f32 v159, v154, v155
    v_mfma_f32_16x16x32_bf16 v[220:223], a[60:63], a[244:247], v[220:223]
    ds_read_b128 v[152:155], v229 offset:2560
    v_mfma_f32_16x16x32_bf16 v[196:199], a[216:219], v[156:159], v[196:199]
    v_exp_f32 v144, v144
    v_mfma_f32_16x16x32_bf16 v[184:187], v[78:81], v[156:159], v[184:187]
    v_exp_f32 v145, v145
    v_mfma_f32_16x16x32_bf16 v[188:191], v[100:103], v[156:159], v[188:191]
    v_exp_f32 v146, v146
    v_mfma_f32_16x16x32_bf16 v[192:195], v[122:125], v[156:159], v[192:195]
    v_cvt_pk_bf16_f32 v30, v220, v221
    v_cvt_pk_bf16_f32 v31, v222, v223
    v_mfma_f32_16x16x16_bf16 v[148:151], v[28:29], v[136:137], v[148:151]
    v_exp_f32 v147, v147
    v_mfma_f32_16x16x32_bf16 v[216:219], a[52:55], a[240:243], v[216:219]
    v_cvt_pk_bf16_f32 v156, v144, v145
    v_cvt_pk_bf16_f32 v157, v146, v147
    v_mfma_f32_16x16x32_bf16 v[216:219], a[64:67], a[244:247], v[216:219]
    ds_read_b128 v[144:147], v228 offset:2560
    v_mfma_f32_16x16x32_bf16 v[212:215], a[56:59], a[240:243], v[212:215]
    v_mfma_f32_16x16x32_bf16 v[212:215], a[68:71], a[244:247], v[212:215]
    v_exp_f32 v148, v148
    v_mfma_f32_16x16x32_bf16 v[208:211], v[252:255], a[248:251], v[208:211]
    v_exp_f32 v149, v149
    v_mfma_f32_16x16x32_bf16 v[200:203], v[252:255], a[252:255], v[200:203]
    ds_read_b128 v[252:255], v242 offset:49152
    v_cvt_pk_bf16_f32 v32, v216, v217
    v_mfma_f32_16x16x32_bf16 v[204:207], v[160:163], a[248:251], v[204:207]
    v_cvt_pk_bf16_f32 v33, v218, v219
    v_cvt_pk_bf16_f32 v34, v212, v213
    v_mfma_f32_16x16x32_bf16 v[180:183], v[160:163], a[252:255], v[180:183]
    s_waitcnt lgkmcnt(2)
    ds_read_b128 v[160:163], v242 offset:49664
    v_cvt_pk_bf16_f32 v35, v214, v215
    v_mfma_f32_16x16x32_bf16 v[152:155], v[30:33], v[132:135], v[152:155]
    s_waitcnt lgkmcnt(2)
    ds_read_b128 a[252:255], v240 offset:5120
    v_cvt_pk_bf16_f32 v158, v148, v149
    v_mfma_f32_16x16x32_bf16 v[144:147], v[6:9], v[132:135], v[144:147]
    v_exp_f32 v150, v150
    v_mfma_f32_16x16x32_bf16 v[220:223], v[164:167], a[72:75], 0
    v_exp_f32 v151, v151
    v_mfma_f32_16x16x32_bf16 v[220:223], v[168:171], a[84:87], v[220:223]
    v_cvt_pk_bf16_f32 v159, v150, v151
    v_mfma_f32_16x16x16_bf16 v[152:155], v[34:35], v[136:137], v[152:155]
    ds_read_b128 v[148:151], v230 offset:640
    v_mfma_f32_16x16x32_bf16 v[196:199], a[216:219], v[156:159], v[196:199]
    v_mfma_f32_16x16x32_bf16 v[184:187], v[66:69], v[156:159], v[184:187]
    v_mfma_f32_16x16x32_bf16 v[188:191], v[88:91], v[156:159], v[188:191]
    v_mfma_f32_16x16x32_bf16 v[192:195], v[110:113], v[156:159], v[192:195]
    v_mfma_f32_16x16x16_bf16 v[144:147], v[10:11], v[136:137], v[144:147]
    s_waitcnt lgkmcnt(1)
    v_mfma_f32_16x16x32_bf16 v[176:179], v[252:255], a[248:251], v[176:179]
    ds_read_b128 v[252:255], v241 offset:61440
    v_mfma_f32_16x16x32_bf16 v[172:175], v[160:163], a[248:251], v[172:175]
    ds_read_b128 a[248:251], v239 offset:5120
    ds_read_b128 v[160:163], v241 offset:61952
    v_mfma_f32_16x16x32_bf16 v[216:219], v[164:167], a[76:79], 0
    v_exp_f32 v152, v152
    v_mfma_f32_16x16x32_bf16 v[216:219], v[168:171], a[88:91], v[216:219]
    v_exp_f32 v153, v153
    v_mfma_f32_16x16x32_bf16 v[212:215], v[164:167], a[80:83], 0
    ds_read_b128 v[164:167], v232 offset:4224
    v_cvt_pk_bf16_f32 v156, v152, v153
    v_mfma_f32_16x16x32_bf16 v[212:215], v[168:171], a[92:95], v[212:215]
    ds_read_b128 v[168:171], v232 offset:4288
    v_mfma_f32_16x16x32_bf16 v[220:223], v[248:251], a[96:99], v[220:223]
    v_exp_f32 v154, v154
    v_mfma_f32_16x16x32_bf16 v[220:223], a[236:239], a[108:111], v[220:223]
    v_exp_f32 v155, v155
    v_mfma_f32_16x16x32_bf16 v[216:219], v[248:251], a[100:103], v[216:219]
    v_cvt_pk_bf16_f32 v157, v154, v155
    v_mfma_f32_16x16x32_bf16 v[216:219], a[236:239], a[112:115], v[216:219]
    ds_read_b128 v[152:155], v230 offset:1280
    v_mfma_f32_16x16x32_bf16 v[212:215], v[248:251], a[104:107], v[212:215]
    ds_read_b128 v[248:251], v232 offset:4352
    v_mfma_f32_16x16x32_bf16 v[212:215], a[236:239], a[116:119], v[212:215]
    ds_read_b128 a[236:239], v232 offset:4416
    v_mfma_f32_16x16x32_bf16 v[220:223], a[240:243], a[120:123], v[220:223]
    v_exp_f32 v144, v144
    v_mfma_f32_16x16x32_bf16 v[220:223], a[244:247], a[132:135], v[220:223]
    v_exp_f32 v145, v145
    v_mfma_f32_16x16x32_bf16 v[216:219], a[240:243], a[124:127], v[216:219]
    v_exp_f32 v146, v146
    v_mfma_f32_16x16x32_bf16 v[216:219], a[244:247], a[136:139], v[216:219]
    v_exp_f32 v147, v147
    v_mfma_f32_16x16x32_bf16 v[212:215], a[240:243], a[128:131], v[212:215]
    ds_read_b128 a[240:243], v232 offset:4480
    v_cvt_pk_bf16_f32 v158, v144, v145
    v_mfma_f32_16x16x32_bf16 v[212:215], a[244:247], a[140:143], v[212:215]
    s_waitcnt lgkmcnt(4)
    v_cvt_pk_bf16_f32 v70, v220, v221
    v_cvt_pk_bf16_f32 v71, v222, v223
    v_mfma_f32_16x16x32_bf16 v[208:211], v[252:255], a[248:251], v[208:211]
    v_cvt_pk_bf16_f32 v92, v216, v217
    v_cvt_pk_bf16_f32 v93, v218, v219
    v_mfma_f32_16x16x32_bf16 v[200:203], v[252:255], a[252:255], v[200:203]
    ds_read_b128 a[244:247], v232 offset:4544
    v_or_b32 v232, v243, v245
    v_mfma_f32_16x16x32_bf16 v[204:207], v[160:163], a[248:251], v[204:207]
    v_cvt_pk_bf16_f32 v114, v212, v213
    v_cvt_pk_bf16_f32 v115, v214, v215
    v_mfma_f32_16x16x32_bf16 v[180:183], v[160:163], a[252:255], v[180:183]
    ds_read_b128 v[252:255], v242 offset:61440
    v_lshrrev_b32 v232, 31, v232
    v_mfma_f32_16x16x32_bf16 v[220:223], a[144:147], v[164:167], 0
    ds_read_b128 v[160:163], v242 offset:61952
    v_lshl_add_u32 v232, v232, 20, v225
    v_mfma_f32_16x16x32_bf16 v[220:223], a[156:159], v[168:171], v[220:223]
    v_cvt_pk_bf16_f32 v208, v208, v209
    v_cvt_pk_bf16_f32 v209, v210, v211
    v_mfma_f32_16x16x32_bf16 v[216:219], a[148:151], v[164:167], 0
    v_cvt_pk_bf16_f32 v210, v204, v205
    v_cvt_pk_bf16_f32 v211, v206, v207
    v_mfma_f32_16x16x32_bf16 v[216:219], a[160:163], v[168:171], v[216:219]
    s_waitcnt vmcnt(0) lgkmcnt(2)
    buffer_store_dwordx4 v[208:211], v243, s[20:23], s51 offen sc0 sc1
    v_mfma_f32_16x16x32_bf16 v[212:215], a[152:155], v[164:167], 0
    s_barrier
    ds_read_b128 v[164:167], v225 offset:8896
    v_cvt_pk_bf16_f32 v200, v200, v201
    v_mfma_f32_16x16x32_bf16 v[212:215], a[164:167], v[168:171], v[212:215]
    s_waitcnt lgkmcnt(2)
    ds_read_b128 v[168:171], v225 offset:8960
    v_cvt_pk_bf16_f32 v201, v202, v203
    v_mfma_f32_16x16x32_bf16 v[176:179], v[252:255], a[248:251], v[176:179]
    s_waitcnt lgkmcnt(2)
    v_cvt_pk_bf16_f32 v202, v180, v181
    v_cvt_pk_bf16_f32 v203, v182, v183
    v_mfma_f32_16x16x32_bf16 v[172:175], v[160:163], a[248:251], v[172:175]
    ds_read_b128 a[248:251], v239 offset:12288
    ds_read_b128 a[252:255], v240 offset:12288
    v_mfma_f32_16x16x32_bf16 v[220:223], a[168:171], v[248:251], v[220:223]
    ds_read_b128 v[252:255], v241 offset:12288
    v_cvt_pk_bf16_f32 v159, v146, v147
    v_mfma_f32_16x16x32_bf16 v[220:223], a[180:183], a[236:239], v[220:223]
    ds_read_b128 v[144:147], v230 offset:1920
    v_cvt_pk_bf16_f32 v176, v176, v177
    v_mfma_f32_16x16x32_bf16 v[196:199], a[216:219], v[156:159], v[196:199]
    v_cvt_pk_bf16_f32 v177, v178, v179
    v_cvt_pk_bf16_f32 v178, v172, v173
    v_mfma_f32_16x16x32_bf16 v[184:187], v[70:73], v[156:159], v[184:187]
    ds_read_b128 v[160:163], v241 offset:12800
    v_cvt_pk_bf16_f32 v179, v174, v175
    v_mfma_f32_16x16x32_bf16 v[188:191], v[92:95], v[156:159], v[188:191]
    v_mfma_f32_16x16x32_bf16 v[192:195], v[114:117], v[156:159], v[192:195]
    v_mfma_f32_16x16x32_bf16 v[216:219], a[172:175], v[248:251], v[216:219]
    v_rcp_f32 v197, v196
    v_mfma_f32_16x16x32_bf16 v[216:219], a[184:187], a[236:239], v[216:219]
    buffer_store_dwordx4 v[200:203], v245, s[20:23], s51 offen sc0 sc1
    v_mfma_f32_16x16x32_bf16 v[212:215], a[176:179], v[248:251], v[212:215]
L_pg4:
    s_cbranch_execz L_pg8
    ds_read_b128 v[248:251], v225 offset:9024
    v_mul_f32 v184, v184, v197
    v_mfma_f32_16x16x32_bf16 v[212:215], a[188:191], a[236:239], v[212:215]
    ds_read_b128 a[236:239], v225 offset:9088
    v_mul_f32 v185, v185, v197
    v_mfma_f32_16x16x32_bf16 v[220:223], a[192:195], a[240:243], v[220:223]
    v_cvt_pk_bf16_f32 v184, v184, v185
    v_mul_f32 v186, v186, v197
    v_mfma_f32_16x16x32_bf16 v[220:223], a[204:207], a[244:247], v[220:223]
    v_mul_f32 v187, v187, v197
    v_cvt_pk_bf16_f32 v185, v186, v187
    v_mfma_f32_16x16x32_bf16 v[216:219], a[196:199], a[240:243], v[216:219]
    v_mul_f32 v188, v188, v197
    v_mul_f32 v189, v189, v197
    v_mfma_f32_16x16x32_bf16 v[216:219], a[208:211], a[244:247], v[216:219]
    v_cvt_pk_bf16_f32 v186, v188, v189
    v_mul_f32 v190, v190, v197
    v_mfma_f32_16x16x32_bf16 v[212:215], a[200:203], a[240:243], v[212:215]
    v_mul_f32 v220, s37, v220
    v_mul_f32 v221, s37, v221
    v_mfma_f32_16x16x32_bf16 v[212:215], a[212:215], a[244:247], v[212:215]
    s_waitcnt lgkmcnt(2)
    v_mul_f32 v222, s37, v222
    v_mul_f32 v223, s37, v223
    v_mfma_f32_16x16x32_bf16 v[208:211], a[220:223], a[248:251], 0
    v_cvt_pk_bf16_f32 v138, v220, v221
    v_cvt_pk_bf16_f32 v139, v222, v223
    v_mfma_f32_16x16x32_bf16 v[220:223], a[144:147], v[164:167], 0
    v_mul_f32 v216, s37, v216
    v_mul_f32 v217, s37, v217
    v_mfma_f32_16x16x32_bf16 v[220:223], a[156:159], v[168:171], v[220:223]
    s_waitcnt lgkmcnt(0)
    v_mul_f32 v218, s37, v218
    v_mul_f32 v219, s37, v219
    v_mfma_f32_16x16x32_bf16 v[220:223], a[168:171], v[248:251], v[220:223]
    v_cvt_pk_bf16_f32 v140, v216, v217
    v_cvt_pk_bf16_f32 v141, v218, v219
    v_mfma_f32_16x16x32_bf16 v[220:223], a[180:183], a[236:239], v[220:223]
    v_mul_f32 v212, s37, v212
    v_mul_f32 v213, s37, v213
    v_mfma_f32_16x16x32_bf16 v[148:151], v[36:39], v[138:141], v[148:151]
    v_mul_f32 v214, s37, v214
    v_mul_f32 v215, s37, v215
    v_mfma_f32_16x16x32_bf16 v[152:155], v[42:45], v[138:141], v[152:155]
    v_cvt_pk_bf16_f32 v142, v212, v213
    v_cvt_pk_bf16_f32 v143, v214, v215
    v_mfma_f32_16x16x32_bf16 v[144:147], v[24:27], v[138:141], v[144:147]
    ds_read_b128 a[240:243], v225 offset:9152
    ds_read_b128 a[244:247], v225 offset:9216
    v_mfma_f32_16x16x16_bf16 v[148:151], v[40:41], v[142:143], v[148:151]
    buffer_store_dwordx4 v[176:179], v244, s[20:23], s51 offen sc0 sc1
    v_mfma_f32_16x16x16_bf16 v[152:155], v[46:47], v[142:143], v[152:155]
    s_add_u32 s51, s51, s48
    v_mul_f32 v191, v191, v197
    v_cvt_pk_bf16_f32 v187, v190, v191
    v_mfma_f32_16x16x16_bf16 v[144:147], v[28:29], v[142:143], v[144:147]
    v_mul_f32 v192, v192, v197
    v_mul_f32 v193, v193, v197
    v_mfma_f32_16x16x32_bf16 v[216:219], a[148:151], v[164:167], 0
    v_cvt_pk_bf16_f32 v188, v192, v193
    v_mul_f32 v194, v194, v197
    v_mfma_f32_16x16x32_bf16 v[216:219], a[160:163], v[168:171], v[216:219]
    v_mul_f32 v195, v195, v197
    v_cvt_pk_bf16_f32 v189, v194, v195
    v_mfma_f32_16x16x32_bf16 v[212:215], a[152:155], v[164:167], 0
    ds_read_b128 v[164:167], v224 offset:30976
    v_max3_f32 v236, v236, v196, v197
    v_mfma_f32_16x16x32_bf16 v[212:215], a[164:167], v[168:171], v[212:215]
    ds_read_b128 v[168:171], v224 offset:31040
    v_mfma_f32_16x16x32_bf16 v[216:219], a[172:175], v[248:251], v[216:219]
    ds_write_b128 v237, v[184:187]
    v_mfma_f32_16x16x32_bf16 v[216:219], a[184:187], a[236:239], v[216:219]
    ds_write_b64 v238, v[188:189]
    v_mfma_f32_16x16x32_bf16 v[212:215], a[176:179], v[248:251], v[212:215]
    v_exp_f32 v148, v148
    v_mfma_f32_16x16x32_bf16 v[212:215], a[188:191], a[236:239], v[212:215]
    s_waitcnt lgkmcnt(4)
    v_exp_f32 v149, v149
    v_mfma_f32_16x16x32_bf16 v[220:223], a[192:195], a[240:243], v[220:223]
    buffer_load_dwordx4 v246, s[4:7], s56 offen lds
    v_mfma_f32_16x16x32_bf16 v[220:223], a[204:207], a[244:247], v[220:223]
    ds_read_b128 v[248:251], v224 offset:31104
    ds_read_b128 a[236:239], v224 offset:31168
    v_mfma_f32_16x16x32_bf16 v[216:219], a[196:199], a[240:243], v[216:219]
    v_exp_f32 v150, v150
    v_mfma_f32_16x16x32_bf16 v[216:219], a[208:211], a[244:247], v[216:219]
    v_exp_f32 v151, v151
    v_mfma_f32_16x16x32_bf16 v[212:215], a[200:203], a[240:243], v[212:215]
    ds_read_b128 a[240:243], v224 offset:31232
    v_mul_f32 v220, s37, v220
    v_mfma_f32_16x16x32_bf16 v[212:215], a[212:215], a[244:247], v[212:215]
    v_mul_f32 v221, s37, v221
    v_mul_f32 v222, s37, v222
    v_mfma_f32_16x16x32_bf16 v[200:203], a[220:223], a[252:255], 0
    v_mul_f32 v223, s37, v223
    v_cvt_pk_bf16_f32 v132, v220, v221
    v_mfma_f32_16x16x32_bf16 v[204:207], a[224:227], a[248:251], 0
    v_cvt_pk_bf16_f32 v133, v222, v223
    v_mul_f32 v216, s37, v216
    v_mfma_f32_16x16x32_bf16 v[180:183], a[224:227], a[252:255], 0
    v_mul_f32 v217, s37, v217
    v_mul_f32 v218, s37, v218
    v_mfma_f32_16x16x32_bf16 v[176:179], a[228:231], a[248:251], 0
    v_mul_f32 v219, s37, v219
    v_cvt_pk_bf16_f32 v134, v216, v217
    v_mfma_f32_16x16x32_bf16 v[172:175], a[232:235], a[248:251], 0
    s_waitcnt lgkmcnt(1)
    v_cvt_pk_bf16_f32 v135, v218, v219
    v_mul_f32 v212, s37, v212
    v_mfma_f32_16x16x32_bf16 v[220:223], a[0:3], v[164:167], 0
    v_mul_f32 v213, s37, v213
    v_mul_f32 v214, s37, v214
    v_mfma_f32_16x16x32_bf16 v[220:223], a[12:15], v[168:171], v[220:223]
    v_mul_f32 v215, s37, v215
    v_cvt_pk_bf16_f32 v136, v212, v213
    v_mfma_f32_16x16x32_bf16 v[216:219], a[4:7], v[164:167], 0
    ds_read_b128 a[244:247], v224 offset:31296
    v_cvt_pk_bf16_f32 v137, v214, v215
    v_mfma_f32_16x16x32_bf16 v[216:219], a[16:19], v[168:171], v[216:219]
    buffer_load_dwordx4 v247, s[4:7], s56 offen offset:1024 lds
    v_mfma_f32_16x16x32_bf16 v[212:215], a[8:11], v[164:167], 0
    s_add_u32 s56, s56, s42
    ds_read_b128 a[248:251], v239 offset:13312
    ds_read_b128 a[252:255], v240 offset:13312
    v_mfma_f32_16x16x32_bf16 v[212:215], a[20:23], v[168:171], v[212:215]
    s_add_u32 m0, s41, 0xd3c0
    v_cvt_pk_bf16_f32 v156, v148, v149
    v_cvt_pk_bf16_f32 v157, v150, v151
    v_mfma_f32_16x16x32_bf16 v[220:223], a[24:27], v[248:251], v[220:223]
    ds_read_b128 v[148:151], v230 offset:2560
    v_mfma_f32_16x16x32_bf16 v[220:223], a[36:39], a[236:239], v[220:223]
    v_exp_f32 v152, v152
    v_mfma_f32_16x16x32_bf16 v[216:219], a[28:31], v[248:251], v[216:219]
    v_exp_f32 v153, v153
    v_mfma_f32_16x16x32_bf16 v[216:219], a[40:43], a[236:239], v[216:219]
    v_exp_f32 v154, v154
    v_mfma_f32_16x16x32_bf16 v[212:215], a[32:35], v[248:251], v[212:215]
    v_exp_f32 v155, v155
    v_mfma_f32_16x16x32_bf16 v[212:215], a[44:47], a[236:239], v[212:215]
    s_waitcnt lgkmcnt(3)
    buffer_load_dwordx4 v246, s[4:7], s56 offen lds
    v_mfma_f32_16x16x32_bf16 v[220:223], a[48:51], a[240:243], v[220:223]
    v_cvt_pk_bf16_f32 v158, v152, v153
    v_cvt_pk_bf16_f32 v159, v154, v155
    v_mfma_f32_16x16x32_bf16 v[220:223], a[60:63], a[244:247], v[220:223]
    ds_read_b128 v[152:155], v234
    v_bfe_u32 v234, s71, v233, 4
    v_mfma_f32_16x16x32_bf16 v[196:199], a[216:219], v[156:159], 0
    v_mad_u32_u24 v234, v234, s40, v231
    v_mfma_f32_16x16x32_bf16 v[184:187], v[76:79], v[156:159], 0
    v_exp_f32 v144, v144
    v_mfma_f32_16x16x32_bf16 v[188:191], v[98:101], v[156:159], 0
    v_exp_f32 v145, v145
    v_mfma_f32_16x16x32_bf16 v[192:195], v[120:123], v[156:159], 0
    s_waitcnt lgkmcnt(1)
    v_cvt_pk_bf16_f32 v12, v220, v221
    v_cvt_pk_bf16_f32 v13, v222, v223
    v_mfma_f32_16x16x32_bf16 v[148:151], v[30:33], v[138:141], v[148:151]
    v_exp_f32 v146, v146
    v_mfma_f32_16x16x32_bf16 v[216:219], a[52:55], a[240:243], v[216:219]
    buffer_load_dwordx4 v247, s[4:7], s56 offen offset:1024 lds
    v_mfma_f32_16x16x32_bf16 v[216:219], a[64:67], a[244:247], v[216:219]
    s_add_u32 s56, s56, s42
    v_exp_f32 v147, v147
    v_mfma_f32_16x16x16_bf16 v[148:151], v[34:35], v[142:143], v[148:151]
    s_add_u32 m0, s41, 0
    v_cvt_pk_bf16_f32 v156, v144, v145
    v_cvt_pk_bf16_f32 v157, v146, v147
    s_waitcnt lgkmcnt(0)
    v_mfma_f32_16x16x32_bf16 v[152:155], v[54:57], v[138:141], v[152:155]
    ds_read_b128 v[144:147], v235
    v_cvt_pk_bf16_f32 v14, v216, v217
    v_mfma_f32_16x16x32_bf16 v[212:215], a[56:59], a[240:243], v[212:215]
    v_cvt_pk_bf16_f32 v15, v218, v219
    v_bfe_u32 v235, s67, v233, 4
    v_mfma_f32_16x16x32_bf16 v[212:215], a[68:71], a[244:247], v[212:215]
    v_mad_u32_u24 v235, v235, s40, v231
    v_mfma_f32_16x16x16_bf16 v[152:155], v[58:59], v[142:143], v[152:155]
    v_exp_f32 v148, v148
    v_mfma_f32_16x16x32_bf16 v[208:211], v[252:255], a[248:251], v[208:211]
    v_exp_f32 v149, v149
    v_mfma_f32_16x16x32_bf16 v[200:203], v[252:255], a[252:255], v[200:203]
    ds_read_b128 v[252:255], v242 offset:12288
    v_cvt_pk_bf16_f32 v158, v148, v149
    v_mfma_f32_16x16x32_bf16 v[204:207], v[160:163], a[248:251], v[204:207]
    v_cvt_pk_bf16_f32 v16, v212, v213
    v_cvt_pk_bf16_f32 v17, v214, v215
    v_mfma_f32_16x16x32_bf16 v[180:183], v[160:163], a[252:255], v[180:183]
    s_waitcnt lgkmcnt(1)
    ds_read_b128 v[160:163], v242 offset:12800
    ds_read_b128 a[252:255], v240 offset:14336
    v_mfma_f32_16x16x32_bf16 v[144:147], v[60:63], v[138:141], v[144:147]
    v_exp_f32 v150, v150
    v_mfma_f32_16x16x32_bf16 v[220:223], v[164:167], a[72:75], 0
    v_exp_f32 v151, v151
    v_mfma_f32_16x16x32_bf16 v[220:223], v[168:171], a[84:87], v[220:223]
    v_cvt_pk_bf16_f32 v159, v150, v151
    v_mfma_f32_16x16x32_bf16 v[216:219], v[164:167], a[76:79], 0
    ds_read_b128 v[148:151], v229 offset:640
    v_mfma_f32_16x16x32_bf16 v[216:219], v[168:171], a[88:91], v[216:219]
    v_exp_f32 v152, v152
    v_mfma_f32_16x16x32_bf16 v[196:199], a[216:219], v[156:159], v[196:199]
    v_exp_f32 v153, v153
    v_mfma_f32_16x16x32_bf16 v[184:187], v[68:71], v[156:159], v[184:187]
    v_exp_f32 v154, v154
    v_mfma_f32_16x16x32_bf16 v[188:191], v[90:93], v[156:159], v[188:191]
    v_exp_f32 v155, v155
    v_mfma_f32_16x16x32_bf16 v[192:195], v[112:115], v[156:159], v[192:195]
    v_cvt_pk_bf16_f32 v156, v152, v153
    v_cvt_pk_bf16_f32 v157, v154, v155
    v_mfma_f32_16x16x16_bf16 v[144:147], v[64:65], v[142:143], v[144:147]
    s_waitcnt lgkmcnt(1)
    ds_read_b128 v[152:155], v228 offset:640
    v_mfma_f32_16x16x32_bf16 v[176:179], v[252:255], a[248:251], v[176:179]
    s_waitcnt lgkmcnt(1)
    ds_read_b128 v[252:255], v241 offset:24576
    v_mfma_f32_16x16x32_bf16 v[148:151], v[42:45], v[132:135], v[148:151]
    v_mfma_f32_16x16x32_bf16 v[172:175], v[160:163], a[248:251], v[172:175]
    ds_read_b128 a[248:251], v239 offset:14336
    ds_read_b128 v[160:163], v241 offset:25088
    v_mfma_f32_16x16x32_bf16 v[212:215], v[164:167], a[80:83], 0
    ds_read_b128 v[164:167], v224 offset:34048
    v_mfma_f32_16x16x32_bf16 v[212:215], v[168:171], a[92:95], v[212:215]
    ds_read_b128 v[168:171], v224 offset:34112
    v_mfma_f32_16x16x16_bf16 v[148:151], v[46:47], v[136:137], v[148:151]
    v_exp_f32 v144, v144
    v_mfma_f32_16x16x32_bf16 v[220:223], v[248:251], a[96:99], v[220:223]
    v_exp_f32 v145, v145
    v_mfma_f32_16x16x32_bf16 v[220:223], a[236:239], a[108:111], v[220:223]
    s_waitcnt lgkmcnt(5)
    v_exp_f32 v146, v146
    v_mfma_f32_16x16x32_bf16 v[152:155], v[18:21], v[132:135], v[152:155]
    v_exp_f32 v147, v147
    v_mfma_f32_16x16x32_bf16 v[216:219], v[248:251], a[100:103], v[216:219]
    v_cvt_pk_bf16_f32 v158, v144, v145
    v_cvt_pk_bf16_f32 v159, v146, v147
    v_mfma_f32_16x16x32_bf16 v[216:219], a[236:239], a[112:115], v[216:219]
    ds_read_b128 v[144:147], v228 offset:1280
    v_mfma_f32_16x16x32_bf16 v[196:199], a[216:219], v[156:159], v[196:199]
    v_exp_f32 v148, v148
    v_mfma_f32_16x16x32_bf16 v[184:187], v[84:87], v[156:159], v[184:187]
    v_exp_f32 v149, v149
    v_mfma_f32_16x16x32_bf16 v[188:191], v[106:109], v[156:159], v[188:191]
    v_exp_f32 v150, v150
    v_mfma_f32_16x16x32_bf16 v[192:195], v[128:131], v[156:159], v[192:195]
    v_exp_f32 v151, v151
    v_mfma_f32_16x16x16_bf16 v[152:155], v[22:23], v[136:137], v[152:155]
    v_rcp_f32 v197, v196
    v_mfma_f32_16x16x32_bf16 v[212:215], v[248:251], a[104:107], v[212:215]
    ds_read_b128 v[248:251], v224 offset:34176
    v_mul_f32 v184, v184, v197
    v_mfma_f32_16x16x32_bf16 v[212:215], a[236:239], a[116:119], v[212:215]
    s_waitcnt lgkmcnt(1)
    ds_read_b128 a[236:239], v224 offset:34240
    v_mul_f32 v185, v185, v197
    v_mfma_f32_16x16x32_bf16 v[144:147], v[0:3], v[132:135], v[144:147]
    v_cvt_pk_bf16_f32 v184, v184, v185
    v_mul_f32 v186, v186, v197
    v_mfma_f32_16x16x32_bf16 v[220:223], a[240:243], a[120:123], v[220:223]
    v_mul_f32 v187, v187, v197
    v_cvt_pk_bf16_f32 v185, v186, v187
    v_mfma_f32_16x16x32_bf16 v[220:223], a[244:247], a[132:135], v[220:223]
    v_mul_f32 v188, v188, v197
    v_mul_f32 v189, v189, v197
    v_mfma_f32_16x16x16_bf16 v[144:147], v[4:5], v[136:137], v[144:147]
    v_cvt_pk_bf16_f32 v186, v188, v189
    v_mul_f32 v190, v190, v197
    v_mfma_f32_16x16x32_bf16 v[216:219], a[240:243], a[124:127], v[216:219]
    v_mul_f32 v191, v191, v197
    v_cvt_pk_bf16_f32 v187, v190, v191
    v_mfma_f32_16x16x32_bf16 v[216:219], a[244:247], a[136:139], v[216:219]
    v_cvt_pk_bf16_f32 v74, v220, v221
    v_cvt_pk_bf16_f32 v75, v222, v223
    v_mfma_f32_16x16x32_bf16 v[212:215], a[240:243], a[128:131], v[212:215]
    ds_read_b128 a[240:243], v224 offset:34304
    v_mul_f32 v192, v192, v197
    v_mfma_f32_16x16x32_bf16 v[212:215], a[244:247], a[140:143], v[212:215]
    ds_read_b128 a[244:247], v224 offset:34368
    v_mul_f32 v193, v193, v197
    v_mfma_f32_16x16x32_bf16 v[208:211], v[252:255], a[248:251], v[208:211]
    v_cvt_pk_bf16_f32 v96, v216, v217
    v_cvt_pk_bf16_f32 v97, v218, v219
    v_mfma_f32_16x16x32_bf16 v[200:203], v[252:255], a[252:255], v[200:203]
    v_cvt_pk_bf16_f32 v188, v192, v193
    v_mul_f32 v194, v194, v197
    v_mfma_f32_16x16x32_bf16 v[204:207], v[160:163], a[248:251], v[204:207]
    v_cvt_pk_bf16_f32 v118, v212, v213
    v_cvt_pk_bf16_f32 v119, v214, v215
    v_mfma_f32_16x16x32_bf16 v[180:183], v[160:163], a[252:255], v[180:183]
    v_mul_f32 v195, v195, v197
    v_cvt_pk_bf16_f32 v189, v194, v195
    v_mfma_f32_16x16x32_bf16 v[220:223], a[0:3], v[164:167], 0
    ds_read_b128 v[252:255], v242 offset:24576
    v_max3_f32 v236, v236, v196, v197
    v_mfma_f32_16x16x32_bf16 v[220:223], a[12:15], v[168:171], v[220:223]
    ds_write_b128 v237, v[184:187] offset:6144
    v_mfma_f32_16x16x32_bf16 v[216:219], a[4:7], v[164:167], 0
    ds_write_b64 v238, v[188:189] offset:6144
    v_mfma_f32_16x16x32_bf16 v[216:219], a[16:19], v[168:171], v[216:219]
    v_cvt_pk_bf16_f32 v156, v148, v149
    v_cvt_pk_bf16_f32 v157, v150, v151
    v_mfma_f32_16x16x32_bf16 v[212:215], a[8:11], v[164:167], 0
    v_exp_f32 v152, v152
    v_mfma_f32_16x16x32_bf16 v[212:215], a[20:23], v[168:171], v[212:215]
    s_waitcnt lgkmcnt(2)
    v_exp_f32 v153, v153
    v_mfma_f32_16x16x32_bf16 v[176:179], v[252:255], a[248:251], v[176:179]
    ds_read_b128 v[160:163], v242 offset:25088
    ds_read_b128 a[252:255], v240 offset:15360
    v_mfma_f32_16x16x32_bf16 v[220:223], a[24:27], v[248:251], v[220:223]
    ds_read_b128 v[252:255], v241 offset:36864
    v_cvt_pk_bf16_f32 v158, v152, v153
    v_mfma_f32_16x16x32_bf16 v[220:223], a[36:39], a[236:239], v[220:223]
    ds_read_b128 v[148:151], v229 offset:1280
    v_mfma_f32_16x16x32_bf16 v[216:219], a[28:31], v[248:251], v[216:219]
    v_exp_f32 v154, v154
    v_mfma_f32_16x16x32_bf16 v[216:219], a[40:43], a[236:239], v[216:219]
    v_exp_f32 v155, v155
    v_mfma_f32_16x16x32_bf16 v[212:215], a[32:35], v[248:251], v[212:215]
    v_cvt_pk_bf16_f32 v159, v154, v155
    v_mfma_f32_16x16x32_bf16 v[212:215], a[44:47], a[236:239], v[212:215]
    ds_read_b128 v[152:155], v229 offset:1920
    v_mfma_f32_16x16x32_bf16 v[196:199], a[216:219], v[156:159], 0
    v_exp_f32 v144, v144
    v_mfma_f32_16x16x32_bf16 v[184:187], v[78:81], v[156:159], 0
    v_exp_f32 v145, v145
    v_mfma_f32_16x16x32_bf16 v[188:191], v[100:103], v[156:159], 0
    v_exp_f32 v146, v146
    v_mfma_f32_16x16x32_bf16 v[192:195], v[122:125], v[156:159], 0
    s_waitcnt lgkmcnt(1)
    v_exp_f32 v147, v147
    v_mfma_f32_16x16x32_bf16 v[148:151], v[24:27], v[132:135], v[148:151]
    v_cvt_pk_bf16_f32 v156, v144, v145
    v_cvt_pk_bf16_f32 v157, v146, v147
    v_mfma_f32_16x16x32_bf16 v[172:175], v[160:163], a[248:251], v[172:175]
    ds_read_b128 a[248:251], v239 offset:15360
    ds_read_b128 v[160:163], v241 offset:37376
    v_mfma_f32_16x16x32_bf16 v[220:223], a[48:51], a[240:243], v[220:223]
    ds_read_b128 v[144:147], v228 offset:1920
    v_mfma_f32_16x16x32_bf16 v[220:223], a[60:63], a[244:247], v[220:223]
    v_mfma_f32_16x16x16_bf16 v[148:151], v[28:29], v[136:137], v[148:151]
    s_waitcnt lgkmcnt(3)
    v_mfma_f32_16x16x32_bf16 v[152:155], v[30:33], v[132:135], v[152:155]
    v_mfma_f32_16x16x32_bf16 v[216:219], a[52:55], a[240:243], v[216:219]
    v_mfma_f32_16x16x32_bf16 v[216:219], a[64:67], a[244:247], v[216:219]
    v_mfma_f32_16x16x32_bf16 v[212:215], a[56:59], a[240:243], v[212:215]
    v_mfma_f32_16x16x32_bf16 v[212:215], a[68:71], a[244:247], v[212:215]
    s_waitcnt lgkmcnt(2)
    v_mfma_f32_16x16x32_bf16 v[208:211], v[252:255], a[248:251], v[208:211]
    s_waitcnt lgkmcnt(0)
    v_mfma_f32_16x16x32_bf16 v[144:147], v[6:9], v[132:135], v[144:147]
    v_cvt_pk_bf16_f32 v36, v220, v221
    v_cvt_pk_bf16_f32 v37, v222, v223
    v_mfma_f32_16x16x16_bf16 v[152:155], v[34:35], v[136:137], v[152:155]
    v_exp_f32 v148, v148
    v_mfma_f32_16x16x32_bf16 v[200:203], v[252:255], a[252:255], v[200:203]
    v_cvt_pk_bf16_f32 v38, v216, v217
    v_cvt_pk_bf16_f32 v39, v218, v219
    v_mfma_f32_16x16x16_bf16 v[144:147], v[10:11], v[136:137], v[144:147]
    v_cvt_pk_bf16_f32 v40, v212, v213
    v_cvt_pk_bf16_f32 v41, v214, v215
    v_mfma_f32_16x16x32_bf16 v[204:207], v[160:163], a[248:251], v[204:207]
    ds_read_b128 v[252:255], v242 offset:36864
    v_mfma_f32_16x16x32_bf16 v[180:183], v[160:163], a[252:255], v[180:183]
    ds_read_b128 v[160:163], v242 offset:37376
    ds_read_b128 a[252:255], v240 offset:16384
    v_mfma_f32_16x16x32_bf16 v[220:223], v[164:167], a[72:75], 0
    v_exp_f32 v149, v149
    v_mfma_f32_16x16x32_bf16 v[220:223], v[168:171], a[84:87], v[220:223]
    v_exp_f32 v150, v150
    v_mfma_f32_16x16x32_bf16 v[216:219], v[164:167], a[76:79], 0
    v_exp_f32 v151, v151
    v_mfma_f32_16x16x32_bf16 v[216:219], v[168:171], a[88:91], v[216:219]
    v_cvt_pk_bf16_f32 v158, v148, v149
    v_cvt_pk_bf16_f32 v159, v150, v151
    v_mfma_f32_16x16x32_bf16 v[212:215], v[164:167], a[80:83], 0
    ds_read_b128 v[164:167], v232 offset:11968
    ds_read_b128 v[148:151], v228 offset:2560
    v_mfma_f32_16x16x32_bf16 v[212:215], v[168:171], a[92:95], v[212:215]
    v_exp_f32 v152, v152
    v_mfma_f32_16x16x32_bf16 v[196:199], a[216:219], v[156:159], v[196:199]
    ds_read_b128 v[168:171], v232 offset:12032
    v_mfma_f32_16x16x32_bf16 v[184:187], v[66:69], v[156:159], v[184:187]
    v_exp_f32 v153, v153
    v_mfma_f32_16x16x32_bf16 v[188:191], v[88:91], v[156:159], v[188:191]
    v_exp_f32 v154, v154
    v_mfma_f32_16x16x32_bf16 v[192:195], v[110:113], v[156:159], v[192:195]
    s_waitcnt lgkmcnt(3)
    v_exp_f32 v155, v155
    v_mfma_f32_16x16x32_bf16 v[176:179], v[252:255], a[248:251], v[176:179]
    ds_read_b128 v[252:255], v241 offset:49152
    v_cvt_pk_bf16_f32 v156, v152, v153
    v_mfma_f32_16x16x32_bf16 v[172:175], v[160:163], a[248:251], v[172:175]
    ds_read_b128 a[248:251], v239 offset:16384
    ds_read_b128 v[160:163], v241 offset:49664
    v_mfma_f32_16x16x32_bf16 v[220:223], v[248:251], a[96:99], v[220:223]
    v_cvt_pk_bf16_f32 v157, v154, v155
    v_mfma_f32_16x16x32_bf16 v[220:223], a[236:239], a[108:111], v[220:223]
    s_waitcnt lgkmcnt(4)
    ds_read_b128 v[152:155], v229 offset:2560
    v_mfma_f32_16x16x32_bf16 v[148:151], v[12:15], v[132:135], v[148:151]
    v_exp_f32 v144, v144
    v_mfma_f32_16x16x32_bf16 v[216:219], v[248:251], a[100:103], v[216:219]
    v_exp_f32 v145, v145
    v_mfma_f32_16x16x32_bf16 v[216:219], a[236:239], a[112:115], v[216:219]
    v_exp_f32 v146, v146
    v_mfma_f32_16x16x32_bf16 v[212:215], v[248:251], a[104:107], v[212:215]
    ds_read_b128 v[248:251], v232 offset:12096
    v_cvt_pk_bf16_f32 v158, v144, v145
    v_mfma_f32_16x16x32_bf16 v[212:215], a[236:239], a[116:119], v[212:215]
    ds_read_b128 a[236:239], v232 offset:12160
    v_mfma_f32_16x16x16_bf16 v[148:151], v[16:17], v[136:137], v[148:151]
    v_exp_f32 v147, v147
    v_mfma_f32_16x16x32_bf16 v[220:223], a[240:243], a[120:123], v[220:223]
    v_cvt_pk_bf16_f32 v159, v146, v147
    v_mfma_f32_16x16x32_bf16 v[220:223], a[244:247], a[132:135], v[220:223]
    ds_read_b128 v[144:147], v230 offset:2560
    v_mfma_f32_16x16x32_bf16 v[196:199], a[216:219], v[156:159], v[196:199]
    v_mfma_f32_16x16x32_bf16 v[184:187], v[70:73], v[156:159], v[184:187]
    v_mfma_f32_16x16x32_bf16 v[188:191], v[92:95], v[156:159], v[188:191]
    v_exp_f32 v148, v148
    v_mfma_f32_16x16x32_bf16 v[192:195], v[114:117], v[156:159], v[192:195]
    s_waitcnt lgkmcnt(2)
    v_exp_f32 v149, v149
    v_mfma_f32_16x16x32_bf16 v[152:155], v[36:39], v[132:135], v[152:155]
    v_cvt_pk_bf16_f32 v76, v220, v221
    v_cvt_pk_bf16_f32 v77, v222, v223
    v_mfma_f32_16x16x32_bf16 v[216:219], a[240:243], a[124:127], v[216:219]
    v_exp_f32 v150, v150
    v_mfma_f32_16x16x32_bf16 v[216:219], a[244:247], a[136:139], v[216:219]
    v_exp_f32 v151, v151
    v_mfma_f32_16x16x16_bf16 v[152:155], v[40:41], v[136:137], v[152:155]
    v_cvt_pk_bf16_f32 v156, v148, v149
    v_cvt_pk_bf16_f32 v157, v150, v151
    v_mfma_f32_16x16x32_bf16 v[212:215], a[240:243], a[128:131], v[212:215]
    ds_read_b128 a[240:243], v232 offset:12224
    ds_read_b128 v[148:151], v230 offset:640
    v_mfma_f32_16x16x32_bf16 v[212:215], a[244:247], a[140:143], v[212:215]
    v_cvt_pk_bf16_f32 v98, v216, v217
    v_cvt_pk_bf16_f32 v99, v218, v219
    v_mfma_f32_16x16x32_bf16 v[208:211], v[252:255], a[248:251], v[208:211]
    ds_read_b128 a[244:247], v232 offset:12288
    v_mfma_f32_16x16x32_bf16 v[200:203], v[252:255], a[252:255], v[200:203]
    ds_read_b128 v[252:255], v242 offset:49152
    v_mfma_f32_16x16x32_bf16 v[204:207], v[160:163], a[248:251], v[204:207]
    v_exp_f32 v152, v152
    v_mfma_f32_16x16x32_bf16 v[180:183], v[160:163], a[252:255], v[180:183]
    v_cvt_pk_bf16_f32 v120, v212, v213
    v_cvt_pk_bf16_f32 v121, v214, v215
    v_mfma_f32_16x16x32_bf16 v[220:223], a[144:147], v[164:167], 0
    ds_read_b128 v[160:163], v242 offset:49664
    ds_read_b128 a[252:255], v240 offset:17408
    v_mfma_f32_16x16x32_bf16 v[220:223], a[156:159], v[168:171], v[220:223]
    v_exp_f32 v153, v153
    v_mfma_f32_16x16x32_bf16 v[216:219], a[148:151], v[164:167], 0
    v_exp_f32 v154, v154
    v_mfma_f32_16x16x32_bf16 v[216:219], a[160:163], v[168:171], v[216:219]
    v_exp_f32 v155, v155
    v_mfma_f32_16x16x32_bf16 v[212:215], a[152:155], v[164:167], 0
    v_cvt_pk_bf16_f32 v158, v152, v153
    v_cvt_pk_bf16_f32 v159, v154, v155
    v_mfma_f32_16x16x32_bf16 v[212:215], a[164:167], v[168:171], v[212:215]
    ds_read_b128 v[152:155], v230 offset:1280
    v_mfma_f32_16x16x32_bf16 v[196:199], a[216:219], v[156:159], v[196:199]
    v_mfma_f32_16x16x32_bf16 v[184:187], v[74:77], v[156:159], v[184:187]
    v_mfma_f32_16x16x32_bf16 v[188:191], v[96:99], v[156:159], v[188:191]
    v_mfma_f32_16x16x32_bf16 v[192:195], v[118:121], v[156:159], v[192:195]
    s_waitcnt lgkmcnt(1)
    v_mfma_f32_16x16x32_bf16 v[176:179], v[252:255], a[248:251], v[176:179]
    ds_read_b128 v[252:255], v241 offset:61440
    v_mfma_f32_16x16x32_bf16 v[172:175], v[160:163], a[248:251], v[172:175]
    ds_read_b128 a[248:251], v239 offset:17408
    ds_read_b128 v[160:163], v241 offset:61952
    v_mfma_f32_16x16x32_bf16 v[220:223], a[168:171], v[248:251], v[220:223]
    v_rcp_f32 v197, v196
    v_mfma_f32_16x16x32_bf16 v[220:223], a[180:183], a[236:239], v[220:223]
    v_mul_f32 v184, v184, v197
    v_mul_f32 v185, v185, v197
    v_mfma_f32_16x16x32_bf16 v[216:219], a[172:175], v[248:251], v[216:219]
    v_cvt_pk_bf16_f32 v184, v184, v185
    v_mul_f32 v186, v186, v197
    v_mfma_f32_16x16x32_bf16 v[216:219], a[184:187], a[236:239], v[216:219]
    v_mul_f32 v187, v187, v197
    v_cvt_pk_bf16_f32 v185, v186, v187
    v_mfma_f32_16x16x32_bf16 v[212:215], a[176:179], v[248:251], v[212:215]
    v_mul_f32 v188, v188, v197
    v_mul_f32 v189, v189, v197
    v_mfma_f32_16x16x32_bf16 v[212:215], a[188:191], a[236:239], v[212:215]
    s_waitcnt vmcnt(0) lgkmcnt(1)
    v_cvt_pk_bf16_f32 v186, v188, v189
    v_mul_f32 v190, v190, v197
    v_mfma_f32_16x16x32_bf16 v[220:223], a[192:195], a[240:243], v[220:223]
    s_barrier
    ds_read_b128 v[164:167], v227 offset:37120
    ds_read_b128 v[168:171], v227 offset:37184
    v_mfma_f32_16x16x32_bf16 v[220:223], a[204:207], a[244:247], v[220:223]
    ds_read_b128 v[248:251], v227 offset:37248
    v_mul_f32 v191, v191, v197
    v_mfma_f32_16x16x32_bf16 v[216:219], a[196:199], a[240:243], v[216:219]
    ds_read_b128 a[236:239], v227 offset:37312
    v_cvt_pk_bf16_f32 v187, v190, v191
    v_mfma_f32_16x16x32_bf16 v[216:219], a[208:211], a[244:247], v[216:219]
    buffer_load_dwordx4 v246, s[4:7], s56 offen lds
    v_mfma_f32_16x16x32_bf16 v[212:215], a[200:203], a[240:243], v[212:215]
    v_mul_f32 v220, s37, v220
    v_mul_f32 v221, s37, v221
    v_mfma_f32_16x16x32_bf16 v[212:215], a[212:215], a[244:247], v[212:215]
    v_mul_f32 v222, s37, v222
    v_mul_f32 v223, s37, v223
    v_mfma_f32_16x16x32_bf16 v[208:211], v[252:255], a[248:251], v[208:211]
    v_cvt_pk_bf16_f32 v138, v220, v221
    v_cvt_pk_bf16_f32 v139, v222, v223
    v_mfma_f32_16x16x32_bf16 v[200:203], v[252:255], a[252:255], v[200:203]
    s_waitcnt lgkmcnt(4)
    v_mul_f32 v216, s37, v216
    v_mul_f32 v217, s37, v217
    v_mfma_f32_16x16x32_bf16 v[204:207], v[160:163], a[248:251], v[204:207]
    v_mul_f32 v218, s37, v218
    v_mul_f32 v219, s37, v219
    v_mfma_f32_16x16x32_bf16 v[180:183], v[160:163], a[252:255], v[180:183]
    s_waitcnt lgkmcnt(2)
    v_cvt_pk_bf16_f32 v140, v216, v217
    v_cvt_pk_bf16_f32 v141, v218, v219
    v_mfma_f32_16x16x32_bf16 v[220:223], a[0:3], v[164:167], 0
    v_mul_f32 v212, s37, v212
    v_mul_f32 v213, s37, v213
    v_mfma_f32_16x16x32_bf16 v[220:223], a[12:15], v[168:171], v[220:223]
    v_mul_f32 v214, s37, v214
    v_mul_f32 v215, s37, v215
    v_mfma_f32_16x16x32_bf16 v[144:147], v[36:39], v[138:141], v[144:147]
    v_cvt_pk_bf16_f32 v142, v212, v213
    v_cvt_pk_bf16_f32 v143, v214, v215
    v_mfma_f32_16x16x32_bf16 v[148:151], v[42:45], v[138:141], v[148:151]
    ds_read_b128 a[240:243], v227 offset:37376
    ds_read_b128 a[244:247], v227 offset:37440
    v_mfma_f32_16x16x32_bf16 v[152:155], v[24:27], v[138:141], v[152:155]
    ds_read_b128 v[252:255], v242 offset:61440
    v_cvt_pk_bf16_f32 v208, v208, v209
    v_mfma_f32_16x16x16_bf16 v[144:147], v[40:41], v[142:143], v[144:147]
    ds_read_b128 v[160:163], v242 offset:61952
    v_cvt_pk_bf16_f32 v209, v210, v211
    v_mfma_f32_16x16x16_bf16 v[148:151], v[46:47], v[142:143], v[148:151]
    v_cvt_pk_bf16_f32 v210, v204, v205
    v_cvt_pk_bf16_f32 v211, v206, v207
    v_mfma_f32_16x16x16_bf16 v[152:155], v[28:29], v[142:143], v[152:155]
    buffer_store_dwordx4 v[208:211], v243, s[20:23], s51 offen sc0 sc1
    v_mfma_f32_16x16x32_bf16 v[216:219], a[4:7], v[164:167], 0
    v_cvt_pk_bf16_f32 v200, v200, v201
    v_cvt_pk_bf16_f32 v201, v202, v203
    v_mfma_f32_16x16x32_bf16 v[216:219], a[16:19], v[168:171], v[216:219]
    v_cvt_pk_bf16_f32 v202, v180, v181
    v_cvt_pk_bf16_f32 v203, v182, v183
    v_mfma_f32_16x16x32_bf16 v[212:215], a[8:11], v[164:167], 0
    v_mul_f32 v192, v192, v197
    v_mul_f32 v193, v193, v197
    v_mfma_f32_16x16x32_bf16 v[212:215], a[20:23], v[168:171], v[212:215]
    s_waitcnt lgkmcnt(1)
    v_cvt_pk_bf16_f32 v188, v192, v193
    v_mul_f32 v194, v194, v197
    v_mfma_f32_16x16x32_bf16 v[176:179], v[252:255], a[248:251], v[176:179]
    s_waitcnt lgkmcnt(0)
    v_mul_f32 v195, v195, v197
    v_cvt_pk_bf16_f32 v189, v194, v195
    v_mfma_f32_16x16x32_bf16 v[172:175], v[160:163], a[248:251], v[172:175]
    ds_read_b128 a[248:251], v239
    v_max3_f32 v236, v236, v196, v197
    v_mfma_f32_16x16x32_bf16 v[220:223], a[24:27], v[248:251], v[220:223]
    ds_write_b128 v237, v[184:187] offset:12288
    v_mfma_f32_16x16x32_bf16 v[220:223], a[36:39], a[236:239], v[220:223]
    v_cvt_pk_bf16_f32 v176, v176, v177
    v_cvt_pk_bf16_f32 v177, v178, v179
    v_mfma_f32_16x16x32_bf16 v[216:219], a[28:31], v[248:251], v[216:219]
    v_cvt_pk_bf16_f32 v178, v172, v173
    v_cvt_pk_bf16_f32 v179, v174, v175
    v_mfma_f32_16x16x32_bf16 v[216:219], a[40:43], a[236:239], v[216:219]
    ds_write_b64 v238, v[188:189] offset:12288
    v_mfma_f32_16x16x32_bf16 v[212:215], a[32:35], v[248:251], v[212:215]
    buffer_store_dwordx4 v[200:203], v245, s[20:23], s51 offen sc0 sc1
    v_mfma_f32_16x16x32_bf16 v[212:215], a[44:47], a[236:239], v[212:215]
    ds_read_b128 a[252:255], v240
    ds_read_b128 v[252:255], v241 offset:12288
    v_mfma_f32_16x16x32_bf16 v[220:223], a[48:51], a[240:243], v[220:223]
    ds_read_b128 v[160:163], v241 offset:12800
    v_mfma_f32_16x16x32_bf16 v[220:223], a[60:63], a[244:247], v[220:223]
    v_exp_f32 v144, v144
    v_mfma_f32_16x16x32_bf16 v[216:219], a[52:55], a[240:243], v[216:219]
    v_exp_f32 v145, v145
    v_mfma_f32_16x16x32_bf16 v[216:219], a[64:67], a[244:247], v[216:219]
    v_exp_f32 v146, v146
    v_mfma_f32_16x16x32_bf16 v[212:215], a[56:59], a[240:243], v[212:215]
    v_exp_f32 v147, v147
    v_mfma_f32_16x16x32_bf16 v[212:215], a[68:71], a[244:247], v[212:215]
    s_waitcnt lgkmcnt(4)
    v_cvt_pk_bf16_f32 v48, v220, v221
    v_cvt_pk_bf16_f32 v49, v222, v223
    v_mfma_f32_16x16x32_bf16 v[208:211], a[220:223], a[248:251], 0
    s_waitcnt lgkmcnt(2)
    v_cvt_pk_bf16_f32 v156, v144, v145
    v_cvt_pk_bf16_f32 v50, v216, v217
    v_mfma_f32_16x16x32_bf16 v[200:203], a[220:223], a[252:255], 0
L_pg5:
    s_cbranch_execz L_back
    v_cvt_pk_bf16_f32 v51, v218, v219
    v_cvt_pk_bf16_f32 v157, v146, v147
    v_mfma_f32_16x16x32_bf16 v[204:207], a[224:227], a[248:251], 0
    v_cvt_pk_bf16_f32 v52, v212, v213
    v_cvt_pk_bf16_f32 v53, v214, v215
    v_mfma_f32_16x16x32_bf16 v[180:183], a[224:227], a[252:255], 0
    ds_read_b128 v[144:147], v230 offset:1920
    v_mfma_f32_16x16x32_bf16 v[172:175], a[232:235], a[248:251], 0
    buffer_store_dwordx4 v[176:179], v244, s[20:23], s51 offen sc0 sc1
    v_mfma_f32_16x16x32_bf16 v[220:223], v[164:167], a[72:75], 0
    s_add_u32 s51, s51, s48
    ds_read_b128 a[252:255], v240 offset:1024
    v_mfma_f32_16x16x32_bf16 v[220:223], v[168:171], a[84:87], v[220:223]
    v_exp_f32 v148, v148
    v_mfma_f32_16x16x32_bf16 v[176:179], a[228:231], a[248:251], 0
    ds_read_b128 a[248:251], v239 offset:1024
    v_mfma_f32_16x16x32_bf16 v[216:219], v[164:167], a[76:79], 0
    v_exp_f32 v149, v149
    v_mfma_f32_16x16x32_bf16 v[216:219], v[168:171], a[88:91], v[216:219]
    s_waitcnt lgkmcnt(2)
    v_exp_f32 v150, v150
    v_mfma_f32_16x16x32_bf16 v[144:147], v[30:33], v[138:141], v[144:147]
    v_exp_f32 v151, v151
    v_mfma_f32_16x16x32_bf16 v[212:215], v[164:167], a[80:83], 0
    ds_read_b128 v[164:167], v225 offset:24384
    v_cvt_pk_bf16_f32 v158, v148, v149
    v_mfma_f32_16x16x32_bf16 v[212:215], v[168:171], a[92:95], v[212:215]
    ds_read_b128 v[168:171], v225 offset:24448
    v_cvt_pk_bf16_f32 v159, v150, v151
    v_mfma_f32_16x16x16_bf16 v[144:147], v[34:35], v[142:143], v[144:147]
    ds_read_b128 v[148:151], v234
    v_bfe_u32 v234, s72, v233, 4
    v_mfma_f32_16x16x32_bf16 v[196:199], a[216:219], v[156:159], 0
    v_mad_u32_u24 v234, v234, s40, v231
    v_mfma_f32_16x16x32_bf16 v[184:187], v[76:79], v[156:159], 0
    v_exp_f32 v152, v152
    v_mfma_f32_16x16x32_bf16 v[188:191], v[98:101], v[156:159], 0
    buffer_load_dwordx4 v247, s[4:7], s56 offen offset:1024 lds
    v_mfma_f32_16x16x32_bf16 v[192:195], v[120:123], v[156:159], 0
    s_add_u32 s56, s56, s42
    v_exp_f32 v153, v153
    v_mfma_f32_16x16x32_bf16 v[220:223], v[248:251], a[96:99], v[220:223]
    s_add_u32 m0, s41, 0x1e40
    v_exp_f32 v154, v154
    v_mfma_f32_16x16x32_bf16 v[220:223], a[236:239], a[108:111], v[220:223]
    v_exp_f32 v155, v155
    v_mfma_f32_16x16x32_bf16 v[216:219], v[248:251], a[100:103], v[216:219]
    v_cvt_pk_bf16_f32 v156, v152, v153
    v_cvt_pk_bf16_f32 v157, v154, v155
    v_mfma_f32_16x16x32_bf16 v[216:219], a[236:239], a[112:115], v[216:219]
    s_waitcnt lgkmcnt(0)
    ds_read_b128 v[152:155], v235
    v_bfe_u32 v235, s69, v233, 4
    v_mfma_f32_16x16x32_bf16 v[148:151], v[54:57], v[138:141], v[148:151]
    v_mad_u32_u24 v235, v235, s40, v231
    v_mfma_f32_16x16x32_bf16 v[212:215], v[248:251], a[104:107], v[212:215]
    ds_read_b128 v[248:251], v225 offset:24512
    v_mfma_f32_16x16x32_bf16 v[212:215], a[236:239], a[116:119], v[212:215]
    ds_read_b128 a[236:239], v225 offset:24576
    v_mfma_f32_16x16x32_bf16 v[220:223], a[240:243], a[120:123], v[220:223]
    buffer_load_dwordx4 v246, s[4:7], s56 offen lds
    v_mfma_f32_16x16x32_bf16 v[220:223], a[244:247], a[132:135], v[220:223]
    v_exp_f32 v144, v144
    v_mfma_f32_16x16x16_bf16 v[148:151], v[58:59], v[142:143], v[148:151]
    v_exp_f32 v145, v145
    v_mfma_f32_16x16x32_bf16 v[216:219], a[240:243], a[124:127], v[216:219]
    v_exp_f32 v146, v146
    v_mfma_f32_16x16x32_bf16 v[216:219], a[244:247], a[136:139], v[216:219]
    s_waitcnt lgkmcnt(2)
    v_exp_f32 v147, v147
    v_mfma_f32_16x16x32_bf16 v[152:155], v[60:63], v[138:141], v[152:155]
    v_cvt_pk_bf16_f32 v82, v220, v221
    v_cvt_pk_bf16_f32 v83, v222, v223
    v_mfma_f32_16x16x32_bf16 v[212:215], a[240:243], a[128:131], v[212:215]
    ds_read_b128 a[240:243], v225 offset:24640
    v_cvt_pk_bf16_f32 v158, v144, v145
    v_mfma_f32_16x16x32_bf16 v[212:215], a[244:247], a[140:143], v[212:215]
    v_cvt_pk_bf16_f32 v104, v216, v217
    v_cvt_pk_bf16_f32 v105, v218, v219
    v_mfma_f32_16x16x16_bf16 v[152:155], v[64:65], v[142:143], v[152:155]
    ds_read_b128 a[244:247], v225 offset:24704
    v_cvt_pk_bf16_f32 v159, v146, v147
    v_mfma_f32_16x16x32_bf16 v[220:223], a[144:147], v[164:167], 0
    buffer_load_dwordx4 v247, s[4:7], s56 offen offset:1024 lds
    v_mfma_f32_16x16x32_bf16 v[220:223], a[156:159], v[168:171], v[220:223]
    s_add_u32 s56, s56, s42
    v_cvt_pk_bf16_f32 v126, v212, v213
    v_cvt_pk_bf16_f32 v127, v214, v215
    v_mfma_f32_16x16x32_bf16 v[196:199], a[216:219], v[156:159], v[196:199]
    s_add_u32 m0, s41, 0x3c80
    ds_read_b128 v[144:147], v234
    v_bfe_u32 v234, s70, v233, 4
    v_mfma_f32_16x16x32_bf16 v[184:187], v[68:71], v[156:159], v[184:187]
    v_mad_u32_u24 v234, v234, s40, v231
    v_mfma_f32_16x16x32_bf16 v[188:191], v[90:93], v[156:159], v[188:191]
    v_exp_f32 v148, v148
    v_mfma_f32_16x16x32_bf16 v[192:195], v[112:115], v[156:159], v[192:195]
    v_exp_f32 v149, v149
    v_mfma_f32_16x16x32_bf16 v[216:219], a[148:151], v[164:167], 0
    v_exp_f32 v150, v150
    v_mfma_f32_16x16x32_bf16 v[216:219], a[160:163], v[168:171], v[216:219]
    v_exp_f32 v151, v151
    v_mfma_f32_16x16x32_bf16 v[212:215], a[152:155], v[164:167], 0
    ds_read_b128 v[164:167], v224 offset:46464
    v_cvt_pk_bf16_f32 v156, v148, v149
    v_mfma_f32_16x16x32_bf16 v[212:215], a[164:167], v[168:171], v[212:215]
    s_waitcnt lgkmcnt(1)
    ds_read_b128 v[168:171], v224 offset:46528
    v_cvt_pk_bf16_f32 v157, v150, v151
    v_mfma_f32_16x16x32_bf16 v[144:147], v[48:51], v[138:141], v[144:147]
    ds_read_b128 v[148:151], v228 offset:640
    v_mfma_f32_16x16x32_bf16 v[220:223], a[168:171], v[248:251], v[220:223]
    v_exp_f32 v152, v152
    v_mfma_f32_16x16x32_bf16 v[220:223], a[180:183], a[236:239], v[220:223]
    v_exp_f32 v153, v153
    v_mfma_f32_16x16x32_bf16 v[216:219], a[172:175], v[248:251], v[216:219]
    v_exp_f32 v154, v154
    v_mfma_f32_16x16x32_bf16 v[216:219], a[184:187], a[236:239], v[216:219]
    v_exp_f32 v155, v155
    v_mfma_f32_16x16x16_bf16 v[144:147], v[52:53], v[142:143], v[144:147]
    v_cvt_pk_bf16_f32 v158, v152, v153
    v_cvt_pk_bf16_f32 v159, v154, v155
    v_mfma_f32_16x16x32_bf16 v[212:215], a[176:179], v[248:251], v[212:215]
    ds_read_b128 v[248:251], v224 offset:46592
    ds_read_b128 v[152:155], v229 offset:640
    v_mfma_f32_16x16x32_bf16 v[212:215], a[188:191], a[236:239], v[212:215]
    v_mfma_f32_16x16x32_bf16 v[196:199], a[216:219], v[156:159], v[196:199]
    ds_read_b128 a[236:239], v224 offset:46656
    v_mfma_f32_16x16x32_bf16 v[184:187], v[84:87], v[156:159], v[184:187]
    v_exp_f32 v144, v144
    v_mfma_f32_16x16x32_bf16 v[188:191], v[106:109], v[156:159], v[188:191]
    v_exp_f32 v145, v145
    v_mfma_f32_16x16x32_bf16 v[192:195], v[128:131], v[156:159], v[192:195]
    v_exp_f32 v146, v146
    v_mfma_f32_16x16x32_bf16 v[220:223], a[192:195], a[240:243], v[220:223]
    v_exp_f32 v147, v147
    v_mfma_f32_16x16x32_bf16 v[220:223], a[204:207], a[244:247], v[220:223]
    v_cvt_pk_bf16_f32 v156, v144, v145
    v_cvt_pk_bf16_f32 v157, v146, v147
    v_mfma_f32_16x16x32_bf16 v[216:219], a[196:199], a[240:243], v[216:219]
    ds_read_b128 v[144:147], v229 offset:1280
    v_mfma_f32_16x16x32_bf16 v[216:219], a[208:211], a[244:247], v[216:219]
    v_mfma_f32_16x16x16_bf16 v[196:199], a[216:217], v[156:157], v[196:199]
    v_mfma_f32_16x16x16_bf16 v[184:187], v[82:83], v[156:157], v[184:187]
    v_mfma_f32_16x16x16_bf16 v[188:191], v[104:105], v[156:157], v[188:191]
    v_mul_f32 v220, s37, v220
    v_mul_f32 v221, s37, v221
    v_mfma_f32_16x16x16_bf16 v[192:195], v[126:127], v[156:157], v[192:195]
    v_mul_f32 v222, s37, v222
    v_mul_f32 v223, s37, v223
    v_mfma_f32_16x16x32_bf16 v[212:215], a[200:203], a[240:243], v[212:215]
    v_cvt_pk_bf16_f32 v132, v220, v221
    v_cvt_pk_bf16_f32 v133, v222, v223
    v_mfma_f32_16x16x32_bf16 v[212:215], a[212:215], a[244:247], v[212:215]
    v_mul_f32 v216, s37, v216
    v_mul_f32 v217, s37, v217
    v_mfma_f32_16x16x32_bf16 v[208:211], v[252:255], a[248:251], v[208:211]
    v_mul_f32 v218, s37, v218
    v_mul_f32 v219, s37, v219
    v_mfma_f32_16x16x32_bf16 v[200:203], v[252:255], a[252:255], v[200:203]
    v_cvt_pk_bf16_f32 v134, v216, v217
    v_cvt_pk_bf16_f32 v135, v218, v219
    v_mfma_f32_16x16x32_bf16 v[204:207], v[160:163], a[248:251], v[204:207]
    s_waitcnt lgkmcnt(0)
    v_mul_f32 v212, s37, v212
    v_mul_f32 v213, s37, v213
    v_mfma_f32_16x16x32_bf16 v[148:151], v[0:3], v[132:135], v[148:151]
    v_mul_f32 v214, s37, v214
    v_mul_f32 v215, s37, v215
    v_mfma_f32_16x16x32_bf16 v[152:155], v[24:27], v[132:135], v[152:155]
    v_cvt_pk_bf16_f32 v136, v212, v213
    v_cvt_pk_bf16_f32 v137, v214, v215
    v_mfma_f32_16x16x32_bf16 v[144:147], v[30:33], v[132:135], v[144:147]
    ds_read_b128 a[240:243], v224 offset:46720
    ds_read_b128 a[244:247], v224 offset:46784
    v_mfma_f32_16x16x16_bf16 v[148:151], v[4:5], v[136:137], v[148:151]
    v_rcp_f32 v197, v196
    v_mfma_f32_16x16x16_bf16 v[152:155], v[28:29], v[136:137], v[152:155]
    v_mul_f32 v184, v184, v197
    v_mul_f32 v185, v185, v197
    v_mfma_f32_16x16x16_bf16 v[144:147], v[34:35], v[136:137], v[144:147]
    v_cvt_pk_bf16_f32 v184, v184, v185
    v_mul_f32 v186, v186, v197
    v_mfma_f32_16x16x32_bf16 v[180:183], v[160:163], a[252:255], v[180:183]
    v_mul_f32 v187, v187, v197
    v_cvt_pk_bf16_f32 v185, v186, v187
    v_mfma_f32_16x16x32_bf16 v[220:223], a[0:3], v[164:167], 0
    v_mul_f32 v188, v188, v197
    v_mul_f32 v189, v189, v197
    v_mfma_f32_16x16x32_bf16 v[220:223], a[12:15], v[168:171], v[220:223]
    v_cvt_pk_bf16_f32 v186, v188, v189
    v_mul_f32 v190, v190, v197
    v_mfma_f32_16x16x32_bf16 v[216:219], a[4:7], v[164:167], 0
    v_mul_f32 v191, v191, v197
    v_cvt_pk_bf16_f32 v187, v190, v191
    v_mfma_f32_16x16x32_bf16 v[216:219], a[16:19], v[168:171], v[216:219]
    v_mul_f32 v192, v192, v197
    v_mul_f32 v193, v193, v197
    v_mfma_f32_16x16x32_bf16 v[212:215], a[8:11], v[164:167], 0
    v_cvt_pk_bf16_f32 v188, v192, v193
    v_mul_f32 v194, v194, v197
    v_mfma_f32_16x16x32_bf16 v[212:215], a[20:23], v[168:171], v[212:215]
    v_mul_f32 v195, v195, v197
    v_cvt_pk_bf16_f32 v189, v194, v195
    v_mfma_f32_16x16x32_bf16 v[220:223], a[24:27], v[248:251], v[220:223]
    ds_read_b128 v[252:255], v242 offset:12288
    v_max3_f32 v236, v236, v196, v197
    v_mfma_f32_16x16x32_bf16 v[220:223], a[36:39], a[236:239], v[220:223]
    ds_write_b128 v237, v[184:187] offset:18432
    v_mfma_f32_16x16x32_bf16 v[216:219], a[28:31], v[248:251], v[216:219]
    ds_write_b64 v238, v[188:189] offset:18432
    v_mfma_f32_16x16x32_bf16 v[216:219], a[40:43], a[236:239], v[216:219]
    v_exp_f32 v148, v148
    v_mfma_f32_16x16x32_bf16 v[212:215], a[32:35], v[248:251], v[212:215]
    v_exp_f32 v149, v149
    v_mfma_f32_16x16x32_bf16 v[212:215], a[44:47], a[236:239], v[212:215]
    s_waitcnt lgkmcnt(2)
    v_exp_f32 v150, v150
    v_mfma_f32_16x16x32_bf16 v[176:179], v[252:255], a[248:251], v[176:179]
    ds_read_b128 v[160:163], v242 offset:12800
    ds_read_b128 a[252:255], v240 offset:2048
    v_mfma_f32_16x16x32_bf16 v[220:223], a[48:51], a[240:243], v[220:223]
    ds_read_b128 v[252:255], v241 offset:24576
    v_cvt_pk_bf16_f32 v156, v148, v149
    v_mfma_f32_16x16x32_bf16 v[220:223], a[60:63], a[244:247], v[220:223]
    v_exp_f32 v151, v151
    v_mfma_f32_16x16x32_bf16 v[216:219], a[52:55], a[240:243], v[216:219]
    v_cvt_pk_bf16_f32 v157, v150, v151
    v_mfma_f32_16x16x32_bf16 v[216:219], a[64:67], a[244:247], v[216:219]
    ds_read_b128 v[148:151], v228 offset:1280
    v_mfma_f32_16x16x32_bf16 v[212:215], a[56:59], a[240:243], v[212:215]
    v_exp_f32 v152, v152
    v_mfma_f32_16x16x32_bf16 v[212:215], a[68:71], a[244:247], v[212:215]
    s_waitcnt lgkmcnt(3)
    v_cvt_pk_bf16_f32 v18, v220, v221
    v_cvt_pk_bf16_f32 v19, v222, v223
    v_mfma_f32_16x16x32_bf16 v[172:175], v[160:163], a[248:251], v[172:175]
    ds_read_b128 a[248:251], v239 offset:2048
    v_cvt_pk_bf16_f32 v20, v216, v217
    v_mfma_f32_16x16x32_bf16 v[220:223], v[164:167], a[72:75], 0
    ds_read_b128 v[160:163], v241 offset:25088
    v_cvt_pk_bf16_f32 v21, v218, v219
    v_mfma_f32_16x16x32_bf16 v[220:223], v[168:171], a[84:87], v[220:223]
    s_waitcnt lgkmcnt(3)
    v_cvt_pk_bf16_f32 v22, v212, v213
    v_cvt_pk_bf16_f32 v23, v214, v215
    v_mfma_f32_16x16x32_bf16 v[200:203], v[252:255], a[252:255], v[200:203]
    v_exp_f32 v153, v153
    v_mfma_f32_16x16x32_bf16 v[216:219], v[164:167], a[76:79], 0
    v_exp_f32 v154, v154
    v_mfma_f32_16x16x32_bf16 v[216:219], v[168:171], a[88:91], v[216:219]
    s_waitcnt lgkmcnt(2)
    v_exp_f32 v155, v155
    v_mfma_f32_16x16x32_bf16 v[148:151], v[6:9], v[132:135], v[148:151]
    s_waitcnt lgkmcnt(1)
    v_cvt_pk_bf16_f32 v158, v152, v153
    v_cvt_pk_bf16_f32 v159, v154, v155
    v_mfma_f32_16x16x32_bf16 v[208:211], v[252:255], a[248:251], v[208:211]
    ds_read_b128 v[252:255], v242 offset:24576
    ds_read_b128 v[152:155], v228 offset:1920
    v_mfma_f32_16x16x32_bf16 v[196:199], a[216:219], v[156:159], 0
    v_exp_f32 v144, v144
    v_mfma_f32_16x16x32_bf16 v[184:187], v[66:69], v[156:159], 0
    v_exp_f32 v145, v145
    v_mfma_f32_16x16x32_bf16 v[188:191], v[88:91], v[156:159], 0
    v_exp_f32 v146, v146
    v_mfma_f32_16x16x32_bf16 v[192:195], v[110:113], v[156:159], 0
    v_exp_f32 v147, v147
    v_mfma_f32_16x16x16_bf16 v[148:151], v[10:11], v[136:137], v[148:151]
    s_waitcnt lgkmcnt(2)
    v_cvt_pk_bf16_f32 v156, v144, v145
    v_cvt_pk_bf16_f32 v157, v146, v147
    v_mfma_f32_16x16x32_bf16 v[204:207], v[160:163], a[248:251], v[204:207]
    ds_read_b128 v[144:147], v229 offset:1920
    v_mfma_f32_16x16x32_bf16 v[180:183], v[160:163], a[252:255], v[180:183]
    s_waitcnt lgkmcnt(2)
    ds_read_b128 v[160:163], v242 offset:25088
    v_mfma_f32_16x16x32_bf16 v[176:179], v[252:255], a[248:251], v[176:179]
    s_waitcnt lgkmcnt(2)
    ds_read_b128 a[252:255], v240 offset:3072
    v_mfma_f32_16x16x32_bf16 v[152:155], v[12:15], v[132:135], v[152:155]
    ds_read_b128 v[252:255], v241 offset:36864
    v_mfma_f32_16x16x32_bf16 v[212:215], v[164:167], a[80:83], 0
    ds_read_b128 v[164:167], v224 offset:49536
    v_mfma_f32_16x16x32_bf16 v[212:215], v[168:171], a[92:95], v[212:215]
    ds_read_b128 v[168:171], v224 offset:49600
    v_mfma_f32_16x16x32_bf16 v[220:223], v[248:251], a[96:99], v[220:223]
    v_exp_f32 v148, v148
    v_mfma_f32_16x16x32_bf16 v[220:223], a[236:239], a[108:111], v[220:223]
    v_exp_f32 v149, v149
    v_mfma_f32_16x16x16_bf16 v[152:155], v[16:17], v[136:137], v[152:155]
    s_waitcnt lgkmcnt(5)
    v_exp_f32 v150, v150
    v_mfma_f32_16x16x32_bf16 v[144:147], v[36:39], v[132:135], v[144:147]
    s_waitcnt lgkmcnt(4)
    v_exp_f32 v151, v151
    v_mfma_f32_16x16x32_bf16 v[172:175], v[160:163], a[248:251], v[172:175]
    ds_read_b128 a[248:251], v239 offset:3072
    ds_read_b128 v[160:163], v241 offset:37376
    v_mfma_f32_16x16x32_bf16 v[216:219], v[248:251], a[100:103], v[216:219]
    v_cvt_pk_bf16_f32 v158, v148, v149
    v_cvt_pk_bf16_f32 v159, v150, v151
    v_mfma_f32_16x16x32_bf16 v[216:219], a[236:239], a[112:115], v[216:219]
    ds_read_b128 v[148:151], v229 offset:2560
    v_mfma_f32_16x16x32_bf16 v[196:199], a[216:219], v[156:159], v[196:199]
    v_exp_f32 v152, v152
    v_mfma_f32_16x16x32_bf16 v[184:187], v[70:73], v[156:159], v[184:187]
    v_exp_f32 v153, v153
    v_mfma_f32_16x16x32_bf16 v[188:191], v[92:95], v[156:159], v[188:191]
    v_exp_f32 v154, v154
    v_mfma_f32_16x16x32_bf16 v[192:195], v[114:117], v[156:159], v[192:195]
    v_exp_f32 v155, v155
    v_mfma_f32_16x16x16_bf16 v[144:147], v[40:41], v[136:137], v[144:147]
    v_cvt_pk_bf16_f32 v156, v152, v153
    v_cvt_pk_bf16_f32 v157, v154, v155
    v_mfma_f32_16x16x32_bf16 v[212:215], v[248:251], a[104:107], v[212:215]
    ds_read_b128 v[248:251], v224 offset:49664
    ds_read_b128 v[152:155], v228 offset:2560
    v_mfma_f32_16x16x32_bf16 v[212:215], a[236:239], a[116:119], v[212:215]
    v_mfma_f32_16x16x32_bf16 v[220:223], a[240:243], a[120:123], v[220:223]
    ds_read_b128 a[236:239], v224 offset:49728
    v_mfma_f32_16x16x32_bf16 v[220:223], a[244:247], a[132:135], v[220:223]
    v_exp_f32 v144, v144
    v_mfma_f32_16x16x32_bf16 v[216:219], a[240:243], a[124:127], v[216:219]
    v_exp_f32 v145, v145
    v_mfma_f32_16x16x32_bf16 v[216:219], a[244:247], a[136:139], v[216:219]
    v_exp_f32 v146, v146
    v_mfma_f32_16x16x32_bf16 v[212:215], a[240:243], a[128:131], v[212:215]
    ds_read_b128 a[240:243], v224 offset:49792
    v_cvt_pk_bf16_f32 v158, v144, v145
    v_mfma_f32_16x16x32_bf16 v[212:215], a[244:247], a[140:143], v[212:215]
    s_waitcnt lgkmcnt(4)
    v_cvt_pk_bf16_f32 v80, v220, v221
    v_cvt_pk_bf16_f32 v81, v222, v223
    v_mfma_f32_16x16x32_bf16 v[208:211], v[252:255], a[248:251], v[208:211]
    s_waitcnt lgkmcnt(2)
    v_cvt_pk_bf16_f32 v102, v216, v217
    v_cvt_pk_bf16_f32 v103, v218, v219
    v_mfma_f32_16x16x32_bf16 v[152:155], v[18:21], v[132:135], v[152:155]
    ds_read_b128 a[244:247], v224 offset:49856
    v_mfma_f32_16x16x32_bf16 v[200:203], v[252:255], a[252:255], v[200:203]
    v_cvt_pk_bf16_f32 v124, v212, v213
    v_cvt_pk_bf16_f32 v125, v214, v215
    v_mfma_f32_16x16x32_bf16 v[204:207], v[160:163], a[248:251], v[204:207]
    ds_read_b128 v[252:255], v242 offset:36864
    v_mfma_f32_16x16x16_bf16 v[152:155], v[22:23], v[136:137], v[152:155]
    v_exp_f32 v147, v147
    v_mfma_f32_16x16x32_bf16 v[180:183], v[160:163], a[252:255], v[180:183]
    ds_read_b128 v[160:163], v242 offset:37376
    ds_read_b128 a[252:255], v240 offset:4096
    v_mfma_f32_16x16x32_bf16 v[220:223], a[0:3], v[164:167], 0
    v_cvt_pk_bf16_f32 v159, v146, v147
    v_mfma_f32_16x16x32_bf16 v[220:223], a[12:15], v[168:171], v[220:223]
    ds_read_b128 v[144:147], v230 offset:640
    v_mfma_f32_16x16x32_bf16 v[196:199], a[216:219], v[156:159], v[196:199]
    v_exp_f32 v152, v152
    v_mfma_f32_16x16x32_bf16 v[184:187], v[74:77], v[156:159], v[184:187]
    v_exp_f32 v153, v153
    v_mfma_f32_16x16x32_bf16 v[188:191], v[96:99], v[156:159], v[188:191]
    v_exp_f32 v154, v154
    v_mfma_f32_16x16x32_bf16 v[192:195], v[118:121], v[156:159], v[192:195]
    s_waitcnt lgkmcnt(3)
    v_exp_f32 v155, v155
    v_mfma_f32_16x16x32_bf16 v[176:179], v[252:255], a[248:251], v[176:179]
    s_waitcnt lgkmcnt(2)
    ds_read_b128 v[252:255], v241 offset:49152
    v_cvt_pk_bf16_f32 v158, v152, v153
    v_mfma_f32_16x16x32_bf16 v[172:175], v[160:163], a[248:251], v[172:175]
    ds_read_b128 a[248:251], v239 offset:4096
    ds_read_b128 v[160:163], v241 offset:49664
    v_mfma_f32_16x16x32_bf16 v[216:219], a[4:7], v[164:167], 0
    v_cvt_pk_bf16_f32 v159, v154, v155
    v_mfma_f32_16x16x32_bf16 v[216:219], a[16:19], v[168:171], v[216:219]
    ds_read_b128 v[152:155], v230 offset:1920
    v_mfma_f32_16x16x32_bf16 v[212:215], a[8:11], v[164:167], 0
    v_mfma_f32_16x16x32_bf16 v[212:215], a[20:23], v[168:171], v[212:215]
    v_mfma_f32_16x16x32_bf16 v[220:223], a[24:27], v[248:251], v[220:223]
    v_mfma_f32_16x16x32_bf16 v[220:223], a[36:39], a[236:239], v[220:223]
    v_mfma_f32_16x16x32_bf16 v[216:219], a[28:31], v[248:251], v[216:219]
    v_mfma_f32_16x16x32_bf16 v[216:219], a[40:43], a[236:239], v[216:219]
    v_mfma_f32_16x16x32_bf16 v[212:215], a[32:35], v[248:251], v[212:215]
    v_mfma_f32_16x16x32_bf16 v[212:215], a[44:47], a[236:239], v[212:215]
    v_mfma_f32_16x16x32_bf16 v[220:223], a[48:51], a[240:243], v[220:223]
    v_mfma_f32_16x16x32_bf16 v[220:223], a[60:63], a[244:247], v[220:223]
    v_mfma_f32_16x16x32_bf16 v[216:219], a[52:55], a[240:243], v[216:219]
    v_mfma_f32_16x16x32_bf16 v[216:219], a[64:67], a[244:247], v[216:219]
    v_mfma_f32_16x16x32_bf16 v[212:215], a[56:59], a[240:243], v[212:215]
    v_mfma_f32_16x16x32_bf16 v[212:215], a[68:71], a[244:247], v[212:215]
    s_waitcnt lgkmcnt(0)
    v_mfma_f32_16x16x32_bf16 v[208:211], v[252:255], a[248:251], v[208:211]
    v_mfma_f32_16x16x32_bf16 v[200:203], v[252:255], a[252:255], v[200:203]
    ds_read_b128 v[252:255], v242 offset:49152
    v_mfma_f32_16x16x32_bf16 v[204:207], v[160:163], a[248:251], v[204:207]
    v_cvt_pk_bf16_f32 v42, v220, v221
    v_cvt_pk_bf16_f32 v43, v222, v223
    v_mfma_f32_16x16x32_bf16 v[180:183], v[160:163], a[252:255], v[180:183]
    v_cvt_pk_bf16_f32 v44, v216, v217
    v_cvt_pk_bf16_f32 v45, v218, v219
    v_mfma_f32_16x16x32_bf16 v[220:223], v[164:167], a[72:75], 0
    v_cvt_pk_bf16_f32 v46, v212, v213
    v_cvt_pk_bf16_f32 v47, v214, v215
    v_mfma_f32_16x16x32_bf16 v[220:223], v[168:171], a[84:87], v[220:223]
    ds_read_b128 v[160:163], v242 offset:49664
    ds_read_b128 a[252:255], v240 offset:5120
    v_mfma_f32_16x16x32_bf16 v[148:151], v[42:45], v[132:135], v[148:151]
    v_mfma_f32_16x16x32_bf16 v[216:219], v[164:167], a[76:79], 0
    v_mfma_f32_16x16x32_bf16 v[216:219], v[168:171], a[88:91], v[216:219]
    s_waitcnt lgkmcnt(2)
    v_mfma_f32_16x16x32_bf16 v[176:179], v[252:255], a[248:251], v[176:179]
    ds_read_b128 v[252:255], v241 offset:61440
    v_mfma_f32_16x16x32_bf16 v[212:215], v[164:167], a[80:83], 0
    ds_read_b128 v[164:167], v232 offset:27456
    v_mfma_f32_16x16x32_bf16 v[212:215], v[168:171], a[92:95], v[212:215]
    ds_read_b128 v[168:171], v232 offset:27520
    v_mfma_f32_16x16x16_bf16 v[148:151], v[46:47], v[136:137], v[148:151]
    s_waitcnt lgkmcnt(4)
    v_mfma_f32_16x16x32_bf16 v[172:175], v[160:163], a[248:251], v[172:175]
    ds_read_b128 a[248:251], v239 offset:5120
    ds_read_b128 v[160:163], v241 offset:61952
    v_mfma_f32_16x16x32_bf16 v[220:223], v[248:251], a[96:99], v[220:223]
    v_mfma_f32_16x16x32_bf16 v[220:223], a[236:239], a[108:111], v[220:223]
    v_mfma_f32_16x16x32_bf16 v[216:219], v[248:251], a[100:103], v[216:219]
    v_mfma_f32_16x16x32_bf16 v[216:219], a[236:239], a[112:115], v[216:219]
    v_mfma_f32_16x16x32_bf16 v[212:215], v[248:251], a[104:107], v[212:215]
    ds_read_b128 v[248:251], v232 offset:27584
    v_mfma_f32_16x16x32_bf16 v[212:215], a[236:239], a[116:119], v[212:215]
    ds_read_b128 a[236:239], v232 offset:27648
    v_mfma_f32_16x16x32_bf16 v[220:223], a[240:243], a[120:123], v[220:223]
    v_exp_f32 v148, v148
    v_mfma_f32_16x16x32_bf16 v[220:223], a[244:247], a[132:135], v[220:223]
    v_exp_f32 v149, v149
    v_mfma_f32_16x16x32_bf16 v[216:219], a[240:243], a[124:127], v[216:219]
    v_exp_f32 v150, v150
    v_mfma_f32_16x16x32_bf16 v[216:219], a[244:247], a[136:139], v[216:219]
    v_exp_f32 v151, v151
    v_mfma_f32_16x16x32_bf16 v[212:215], a[240:243], a[128:131], v[212:215]
    ds_read_b128 a[240:243], v232 offset:27712
    v_cvt_pk_bf16_f32 v156, v148, v149
    v_mfma_f32_16x16x32_bf16 v[212:215], a[244:247], a[140:143], v[212:215]
    s_waitcnt lgkmcnt(3)
    v_cvt_pk_bf16_f32 v78, v220, v221
    v_cvt_pk_bf16_f32 v79, v222, v223
    v_mfma_f32_16x16x32_bf16 v[208:211], v[252:255], a[248:251], v[208:211]
    v_cvt_pk_bf16_f32 v100, v216, v217
    v_cvt_pk_bf16_f32 v101, v218, v219
    v_mfma_f32_16x16x32_bf16 v[200:203], v[252:255], a[252:255], v[200:203]
    ds_read_b128 a[244:247], v232 offset:27776
    ds_read_b128 v[252:255], v242 offset:61440
    v_mfma_f32_16x16x32_bf16 v[204:207], v[160:163], a[248:251], v[204:207]
    v_cvt_pk_bf16_f32 v122, v212, v213
    v_cvt_pk_bf16_f32 v123, v214, v215
    v_mfma_f32_16x16x32_bf16 v[180:183], v[160:163], a[252:255], v[180:183]
    ds_read_b128 v[160:163], v242 offset:61952
    v_cvt_pk_bf16_f32 v208, v208, v209
    v_mfma_f32_16x16x32_bf16 v[220:223], a[144:147], v[164:167], 0
    v_cvt_pk_bf16_f32 v209, v210, v211
    v_cvt_pk_bf16_f32 v200, v200, v201
    v_mfma_f32_16x16x32_bf16 v[220:223], a[156:159], v[168:171], v[220:223]
    v_cvt_pk_bf16_f32 v210, v204, v205
    v_cvt_pk_bf16_f32 v211, v206, v207
    v_mfma_f32_16x16x32_bf16 v[216:219], a[148:151], v[164:167], 0
    s_waitcnt vmcnt(0) lgkmcnt(2)
    buffer_store_dwordx4 v[208:211], v243, s[20:23], s51 offen sc0 sc1
    v_mfma_f32_16x16x32_bf16 v[216:219], a[160:163], v[168:171], v[216:219]
    s_barrier
    ds_read_b128 a[252:255], v240 offset:12288
    v_cvt_pk_bf16_f32 v201, v202, v203
    v_mfma_f32_16x16x32_bf16 v[212:215], a[152:155], v[164:167], 0
    ds_read_b128 v[164:167], v225 offset:39872
    v_cvt_pk_bf16_f32 v202, v180, v181
    v_mfma_f32_16x16x32_bf16 v[212:215], a[164:167], v[168:171], v[212:215]
    s_waitcnt lgkmcnt(3)
    ds_read_b128 v[168:171], v225 offset:39936
    v_cvt_pk_bf16_f32 v203, v182, v183
    v_mfma_f32_16x16x32_bf16 v[176:179], v[252:255], a[248:251], v[176:179]
    s_waitcnt lgkmcnt(3)
    ds_read_b128 v[252:255], v241 offset:12288
    v_cvt_pk_bf16_f32 v157, v150, v151
    v_mfma_f32_16x16x32_bf16 v[172:175], v[160:163], a[248:251], v[172:175]
    ds_read_b128 v[148:151], v230 offset:1280
    v_mfma_f32_16x16x32_bf16 v[196:199], a[216:219], v[156:159], v[196:199]
    ds_read_b128 a[248:251], v239 offset:12288
    v_mfma_f32_16x16x32_bf16 v[184:187], v[78:81], v[156:159], v[184:187]
    ds_read_b128 v[160:163], v241 offset:12800
    v_cvt_pk_bf16_f32 v176, v176, v177
    v_mfma_f32_16x16x32_bf16 v[188:191], v[100:103], v[156:159], v[188:191]
    v_cvt_pk_bf16_f32 v177, v178, v179
    v_cvt_pk_bf16_f32 v178, v172, v173
    v_mfma_f32_16x16x32_bf16 v[192:195], v[122:125], v[156:159], v[192:195]
    v_cvt_pk_bf16_f32 v179, v174, v175
    v_mfma_f32_16x16x32_bf16 v[220:223], a[168:171], v[248:251], v[220:223]
    v_rcp_f32 v197, v196
    v_mfma_f32_16x16x32_bf16 v[220:223], a[180:183], a[236:239], v[220:223]
    v_mul_f32 v184, v184, v197
    v_mul_f32 v185, v185, v197
    v_mfma_f32_16x16x32_bf16 v[216:219], a[172:175], v[248:251], v[216:219]
    buffer_store_dwordx4 v[200:203], v245, s[20:23], s51 offen sc0 sc1
    v_mfma_f32_16x16x32_bf16 v[216:219], a[184:187], a[236:239], v[216:219]
    v_cvt_pk_bf16_f32 v184, v184, v185
    v_mul_f32 v186, v186, v197
    v_mfma_f32_16x16x32_bf16 v[212:215], a[176:179], v[248:251], v[212:215]
    ds_read_b128 v[248:251], v225 offset:40000
    v_mul_f32 v187, v187, v197
    v_mfma_f32_16x16x32_bf16 v[212:215], a[188:191], a[236:239], v[212:215]
    ds_read_b128 a[236:239], v225 offset:40064
    v_cvt_pk_bf16_f32 v185, v186, v187
    v_mfma_f32_16x16x32_bf16 v[220:223], a[192:195], a[240:243], v[220:223]
    v_mul_f32 v188, v188, v197
    v_mul_f32 v189, v189, v197
    v_mfma_f32_16x16x32_bf16 v[220:223], a[204:207], a[244:247], v[220:223]
    v_cvt_pk_bf16_f32 v186, v188, v189
    v_mul_f32 v190, v190, v197
    v_mfma_f32_16x16x32_bf16 v[216:219], a[196:199], a[240:243], v[216:219]
    v_mul_f32 v191, v191, v197
    v_cvt_pk_bf16_f32 v187, v190, v191
    v_mfma_f32_16x16x32_bf16 v[216:219], a[208:211], a[244:247], v[216:219]
    v_mul_f32 v192, v192, v197
    v_mul_f32 v193, v193, v197
    v_mfma_f32_16x16x32_bf16 v[212:215], a[200:203], a[240:243], v[212:215]
    v_mul_f32 v220, s37, v220
    v_mul_f32 v221, s37, v221
    v_mfma_f32_16x16x32_bf16 v[212:215], a[212:215], a[244:247], v[212:215]
    s_waitcnt lgkmcnt(2)
    v_mul_f32 v222, s37, v222
    v_mul_f32 v223, s37, v223
    v_mfma_f32_16x16x32_bf16 v[208:211], a[220:223], a[248:251], 0
    v_cvt_pk_bf16_f32 v138, v220, v221
    v_cvt_pk_bf16_f32 v139, v222, v223
    v_mfma_f32_16x16x32_bf16 v[220:223], a[144:147], v[164:167], 0
    v_mul_f32 v216, s37, v216
    v_mul_f32 v217, s37, v217
    v_mfma_f32_16x16x32_bf16 v[220:223], a[156:159], v[168:171], v[220:223]
    s_waitcnt lgkmcnt(0)
    v_mul_f32 v218, s37, v218
    v_mul_f32 v219, s37, v219
    v_mfma_f32_16x16x32_bf16 v[220:223], a[168:171], v[248:251], v[220:223]
    v_cvt_pk_bf16_f32 v140, v216, v217
    v_cvt_pk_bf16_f32 v141, v218, v219
    v_mfma_f32_16x16x32_bf16 v[220:223], a[180:183], a[236:239], v[220:223]
    v_mul_f32 v212, s37, v212
    v_mul_f32 v213, s37, v213
    v_mfma_f32_16x16x32_bf16 v[144:147], v[24:27], v[138:141], v[144:147]
    v_mul_f32 v214, s37, v214
    v_mul_f32 v215, s37, v215
    v_mfma_f32_16x16x32_bf16 v[148:151], v[30:33], v[138:141], v[148:151]
    v_cvt_pk_bf16_f32 v142, v212, v213
    v_cvt_pk_bf16_f32 v143, v214, v215
    v_mfma_f32_16x16x32_bf16 v[152:155], v[36:39], v[138:141], v[152:155]
    ds_read_b128 a[240:243], v225 offset:40128
    ds_read_b128 a[244:247], v225 offset:40192
    v_mfma_f32_16x16x16_bf16 v[144:147], v[28:29], v[142:143], v[144:147]
    buffer_store_dwordx4 v[176:179], v244, s[20:23], s51 offen sc0 sc1
    v_mfma_f32_16x16x16_bf16 v[148:151], v[34:35], v[142:143], v[148:151]
    s_add_u32 s51, s51, s48
    v_cvt_pk_bf16_f32 v188, v192, v193
    v_mul_f32 v194, v194, v197
    v_mfma_f32_16x16x16_bf16 v[152:155], v[40:41], v[142:143], v[152:155]
    v_mul_f32 v195, v195, v197
    v_cvt_pk_bf16_f32 v189, v194, v195
    v_mfma_f32_16x16x32_bf16 v[216:219], a[148:151], v[164:167], 0
    v_max3_f32 v236, v236, v196, v197
    v_cndmask_b32 v225, v243, v245, vcc
    v_mfma_f32_16x16x32_bf16 v[216:219], a[160:163], v[168:171], v[216:219]
    ds_write_b128 v237, v[184:187]
    v_mfma_f32_16x16x32_bf16 v[212:215], a[152:155], v[164:167], 0
    ds_write_b64 v238, v[188:189]
    v_mfma_f32_16x16x32_bf16 v[212:215], a[164:167], v[168:171], v[212:215]
    v_exp_f32 v144, v144
    v_mfma_f32_16x16x32_bf16 v[216:219], a[172:175], v[248:251], v[216:219]
    v_exp_f32 v145, v145
    v_mfma_f32_16x16x32_bf16 v[216:219], a[184:187], a[236:239], v[216:219]
    v_exp_f32 v146, v146
    v_mfma_f32_16x16x32_bf16 v[212:215], a[176:179], v[248:251], v[212:215]
    ds_read_b128 v[164:167], v224
    ds_read_b128 v[168:171], v224 offset:64
    v_mfma_f32_16x16x32_bf16 v[212:215], a[188:191], a[236:239], v[212:215]
    s_waitcnt lgkmcnt(4)
    ds_read_b128 v[248:251], v224 offset:128
    v_cvt_pk_bf16_f32 v156, v144, v145
    v_mfma_f32_16x16x32_bf16 v[220:223], a[192:195], a[240:243], v[220:223]
L_pg6:
    s_cbranch_execz L_back
    ds_read_b128 a[236:239], v224 offset:192
    v_mfma_f32_16x16x32_bf16 v[220:223], a[204:207], a[244:247], v[220:223]
    buffer_load_dwordx4 v246, s[4:7], s56 offen lds
    v_mfma_f32_16x16x32_bf16 v[216:219], a[196:199], a[240:243], v[216:219]
    v_exp_f32 v147, v147
    v_mfma_f32_16x16x32_bf16 v[216:219], a[208:211], a[244:247], v[216:219]
    v_cvt_pk_bf16_f32 v157, v146, v147
    v_mfma_f32_16x16x32_bf16 v[212:215], a[200:203], a[240:243], v[212:215]
    ds_read_b128 a[240:243], v224 offset:256
    ds_read_b128 v[144:147], v230 offset:2560
    v_mfma_f32_16x16x32_bf16 v[212:215], a[212:215], a[244:247], v[212:215]
    v_mul_f32 v220, s37, v220
    v_mul_f32 v221, s37, v221
    v_mfma_f32_16x16x32_bf16 v[200:203], a[220:223], a[252:255], 0
    v_mul_f32 v222, s37, v222
    v_mul_f32 v223, s37, v223
    v_mfma_f32_16x16x32_bf16 v[204:207], a[224:227], a[248:251], 0
    v_cvt_pk_bf16_f32 v132, v220, v221
    v_cvt_pk_bf16_f32 v133, v222, v223
    v_mfma_f32_16x16x32_bf16 v[180:183], a[224:227], a[252:255], 0
    v_mul_f32 v216, s37, v216
    v_mul_f32 v217, s37, v217
    v_mfma_f32_16x16x32_bf16 v[176:179], a[228:231], a[248:251], 0
    v_mul_f32 v218, s37, v218
    v_mul_f32 v219, s37, v219
    v_mfma_f32_16x16x32_bf16 v[172:175], a[232:235], a[248:251], 0
    s_waitcnt lgkmcnt(2)
    v_cvt_pk_bf16_f32 v134, v216, v217
    v_cvt_pk_bf16_f32 v135, v218, v219
    v_mfma_f32_16x16x32_bf16 v[220:223], a[0:3], v[164:167], 0
    v_mul_f32 v212, s37, v212
    v_mul_f32 v213, s37, v213
    v_mfma_f32_16x16x32_bf16 v[220:223], a[12:15], v[168:171], v[220:223]
    s_waitcnt lgkmcnt(0)
    v_mul_f32 v214, s37, v214
    v_mul_f32 v215, s37, v215
    v_mfma_f32_16x16x32_bf16 v[144:147], v[42:45], v[138:141], v[144:147]
    v_cvt_pk_bf16_f32 v136, v212, v213
    v_cvt_pk_bf16_f32 v137, v214, v215
    v_mfma_f32_16x16x32_bf16 v[216:219], a[4:7], v[164:167], 0
    ds_read_b128 a[244:247], v224 offset:320
    ds_read_b128 a[248:251], v239 offset:13312
    v_mfma_f32_16x16x32_bf16 v[216:219], a[16:19], v[168:171], v[216:219]
    buffer_load_dwordx4 v247, s[4:7], s56 offen offset:1024 lds
    v_mfma_f32_16x16x16_bf16 v[144:147], v[46:47], v[142:143], v[144:147]
    s_add_u32 s56, s56, s42
    ds_read_b128 a[252:255], v240 offset:13312
    s_add_u32 m0, s41, 0x5ac0
    v_mfma_f32_16x16x32_bf16 v[212:215], a[8:11], v[164:167], 0
    v_exp_f32 v148, v148
    v_mfma_f32_16x16x32_bf16 v[212:215], a[20:23], v[168:171], v[212:215]
    v_exp_f32 v149, v149
    v_mfma_f32_16x16x32_bf16 v[220:223], a[24:27], v[248:251], v[220:223]
    v_exp_f32 v150, v150
    v_mfma_f32_16x16x32_bf16 v[220:223], a[36:39], a[236:239], v[220:223]
    v_exp_f32 v151, v151
    v_mfma_f32_16x16x32_bf16 v[216:219], a[28:31], v[248:251], v[216:219]
    v_cvt_pk_bf16_f32 v158, v148, v149
    v_cvt_pk_bf16_f32 v159, v150, v151
    v_mfma_f32_16x16x32_bf16 v[216:219], a[40:43], a[236:239], v[216:219]
    ds_read_b128 v[148:151], v235
    v_bfe_u32 v235, s67, v233, 4
    v_mfma_f32_16x16x32_bf16 v[196:199], a[216:219], v[156:159], 0
    buffer_load_dwordx4 v246, s[4:7], s56 offen lds
    v_mfma_f32_16x16x32_bf16 v[184:187], v[68:71], v[156:159], 0
    v_mad_u32_u24 v235, v235, s40, v231
    v_cndmask_b32 v246, v245, v243, vcc
    v_mfma_f32_16x16x32_bf16 v[188:191], v[90:93], v[156:159], 0
    v_exp_f32 v152, v152
    v_mfma_f32_16x16x32_bf16 v[192:195], v[112:115], v[156:159], 0
    v_exp_f32 v153, v153
    v_mfma_f32_16x16x32_bf16 v[212:215], a[32:35], v[248:251], v[212:215]
    v_exp_f32 v154, v154
    v_mfma_f32_16x16x32_bf16 v[212:215], a[44:47], a[236:239], v[212:215]
    v_exp_f32 v155, v155
    v_mfma_f32_16x16x32_bf16 v[220:223], a[48:51], a[240:243], v[220:223]
    s_waitcnt lgkmcnt(1)
    v_cvt_pk_bf16_f32 v156, v152, v153
    v_cvt_pk_bf16_f32 v157, v154, v155
    v_mfma_f32_16x16x32_bf16 v[220:223], a[60:63], a[244:247], v[220:223]
    s_waitcnt lgkmcnt(0)
    ds_read_b128 v[152:155], v234
    v_bfe_u32 v234, s72, v233, 4
    v_mfma_f32_16x16x32_bf16 v[148:151], v[60:63], v[138:141], v[148:151]
    buffer_load_dwordx4 v247, s[4:7], s56 offen offset:1024 lds
    v_mfma_f32_16x16x32_bf16 v[216:219], a[52:55], a[240:243], v[216:219]
    v_mad_u32_u24 v234, v234, s40, v231
    v_bfrev_b32 v247, 1
    v_mfma_f32_16x16x32_bf16 v[216:219], a[64:67], a[244:247], v[216:219]
    v_cvt_pk_bf16_f32 v0, v220, v221
    v_cvt_pk_bf16_f32 v1, v222, v223
    v_mfma_f32_16x16x16_bf16 v[148:151], v[64:65], v[142:143], v[148:151]
    v_exp_f32 v144, v144
    v_mfma_f32_16x16x32_bf16 v[212:215], a[56:59], a[240:243], v[212:215]
    v_exp_f32 v145, v145
    v_mfma_f32_16x16x32_bf16 v[212:215], a[68:71], a[244:247], v[212:215]
    v_exp_f32 v146, v146
    v_mfma_f32_16x16x32_bf16 v[208:211], v[252:255], a[248:251], v[208:211]
    s_waitcnt lgkmcnt(0)
    v_cvt_pk_bf16_f32 v2, v216, v217
    v_cvt_pk_bf16_f32 v3, v218, v219
    v_mfma_f32_16x16x32_bf16 v[152:155], v[48:51], v[138:141], v[152:155]
    v_exp_f32 v147, v147
    v_mfma_f32_16x16x32_bf16 v[200:203], v[252:255], a[252:255], v[200:203]
    ds_read_b128 v[252:255], v242 offset:12288
    v_cvt_pk_bf16_f32 v4, v212, v213
    v_mfma_f32_16x16x32_bf16 v[204:207], v[160:163], a[248:251], v[204:207]
    v_cvt_pk_bf16_f32 v5, v214, v215
    v_cvt_pk_bf16_f32 v158, v144, v145
    v_mfma_f32_16x16x16_bf16 v[152:155], v[52:53], v[142:143], v[152:155]
    v_cvt_pk_bf16_f32 v159, v146, v147
    v_mfma_f32_16x16x32_bf16 v[180:183], v[160:163], a[252:255], v[180:183]
    ds_read_b128 v[160:163], v242 offset:12800
    ds_read_b128 a[252:255], v240 offset:14336
    v_mfma_f32_16x16x32_bf16 v[196:199], a[216:219], v[156:159], v[196:199]
    ds_read_b128 v[144:147], v229 offset:640
    v_mfma_f32_16x16x32_bf16 v[184:187], v[76:79], v[156:159], v[184:187]
    v_exp_f32 v148, v148
    v_mfma_f32_16x16x32_bf16 v[188:191], v[98:101], v[156:159], v[188:191]
    v_exp_f32 v149, v149
    v_mfma_f32_16x16x32_bf16 v[192:195], v[120:123], v[156:159], v[192:195]
    s_waitcnt lgkmcnt(3)
    v_exp_f32 v150, v150
    v_mfma_f32_16x16x32_bf16 v[176:179], v[252:255], a[248:251], v[176:179]
    ds_read_b128 v[252:255], v241 offset:24576
    v_cvt_pk_bf16_f32 v156, v148, v149
    v_mfma_f32_16x16x32_bf16 v[220:223], v[164:167], a[72:75], 0
    v_exp_f32 v151, v151
    v_mfma_f32_16x16x32_bf16 v[220:223], v[168:171], a[84:87], v[220:223]
    s_waitcnt lgkmcnt(3)
    v_cvt_pk_bf16_f32 v157, v150, v151
    v_mfma_f32_16x16x32_bf16 v[172:175], v[160:163], a[248:251], v[172:175]
    ds_read_b128 a[248:251], v239 offset:14336
    ds_read_b128 v[160:163], v241 offset:25088
    v_mfma_f32_16x16x16_bf16 v[196:199], a[216:217], v[156:157], v[196:199]
    ds_read_b128 v[148:151], v228 offset:640
    v_mfma_f32_16x16x16_bf16 v[184:187], v[86:87], v[156:157], v[184:187]
    v_exp_f32 v152, v152
    v_mfma_f32_16x16x16_bf16 v[188:191], v[108:109], v[156:157], v[188:191]
    v_exp_f32 v153, v153
    v_mfma_f32_16x16x16_bf16 v[192:195], v[130:131], v[156:157], v[192:195]
    s_waitcnt lgkmcnt(4)
    v_exp_f32 v154, v154
    v_mfma_f32_16x16x32_bf16 v[144:147], v[30:33], v[132:135], v[144:147]
    v_exp_f32 v155, v155
    v_mfma_f32_16x16x32_bf16 v[216:219], v[164:167], a[76:79], 0
    v_cvt_pk_bf16_f32 v156, v152, v153
    v_cvt_pk_bf16_f32 v157, v154, v155
    v_mfma_f32_16x16x32_bf16 v[216:219], v[168:171], a[88:91], v[216:219]
    ds_read_b128 v[152:155], v228 offset:1280
    v_mfma_f32_16x16x16_bf16 v[196:199], a[216:217], v[156:157], v[196:199]
    v_mfma_f32_16x16x16_bf16 v[184:187], v[82:83], v[156:157], v[184:187]
    v_mfma_f32_16x16x16_bf16 v[188:191], v[104:105], v[156:157], v[188:191]
    v_mfma_f32_16x16x16_bf16 v[192:195], v[126:127], v[156:157], v[192:195]
    v_mfma_f32_16x16x16_bf16 v[144:147], v[34:35], v[136:137], v[144:147]
    s_waitcnt lgkmcnt(1)
    v_mfma_f32_16x16x32_bf16 v[148:151], v[6:9], v[132:135], v[148:151]
    v_mfma_f32_16x16x32_bf16 v[212:215], v[164:167], a[80:83], 0
    ds_read_b128 v[164:167], v224 offset:3072
    v_mfma_f32_16x16x32_bf16 v[212:215], v[168:171], a[92:95], v[212:215]
    s_waitcnt lgkmcnt(1)
    ds_read_b128 v[168:171], v224 offset:3136
    v_mfma_f32_16x16x32_bf16 v[152:155], v[12:15], v[132:135], v[152:155]
    v_rcp_f32 v197, v196
    v_mfma_f32_16x16x16_bf16 v[148:151], v[10:11], v[136:137], v[148:151]
    v_mul_f32 v184, v184, v197
    v_mul_f32 v185, v185, v197
    v_mfma_f32_16x16x32_bf16 v[220:223], v[248:251], a[96:99], v[220:223]
    v_cvt_pk_bf16_f32 v184, v184, v185
    v_mul_f32 v186, v186, v197
    v_mfma_f32_16x16x32_bf16 v[220:223], a[236:239], a[108:111], v[220:223]
    v_mul_f32 v187, v187, v197
    v_cvt_pk_bf16_f32 v185, v186, v187
    v_mfma_f32_16x16x16_bf16 v[152:155], v[16:17], v[136:137], v[152:155]
    v_mul_f32 v188, v188, v197
    v_mul_f32 v189, v189, v197
    v_mfma_f32_16x16x32_bf16 v[216:219], v[248:251], a[100:103], v[216:219]
    v_cvt_pk_bf16_f32 v186, v188, v189
    v_mul_f32 v190, v190, v197
    v_mfma_f32_16x16x32_bf16 v[216:219], a[236:239], a[112:115], v[216:219]
    v_mul_f32 v191, v191, v197
    v_cvt_pk_bf16_f32 v187, v190, v191
    v_mfma_f32_16x16x32_bf16 v[212:215], v[248:251], a[104:107], v[212:215]
    ds_read_b128 v[248:251], v224 offset:3200
    v_mul_f32 v192, v192, v197
    v_mfma_f32_16x16x32_bf16 v[212:215], a[236:239], a[116:119], v[212:215]
    ds_read_b128 a[236:239], v224 offset:3264
    v_mul_f32 v193, v193, v197
    v_mfma_f32_16x16x32_bf16 v[220:223], a[240:243], a[120:123], v[220:223]
    v_cvt_pk_bf16_f32 v188, v192, v193
    v_mul_f32 v194, v194, v197
    v_mfma_f32_16x16x32_bf16 v[220:223], a[244:247], a[132:135], v[220:223]
    v_mul_f32 v195, v195, v197
    v_cvt_pk_bf16_f32 v189, v194, v195
    v_mfma_f32_16x16x32_bf16 v[216:219], a[240:243], a[124:127], v[216:219]
    v_max3_f32 v236, v236, v196, v197
    v_mfma_f32_16x16x32_bf16 v[216:219], a[244:247], a[136:139], v[216:219]
    ds_write_b128 v237, v[184:187] offset:6144
    v_mfma_f32_16x16x32_bf16 v[212:215], a[240:243], a[128:131], v[212:215]
    ds_write_b64 v238, v[188:189] offset:6144
    v_mfma_f32_16x16x32_bf16 v[212:215], a[244:247], a[140:143], v[212:215]
    v_cvt_pk_bf16_f32 v66, v220, v221
    v_cvt_pk_bf16_f32 v67, v222, v223
    v_mfma_f32_16x16x32_bf16 v[208:211], v[252:255], a[248:251], v[208:211]
    v_exp_f32 v144, v144
    v_mfma_f32_16x16x32_bf16 v[200:203], v[252:255], a[252:255], v[200:203]
    v_cvt_pk_bf16_f32 v88, v216, v217
    v_cvt_pk_bf16_f32 v89, v218, v219
    v_mfma_f32_16x16x32_bf16 v[204:207], v[160:163], a[248:251], v[204:207]
    v_cvt_pk_bf16_f32 v110, v212, v213
    v_cvt_pk_bf16_f32 v111, v214, v215
    v_mfma_f32_16x16x32_bf16 v[180:183], v[160:163], a[252:255], v[180:183]
    s_waitcnt lgkmcnt(2)
    ds_read_b128 a[240:243], v224 offset:3328
    ds_read_b128 a[244:247], v224 offset:3392
    v_mfma_f32_16x16x32_bf16 v[220:223], a[0:3], v[164:167], 0
    ds_read_b128 v[252:255], v242 offset:24576
    v_mfma_f32_16x16x32_bf16 v[220:223], a[12:15], v[168:171], v[220:223]
    ds_read_b128 v[160:163], v242 offset:25088
    v_mfma_f32_16x16x32_bf16 v[216:219], a[4:7], v[164:167], 0
    ds_read_b128 a[252:255], v240 offset:15360
    v_mfma_f32_16x16x32_bf16 v[216:219], a[16:19], v[168:171], v[216:219]
    v_exp_f32 v145, v145
    v_mfma_f32_16x16x32_bf16 v[212:215], a[8:11], v[164:167], 0
    v_exp_f32 v146, v146
    v_mfma_f32_16x16x32_bf16 v[212:215], a[20:23], v[168:171], v[212:215]
    v_exp_f32 v147, v147
    v_mfma_f32_16x16x32_bf16 v[220:223], a[24:27], v[248:251], v[220:223]
    v_cvt_pk_bf16_f32 v156, v144, v145
    v_cvt_pk_bf16_f32 v157, v146, v147
    v_mfma_f32_16x16x32_bf16 v[220:223], a[36:39], a[236:239], v[220:223]
    s_waitcnt lgkmcnt(2)
    ds_read_b128 v[144:147], v229 offset:1280
    v_mfma_f32_16x16x32_bf16 v[176:179], v[252:255], a[248:251], v[176:179]
    s_waitcnt lgkmcnt(2)
    ds_read_b128 v[252:255], v241 offset:36864
    v_mfma_f32_16x16x32_bf16 v[172:175], v[160:163], a[248:251], v[172:175]
    ds_read_b128 a[248:251], v239 offset:15360
    v_mfma_f32_16x16x32_bf16 v[216:219], a[28:31], v[248:251], v[216:219]
    ds_read_b128 v[160:163], v241 offset:37376
    v_mfma_f32_16x16x32_bf16 v[216:219], a[40:43], a[236:239], v[216:219]
    v_exp_f32 v148, v148
    v_mfma_f32_16x16x32_bf16 v[212:215], a[32:35], v[248:251], v[212:215]
    v_exp_f32 v149, v149
    v_mfma_f32_16x16x32_bf16 v[212:215], a[44:47], a[236:239], v[212:215]
    v_exp_f32 v150, v150
    v_mfma_f32_16x16x32_bf16 v[220:223], a[48:51], a[240:243], v[220:223]
    v_exp_f32 v151, v151
    v_mfma_f32_16x16x32_bf16 v[220:223], a[60:63], a[244:247], v[220:223]
    s_waitcnt lgkmcnt(3)
    v_cvt_pk_bf16_f32 v158, v148, v149
    v_cvt_pk_bf16_f32 v159, v150, v151
    v_mfma_f32_16x16x32_bf16 v[144:147], v[36:39], v[132:135], v[144:147]
    ds_read_b128 v[148:151], v229 offset:1920
    v_mfma_f32_16x16x32_bf16 v[196:199], a[216:219], v[156:159], 0
    v_exp_f32 v152, v152
    v_mfma_f32_16x16x32_bf16 v[184:187], v[70:73], v[156:159], 0
    v_exp_f32 v153, v153
    v_mfma_f32_16x16x32_bf16 v[188:191], v[92:95], v[156:159], 0
    v_cvt_pk_bf16_f32 v24, v220, v221
    v_cvt_pk_bf16_f32 v25, v222, v223
    v_mfma_f32_16x16x32_bf16 v[192:195], v[114:117], v[156:159], 0
    v_exp_f32 v154, v154
    v_mfma_f32_16x16x16_bf16 v[144:147], v[40:41], v[136:137], v[144:147]
    v_exp_f32 v155, v155
    v_mfma_f32_16x16x32_bf16 v[216:219], a[52:55], a[240:243], v[216:219]
    v_cvt_pk_bf16_f32 v156, v152, v153
    v_cvt_pk_bf16_f32 v157, v154, v155
    v_mfma_f32_16x16x32_bf16 v[216:219], a[64:67], a[244:247], v[216:219]
    s_waitcnt lgkmcnt(0)
    ds_read_b128 v[152:155], v228 offset:1920
    v_mfma_f32_16x16x32_bf16 v[148:151], v[42:45], v[132:135], v[148:151]
    v_mfma_f32_16x16x32_bf16 v[212:215], a[56:59], a[240:243], v[212:215]
    v_exp_f32 v144, v144
    v_mfma_f32_16x16x32_bf16 v[212:215], a[68:71], a[244:247], v[212:215]
    v_exp_f32 v145, v145
    v_mfma_f32_16x16x32_bf16 v[208:211], v[252:255], a[248:251], v[208:211]
    v_exp_f32 v146, v146
    v_mfma_f32_16x16x16_bf16 v[148:151], v[46:47], v[136:137], v[148:151]
    v_cvt_pk_bf16_f32 v26, v216, v217
    v_cvt_pk_bf16_f32 v27, v218, v219
    v_mfma_f32_16x16x32_bf16 v[200:203], v[252:255], a[252:255], v[200:203]
    ds_read_b128 v[252:255], v242 offset:36864
    v_cvt_pk_bf16_f32 v28, v212, v213
    v_mfma_f32_16x16x32_bf16 v[204:207], v[160:163], a[248:251], v[204:207]
    s_waitcnt lgkmcnt(1)
    v_cvt_pk_bf16_f32 v29, v214, v215
    v_cvt_pk_bf16_f32 v158, v144, v145
    v_mfma_f32_16x16x32_bf16 v[152:155], v[18:21], v[132:135], v[152:155]
    v_exp_f32 v147, v147
    v_mfma_f32_16x16x32_bf16 v[180:183], v[160:163], a[252:255], v[180:183]
    ds_read_b128 v[160:163], v242 offset:37376
    ds_read_b128 a[252:255], v240 offset:16384
    v_mfma_f32_16x16x32_bf16 v[220:223], v[164:167], a[72:75], 0
    v_cvt_pk_bf16_f32 v159, v146, v147
    v_mfma_f32_16x16x32_bf16 v[220:223], v[168:171], a[84:87], v[220:223]
    ds_read_b128 v[144:147], v228 offset:2560
    v_mfma_f32_16x16x32_bf16 v[196:199], a[216:219], v[156:159], v[196:199]
    v_exp_f32 v148, v148
    v_mfma_f32_16x16x32_bf16 v[184:187], v[74:77], v[156:159], v[184:187]
    v_exp_f32 v149, v149
    v_mfma_f32_16x16x32_bf16 v[188:191], v[96:99], v[156:159], v[188:191]
    v_exp_f32 v150, v150
    v_mfma_f32_16x16x32_bf16 v[192:195], v[118:121], v[156:159], v[192:195]
    v_exp_f32 v151, v151
    v_mfma_f32_16x16x16_bf16 v[152:155], v[22:23], v[136:137], v[152:155]
    s_waitcnt lgkmcnt(3)
    v_cvt_pk_bf16_f32 v156, v148, v149
    v_cvt_pk_bf16_f32 v157, v150, v151
    v_mfma_f32_16x16x32_bf16 v[176:179], v[252:255], a[248:251], v[176:179]
    s_waitcnt lgkmcnt(2)
    ds_read_b128 v[252:255], v241 offset:49152
    ds_read_b128 v[148:151], v229 offset:2560
    v_mfma_f32_16x16x32_bf16 v[172:175], v[160:163], a[248:251], v[172:175]
    s_waitcnt lgkmcnt(2)
    v_mfma_f32_16x16x32_bf16 v[144:147], v[0:3], v[132:135], v[144:147]
    ds_read_b128 a[248:251], v239 offset:16384
    v_mfma_f32_16x16x32_bf16 v[216:219], v[164:167], a[76:79], 0
    ds_read_b128 v[160:163], v241 offset:49664
    v_mfma_f32_16x16x32_bf16 v[216:219], v[168:171], a[88:91], v[216:219]
    v_exp_f32 v152, v152
    v_mfma_f32_16x16x32_bf16 v[212:215], v[164:167], a[80:83], 0
    ds_read_b128 v[164:167], v232 offset:42944
    v_mfma_f32_16x16x32_bf16 v[212:215], v[168:171], a[92:95], v[212:215]
    ds_read_b128 v[168:171], v232 offset:43008
    v_mfma_f32_16x16x16_bf16 v[144:147], v[4:5], v[136:137], v[144:147]
    v_exp_f32 v153, v153
    v_mfma_f32_16x16x32_bf16 v[220:223], v[248:251], a[96:99], v[220:223]
    v_exp_f32 v154, v154
    v_mfma_f32_16x16x32_bf16 v[220:223], a[236:239], a[108:111], v[220:223]
    s_waitcnt lgkmcnt(4)
    v_exp_f32 v155, v155
    v_mfma_f32_16x16x32_bf16 v[148:151], v[24:27], v[132:135], v[148:151]
    v_cvt_pk_bf16_f32 v158, v152, v153
    v_cvt_pk_bf16_f32 v159, v154, v155
    v_mfma_f32_16x16x32_bf16 v[216:219], v[248:251], a[100:103], v[216:219]
    ds_read_b128 v[152:155], v230 offset:2560
    v_mfma_f32_16x16x32_bf16 v[216:219], a[236:239], a[112:115], v[216:219]
    v_exp_f32 v144, v144
    v_mfma_f32_16x16x32_bf16 v[196:199], a[216:219], v[156:159], v[196:199]
    v_exp_f32 v145, v145
    v_mfma_f32_16x16x32_bf16 v[184:187], v[78:81], v[156:159], v[184:187]
    v_exp_f32 v146, v146
    v_mfma_f32_16x16x32_bf16 v[188:191], v[100:103], v[156:159], v[188:191]
    v_exp_f32 v147, v147
    v_mfma_f32_16x16x32_bf16 v[192:195], v[122:125], v[156:159], v[192:195]
    v_cvt_pk_bf16_f32 v156, v144, v145
    v_cvt_pk_bf16_f32 v157, v146, v147
    v_mfma_f32_16x16x16_bf16 v[148:151], v[28:29], v[136:137], v[148:151]
    ds_read_b128 v[144:147], v230 offset:640
    v_mfma_f32_16x16x32_bf16 v[212:215], v[248:251], a[104:107], v[212:215]
    ds_read_b128 v[248:251], v232 offset:43072
    v_mfma_f32_16x16x32_bf16 v[212:215], a[236:239], a[116:119], v[212:215]
    ds_read_b128 a[236:239], v232 offset:43136
    v_mfma_f32_16x16x32_bf16 v[220:223], a[240:243], a[120:123], v[220:223]
    v_mfma_f32_16x16x32_bf16 v[220:223], a[244:247], a[132:135], v[220:223]
    v_mfma_f32_16x16x32_bf16 v[216:219], a[240:243], a[124:127], v[216:219]
    v_exp_f32 v148, v148
    v_mfma_f32_16x16x32_bf16 v[216:219], a[244:247], a[136:139], v[216:219]
    v_exp_f32 v149, v149
    v_mfma_f32_16x16x32_bf16 v[212:215], a[240:243], a[128:131], v[212:215]
    ds_read_b128 a[240:243], v232 offset:43200
    v_cvt_pk_bf16_f32 v158, v148, v149
    v_mfma_f32_16x16x32_bf16 v[212:215], a[244:247], a[140:143], v[212:215]
    s_waitcnt lgkmcnt(4)
    v_cvt_pk_bf16_f32 v68, v220, v221
    v_cvt_pk_bf16_f32 v69, v222, v223
    v_mfma_f32_16x16x32_bf16 v[208:211], v[252:255], a[248:251], v[208:211]
    v_cvt_pk_bf16_f32 v90, v216, v217
    v_cvt_pk_bf16_f32 v91, v218, v219
    v_mfma_f32_16x16x32_bf16 v[200:203], v[252:255], a[252:255], v[200:203]
    ds_read_b128 a[244:247], v232 offset:43264
    v_or_b32 v232, v243, v245
    v_mfma_f32_16x16x32_bf16 v[204:207], v[160:163], a[248:251], v[204:207]
    v_cvt_pk_bf16_f32 v112, v212, v213
    v_cvt_pk_bf16_f32 v113, v214, v215
    v_mfma_f32_16x16x32_bf16 v[180:183], v[160:163], a[252:255], v[180:183]
    ds_read_b128 v[252:255], v242 offset:49152
    v_lshrrev_b32 v232, 31, v232
    v_mfma_f32_16x16x32_bf16 v[220:223], a[144:147], v[164:167], 0
    ds_read_b128 v[160:163], v242 offset:49664
    v_lshl_add_u32 v232, v232, 20, v226
    v_mfma_f32_16x16x32_bf16 v[220:223], a[156:159], v[168:171], v[220:223]
    ds_read_b128 a[252:255], v240 offset:17408
    v_mfma_f32_16x16x32_bf16 v[216:219], a[148:151], v[164:167], 0
    v_exp_f32 v150, v150
    v_mfma_f32_16x16x32_bf16 v[216:219], a[160:163], v[168:171], v[216:219]
    v_exp_f32 v151, v151
    v_mfma_f32_16x16x32_bf16 v[212:215], a[152:155], v[164:167], 0
    v_cvt_pk_bf16_f32 v159, v150, v151
    v_mfma_f32_16x16x32_bf16 v[212:215], a[164:167], v[168:171], v[212:215]
    ds_read_b128 v[148:151], v230 offset:1280
    v_mfma_f32_16x16x32_bf16 v[196:199], a[216:219], v[156:159], v[196:199]
    v_mfma_f32_16x16x32_bf16 v[184:187], v[66:69], v[156:159], v[184:187]
    v_mfma_f32_16x16x32_bf16 v[188:191], v[88:91], v[156:159], v[188:191]
    v_mfma_f32_16x16x32_bf16 v[192:195], v[110:113], v[156:159], v[192:195]
    s_waitcnt lgkmcnt(1)
    v_mfma_f32_16x16x32_bf16 v[176:179], v[252:255], a[248:251], v[176:179]
    ds_read_b128 v[252:255], v241 offset:61440
    v_mfma_f32_16x16x32_bf16 v[172:175], v[160:163], a[248:251], v[172:175]
    ds_read_b128 a[248:251], v239 offset:17408
    ds_read_b128 v[160:163], v241 offset:61952
    v_mfma_f32_16x16x32_bf16 v[220:223], a[168:171], v[248:251], v[220:223]
    v_rcp_f32 v197, v196
    v_mfma_f32_16x16x32_bf16 v[220:223], a[180:183], a[236:239], v[220:223]
    v_mul_f32 v184, v184, v197
    v_mul_f32 v185, v185, v197
    v_mfma_f32_16x16x32_bf16 v[216:219], a[172:175], v[248:251], v[216:219]
    v_cvt_pk_bf16_f32 v184, v184, v185
    v_mul_f32 v186, v186, v197
    v_mfma_f32_16x16x32_bf16 v[216:219], a[184:187], a[236:239], v[216:219]
    v_mul_f32 v187, v187, v197
    v_cvt_pk_bf16_f32 v185, v186, v187
    v_mfma_f32_16x16x32_bf16 v[212:215], a[176:179], v[248:251], v[212:215]
    v_mul_f32 v188, v188, v197
    v_mul_f32 v189, v189, v197
    v_mfma_f32_16x16x32_bf16 v[212:215], a[188:191], a[236:239], v[212:215]
    s_waitcnt vmcnt(0) lgkmcnt(1)
    v_cvt_pk_bf16_f32 v186, v188, v189
    v_mul_f32 v190, v190, v197
    v_mfma_f32_16x16x32_bf16 v[220:223], a[192:195], a[240:243], v[220:223]
    s_barrier
    ds_read_b128 v[164:167], v227 offset:6144
    ds_read_b128 v[168:171], v227 offset:6208
    v_mfma_f32_16x16x32_bf16 v[220:223], a[204:207], a[244:247], v[220:223]
    ds_read_b128 v[248:251], v227 offset:6272
    v_mul_f32 v191, v191, v197
    v_mfma_f32_16x16x32_bf16 v[216:219], a[196:199], a[240:243], v[216:219]
    ds_read_b128 a[236:239], v227 offset:6336
    v_cvt_pk_bf16_f32 v187, v190, v191
    v_mfma_f32_16x16x32_bf16 v[216:219], a[208:211], a[244:247], v[216:219]
    v_mul_f32 v192, v192, v197
    v_mul_f32 v193, v193, v197
    v_mfma_f32_16x16x32_bf16 v[212:215], a[200:203], a[240:243], v[212:215]
    v_mul_f32 v220, s37, v220
    v_mul_f32 v221, s37, v221
    v_mfma_f32_16x16x32_bf16 v[212:215], a[212:215], a[244:247], v[212:215]
    v_mul_f32 v222, s37, v222
    v_mul_f32 v223, s37, v223
    v_mfma_f32_16x16x32_bf16 v[208:211], v[252:255], a[248:251], v[208:211]
    v_cvt_pk_bf16_f32 v138, v220, v221
    v_cvt_pk_bf16_f32 v139, v222, v223
    v_mfma_f32_16x16x32_bf16 v[200:203], v[252:255], a[252:255], v[200:203]
    s_waitcnt lgkmcnt(4)
    v_mul_f32 v216, s37, v216
    v_mul_f32 v217, s37, v217
    v_mfma_f32_16x16x32_bf16 v[204:207], v[160:163], a[248:251], v[204:207]
    v_mul_f32 v218, s37, v218
    v_mul_f32 v219, s37, v219
    v_mfma_f32_16x16x32_bf16 v[180:183], v[160:163], a[252:255], v[180:183]
    s_waitcnt lgkmcnt(2)
    v_cvt_pk_bf16_f32 v140, v216, v217
    v_cvt_pk_bf16_f32 v141, v218, v219
    v_mfma_f32_16x16x32_bf16 v[220:223], a[0:3], v[164:167], 0
    v_mul_f32 v212, s37, v212
    v_mul_f32 v213, s37, v213
    v_mfma_f32_16x16x32_bf16 v[220:223], a[12:15], v[168:171], v[220:223]
    v_mul_f32 v214, s37, v214
    v_mul_f32 v215, s37, v215
    v_mfma_f32_16x16x32_bf16 v[152:155], v[24:27], v[138:141], v[152:155]
    v_cvt_pk_bf16_f32 v142, v212, v213
    v_cvt_pk_bf16_f32 v143, v214, v215
    v_mfma_f32_16x16x32_bf16 v[144:147], v[30:33], v[138:141], v[144:147]
    ds_read_b128 a[240:243], v227 offset:6400
    ds_read_b128 a[244:247], v227 offset:6464
    v_mfma_f32_16x16x32_bf16 v[148:151], v[36:39], v[138:141], v[148:151]
    ds_read_b128 v[252:255], v242 offset:61440
    v_cvt_pk_bf16_f32 v208, v208, v209
    v_mfma_f32_16x16x16_bf16 v[152:155], v[28:29], v[142:143], v[152:155]
    ds_read_b128 v[160:163], v242 offset:61952
    v_cvt_pk_bf16_f32 v209, v210, v211
    v_mfma_f32_16x16x16_bf16 v[144:147], v[34:35], v[142:143], v[144:147]
    v_cvt_pk_bf16_f32 v210, v204, v205
    v_cvt_pk_bf16_f32 v211, v206, v207
    v_mfma_f32_16x16x16_bf16 v[148:151], v[40:41], v[142:143], v[148:151]
    buffer_store_dwordx4 v[208:211], v243, s[20:23], s51 offen sc0 sc1
    v_mfma_f32_16x16x32_bf16 v[216:219], a[4:7], v[164:167], 0
    v_cvt_pk_bf16_f32 v200, v200, v201
    v_cvt_pk_bf16_f32 v201, v202, v203
    v_mfma_f32_16x16x32_bf16 v[216:219], a[16:19], v[168:171], v[216:219]
    v_cvt_pk_bf16_f32 v202, v180, v181
    v_cvt_pk_bf16_f32 v203, v182, v183
    v_mfma_f32_16x16x32_bf16 v[212:215], a[8:11], v[164:167], 0
    v_cvt_pk_bf16_f32 v188, v192, v193
    v_mul_f32 v194, v194, v197
    v_mfma_f32_16x16x32_bf16 v[212:215], a[20:23], v[168:171], v[212:215]
    s_waitcnt lgkmcnt(1)
    v_mul_f32 v195, v195, v197
    v_cvt_pk_bf16_f32 v189, v194, v195
    v_mfma_f32_16x16x32_bf16 v[176:179], v[252:255], a[248:251], v[176:179]
    s_waitcnt lgkmcnt(0)
    ds_read_b128 a[252:255], v240
    v_max3_f32 v236, v236, v196, v197
    v_mfma_f32_16x16x32_bf16 v[172:175], v[160:163], a[248:251], v[172:175]
    ds_write_b128 v237, v[184:187] offset:12288
    v_mfma_f32_16x16x32_bf16 v[220:223], a[24:27], v[248:251], v[220:223]
    ds_write_b64 v238, v[188:189] offset:12288
    v_mfma_f32_16x16x32_bf16 v[220:223], a[36:39], a[236:239], v[220:223]
    v_cndmask_b32 v227, v240, v239, vcc
    v_cvt_pk_bf16_f32 v176, v176, v177
    v_mfma_f32_16x16x32_bf16 v[216:219], a[28:31], v[248:251], v[216:219]
    v_cvt_pk_bf16_f32 v177, v178, v179
    v_cvt_pk_bf16_f32 v178, v172, v173
    v_mfma_f32_16x16x32_bf16 v[216:219], a[40:43], a[236:239], v[216:219]
    v_cvt_pk_bf16_f32 v179, v174, v175
    v_mfma_f32_16x16x32_bf16 v[212:215], a[32:35], v[248:251], v[212:215]
    buffer_store_dwordx4 v[200:203], v245, s[20:23], s51 offen sc0 sc1
    v_mfma_f32_16x16x32_bf16 v[212:215], a[44:47], a[236:239], v[212:215]
    ds_read_b128 a[248:251], v239
    ds_read_b128 v[252:255], v241 offset:12288
    v_mfma_f32_16x16x32_bf16 v[220:223], a[48:51], a[240:243], v[220:223]
    ds_read_b128 v[160:163], v241 offset:12800
    v_mfma_f32_16x16x32_bf16 v[220:223], a[60:63], a[244:247], v[220:223]
    v_exp_f32 v152, v152
    v_mfma_f32_16x16x32_bf16 v[216:219], a[52:55], a[240:243], v[216:219]
    v_exp_f32 v153, v153
    v_mfma_f32_16x16x32_bf16 v[216:219], a[64:67], a[244:247], v[216:219]
    v_exp_f32 v154, v154
    v_mfma_f32_16x16x32_bf16 v[212:215], a[56:59], a[240:243], v[212:215]
    v_exp_f32 v155, v155
    v_mfma_f32_16x16x32_bf16 v[212:215], a[68:71], a[244:247], v[212:215]
    s_waitcnt lgkmcnt(2)
    v_cvt_pk_bf16_f32 v54, v220, v221
    v_cvt_pk_bf16_f32 v55, v222, v223
    v_mfma_f32_16x16x32_bf16 v[208:211], a[220:223], a[248:251], 0
    v_cvt_pk_bf16_f32 v156, v152, v153
    v_cvt_pk_bf16_f32 v56, v216, v217
    v_mfma_f32_16x16x32_bf16 v[200:203], a[220:223], a[252:255], 0
    v_cvt_pk_bf16_f32 v57, v218, v219
    v_cvt_pk_bf16_f32 v157, v154, v155
    v_mfma_f32_16x16x32_bf16 v[204:207], a[224:227], a[248:251], 0
    v_cvt_pk_bf16_f32 v58, v212, v213
    v_cvt_pk_bf16_f32 v59, v214, v215
    v_mfma_f32_16x16x32_bf16 v[180:183], a[224:227], a[252:255], 0
    ds_read_b128 v[152:155], v230 offset:1920
    v_mfma_f32_16x16x32_bf16 v[172:175], a[232:235], a[248:251], 0
    buffer_store_dwordx4 v[176:179], v244, s[20:23], s51 offen sc0 sc1
    v_mfma_f32_16x16x32_bf16 v[220:223], v[164:167], a[72:75], 0
    s_add_u32 s51, s51, s48
    ds_read_b128 a[252:255], v240 offset:1024
    v_mfma_f32_16x16x32_bf16 v[220:223], v[168:171], a[84:87], v[220:223]
    v_exp_f32 v144, v144
    v_mfma_f32_16x16x32_bf16 v[176:179], a[228:231], a[248:251], 0
    ds_read_b128 a[248:251], v239 offset:1024
    v_mfma_f32_16x16x32_bf16 v[216:219], v[164:167], a[76:79], 0
    v_exp_f32 v145, v145
    v_mfma_f32_16x16x32_bf16 v[216:219], v[168:171], a[88:91], v[216:219]
    s_waitcnt lgkmcnt(2)
    v_exp_f32 v146, v146
    v_mfma_f32_16x16x32_bf16 v[152:155], v[42:45], v[138:141], v[152:155]
    v_exp_f32 v147, v147
    v_mfma_f32_16x16x32_bf16 v[212:215], v[164:167], a[80:83], 0
    ds_read_b128 v[164:167], v226 offset:1152
    v_cvt_pk_bf16_f32 v158, v144, v145
    v_mfma_f32_16x16x32_bf16 v[212:215], v[168:171], a[92:95], v[212:215]
    ds_read_b128 v[168:171], v226 offset:1216
    v_cvt_pk_bf16_f32 v159, v146, v147
    v_mfma_f32_16x16x16_bf16 v[152:155], v[46:47], v[142:143], v[152:155]
    ds_read_b128 v[144:147], v235
    v_bfe_u32 v235, s71, v233, 4
    v_mfma_f32_16x16x32_bf16 v[196:199], a[216:219], v[156:159], 0
    v_mad_u32_u24 v235, v235, s40, v231
    v_mfma_f32_16x16x32_bf16 v[184:187], v[68:71], v[156:159], 0
    v_exp_f32 v148, v148
    v_mfma_f32_16x16x32_bf16 v[188:191], v[90:93], v[156:159], 0
    v_exp_f32 v149, v149
    v_mfma_f32_16x16x32_bf16 v[192:195], v[112:115], v[156:159], 0
    v_exp_f32 v150, v150
    v_mfma_f32_16x16x32_bf16 v[220:223], v[248:251], a[96:99], v[220:223]
    v_exp_f32 v151, v151
    v_mfma_f32_16x16x32_bf16 v[220:223], a[236:239], a[108:111], v[220:223]
    v_cvt_pk_bf16_f32 v156, v148, v149
    v_cvt_pk_bf16_f32 v157, v150, v151
    v_mfma_f32_16x16x32_bf16 v[216:219], v[248:251], a[100:103], v[216:219]
    ds_read_b128 v[148:151], v234
    v_bfe_u32 v234, s69, v233, 4
    v_mfma_f32_16x16x32_bf16 v[216:219], a[236:239], a[112:115], v[216:219]
    s_waitcnt lgkmcnt(1)
    v_mad_u32_u24 v234, v234, s40, v231
    v_mfma_f32_16x16x32_bf16 v[144:147], v[48:51], v[138:141], v[144:147]
    v_exp_f32 v152, v152
    v_mfma_f32_16x16x32_bf16 v[212:215], v[248:251], a[104:107], v[212:215]
    ds_read_b128 v[248:251], v226 offset:1280
    v_mfma_f32_16x16x32_bf16 v[212:215], a[236:239], a[116:119], v[212:215]
    ds_read_b128 a[236:239], v226 offset:1344
    v_mfma_f32_16x16x32_bf16 v[220:223], a[240:243], a[120:123], v[220:223]
L_pg7:
    s_cbranch_execz L_back
    v_exp_f32 v153, v153
    v_mfma_f32_16x16x32_bf16 v[220:223], a[244:247], a[132:135], v[220:223]
    v_exp_f32 v154, v154
    v_mfma_f32_16x16x16_bf16 v[144:147], v[52:53], v[142:143], v[144:147]
    s_waitcnt lgkmcnt(2)
    v_exp_f32 v155, v155
    v_mfma_f32_16x16x32_bf16 v[148:151], v[54:57], v[138:141], v[148:151]
    v_cvt_pk_bf16_f32 v158, v152, v153
    v_cvt_pk_bf16_f32 v159, v154, v155
    v_mfma_f32_16x16x32_bf16 v[216:219], a[240:243], a[124:127], v[216:219]
    ds_read_b128 v[152:155], v235
    v_cvt_pk_bf16_f32 v84, v220, v221
    v_mfma_f32_16x16x32_bf16 v[216:219], a[244:247], a[136:139], v[216:219]
    v_cvt_pk_bf16_f32 v85, v222, v223
    v_bfe_u32 v235, s70, v233, 4
    v_mfma_f32_16x16x32_bf16 v[196:199], a[216:219], v[156:159], v[196:199]
    v_mad_u32_u24 v235, v235, s40, v231
    v_mfma_f32_16x16x32_bf16 v[184:187], v[76:79], v[156:159], v[184:187]
    v_exp_f32 v144, v144
    v_mfma_f32_16x16x32_bf16 v[188:191], v[98:101], v[156:159], v[188:191]
    v_exp_f32 v145, v145
    v_mfma_f32_16x16x32_bf16 v[192:195], v[120:123], v[156:159], v[192:195]
    v_cvt_pk_bf16_f32 v106, v216, v217
    v_cvt_pk_bf16_f32 v107, v218, v219
    v_mfma_f32_16x16x16_bf16 v[148:151], v[58:59], v[142:143], v[148:151]
    v_exp_f32 v146, v146
    v_mfma_f32_16x16x32_bf16 v[212:215], a[240:243], a[128:131], v[212:215]
    ds_read_b128 a[240:243], v226 offset:1408
    v_cvt_pk_bf16_f32 v156, v144, v145
    v_mfma_f32_16x16x32_bf16 v[212:215], a[244:247], a[140:143], v[212:215]
    s_waitcnt lgkmcnt(1)
    ds_read_b128 a[244:247], v226 offset:1472
    v_cndmask_b32 v226, v244, v247, vcc
    v_mfma_f32_16x16x32_bf16 v[152:155], v[60:63], v[138:141], v[152:155]
    v_cndmask_b32 v247, v247, v244, vcc
    v_mfma_f32_16x16x32_bf16 v[220:223], a[144:147], v[164:167], 0
    v_exp_f32 v147, v147
    v_mfma_f32_16x16x32_bf16 v[220:223], a[156:159], v[168:171], v[220:223]
    v_cvt_pk_bf16_f32 v157, v146, v147
    v_cvt_pk_bf16_f32 v128, v212, v213
    v_mfma_f32_16x16x16_bf16 v[152:155], v[64:65], v[142:143], v[152:155]
    ds_read_b128 v[144:147], v228 offset:640
    v_cvt_pk_bf16_f32 v129, v214, v215
    v_mfma_f32_16x16x16_bf16 v[196:199], a[216:217], v[156:157], v[196:199]
    v_exp_f32 v148, v148
    v_mfma_f32_16x16x16_bf16 v[184:187], v[82:83], v[156:157], v[184:187]
    v_exp_f32 v149, v149
    v_mfma_f32_16x16x16_bf16 v[188:191], v[104:105], v[156:157], v[188:191]
    v_exp_f32 v150, v150
    v_mfma_f32_16x16x16_bf16 v[192:195], v[126:127], v[156:157], v[192:195]
    v_exp_f32 v151, v151
    v_mfma_f32_16x16x32_bf16 v[216:219], a[148:151], v[164:167], 0
    v_cvt_pk_bf16_f32 v156, v148, v149
    v_cvt_pk_bf16_f32 v157, v150, v151
    v_mfma_f32_16x16x32_bf16 v[216:219], a[160:163], v[168:171], v[216:219]
    ds_read_b128 v[148:151], v229 offset:640
    v_mfma_f32_16x16x32_bf16 v[212:215], a[152:155], v[164:167], 0
    ds_read_b128 v[164:167], v224 offset:15488
    v_mfma_f32_16x16x32_bf16 v[212:215], a[164:167], v[168:171], v[212:215]
    ds_read_b128 v[168:171], v224 offset:15552
    v_mfma_f32_16x16x32_bf16 v[220:223], a[168:171], v[248:251], v[220:223]
    v_exp_f32 v152, v152
    v_mfma_f32_16x16x32_bf16 v[220:223], a[180:183], a[236:239], v[220:223]
    v_exp_f32 v153, v153
    v_mfma_f32_16x16x32_bf16 v[216:219], a[172:175], v[248:251], v[216:219]
    v_exp_f32 v154, v154
    v_mfma_f32_16x16x32_bf16 v[216:219], a[184:187], a[236:239], v[216:219]
    v_exp_f32 v155, v155
    v_mfma_f32_16x16x32_bf16 v[212:215], a[176:179], v[248:251], v[212:215]
    ds_read_b128 v[248:251], v224 offset:15616
    v_cvt_pk_bf16_f32 v158, v152, v153
    v_mfma_f32_16x16x32_bf16 v[212:215], a[188:191], a[236:239], v[212:215]
    s_waitcnt lgkmcnt(4)
    ds_read_b128 a[236:239], v224 offset:15680
    v_cvt_pk_bf16_f32 v159, v154, v155
    v_mfma_f32_16x16x32_bf16 v[220:223], a[192:195], a[240:243], v[220:223]
    ds_read_b128 v[152:155], v229 offset:1280
    v_mfma_f32_16x16x32_bf16 v[220:223], a[204:207], a[244:247], v[220:223]
    v_mfma_f32_16x16x32_bf16 v[196:199], a[216:219], v[156:159], v[196:199]
    v_mfma_f32_16x16x32_bf16 v[184:187], v[84:87], v[156:159], v[184:187]
    v_mfma_f32_16x16x32_bf16 v[188:191], v[106:109], v[156:159], v[188:191]
    v_mfma_f32_16x16x32_bf16 v[192:195], v[128:131], v[156:159], v[192:195]
    v_mfma_f32_16x16x32_bf16 v[216:219], a[196:199], a[240:243], v[216:219]
    v_mfma_f32_16x16x32_bf16 v[216:219], a[208:211], a[244:247], v[216:219]
    v_mfma_f32_16x16x32_bf16 v[212:215], a[200:203], a[240:243], v[212:215]
    ds_read_b128 a[240:243], v224 offset:15744
    v_mul_f32 v220, s37, v220
    v_mfma_f32_16x16x32_bf16 v[212:215], a[212:215], a[244:247], v[212:215]
    v_mul_f32 v221, s37, v221
    v_mul_f32 v222, s37, v222
    v_mfma_f32_16x16x32_bf16 v[208:211], v[252:255], a[248:251], v[208:211]
    v_mul_f32 v223, s37, v223
    v_cvt_pk_bf16_f32 v132, v220, v221
    v_mfma_f32_16x16x32_bf16 v[200:203], v[252:255], a[252:255], v[200:203]
    v_cvt_pk_bf16_f32 v133, v222, v223
    v_mul_f32 v216, s37, v216
    v_mfma_f32_16x16x32_bf16 v[204:207], v[160:163], a[248:251], v[204:207]
    v_mul_f32 v217, s37, v217
    v_mul_f32 v218, s37, v218
    v_mfma_f32_16x16x32_bf16 v[180:183], v[160:163], a[252:255], v[180:183]
    s_waitcnt lgkmcnt(1)
    v_mul_f32 v219, s37, v219
    v_cvt_pk_bf16_f32 v134, v216, v217
    v_mfma_f32_16x16x32_bf16 v[220:223], a[0:3], v[164:167], 0
    v_cvt_pk_bf16_f32 v135, v218, v219
    v_mul_f32 v212, s37, v212
    v_mfma_f32_16x16x32_bf16 v[220:223], a[12:15], v[168:171], v[220:223]
    v_mul_f32 v213, s37, v213
    v_mul_f32 v214, s37, v214
    v_mfma_f32_16x16x32_bf16 v[144:147], v[12:15], v[132:135], v[144:147]
    v_mul_f32 v215, s37, v215
    v_cvt_pk_bf16_f32 v136, v212, v213
    v_mfma_f32_16x16x32_bf16 v[148:151], v[36:39], v[132:135], v[148:151]
    ds_read_b128 a[244:247], v224 offset:15808
    v_cvt_pk_bf16_f32 v137, v214, v215
    v_mfma_f32_16x16x32_bf16 v[152:155], v[42:45], v[132:135], v[152:155]
    v_rcp_f32 v197, v196
    v_mfma_f32_16x16x16_bf16 v[144:147], v[16:17], v[136:137], v[144:147]
    v_mul_f32 v184, v184, v197
    v_mul_f32 v185, v185, v197
    v_mfma_f32_16x16x16_bf16 v[148:151], v[40:41], v[136:137], v[148:151]
    v_cvt_pk_bf16_f32 v184, v184, v185
    v_mul_f32 v186, v186, v197
    v_mfma_f32_16x16x16_bf16 v[152:155], v[46:47], v[136:137], v[152:155]
    v_mul_f32 v187, v187, v197
    v_cvt_pk_bf16_f32 v185, v186, v187
    v_mfma_f32_16x16x32_bf16 v[216:219], a[4:7], v[164:167], 0
    v_mul_f32 v188, v188, v197
    v_mul_f32 v189, v189, v197
    v_mfma_f32_16x16x32_bf16 v[216:219], a[16:19], v[168:171], v[216:219]
    v_cvt_pk_bf16_f32 v186, v188, v189
    v_mul_f32 v190, v190, v197
    v_mfma_f32_16x16x32_bf16 v[212:215], a[8:11], v[164:167], 0
    v_mul_f32 v191, v191, v197
    v_cvt_pk_bf16_f32 v187, v190, v191
    v_mfma_f32_16x16x32_bf16 v[212:215], a[20:23], v[168:171], v[212:215]
    v_mul_f32 v192, v192, v197
    v_mul_f32 v193, v193, v197
    v_mfma_f32_16x16x32_bf16 v[220:223], a[24:27], v[248:251], v[220:223]
    v_cvt_pk_bf16_f32 v188, v192, v193
    v_mul_f32 v194, v194, v197
    v_mfma_f32_16x16x32_bf16 v[220:223], a[36:39], a[236:239], v[220:223]
    v_mul_f32 v195, v195, v197
    v_cvt_pk_bf16_f32 v189, v194, v195
    v_mfma_f32_16x16x32_bf16 v[216:219], a[28:31], v[248:251], v[216:219]
    ds_read_b128 v[252:255], v242 offset:12288
    v_max3_f32 v236, v236, v196, v197
    v_mfma_f32_16x16x32_bf16 v[216:219], a[40:43], a[236:239], v[216:219]
    ds_write_b128 v237, v[184:187] offset:18432
    v_mfma_f32_16x16x32_bf16 v[212:215], a[32:35], v[248:251], v[212:215]
    ds_write_b64 v238, v[188:189] offset:18432
    v_mfma_f32_16x16x32_bf16 v[212:215], a[44:47], a[236:239], v[212:215]
    s_waitcnt lgkmcnt(3)
    v_exp_f32 v144, v144
    v_mfma_f32_16x16x32_bf16 v[220:223], a[48:51], a[240:243], v[220:223]
    v_exp_f32 v145, v145
    v_mfma_f32_16x16x32_bf16 v[220:223], a[60:63], a[244:247], v[220:223]
    s_waitcnt lgkmcnt(2)
    v_exp_f32 v146, v146
    v_mfma_f32_16x16x32_bf16 v[176:179], v[252:255], a[248:251], v[176:179]
    ds_read_b128 v[160:163], v242 offset:12800
    ds_read_b128 a[252:255], v240 offset:2048
    v_mfma_f32_16x16x32_bf16 v[216:219], a[52:55], a[240:243], v[216:219]
    ds_read_b128 v[252:255], v241 offset:24576
    v_cvt_pk_bf16_f32 v156, v144, v145
    v_mfma_f32_16x16x32_bf16 v[216:219], a[64:67], a[244:247], v[216:219]
    v_cvt_pk_bf16_f32 v6, v220, v221
    v_cvt_pk_bf16_f32 v7, v222, v223
    v_mfma_f32_16x16x32_bf16 v[212:215], a[56:59], a[240:243], v[212:215]
    v_exp_f32 v147, v147
    v_mfma_f32_16x16x32_bf16 v[212:215], a[68:71], a[244:247], v[212:215]
    v_cvt_pk_bf16_f32 v157, v146, v147
    v_mfma_f32_16x16x32_bf16 v[220:223], v[164:167], a[72:75], 0
    ds_read_b128 v[144:147], v228 offset:1280
    v_cvt_pk_bf16_f32 v8, v216, v217
    v_mfma_f32_16x16x32_bf16 v[220:223], v[168:171], a[84:87], v[220:223]
    s_waitcnt lgkmcnt(3)
    v_cvt_pk_bf16_f32 v9, v218, v219
    v_mfma_f32_16x16x32_bf16 v[172:175], v[160:163], a[248:251], v[172:175]
    ds_read_b128 a[248:251], v239 offset:2048
    v_cvt_pk_bf16_f32 v10, v212, v213
    v_mfma_f32_16x16x32_bf16 v[216:219], v[164:167], a[76:79], 0
    ds_read_b128 v[160:163], v241 offset:25088
    v_cvt_pk_bf16_f32 v11, v214, v215
    v_mfma_f32_16x16x32_bf16 v[216:219], v[168:171], a[88:91], v[216:219]
    s_waitcnt lgkmcnt(3)
    v_exp_f32 v148, v148
    v_mfma_f32_16x16x32_bf16 v[200:203], v[252:255], a[252:255], v[200:203]
    v_exp_f32 v149, v149
    v_mfma_f32_16x16x32_bf16 v[212:215], v[164:167], a[80:83], 0
    ds_read_b128 v[164:167], v224 offset:18560
    v_cvt_pk_bf16_f32 v158, v148, v149
    v_mfma_f32_16x16x32_bf16 v[212:215], v[168:171], a[92:95], v[212:215]
    s_waitcnt lgkmcnt(3)
    ds_read_b128 v[168:171], v224 offset:18624
    v_mfma_f32_16x16x32_bf16 v[144:147], v[18:21], v[132:135], v[144:147]
    s_waitcnt lgkmcnt(3)
    v_exp_f32 v150, v150
    v_mfma_f32_16x16x32_bf16 v[208:211], v[252:255], a[248:251], v[208:211]
    s_waitcnt lgkmcnt(2)
    ds_read_b128 v[252:255], v242 offset:24576
    v_mfma_f32_16x16x32_bf16 v[204:207], v[160:163], a[248:251], v[204:207]
    v_exp_f32 v151, v151
    v_mfma_f32_16x16x32_bf16 v[180:183], v[160:163], a[252:255], v[180:183]
    ds_read_b128 v[160:163], v242 offset:25088
    ds_read_b128 a[252:255], v240 offset:3072
    v_mfma_f32_16x16x16_bf16 v[144:147], v[22:23], v[136:137], v[144:147]
    v_cvt_pk_bf16_f32 v159, v150, v151
    v_mfma_f32_16x16x32_bf16 v[220:223], v[248:251], a[96:99], v[220:223]
    ds_read_b128 v[148:151], v228 offset:1920
    v_mfma_f32_16x16x32_bf16 v[220:223], a[236:239], a[108:111], v[220:223]
    v_exp_f32 v152, v152
    v_mfma_f32_16x16x32_bf16 v[196:199], a[216:219], v[156:159], 0
    v_exp_f32 v153, v153
    v_mfma_f32_16x16x32_bf16 v[184:187], v[74:77], v[156:159], 0
    v_exp_f32 v154, v154
    v_mfma_f32_16x16x32_bf16 v[188:191], v[96:99], v[156:159], 0
    v_exp_f32 v155, v155
    v_mfma_f32_16x16x32_bf16 v[192:195], v[118:121], v[156:159], 0
    s_waitcnt lgkmcnt(3)
    v_cvt_pk_bf16_f32 v156, v152, v153
    v_cvt_pk_bf16_f32 v157, v154, v155
    v_mfma_f32_16x16x32_bf16 v[176:179], v[252:255], a[248:251], v[176:179]
    s_waitcnt lgkmcnt(2)
    ds_read_b128 v[252:255], v241 offset:36864
    ds_read_b128 v[152:155], v229 offset:1920
    v_mfma_f32_16x16x32_bf16 v[172:175], v[160:163], a[248:251], v[172:175]
    s_waitcnt lgkmcnt(2)
    v_exp_f32 v144, v144
    v_mfma_f32_16x16x32_bf16 v[148:151], v[0:3], v[132:135], v[148:151]
    ds_read_b128 a[248:251], v239 offset:3072
    v_mfma_f32_16x16x32_bf16 v[216:219], v[248:251], a[100:103], v[216:219]
    ds_read_b128 v[160:163], v241 offset:37376
    v_mfma_f32_16x16x32_bf16 v[216:219], a[236:239], a[112:115], v[216:219]
    v_exp_f32 v145, v145
    v_mfma_f32_16x16x32_bf16 v[212:215], v[248:251], a[104:107], v[212:215]
    ds_read_b128 v[248:251], v224 offset:18688
    v_cvt_pk_bf16_f32 v158, v144, v145
    v_mfma_f32_16x16x32_bf16 v[212:215], a[236:239], a[116:119], v[212:215]
    ds_read_b128 a[236:239], v224 offset:18752
    v_mfma_f32_16x16x16_bf16 v[148:151], v[4:5], v[136:137], v[148:151]
    v_mov_b32 v5, s25
    v_mfma_f32_16x16x32_bf16 v[220:223], a[240:243], a[120:123], v[220:223]
    v_exp_f32 v146, v146
    v_mfma_f32_16x16x32_bf16 v[220:223], a[244:247], a[132:135], v[220:223]
    s_waitcnt lgkmcnt(4)
    v_exp_f32 v147, v147
    v_mfma_f32_16x16x32_bf16 v[152:155], v[24:27], v[132:135], v[152:155]
    v_cvt_pk_bf16_f32 v159, v146, v147
    v_mfma_f32_16x16x32_bf16 v[216:219], a[240:243], a[124:127], v[216:219]
    ds_read_b128 v[144:147], v229 offset:2560
    v_mfma_f32_16x16x32_bf16 v[216:219], a[244:247], a[136:139], v[216:219]
    v_exp_f32 v148, v148
    v_mfma_f32_16x16x32_bf16 v[196:199], a[216:219], v[156:159], v[196:199]
    v_cvt_pk_bf16_f32 v72, v220, v221
    v_cvt_pk_bf16_f32 v73, v222, v223
    v_mfma_f32_16x16x32_bf16 v[184:187], v[78:81], v[156:159], v[184:187]
    v_exp_f32 v149, v149
    v_mfma_f32_16x16x32_bf16 v[188:191], v[100:103], v[156:159], v[188:191]
    v_exp_f32 v150, v150
    v_mfma_f32_16x16x32_bf16 v[192:195], v[122:125], v[156:159], v[192:195]
    v_cvt_pk_bf16_f32 v94, v216, v217
    v_cvt_pk_bf16_f32 v95, v218, v219
    v_mfma_f32_16x16x16_bf16 v[152:155], v[28:29], v[136:137], v[152:155]
    v_exp_f32 v151, v151
    v_mfma_f32_16x16x32_bf16 v[212:215], a[240:243], a[128:131], v[212:215]
    ds_read_b128 a[240:243], v224 offset:18816
    v_cvt_pk_bf16_f32 v156, v148, v149
    v_mfma_f32_16x16x32_bf16 v[212:215], a[244:247], a[140:143], v[212:215]
    s_waitcnt lgkmcnt(2)
    ds_read_b128 a[244:247], v224 offset:18880
    v_cndmask_b32 v224, v239, v240, vcc
    v_mfma_f32_16x16x32_bf16 v[208:211], v[252:255], a[248:251], v[208:211]
    v_cvt_pk_bf16_f32 v157, v150, v151
    v_mfma_f32_16x16x32_bf16 v[200:203], v[252:255], a[252:255], v[200:203]
    ds_read_b128 v[252:255], v242 offset:36864
    ds_read_b128 v[148:151], v228 offset:2560
    v_mfma_f32_16x16x32_bf16 v[204:207], v[160:163], a[248:251], v[204:207]
    v_cvt_pk_bf16_f32 v116, v212, v213
    v_cvt_pk_bf16_f32 v117, v214, v215
    v_mfma_f32_16x16x32_bf16 v[180:183], v[160:163], a[252:255], v[180:183]
    ds_read_b128 v[160:163], v242 offset:37376
    v_mfma_f32_16x16x32_bf16 v[220:223], a[0:3], v[164:167], 0
    ds_read_b128 a[0:3], v241 offset:12288
    v_mfma_f32_16x16x32_bf16 v[220:223], a[12:15], v[168:171], v[220:223]
    ds_read_b128 a[12:15], v242 offset:12800
    v_mfma_f32_16x16x32_bf16 v[216:219], a[4:7], v[164:167], 0
    ds_read_b128 a[4:7], v241 offset:12800
    v_mfma_f32_16x16x32_bf16 v[216:219], a[16:19], v[168:171], v[216:219]
    s_waitcnt lgkmcnt(5)
    ds_read_b128 a[16:19], v241 offset:24576
    v_mfma_f32_16x16x32_bf16 v[176:179], v[252:255], a[248:251], v[176:179]
    ds_read_b128 a[252:255], v240 offset:4096
    v_mfma_f32_16x16x32_bf16 v[212:215], a[8:11], v[164:167], 0
    ds_read_b128 a[8:11], v242 offset:12288
    v_mfma_f32_16x16x32_bf16 v[212:215], a[20:23], v[168:171], v[212:215]
    s_waitcnt lgkmcnt(7)
    ds_read_b128 a[20:23], v241 offset:25088
    v_mfma_f32_16x16x32_bf16 v[148:151], v[6:9], v[132:135], v[148:151]
    s_waitcnt lgkmcnt(7)
    ds_read_b128 v[252:255], v242 offset:61440
    v_mov_b32 v6, 0x27e00
    v_mfma_f32_16x16x32_bf16 v[172:175], v[160:163], a[248:251], v[172:175]
    ds_read_b128 a[248:251], v239 offset:4096
    v_mfma_f32_16x16x32_bf16 v[220:223], a[24:27], v[248:251], v[220:223]
    ds_read_b128 a[24:27], v242 offset:24576
    v_mfma_f32_16x16x32_bf16 v[220:223], a[36:39], a[236:239], v[220:223]
    ds_read_b128 a[36:39], v241 offset:37376
    v_mfma_f32_16x16x16_bf16 v[148:151], v[10:11], v[136:137], v[148:151]
    ds_read_b128 v[160:163], v242 offset:61952
    v_mfma_f32_16x16x32_bf16 v[216:219], a[28:31], v[248:251], v[216:219]
    ds_read_b128 a[28:31], v242 offset:25088
    v_mfma_f32_16x16x32_bf16 v[216:219], a[40:43], a[236:239], v[216:219]
    ds_read_b128 a[40:43], v242 offset:36864
    v_mfma_f32_16x16x32_bf16 v[212:215], a[32:35], v[248:251], v[212:215]
    ds_read_b128 a[32:35], v241 offset:36864
    v_mfma_f32_16x16x32_bf16 v[212:215], a[44:47], a[236:239], v[212:215]
    ds_read_b128 a[44:47], v242 offset:37376
    v_mfma_f32_16x16x32_bf16 v[220:223], a[48:51], a[240:243], v[220:223]
    ds_read_b128 a[48:51], v241 offset:49152
    v_mfma_f32_16x16x32_bf16 v[220:223], a[60:63], a[244:247], v[220:223]
    ds_read_b128 a[60:63], v242 offset:49664
    v_mfma_f32_16x16x32_bf16 v[216:219], a[52:55], a[240:243], v[216:219]
    ds_read_b128 a[52:55], v241 offset:49664
    v_mfma_f32_16x16x32_bf16 v[216:219], a[64:67], a[244:247], v[216:219]
    ds_read_b128 a[64:67], v241 offset:61440
    v_mfma_f32_16x16x32_bf16 v[212:215], a[56:59], a[240:243], v[212:215]
    ds_read_b128 a[56:59], v242 offset:49152
    v_mfma_f32_16x16x32_bf16 v[212:215], a[68:71], a[244:247], v[212:215]
    v_cvt_pk_bf16_f32 v30, v220, v221
    v_cvt_pk_bf16_f32 v31, v222, v223
    v_mfma_f32_16x16x32_bf16 v[220:223], v[164:167], a[72:75], 0
    ds_read_b128 a[68:71], v241 offset:61952
    v_cvt_pk_bf16_f32 v32, v216, v217
    v_mfma_f32_16x16x32_bf16 v[220:223], v[168:171], a[84:87], v[220:223]
    s_waitcnt lgkmcnt(5)
    v_cvt_pk_bf16_f32 v33, v218, v219
    v_mfma_f32_16x16x32_bf16 v[208:211], a[48:51], a[248:251], v[208:211]
    v_cvt_pk_bf16_f32 v34, v212, v213
    v_cvt_pk_bf16_f32 v35, v214, v215
    v_mfma_f32_16x16x32_bf16 v[144:147], v[30:33], v[132:135], v[144:147]
    v_exp_f32 v152, v152
    v_mfma_f32_16x16x32_bf16 v[200:203], a[48:51], a[252:255], v[200:203]
    s_waitcnt lgkmcnt(3)
    v_exp_f32 v153, v153
    v_mfma_f32_16x16x32_bf16 v[204:207], a[52:55], a[248:251], v[204:207]
    v_exp_f32 v154, v154
    v_mfma_f32_16x16x32_bf16 v[180:183], a[52:55], a[252:255], v[180:183]
    ds_read_b128 a[252:255], v240 offset:5120
    v_cvt_pk_bf16_f32 v158, v152, v153
    v_mfma_f32_16x16x16_bf16 v[144:147], v[34:35], v[136:137], v[144:147]
    s_waitcnt lgkmcnt(2)
    v_exp_f32 v155, v155
    v_mfma_f32_16x16x32_bf16 v[176:179], a[56:59], a[248:251], v[176:179]
    v_cvt_pk_bf16_f32 v159, v154, v155
    v_mfma_f32_16x16x32_bf16 v[172:175], a[60:63], a[248:251], v[172:175]
    ds_read_b128 a[248:251], v239 offset:5120
    ds_read_b128 v[152:155], v230 offset:640
    v_mfma_f32_16x16x32_bf16 v[196:199], a[216:219], v[156:159], v[196:199]
    v_exp_f32 v148, v148
    v_mfma_f32_16x16x32_bf16 v[184:187], v[66:69], v[156:159], v[184:187]
    v_exp_f32 v144, v144
    v_mfma_f32_16x16x32_bf16 v[188:191], v[88:91], v[156:159], v[188:191]
    v_exp_f32 v145, v145
    v_mfma_f32_16x16x32_bf16 v[192:195], v[110:113], v[156:159], v[192:195]
    v_exp_f32 v146, v146
    v_mfma_f32_16x16x32_bf16 v[216:219], v[164:167], a[76:79], 0
    v_exp_f32 v147, v147
    v_mfma_f32_16x16x32_bf16 v[216:219], v[168:171], a[88:91], v[216:219]
    s_waitcnt lgkmcnt(1)
    v_cvt_pk_bf16_f32 v156, v144, v145
    v_cvt_pk_bf16_f32 v157, v146, v147
    v_mfma_f32_16x16x32_bf16 v[212:215], v[164:167], a[80:83], 0
    s_barrier
    ds_read_b128 v[164:167], v232 offset:4224
    ds_read_b128 v[144:147], v230 offset:1280
    v_mfma_f32_16x16x32_bf16 v[212:215], v[168:171], a[92:95], v[212:215]
    v_exp_f32 v149, v149
    v_mfma_f32_16x16x32_bf16 v[220:223], v[248:251], a[96:99], v[220:223]
    ds_read_b128 v[168:171], v232 offset:4288
    v_cvt_pk_bf16_f32 v158, v148, v149
    v_mfma_f32_16x16x32_bf16 v[220:223], a[236:239], a[108:111], v[220:223]
    v_exp_f32 v150, v150
    v_mfma_f32_16x16x32_bf16 v[216:219], v[248:251], a[100:103], v[216:219]
    v_exp_f32 v151, v151
    v_mfma_f32_16x16x32_bf16 v[216:219], a[236:239], a[112:115], v[216:219]
    v_cvt_pk_bf16_f32 v159, v150, v151
    v_mfma_f32_16x16x32_bf16 v[212:215], v[248:251], a[104:107], v[212:215]
    ds_read_b128 v[248:251], v232 offset:4352
    ds_read_b128 v[148:151], v230 offset:1920
    v_mfma_f32_16x16x32_bf16 v[212:215], a[236:239], a[116:119], v[212:215]
    v_mfma_f32_16x16x32_bf16 v[196:199], a[216:219], v[156:159], v[196:199]
    ds_read_b128 a[236:239], v232 offset:4416
    v_mfma_f32_16x16x32_bf16 v[220:223], a[240:243], a[120:123], v[220:223]
    v_mfma_f32_16x16x32_bf16 v[220:223], a[244:247], a[132:135], v[220:223]
    v_mfma_f32_16x16x32_bf16 v[216:219], a[240:243], a[124:127], v[216:219]
    v_mfma_f32_16x16x32_bf16 v[216:219], a[244:247], a[136:139], v[216:219]
    v_mfma_f32_16x16x32_bf16 v[212:215], a[240:243], a[128:131], v[212:215]
    ds_read_b128 a[240:243], v232 offset:4480
    v_mfma_f32_16x16x32_bf16 v[212:215], a[244:247], a[140:143], v[212:215]
    ds_read_b128 a[244:247], v232 offset:4544
    v_mfma_f32_16x16x32_bf16 v[208:211], a[64:67], a[248:251], v[208:211]
    v_rcp_f32 v197, v196
    v_mfma_f32_16x16x32_bf16 v[200:203], a[64:67], a[252:255], v[200:203]
    v_cvt_pk_bf16_f32 v70, v220, v221
    v_cvt_pk_bf16_f32 v71, v222, v223
    v_mfma_f32_16x16x32_bf16 v[204:207], a[68:71], a[248:251], v[204:207]
    v_cvt_pk_bf16_f32 v92, v216, v217
    v_cvt_pk_bf16_f32 v93, v218, v219
    v_mfma_f32_16x16x32_bf16 v[184:187], v[70:73], v[156:159], v[184:187]
    v_cvt_pk_bf16_f32 v114, v212, v213
    v_cvt_pk_bf16_f32 v115, v214, v215
    v_mfma_f32_16x16x32_bf16 v[188:191], v[92:95], v[156:159], v[188:191]
    v_cvt_pk_bf16_f32 v208, v208, v209
    v_cvt_pk_bf16_f32 v209, v210, v211
    v_mfma_f32_16x16x32_bf16 v[192:195], v[114:117], v[156:159], v[192:195]
    v_cvt_pk_bf16_f32 v210, v204, v205
    v_cvt_pk_bf16_f32 v211, v206, v207
    v_mfma_f32_16x16x32_bf16 v[180:183], a[68:71], a[252:255], v[180:183]
    buffer_store_dwordx4 v[208:211], v243, s[20:23], s51 offen sc0 sc1
    v_mfma_f32_16x16x32_bf16 v[176:179], v[252:255], a[248:251], v[176:179]
    v_cvt_pk_bf16_f32 v200, v200, v201
    v_cvt_pk_bf16_f32 v201, v202, v203
    v_mfma_f32_16x16x32_bf16 v[172:175], v[160:163], a[248:251], v[172:175]
    s_waitcnt lgkmcnt(0)
    v_mul_f32 v184, v184, v197
    v_mul_f32 v185, v185, v197
    v_mfma_f32_16x16x32_bf16 v[220:223], a[144:147], v[164:167], 0
    v_cvt_pk_bf16_f32 v202, v180, v181
    v_cvt_pk_bf16_f32 v203, v182, v183
    v_mfma_f32_16x16x32_bf16 v[220:223], a[156:159], v[168:171], v[220:223]
    v_cvt_pk_bf16_f32 v176, v176, v177
    v_cvt_pk_bf16_f32 v177, v178, v179
    v_mfma_f32_16x16x32_bf16 v[216:219], a[148:151], v[164:167], 0
    v_cvt_pk_bf16_f32 v178, v172, v173
    v_cvt_pk_bf16_f32 v179, v174, v175
    v_mfma_f32_16x16x32_bf16 v[216:219], a[160:163], v[168:171], v[216:219]
    v_cvt_pk_bf16_f32 v184, v184, v185
    v_mul_f32 v186, v186, v197
    v_mfma_f32_16x16x32_bf16 v[212:215], a[152:155], v[164:167], 0
    v_mul_f32 v187, v187, v197
    v_cvt_pk_bf16_f32 v185, v186, v187
    v_mfma_f32_16x16x32_bf16 v[212:215], a[164:167], v[168:171], v[212:215]
    v_mul_f32 v188, v188, v197
    v_mul_f32 v189, v189, v197
    v_mfma_f32_16x16x32_bf16 v[220:223], a[168:171], v[248:251], v[220:223]
    v_cvt_pk_bf16_f32 v186, v188, v189
    v_mul_f32 v190, v190, v197
    v_mfma_f32_16x16x32_bf16 v[220:223], a[180:183], a[236:239], v[220:223]
    v_mul_f32 v191, v191, v197
    v_cvt_pk_bf16_f32 v187, v190, v191
    v_mfma_f32_16x16x32_bf16 v[216:219], a[172:175], v[248:251], v[216:219]
    v_mul_f32 v192, v192, v197
    v_mul_f32 v193, v193, v197
    v_mfma_f32_16x16x32_bf16 v[216:219], a[184:187], a[236:239], v[216:219]
    buffer_store_dwordx4 v[200:203], v245, s[20:23], s51 offen sc0 sc1
    v_mfma_f32_16x16x32_bf16 v[212:215], a[176:179], v[248:251], v[212:215]
    v_cvt_pk_bf16_f32 v188, v192, v193
    v_mul_f32 v194, v194, v197
    v_mfma_f32_16x16x32_bf16 v[212:215], a[188:191], a[236:239], v[212:215]
    v_mul_f32 v195, v195, v197
    v_cvt_pk_bf16_f32 v189, v194, v195
    v_mfma_f32_16x16x32_bf16 v[220:223], a[192:195], a[240:243], v[220:223]
    ds_read_b128 a[248:251], v239 offset:12288
    v_max3_f32 v236, v236, v196, v197
    v_mfma_f32_16x16x32_bf16 v[220:223], a[204:207], a[244:247], v[220:223]
    ds_write_b128 v237, v[184:187]
    v_mfma_f32_16x16x32_bf16 v[216:219], a[196:199], a[240:243], v[216:219]
    ds_write_b64 v238, v[188:189]
    v_mfma_f32_16x16x32_bf16 v[216:219], a[208:211], a[244:247], v[216:219]
    v_mfma_f32_16x16x32_bf16 v[212:215], a[200:203], a[240:243], v[212:215]
    v_mfma_f32_16x16x32_bf16 v[212:215], a[212:215], a[244:247], v[212:215]
    s_waitcnt lgkmcnt(2)
    v_mfma_f32_16x16x32_bf16 v[204:207], a[228:231], a[248:251], 0
    ds_read_b128 a[252:255], v240 offset:12288
    v_mul_f32 v220, s37, v220
    v_mfma_f32_16x16x32_bf16 v[200:203], a[232:235], a[248:251], 0
    v_mul_f32 v221, s37, v221
    v_mul_f32 v222, s37, v222
    v_mul_f32 v223, s37, v223
    v_cvt_pk_bf16_f32 v138, v220, v221
    v_cvt_pk_bf16_f32 v139, v222, v223
    v_mfma_f32_16x16x32_bf16 v[220:223], a[220:223], a[248:251], 0
    v_mul_f32 v216, s37, v216
    v_mul_f32 v217, s37, v217
    v_mul_f32 v218, s37, v218
    v_mul_f32 v219, s37, v219
    v_cvt_pk_bf16_f32 v140, v216, v217
    v_cvt_pk_bf16_f32 v141, v218, v219
    v_mfma_f32_16x16x32_bf16 v[216:219], a[224:227], a[248:251], 0
    s_waitcnt lgkmcnt(1)
    v_mul_f32 v212, s37, v212
    v_mul_f32 v213, s37, v213
    v_mfma_f32_16x16x32_bf16 v[152:155], v[36:39], v[138:141], v[152:155]
    s_barrier
    v_mul_f32 v214, s37, v214
    v_mul_f32 v215, s37, v215
    v_mfma_f32_16x16x32_bf16 v[144:147], v[42:45], v[138:141], v[144:147]
    v_cvt_pk_bf16_f32 v142, v212, v213
    v_cvt_pk_bf16_f32 v143, v214, v215
    v_mfma_f32_16x16x32_bf16 v[148:151], v[24:27], v[138:141], v[148:151]
    buffer_store_dwordx4 v[176:179], v244, s[20:23], s51 offen sc0 sc1
    v_mfma_f32_16x16x16_bf16 v[152:155], v[40:41], v[142:143], v[152:155]
    s_add_u32 s51, s51, s48
    ds_read_b128 a[236:239], v239 offset:13312
    ds_read_b128 a[240:243], v240 offset:13312
    v_mfma_f32_16x16x16_bf16 v[144:147], v[46:47], v[142:143], v[144:147]
    ds_read_b128 a[244:247], v239 offset:14336
    v_mfma_f32_16x16x16_bf16 v[148:151], v[28:29], v[142:143], v[148:151]
    s_waitcnt lgkmcnt(3)
    ds_read_b128 v[164:167], v240 offset:14336
    v_mfma_f32_16x16x32_bf16 v[212:215], a[220:223], a[252:255], 0
    ds_read_b128 v[168:171], v239 offset:15360
    v_mfma_f32_16x16x32_bf16 v[208:211], a[224:227], a[252:255], 0
    s_waitcnt lgkmcnt(4)
    ds_read_b128 v[248:251], v240 offset:15360
    v_exp_f32 v152, v152
    v_exp_f32 v153, v153
    ds_read_b128 a[248:251], v239 offset:16384
    ds_read_b128 a[252:255], v240 offset:16384
    v_exp_f32 v154, v154
    v_mfma_f32_16x16x32_bf16 v[220:223], a[0:3], a[236:239], v[220:223]
    s_waitcnt lgkmcnt(6)
    ds_read_b128 v[252:255], v242 offset:61440
    v_cvt_pk_bf16_f32 v156, v152, v153
    v_mfma_f32_16x16x32_bf16 v[212:215], a[0:3], a[240:243], v[212:215]
    ds_read_b128 v[160:163], v242 offset:61952
    v_mfma_f32_16x16x32_bf16 v[216:219], a[4:7], a[236:239], v[216:219]
    v_exp_f32 v155, v155
    v_mfma_f32_16x16x32_bf16 v[208:211], a[4:7], a[240:243], v[208:211]
    ds_read_b128 a[240:243], v240 offset:17408
    v_cvt_pk_bf16_f32 v157, v154, v155
    v_mfma_f32_16x16x32_bf16 v[204:207], a[8:11], a[236:239], v[204:207]
    ds_read_b128 v[152:155], v230 offset:2560
    v_mfma_f32_16x16x32_bf16 v[200:203], a[12:15], a[236:239], v[200:203]
    s_waitcnt lgkmcnt(7)
    ds_read_b128 a[236:239], v239 offset:17408
    v_mfma_f32_16x16x32_bf16 v[220:223], a[16:19], a[244:247], v[220:223]
    v_exp_f32 v144, v144
    v_mfma_f32_16x16x32_bf16 v[212:215], a[16:19], v[164:167], v[212:215]
    v_exp_f32 v145, v145
    v_mfma_f32_16x16x32_bf16 v[216:219], a[20:23], a[244:247], v[216:219]
    v_exp_f32 v146, v146
    v_mfma_f32_16x16x32_bf16 v[208:211], a[20:23], v[164:167], v[208:211]
    ds_read_b128 v[164:167], v224 offset:1024
    v_cvt_pk_bf16_f32 v158, v144, v145
    v_mfma_f32_16x16x32_bf16 v[204:207], a[24:27], a[244:247], v[204:207]
    v_exp_f32 v147, v147
    v_mfma_f32_16x16x32_bf16 v[200:203], a[28:31], a[244:247], v[200:203]
    s_waitcnt lgkmcnt(2)
    ds_read_b128 a[244:247], v224
    v_cvt_pk_bf16_f32 v159, v146, v147
    v_mfma_f32_16x16x32_bf16 v[152:155], v[30:33], v[138:141], v[152:155]
    ds_read_b128 v[144:147], v234
    v_mfma_f32_16x16x32_bf16 v[196:199], a[216:219], v[156:159], 0
    v_exp_f32 v148, v148
    v_mfma_f32_16x16x32_bf16 v[184:187], v[76:79], v[156:159], 0
    v_exp_f32 v149, v149
    v_mfma_f32_16x16x32_bf16 v[188:191], v[98:101], v[156:159], 0
    v_exp_f32 v150, v150
    v_mfma_f32_16x16x32_bf16 v[192:195], v[120:123], v[156:159], 0
    v_exp_f32 v151, v151
    v_mfma_f32_16x16x16_bf16 v[152:155], v[34:35], v[142:143], v[152:155]
    v_cvt_pk_bf16_f32 v156, v148, v149
    v_cvt_pk_bf16_f32 v157, v150, v151
    v_mfma_f32_16x16x32_bf16 v[220:223], a[32:35], v[168:171], v[220:223]
    ds_read_b128 v[148:151], v235
    v_mfma_f32_16x16x32_bf16 v[212:215], a[32:35], v[248:251], v[212:215]
    s_waitcnt lgkmcnt(1)
    v_mfma_f32_16x16x32_bf16 v[144:147], v[48:51], v[138:141], v[144:147]
    v_mfma_f32_16x16x32_bf16 v[216:219], a[36:39], v[168:171], v[216:219]
    v_mfma_f32_16x16x32_bf16 v[208:211], a[36:39], v[248:251], v[208:211]
    ds_read_b128 v[248:251], v224 offset:3072
    v_mfma_f32_16x16x32_bf16 v[204:207], a[40:43], v[168:171], v[204:207]
    v_exp_f32 v152, v152
    v_mfma_f32_16x16x32_bf16 v[200:203], a[44:47], v[168:171], v[200:203]
    ds_read_b128 v[168:171], v224 offset:2048
    v_mfma_f32_16x16x16_bf16 v[144:147], v[52:53], v[142:143], v[144:147]
    s_waitcnt lgkmcnt(2)
    v_exp_f32 v153, v153
    v_mfma_f32_16x16x32_bf16 v[148:151], v[54:57], v[138:141], v[148:151]
    v_exp_f32 v154, v154
    v_mfma_f32_16x16x32_bf16 v[220:223], a[48:51], a[248:251], v[220:223]
    v_exp_f32 v155, v155
    v_mfma_f32_16x16x32_bf16 v[212:215], a[48:51], a[252:255], v[212:215]
    v_cvt_pk_bf16_f32 v158, v152, v153
    v_cvt_pk_bf16_f32 v159, v154, v155
    v_mfma_f32_16x16x16_bf16 v[148:151], v[58:59], v[142:143], v[148:151]
L_pg8:
    s_cbranch_execz L_back
    v_exp_f32 v144, v144
    v_mfma_f32_16x16x32_bf16 v[196:199], a[216:219], v[156:159], v[196:199]
    v_exp_f32 v145, v145
    v_mfma_f32_16x16x32_bf16 v[184:187], v[68:71], v[156:159], v[184:187]
    v_exp_f32 v146, v146
    v_mfma_f32_16x16x32_bf16 v[188:191], v[90:93], v[156:159], v[188:191]
    v_exp_f32 v147, v147
    v_mfma_f32_16x16x32_bf16 v[192:195], v[112:115], v[156:159], v[192:195]
    v_cvt_pk_bf16_f32 v156, v144, v145
    v_cvt_pk_bf16_f32 v157, v146, v147
    v_mfma_f32_16x16x32_bf16 v[216:219], a[52:55], a[248:251], v[216:219]
    v_exp_f32 v148, v148
    v_mfma_f32_16x16x32_bf16 v[208:211], a[52:55], a[252:255], v[208:211]
    ds_read_b128 a[252:255], v224 offset:5120
    v_mfma_f32_16x16x32_bf16 v[204:207], a[56:59], a[248:251], v[204:207]
    v_exp_f32 v149, v149
    v_mfma_f32_16x16x32_bf16 v[200:203], a[60:63], a[248:251], v[200:203]
    ds_read_b128 a[248:251], v224 offset:4096
    v_cvt_pk_bf16_f32 v158, v148, v149
    v_mfma_f32_16x16x32_bf16 v[220:223], a[64:67], a[236:239], v[220:223]
    v_exp_f32 v150, v150
    v_mfma_f32_16x16x32_bf16 v[212:215], a[64:67], a[240:243], v[212:215]
    v_exp_f32 v151, v151
    v_mfma_f32_16x16x32_bf16 v[216:219], a[68:71], a[236:239], v[216:219]
    v_cvt_pk_bf16_f32 v159, v150, v151
    v_mfma_f32_16x16x32_bf16 v[208:211], a[68:71], a[240:243], v[208:211]
    v_mfma_f32_16x16x32_bf16 v[204:207], v[252:255], a[236:239], v[204:207]
    ds_read_b128 v[252:255], v242 offset:61440
    v_cvt_pk_bf16_f32 v220, v220, v221
    v_mfma_f32_16x16x32_bf16 v[196:199], a[216:219], v[156:159], v[196:199]
    v_cvt_pk_bf16_f32 v221, v222, v223
    v_cvt_pk_bf16_f32 v212, v212, v213
    v_mfma_f32_16x16x32_bf16 v[184:187], v[82:85], v[156:159], v[184:187]
    v_cvt_pk_bf16_f32 v222, v216, v217
    v_cvt_pk_bf16_f32 v223, v218, v219
    v_mfma_f32_16x16x32_bf16 v[188:191], v[104:107], v[156:159], v[188:191]
    buffer_store_dwordx4 v[220:223], v243, s[20:23], s51 offen sc0 sc1
    v_mfma_f32_16x16x32_bf16 v[192:195], v[126:129], v[156:159], v[192:195]
    v_cvt_pk_bf16_f32 v213, v214, v215
    v_cvt_pk_bf16_f32 v214, v208, v209
    v_mfma_f32_16x16x32_bf16 v[200:203], v[160:163], a[236:239], v[200:203]
    v_cvt_pk_bf16_f32 v215, v210, v211
    v_cvt_pk_bf16_f32 v204, v204, v205
    v_mfma_f32_16x16x32_bf16 v[180:183], a[220:223], a[244:247], 0
    ds_read_b128 v[160:163], v242 offset:61952
    v_cvt_pk_bf16_f32 v205, v206, v207
    v_mfma_f32_16x16x32_bf16 v[176:179], a[224:227], a[244:247], 0
    v_rcp_f32 v197, v196
    v_mfma_f32_16x16x32_bf16 v[172:175], a[228:231], a[244:247], 0
    v_cvt_pk_bf16_f32 v206, v200, v201
    v_cvt_pk_bf16_f32 v207, v202, v203
    v_mfma_f32_16x16x32_bf16 v[220:223], a[232:235], a[244:247], 0
    v_mul_f32 v184, v184, v197
    v_mul_f32 v185, v185, v197
    v_mfma_f32_16x16x32_bf16 v[180:183], a[0:3], v[164:167], v[180:183]
    v_cvt_pk_bf16_f32 v184, v184, v185
    v_mul_f32 v186, v186, v197
    v_mfma_f32_16x16x32_bf16 v[176:179], a[4:7], v[164:167], v[176:179]
    v_mul_f32 v187, v187, v197
    v_cvt_pk_bf16_f32 v185, v186, v187
    v_mfma_f32_16x16x32_bf16 v[172:175], a[8:11], v[164:167], v[172:175]
    v_mul_f32 v188, v188, v197
    v_mul_f32 v189, v189, v197
    v_mfma_f32_16x16x32_bf16 v[220:223], a[12:15], v[164:167], v[220:223]
    s_waitcnt lgkmcnt(1)
    v_cvt_pk_bf16_f32 v186, v188, v189
    v_mul_f32 v190, v190, v197
    v_mfma_f32_16x16x32_bf16 v[180:183], a[16:19], v[168:171], v[180:183]
    v_mul_f32 v191, v191, v197
    v_cvt_pk_bf16_f32 v187, v190, v191
    v_mfma_f32_16x16x32_bf16 v[176:179], a[20:23], v[168:171], v[176:179]
    buffer_store_dwordx4 v[212:215], v245, s[20:23], s51 offen sc0 sc1
    v_mfma_f32_16x16x32_bf16 v[172:175], a[24:27], v[168:171], v[172:175]
    v_mul_f32 v192, v192, v197
    v_mul_f32 v193, v193, v197
    v_mfma_f32_16x16x32_bf16 v[220:223], a[28:31], v[168:171], v[220:223]
    v_cvt_pk_bf16_f32 v188, v192, v193
    v_mul_f32 v194, v194, v197
    v_mfma_f32_16x16x32_bf16 v[180:183], a[32:35], v[248:251], v[180:183]
    v_mul_f32 v195, v195, v197
    v_cvt_pk_bf16_f32 v189, v194, v195
    v_mfma_f32_16x16x32_bf16 v[176:179], a[36:39], v[248:251], v[176:179]
    v_max3_f32 v236, v236, v196, v197
    v_cmp_lt_f32 vcc, 0x53800000, v236
    v_mfma_f32_16x16x32_bf16 v[172:175], a[40:43], v[248:251], v[172:175]
    ds_write_b128 v237, v[184:187] offset:6144
    v_mfma_f32_16x16x32_bf16 v[220:223], a[44:47], v[248:251], v[220:223]
    s_or_b32 s24, vcc_lo, vcc_hi
    ds_write_b64 v238, v[188:189] offset:6144
    v_mfma_f32_16x16x32_bf16 v[180:183], a[48:51], a[248:251], v[180:183]
    v_mov_b32 v4, s24
    v_mfma_f32_16x16x32_bf16 v[176:179], a[52:55], a[248:251], v[176:179]
    ds_write_b32 v5, v4
    v_mfma_f32_16x16x32_bf16 v[172:175], a[56:59], a[248:251], v[172:175]
    v_mfma_f32_16x16x32_bf16 v[220:223], a[60:63], a[248:251], v[220:223]
    v_mfma_f32_16x16x32_bf16 v[180:183], a[64:67], a[252:255], v[180:183]
    buffer_store_dwordx4 v[204:207], v244, s[20:23], s51 offen sc0 sc1
    v_mfma_f32_16x16x32_bf16 v[176:179], a[68:71], a[252:255], v[176:179]
    s_add_u32 s51, s51, s48
    v_mfma_f32_16x16x32_bf16 v[172:175], v[252:255], a[252:255], v[172:175]
    s_waitcnt lgkmcnt(3)
    ds_read_b128 v[252:255], v242 offset:61440
    v_mfma_f32_16x16x32_bf16 v[220:223], v[160:163], a[252:255], v[220:223]
    s_waitcnt lgkmcnt(1)
    ds_read_b128 v[160:163], v242 offset:61952
    s_nop 0
    v_cvt_pk_bf16_f32 v180, v180, v181
    v_cvt_pk_bf16_f32 v181, v182, v183
    v_cvt_pk_bf16_f32 v182, v176, v177
    v_cvt_pk_bf16_f32 v183, v178, v179
    v_cvt_pk_bf16_f32 v172, v172, v173
    v_cvt_pk_bf16_f32 v173, v174, v175
    v_cvt_pk_bf16_f32 v174, v220, v221
    v_cvt_pk_bf16_f32 v175, v222, v223
    s_barrier
    ds_read_b128 a[236:239], v227
    ds_read_b128 a[240:243], v227 offset:1024
    ds_read_b128 a[244:247], v227 offset:2048
    ds_read_b128 v[164:167], v227 offset:3072
    ds_read_b128 v[168:171], v227 offset:4096
    ds_read_b128 v[248:251], v227 offset:5120
    ds_read_b128 v[0:3], v6
    buffer_store_dwordx4 v[180:183], v225, s[20:23], s51 offen sc0 sc1
    s_waitcnt lgkmcnt(6)
    v_mfma_f32_16x16x32_bf16 v[216:219], a[220:223], a[236:239], 0
    v_mfma_f32_16x16x32_bf16 v[212:215], a[224:227], a[236:239], 0
    v_mfma_f32_16x16x32_bf16 v[208:211], a[228:231], a[236:239], 0
    v_mfma_f32_16x16x32_bf16 v[204:207], a[232:235], a[236:239], 0
    s_waitcnt lgkmcnt(4)
    v_mfma_f32_16x16x32_bf16 v[216:219], a[0:3], a[240:243], v[216:219]
    v_mfma_f32_16x16x32_bf16 v[212:215], a[4:7], a[240:243], v[212:215]
    v_mfma_f32_16x16x32_bf16 v[208:211], a[8:11], a[240:243], v[208:211]
    s_waitcnt lgkmcnt(0)
    v_or3_b32 v0, v0, v1, v2
    v_or_b32 v0, v0, v3
    v_mfma_f32_16x16x32_bf16 v[204:207], a[12:15], a[240:243], v[204:207]
    v_readfirstlane_b32 s24, v0
    v_mfma_f32_16x16x32_bf16 v[216:219], a[16:19], a[244:247], v[216:219]
    v_mfma_f32_16x16x32_bf16 v[212:215], a[20:23], a[244:247], v[212:215]
    v_mfma_f32_16x16x32_bf16 v[208:211], a[24:27], a[244:247], v[208:211]
    v_mfma_f32_16x16x32_bf16 v[204:207], a[28:31], a[244:247], v[204:207]
    buffer_store_dwordx4 v[172:175], v226, s[20:23], s51 offen sc0 sc1
    v_mfma_f32_16x16x32_bf16 v[216:219], a[32:35], v[164:167], v[216:219]
    v_mfma_f32_16x16x32_bf16 v[212:215], a[36:39], v[164:167], v[212:215]
    v_mfma_f32_16x16x32_bf16 v[208:211], a[40:43], v[164:167], v[208:211]
    v_mfma_f32_16x16x32_bf16 v[204:207], a[44:47], v[164:167], v[204:207]
    v_mfma_f32_16x16x32_bf16 v[216:219], a[48:51], v[168:171], v[216:219]
    v_mfma_f32_16x16x32_bf16 v[212:215], a[52:55], v[168:171], v[212:215]
    v_mfma_f32_16x16x32_bf16 v[208:211], a[56:59], v[168:171], v[208:211]
    v_mfma_f32_16x16x32_bf16 v[204:207], a[60:63], v[168:171], v[204:207]
    v_mfma_f32_16x16x32_bf16 v[216:219], a[64:67], v[248:251], v[216:219]
    v_mfma_f32_16x16x32_bf16 v[212:215], a[68:71], v[248:251], v[212:215]
    v_mfma_f32_16x16x32_bf16 v[208:211], v[252:255], v[248:251], v[208:211]
    v_mfma_f32_16x16x32_bf16 v[204:207], v[160:163], v[248:251], v[204:207]
    s_nop 4
    v_cvt_pk_bf16_f32 v216, v216, v217
    v_cvt_pk_bf16_f32 v217, v218, v219
    v_cvt_pk_bf16_f32 v218, v212, v213
    v_cvt_pk_bf16_f32 v219, v214, v215
    buffer_store_dwordx4 v[216:219], v246, s[20:23], s51 offen sc0 sc1
    v_cvt_pk_bf16_f32 v208, v208, v209
    v_cvt_pk_bf16_f32 v209, v210, v211
    v_cvt_pk_bf16_f32 v210, v204, v205
    v_cvt_pk_bf16_f32 v211, v206, v207
    buffer_store_dwordx4 v[208:211], v247, s[20:23], s51 offen sc0 sc1
    s_nop 1
    s_cmp_lg_u32 s24, 0
    s_cbranch_scc1 L_safe
L_exit:
    s_endpgm
L_end:
L_safe:
    s_waitcnt vmcnt(0) lgkmcnt(0)
    s_barrier
    v_mbcnt_lo_u32_b32 v0, -1, 0
    v_mbcnt_hi_u32_b32 v0, -1, v0
    s_lshl_b32 s24, s36, 6
    v_add_u32 v0, s24, v0
    s_load_dwordx2 s[8:9], s[0:1], 8
    s_load_dwordx2 s[4:5], s[0:1], 0
    s_load_dwordx2 s[16:17], s[0:1], 24
    s_load_dwordx2 s[12:13], s[0:1], 16
    s_load_dwordx2 s[20:21], s[0:1], 32
    v_lshrrev_b32 v74, 6, v0
    v_and_b32 v60, 63, v0
    v_readfirstlane_b32 s36, v74
    v_mul_u32_u24 v76, 0x2aab, v60
    v_lshrrev_b32 v76, 16, v76
    v_mul_u32_u24 v74, 6, v76
    v_sub_u32 v77, v60, v74
    v_lshrrev_b32 v74, 1, v76
    v_and_b32 v74, 4, v74
    v_xor_b32 v76, v76, v74
    v_mul_u32_u24 v74, 0x480, v76
    v_lshl_add_u32 v251, v77, 4, v74
    v_add_u32 v79, 64, v60
    v_mul_u32_u24 v78, 0x2aab, v79
    v_lshrrev_b32 v78, 16, v78
    v_mul_u32_u24 v74, 6, v78
    v_sub_u32 v79, v60, v74
    v_lshrrev_b32 v74, 1, v78
    v_and_b32 v74, 4, v74
    v_xor_b32 v78, v78, v74
    v_mul_u32_u24 v74, 0x480, v78
    v_lshl_add_u32 v252, v79, 4, v74
    v_add_u32 v81, 0x80, v60
    v_mul_u32_u24 v80, 0x2aab, v81
    v_lshrrev_b32 v80, 16, v80
    v_mul_u32_u24 v74, 6, v80
    v_sub_u32 v81, v60, v74
    v_lshrrev_b32 v74, 1, v80
    v_and_b32 v74, 4, v74
    v_xor_b32 v80, v80, v74
    v_mul_u32_u24 v74, 0x480, v80
    v_lshl_add_u32 v253, v81, 4, v74
    s_mul_i32 s49, s36, 0x60
    s_mul_i32 s50, s36, 0xc00
    s_add_u32 s50, s50, 0x15e00
    s_mov_b32 s10, 0x36000
    s_mov_b32 s11, 0x20000
    s_mov_b32 s6, 0x1260400
    s_mov_b32 s7, 0x20000
    s_mov_b32 s18, 0x548
    s_mov_b32 s19, 0x20000
    s_mov_b32 s14, 0x12000
    s_mov_b32 s15, 0x20000
    s_mov_b32 s22, 0x1260000
    s_mov_b32 s23, 0x20000
    s_mul_i32 s58, s36, 0x152
    v_lshlrev_b32 v199, 1, v60
    s_add_u32 s57, s49, 0x180
    s_add_u32 m0, s50, 0
    s_bfe_u32 s35, s2, 0x30003
    s_lshr_b32 s55, s2, 6
    s_and_b32 s54, s2, 1
    s_lshl2_add_u32 s34, s54, s55
    s_and_b32 s46, s55, 1
    s_bfe_u32 s54, s2, 0x10002
    s_mul_i32 s54, s54, 0x15000
    s_bfe_u32 s55, s2, 0x10001
    s_mul_i32 s55, s55, 0x180
    s_add_u32 s38, s54, s55
    s_lshl_b32 s41, s36, 11
    s_min_u32 s41, s41, 0x1600
    s_mul_i32 s54, s35, 14
    s_sub_u32 s54, s54, 3
    s_movk_i32 s53, 0x6f
    s_lshr_b32 s55, s41, 4
    v_add_u32 v99, s55, v60
    v_mov_b32 v100, 0x8000
    v_mul_u32_u24 v97, 0xaab, v99
    v_lshrrev_b32 v97, 16, v97
    v_mul_u32_u24 v98, 24, v97
    v_sub_u32 v96, v99, v98
    v_and_or_b32 v98, 2, v97, 64
    v_xor_b32 v96, v96, v98
    v_add_u32 v97, s54, v97
    v_cmp_lt_u32 vcc, s53, v97
    v_add_u32 v99, 64, v99
    s_mul_i32 s51, s34, 0x24c000
    v_cndmask_b32 v97, v97, v100, vcc
    v_mul_u32_u24 v97, 0x300, v97
    v_lshl_add_u32 v246, v96, 4, v97
    v_mul_u32_u24 v97, 0xaab, v99
    v_lshrrev_b32 v97, 16, v97
    v_mul_u32_u24 v98, 24, v97
    s_waitcnt lgkmcnt(0)
    buffer_load_ushort v196, v199, s[16:19], s58 offen
    buffer_load_ushort v197, v199, s[16:19], s58 offen offset:128
    buffer_load_ushort v198, v199, s[16:19], s58 offen offset:256
    buffer_load_dwordx4 v251, s[8:11], s57 offen lds
    v_sub_u32 v96, v99, v98
    v_and_b32 v98, 2, v97
    v_xor_b32 v96, v96, v98
    buffer_load_dwordx4 v252, s[8:11], s57 offen offset:1024 lds
    v_add_u32 v97, s54, v97
    v_cmp_lt_u32 vcc, s53, v97
    s_sub_u32 s4, s4, 0x400
    s_subb_u32 s5, s5, 0
    s_add_u32 s51, s51, s38
    v_cndmask_b32 v97, v97, v100, vcc
    v_mul_u32_u24 v97, 0x300, v97
    v_lshl_add_u32 v247, v96, 4, v97
    s_mul_i32 s55, s46, 0x222000
    buffer_load_dwordx4 v253, s[8:11], s57 offen offset:2048 lds
    s_add_u32 s56, s51, s55
    s_mul_i32 s42, s46, 0xfffac000
    s_add_u32 s42, s42, 0x2a000
    s_mul_i32 s55, s46, 7
    s_cmp_eq_u32 s34, s55
    s_cselect_b32 s43, 5, -3
    s_cselect_b32 s45, 0, -1
    s_cselect_b32 s47, 1, 0
    s_mul_i32 s43, s43, s42
    s_add_u32 s43, s43, s56
    s_mul_i32 s45, s45, s42
    s_add_u32 s45, s45, s56
    s_add_u32 s44, s43, s42
    s_cmp_eq_u32 s47, 1
    s_cmov_b32 s45, 0x2000000
    s_add_u32 m0, s41, 0
    s_add_u32 s57, s49, 0x9180
    buffer_load_dwordx4 v246, s[4:7], s43 offen lds
    v_lshrrev_b32 v61, 4, v60
    v_and_b32 v62, 7, v60
    v_bfe_u32 v63, v60, 3, 1
    v_bfe_u32 v96, v60, 2, 2
    v_and_b32 v97, 3, v60
    v_and_b32 v103, 1, v61
    v_lshl_add_u32 v99, v61, 3, v96
    v_lshl_add_u32 v99, v103, 2, v99
    buffer_load_dwordx4 v247, s[4:7], s43 offen offset:1024 lds
    s_add_u32 m0, s41, 0x1e40
    v_lshl_add_u32 v101, v97, 3, s50
    s_movk_i32 s27, 0x60
    v_mad_u32_u24 v254, v99, s27, v101
    v_xor_b32 v99, 4, v99
    v_mad_u32_u24 v255, v99, s27, v101
    v_mul_u32_u24 v102, 0x1e40, v63
    v_and_b32 v98, 2, v60
    buffer_load_dwordx4 v246, s[4:7], s44 offen lds
    v_xor_b32 v98, v98, v61
    v_lshlrev_b32 v98, 4, v98
    v_mul_u32_u24 v100, 0x180, v62
    v_add3_u32 v224, v98, v100, v102
    v_mul_u32_u24 v99, 0x1e40, v96
    v_mul_u32_u24 v227, 0x180, v97
    v_add3_u32 v227, v227, v98, v99
    s_cmp_eq_u32 s35, 0
    s_cselect_b32 s29, 3, 0
    s_cselect_b32 s30, -3, -2
    buffer_load_dwordx4 v247, s[4:7], s44 offen offset:1024 lds
    s_add_u32 m0, s41, 0x3c80
    s_mul_i32 s32, s36, 0xf00
    s_add_u32 s32, s32, 0xf200
    s_mov_b32 s40, 0x140
    s_lshl_b32 s31, s36, 10
    s_add_u32 s31, s31, 0x12e40
    v_mul_u32_u24 v119, 13, v60
    v_lshrrev_b32 v119, 8, v119
    v_mul_u32_u24 v118, 20, v119
    v_sub_u32 v118, v60, v118
    buffer_load_dwordx4 v246, s[4:7], s45 offen lds
    v_add_u32 v120, -11, v118
    v_max_i32 v120, 0, v120
    v_mul_u32_u24 v121, 11, v120
    v_lshrrev_b32 v121, 5, v121
    v_mul_u32_u24 v122, 3, v121
    v_sub_u32 v120, v120, v122
    v_lshlrev_b32 v120, 2, v120
    buffer_load_dwordx4 v247, s[4:7], s45 offen offset:1024 lds
    s_add_u32 m0, s41, 0x5ac0
    v_sub_u32 v121, v120, v121
    v_cmp_lt_u32 vcc, 10, v118
    v_add_u32 v121, s29, v121
    v_add_u32 v120, s30, v120
    v_add_u32 v122, -3, v118
    v_cndmask_b32 v121, v118, v121, vcc
    v_cndmask_b32 v120, v122, v120, vcc
    buffer_load_dwordx4 v246, s[4:7], s56 offen lds
    v_cmp_gt_u32 s[60:61], 7, v120
    v_add_u32 v120, 1, v120
    v_cmp_gt_u32 s[62:63], 7, v120
    v_add_u32 v120, 1, v120
    v_cmp_gt_u32 s[64:65], 7, v120
    v_add_u32 v120, 1, v120
    v_cmp_gt_u32 s[66:67], 7, v120
    s_cmp_eq_u32 s46, 0
    s_cselect_b32 s28, 13, -13
    s_cselect_b32 s69, 0, 39
    buffer_load_dwordx4 v247, s[4:7], s56 offen offset:1024 lds
    s_add_u32 m0, s50, 0x3000
    s_add_u32 s56, s56, s42
    v_add_u32 v119, 2, v119
    v_mad_i32_i24 v121, v119, s28, v121
    s_lshl4_add_u32 s69, s69, s31
    v_lshl_add_u32 v121, v121, 2, s69
    s_mul_i32 s69, s28, 12
    v_add_u32 v118, s69, v121
    v_add_u32 v119, s69, v118
    buffer_load_dwordx4 v251, s[8:11], s57 offen lds
    s_lshl_b32 s69, s28, 3
    v_add_u32 v122, s69, v119
    v_lshl_add_u32 v123, v60, 4, s32
    v_lshl_add_u32 v125, v60, 2, s31
    s_mov_b32 s68, 0x40ddb3d7
    v_mov_b32 v124, 0xf149f2ca
    s_and_b32 s72, s60, 0xfff00000
    s_and_b32 s70, s62, 0xfff00000
    v_mul_u32_u24 v74, 0x180, v76
    buffer_load_dwordx4 v252, s[8:11], s57 offen offset:1024 lds
    v_lshl_add_u32 v192, v77, 4, v74
    v_mul_u32_u24 v74, 0x180, v78
    v_lshl_add_u32 v193, v79, 4, v74
    v_mul_u32_u24 v74, 0x180, v80
    v_lshl_add_u32 v194, v81, 4, v74
    v_and_b32 v74, 16, v78
    v_mul_u32_u24 v74, 0x300, v74
    v_add_u32 v195, v74, v193
    buffer_load_dwordx4 v253, s[8:11], s57 offen offset:2048 lds
    s_add_u32 s57, s49, 0x12180
    s_add_u32 m0, s50, 0x6000
    v_add_u32 v98, 3, v62
    v_and_b32 v98, 2, v98
    v_xor_b32 v98, v98, v61
    v_lshl_add_u32 v98, v98, 4, v100
    v_add_u32 v225, v98, v102
    v_xor_b32 v99, 1, v63
    v_mul_u32_u24 v99, 0xd3c0, v99
    v_add_u32 v226, v98, v99
    s_mov_b32 s37, 0x3e553b95
    s_cmp_eq_u32 s35, 7
    s_cselect_b32 s33, 2, 64
    v_lshrrev_b32 v184, 1, v61
    v_lshl_add_u32 v185, v63, 1, v184
    v_lshlrev_b32 v232, 2, v185
    v_lshl_add_u32 v185, v63, 2, v61
    v_lshlrev_b32 v233, 2, v185
    v_sub_u32 v184, v184, v63
    v_mul_i32_i24 v184, 0x140, v184
    s_sub_u32 s24, s32, 0x140
    v_add_u32 v184, s24, v184
    v_lshl_add_u32 v185, v103, 2, 3
    v_cmp_gt_u32 vcc, s29, v62
    v_sub_u32 v186, v185, v62
    v_min_u32 v187, 10, v186
    v_mad_u32_u24 v190, v62, 3, v103
    v_add_u32 v191, 11, v190
    v_cndmask_b32 v187, v187, v191, vcc
    v_lshl_add_u32 v228, v187, 4, v184
    v_add_u32 v186, 8, v186
    v_min_u32 v187, 10, v186
    v_lshl_add_u32 v186, v103, 4, v62
    v_cmp_gt_u32 vcc, s29, v186
    v_add_u32 v191, 13, v190
    v_min_u32 v186, 5, v62
    v_cndmask_b32 v187, v187, v191, vcc
    v_lshl_add_u32 v229, v187, 4, v184
    v_cmp_lt_u32 vcc, s33, v186
    v_sub_u32 v187, v185, v186
    v_min_u32 v187, 10, v187
    v_mad_u32_u24 v190, v186, 3, 2
    v_add_u32 v191, v190, v103
    v_cndmask_b32 v185, v187, v191, vcc
    v_sub_u32 v187, 11, v186
    v_min_u32 v187, 10, v187
    v_add_u32 v191, 2, v190
    v_cndmask_b32 v187, v187, v191, vcc
    v_cmp_lt_u32 vcc, 5, v62
    v_mul_u32_u24 v191, 10, v103
    v_mov_b32 v190, 10
    v_cndmask_b32 v185, v185, v191, vcc
    v_cndmask_b32 v187, v187, v190, vcc
    v_lshl_add_u32 v230, v185, 4, v184
    v_lshl_add_u32 v231, v187, 4, s32
    v_mov_b32 v96, 0x3f803f80
    v_cmp_eq_u32 vcc, 0, v97
    s_mov_b32 s69, 0x32104321
    s_and_b32 s24, s36, 1
    v_cndmask_b32 v96, 0, v96, vcc
    v_accvgpr_write_b32 a216, v96
    v_accvgpr_write_b32 a217, v96
    v_accvgpr_write_b32 a218, v96
    v_accvgpr_write_b32 a219, v96
    s_lshr_b32 s27, s36, 1
    v_lshlrev_b32 v99, 4, v60
    s_mul_i32 s25, s27, 0xc00
    s_add_u32 s25, s25, 0x12e00
    s_lshl_b32 s26, s24, 11
    s_add_u32 s26, s26, s25
    v_add_u32 v237, s26, v99
    s_lshl3_add_u32 s26, s24, s25
    s_add_u32 s26, s26, 0x400
    v_add_u32 v238, s26, v99
    s_mul_i32 s25, s24, 0x1800
    s_add_u32 s26, s25, 0x12e00
    v_add_u32 v239, s26, v99
    s_sub_u32 s25, 0x14600, s25
    v_add_u32 v240, s25, v99
    v_lshrrev_b32 v99, 2, v60
    v_and_b32 v97, 3, v60
    v_and_b32 v98, 2, v61
    v_lshlrev_b32 v98, 1, v98
    v_xor_b32 v99, v99, v98
    v_mul_u32_u24 v99, 0x60, v99
    v_lshl_add_u32 v108, v97, 4, v99
    v_lshrrev_b32 v98, 1, v97
    v_mul_u32_u24 v98, 0xba0, v98
    s_mul_i32 s26, s27, 0x1800
    s_add_u32 s26, s26, 0x15e40
    v_add3_u32 v109, v108, v98, s26
    s_lshl_b32 s25, s24, 5
    s_add_u32 s52, s25, s50
    v_add_u32 v108, s52, v108
    v_bfrev_b32 v98, v97
    v_lshrrev_b32 v98, 27, v98
    v_add3_u32 v86, v99, v98, s50
    v_lshlrev_b32 v99, 7, v61
    v_lshl_add_u32 v99, v62, 4, v99
    v_lshl_add_u32 v98, v63, 9, v99
    v_add_u32 v87, s50, v98
    v_lshl_add_u32 v99, v63, 10, v99
    s_add_u32 s26, s26, 0x7c0
    v_add_u32 v242, s26, v99
    s_lshl_b32 s26, s24, 10
    s_add_u32 s26, s26, s50
    v_add_u32 v241, s26, v99
    v_xor_b32 v99, s46, v63
    v_mul_u32_u24 v99, 0x2a000, v99
    v_mul_u32_u24 v98, 0x300, v62
    v_lshl_add_u32 v99, v61, 4, v99
    v_cmp_lt_u32 vcc, 5, v62
    v_add_u32 v99, v99, v98
    v_add_u32 v98, 0x1800, v99
    v_bfrev_b32 v100, 1
    v_cndmask_b32 v98, v98, v100, vcc
    s_sub_u32 s59, 0, s24
    s_mov_b32 vcc_lo, s59
    s_mov_b32 vcc_hi, s59
    v_cndmask_b32 v100, v99, v98, vcc
    v_cndmask_b32 v101, v98, v99, vcc
    s_mov_b32 vcc_lo, s59
    s_mov_b32 vcc_hi, s59
    v_lshrrev_b32 v96, 31, v100
    v_lshl_add_u32 v239, v96, 20, v239
    v_lshrrev_b32 v96, 31, v101
    v_lshl_add_u32 v240, v96, 20, v240
    s_add_u32 s25, s25, s49
    v_add_u32 v243, s25, v100
    v_add_u32 v245, s25, v101
    s_mul_i32 s26, s27, 0xc0
    s_add_u32 s26, s26, 64
    v_add_u32 v244, s26, v100
    s_mul_i32 s25, s35, 0x2a00
    s_add_u32 s51, s51, s25
    s_mul_i32 s25, s46, 0x1f8000
    s_add_u32 s51, s51, s25
    s_lshl_b32 s48, s42, 1
    s_waitcnt vmcnt(16)
    v_lshlrev_b32 v196, 16, v196
    v_mul_f32 v196, s68, v196
    ds_write_b32 v125, v196
    s_waitcnt vmcnt(15)
    v_lshlrev_b32 v197, 16, v197
    v_mul_f32 v197, s68, v197
    ds_write_b32 v125, v197 offset:256
    s_waitcnt vmcnt(14)
    v_lshlrev_b32 v198, 16, v198
    v_mul_f32 v198, s68, v198
    ds_write_b32 v125, v198 offset:512
    s_mov_b32 s68, 0x760007
    s_cmp_eq_u32 s47, 1
    s_cmov_b32 s68, 0x760097
    ds_read2_b32 v[144:145], v121 offset0:0 offset1:1
    ds_read2_b32 v[146:147], v121 offset0:2 offset1:3
    ds_read2_b32 v[148:149], v118 offset0:0 offset1:1
    ds_read2_b32 v[150:151], v118 offset0:2 offset1:3
    ds_read2_b32 v[152:153], v119 offset0:0 offset1:1
    ds_read2_b32 v[154:155], v119 offset0:2 offset1:3
    ds_read2_b32 v[156:157], v122 offset0:0 offset1:1
    ds_read2_b32 v[158:159], v122 offset0:2 offset1:3
    s_waitcnt lgkmcnt(5)
    v_cndmask_b32 v148, v124, v148, s[60:61]
    v_cndmask_b32 v149, v124, v149, s[62:63]
    s_waitcnt lgkmcnt(4)
    v_cndmask_b32 v150, v124, v150, s[64:65]
    v_cndmask_b32 v151, v124, v151, s[66:67]
    s_and_b32 s61, s61, 0xfffffff
    s_and_b32 s63, s63, 0xfffffff
    s_and_b32 s65, s65, 0xfffffff
    s_waitcnt vmcnt(11)
    ds_read_b64_tr_b16 a[0:1], v254
    ds_read_b64_tr_b16 a[2:3], v255
    ds_read_b64_tr_b16 a[4:5], v254 offset:32
    ds_read_b64_tr_b16 a[6:7], v255 offset:32
    ds_read_b64_tr_b16 a[8:9], v254 offset:64
    s_waitcnt lgkmcnt(6)
    v_cndmask_b32 v156, v124, v156, s[60:61]
    ds_read_b64_tr_b16 a[10:11], v255 offset:64
    v_cndmask_b32 v157, v124, v157, s[62:63]
    s_waitcnt lgkmcnt(6)
    v_cndmask_b32 v158, v124, v158, s[64:65]
    s_and_b32 s67, s67, 0xfffffff
    v_cndmask_b32 v159, v124, v159, s[66:67]
    s_mov_b32 s73, s61
    v_cndmask_b32 v144, v124, v144, s[72:73]
    s_mov_b32 s71, s63
    v_cndmask_b32 v145, v124, v145, s[70:71]
    s_and_b32 s72, s64, 0xfff00000
    s_mov_b32 s73, s65
    v_cndmask_b32 v146, v124, v146, s[72:73]
    s_and_b32 s70, s66, 0xfff00000
    s_mov_b32 s71, s67
    v_cndmask_b32 v147, v124, v147, s[70:71]
    s_and_b32 s61, s61, 0xff
    v_cndmask_b32 v152, v124, v152, s[60:61]
    s_and_b32 s63, s63, 0xff
    v_cndmask_b32 v153, v124, v153, s[62:63]
    s_and_b32 s65, s65, 0xff
    v_cndmask_b32 v154, v124, v154, s[64:65]
    s_and_b32 s67, s67, 0xff
    v_cndmask_b32 v155, v124, v155, s[66:67]
    ds_write_b128 v123, v[144:147]
    ds_write_b128 v123, v[148:151] offset:960
    ds_write_b128 v123, v[152:155] offset:1920
    ds_write_b128 v123, v[156:159] offset:2880
    s_mov_b32 s60, 0x2222
    s_cmp_eq_u32 s47, 1
    s_cmov_b32 s60, 0xbbbb
    v_bfe_u32 v234, s60, v232, 4
    v_mad_u32_u24 v235, v234, s40, v228
    v_mad_u32_u24 v234, v234, s40, v229
    s_mov_b32 s61, 0x4444
    s_cmp_eq_u32 s47, 1
    s_cmov_b32 s61, 0x4241
    v_bfe_u32 v250, s61, v232, 4
    s_mov_b32 s62, 0x8808
    s_cmp_eq_u32 s47, 1
    s_cmov_b32 s62, 0x8898
    s_mov_b32 s63, 0x32104321
    s_cmp_eq_u32 s47, 1
    s_cmov_b32 s63, 0x30a940ba
    s_mov_b32 s64, 0x76540765
    s_cmp_eq_u32 s47, 1
    s_cmov_b32 s64, 0x76549765
    s_mov_b32 s65, 0x2222
    s_cmp_eq_u32 s47, 1
    s_cmov_b32 s65, 0x2221
    s_mov_b32 s66, 0x10002100
    s_cmp_eq_u32 s47, 1
    s_cmov_b32 s66, 0x10002000
    s_mov_b32 s67, 0x54326543
    s_mov_b32 s70, 0x76540765
    s_mov_b32 s71, 0x10002100
    s_mov_b32 s72, 0x760007
    ds_read_b128 v[144:147], v235
    v_bfe_u32 v235, s62, v232, 4
    ds_read_b128 v[148:151], v234
    v_mad_u32_u24 v234, v250, s40, v229
    v_mad_u32_u24 v250, v250, s40, v228
    ds_read_b128 v[152:155], v234
    v_bfe_u32 v234, s60, v232, 4
    v_mad_u32_u24 v234, v234, s40, v230
    ds_read_b128 v[156:159], v250
    v_mad_u32_u24 v250, v235, s40, v229
    v_mad_u32_u24 v235, v235, s40, v228
    ds_read_b128 v[160:163], v228 offset:1920
    ds_read_b128 v[164:167], v229 offset:1920
    s_waitcnt vmcnt(3)
    s_barrier
    buffer_load_dwordx4 v251, s[8:11], s57 offen lds
    buffer_load_dwordx4 v252, s[8:11], s57 offen offset:1024 lds
    ds_read_b128 a[236:239], v224
    ds_read_b128 a[240:243], v224 offset:64
    ds_read_b128 a[244:247], v224 offset:128
    ds_read_b128 a[248:251], v224 offset:192
    ds_read_b128 a[252:255], v224 offset:256
    buffer_load_dwordx4 v253, s[8:11], s57 offen offset:2048 lds
    s_add_u32 s57, s49, 0x1b180
    s_add_u32 m0, s50, 0x9000
    ds_read_b128 a[220:223], v224 offset:320
    ds_read_b128 a[224:227], v224 offset:3072
    ds_read_b128 a[228:231], v224 offset:3136
    s_waitcnt lgkmcnt(7)
    v_mfma_f32_16x16x32_bf16 v[220:223], a[0:3], a[236:239], 0
    ds_read_b128 a[232:235], v224 offset:3200
    v_mfma_f32_16x16x32_bf16 v[216:219], a[4:7], a[236:239], 0
    buffer_load_dwordx4 v251, s[8:11], s57 offen lds
    v_mfma_f32_16x16x32_bf16 v[212:215], a[8:11], a[236:239], 0
    s_waitcnt lgkmcnt(2)
    ds_read_b128 a[236:239], v224 offset:3264
    ds_read_b128 v[168:171], v250
    v_bfe_u32 v250, s62, v232, 4
    v_mad_u32_u24 v250, v250, s40, v230
    ds_read_b128 v[172:175], v235
    v_bfe_u32 v235, s61, v232, 4
    v_mad_u32_u24 v235, v235, s40, v230
    buffer_load_dwordx4 v252, s[8:11], s57 offen offset:1024 lds
    v_mfma_f32_16x16x32_bf16 v[208:211], a[0:3], a[224:227], 0
    s_waitcnt vmcnt(5)
    ds_read_b64_tr_b16 a[12:13], v254 offset:12288
    ds_read_b64_tr_b16 a[14:15], v255 offset:12288
    v_mfma_f32_16x16x32_bf16 v[204:207], a[4:7], a[224:227], 0
    ds_read_b64_tr_b16 a[16:17], v254 offset:12320
    ds_read_b64_tr_b16 a[18:19], v255 offset:12320
    v_mfma_f32_16x16x32_bf16 v[200:203], a[8:11], a[224:227], 0
    s_waitcnt lgkmcnt(2)
    ds_read_b128 a[224:227], v224 offset:15680
    ds_read_b64_tr_b16 a[20:21], v254 offset:12352
    ds_read_b64_tr_b16 a[22:23], v255 offset:12352
    buffer_load_dwordx4 v253, s[8:11], s57 offen offset:2048 lds
    s_add_u32 s57, s49, 0x24180
    s_add_u32 m0, s50, 0xc000
    s_nop 0
    v_mfma_f32_16x16x32_bf16 v[220:223], a[12:15], a[240:243], v[220:223]
    s_waitcnt lgkmcnt(3)
    v_mfma_f32_16x16x32_bf16 v[216:219], a[16:19], a[240:243], v[216:219]
    buffer_load_dwordx4 v251, s[8:11], s57 offen lds
    v_mfma_f32_16x16x32_bf16 v[208:211], a[12:15], a[228:231], v[208:211]
    s_waitcnt lgkmcnt(0)
    v_mfma_f32_16x16x32_bf16 v[212:215], a[20:23], a[240:243], v[212:215]
    ds_read_b128 a[240:243], v224 offset:3328
    v_mfma_f32_16x16x32_bf16 v[204:207], a[16:19], a[228:231], v[204:207]
    v_mfma_f32_16x16x32_bf16 v[200:203], a[20:23], a[228:231], v[200:203]
    s_waitcnt vmcnt(4)
    buffer_load_dwordx4 v252, s[8:11], s57 offen offset:1024 lds
    ds_read_b128 a[228:231], v224 offset:15744
    buffer_load_dwordx4 v253, s[8:11], s57 offen offset:2048 lds
    s_add_u32 s57, s49, 0x2d180
    s_add_u32 m0, s50, 0xf000
    s_nop 0
    buffer_load_dwordx4 v251, s[8:11], s57 offen lds
    buffer_load_dwordx4 v252, s[8:11], s57 offen offset:1024 lds
    ds_read_b64_tr_b16 a[24:25], v254 offset:24576
    ds_read_b64_tr_b16 a[26:27], v255 offset:24576
    ds_read_b64_tr_b16 a[28:29], v254 offset:24608
    ds_read_b64_tr_b16 a[30:31], v255 offset:24608
    ds_read_b64_tr_b16 a[32:33], v254 offset:24640
    ds_read_b64_tr_b16 a[34:35], v255 offset:24640
    buffer_load_dwordx4 v253, s[8:11], s57 offen offset:2048 lds
    s_add_u32 m0, s41, 0x7900
    s_add_u32 s57, s49, 0x300
    s_waitcnt lgkmcnt(4)
    v_mfma_f32_16x16x32_bf16 v[220:223], a[24:27], a[244:247], v[220:223]
    s_waitcnt lgkmcnt(2)
    buffer_load_dwordx4 v246, s[4:7], s56 offen lds
    v_mfma_f32_16x16x32_bf16 v[216:219], a[28:31], a[244:247], v[216:219]
    s_waitcnt lgkmcnt(0)
    v_mfma_f32_16x16x32_bf16 v[212:215], a[32:35], a[244:247], v[212:215]
    ds_read_b128 a[244:247], v224 offset:3392
    v_mfma_f32_16x16x32_bf16 v[208:211], a[24:27], a[232:235], v[208:211]
    v_mfma_f32_16x16x32_bf16 v[204:207], a[28:31], a[232:235], v[204:207]
    s_waitcnt vmcnt(7)
    buffer_load_dwordx4 v247, s[4:7], s56 offen offset:1024 lds
    v_mfma_f32_16x16x32_bf16 v[200:203], a[32:35], a[232:235], v[200:203]
    s_add_u32 s56, s56, s42
    s_add_u32 m0, s41, 0x9740
    ds_read_b128 a[232:235], v224 offset:15808
    ds_read_b64_tr_b16 a[36:37], v254 offset:36864
    ds_read_b64_tr_b16 a[38:39], v255 offset:36864
    ds_read_b64_tr_b16 a[40:41], v254 offset:36896
    ds_read_b64_tr_b16 a[42:43], v255 offset:36896
    ds_read_b64_tr_b16 a[44:45], v254 offset:36928
    ds_read_b64_tr_b16 a[46:47], v255 offset:36928
    buffer_load_dwordx4 v246, s[4:7], s56 offen lds
    buffer_load_dwordx4 v247, s[4:7], s56 offen offset:1024 lds
    s_waitcnt lgkmcnt(4)
    v_mfma_f32_16x16x32_bf16 v[220:223], a[36:39], a[248:251], v[220:223]
    s_add_u32 s56, s56, s42
    s_add_u32 m0, s41, 0xb580
    s_waitcnt lgkmcnt(2)
    v_mfma_f32_16x16x32_bf16 v[216:219], a[40:43], a[248:251], v[216:219]
    s_waitcnt lgkmcnt(0)
    v_mfma_f32_16x16x32_bf16 v[212:215], a[44:47], a[248:251], v[212:215]
    ds_read_b128 a[248:251], v224 offset:15488
    v_mfma_f32_16x16x32_bf16 v[208:211], a[36:39], a[236:239], v[208:211]
    v_mfma_f32_16x16x32_bf16 v[204:207], a[40:43], a[236:239], v[204:207]
    buffer_load_dwordx4 v246, s[4:7], s56 offen lds
    v_mfma_f32_16x16x32_bf16 v[200:203], a[44:47], a[236:239], v[200:203]
    s_waitcnt vmcnt(8)
    ds_read_b128 a[236:239], v224 offset:18560
    ds_read_b64_tr_b16 a[48:49], v254 offset:49152
    ds_read_b64_tr_b16 a[50:51], v255 offset:49152
    ds_read_b64_tr_b16 a[52:53], v254 offset:49184
    ds_read_b64_tr_b16 a[54:55], v255 offset:49184
    ds_read_b64_tr_b16 a[56:57], v254 offset:49216
    buffer_load_dwordx4 v247, s[4:7], s56 offen offset:1024 lds
    s_add_u32 s56, s56, s42
    s_add_u32 m0, s41, 0xd3c0
    ds_read_b64_tr_b16 a[58:59], v255 offset:49216
    buffer_load_dwordx4 v246, s[4:7], s56 offen lds
    s_waitcnt lgkmcnt(4)
    v_mfma_f32_16x16x32_bf16 v[220:223], a[48:51], a[252:255], v[220:223]
    s_waitcnt lgkmcnt(2)
    v_mfma_f32_16x16x32_bf16 v[216:219], a[52:55], a[252:255], v[216:219]
    s_waitcnt lgkmcnt(0)
    v_mfma_f32_16x16x32_bf16 v[212:215], a[56:59], a[252:255], v[212:215]
    ds_read_b128 a[252:255], v224 offset:15552
    v_mfma_f32_16x16x32_bf16 v[208:211], a[48:51], a[240:243], v[208:211]
    s_waitcnt vmcnt(7)
    buffer_load_dwordx4 v247, s[4:7], s56 offen offset:1024 lds
    v_mfma_f32_16x16x32_bf16 v[204:207], a[52:55], a[240:243], v[204:207]
    s_add_u32 m0, s50, 0
    ds_read_b64_tr_b16 a[60:61], v254 offset:61440
    ds_read_b64_tr_b16 a[62:63], v255 offset:61440
    v_mfma_f32_16x16x32_bf16 v[200:203], a[56:59], a[240:243], v[200:203]
    s_add_u32 s56, s56, s42
    ds_read_b128 a[240:243], v224 offset:18624
    ds_read_b64_tr_b16 a[64:65], v254 offset:61472
    ds_read_b64_tr_b16 a[66:67], v255 offset:61472
    ds_read_b64_tr_b16 a[68:69], v254 offset:61504
    ds_read_b64_tr_b16 a[70:71], v255 offset:61504
    buffer_load_dwordx4 v251, s[8:11], s57 offen lds
    s_waitcnt lgkmcnt(5)
    v_mfma_f32_16x16x32_bf16 v[220:223], a[60:63], a[220:223], v[220:223]
    v_mfma_f32_16x16x32_bf16 v[208:211], a[60:63], a[244:247], v[208:211]
    s_waitcnt lgkmcnt(2)
    buffer_load_dwordx4 v252, s[8:11], s57 offen offset:1024 lds
    v_mfma_f32_16x16x32_bf16 v[216:219], a[64:67], a[220:223], v[216:219]
    s_waitcnt lgkmcnt(0)
    v_mfma_f32_16x16x32_bf16 v[212:215], a[68:71], a[220:223], v[212:215]
    ds_read_b128 a[220:223], v224 offset:15616
    v_mfma_f32_16x16x32_bf16 v[204:207], a[64:67], a[244:247], v[204:207]
    v_mfma_f32_16x16x32_bf16 v[200:203], a[68:71], a[244:247], v[200:203]
    ds_read_b128 a[244:247], v224 offset:18688
    v_cvt_pk_bf16_f32 v0, v220, v221
    v_cvt_pk_bf16_f32 v1, v222, v223
    v_mfma_f32_16x16x32_bf16 v[220:223], a[0:3], a[248:251], 0
    v_cvt_pk_bf16_f32 v2, v216, v217
    v_cvt_pk_bf16_f32 v3, v218, v219
    v_mfma_f32_16x16x32_bf16 v[220:223], a[12:15], a[252:255], v[220:223]
    v_cvt_pk_bf16_f32 v4, v212, v213
    v_cvt_pk_bf16_f32 v5, v214, v215
    v_mfma_f32_16x16x32_bf16 v[216:219], a[4:7], a[248:251], 0
    v_cvt_pk_bf16_f32 v24, v208, v209
    v_cvt_pk_bf16_f32 v25, v210, v211
    v_mfma_f32_16x16x32_bf16 v[216:219], a[16:19], a[252:255], v[216:219]
    v_cvt_pk_bf16_f32 v26, v204, v205
    v_cvt_pk_bf16_f32 v27, v206, v207
    v_mfma_f32_16x16x32_bf16 v[212:215], a[8:11], a[248:251], 0
    v_cvt_pk_bf16_f32 v28, v200, v201
    v_cvt_pk_bf16_f32 v29, v202, v203
    v_mfma_f32_16x16x32_bf16 v[212:215], a[20:23], a[252:255], v[212:215]
    s_waitcnt lgkmcnt(1)
    ds_read_b128 a[248:251], v224 offset:18752
    ds_read_b128 a[252:255], v224 offset:18816
    v_mfma_f32_16x16x32_bf16 v[220:223], a[24:27], a[220:223], v[220:223]
    buffer_load_dwordx4 v253, s[8:11], s57 offen offset:2048 lds
    v_mfma_f32_16x16x32_bf16 v[220:223], a[36:39], a[224:227], v[220:223]
    s_add_u32 s57, s49, 0x9300
    s_add_u32 m0, s50, 0x3000
    v_mfma_f32_16x16x32_bf16 v[216:219], a[28:31], a[220:223], v[216:219]
    buffer_load_dwordx4 v251, s[8:11], s57 offen lds
    v_mfma_f32_16x16x32_bf16 v[216:219], a[40:43], a[224:227], v[216:219]
    v_mfma_f32_16x16x32_bf16 v[212:215], a[32:35], a[220:223], v[212:215]
    ds_read_b128 a[220:223], v224 offset:18880
    v_mfma_f32_16x16x32_bf16 v[212:215], a[44:47], a[224:227], v[212:215]
    ds_read_b128 a[224:227], v227 offset:6144
    v_mfma_f32_16x16x32_bf16 v[220:223], a[48:51], a[228:231], v[220:223]
    buffer_load_dwordx4 v252, s[8:11], s57 offen offset:1024 lds
    v_mfma_f32_16x16x32_bf16 v[220:223], a[60:63], a[232:235], v[220:223]
    v_mfma_f32_16x16x32_bf16 v[216:219], a[52:55], a[228:231], v[216:219]
    v_mfma_f32_16x16x32_bf16 v[216:219], a[64:67], a[232:235], v[216:219]
    buffer_load_dwordx4 v253, s[8:11], s57 offen offset:2048 lds
    v_mfma_f32_16x16x32_bf16 v[212:215], a[56:59], a[228:231], v[212:215]
    s_add_u32 s57, s49, 0x12300
    ds_read_b128 a[228:231], v227 offset:6208
    s_add_u32 m0, s50, 0x6000
    v_mfma_f32_16x16x32_bf16 v[212:215], a[68:71], a[232:235], v[212:215]
    v_cvt_pk_bf16_f32 v6, v220, v221
    v_cvt_pk_bf16_f32 v7, v222, v223
    v_mfma_f32_16x16x32_bf16 v[208:211], a[0:3], a[236:239], 0
    v_cvt_pk_bf16_f32 v8, v216, v217
    v_cvt_pk_bf16_f32 v9, v218, v219
    v_mfma_f32_16x16x32_bf16 v[208:211], a[12:15], a[240:243], v[208:211]
    ds_read_b128 a[232:235], v227 offset:6272
    v_mfma_f32_16x16x32_bf16 v[204:207], a[4:7], a[236:239], 0
    v_cvt_pk_bf16_f32 v10, v212, v213
    v_cvt_pk_bf16_f32 v11, v214, v215
    v_mfma_f32_16x16x32_bf16 v[204:207], a[16:19], a[240:243], v[204:207]
    buffer_load_dwordx4 v251, s[8:11], s57 offen lds
    v_mfma_f32_16x16x32_bf16 v[200:203], a[8:11], a[236:239], 0
    ds_read_b128 a[236:239], v227 offset:6336
    v_mfma_f32_16x16x32_bf16 v[200:203], a[20:23], a[240:243], v[200:203]
    s_waitcnt lgkmcnt(3)
    ds_read_b128 a[240:243], v227 offset:6400
    v_mfma_f32_16x16x32_bf16 v[208:211], a[24:27], a[244:247], v[208:211]
    buffer_load_dwordx4 v252, s[8:11], s57 offen offset:1024 lds
    v_mfma_f32_16x16x32_bf16 v[208:211], a[36:39], a[248:251], v[208:211]
    v_mfma_f32_16x16x32_bf16 v[204:207], a[28:31], a[244:247], v[204:207]
    v_mfma_f32_16x16x32_bf16 v[204:207], a[40:43], a[248:251], v[204:207]
    v_mfma_f32_16x16x32_bf16 v[200:203], a[32:35], a[244:247], v[200:203]
    ds_read_b128 a[244:247], v227 offset:6464
    v_mfma_f32_16x16x32_bf16 v[200:203], a[44:47], a[248:251], v[200:203]
    buffer_load_dwordx4 v253, s[8:11], s57 offen offset:2048 lds
    v_mfma_f32_16x16x32_bf16 v[208:211], a[48:51], a[252:255], v[208:211]
    s_add_u32 s57, s49, 0x1b300
    s_add_u32 m0, s50, 0x9000
    v_mfma_f32_16x16x32_bf16 v[208:211], a[60:63], a[220:223], v[208:211]
    v_mfma_f32_16x16x32_bf16 v[204:207], a[52:55], a[252:255], v[204:207]
    s_waitcnt vmcnt(13)
    buffer_load_dwordx4 v251, s[8:11], s57 offen lds
    v_mfma_f32_16x16x32_bf16 v[204:207], a[64:67], a[220:223], v[204:207]
    s_barrier
    ds_read_b128 a[248:251], v224 offset:30976
    v_mfma_f32_16x16x32_bf16 v[200:203], a[56:59], a[252:255], v[200:203]
    ds_read_b128 a[252:255], v224 offset:31040
    v_mfma_f32_16x16x32_bf16 v[200:203], a[68:71], a[220:223], v[200:203]
    v_cvt_pk_bf16_f32 v30, v208, v209
    v_cvt_pk_bf16_f32 v31, v210, v211
    v_mfma_f32_16x16x32_bf16 v[220:223], a[0:3], a[224:227], 0
    s_waitcnt lgkmcnt(2)
    v_cvt_pk_bf16_f32 v32, v204, v205
    v_cvt_pk_bf16_f32 v33, v206, v207
    v_mfma_f32_16x16x32_bf16 v[220:223], a[12:15], a[228:231], v[220:223]
    ds_read_b128 a[220:223], v224 offset:31104
    v_mfma_f32_16x16x32_bf16 v[216:219], a[4:7], a[224:227], 0
    v_cvt_pk_bf16_f32 v34, v200, v201
    v_cvt_pk_bf16_f32 v35, v202, v203
    v_mfma_f32_16x16x32_bf16 v[216:219], a[16:19], a[228:231], v[216:219]
    buffer_load_dwordx4 v252, s[8:11], s57 offen offset:1024 lds
    v_mfma_f32_16x16x32_bf16 v[212:215], a[8:11], a[224:227], 0
    ds_read_b128 a[224:227], v224 offset:31168
    v_mfma_f32_16x16x32_bf16 v[212:215], a[20:23], a[228:231], v[212:215]
    ds_read_b128 a[228:231], v224 offset:31232
    v_mfma_f32_16x16x32_bf16 v[220:223], a[24:27], a[232:235], v[220:223]
    buffer_load_dwordx4 v253, s[8:11], s57 offen offset:2048 lds
    v_mfma_f32_16x16x32_bf16 v[220:223], a[36:39], a[236:239], v[220:223]
    s_add_u32 s57, s49, 0x24300
    s_add_u32 m0, s50, 0xc000
    v_mfma_f32_16x16x32_bf16 v[216:219], a[28:31], a[232:235], v[216:219]
    v_mfma_f32_16x16x32_bf16 v[216:219], a[40:43], a[236:239], v[216:219]
    buffer_load_dwordx4 v251, s[8:11], s57 offen lds
    v_mfma_f32_16x16x32_bf16 v[212:215], a[32:35], a[232:235], v[212:215]
    ds_read_b128 a[232:235], v224 offset:31296
    v_mfma_f32_16x16x32_bf16 v[212:215], a[44:47], a[236:239], v[212:215]
    ds_read_b128 a[236:239], v224 offset:34048
    v_mfma_f32_16x16x32_bf16 v[220:223], a[48:51], a[240:243], v[220:223]
    v_mfma_f32_16x16x32_bf16 v[220:223], a[60:63], a[244:247], v[220:223]
    s_waitcnt vmcnt(13)
    buffer_load_dwordx4 v252, s[8:11], s57 offen offset:1024 lds
    v_mfma_f32_16x16x32_bf16 v[216:219], a[52:55], a[240:243], v[216:219]
    s_barrier
    v_mfma_f32_16x16x32_bf16 v[216:219], a[64:67], a[244:247], v[216:219]
    v_mfma_f32_16x16x32_bf16 v[212:215], a[56:59], a[240:243], v[212:215]
    ds_read_b128 a[240:243], v224 offset:34112
    v_mfma_f32_16x16x32_bf16 v[212:215], a[68:71], a[244:247], v[212:215]
    s_waitcnt lgkmcnt(3)
    ds_read_b128 a[244:247], v224 offset:34176
    v_cvt_pk_bf16_f32 v48, v220, v221
    v_mfma_f32_16x16x32_bf16 v[208:211], a[0:3], a[248:251], 0
    v_cvt_pk_bf16_f32 v49, v222, v223
    v_mfma_f32_16x16x32_bf16 v[208:211], a[12:15], a[252:255], v[208:211]
    v_cvt_pk_bf16_f32 v50, v216, v217
    v_cvt_pk_bf16_f32 v51, v218, v219
    v_mfma_f32_16x16x32_bf16 v[204:207], a[4:7], a[248:251], 0
    v_cvt_pk_bf16_f32 v52, v212, v213
    v_cvt_pk_bf16_f32 v53, v214, v215
    v_mfma_f32_16x16x32_bf16 v[204:207], a[16:19], a[252:255], v[204:207]
    buffer_load_dwordx4 v253, s[8:11], s57 offen offset:2048 lds
    v_mfma_f32_16x16x32_bf16 v[200:203], a[8:11], a[248:251], 0
    s_add_u32 s57, s49, 0x2d300
    ds_read_b128 a[248:251], v224 offset:34240
    s_add_u32 m0, s50, 0xf000
    v_mfma_f32_16x16x32_bf16 v[200:203], a[20:23], a[252:255], v[200:203]
    ds_read_b128 a[252:255], v224 offset:34304
    v_mfma_f32_16x16x32_bf16 v[208:211], a[24:27], a[220:223], v[208:211]
    buffer_load_dwordx4 v251, s[8:11], s57 offen lds
    v_mfma_f32_16x16x32_bf16 v[208:211], a[36:39], a[224:227], v[208:211]
    v_mfma_f32_16x16x32_bf16 v[204:207], a[28:31], a[220:223], v[204:207]
    buffer_load_dwordx4 v252, s[8:11], s57 offen offset:1024 lds
    v_mfma_f32_16x16x32_bf16 v[204:207], a[40:43], a[224:227], v[204:207]
    s_waitcnt vmcnt(14)
    ds_read_b64_tr_b16 a[72:73], v254
    ds_read_b64_tr_b16 a[74:75], v255
    v_mfma_f32_16x16x32_bf16 v[200:203], a[32:35], a[220:223], v[200:203]
    ds_read_b128 a[220:223], v224 offset:34368
    ds_read_b64_tr_b16 a[76:77], v254 offset:32
    v_mfma_f32_16x16x32_bf16 v[200:203], a[44:47], a[224:227], v[200:203]
    ds_read_b128 a[224:227], v224 offset:46464
    v_mfma_f32_16x16x32_bf16 v[208:211], a[48:51], a[228:231], v[208:211]
    s_waitcnt lgkmcnt(6)
    buffer_load_dwordx4 v253, s[8:11], s57 offen offset:2048 lds
    v_mfma_f32_16x16x32_bf16 v[208:211], a[60:63], a[232:235], v[208:211]
    s_add_u32 s57, s49, 0
    ds_read_b64_tr_b16 a[78:79], v255 offset:32
    ds_read_b64_tr_b16 a[80:81], v254 offset:64
    v_mfma_f32_16x16x32_bf16 v[204:207], a[52:55], a[228:231], v[204:207]
    s_add_u32 m0, s50, 0
    ds_read_b64_tr_b16 a[82:83], v255 offset:64
    v_mfma_f32_16x16x32_bf16 v[204:207], a[64:67], a[232:235], v[204:207]
    v_mfma_f32_16x16x32_bf16 v[200:203], a[56:59], a[228:231], v[200:203]
    v_cvt_pk_bf16_f32 v12, v208, v209
    v_cvt_pk_bf16_f32 v13, v210, v211
    v_mfma_f32_16x16x32_bf16 v[200:203], a[68:71], a[232:235], v[200:203]
    ds_read_b128 a[228:231], v224 offset:46528
    ds_read_b128 a[232:235], v224 offset:46592
    v_mfma_f32_16x16x32_bf16 v[220:223], a[0:3], a[236:239], 0
    v_mfma_f32_16x16x32_bf16 v[220:223], a[12:15], a[240:243], v[220:223]
    v_cvt_pk_bf16_f32 v14, v204, v205
    v_cvt_pk_bf16_f32 v15, v206, v207
    v_mfma_f32_16x16x32_bf16 v[216:219], a[4:7], a[236:239], 0
    s_waitcnt lgkmcnt(2)
    buffer_load_dwordx4 v251, s[8:11], s57 offen lds
    v_mfma_f32_16x16x32_bf16 v[216:219], a[16:19], a[240:243], v[216:219]
    v_cvt_pk_bf16_f32 v16, v200, v201
    v_cvt_pk_bf16_f32 v17, v202, v203
    v_mfma_f32_16x16x32_bf16 v[212:215], a[8:11], a[236:239], 0
    s_waitcnt vmcnt(13)
    ds_read_b128 a[236:239], v224 offset:46656
    ds_read_b64_tr_b16 a[84:85], v254 offset:12288
    v_mfma_f32_16x16x32_bf16 v[212:215], a[20:23], a[240:243], v[212:215]
    ds_read_b128 a[240:243], v224 offset:46720
    v_mfma_f32_16x16x32_bf16 v[220:223], a[24:27], a[244:247], v[220:223]
    buffer_load_dwordx4 v252, s[8:11], s57 offen offset:1024 lds
    v_mfma_f32_16x16x32_bf16 v[220:223], a[36:39], a[248:251], v[220:223]
    buffer_load_dwordx4 v253, s[8:11], s57 offen offset:2048 lds
    v_mfma_f32_16x16x32_bf16 v[216:219], a[28:31], a[244:247], v[216:219]
    s_add_u32 s57, s49, 0x9000
    ds_read_b64_tr_b16 a[86:87], v255 offset:12288
    ds_read_b64_tr_b16 a[88:89], v254 offset:12320
    v_mfma_f32_16x16x32_bf16 v[216:219], a[40:43], a[248:251], v[216:219]
    s_add_u32 m0, s50, 0x3000
    ds_read_b64_tr_b16 a[90:91], v255 offset:12320
    ds_read_b64_tr_b16 a[92:93], v254 offset:12352
    v_mfma_f32_16x16x32_bf16 v[212:215], a[32:35], a[244:247], v[212:215]
    ds_read_b128 a[244:247], v224 offset:46784
    ds_read_b64_tr_b16 a[94:95], v255 offset:12352
    v_mfma_f32_16x16x32_bf16 v[212:215], a[44:47], a[248:251], v[212:215]
    ds_read_b128 a[248:251], v224 offset:49536
    v_mfma_f32_16x16x32_bf16 v[220:223], a[48:51], a[252:255], v[220:223]
    v_mfma_f32_16x16x32_bf16 v[220:223], a[60:63], a[220:223], v[220:223]
    v_mfma_f32_16x16x32_bf16 v[216:219], a[52:55], a[252:255], v[216:219]
    s_waitcnt vmcnt(12)
    ds_read_b64_tr_b16 a[96:97], v254 offset:24576
    ds_read_b64_tr_b16 a[98:99], v255 offset:24576
    v_mfma_f32_16x16x32_bf16 v[216:219], a[64:67], a[220:223], v[216:219]
    ds_read_b64_tr_b16 a[100:101], v254 offset:24608
    ds_read_b64_tr_b16 a[102:103], v255 offset:24608
    v_mfma_f32_16x16x32_bf16 v[212:215], a[56:59], a[252:255], v[212:215]
    ds_read_b128 a[252:255], v224 offset:49600
    v_cvt_pk_bf16_f32 v36, v220, v221
    v_mfma_f32_16x16x32_bf16 v[212:215], a[68:71], a[220:223], v[212:215]
    ds_read_b128 a[220:223], v224 offset:49664
    v_cvt_pk_bf16_f32 v37, v222, v223
    v_mfma_f32_16x16x32_bf16 v[208:211], a[0:3], a[224:227], 0
    s_waitcnt lgkmcnt(8)
    v_cvt_pk_bf16_f32 v38, v216, v217
    v_cvt_pk_bf16_f32 v39, v218, v219
    v_mfma_f32_16x16x32_bf16 v[208:211], a[12:15], a[228:231], v[208:211]
    s_waitcnt lgkmcnt(7)
    buffer_load_dwordx4 v251, s[8:11], s57 offen lds
    v_mfma_f32_16x16x32_bf16 v[204:207], a[4:7], a[224:227], 0
    v_cvt_pk_bf16_f32 v40, v212, v213
    v_cvt_pk_bf16_f32 v41, v214, v215
    v_mfma_f32_16x16x32_bf16 v[204:207], a[16:19], a[228:231], v[204:207]
    buffer_load_dwordx4 v252, s[8:11], s57 offen offset:1024 lds
    v_mfma_f32_16x16x32_bf16 v[200:203], a[8:11], a[224:227], 0
    ds_read_b128 a[224:227], v224 offset:49728
    ds_read_b64_tr_b16 a[104:105], v254 offset:24640
    v_mfma_f32_16x16x32_bf16 v[200:203], a[20:23], a[228:231], v[200:203]
    ds_read_b128 a[228:231], v224 offset:49792
    v_mfma_f32_16x16x32_bf16 v[208:211], a[24:27], a[232:235], v[208:211]
    s_waitcnt vmcnt(11)
    buffer_load_dwordx4 v253, s[8:11], s57 offen offset:2048 lds
    v_mfma_f32_16x16x32_bf16 v[208:211], a[36:39], a[236:239], v[208:211]
    s_add_u32 s57, s49, 0x12000
    ds_read_b64_tr_b16 a[106:107], v255 offset:24640
    ds_read_b64_tr_b16 a[108:109], v254 offset:36864
    v_mfma_f32_16x16x32_bf16 v[204:207], a[28:31], a[232:235], v[204:207]
    s_add_u32 m0, s50, 0x6000
    ds_read_b64_tr_b16 a[110:111], v255 offset:36864
    ds_read_b64_tr_b16 a[112:113], v254 offset:36896
    v_mfma_f32_16x16x32_bf16 v[204:207], a[40:43], a[236:239], v[204:207]
    ds_read_b64_tr_b16 a[114:115], v255 offset:36896
    ds_read_b64_tr_b16 a[116:117], v254 offset:36928
    v_mfma_f32_16x16x32_bf16 v[200:203], a[32:35], a[232:235], v[200:203]
    ds_read_b128 a[232:235], v224 offset:49856
    ds_read_b64_tr_b16 a[118:119], v255 offset:36928
    v_mfma_f32_16x16x32_bf16 v[200:203], a[44:47], a[236:239], v[200:203]
    ds_read_b128 a[236:239], v227 offset:37120
    v_mfma_f32_16x16x32_bf16 v[208:211], a[48:51], a[240:243], v[208:211]
    v_mfma_f32_16x16x32_bf16 v[208:211], a[60:63], a[244:247], v[208:211]
    s_waitcnt lgkmcnt(8)
    buffer_load_dwordx4 v251, s[8:11], s57 offen lds
    v_mfma_f32_16x16x32_bf16 v[204:207], a[52:55], a[240:243], v[204:207]
    buffer_load_dwordx4 v252, s[8:11], s57 offen offset:1024 lds
    v_mfma_f32_16x16x32_bf16 v[204:207], a[64:67], a[244:247], v[204:207]
    v_mfma_f32_16x16x32_bf16 v[200:203], a[56:59], a[240:243], v[200:203]
    ds_read_b128 a[240:243], v227 offset:37184
    v_mfma_f32_16x16x32_bf16 v[200:203], a[68:71], a[244:247], v[200:203]
    ds_read_b128 a[244:247], v227 offset:37248
    v_cvt_pk_bf16_f32 v18, v208, v209
    v_mfma_f32_16x16x32_bf16 v[220:223], a[0:3], a[248:251], 0
    v_cvt_pk_bf16_f32 v19, v210, v211
    v_mfma_f32_16x16x32_bf16 v[220:223], a[12:15], a[252:255], v[220:223]
    v_cvt_pk_bf16_f32 v20, v204, v205
    v_cvt_pk_bf16_f32 v21, v206, v207
    v_mfma_f32_16x16x32_bf16 v[216:219], a[4:7], a[248:251], 0
    v_cvt_pk_bf16_f32 v22, v200, v201
    v_cvt_pk_bf16_f32 v23, v202, v203
    v_mfma_f32_16x16x32_bf16 v[216:219], a[16:19], a[252:255], v[216:219]
    s_waitcnt vmcnt(11)
    buffer_load_dwordx4 v253, s[8:11], s57 offen offset:2048 lds
    v_mfma_f32_16x16x32_bf16 v[212:215], a[8:11], a[248:251], 0
    s_add_u32 s57, s49, 0x1b000
    ds_read_b128 a[248:251], v227 offset:37312
    ds_read_b64_tr_b16 a[120:121], v254 offset:49152
    v_mfma_f32_16x16x32_bf16 v[212:215], a[20:23], a[252:255], v[212:215]
    s_add_u32 m0, s50, 0x9000
    ds_read_b128 a[252:255], v227 offset:37376
    v_mfma_f32_16x16x32_bf16 v[220:223], a[24:27], a[220:223], v[220:223]
    s_waitcnt lgkmcnt(4)
    buffer_load_dwordx4 v251, s[8:11], s57 offen lds
    v_mfma_f32_16x16x32_bf16 v[220:223], a[36:39], a[224:227], v[220:223]
    ds_read_b64_tr_b16 a[122:123], v255 offset:49152
    ds_read_b64_tr_b16 a[124:125], v254 offset:49184
    v_mfma_f32_16x16x32_bf16 v[216:219], a[28:31], a[220:223], v[216:219]
    ds_read_b64_tr_b16 a[126:127], v255 offset:49184
    ds_read_b64_tr_b16 a[128:129], v254 offset:49216
    v_mfma_f32_16x16x32_bf16 v[216:219], a[40:43], a[224:227], v[216:219]
    buffer_load_dwordx4 v252, s[8:11], s57 offen offset:1024 lds
    v_mfma_f32_16x16x32_bf16 v[212:215], a[32:35], a[220:223], v[212:215]
    ds_read_b128 a[220:223], v227 offset:37440
    ds_read_b64_tr_b16 a[130:131], v255 offset:49216
    v_mfma_f32_16x16x32_bf16 v[212:215], a[44:47], a[224:227], v[212:215]
    ds_read_b128 a[224:227], v224
    v_mfma_f32_16x16x32_bf16 v[220:223], a[48:51], a[228:231], v[220:223]
    v_mfma_f32_16x16x32_bf16 v[220:223], a[60:63], a[232:235], v[220:223]
    s_waitcnt vmcnt(11)
    buffer_load_dwordx4 v253, s[8:11], s57 offen offset:2048 lds
    v_mfma_f32_16x16x32_bf16 v[216:219], a[52:55], a[228:231], v[216:219]
    s_add_u32 s57, s49, 0x24000
    ds_read_b64_tr_b16 a[132:133], v254 offset:61440
    ds_read_b64_tr_b16 a[134:135], v255 offset:61440
    v_mfma_f32_16x16x32_bf16 v[216:219], a[64:67], a[232:235], v[216:219]
    s_add_u32 m0, s50, 0xc000
    ds_read_b64_tr_b16 a[136:137], v254 offset:61472
    v_cvt_pk_bf16_f32 v42, v220, v221
    v_mfma_f32_16x16x32_bf16 v[212:215], a[56:59], a[228:231], v[212:215]
    ds_read_b128 a[228:231], v224 offset:64
    v_cvt_pk_bf16_f32 v43, v222, v223
    v_mfma_f32_16x16x32_bf16 v[212:215], a[68:71], a[232:235], v[212:215]
    ds_read_b128 a[232:235], v224 offset:128
    v_cvt_pk_bf16_f32 v44, v216, v217
    v_mfma_f32_16x16x32_bf16 v[208:211], a[0:3], a[236:239], 0
    ds_read_b64_tr_b16 a[138:139], v255 offset:61472
    v_cvt_pk_bf16_f32 v45, v218, v219
    v_mfma_f32_16x16x32_bf16 v[208:211], a[12:15], a[240:243], v[208:211]
    s_waitcnt lgkmcnt(7)
    buffer_load_dwordx4 v251, s[8:11], s57 offen lds
    v_mfma_f32_16x16x32_bf16 v[204:207], a[4:7], a[236:239], 0
    v_cvt_pk_bf16_f32 v46, v212, v213
    v_cvt_pk_bf16_f32 v47, v214, v215
    v_mfma_f32_16x16x32_bf16 v[204:207], a[16:19], a[240:243], v[204:207]
    ds_read_b64_tr_b16 a[140:141], v254 offset:61504
    ds_read_b64_tr_b16 a[142:143], v255 offset:61504
    v_mfma_f32_16x16x32_bf16 v[200:203], a[8:11], a[236:239], 0
    ds_read_b128 a[236:239], v224 offset:192
    v_mfma_f32_16x16x32_bf16 v[200:203], a[20:23], a[240:243], v[200:203]
    ds_read_b128 a[240:243], v224 offset:256
    v_mfma_f32_16x16x32_bf16 v[208:211], a[24:27], a[244:247], v[208:211]
    buffer_load_dwordx4 v252, s[8:11], s57 offen offset:1024 lds
    v_mfma_f32_16x16x32_bf16 v[208:211], a[36:39], a[248:251], v[208:211]
    v_mfma_f32_16x16x32_bf16 v[204:207], a[28:31], a[244:247], v[204:207]
    s_waitcnt vmcnt(11)
    buffer_load_dwordx4 v253, s[8:11], s57 offen offset:2048 lds
    v_mfma_f32_16x16x32_bf16 v[204:207], a[40:43], a[248:251], v[204:207]
    s_add_u32 s57, s49, 0x2d000
    ds_read_b64_tr_b16 a[144:145], v254
    ds_read_b64_tr_b16 a[146:147], v255
    v_mfma_f32_16x16x32_bf16 v[200:203], a[32:35], a[244:247], v[200:203]
    s_add_u32 m0, s50, 0xf000
    ds_read_b128 a[244:247], v224 offset:320
    ds_read_b64_tr_b16 a[148:149], v254 offset:32
    v_mfma_f32_16x16x32_bf16 v[200:203], a[44:47], a[248:251], v[200:203]
    ds_read_b128 a[248:251], v224 offset:3072
    v_mfma_f32_16x16x32_bf16 v[208:211], a[48:51], a[252:255], v[208:211]
    s_waitcnt lgkmcnt(6)
    buffer_load_dwordx4 v251, s[8:11], s57 offen lds
    v_mfma_f32_16x16x32_bf16 v[208:211], a[60:63], a[220:223], v[208:211]
    ds_read_b64_tr_b16 a[150:151], v255 offset:32
    ds_read_b64_tr_b16 a[152:153], v254 offset:64
    v_mfma_f32_16x16x32_bf16 v[204:207], a[52:55], a[252:255], v[204:207]
    ds_read_b64_tr_b16 a[154:155], v255 offset:64
    v_mfma_f32_16x16x32_bf16 v[204:207], a[64:67], a[220:223], v[204:207]
    v_mfma_f32_16x16x32_bf16 v[200:203], a[56:59], a[252:255], v[200:203]
    ds_read_b128 a[252:255], v224 offset:3136
    v_mfma_f32_16x16x32_bf16 v[200:203], a[68:71], a[220:223], v[200:203]
    v_cvt_pk_bf16_f32 v54, v208, v209
    v_cvt_pk_bf16_f32 v55, v210, v211
    v_mfma_f32_16x16x32_bf16 v[220:223], a[224:227], a[72:75], 0
    ds_read_b128 a[220:223], v224 offset:3200
    v_mfma_f32_16x16x32_bf16 v[220:223], a[228:231], a[84:87], v[220:223]
    v_cvt_pk_bf16_f32 v56, v204, v205
    v_cvt_pk_bf16_f32 v57, v206, v207
    v_mfma_f32_16x16x32_bf16 v[216:219], a[224:227], a[76:79], 0
    v_cvt_pk_bf16_f32 v58, v200, v201
    v_cvt_pk_bf16_f32 v59, v202, v203
    v_mfma_f32_16x16x32_bf16 v[216:219], a[228:231], a[88:91], v[216:219]
    buffer_load_dwordx4 v252, s[8:11], s57 offen offset:1024 lds
    v_mfma_f32_16x16x32_bf16 v[212:215], a[224:227], a[80:83], 0
    s_waitcnt vmcnt(11)
    ds_read_b128 a[224:227], v224 offset:3264
    ds_read_b64_tr_b16 a[156:157], v254 offset:12288
    v_mfma_f32_16x16x32_bf16 v[212:215], a[228:231], a[92:95], v[212:215]
    ds_read_b128 a[228:231], v224 offset:3328
    v_mfma_f32_16x16x32_bf16 v[220:223], a[232:235], a[96:99], v[220:223]
    buffer_load_dwordx4 v253, s[8:11], s57 offen offset:2048 lds
    v_mfma_f32_16x16x32_bf16 v[220:223], a[236:239], a[108:111], v[220:223]
    s_add_u32 s57, s49, 0
    ds_read_b64_tr_b16 a[158:159], v255 offset:12288
    ds_read_b64_tr_b16 a[160:161], v254 offset:12320
    v_mfma_f32_16x16x32_bf16 v[216:219], a[232:235], a[100:103], v[216:219]
    s_add_u32 m0, s50, 0
    ds_read_b64_tr_b16 a[162:163], v255 offset:12320
    ds_read_b64_tr_b16 a[164:165], v254 offset:12352
    v_mfma_f32_16x16x32_bf16 v[216:219], a[236:239], a[112:115], v[216:219]
    s_waitcnt lgkmcnt(7)
    buffer_load_dwordx4 v192, s[12:15], s57 offen lds
    v_mfma_f32_16x16x32_bf16 v[212:215], a[232:235], a[104:107], v[212:215]
    ds_read_b128 a[232:235], v224 offset:3392
    ds_read_b64_tr_b16 a[166:167], v255 offset:12352
    v_mfma_f32_16x16x32_bf16 v[212:215], a[236:239], a[116:119], v[212:215]
    ds_read_b128 a[236:239], v224 offset:15488
    v_mfma_f32_16x16x32_bf16 v[220:223], a[240:243], a[120:123], v[220:223]
    buffer_load_dwordx4 v193, s[12:15], s57 offen offset:1024 lds
    v_mfma_f32_16x16x32_bf16 v[220:223], a[244:247], a[132:135], v[220:223]
    v_mfma_f32_16x16x32_bf16 v[216:219], a[240:243], a[124:127], v[216:219]
    s_waitcnt vmcnt(11)
    ds_read_b64_tr_b16 a[168:169], v254 offset:24576
    ds_read_b64_tr_b16 a[170:171], v255 offset:24576
    v_mfma_f32_16x16x32_bf16 v[216:219], a[244:247], a[136:139], v[216:219]
    ds_read_b64_tr_b16 a[172:173], v254 offset:24608
    ds_read_b64_tr_b16 a[174:175], v255 offset:24608
    v_mfma_f32_16x16x32_bf16 v[212:215], a[240:243], a[128:131], v[212:215]
    ds_read_b128 a[240:243], v224 offset:15552
    v_cvt_pk_bf16_f32 v66, v220, v221
    v_mfma_f32_16x16x32_bf16 v[212:215], a[244:247], a[140:143], v[212:215]
    ds_read_b128 a[244:247], v224 offset:15616
    v_cvt_pk_bf16_f32 v67, v222, v223
    v_mfma_f32_16x16x32_bf16 v[208:211], a[248:251], a[72:75], 0
    v_cvt_pk_bf16_f32 v88, v216, v217
    v_cvt_pk_bf16_f32 v89, v218, v219
    v_mfma_f32_16x16x32_bf16 v[208:211], a[252:255], a[84:87], v[208:211]
    buffer_load_dwordx4 v194, s[12:15], s57 offen offset:2048 lds
    v_mfma_f32_16x16x32_bf16 v[204:207], a[248:251], a[76:79], 0
    s_add_u32 s57, s49, 0x3000
    v_cvt_pk_bf16_f32 v110, v212, v213
    v_cvt_pk_bf16_f32 v111, v214, v215
    v_mfma_f32_16x16x32_bf16 v[204:207], a[252:255], a[88:91], v[204:207]
    s_add_u32 m0, s50, 0x3000
    ds_read_b64_tr_b16 a[176:177], v254 offset:24640
    ds_read_b64_tr_b16 a[178:179], v255 offset:24640
    v_mfma_f32_16x16x32_bf16 v[200:203], a[248:251], a[80:83], 0
    ds_read_b128 a[248:251], v224 offset:15680
    v_mfma_f32_16x16x32_bf16 v[200:203], a[252:255], a[92:95], v[200:203]
    ds_read_b128 a[252:255], v224 offset:15744
    v_mfma_f32_16x16x32_bf16 v[208:211], a[220:223], a[96:99], v[208:211]
    s_waitcnt lgkmcnt(5)
    buffer_load_dwordx4 v192, s[12:15], s57 offen lds
    v_mfma_f32_16x16x32_bf16 v[208:211], a[224:227], a[108:111], v[208:211]
    s_waitcnt vmcnt(10)
    buffer_load_dwordx4 v195, s[12:15], s57 offen offset:1024 lds
    v_mfma_f32_16x16x32_bf16 v[204:207], a[220:223], a[100:103], v[204:207]
    s_addk_i32 s57, 0x3000
    ds_read_b64_tr_b16 a[180:181], v254 offset:36864
    ds_read_b64_tr_b16 a[182:183], v255 offset:36864
    v_mfma_f32_16x16x32_bf16 v[204:207], a[224:227], a[112:115], v[204:207]
    ds_read_b64_tr_b16 a[184:185], v254 offset:36896
    ds_read_b64_tr_b16 a[186:187], v255 offset:36896
    v_mfma_f32_16x16x32_bf16 v[200:203], a[220:223], a[104:107], v[200:203]
    ds_read_b128 a[220:223], v224 offset:15808
    ds_read_b64_tr_b16 a[188:189], v254 offset:36928
    v_mfma_f32_16x16x32_bf16 v[200:203], a[224:227], a[116:119], v[200:203]
    ds_read_b128 a[224:227], v224 offset:18560
    v_mfma_f32_16x16x32_bf16 v[208:211], a[228:231], a[120:123], v[208:211]
    buffer_load_dwordx4 v194, s[12:15], s57 offen offset:2048 lds
    v_mfma_f32_16x16x32_bf16 v[208:211], a[232:235], a[132:135], v[208:211]
    s_add_u32 s57, s49, 0x4800
    ds_read_b64_tr_b16 a[190:191], v255 offset:36928
    s_add_u32 m0, s50, 0x6000
    v_mfma_f32_16x16x32_bf16 v[204:207], a[228:231], a[124:127], v[204:207]
    v_mfma_f32_16x16x32_bf16 v[204:207], a[232:235], a[136:139], v[204:207]
    s_waitcnt lgkmcnt(8)
    buffer_load_dwordx4 v192, s[12:15], s57 offen lds
    v_mfma_f32_16x16x32_bf16 v[200:203], a[228:231], a[128:131], v[200:203]
    ds_read_b128 a[228:231], v224 offset:18624
    v_cvt_pk_bf16_f32 v68, v208, v209
    v_mfma_f32_16x16x32_bf16 v[200:203], a[232:235], a[140:143], v[200:203]
    ds_read_b128 a[232:235], v224 offset:18688
    v_cvt_pk_bf16_f32 v69, v210, v211
    v_mfma_f32_16x16x32_bf16 v[220:223], a[236:239], a[72:75], 0
    v_cvt_pk_bf16_f32 v90, v204, v205
    v_cvt_pk_bf16_f32 v91, v206, v207
    v_mfma_f32_16x16x32_bf16 v[220:223], a[240:243], a[84:87], v[220:223]
    v_mfma_f32_16x16x32_bf16 v[216:219], a[236:239], a[76:79], 0
    buffer_load_dwordx4 v193, s[12:15], s57 offen offset:1024 lds
    v_mfma_f32_16x16x32_bf16 v[216:219], a[240:243], a[88:91], v[216:219]
    v_cvt_pk_bf16_f32 v112, v200, v201
    v_cvt_pk_bf16_f32 v113, v202, v203
    v_mfma_f32_16x16x32_bf16 v[212:215], a[236:239], a[80:83], 0
    s_waitcnt vmcnt(11)
    ds_read_b128 a[236:239], v224 offset:18752
    ds_read_b64_tr_b16 a[192:193], v254 offset:49152
    v_mfma_f32_16x16x32_bf16 v[212:215], a[240:243], a[92:95], v[212:215]
    ds_read_b128 a[240:243], v224 offset:18816
    v_mfma_f32_16x16x32_bf16 v[220:223], a[244:247], a[96:99], v[220:223]
    buffer_load_dwordx4 v194, s[12:15], s57 offen offset:2048 lds
    v_mfma_f32_16x16x32_bf16 v[220:223], a[248:251], a[108:111], v[220:223]
    s_add_u32 s57, s49, 0x9000
    ds_read_b64_tr_b16 a[194:195], v255 offset:49152
    ds_read_b64_tr_b16 a[196:197], v254 offset:49184
    v_mfma_f32_16x16x32_bf16 v[216:219], a[244:247], a[100:103], v[216:219]
    s_add_u32 m0, s50, 0x9000
    ds_read_b64_tr_b16 a[198:199], v255 offset:49184
    ds_read_b64_tr_b16 a[200:201], v254 offset:49216
    v_mfma_f32_16x16x32_bf16 v[216:219], a[248:251], a[112:115], v[216:219]
    ds_read_b64_tr_b16 a[202:203], v255 offset:49216
    v_mfma_f32_16x16x32_bf16 v[212:215], a[244:247], a[104:107], v[212:215]
    ds_read_b128 a[244:247], v224 offset:18880
    v_mfma_f32_16x16x32_bf16 v[212:215], a[248:251], a[116:119], v[212:215]
    ds_read_b128 a[248:251], v227 offset:6144
    v_mfma_f32_16x16x32_bf16 v[220:223], a[252:255], a[120:123], v[220:223]
    s_waitcnt lgkmcnt(9)
    buffer_load_dwordx4 v192, s[12:15], s57 offen lds
    v_mfma_f32_16x16x32_bf16 v[220:223], a[220:223], a[132:135], v[220:223]
    v_mfma_f32_16x16x32_bf16 v[216:219], a[252:255], a[124:127], v[216:219]
    buffer_load_dwordx4 v193, s[12:15], s57 offen offset:1024 lds
    v_mfma_f32_16x16x32_bf16 v[216:219], a[220:223], a[136:139], v[216:219]
    s_waitcnt vmcnt(11)
    ds_read_b64_tr_b16 a[204:205], v254 offset:61440
    ds_read_b64_tr_b16 a[206:207], v255 offset:61440
    v_mfma_f32_16x16x32_bf16 v[212:215], a[252:255], a[128:131], v[212:215]
    ds_read_b128 a[252:255], v227 offset:6208
    ds_read_b64_tr_b16 a[208:209], v254 offset:61472
    v_mfma_f32_16x16x32_bf16 v[212:215], a[220:223], a[140:143], v[212:215]
    v_cvt_pk_bf16_f32 v72, v220, v221
    v_cvt_pk_bf16_f32 v73, v222, v223
    v_mfma_f32_16x16x32_bf16 v[208:211], a[224:227], a[72:75], 0
    v_cvt_pk_bf16_f32 v94, v216, v217
    v_cvt_pk_bf16_f32 v95, v218, v219
    v_mfma_f32_16x16x32_bf16 v[208:211], a[228:231], a[84:87], v[208:211]
    ds_read_b128 a[220:223], v227 offset:6272
    ds_read_b64_tr_b16 a[210:211], v255 offset:61472
    v_mfma_f32_16x16x32_bf16 v[204:207], a[224:227], a[76:79], 0
    v_cvt_pk_bf16_f32 v116, v212, v213
    v_cvt_pk_bf16_f32 v117, v214, v215
    v_mfma_f32_16x16x32_bf16 v[204:207], a[228:231], a[88:91], v[204:207]
    buffer_load_dwordx4 v194, s[12:15], s57 offen offset:2048 lds
    v_mfma_f32_16x16x32_bf16 v[200:203], a[224:227], a[80:83], 0
    s_add_u32 s57, s49, 0xc000
    ds_read_b128 a[224:227], v227 offset:6336
    ds_read_b64_tr_b16 a[212:213], v254 offset:61504
    v_mfma_f32_16x16x32_bf16 v[200:203], a[228:231], a[92:95], v[200:203]
    s_add_u32 m0, s50, 0xc000
    ds_read_b128 a[228:231], v227 offset:6400
    v_mfma_f32_16x16x32_bf16 v[208:211], a[232:235], a[96:99], v[208:211]
    s_waitcnt lgkmcnt(6)
    buffer_load_dwordx4 v192, s[12:15], s57 offen lds
    v_mfma_f32_16x16x32_bf16 v[208:211], a[236:239], a[108:111], v[208:211]
    ds_read_b64_tr_b16 a[214:215], v255 offset:61504
    v_mfma_f32_16x16x32_bf16 v[204:207], a[232:235], a[100:103], v[204:207]
    v_mfma_f32_16x16x32_bf16 v[204:207], a[236:239], a[112:115], v[204:207]
    buffer_load_dwordx4 v195, s[12:15], s57 offen offset:1024 lds
    v_mfma_f32_16x16x32_bf16 v[200:203], a[232:235], a[104:107], v[200:203]
    s_addk_i32 s57, 0x3000
    ds_read_b128 a[232:235], v227 offset:6464
    v_mfma_f32_16x16x32_bf16 v[200:203], a[236:239], a[116:119], v[200:203]
    ds_read_b128 a[236:239], v225 offset:24384
    v_mfma_f32_16x16x32_bf16 v[208:211], a[240:243], a[120:123], v[208:211]
    v_mfma_f32_16x16x32_bf16 v[208:211], a[244:247], a[132:135], v[208:211]
    buffer_load_dwordx4 v194, s[12:15], s57 offen offset:2048 lds
    v_mfma_f32_16x16x32_bf16 v[204:207], a[240:243], a[124:127], v[204:207]
    s_add_u32 s57, s49, 0xd800
    s_add_u32 m0, s50, 0xf000
    v_mfma_f32_16x16x32_bf16 v[204:207], a[244:247], a[136:139], v[204:207]
    v_mfma_f32_16x16x32_bf16 v[200:203], a[240:243], a[128:131], v[200:203]
    ds_read_b128 a[240:243], v225 offset:24448
    v_mfma_f32_16x16x32_bf16 v[200:203], a[244:247], a[140:143], v[200:203]
    v_cvt_pk_bf16_f32 v70, v208, v209
    v_cvt_pk_bf16_f32 v71, v210, v211
    v_mfma_f32_16x16x32_bf16 v[220:223], a[248:251], a[72:75], 0
    ds_read_b128 a[244:247], v225 offset:24512
    v_mfma_f32_16x16x32_bf16 v[220:223], a[252:255], a[84:87], v[220:223]
    v_cvt_pk_bf16_f32 v92, v204, v205
    v_cvt_pk_bf16_f32 v93, v206, v207
    v_mfma_f32_16x16x32_bf16 v[216:219], a[248:251], a[76:79], 0
    v_cvt_pk_bf16_f32 v114, v200, v201
    v_cvt_pk_bf16_f32 v115, v202, v203
    v_mfma_f32_16x16x32_bf16 v[216:219], a[252:255], a[88:91], v[216:219]
    s_waitcnt lgkmcnt(2)
    buffer_load_dwordx4 v192, s[12:15], s57 offen lds
    v_mfma_f32_16x16x32_bf16 v[212:215], a[248:251], a[80:83], 0
    ds_read_b128 a[248:251], v225 offset:24576
    v_mfma_f32_16x16x32_bf16 v[212:215], a[252:255], a[92:95], v[212:215]
    ds_read_b128 a[252:255], v225 offset:24640
    v_mfma_f32_16x16x32_bf16 v[220:223], a[220:223], a[96:99], v[220:223]
    buffer_load_dwordx4 v193, s[12:15], s57 offen offset:1024 lds
    v_mfma_f32_16x16x32_bf16 v[220:223], a[224:227], a[108:111], v[220:223]
    v_mfma_f32_16x16x32_bf16 v[216:219], a[220:223], a[100:103], v[216:219]
    buffer_load_dwordx4 v194, s[12:15], s57 offen offset:2048 lds
    v_mfma_f32_16x16x32_bf16 v[216:219], a[224:227], a[112:115], v[216:219]
    s_add_u32 m0, s41, 0
    v_mfma_f32_16x16x32_bf16 v[212:215], a[220:223], a[104:107], v[212:215]
    ds_read_b128 a[220:223], v225 offset:24704
    v_mfma_f32_16x16x32_bf16 v[212:215], a[224:227], a[116:119], v[212:215]
    ds_read_b128 a[224:227], v225 offset:27456
    v_mfma_f32_16x16x32_bf16 v[220:223], a[228:231], a[120:123], v[220:223]
    v_mfma_f32_16x16x32_bf16 v[220:223], a[232:235], a[132:135], v[220:223]
    v_mfma_f32_16x16x32_bf16 v[216:219], a[228:231], a[124:127], v[216:219]
    v_mfma_f32_16x16x32_bf16 v[216:219], a[232:235], a[136:139], v[216:219]
    v_mfma_f32_16x16x32_bf16 v[212:215], a[228:231], a[128:131], v[212:215]
    ds_read_b128 a[228:231], v225 offset:27520
    v_mfma_f32_16x16x32_bf16 v[212:215], a[232:235], a[140:143], v[212:215]
    ds_read_b128 a[232:235], v225 offset:27584
    v_mfma_f32_16x16x32_bf16 v[208:211], a[144:147], a[236:239], 0
    s_waitcnt lgkmcnt(3)
    v_mfma_f32_16x16x32_bf16 v[208:211], a[156:159], a[240:243], v[208:211]
    v_cvt_pk_bf16_f32 v82, v220, v221
    v_cvt_pk_bf16_f32 v83, v222, v223
    v_mfma_f32_16x16x32_bf16 v[204:207], a[148:151], a[236:239], 0
    v_cvt_pk_bf16_f32 v104, v216, v217
    v_cvt_pk_bf16_f32 v105, v218, v219
    v_mfma_f32_16x16x32_bf16 v[204:207], a[160:163], a[240:243], v[204:207]
    v_cvt_pk_bf16_f32 v126, v212, v213
    v_cvt_pk_bf16_f32 v127, v214, v215
    v_mfma_f32_16x16x32_bf16 v[200:203], a[152:155], a[236:239], 0
    ds_read_b128 a[236:239], v225 offset:27648
    v_mfma_f32_16x16x32_bf16 v[200:203], a[164:167], a[240:243], v[200:203]
    ds_read_b128 a[240:243], v225 offset:27712
    v_mfma_f32_16x16x32_bf16 v[208:211], a[168:171], a[244:247], v[208:211]
    v_mfma_f32_16x16x32_bf16 v[208:211], a[180:183], a[248:251], v[208:211]
    v_mfma_f32_16x16x32_bf16 v[204:207], a[172:175], a[244:247], v[204:207]
    v_mfma_f32_16x16x32_bf16 v[204:207], a[184:187], a[248:251], v[204:207]
    v_mfma_f32_16x16x32_bf16 v[200:203], a[176:179], a[244:247], v[200:203]
    ds_read_b128 a[244:247], v225 offset:27776
    v_mfma_f32_16x16x32_bf16 v[200:203], a[188:191], a[248:251], v[200:203]
    ds_read_b128 a[248:251], v224 offset:30976
    v_mfma_f32_16x16x32_bf16 v[208:211], a[192:195], a[252:255], v[208:211]
    v_mfma_f32_16x16x32_bf16 v[208:211], a[204:207], a[220:223], v[208:211]
    v_mfma_f32_16x16x32_bf16 v[204:207], a[196:199], a[252:255], v[204:207]
    v_mfma_f32_16x16x32_bf16 v[204:207], a[208:211], a[220:223], v[204:207]
    v_mfma_f32_16x16x32_bf16 v[200:203], a[200:203], a[252:255], v[200:203]
    s_waitcnt lgkmcnt(1)
    ds_read_b128 a[252:255], v224 offset:31040
    v_mfma_f32_16x16x32_bf16 v[200:203], a[212:215], a[220:223], v[200:203]
    s_barrier
    ds_read_b128 a[220:223], v224 offset:31104
    v_mfma_f32_16x16x32_bf16 v[220:223], a[144:147], a[224:227], 0
    v_cvt_pk_bf16_f32 v132, v208, v209
    v_cvt_pk_bf16_f32 v133, v210, v211
    v_mfma_f32_16x16x32_bf16 v[220:223], a[156:159], a[228:231], v[220:223]
    v_cvt_pk_bf16_f32 v134, v204, v205
    v_cvt_pk_bf16_f32 v135, v206, v207
    v_mfma_f32_16x16x32_bf16 v[216:219], a[148:151], a[224:227], 0
    v_cvt_pk_bf16_f32 v136, v200, v201
    v_cvt_pk_bf16_f32 v137, v202, v203
    v_mfma_f32_16x16x32_bf16 v[216:219], a[160:163], a[228:231], v[216:219]
    buffer_load_dwordx4 v246, s[4:7], s56 offen lds
    v_mfma_f32_16x16x32_bf16 v[144:147], v[0:3], v[132:135], v[144:147]
    buffer_load_dwordx4 v247, s[4:7], s56 offen offset:1024 lds
    v_mfma_f32_16x16x32_bf16 v[148:151], v[24:27], v[132:135], v[148:151]
    s_add_u32 s56, s56, s42
    s_add_u32 m0, s41, 0x1e40
    v_mfma_f32_16x16x32_bf16 v[152:155], v[30:33], v[132:135], v[152:155]
    v_mfma_f32_16x16x32_bf16 v[156:159], v[6:9], v[132:135], v[156:159]
    v_mfma_f32_16x16x16_bf16 v[144:147], v[4:5], v[136:137], v[144:147]
    buffer_load_dwordx4 v246, s[4:7], s56 offen lds
    v_mfma_f32_16x16x16_bf16 v[148:151], v[28:29], v[136:137], v[148:151]
    v_mfma_f32_16x16x32_bf16 v[160:163], v[12:15], v[132:135], v[160:163]
    v_mfma_f32_16x16x32_bf16 v[164:167], v[36:39], v[132:135], v[164:167]
    v_mfma_f32_16x16x16_bf16 v[152:155], v[34:35], v[136:137], v[152:155]
    buffer_load_dwordx4 v247, s[4:7], s56 offen offset:1024 lds
    v_mfma_f32_16x16x16_bf16 v[156:159], v[10:11], v[136:137], v[156:159]
    s_add_u32 s56, s56, s42
    v_max3_f32 v248, v144, v145, v146
    s_add_u32 m0, s41, 0x3c80
    v_mfma_f32_16x16x16_bf16 v[160:163], v[16:17], v[136:137], v[160:163]
    v_max3_f32 v249, v147, v148, v149
    v_max3_f32 v248, v248, v150, v151
    v_mfma_f32_16x16x16_bf16 v[164:167], v[40:41], v[136:137], v[164:167]
    v_max3_f32 v249, v249, v152, v153
    v_max3_f32 v248, v248, v154, v155
    v_mfma_f32_16x16x32_bf16 v[168:171], v[42:45], v[132:135], v[168:171]
    buffer_load_dwordx4 v246, s[4:7], s56 offen lds
    v_mfma_f32_16x16x32_bf16 v[172:175], v[18:21], v[132:135], v[172:175]
    v_max3_f32 v249, v249, v156, v157
    v_max3_f32 v248, v248, v158, v159
    v_mfma_f32_16x16x32_bf16 v[212:215], a[152:155], a[224:227], 0
    ds_read_b128 a[224:227], v224 offset:31168
    v_max3_f32 v249, v249, v160, v161
    v_mfma_f32_16x16x32_bf16 v[212:215], a[164:167], a[228:231], v[212:215]
    ds_read_b128 a[228:231], v224 offset:31232
    v_max3_f32 v248, v248, v162, v163
    v_mfma_f32_16x16x16_bf16 v[168:171], v[46:47], v[136:137], v[168:171]
    v_max3_f32 v249, v249, v164, v165
    v_max3_f32 v248, v248, v166, v167
    v_mfma_f32_16x16x16_bf16 v[172:175], v[22:23], v[136:137], v[172:175]
    buffer_load_dwordx4 v247, s[4:7], s56 offen offset:1024 lds
    v_mfma_f32_16x16x32_bf16 v[220:223], a[168:171], a[232:235], v[220:223]
    s_add_u32 s56, s56, s42
    s_add_u32 m0, s41, 0x5ac0
    v_mfma_f32_16x16x32_bf16 v[220:223], a[180:183], a[236:239], v[220:223]
    v_max3_f32 v249, v249, v168, v169
    v_max3_f32 v248, v248, v170, v171
    v_mfma_f32_16x16x32_bf16 v[216:219], a[172:175], a[232:235], v[216:219]
    v_max3_f32 v249, v249, v172, v173
    v_max3_f32 v248, v248, v174, v175
    v_mfma_f32_16x16x32_bf16 v[216:219], a[184:187], a[236:239], v[216:219]
    buffer_load_dwordx4 v246, s[4:7], s56 offen lds
    v_mfma_f32_16x16x32_bf16 v[212:215], a[176:179], a[232:235], v[212:215]
    ds_read_b128 a[232:235], v224 offset:31296
    v_max_f32 v248, v248, v249
    v_mfma_f32_16x16x32_bf16 v[212:215], a[188:191], a[236:239], v[212:215]
    ds_read_b128 a[236:239], v224 offset:34048
    v_mov_b32 v249, v248
    v_mfma_f32_16x16x32_bf16 v[220:223], a[192:195], a[240:243], v[220:223]
    v_mfma_f32_16x16x32_bf16 v[220:223], a[204:207], a[244:247], v[220:223]
    buffer_load_dwordx4 v247, s[4:7], s56 offen offset:1024 lds
    v_mfma_f32_16x16x32_bf16 v[216:219], a[196:199], a[240:243], v[216:219]
    s_add_u32 s56, s56, s42
    v_permlane16_swap_b32 v248, v249
    v_mfma_f32_16x16x32_bf16 v[216:219], a[208:211], a[244:247], v[216:219]
    s_add_u32 m0, s41, 0x7900
    v_max_f32 v248, v248, v249
    v_mov_b32 v249, v248
    v_mfma_f32_16x16x32_bf16 v[212:215], a[200:203], a[240:243], v[212:215]
    v_cvt_pk_bf16_f32 v138, v220, v221
    v_cvt_pk_bf16_f32 v139, v222, v223
    v_mfma_f32_16x16x32_bf16 v[212:215], a[212:215], a[244:247], v[212:215]
    s_waitcnt lgkmcnt(2)
    ds_read_b128 a[240:243], v224 offset:34112
    v_cvt_pk_bf16_f32 v140, v216, v217
    v_mfma_f32_16x16x32_bf16 v[208:211], a[248:251], a[72:75], 0
    ds_read_b128 a[244:247], v224 offset:34176
    v_cvt_pk_bf16_f32 v141, v218, v219
    v_mfma_f32_16x16x32_bf16 v[208:211], a[252:255], a[84:87], v[208:211]
    v_permlane32_swap_b32 v248, v249
    v_mfma_f32_16x16x32_bf16 v[204:207], a[248:251], a[76:79], 0
    v_cvt_pk_bf16_f32 v142, v212, v213
    v_cvt_pk_bf16_f32 v143, v214, v215
    v_mfma_f32_16x16x32_bf16 v[204:207], a[252:255], a[88:91], v[204:207]
    v_max_f32 v248, v248, v249
    v_mul_f32 v236, s37, v248
    v_mfma_f32_16x16x32_bf16 v[200:203], a[248:251], a[80:83], 0
    ds_read_b128 a[248:251], v224 offset:34240
    v_fma_f32 v144, v144, s37, -v236
    v_mfma_f32_16x16x32_bf16 v[200:203], a[252:255], a[92:95], v[200:203]
    ds_read_b128 a[252:255], v224 offset:34304
    v_fma_f32 v145, v145, s37, -v236
    v_mfma_f32_16x16x32_bf16 v[208:211], a[220:223], a[96:99], v[208:211]
    v_fma_f32 v146, v146, s37, -v236
    v_fma_f32 v147, v147, s37, -v236
    v_mfma_f32_16x16x32_bf16 v[208:211], a[224:227], a[108:111], v[208:211]
    v_exp_f32 v144, v144
    v_mfma_f32_16x16x32_bf16 v[204:207], a[220:223], a[100:103], v[204:207]
    v_exp_f32 v145, v145
    v_mfma_f32_16x16x32_bf16 v[204:207], a[224:227], a[112:115], v[204:207]
    v_exp_f32 v146, v146
    v_mfma_f32_16x16x32_bf16 v[200:203], a[220:223], a[104:107], v[200:203]
    ds_read_b128 a[220:223], v224 offset:34368
    v_cvt_pk_bf16_f32 v176, v144, v145
    v_mfma_f32_16x16x32_bf16 v[200:203], a[224:227], a[116:119], v[200:203]
    ds_read_b128 a[224:227], v224 offset:46464
    v_fma_f32 v148, v148, s37, -v236
    v_mfma_f32_16x16x32_bf16 v[208:211], a[228:231], a[120:123], v[208:211]
    s_waitcnt lgkmcnt(3)
    v_exp_f32 v147, v147
    v_mfma_f32_16x16x32_bf16 v[208:211], a[232:235], a[132:135], v[208:211]
    v_cvt_pk_bf16_f32 v177, v146, v147
    v_fma_f32 v149, v149, s37, -v236
    v_mfma_f32_16x16x32_bf16 v[204:207], a[228:231], a[124:127], v[204:207]
    ds_read_b128 v[144:147], v234
    v_bfe_u32 v234, s63, v233, 4
    v_mfma_f32_16x16x32_bf16 v[204:207], a[232:235], a[136:139], v[204:207]
    v_mad_u32_u24 v234, v234, s40, v231
    v_fma_f32 v150, v150, s37, -v236
    v_mfma_f32_16x16x32_bf16 v[200:203], a[228:231], a[128:131], v[200:203]
    v_cvt_pk_bf16_f32 v74, v208, v209
    v_cvt_pk_bf16_f32 v75, v210, v211
    v_mfma_f32_16x16x32_bf16 v[200:203], a[232:235], a[140:143], v[200:203]
    ds_read_b128 a[228:231], v224 offset:46528
    ds_read_b128 a[232:235], v224 offset:46592
    v_mfma_f32_16x16x32_bf16 v[220:223], a[236:239], a[72:75], 0
    v_cvt_pk_bf16_f32 v96, v204, v205
    v_cvt_pk_bf16_f32 v97, v206, v207
    v_mfma_f32_16x16x32_bf16 v[220:223], a[240:243], a[84:87], v[220:223]
    v_fma_f32 v151, v151, s37, -v236
    v_fma_f32 v152, v152, s37, -v236
    v_mfma_f32_16x16x32_bf16 v[216:219], a[236:239], a[76:79], 0
    v_cvt_pk_bf16_f32 v118, v200, v201
    v_cvt_pk_bf16_f32 v119, v202, v203
    v_mfma_f32_16x16x32_bf16 v[216:219], a[240:243], a[88:91], v[216:219]
    s_waitcnt lgkmcnt(2)
    v_exp_f32 v148, v148
    v_mfma_f32_16x16x32_bf16 v[144:147], v[24:27], v[138:141], v[144:147]
    v_exp_f32 v149, v149
    v_mfma_f32_16x16x32_bf16 v[212:215], a[236:239], a[80:83], 0
    ds_read_b128 a[236:239], v224 offset:46656
    v_cvt_pk_bf16_f32 v178, v148, v149
    v_mfma_f32_16x16x32_bf16 v[212:215], a[240:243], a[92:95], v[212:215]
    ds_read_b128 a[240:243], v224 offset:46720
    v_fma_f32 v153, v153, s37, -v236
    v_mfma_f32_16x16x16_bf16 v[144:147], v[28:29], v[142:143], v[144:147]
    v_exp_f32 v150, v150
    v_mfma_f32_16x16x32_bf16 v[220:223], a[244:247], a[96:99], v[220:223]
    v_exp_f32 v151, v151
    v_mfma_f32_16x16x32_bf16 v[220:223], a[248:251], a[108:111], v[220:223]
    v_cvt_pk_bf16_f32 v179, v150, v151
    v_fma_f32 v154, v154, s37, -v236
    v_mfma_f32_16x16x32_bf16 v[216:219], a[244:247], a[100:103], v[216:219]
    ds_read_b128 v[148:151], v235
    v_bfe_u32 v235, s64, v233, 4
    v_mfma_f32_16x16x32_bf16 v[216:219], a[248:251], a[112:115], v[216:219]
    v_mad_u32_u24 v235, v235, s40, v231
    v_fma_f32 v155, v155, s37, -v236
    v_mfma_f32_16x16x32_bf16 v[196:199], a[216:219], v[176:179], 0
    v_exp_f32 v152, v152
    v_mfma_f32_16x16x32_bf16 v[184:187], v[66:69], v[176:179], 0
    v_exp_f32 v153, v153
    v_mfma_f32_16x16x32_bf16 v[188:191], v[88:91], v[176:179], 0
    v_exp_f32 v154, v154
    v_mfma_f32_16x16x32_bf16 v[192:195], v[110:113], v[176:179], 0
    v_exp_f32 v155, v155
    v_mfma_f32_16x16x32_bf16 v[212:215], a[244:247], a[104:107], v[212:215]
    ds_read_b128 a[244:247], v224 offset:46784
    v_cvt_pk_bf16_f32 v180, v152, v153
    v_mfma_f32_16x16x32_bf16 v[212:215], a[248:251], a[116:119], v[212:215]
    s_waitcnt vmcnt(20) lgkmcnt(1)
    ds_read_b64_tr_b16 a[248:249], v86 offset:12288
    ds_read_b64_tr_b16 a[250:251], v86 offset:13824
    v_mfma_f32_16x16x32_bf16 v[148:151], v[30:33], v[138:141], v[148:151]
    v_cvt_pk_bf16_f32 v181, v154, v155
    v_fma_f32 v156, v156, s37, -v236
    v_mfma_f32_16x16x32_bf16 v[220:223], a[252:255], a[120:123], v[220:223]
    ds_read_b128 v[152:155], v230 offset:1920
    v_fma_f32 v157, v157, s37, -v236
    v_mfma_f32_16x16x32_bf16 v[220:223], a[220:223], a[132:135], v[220:223]
    v_fma_f32 v158, v158, s37, -v236
    v_fma_f32 v159, v159, s37, -v236
    v_mfma_f32_16x16x16_bf16 v[148:151], v[34:35], v[142:143], v[148:151]
    v_exp_f32 v156, v156
    v_mfma_f32_16x16x32_bf16 v[216:219], a[252:255], a[124:127], v[216:219]
    v_exp_f32 v157, v157
    v_mfma_f32_16x16x32_bf16 v[216:219], a[220:223], a[136:139], v[216:219]
    v_exp_f32 v158, v158
    v_mfma_f32_16x16x32_bf16 v[212:215], a[252:255], a[128:131], v[212:215]
    v_cvt_pk_bf16_f32 v76, v220, v221
    v_cvt_pk_bf16_f32 v77, v222, v223
    v_mfma_f32_16x16x32_bf16 v[212:215], a[220:223], a[140:143], v[212:215]
    ds_read_b64_tr_b16 a[252:253], v86 offset:12320
    ds_read_b64_tr_b16 a[254:255], v86 offset:13856
    v_mfma_f32_16x16x32_bf16 v[208:211], a[224:227], a[72:75], 0
    s_waitcnt vmcnt(4) lgkmcnt(2)
    v_cvt_pk_bf16_f32 v98, v216, v217
    v_cvt_pk_bf16_f32 v99, v218, v219
    v_mfma_f32_16x16x32_bf16 v[208:211], a[228:231], a[84:87], v[208:211]
    s_barrier
    ds_read_b128 v[252:255], v224 offset:320
    v_cvt_pk_bf16_f32 v120, v212, v213
    v_mfma_f32_16x16x32_bf16 v[152:155], v[36:39], v[138:141], v[152:155]
    ds_read_b64_tr_b16 a[220:221], v86 offset:12352
    v_cvt_pk_bf16_f32 v121, v214, v215
    v_mfma_f32_16x16x32_bf16 v[204:207], a[224:227], a[76:79], 0
    ds_read_b64_tr_b16 a[222:223], v86 offset:13888
    v_cvt_pk_bf16_f32 v182, v156, v157
    v_mfma_f32_16x16x32_bf16 v[204:207], a[228:231], a[88:91], v[204:207]
    v_exp_f32 v159, v159
    v_mfma_f32_16x16x16_bf16 v[152:155], v[40:41], v[142:143], v[152:155]
    v_cvt_pk_bf16_f32 v183, v158, v159
    v_fma_f32 v160, v160, s37, -v236
    v_mfma_f32_16x16x32_bf16 v[200:203], a[224:227], a[80:83], 0
    ds_read_b128 a[224:227], v224 offset:49536
    ds_read_b128 v[156:159], v250
    v_mfma_f32_16x16x32_bf16 v[200:203], a[228:231], a[92:95], v[200:203]
    v_bfe_u32 v250, s65, v232, 4
    v_fma_f32 v161, v161, s37, -v236
    v_mfma_f32_16x16x32_bf16 v[196:199], a[216:219], v[180:183], v[196:199]
    ds_read_b128 a[228:231], v224 offset:49600
    v_fma_f32 v162, v162, s37, -v236
    v_mfma_f32_16x16x32_bf16 v[184:187], v[70:73], v[180:183], v[184:187]
    v_fma_f32 v163, v163, s37, -v236
    v_fma_f32 v164, v164, s37, -v236
    v_mfma_f32_16x16x32_bf16 v[188:191], v[92:95], v[180:183], v[188:191]
    v_exp_f32 v160, v160
    v_mfma_f32_16x16x32_bf16 v[192:195], v[114:117], v[180:183], v[192:195]
    v_exp_f32 v161, v161
    v_mfma_f32_16x16x32_bf16 v[208:211], a[232:235], a[96:99], v[208:211]
    v_exp_f32 v162, v162
    v_mfma_f32_16x16x32_bf16 v[208:211], a[236:239], a[108:111], v[208:211]
    v_exp_f32 v163, v163
    v_mfma_f32_16x16x32_bf16 v[204:207], a[232:235], a[100:103], v[204:207]
    v_cvt_pk_bf16_f32 v176, v160, v161
    v_cvt_pk_bf16_f32 v177, v162, v163
    v_mfma_f32_16x16x32_bf16 v[204:207], a[236:239], a[112:115], v[204:207]
    s_waitcnt lgkmcnt(1)
    ds_read_b128 v[160:163], v234
    v_mad_u32_u24 v234, v250, s40, v229
    v_mfma_f32_16x16x32_bf16 v[156:159], v[42:45], v[138:141], v[156:159]
    v_mad_u32_u24 v250, v250, s40, v228
    v_fma_f32 v165, v165, s37, -v236
    v_mfma_f32_16x16x32_bf16 v[200:203], a[232:235], a[104:107], v[200:203]
    ds_read_b128 a[232:235], v224 offset:49664
    v_fma_f32 v166, v166, s37, -v236
    v_mfma_f32_16x16x32_bf16 v[200:203], a[236:239], a[116:119], v[200:203]
    ds_read_b128 a[236:239], v224 offset:49728
    v_fma_f32 v167, v167, s37, -v236
    v_mfma_f32_16x16x16_bf16 v[156:159], v[46:47], v[142:143], v[156:159]
    s_waitcnt vmcnt(0)
    ds_write_b128 v87, a[248:251] offset:12288
    v_mfma_f32_16x16x32_bf16 v[208:211], a[240:243], a[120:123], v[208:211]
    ds_write_b128 v87, a[252:255] offset:13312
    v_mfma_f32_16x16x32_bf16 v[208:211], a[244:247], a[132:135], v[208:211]
    s_waitcnt lgkmcnt(4)
    ds_write_b128 v87, a[220:223] offset:14336
    v_mfma_f32_16x16x32_bf16 v[160:163], v[48:51], v[138:141], v[160:163]
    v_exp_f32 v164, v164
    v_mfma_f32_16x16x32_bf16 v[204:207], a[240:243], a[124:127], v[204:207]
    v_exp_f32 v165, v165
    v_mfma_f32_16x16x32_bf16 v[204:207], a[244:247], a[136:139], v[204:207]
    v_exp_f32 v166, v166
    v_mfma_f32_16x16x32_bf16 v[200:203], a[240:243], a[128:131], v[200:203]
    v_cvt_pk_bf16_f32 v80, v208, v209
    v_cvt_pk_bf16_f32 v81, v210, v211
    v_mfma_f32_16x16x32_bf16 v[200:203], a[244:247], a[140:143], v[200:203]
    v_exp_f32 v167, v167
    v_mfma_f32_16x16x16_bf16 v[160:163], v[52:53], v[142:143], v[160:163]
    v_cvt_pk_bf16_f32 v178, v164, v165
    v_cvt_pk_bf16_f32 v102, v204, v205
    v_mfma_f32_16x16x32_bf16 v[220:223], a[224:227], a[72:75], 0
    v_cvt_pk_bf16_f32 v103, v206, v207
    v_cvt_pk_bf16_f32 v179, v166, v167
    v_mfma_f32_16x16x32_bf16 v[220:223], a[228:231], a[84:87], v[220:223]
    v_cvt_pk_bf16_f32 v124, v200, v201
    v_cvt_pk_bf16_f32 v125, v202, v203
    v_mfma_f32_16x16x32_bf16 v[196:199], a[216:219], v[176:179], v[196:199]
    ds_read_b128 a[240:243], v224 offset:49792
    ds_read_b128 a[244:247], v224 offset:49856
    v_mfma_f32_16x16x32_bf16 v[184:187], v[74:77], v[176:179], v[184:187]
    ds_read_b128 v[164:167], v235
    v_bfe_u32 v235, s62, v232, 4
    v_mfma_f32_16x16x32_bf16 v[188:191], v[96:99], v[176:179], v[188:191]
    v_fma_f32 v168, v168, s37, -v236
    v_fma_f32 v169, v169, s37, -v236
    v_mfma_f32_16x16x32_bf16 v[192:195], v[118:121], v[176:179], v[192:195]
    ds_read_b64_tr_b16 a[248:249], v86 offset:24576
    ds_read_b64_tr_b16 a[250:251], v86 offset:26112
    v_mfma_f32_16x16x32_bf16 v[216:219], a[224:227], a[76:79], 0
    ds_read_b64_tr_b16 a[252:253], v86 offset:24608
    ds_read_b64_tr_b16 a[254:255], v86 offset:26144
    v_mfma_f32_16x16x32_bf16 v[216:219], a[228:231], a[88:91], v[216:219]
    ds_read_b64_tr_b16 a[220:221], v86 offset:24640
    ds_read_b64_tr_b16 a[222:223], v86 offset:26176
    v_mfma_f32_16x16x32_bf16 v[212:215], a[224:227], a[80:83], 0
    ds_read_b128 a[224:227], v225 offset:39872
    v_fma_f32 v170, v170, s37, -v236
    v_mfma_f32_16x16x32_bf16 v[212:215], a[228:231], a[92:95], v[212:215]
    s_waitcnt lgkmcnt(10)
    ds_read_b128 a[228:231], v225 offset:39936
    v_fma_f32 v171, v171, s37, -v236
    v_mfma_f32_16x16x32_bf16 v[220:223], a[232:235], a[96:99], v[220:223]
    v_exp_f32 v168, v168
    v_mfma_f32_16x16x32_bf16 v[220:223], a[236:239], a[108:111], v[220:223]
    s_waitcnt lgkmcnt(8)
    v_exp_f32 v169, v169
    v_mfma_f32_16x16x32_bf16 v[164:167], v[54:57], v[138:141], v[164:167]
    s_waitcnt lgkmcnt(6)
    ds_write_b128 v87, a[248:251] offset:24576
    v_mfma_f32_16x16x32_bf16 v[216:219], a[232:235], a[100:103], v[216:219]
    s_waitcnt lgkmcnt(5)
    ds_write_b128 v87, a[252:255] offset:25600
    v_mfma_f32_16x16x32_bf16 v[216:219], a[236:239], a[112:115], v[216:219]
    s_waitcnt lgkmcnt(4)
    ds_write_b128 v87, a[220:223] offset:26624
    v_mfma_f32_16x16x32_bf16 v[212:215], a[232:235], a[104:107], v[212:215]
    v_exp_f32 v170, v170
    v_mfma_f32_16x16x32_bf16 v[212:215], a[236:239], a[116:119], v[212:215]
    v_exp_f32 v171, v171
    v_mfma_f32_16x16x16_bf16 v[164:167], v[58:59], v[142:143], v[164:167]
    v_cvt_pk_bf16_f32 v180, v168, v169
    v_cvt_pk_bf16_f32 v181, v170, v171
    v_mfma_f32_16x16x32_bf16 v[220:223], a[240:243], a[120:123], v[220:223]
    v_fma_f32 v172, v172, s37, -v236
    v_fma_f32 v173, v173, s37, -v236
    v_mfma_f32_16x16x32_bf16 v[220:223], a[244:247], a[132:135], v[220:223]
    v_fma_f32 v174, v174, s37, -v236
    v_fma_f32 v175, v175, s37, -v236
    v_mfma_f32_16x16x32_bf16 v[216:219], a[240:243], a[124:127], v[216:219]
    v_exp_f32 v172, v172
    v_mfma_f32_16x16x32_bf16 v[216:219], a[244:247], a[136:139], v[216:219]
    v_exp_f32 v173, v173
    v_mfma_f32_16x16x32_bf16 v[212:215], a[240:243], a[128:131], v[212:215]
    ds_read_b128 a[232:235], v225 offset:40000
    v_cvt_pk_bf16_f32 v78, v220, v221
    v_mfma_f32_16x16x32_bf16 v[212:215], a[244:247], a[140:143], v[212:215]
    s_waitcnt lgkmcnt(3)
    ds_read_b128 a[236:239], v225 offset:40064
    v_cvt_pk_bf16_f32 v79, v222, v223
    v_mfma_f32_16x16x32_bf16 v[208:211], a[144:147], a[224:227], 0
    v_cvt_pk_bf16_f32 v100, v216, v217
    v_cvt_pk_bf16_f32 v101, v218, v219
    v_mfma_f32_16x16x32_bf16 v[208:211], a[156:159], a[228:231], v[208:211]
    ds_read_b128 a[240:243], v225 offset:40128
    ds_read_b128 a[244:247], v225 offset:40192
    v_mfma_f32_16x16x32_bf16 v[204:207], a[148:151], a[224:227], 0
    v_cvt_pk_bf16_f32 v122, v212, v213
    v_cvt_pk_bf16_f32 v123, v214, v215
    v_mfma_f32_16x16x32_bf16 v[204:207], a[160:163], a[228:231], v[204:207]
    ds_read_b128 a[248:251], v227 offset:37120
    ds_read_b128 a[252:255], v227 offset:37184
    v_mfma_f32_16x16x32_bf16 v[200:203], a[152:155], a[224:227], 0
    ds_read_b128 a[220:223], v227 offset:37248
    v_cvt_pk_bf16_f32 v182, v172, v173
    v_mfma_f32_16x16x32_bf16 v[200:203], a[164:167], a[228:231], v[200:203]
    s_waitcnt lgkmcnt(6)
    ds_read_b128 a[224:227], v227 offset:37312
    v_max3_f32 v248, v144, v145, v146
    v_mfma_f32_16x16x32_bf16 v[208:211], a[168:171], a[232:235], v[208:211]
    s_waitcnt lgkmcnt(6)
    ds_read_b128 a[228:231], v227 offset:37376
    v_max3_f32 v249, v147, v148, v149
    v_mfma_f32_16x16x32_bf16 v[208:211], a[180:183], a[236:239], v[208:211]
    ds_read_b128 v[168:171], v234
    v_bfe_u32 v234, s62, v232, 4
    v_mfma_f32_16x16x32_bf16 v[204:207], a[172:175], a[232:235], v[204:207]
    v_mad_u32_u24 v234, v234, s40, v230
    v_max3_f32 v248, v248, v150, v151
    v_mfma_f32_16x16x32_bf16 v[204:207], a[184:187], a[236:239], v[204:207]
    v_exp_f32 v174, v174
    v_mfma_f32_16x16x32_bf16 v[200:203], a[176:179], a[232:235], v[200:203]
    ds_read_b128 a[232:235], v227 offset:37440
    v_max3_f32 v249, v249, v152, v153
    v_mfma_f32_16x16x32_bf16 v[200:203], a[188:191], a[236:239], v[200:203]
    s_waitcnt lgkmcnt(6)
    ds_read_b64_tr_b16 a[236:237], v86 offset:36864
    ds_read_b64_tr_b16 a[238:239], v86 offset:38400
    v_mfma_f32_16x16x32_bf16 v[208:211], a[192:195], a[240:243], v[208:211]
    v_exp_f32 v175, v175
    v_mfma_f32_16x16x32_bf16 v[208:211], a[204:207], a[244:247], v[208:211]
    v_cvt_pk_bf16_f32 v183, v174, v175
    v_max3_f32 v248, v248, v154, v155
    v_mfma_f32_16x16x32_bf16 v[204:207], a[196:199], a[240:243], v[204:207]
    ds_read_b128 v[172:175], v250
    v_mad_u32_u24 v250, v235, s40, v228
    v_mfma_f32_16x16x32_bf16 v[204:207], a[208:211], a[244:247], v[204:207]
    v_mad_u32_u24 v235, v235, s40, v229
    v_max3_f32 v249, v249, v156, v157
    v_mfma_f32_16x16x32_bf16 v[196:199], a[216:219], v[180:183], v[196:199]
    v_cvt_pk_bf16_f32 v132, v208, v209
    v_cvt_pk_bf16_f32 v133, v210, v211
    v_mfma_f32_16x16x32_bf16 v[184:187], v[78:81], v[180:183], v[184:187]
    v_max3_f32 v248, v248, v158, v159
    v_max3_f32 v249, v249, v160, v161
    v_mfma_f32_16x16x32_bf16 v[188:191], v[100:103], v[180:183], v[188:191]
    v_cvt_pk_bf16_f32 v134, v204, v205
    v_cvt_pk_bf16_f32 v135, v206, v207
    v_mfma_f32_16x16x32_bf16 v[192:195], v[122:125], v[180:183], v[192:195]
    s_waitcnt lgkmcnt(1)
    v_rcp_f32 v197, v196
    v_mfma_f32_16x16x32_bf16 v[168:171], v[30:33], v[132:135], v[168:171]
    v_mul_f32 v184, v184, v197
    v_mul_f32 v185, v185, v197
    v_mfma_f32_16x16x32_bf16 v[200:203], a[200:203], a[240:243], v[200:203]
    v_cvt_pk_bf16_f32 v184, v184, v185
    v_mul_f32 v186, v186, v197
    v_mfma_f32_16x16x32_bf16 v[200:203], a[212:215], a[244:247], v[200:203]
    s_waitcnt lgkmcnt(0)
    v_mul_f32 v187, v187, v197
    v_cvt_pk_bf16_f32 v185, v186, v187
    v_mfma_f32_16x16x32_bf16 v[172:175], v[6:9], v[132:135], v[172:175]
    v_mul_f32 v188, v188, v197
    v_mul_f32 v189, v189, v197
    v_mfma_f32_16x16x32_bf16 v[220:223], a[248:251], a[72:75], 0
    v_cvt_pk_bf16_f32 v186, v188, v189
    v_mul_f32 v190, v190, v197
    v_mfma_f32_16x16x32_bf16 v[220:223], a[252:255], a[84:87], v[220:223]
    v_cvt_pk_bf16_f32 v136, v200, v201
    v_cvt_pk_bf16_f32 v137, v202, v203
    v_mfma_f32_16x16x32_bf16 v[216:219], a[248:251], a[76:79], 0
    v_mul_f32 v191, v191, v197
    v_cvt_pk_bf16_f32 v187, v190, v191
    v_mfma_f32_16x16x32_bf16 v[216:219], a[252:255], a[88:91], v[216:219]
    v_mul_f32 v192, v192, v197
    v_mul_f32 v193, v193, v197
    v_mfma_f32_16x16x16_bf16 v[168:171], v[34:35], v[136:137], v[168:171]
    v_cvt_pk_bf16_f32 v188, v192, v193
    v_mul_f32 v194, v194, v197
    v_mfma_f32_16x16x16_bf16 v[172:175], v[10:11], v[136:137], v[172:175]
    ds_read_b64_tr_b16 a[240:241], v86 offset:36896
    v_mul_f32 v195, v195, v197
    v_mfma_f32_16x16x32_bf16 v[212:215], a[248:251], a[80:83], 0
    ds_read_b64_tr_b16 a[242:243], v86 offset:38432
    v_cvt_pk_bf16_f32 v189, v194, v195
    v_mfma_f32_16x16x32_bf16 v[212:215], a[252:255], a[92:95], v[212:215]
    ds_write_b128 v237, v[184:187]
    v_mfma_f32_16x16x32_bf16 v[220:223], a[220:223], a[96:99], v[220:223]
    ds_write_b64 v238, v[188:189]
    v_mfma_f32_16x16x32_bf16 v[220:223], a[224:227], a[108:111], v[220:223]
    v_max3_f32 v248, v248, v162, v163
    v_max3_f32 v249, v249, v164, v165
    v_mfma_f32_16x16x32_bf16 v[216:219], a[220:223], a[100:103], v[216:219]
    v_max3_f32 v248, v248, v166, v167
    v_max_f32 v248, v248, v249
    v_mfma_f32_16x16x32_bf16 v[216:219], a[224:227], a[112:115], v[216:219]
    v_mov_b32 v249, v248
    v_mfma_f32_16x16x32_bf16 v[212:215], a[220:223], a[104:107], v[212:215]
    ds_read_b64_tr_b16 a[244:245], v86 offset:36928
    ds_read_b64_tr_b16 a[246:247], v86 offset:38464
    v_mfma_f32_16x16x32_bf16 v[212:215], a[224:227], a[116:119], v[212:215]
    ds_write_b128 v87, a[236:239] offset:36864
    v_mfma_f32_16x16x32_bf16 v[220:223], a[228:231], a[120:123], v[220:223]
    s_waitcnt lgkmcnt(5)
    ds_write_b128 v87, a[240:243] offset:37888
    v_mfma_f32_16x16x32_bf16 v[220:223], a[232:235], a[132:135], v[220:223]
    v_permlane16_swap_b32 v248, v249
    v_mfma_f32_16x16x32_bf16 v[216:219], a[228:231], a[124:127], v[216:219]
    v_max_f32 v248, v248, v249
    v_mov_b32 v249, v248
    v_mfma_f32_16x16x32_bf16 v[216:219], a[232:235], a[136:139], v[216:219]
    s_waitcnt lgkmcnt(2)
    ds_write_b128 v87, a[244:247] offset:38912
    v_mfma_f32_16x16x32_bf16 v[212:215], a[228:231], a[128:131], v[212:215]
    v_permlane32_swap_b32 v248, v249
    v_mfma_f32_16x16x32_bf16 v[212:215], a[232:235], a[140:143], v[212:215]
    v_cvt_pk_bf16_f32 v84, v220, v221
    v_cvt_pk_bf16_f32 v85, v222, v223
    v_max_f32 v248, v248, v249
    v_mul_f32 v236, s37, v248
    v_cvt_pk_bf16_f32 v106, v216, v217
    v_cvt_pk_bf16_f32 v107, v218, v219
    v_fma_f32 v144, v144, s37, -v236
    v_fma_f32 v145, v145, s37, -v236
    v_cvt_pk_bf16_f32 v128, v212, v213
    v_cvt_pk_bf16_f32 v129, v214, v215
    v_fma_f32 v146, v146, s37, -v236
    v_fma_f32 v147, v147, s37, -v236
    v_exp_f32 v144, v144
    v_exp_f32 v145, v145
    ds_read_b128 a[236:239], v224
    ds_read_b128 a[240:243], v224 offset:64
    v_exp_f32 v146, v146
    ds_read_b128 a[244:247], v224 offset:128
    v_exp_f32 v147, v147
    ds_read_b64_tr_b16 a[248:249], v86 offset:49152
    ds_read_b64_tr_b16 a[250:251], v86 offset:50688
    ds_read_b64_tr_b16 a[252:253], v86 offset:49184
    ds_read_b64_tr_b16 a[254:255], v86 offset:50720
    v_cvt_pk_bf16_f32 v176, v144, v145
    ds_read_b64_tr_b16 a[220:221], v86 offset:49216
    ds_read_b64_tr_b16 a[222:223], v86 offset:50752
    ds_read_b64_tr_b16 a[224:225], v86 offset:61440
    v_cvt_pk_bf16_f32 v177, v146, v147
    ds_read_b128 v[144:147], v228 offset:1280
    v_fma_f32 v148, v148, s37, -v236
    s_waitcnt lgkmcnt(10)
    v_mfma_f32_16x16x32_bf16 v[208:211], a[0:3], a[236:239], 0
    s_waitcnt lgkmcnt(9)
    ds_read_b64_tr_b16 a[226:227], v86 offset:62976
    v_fma_f32 v149, v149, s37, -v236
    v_mfma_f32_16x16x32_bf16 v[208:211], a[12:15], a[240:243], v[208:211]
    ds_read_b64_tr_b16 a[228:229], v86 offset:61472
    ds_read_b64_tr_b16 a[230:231], v86 offset:63008
    v_mfma_f32_16x16x32_bf16 v[204:207], a[4:7], a[236:239], 0
    ds_read_b64_tr_b16 a[232:233], v86 offset:61504
    ds_read_b64_tr_b16 a[234:235], v86 offset:63040
    v_mfma_f32_16x16x32_bf16 v[204:207], a[16:19], a[240:243], v[204:207]
    s_waitcnt lgkmcnt(11)
    ds_write_b128 v87, a[248:251] offset:49152
    v_mfma_f32_16x16x32_bf16 v[200:203], a[8:11], a[236:239], 0
    s_waitcnt lgkmcnt(10)
    ds_write_b128 v87, a[252:255] offset:50176
    v_mfma_f32_16x16x32_bf16 v[200:203], a[20:23], a[240:243], v[200:203]
    s_waitcnt lgkmcnt(7)
    ds_write_b128 v87, a[220:223] offset:51200
    v_mfma_f32_16x16x32_bf16 v[144:147], v[12:15], v[132:135], v[144:147]
    s_waitcnt lgkmcnt(7)
    ds_write_b128 v87, a[224:227] offset:61440
    v_mfma_f32_16x16x32_bf16 v[220:223], a[236:239], a[72:75], 0
    s_waitcnt lgkmcnt(5)
    ds_write_b128 v87, a[228:231] offset:62464
    v_mfma_f32_16x16x32_bf16 v[220:223], a[240:243], a[84:87], v[220:223]
    s_waitcnt lgkmcnt(5)
    ds_write_b128 v87, a[232:235] offset:63488
    v_mfma_f32_16x16x32_bf16 v[216:219], a[236:239], a[76:79], 0
    v_fma_f32 v150, v150, s37, -v236
    v_fma_f32 v151, v151, s37, -v236
    v_mfma_f32_16x16x32_bf16 v[216:219], a[240:243], a[88:91], v[216:219]
    v_exp_f32 v148, v148
    v_mfma_f32_16x16x16_bf16 v[144:147], v[16:17], v[136:137], v[144:147]
    v_exp_f32 v149, v149
    v_mfma_f32_16x16x32_bf16 v[212:215], a[236:239], a[80:83], 0
    v_exp_f32 v150, v150
    v_mfma_f32_16x16x32_bf16 v[212:215], a[240:243], a[92:95], v[212:215]
    v_exp_f32 v151, v151
    v_mfma_f32_16x16x32_bf16 v[208:211], a[24:27], a[244:247], v[208:211]
    v_cvt_pk_bf16_f32 v178, v148, v149
    v_cvt_pk_bf16_f32 v179, v150, v151
    v_mfma_f32_16x16x32_bf16 v[204:207], a[28:31], a[244:247], v[204:207]
    v_fma_f32 v152, v152, s37, -v236
    v_fma_f32 v153, v153, s37, -v236
    v_mfma_f32_16x16x32_bf16 v[196:199], a[216:219], v[176:179], 0
    v_fma_f32 v154, v154, s37, -v236
    v_fma_f32 v155, v155, s37, -v236
    v_mfma_f32_16x16x32_bf16 v[184:187], v[68:71], v[176:179], 0
    v_exp_f32 v152, v152
    v_mfma_f32_16x16x32_bf16 v[188:191], v[90:93], v[176:179], 0
    v_exp_f32 v153, v153
    v_mfma_f32_16x16x32_bf16 v[192:195], v[112:115], v[176:179], 0
    v_exp_f32 v154, v154
    v_mfma_f32_16x16x32_bf16 v[200:203], a[32:35], a[244:247], v[200:203]
    v_exp_f32 v155, v155
    v_mfma_f32_16x16x32_bf16 v[220:223], a[244:247], a[96:99], v[220:223]
    v_cvt_pk_bf16_f32 v180, v152, v153
    v_cvt_pk_bf16_f32 v181, v154, v155
    v_mfma_f32_16x16x32_bf16 v[216:219], a[244:247], a[100:103], v[216:219]
    v_fma_f32 v156, v156, s37, -v236
    v_fma_f32 v157, v157, s37, -v236
    v_mfma_f32_16x16x32_bf16 v[212:215], a[244:247], a[104:107], v[212:215]
    ds_read_b128 a[248:251], v224 offset:192
    ds_read_b128 a[252:255], v224 offset:256
    v_fma_f32 v158, v158, s37, -v236
    v_fma_f32 v159, v159, s37, -v236
    ds_read_b128 a[236:239], v224 offset:3072
    v_exp_f32 v156, v156
    ds_read_b128 a[240:243], v224 offset:3136
    ds_read_b128 a[244:247], v224 offset:3200
    v_exp_f32 v157, v157
    v_exp_f32 v158, v158
    ds_read_b64_tr_b16 a[220:221], v108
    ds_read_b64_tr_b16 a[222:223], v108 offset:1536
    v_exp_f32 v159, v159
    v_cvt_pk_bf16_f32 v182, v156, v157
    ds_read_b64_tr_b16 a[224:225], v108 offset:8
    s_waitcnt lgkmcnt(7)
    v_mfma_f32_16x16x32_bf16 v[212:215], a[248:251], a[116:119], v[212:215]
    ds_read_b64_tr_b16 a[226:227], v108 offset:1544
    v_cvt_pk_bf16_f32 v183, v158, v159
    v_mfma_f32_16x16x32_bf16 v[208:211], a[36:39], a[248:251], v[208:211]
    ds_read_b64_tr_b16 a[228:229], v109
    v_fma_f32 v160, v160, s37, -v236
    v_mfma_f32_16x16x32_bf16 v[196:199], a[216:219], v[180:183], v[196:199]
    ds_read_b64_tr_b16 a[230:231], v109 offset:1536
    v_fma_f32 v161, v161, s37, -v236
    v_mfma_f32_16x16x32_bf16 v[184:187], v[76:79], v[180:183], v[184:187]
    ds_read_b64_tr_b16 a[232:233], v109 offset:8
    v_fma_f32 v162, v162, s37, -v236
    v_mfma_f32_16x16x32_bf16 v[188:191], v[98:101], v[180:183], v[188:191]
    ds_read_b64_tr_b16 a[234:235], v109 offset:1544
    v_fma_f32 v163, v163, s37, -v236
    v_mfma_f32_16x16x32_bf16 v[192:195], v[120:123], v[180:183], v[192:195]
    ds_read_b128 v[148:151], v229 offset:1280
    v_fma_f32 v164, v164, s37, -v236
    v_mfma_f32_16x16x32_bf16 v[204:207], a[40:43], a[248:251], v[204:207]
    v_exp_f32 v160, v160
    v_mfma_f32_16x16x32_bf16 v[200:203], a[44:47], a[248:251], v[200:203]
    ds_read_b128 v[152:155], v229 offset:1920
    v_fma_f32 v165, v165, s37, -v236
    v_mfma_f32_16x16x32_bf16 v[220:223], a[248:251], a[108:111], v[220:223]
    ds_read_b128 v[156:159], v228 offset:1920
    v_fma_f32 v166, v166, s37, -v236
    v_mfma_f32_16x16x32_bf16 v[216:219], a[248:251], a[112:115], v[216:219]
    s_waitcnt lgkmcnt(7)
    v_exp_f32 v161, v161
    v_mfma_f32_16x16x32_bf16 v[208:211], a[48:51], a[252:255], v[208:211]
    ds_read_b128 a[248:251], v224 offset:3264
    v_cvt_pk_bf16_f32 v176, v160, v161
    v_mfma_f32_16x16x32_bf16 v[208:211], a[60:63], v[252:255], v[208:211]
    v_exp_f32 v162, v162
    v_mfma_f32_16x16x32_bf16 v[204:207], a[52:55], a[252:255], v[204:207]
    v_exp_f32 v163, v163
    v_mfma_f32_16x16x32_bf16 v[204:207], a[64:67], v[252:255], v[204:207]
    s_waitcnt lgkmcnt(3)
    v_cvt_pk_bf16_f32 v177, v162, v163
    v_fma_f32 v167, v167, s37, -v236
    v_mfma_f32_16x16x32_bf16 v[148:151], v[36:39], v[132:135], v[148:151]
    s_waitcnt lgkmcnt(2)
    ds_read_b128 v[160:163], v250
    v_cvt_pk_bf16_f32 v0, v208, v209
    v_mfma_f32_16x16x32_bf16 v[152:155], v[42:45], v[132:135], v[152:155]
    v_cvt_pk_bf16_f32 v1, v210, v211
    v_bfe_u32 v250, s66, v233, 4
    v_mfma_f32_16x16x32_bf16 v[200:203], a[56:59], a[252:255], v[200:203]
    v_cvt_pk_bf16_f32 v2, v204, v205
    v_cvt_pk_bf16_f32 v3, v206, v207
    v_mfma_f32_16x16x32_bf16 v[200:203], a[68:71], v[252:255], v[200:203]
    v_mad_u32_u24 v250, v250, s40, v231
    v_max3_f32 v248, v168, v169, v170
    v_mfma_f32_16x16x16_bf16 v[148:151], v[40:41], v[136:137], v[148:151]
    v_exp_f32 v164, v164
    v_mfma_f32_16x16x16_bf16 v[152:155], v[46:47], v[136:137], v[152:155]
    s_waitcnt lgkmcnt(1)
    v_exp_f32 v165, v165
    v_mfma_f32_16x16x32_bf16 v[156:159], v[18:21], v[132:135], v[156:159]
    v_exp_f32 v166, v166
    v_mfma_f32_16x16x32_bf16 v[220:223], a[252:255], a[120:123], v[220:223]
    v_cvt_pk_bf16_f32 v4, v200, v201
    v_cvt_pk_bf16_f32 v5, v202, v203
    v_mfma_f32_16x16x32_bf16 v[220:223], v[252:255], a[132:135], v[220:223]
    v_exp_f32 v167, v167
    v_mfma_f32_16x16x16_bf16 v[156:159], v[22:23], v[136:137], v[156:159]
    s_waitcnt lgkmcnt(0)
    v_cvt_pk_bf16_f32 v178, v164, v165
    v_cvt_pk_bf16_f32 v179, v166, v167
    v_mfma_f32_16x16x32_bf16 v[160:163], v[0:3], v[132:135], v[160:163]
    ds_read_b128 v[164:167], v235
    v_bfe_u32 v235, s65, v232, 4
    v_mfma_f32_16x16x32_bf16 v[196:199], a[216:219], v[176:179], v[196:199]
    v_cvt_pk_bf16_f32 v66, v220, v221
    v_cvt_pk_bf16_f32 v67, v222, v223
    v_mfma_f32_16x16x32_bf16 v[184:187], v[82:85], v[176:179], v[184:187]
    v_mad_u32_u24 v235, v235, s40, v230
    v_max3_f32 v249, v171, v172, v173
    v_mfma_f32_16x16x32_bf16 v[188:191], v[104:107], v[176:179], v[188:191]
    v_max3_f32 v248, v248, v174, v175
    v_max3_f32 v249, v249, v144, v145
    v_mfma_f32_16x16x32_bf16 v[192:195], v[126:129], v[176:179], v[192:195]
    v_rcp_f32 v197, v196
    v_mfma_f32_16x16x16_bf16 v[160:163], v[4:5], v[136:137], v[160:163]
    v_mul_f32 v184, v184, v197
    v_mul_f32 v185, v185, v197
    v_mfma_f32_16x16x32_bf16 v[216:219], a[252:255], a[124:127], v[216:219]
    v_cvt_pk_bf16_f32 v184, v184, v185
    v_mul_f32 v186, v186, v197
    v_mfma_f32_16x16x32_bf16 v[216:219], v[252:255], a[136:139], v[216:219]
    v_mul_f32 v187, v187, v197
    v_cvt_pk_bf16_f32 v185, v186, v187
    v_mfma_f32_16x16x32_bf16 v[212:215], a[252:255], a[128:131], v[212:215]
    ds_read_b128 a[252:255], v224 offset:3328
    v_mul_f32 v188, v188, v197
    v_mfma_f32_16x16x32_bf16 v[212:215], v[252:255], a[140:143], v[212:215]
    ds_read_b128 v[252:255], v224 offset:3392
    v_mul_f32 v189, v189, v197
    v_mfma_f32_16x16x32_bf16 v[208:211], a[0:3], a[236:239], 0
    v_cvt_pk_bf16_f32 v88, v216, v217
    v_cvt_pk_bf16_f32 v89, v218, v219
    v_mfma_f32_16x16x32_bf16 v[208:211], a[12:15], a[240:243], v[208:211]
    v_cvt_pk_bf16_f32 v186, v188, v189
    v_mul_f32 v190, v190, v197
    v_mfma_f32_16x16x32_bf16 v[204:207], a[4:7], a[236:239], 0
    v_cvt_pk_bf16_f32 v110, v212, v213
    v_cvt_pk_bf16_f32 v111, v214, v215
    v_mfma_f32_16x16x32_bf16 v[204:207], a[16:19], a[240:243], v[204:207]
    v_mul_f32 v191, v191, v197
    v_cvt_pk_bf16_f32 v187, v190, v191
    v_mfma_f32_16x16x32_bf16 v[200:203], a[8:11], a[236:239], 0
    v_mul_f32 v192, v192, v197
    v_mul_f32 v193, v193, v197
    v_mfma_f32_16x16x32_bf16 v[200:203], a[20:23], a[240:243], v[200:203]
    v_cvt_pk_bf16_f32 v188, v192, v193
    v_mul_f32 v194, v194, v197
    v_mfma_f32_16x16x32_bf16 v[220:223], a[236:239], a[72:75], 0
    v_mul_f32 v195, v195, v197
    v_cvt_pk_bf16_f32 v189, v194, v195
    v_mfma_f32_16x16x32_bf16 v[220:223], a[240:243], a[84:87], v[220:223]
    ds_write_b128 v237, v[184:187] offset:6144
    v_mfma_f32_16x16x32_bf16 v[216:219], a[236:239], a[76:79], 0
    ds_write_b64 v238, v[188:189] offset:6144
    v_mfma_f32_16x16x32_bf16 v[216:219], a[240:243], a[88:91], v[216:219]
    v_max3_f32 v248, v248, v146, v147
    v_max3_f32 v249, v249, v148, v149
    v_mfma_f32_16x16x32_bf16 v[212:215], a[236:239], a[80:83], 0
    v_max3_f32 v248, v248, v150, v151
    v_max3_f32 v249, v249, v152, v153
    v_mfma_f32_16x16x32_bf16 v[212:215], a[240:243], a[92:95], v[212:215]
    v_max3_f32 v248, v248, v154, v155
    v_max3_f32 v249, v249, v156, v157
    v_mfma_f32_16x16x32_bf16 v[208:211], a[24:27], a[244:247], v[208:211]
    ds_read_b128 a[236:239], v225 offset:42944
    ds_read_b128 a[240:243], v225 offset:43008
    v_mfma_f32_16x16x32_bf16 v[208:211], a[36:39], a[248:251], v[208:211]
    v_max3_f32 v248, v248, v158, v159
    v_max3_f32 v249, v249, v160, v161
    v_mfma_f32_16x16x32_bf16 v[204:207], a[28:31], a[244:247], v[204:207]
    v_max3_f32 v248, v248, v162, v163
    v_mfma_f32_16x16x32_bf16 v[204:207], a[40:43], a[248:251], v[204:207]
    v_mfma_f32_16x16x32_bf16 v[200:203], a[32:35], a[244:247], v[200:203]
    v_mfma_f32_16x16x32_bf16 v[200:203], a[44:47], a[248:251], v[200:203]
    v_mfma_f32_16x16x32_bf16 v[220:223], a[244:247], a[96:99], v[220:223]
    v_mfma_f32_16x16x32_bf16 v[220:223], a[248:251], a[108:111], v[220:223]
    v_mfma_f32_16x16x32_bf16 v[216:219], a[244:247], a[100:103], v[216:219]
    v_mfma_f32_16x16x32_bf16 v[216:219], a[248:251], a[112:115], v[216:219]
    v_mfma_f32_16x16x32_bf16 v[212:215], a[244:247], a[104:107], v[212:215]
    ds_read_b128 a[244:247], v225 offset:43072
    v_mfma_f32_16x16x32_bf16 v[212:215], a[248:251], a[116:119], v[212:215]
    s_waitcnt lgkmcnt(1)
    ds_read_b128 a[248:251], v225 offset:43136
    v_mfma_f32_16x16x32_bf16 v[208:211], a[48:51], a[252:255], v[208:211]
    v_mfma_f32_16x16x32_bf16 v[208:211], a[60:63], v[252:255], v[208:211]
    v_mfma_f32_16x16x32_bf16 v[204:207], a[52:55], a[252:255], v[204:207]
    v_mfma_f32_16x16x32_bf16 v[204:207], a[64:67], v[252:255], v[204:207]
    v_mfma_f32_16x16x32_bf16 v[200:203], a[56:59], a[252:255], v[200:203]
    v_mfma_f32_16x16x32_bf16 v[200:203], a[68:71], v[252:255], v[200:203]
    v_mfma_f32_16x16x32_bf16 v[220:223], a[252:255], a[120:123], v[220:223]
    v_mfma_f32_16x16x32_bf16 v[220:223], v[252:255], a[132:135], v[220:223]
    v_mfma_f32_16x16x32_bf16 v[216:219], a[252:255], a[124:127], v[216:219]
    v_mfma_f32_16x16x32_bf16 v[216:219], v[252:255], a[136:139], v[216:219]
    v_cvt_pk_bf16_f32 v24, v208, v209
    v_cvt_pk_bf16_f32 v25, v210, v211
    v_mfma_f32_16x16x32_bf16 v[212:215], a[252:255], a[128:131], v[212:215]
    v_cvt_pk_bf16_f32 v26, v204, v205
    v_cvt_pk_bf16_f32 v27, v206, v207
    v_mfma_f32_16x16x32_bf16 v[212:215], v[252:255], a[140:143], v[212:215]
    v_cvt_pk_bf16_f32 v28, v200, v201
    v_cvt_pk_bf16_f32 v29, v202, v203
    v_mfma_f32_16x16x32_bf16 v[164:167], v[24:27], v[132:135], v[164:167]
    v_cvt_pk_bf16_f32 v68, v220, v221
    v_cvt_pk_bf16_f32 v69, v222, v223
    v_mfma_f32_16x16x32_bf16 v[208:211], a[144:147], a[236:239], 0
    v_cvt_pk_bf16_f32 v90, v216, v217
    v_cvt_pk_bf16_f32 v91, v218, v219
    v_mfma_f32_16x16x32_bf16 v[208:211], a[156:159], a[240:243], v[208:211]
    v_cvt_pk_bf16_f32 v112, v212, v213
    v_cvt_pk_bf16_f32 v113, v214, v215
    v_mfma_f32_16x16x16_bf16 v[164:167], v[28:29], v[136:137], v[164:167]
    ds_read_b128 a[252:255], v225 offset:43200
    ds_read_b128 v[252:255], v225 offset:43264
    v_mfma_f32_16x16x32_bf16 v[204:207], a[148:151], a[236:239], 0
    v_mfma_f32_16x16x32_bf16 v[204:207], a[160:163], a[240:243], v[204:207]
    v_mfma_f32_16x16x32_bf16 v[200:203], a[152:155], a[236:239], 0
    ds_read_b128 a[236:239], v226 offset:1152
    v_mfma_f32_16x16x32_bf16 v[200:203], a[164:167], a[240:243], v[200:203]
    s_waitcnt lgkmcnt(3)
    ds_read_b128 a[240:243], v226 offset:1216
    v_max3_f32 v249, v249, v164, v165
    v_mfma_f32_16x16x32_bf16 v[208:211], a[168:171], a[244:247], v[208:211]
    v_max3_f32 v248, v248, v166, v167
    v_max_f32 v248, v248, v249
    v_mfma_f32_16x16x32_bf16 v[208:211], a[180:183], a[248:251], v[208:211]
    v_mov_b32 v249, v248
    v_mfma_f32_16x16x32_bf16 v[204:207], a[172:175], a[244:247], v[204:207]
    s_waitcnt lgkmcnt(2)
    v_mfma_f32_16x16x32_bf16 v[204:207], a[184:187], a[248:251], v[204:207]
    s_barrier
    buffer_load_dwordx4 v246, s[4:7], s56 offen lds
    v_mfma_f32_16x16x32_bf16 v[200:203], a[176:179], a[244:247], v[200:203]
    ds_read_b128 a[244:247], v226 offset:1280
    v_mfma_f32_16x16x32_bf16 v[200:203], a[188:191], a[248:251], v[200:203]
    ds_read_b128 a[248:251], v226 offset:1344
    v_mfma_f32_16x16x32_bf16 v[208:211], a[192:195], a[252:255], v[208:211]
    v_permlane16_swap_b32 v248, v249
    v_mfma_f32_16x16x32_bf16 v[208:211], a[204:207], v[252:255], v[208:211]
    v_max_f32 v248, v248, v249
    v_mov_b32 v249, v248
    v_mfma_f32_16x16x32_bf16 v[204:207], a[196:199], a[252:255], v[204:207]
    v_mfma_f32_16x16x32_bf16 v[204:207], a[208:211], v[252:255], v[204:207]
    v_permlane32_swap_b32 v248, v249
    v_mfma_f32_16x16x32_bf16 v[200:203], a[200:203], a[252:255], v[200:203]
    ds_read_b128 a[252:255], v226 offset:1408
    v_max_f32 v248, v248, v249
    v_mfma_f32_16x16x32_bf16 v[200:203], a[212:215], v[252:255], v[200:203]
    s_waitcnt lgkmcnt(3)
    v_cvt_pk_bf16_f32 v138, v208, v209
    v_cvt_pk_bf16_f32 v139, v210, v211
    v_mfma_f32_16x16x32_bf16 v[220:223], a[144:147], a[236:239], 0
    v_cvt_pk_bf16_f32 v140, v204, v205
    v_cvt_pk_bf16_f32 v141, v206, v207
    v_mfma_f32_16x16x32_bf16 v[220:223], a[156:159], a[240:243], v[220:223]
    ds_read_b128 v[252:255], v226 offset:1472
    v_mul_f32 v236, s37, v248
    v_mfma_f32_16x16x32_bf16 v[216:219], a[148:151], a[236:239], 0
    v_cvt_pk_bf16_f32 v142, v200, v201
    v_cvt_pk_bf16_f32 v143, v202, v203
    v_mfma_f32_16x16x32_bf16 v[216:219], a[160:163], a[240:243], v[216:219]
    buffer_load_dwordx4 v247, s[4:7], s56 offen offset:1024 lds
    v_mfma_f32_16x16x32_bf16 v[212:215], a[152:155], a[236:239], 0
    s_add_u32 s56, s56, s42
    ds_read_b128 a[236:239], v227 offset:6144
    v_fma_f32 v168, v168, s37, -v236
    v_mfma_f32_16x16x32_bf16 v[212:215], a[164:167], a[240:243], v[212:215]
    s_add_u32 m0, s41, 0x9740
    ds_read_b128 a[240:243], v227 offset:6208
    v_fma_f32 v169, v169, s37, -v236
    s_waitcnt lgkmcnt(4)
    v_mfma_f32_16x16x32_bf16 v[220:223], a[168:171], a[244:247], v[220:223]
    v_fma_f32 v170, v170, s37, -v236
    v_fma_f32 v171, v171, s37, -v236
    v_mfma_f32_16x16x32_bf16 v[220:223], a[180:183], a[248:251], v[220:223]
    v_exp_f32 v168, v168
    v_mfma_f32_16x16x32_bf16 v[216:219], a[172:175], a[244:247], v[216:219]
    v_exp_f32 v169, v169
    v_mfma_f32_16x16x32_bf16 v[216:219], a[184:187], a[248:251], v[216:219]
    v_exp_f32 v170, v170
    v_mfma_f32_16x16x32_bf16 v[212:215], a[176:179], a[244:247], v[212:215]
    ds_read_b128 a[244:247], v227 offset:6272
    v_cvt_pk_bf16_f32 v180, v168, v169
    v_mfma_f32_16x16x32_bf16 v[212:215], a[188:191], a[248:251], v[212:215]
    s_waitcnt lgkmcnt(3)
    ds_read_b128 a[248:251], v227 offset:6336
    v_fma_f32 v172, v172, s37, -v236
    v_mfma_f32_16x16x32_bf16 v[220:223], a[192:195], a[252:255], v[220:223]
    buffer_load_dwordx4 v246, s[4:7], s56 offen lds
    v_mfma_f32_16x16x32_bf16 v[220:223], a[204:207], v[252:255], v[220:223]
    v_exp_f32 v171, v171
    v_mfma_f32_16x16x32_bf16 v[216:219], a[196:199], a[252:255], v[216:219]
    v_cvt_pk_bf16_f32 v181, v170, v171
    v_fma_f32 v173, v173, s37, -v236
    v_mfma_f32_16x16x32_bf16 v[216:219], a[208:211], v[252:255], v[216:219]
    ds_read_b128 v[168:171], v234
    v_bfe_u32 v234, s67, v233, 4
    v_mfma_f32_16x16x32_bf16 v[212:215], a[200:203], a[252:255], v[212:215]
    v_cvt_pk_bf16_f32 v132, v220, v221
    v_cvt_pk_bf16_f32 v133, v222, v223
    v_mfma_f32_16x16x32_bf16 v[212:215], a[212:215], v[252:255], v[212:215]
    s_waitcnt lgkmcnt(3)
    ds_read_b128 a[252:255], v227 offset:6400
    ds_read_b128 v[252:255], v227 offset:6464
    v_mfma_f32_16x16x32_bf16 v[208:211], a[0:3], a[236:239], 0
    v_cvt_pk_bf16_f32 v134, v216, v217
    v_cvt_pk_bf16_f32 v135, v218, v219
    v_mfma_f32_16x16x32_bf16 v[208:211], a[12:15], a[240:243], v[208:211]
    v_mad_u32_u24 v234, v234, s40, v231
    v_fma_f32 v174, v174, s37, -v236
    v_mfma_f32_16x16x32_bf16 v[204:207], a[4:7], a[236:239], 0
    v_cvt_pk_bf16_f32 v136, v212, v213
    v_cvt_pk_bf16_f32 v137, v214, v215
    v_mfma_f32_16x16x32_bf16 v[204:207], a[16:19], a[240:243], v[204:207]
    buffer_load_dwordx4 v247, s[4:7], s56 offen offset:1024 lds
    v_mfma_f32_16x16x32_bf16 v[200:203], a[8:11], a[236:239], 0
    s_add_u32 s56, s56, s42
    v_fma_f32 v175, v175, s37, -v236
    v_fma_f32 v144, v144, s37, -v236
    v_mfma_f32_16x16x32_bf16 v[200:203], a[20:23], a[240:243], v[200:203]
    s_add_u32 m0, s41, 0xb580
    v_exp_f32 v172, v172
    s_waitcnt lgkmcnt(2)
    v_mfma_f32_16x16x32_bf16 v[168:171], v[24:27], v[138:141], v[168:171]
    v_exp_f32 v173, v173
    v_mfma_f32_16x16x32_bf16 v[220:223], a[236:239], a[72:75], 0
    v_exp_f32 v174, v174
    v_mfma_f32_16x16x32_bf16 v[220:223], a[240:243], a[84:87], v[220:223]
    v_exp_f32 v175, v175
    v_mfma_f32_16x16x32_bf16 v[216:219], a[236:239], a[76:79], 0
    v_cvt_pk_bf16_f32 v182, v172, v173
    v_cvt_pk_bf16_f32 v183, v174, v175
    v_mfma_f32_16x16x32_bf16 v[216:219], a[240:243], a[88:91], v[216:219]
    ds_read_b128 v[172:175], v235
    v_bfe_u32 v235, s68, v233, 4
    v_mfma_f32_16x16x32_bf16 v[196:199], a[216:219], v[180:183], 0
    v_mad_u32_u24 v235, v235, s40, v231
    v_fma_f32 v145, v145, s37, -v236
    v_mfma_f32_16x16x32_bf16 v[184:187], v[70:73], v[180:183], 0
    v_fma_f32 v146, v146, s37, -v236
    v_fma_f32 v147, v147, s37, -v236
    v_mfma_f32_16x16x32_bf16 v[188:191], v[92:95], v[180:183], 0
    v_exp_f32 v144, v144
    v_mfma_f32_16x16x32_bf16 v[192:195], v[114:117], v[180:183], 0
    v_exp_f32 v145, v145
    v_mfma_f32_16x16x16_bf16 v[168:171], v[28:29], v[142:143], v[168:171]
    v_exp_f32 v146, v146
    v_mfma_f32_16x16x32_bf16 v[212:215], a[236:239], a[80:83], 0
    ds_read_b128 a[236:239], v239
    v_cvt_pk_bf16_f32 v176, v144, v145
    v_mfma_f32_16x16x32_bf16 v[212:215], a[240:243], a[92:95], v[212:215]
    s_waitcnt lgkmcnt(1)
    ds_read_b128 a[240:243], v240
    v_fma_f32 v148, v148, s37, -v236
    v_mfma_f32_16x16x32_bf16 v[172:175], v[30:33], v[138:141], v[172:175]
    v_exp_f32 v147, v147
    v_mfma_f32_16x16x32_bf16 v[208:211], a[24:27], a[244:247], v[208:211]
    v_cvt_pk_bf16_f32 v177, v146, v147
    v_fma_f32 v149, v149, s37, -v236
    v_mfma_f32_16x16x32_bf16 v[208:211], a[36:39], a[248:251], v[208:211]
    ds_read_b128 v[144:147], v230 offset:1280
    v_fma_f32 v150, v150, s37, -v236
    v_mfma_f32_16x16x16_bf16 v[172:175], v[34:35], v[142:143], v[172:175]
    v_fma_f32 v151, v151, s37, -v236
    v_fma_f32 v152, v152, s37, -v236
    v_mfma_f32_16x16x32_bf16 v[204:207], a[28:31], a[244:247], v[204:207]
    v_exp_f32 v148, v148
    v_mfma_f32_16x16x32_bf16 v[204:207], a[40:43], a[248:251], v[204:207]
    v_exp_f32 v149, v149
    v_mfma_f32_16x16x32_bf16 v[200:203], a[32:35], a[244:247], v[200:203]
    v_exp_f32 v150, v150
    v_mfma_f32_16x16x32_bf16 v[200:203], a[44:47], a[248:251], v[200:203]
    v_exp_f32 v151, v151
    v_mfma_f32_16x16x32_bf16 v[220:223], a[244:247], a[96:99], v[220:223]
    v_cvt_pk_bf16_f32 v178, v148, v149
    v_cvt_pk_bf16_f32 v179, v150, v151
    v_mfma_f32_16x16x32_bf16 v[220:223], a[248:251], a[108:111], v[220:223]
    ds_read_b128 v[148:151], v230 offset:1920
    v_fma_f32 v153, v153, s37, -v236
    v_mfma_f32_16x16x32_bf16 v[196:199], a[216:219], v[176:179], v[196:199]
    v_fma_f32 v154, v154, s37, -v236
    v_fma_f32 v155, v155, s37, -v236
    v_mfma_f32_16x16x32_bf16 v[184:187], v[74:77], v[176:179], v[184:187]
    v_exp_f32 v152, v152
    v_mfma_f32_16x16x32_bf16 v[188:191], v[96:99], v[176:179], v[188:191]
    v_exp_f32 v153, v153
    v_mfma_f32_16x16x32_bf16 v[192:195], v[118:121], v[176:179], v[192:195]
    s_waitcnt lgkmcnt(1)
    v_exp_f32 v154, v154
    v_mfma_f32_16x16x32_bf16 v[144:147], v[36:39], v[138:141], v[144:147]
    v_exp_f32 v155, v155
    v_mfma_f32_16x16x32_bf16 v[216:219], a[244:247], a[100:103], v[216:219]
    v_cvt_pk_bf16_f32 v180, v152, v153
    v_cvt_pk_bf16_f32 v181, v154, v155
    v_mfma_f32_16x16x32_bf16 v[216:219], a[248:251], a[112:115], v[216:219]
    ds_read_b128 v[152:155], v250
    v_bfe_u32 v250, s69, v233, 4
    v_mfma_f32_16x16x16_bf16 v[144:147], v[40:41], v[142:143], v[144:147]
    s_waitcnt lgkmcnt(1)
    v_mad_u32_u24 v250, v250, s40, v231
    v_fma_f32 v156, v156, s37, -v236
    v_mfma_f32_16x16x32_bf16 v[148:151], v[42:45], v[138:141], v[148:151]
    v_fma_f32 v157, v157, s37, -v236
    v_fma_f32 v158, v158, s37, -v236
    v_mfma_f32_16x16x32_bf16 v[212:215], a[244:247], a[104:107], v[212:215]
    ds_read_b128 a[244:247], v239 offset:1024
    v_fma_f32 v159, v159, s37, -v236
    v_mfma_f32_16x16x32_bf16 v[212:215], a[248:251], a[116:119], v[212:215]
    ds_read_b128 a[248:251], v240 offset:1024
    v_fma_f32 v160, v160, s37, -v236
    v_mfma_f32_16x16x16_bf16 v[148:151], v[46:47], v[142:143], v[148:151]
    v_exp_f32 v156, v156
    v_mfma_f32_16x16x32_bf16 v[208:211], a[48:51], a[252:255], v[208:211]
    v_exp_f32 v157, v157
    v_mfma_f32_16x16x32_bf16 v[208:211], a[60:63], v[252:255], v[208:211]
    s_waitcnt lgkmcnt(2)
    v_exp_f32 v158, v158
    v_mfma_f32_16x16x32_bf16 v[152:155], v[48:51], v[138:141], v[152:155]
    v_exp_f32 v159, v159
    v_mfma_f32_16x16x32_bf16 v[204:207], a[52:55], a[252:255], v[204:207]
    v_cvt_pk_bf16_f32 v182, v156, v157
    v_cvt_pk_bf16_f32 v183, v158, v159
    v_mfma_f32_16x16x32_bf16 v[204:207], a[64:67], v[252:255], v[204:207]
    ds_read_b128 v[156:159], v234
    v_cvt_pk_bf16_f32 v60, v208, v209
    v_mfma_f32_16x16x32_bf16 v[196:199], a[216:219], v[180:183], v[196:199]
    v_cvt_pk_bf16_f32 v61, v210, v211
    v_bfe_u32 v234, s70, v233, 4
    v_mfma_f32_16x16x32_bf16 v[184:187], v[78:81], v[180:183], v[184:187]
    v_mad_u32_u24 v234, v234, s40, v231
    v_fma_f32 v161, v161, s37, -v236
    v_mfma_f32_16x16x32_bf16 v[188:191], v[100:103], v[180:183], v[188:191]
    v_cvt_pk_bf16_f32 v62, v204, v205
    v_cvt_pk_bf16_f32 v63, v206, v207
    v_mfma_f32_16x16x32_bf16 v[192:195], v[122:125], v[180:183], v[192:195]
    v_fma_f32 v162, v162, s37, -v236
    v_fma_f32 v163, v163, s37, -v236
    v_mfma_f32_16x16x16_bf16 v[152:155], v[52:53], v[142:143], v[152:155]
    v_exp_f32 v160, v160
    v_mfma_f32_16x16x32_bf16 v[200:203], a[56:59], a[252:255], v[200:203]
    v_exp_f32 v161, v161
    v_mfma_f32_16x16x32_bf16 v[200:203], a[68:71], v[252:255], v[200:203]
    s_waitcnt lgkmcnt(0)
    v_exp_f32 v162, v162
    v_mfma_f32_16x16x32_bf16 v[156:159], v[54:57], v[138:141], v[156:159]
    v_exp_f32 v163, v163
    v_mfma_f32_16x16x32_bf16 v[220:223], a[252:255], a[120:123], v[220:223]
    v_cvt_pk_bf16_f32 v176, v160, v161
    v_cvt_pk_bf16_f32 v177, v162, v163
    v_mfma_f32_16x16x32_bf16 v[220:223], v[252:255], a[132:135], v[220:223]
    ds_read_b128 v[160:163], v235
    v_cvt_pk_bf16_f32 v64, v200, v201
    v_mfma_f32_16x16x16_bf16 v[156:159], v[58:59], v[142:143], v[156:159]
    v_cvt_pk_bf16_f32 v65, v202, v203
    v_bfe_u32 v235, s71, v233, 4
    v_mfma_f32_16x16x32_bf16 v[216:219], a[252:255], a[124:127], v[216:219]
    v_mad_u32_u24 v235, v235, s40, v231
    v_fma_f32 v164, v164, s37, -v236
    v_mfma_f32_16x16x32_bf16 v[216:219], v[252:255], a[136:139], v[216:219]
    v_cvt_pk_bf16_f32 v86, v220, v221
    v_cvt_pk_bf16_f32 v87, v222, v223
    v_mfma_f32_16x16x32_bf16 v[212:215], a[252:255], a[128:131], v[212:215]
    ds_read_b128 a[252:255], v241 offset:12288
    v_fma_f32 v165, v165, s37, -v236
    v_mfma_f32_16x16x32_bf16 v[212:215], v[252:255], a[140:143], v[212:215]
    ds_read_b128 v[252:255], v241 offset:12800
    v_fma_f32 v166, v166, s37, -v236
    v_mfma_f32_16x16x32_bf16 v[208:211], a[220:223], a[236:239], 0
    v_cvt_pk_bf16_f32 v108, v216, v217
    v_cvt_pk_bf16_f32 v109, v218, v219
    v_mfma_f32_16x16x32_bf16 v[200:203], a[220:223], a[240:243], 0
    s_waitcnt lgkmcnt(2)
    v_fma_f32 v167, v167, s37, -v236
    v_max3_f32 v248, v168, v169, v170
    v_mfma_f32_16x16x32_bf16 v[160:163], v[60:63], v[138:141], v[160:163]
    v_cvt_pk_bf16_f32 v130, v212, v213
    v_cvt_pk_bf16_f32 v131, v214, v215
    v_mfma_f32_16x16x32_bf16 v[204:207], a[224:227], a[236:239], 0
    v_exp_f32 v164, v164
    v_mfma_f32_16x16x32_bf16 v[220:223], a[224:227], a[240:243], 0
    ds_read_b128 a[240:243], v242 offset:12800
    v_max3_f32 v249, v171, v172, v173
    v_mfma_f32_16x16x16_bf16 v[160:163], v[64:65], v[142:143], v[160:163]
    v_exp_f32 v165, v165
    v_mfma_f32_16x16x32_bf16 v[216:219], a[228:231], a[236:239], 0
    v_exp_f32 v166, v166
    v_mfma_f32_16x16x32_bf16 v[212:215], a[232:235], a[236:239], 0
    s_waitcnt lgkmcnt(1)
    ds_read_b128 a[236:239], v242 offset:12288
    v_cvt_pk_bf16_f32 v178, v164, v165
    v_mfma_f32_16x16x32_bf16 v[208:211], a[252:255], a[244:247], v[208:211]
    v_exp_f32 v167, v167
    v_mfma_f32_16x16x32_bf16 v[200:203], a[252:255], a[248:251], v[200:203]
    ds_read_b128 a[252:255], v241 offset:24576
    v_cvt_pk_bf16_f32 v179, v166, v167
    v_mfma_f32_16x16x32_bf16 v[204:207], v[252:255], a[244:247], v[204:207]
    ds_read_b128 v[164:167], v228 offset:640
    v_max3_f32 v248, v248, v174, v175
    v_mfma_f32_16x16x32_bf16 v[196:199], a[216:219], v[176:179], v[196:199]
    v_max3_f32 v249, v249, v144, v145
    v_max3_f32 v248, v248, v146, v147
    v_mfma_f32_16x16x32_bf16 v[184:187], v[66:69], v[176:179], v[184:187]
    v_max3_f32 v249, v249, v148, v149
    v_max3_f32 v248, v248, v150, v151
    v_mfma_f32_16x16x32_bf16 v[188:191], v[88:91], v[176:179], v[188:191]
    v_max3_f32 v249, v249, v152, v153
    v_max3_f32 v248, v248, v154, v155
    v_mfma_f32_16x16x32_bf16 v[192:195], v[110:113], v[176:179], v[192:195]
    v_rcp_f32 v197, v196
    v_mfma_f32_16x16x32_bf16 v[220:223], v[252:255], a[248:251], v[220:223]
    s_waitcnt lgkmcnt(2)
    ds_read_b128 a[248:251], v240 offset:2048
    ds_read_b128 v[252:255], v241 offset:25088
    v_mfma_f32_16x16x32_bf16 v[216:219], a[236:239], a[244:247], v[216:219]
    ds_read_b128 a[236:239], v242 offset:24576
    v_mul_f32 v184, v184, v197
    v_mfma_f32_16x16x32_bf16 v[212:215], a[240:243], a[244:247], v[212:215]
    s_waitcnt lgkmcnt(3)
    ds_read_b128 a[244:247], v239 offset:2048
    v_mul_f32 v185, v185, v197
    v_mfma_f32_16x16x32_bf16 v[164:167], v[12:15], v[132:135], v[164:167]
    ds_read_b128 a[240:243], v242 offset:25088
    v_cvt_pk_bf16_f32 v184, v184, v185
    v_mul_f32 v186, v186, v197
    v_mul_f32 v187, v187, v197
    v_cvt_pk_bf16_f32 v185, v186, v187
    v_mul_f32 v188, v188, v197
    v_mfma_f32_16x16x16_bf16 v[164:167], v[16:17], v[136:137], v[164:167]
    s_waitcnt lgkmcnt(4)
    v_mul_f32 v189, v189, v197
    v_cvt_pk_bf16_f32 v186, v188, v189
    v_mul_f32 v190, v190, v197
    v_mul_f32 v191, v191, v197
    v_cvt_pk_bf16_f32 v187, v190, v191
    v_mul_f32 v192, v192, v197
    v_mfma_f32_16x16x32_bf16 v[200:203], a[252:255], a[248:251], v[200:203]
    s_waitcnt lgkmcnt(3)
    v_mul_f32 v193, v193, v197
    v_cvt_pk_bf16_f32 v188, v192, v193
    v_mfma_f32_16x16x32_bf16 v[220:223], v[252:255], a[248:251], v[220:223]
    s_waitcnt lgkmcnt(1)
    ds_read_b128 a[248:251], v240 offset:3072
    v_mul_f32 v194, v194, v197
    v_mul_f32 v195, v195, v197
    v_cvt_pk_bf16_f32 v189, v194, v195
    ds_write_b128 v237, v[184:187] offset:12288
    v_mfma_f32_16x16x32_bf16 v[208:211], a[252:255], a[244:247], v[208:211]
    ds_write_b64 v238, v[188:189] offset:12288
    v_mfma_f32_16x16x32_bf16 v[204:207], v[252:255], a[244:247], v[204:207]
    v_max3_f32 v249, v249, v156, v157
    v_max3_f32 v248, v248, v158, v159
    v_mfma_f32_16x16x32_bf16 v[216:219], a[236:239], a[244:247], v[216:219]
    s_waitcnt lgkmcnt(3)
    v_max3_f32 v249, v249, v160, v161
    v_max3_f32 v248, v248, v162, v163
    v_mfma_f32_16x16x32_bf16 v[212:215], a[240:243], a[244:247], v[212:215]
    v_max_f32 v248, v248, v249
    v_mov_b32 v249, v248
    s_nop 1
    ds_read_b128 a[244:247], v239 offset:3072
    ds_read_b128 a[252:255], v241 offset:36864
    v_permlane16_swap_b32 v248, v249
    ds_read_b128 v[252:255], v241 offset:37376
    v_max_f32 v248, v248, v249
    ds_read_b128 a[236:239], v242 offset:36864
    v_mov_b32 v249, v248
    ds_read_b128 a[240:243], v242 offset:37376
    s_nop 0
    v_permlane32_swap_b32 v248, v249
    v_max_f32 v248, v248, v249
    v_mul_f32 v236, s37, v248
    v_fma_f32 v168, v168, s37, -v236
    v_fma_f32 v169, v169, s37, -v236
    v_fma_f32 v170, v170, s37, -v236
    v_fma_f32 v171, v171, s37, -v236
    v_exp_f32 v168, v168
    v_exp_f32 v169, v169
    v_exp_f32 v170, v170
    s_waitcnt lgkmcnt(3)
    v_mfma_f32_16x16x32_bf16 v[208:211], a[252:255], a[244:247], v[208:211]
    v_exp_f32 v171, v171
    v_mfma_f32_16x16x32_bf16 v[200:203], a[252:255], a[248:251], v[200:203]
    s_waitcnt lgkmcnt(2)
    ds_read_b128 a[252:255], v241 offset:49152
    v_cvt_pk_bf16_f32 v180, v168, v169
    v_mfma_f32_16x16x32_bf16 v[204:207], v[252:255], a[244:247], v[204:207]
    v_cvt_pk_bf16_f32 v181, v170, v171
    v_fma_f32 v172, v172, s37, -v236
    v_mfma_f32_16x16x32_bf16 v[220:223], v[252:255], a[248:251], v[220:223]
    s_waitcnt lgkmcnt(2)
    ds_read_b128 a[248:251], v240 offset:4096
    ds_read_b128 v[252:255], v241 offset:49664
    v_mfma_f32_16x16x32_bf16 v[216:219], a[236:239], a[244:247], v[216:219]
    s_waitcnt lgkmcnt(3)
    ds_read_b128 a[236:239], v242 offset:49152
    v_fma_f32 v173, v173, s37, -v236
    v_mfma_f32_16x16x32_bf16 v[212:215], a[240:243], a[244:247], v[212:215]
    s_waitcnt lgkmcnt(2)
    ds_read_b128 a[244:247], v239 offset:4096
    v_fma_f32 v174, v174, s37, -v236
    v_fma_f32 v175, v175, s37, -v236
    v_exp_f32 v172, v172
    ds_read_b128 a[240:243], v242 offset:49664
    ds_read_b128 v[168:171], v229 offset:640
    v_exp_f32 v173, v173
    v_exp_f32 v174, v174
    v_exp_f32 v175, v175
    v_cvt_pk_bf16_f32 v182, v172, v173
    v_cvt_pk_bf16_f32 v183, v174, v175
    ds_read_b128 v[172:175], v229 offset:1280
    v_mfma_f32_16x16x32_bf16 v[200:203], a[252:255], a[248:251], v[200:203]
    v_fma_f32 v144, v144, s37, -v236
    v_fma_f32 v145, v145, s37, -v236
    v_mfma_f32_16x16x32_bf16 v[196:199], a[216:219], v[180:183], 0
    v_fma_f32 v146, v146, s37, -v236
    v_fma_f32 v147, v147, s37, -v236
    v_mfma_f32_16x16x32_bf16 v[184:187], v[68:71], v[180:183], 0
    v_exp_f32 v144, v144
    v_mfma_f32_16x16x32_bf16 v[188:191], v[90:93], v[180:183], 0
    v_exp_f32 v145, v145
    v_mfma_f32_16x16x32_bf16 v[192:195], v[112:115], v[180:183], 0
    s_waitcnt lgkmcnt(1)
    v_exp_f32 v146, v146
    v_mfma_f32_16x16x32_bf16 v[168:171], v[36:39], v[132:135], v[168:171]
    v_exp_f32 v147, v147
    v_mfma_f32_16x16x32_bf16 v[208:211], a[252:255], a[244:247], v[208:211]
    s_waitcnt lgkmcnt(0)
    ds_read_b128 a[252:255], v241 offset:61440
    v_cvt_pk_bf16_f32 v176, v144, v145
    v_mfma_f32_16x16x32_bf16 v[172:175], v[42:45], v[132:135], v[172:175]
    v_cvt_pk_bf16_f32 v177, v146, v147
    v_fma_f32 v148, v148, s37, -v236
    v_mfma_f32_16x16x16_bf16 v[168:171], v[40:41], v[136:137], v[168:171]
    ds_read_b128 v[144:147], v228 offset:1280
    v_fma_f32 v149, v149, s37, -v236
    v_mfma_f32_16x16x32_bf16 v[204:207], v[252:255], a[244:247], v[204:207]
    v_fma_f32 v150, v150, s37, -v236
    v_fma_f32 v151, v151, s37, -v236
    v_mfma_f32_16x16x16_bf16 v[172:175], v[46:47], v[136:137], v[172:175]
    v_exp_f32 v148, v148
    v_mfma_f32_16x16x32_bf16 v[220:223], v[252:255], a[248:251], v[220:223]
    ds_read_b128 a[248:251], v240 offset:5120
    ds_read_b128 v[252:255], v241 offset:61952
    v_mfma_f32_16x16x32_bf16 v[216:219], a[236:239], a[244:247], v[216:219]
    ds_read_b128 a[236:239], v242 offset:61440
    v_fma_f32 v152, v152, s37, -v236
    v_mfma_f32_16x16x32_bf16 v[212:215], a[240:243], a[244:247], v[212:215]
    s_waitcnt lgkmcnt(3)
    ds_read_b128 a[244:247], v239 offset:5120
    v_exp_f32 v149, v149
    v_exp_f32 v150, v150
    ds_read_b128 a[240:243], v242 offset:61952
    v_mfma_f32_16x16x32_bf16 v[144:147], v[18:21], v[132:135], v[144:147]
    v_exp_f32 v151, v151
    v_cvt_pk_bf16_f32 v178, v148, v149
    v_cvt_pk_bf16_f32 v179, v150, v151
    ds_read_b128 v[148:151], v228 offset:1920
    v_fma_f32 v153, v153, s37, -v236
    v_mfma_f32_16x16x32_bf16 v[196:199], a[216:219], v[176:179], v[196:199]
    v_fma_f32 v154, v154, s37, -v236
    v_fma_f32 v155, v155, s37, -v236
    v_mfma_f32_16x16x32_bf16 v[184:187], v[76:79], v[176:179], v[184:187]
    v_exp_f32 v152, v152
    v_mfma_f32_16x16x32_bf16 v[188:191], v[98:101], v[176:179], v[188:191]
    v_exp_f32 v153, v153
    v_mfma_f32_16x16x32_bf16 v[192:195], v[120:123], v[176:179], v[192:195]
    v_exp_f32 v154, v154
    v_mfma_f32_16x16x16_bf16 v[144:147], v[22:23], v[136:137], v[144:147]
    s_waitcnt lgkmcnt(2)
    v_exp_f32 v155, v155
    v_mfma_f32_16x16x32_bf16 v[208:211], a[252:255], a[244:247], v[208:211]
    v_cvt_pk_bf16_f32 v180, v152, v153
    v_cvt_pk_bf16_f32 v181, v154, v155
    v_mfma_f32_16x16x32_bf16 v[200:203], a[252:255], a[248:251], v[200:203]
    s_waitcnt lgkmcnt(0)
    ds_read_b128 a[252:255], v224 offset:15616
    ds_read_b128 v[152:155], v229 offset:1920
    v_mfma_f32_16x16x32_bf16 v[148:151], v[0:3], v[132:135], v[148:151]
    v_fma_f32 v156, v156, s37, -v236
    v_fma_f32 v157, v157, s37, -v236
    v_mfma_f32_16x16x32_bf16 v[204:207], v[252:255], a[244:247], v[204:207]
    v_cvt_pk_bf16_f32 v208, v208, v209
    v_cvt_pk_bf16_f32 v209, v210, v211
    v_mfma_f32_16x16x32_bf16 v[220:223], v[252:255], a[248:251], v[220:223]
    ds_read_b128 a[248:251], v224 offset:15552
    ds_read_b128 v[252:255], v224 offset:15680
    v_mfma_f32_16x16x16_bf16 v[148:151], v[4:5], v[136:137], v[148:151]
    v_cvt_pk_bf16_f32 v200, v200, v201
    v_cvt_pk_bf16_f32 v201, v202, v203
    v_mfma_f32_16x16x32_bf16 v[216:219], a[236:239], a[244:247], v[216:219]
    ds_read_b128 a[236:239], v224 offset:15744
    v_cvt_pk_bf16_f32 v210, v204, v205
    v_mfma_f32_16x16x32_bf16 v[212:215], a[240:243], a[244:247], v[212:215]
    s_waitcnt lgkmcnt(3)
    ds_read_b128 a[244:247], v224 offset:15488
    ds_read_b128 a[240:243], v224 offset:15808
    v_cvt_pk_bf16_f32 v211, v206, v207
    buffer_store_dwordx4 v[208:211], v243, s[20:23], s51 offen sc0 sc1
    v_mfma_f32_16x16x32_bf16 v[152:155], v[24:27], v[132:135], v[152:155]
    v_cvt_pk_bf16_f32 v202, v220, v221
    v_cvt_pk_bf16_f32 v203, v222, v223
    v_cvt_pk_bf16_f32 v216, v216, v217
    v_cvt_pk_bf16_f32 v217, v218, v219
    v_cvt_pk_bf16_f32 v218, v212, v213
    v_cvt_pk_bf16_f32 v219, v214, v215
    v_mfma_f32_16x16x16_bf16 v[152:155], v[28:29], v[136:137], v[152:155]
    s_waitcnt lgkmcnt(1)
    v_fma_f32 v158, v158, s37, -v236
    v_fma_f32 v159, v159, s37, -v236
    v_exp_f32 v156, v156
    v_exp_f32 v157, v157
    v_mfma_f32_16x16x32_bf16 v[208:211], a[0:3], a[244:247], 0
    v_exp_f32 v158, v158
    v_mfma_f32_16x16x32_bf16 v[208:211], a[12:15], a[248:251], v[208:211]
    v_exp_f32 v159, v159
    v_mfma_f32_16x16x32_bf16 v[204:207], a[4:7], a[244:247], 0
    v_cvt_pk_bf16_f32 v182, v156, v157
    v_cvt_pk_bf16_f32 v183, v158, v159
    v_mfma_f32_16x16x32_bf16 v[204:207], a[16:19], a[248:251], v[204:207]
    ds_read_b128 v[156:159], v229 offset:2560
    v_fma_f32 v160, v160, s37, -v236
    v_mfma_f32_16x16x32_bf16 v[196:199], a[216:219], v[180:183], v[196:199]
    v_fma_f32 v161, v161, s37, -v236
    v_fma_f32 v162, v162, s37, -v236
    v_mfma_f32_16x16x32_bf16 v[184:187], v[82:85], v[180:183], v[184:187]
    v_fma_f32 v163, v163, s37, -v236
    v_max3_f32 v248, v164, v165, v166
    v_mfma_f32_16x16x32_bf16 v[188:191], v[104:107], v[180:183], v[188:191]
    v_exp_f32 v160, v160
    v_mfma_f32_16x16x32_bf16 v[192:195], v[126:129], v[180:183], v[192:195]
    buffer_store_dwordx4 v[200:203], v245, s[20:23], s51 offen sc0 sc1
    v_mfma_f32_16x16x32_bf16 v[220:223], a[244:247], a[72:75], 0
    v_exp_f32 v161, v161
    v_mfma_f32_16x16x32_bf16 v[220:223], a[248:251], a[84:87], v[220:223]
    v_exp_f32 v162, v162
    v_mfma_f32_16x16x32_bf16 v[200:203], a[8:11], a[244:247], 0
    v_exp_f32 v163, v163
    v_mfma_f32_16x16x32_bf16 v[200:203], a[20:23], a[248:251], v[200:203]
    v_cvt_pk_bf16_f32 v176, v160, v161
    v_cvt_pk_bf16_f32 v177, v162, v163
    v_mfma_f32_16x16x32_bf16 v[212:215], a[244:247], a[80:83], 0
    ds_read_b128 v[160:163], v228 offset:2560
    v_max3_f32 v249, v167, v168, v169
    v_mfma_f32_16x16x32_bf16 v[212:215], a[248:251], a[92:95], v[212:215]
    v_max3_f32 v248, v248, v170, v171
    v_max3_f32 v249, v249, v172, v173
    v_mfma_f32_16x16x16_bf16 v[196:199], a[216:217], v[176:177], v[196:199]
    v_max3_f32 v248, v248, v174, v175
    v_max3_f32 v249, v249, v144, v145
    v_mfma_f32_16x16x16_bf16 v[184:187], v[86:87], v[176:177], v[184:187]
    v_max3_f32 v248, v248, v146, v147
    v_max3_f32 v249, v249, v148, v149
    v_mfma_f32_16x16x16_bf16 v[188:191], v[108:109], v[176:177], v[188:191]
    v_max3_f32 v248, v248, v150, v151
    v_max3_f32 v249, v249, v152, v153
    v_mfma_f32_16x16x16_bf16 v[192:195], v[130:131], v[176:177], v[192:195]
    v_rcp_f32 v197, v196
    v_mfma_f32_16x16x32_bf16 v[208:211], a[24:27], a[252:255], v[208:211]
    v_mul_f32 v184, v184, v197
    v_mul_f32 v185, v185, v197
    v_mfma_f32_16x16x32_bf16 v[208:211], a[36:39], v[252:255], v[208:211]
    buffer_store_dwordx4 v[216:219], v244, s[20:23], s51 offen sc0 sc1
    v_mfma_f32_16x16x32_bf16 v[204:207], a[28:31], a[252:255], v[204:207]
    s_add_u32 s51, s51, s48
    v_cvt_pk_bf16_f32 v184, v184, v185
    v_mul_f32 v186, v186, v197
    v_mfma_f32_16x16x32_bf16 v[204:207], a[40:43], v[252:255], v[204:207]
    v_mul_f32 v187, v187, v197
    v_cvt_pk_bf16_f32 v185, v186, v187
    v_mfma_f32_16x16x32_bf16 v[216:219], a[244:247], a[76:79], 0
    ds_read_b128 a[244:247], v224 offset:18560
    v_mul_f32 v188, v188, v197
    v_mfma_f32_16x16x32_bf16 v[216:219], a[248:251], a[88:91], v[216:219]
    ds_read_b128 a[248:251], v224 offset:18624
    v_mul_f32 v189, v189, v197
    v_mfma_f32_16x16x32_bf16 v[200:203], a[32:35], a[252:255], v[200:203]
    v_cvt_pk_bf16_f32 v186, v188, v189
    v_mul_f32 v190, v190, v197
    v_mfma_f32_16x16x32_bf16 v[200:203], a[44:47], v[252:255], v[200:203]
    v_mul_f32 v191, v191, v197
    v_cvt_pk_bf16_f32 v187, v190, v191
    v_mfma_f32_16x16x32_bf16 v[220:223], a[252:255], a[96:99], v[220:223]
    v_mul_f32 v192, v192, v197
    v_mul_f32 v193, v193, v197
    v_mfma_f32_16x16x32_bf16 v[220:223], v[252:255], a[108:111], v[220:223]
    v_cvt_pk_bf16_f32 v188, v192, v193
    v_mul_f32 v194, v194, v197
    v_mfma_f32_16x16x32_bf16 v[216:219], a[252:255], a[100:103], v[216:219]
    v_mul_f32 v195, v195, v197
    v_cvt_pk_bf16_f32 v189, v194, v195
    v_mfma_f32_16x16x32_bf16 v[216:219], v[252:255], a[112:115], v[216:219]
    ds_write_b128 v237, v[184:187] offset:18432
    v_mfma_f32_16x16x32_bf16 v[212:215], a[252:255], a[104:107], v[212:215]
    ds_write_b64 v238, v[188:189] offset:18432
    v_mfma_f32_16x16x32_bf16 v[212:215], v[252:255], a[116:119], v[212:215]
    v_max3_f32 v248, v248, v154, v155
    v_mfma_f32_16x16x32_bf16 v[208:211], a[48:51], a[236:239], v[208:211]
    s_waitcnt lgkmcnt(2)
    v_mfma_f32_16x16x32_bf16 v[208:211], a[60:63], a[240:243], v[208:211]
    v_mfma_f32_16x16x32_bf16 v[204:207], a[52:55], a[236:239], v[204:207]
    ds_read_b128 a[252:255], v224 offset:18688
    ds_read_b128 v[252:255], v224 offset:18752
    v_mfma_f32_16x16x32_bf16 v[204:207], a[64:67], a[240:243], v[204:207]
    v_mfma_f32_16x16x32_bf16 v[200:203], a[56:59], a[236:239], v[200:203]
    v_mfma_f32_16x16x32_bf16 v[200:203], a[68:71], a[240:243], v[200:203]
    v_mfma_f32_16x16x32_bf16 v[220:223], a[236:239], a[120:123], v[220:223]
    v_mfma_f32_16x16x32_bf16 v[220:223], a[240:243], a[132:135], v[220:223]
    v_cvt_pk_bf16_f32 v6, v208, v209
    v_cvt_pk_bf16_f32 v7, v210, v211
    v_mfma_f32_16x16x32_bf16 v[216:219], a[236:239], a[124:127], v[216:219]
    v_mfma_f32_16x16x32_bf16 v[216:219], a[240:243], a[136:139], v[216:219]
    v_cvt_pk_bf16_f32 v8, v204, v205
    v_cvt_pk_bf16_f32 v9, v206, v207
    v_mfma_f32_16x16x32_bf16 v[212:215], a[236:239], a[128:131], v[212:215]
    v_cvt_pk_bf16_f32 v10, v200, v201
    v_cvt_pk_bf16_f32 v11, v202, v203
    v_mfma_f32_16x16x32_bf16 v[212:215], a[240:243], a[140:143], v[212:215]
    v_cvt_pk_bf16_f32 v72, v220, v221
    v_cvt_pk_bf16_f32 v73, v222, v223
    v_mfma_f32_16x16x32_bf16 v[160:163], v[6:9], v[132:135], v[160:163]
    v_cvt_pk_bf16_f32 v94, v216, v217
    v_cvt_pk_bf16_f32 v95, v218, v219
    v_mfma_f32_16x16x32_bf16 v[208:211], a[0:3], a[244:247], 0
    ds_read_b128 a[236:239], v224 offset:18816
    ds_read_b128 a[240:243], v224 offset:18880
    v_mfma_f32_16x16x32_bf16 v[208:211], a[12:15], a[248:251], v[208:211]
    v_cvt_pk_bf16_f32 v116, v212, v213
    v_cvt_pk_bf16_f32 v117, v214, v215
    v_mfma_f32_16x16x16_bf16 v[160:163], v[10:11], v[136:137], v[160:163]
    v_mfma_f32_16x16x32_bf16 v[204:207], a[4:7], a[244:247], 0
    v_mfma_f32_16x16x32_bf16 v[204:207], a[16:19], a[248:251], v[204:207]
    v_mfma_f32_16x16x32_bf16 v[200:203], a[8:11], a[244:247], 0
    v_mfma_f32_16x16x32_bf16 v[200:203], a[20:23], a[248:251], v[200:203]
    v_mfma_f32_16x16x32_bf16 v[220:223], a[244:247], a[72:75], 0
    v_mfma_f32_16x16x32_bf16 v[220:223], a[248:251], a[84:87], v[220:223]
    v_mfma_f32_16x16x32_bf16 v[216:219], a[244:247], a[76:79], 0
    v_mfma_f32_16x16x32_bf16 v[216:219], a[248:251], a[88:91], v[216:219]
    v_mfma_f32_16x16x32_bf16 v[212:215], a[244:247], a[80:83], 0
    ds_read_b128 a[244:247], v226 offset:4224
    v_mfma_f32_16x16x32_bf16 v[212:215], a[248:251], a[92:95], v[212:215]
    s_waitcnt lgkmcnt(1)
    ds_read_b128 a[248:251], v226 offset:4288
    v_mfma_f32_16x16x32_bf16 v[208:211], a[24:27], a[252:255], v[208:211]
    v_mfma_f32_16x16x32_bf16 v[208:211], a[36:39], v[252:255], v[208:211]
    v_mfma_f32_16x16x32_bf16 v[204:207], a[28:31], a[252:255], v[204:207]
    v_mfma_f32_16x16x32_bf16 v[204:207], a[40:43], v[252:255], v[204:207]
    v_mfma_f32_16x16x32_bf16 v[200:203], a[32:35], a[252:255], v[200:203]
    v_mfma_f32_16x16x32_bf16 v[200:203], a[44:47], v[252:255], v[200:203]
    v_mfma_f32_16x16x32_bf16 v[220:223], a[252:255], a[96:99], v[220:223]
    v_mfma_f32_16x16x32_bf16 v[220:223], v[252:255], a[108:111], v[220:223]
    v_mfma_f32_16x16x32_bf16 v[216:219], a[252:255], a[100:103], v[216:219]
    v_mfma_f32_16x16x32_bf16 v[216:219], v[252:255], a[112:115], v[216:219]
    v_mfma_f32_16x16x32_bf16 v[212:215], a[252:255], a[104:107], v[212:215]
    ds_read_b128 a[252:255], v226 offset:4352
    v_mfma_f32_16x16x32_bf16 v[212:215], v[252:255], a[116:119], v[212:215]
    ds_read_b128 v[252:255], v226 offset:4416
    v_mfma_f32_16x16x32_bf16 v[208:211], a[48:51], a[236:239], v[208:211]
    v_mfma_f32_16x16x32_bf16 v[208:211], a[60:63], a[240:243], v[208:211]
    v_mfma_f32_16x16x32_bf16 v[204:207], a[52:55], a[236:239], v[204:207]
    v_mfma_f32_16x16x32_bf16 v[204:207], a[64:67], a[240:243], v[204:207]
    v_mfma_f32_16x16x32_bf16 v[200:203], a[56:59], a[236:239], v[200:203]
    v_mfma_f32_16x16x32_bf16 v[200:203], a[68:71], a[240:243], v[200:203]
    v_mfma_f32_16x16x32_bf16 v[220:223], a[236:239], a[120:123], v[220:223]
    v_mfma_f32_16x16x32_bf16 v[220:223], a[240:243], a[132:135], v[220:223]
    v_mfma_f32_16x16x32_bf16 v[216:219], a[236:239], a[124:127], v[216:219]
    v_mfma_f32_16x16x32_bf16 v[216:219], a[240:243], a[136:139], v[216:219]
    v_cvt_pk_bf16_f32 v30, v208, v209
    v_cvt_pk_bf16_f32 v31, v210, v211
    v_mfma_f32_16x16x32_bf16 v[212:215], a[236:239], a[128:131], v[212:215]
    v_cvt_pk_bf16_f32 v32, v204, v205
    v_cvt_pk_bf16_f32 v33, v206, v207
    v_mfma_f32_16x16x32_bf16 v[212:215], a[240:243], a[140:143], v[212:215]
    v_cvt_pk_bf16_f32 v34, v200, v201
    v_cvt_pk_bf16_f32 v35, v202, v203
    v_mfma_f32_16x16x32_bf16 v[156:159], v[30:33], v[132:135], v[156:159]
    s_waitcnt lgkmcnt(0)
    v_cvt_pk_bf16_f32 v70, v220, v221
    v_cvt_pk_bf16_f32 v71, v222, v223
    v_mfma_f32_16x16x32_bf16 v[208:211], a[144:147], a[244:247], 0
    v_cvt_pk_bf16_f32 v92, v216, v217
    v_cvt_pk_bf16_f32 v93, v218, v219
    v_mfma_f32_16x16x32_bf16 v[208:211], a[156:159], a[248:251], v[208:211]
    v_cvt_pk_bf16_f32 v114, v212, v213
    v_cvt_pk_bf16_f32 v115, v214, v215
    v_mfma_f32_16x16x16_bf16 v[156:159], v[34:35], v[136:137], v[156:159]
    ds_read_b128 a[236:239], v226 offset:4480
    ds_read_b128 a[240:243], v226 offset:4544
    v_mfma_f32_16x16x32_bf16 v[204:207], a[148:151], a[244:247], 0
    v_mfma_f32_16x16x32_bf16 v[204:207], a[160:163], a[248:251], v[204:207]
    v_mfma_f32_16x16x32_bf16 v[200:203], a[152:155], a[244:247], 0
    ds_read_b128 a[244:247], v225 offset:8896
    v_mfma_f32_16x16x32_bf16 v[200:203], a[164:167], a[248:251], v[200:203]
    ds_read_b128 a[248:251], v225 offset:8960
    v_max3_f32 v249, v249, v156, v157
    v_mfma_f32_16x16x32_bf16 v[208:211], a[168:171], a[252:255], v[208:211]
    v_max3_f32 v248, v248, v158, v159
    v_max3_f32 v249, v249, v160, v161
    v_mfma_f32_16x16x32_bf16 v[208:211], a[180:183], v[252:255], v[208:211]
    v_max3_f32 v248, v248, v162, v163
    v_max_f32 v248, v248, v249
    v_mfma_f32_16x16x32_bf16 v[204:207], a[172:175], a[252:255], v[204:207]
    s_waitcnt vmcnt(3) lgkmcnt(2)
    v_mov_b32 v249, v248
    v_mfma_f32_16x16x32_bf16 v[204:207], a[184:187], v[252:255], v[204:207]
    s_barrier
    buffer_load_dwordx4 v246, s[4:7], s56 offen lds
    v_mfma_f32_16x16x32_bf16 v[200:203], a[176:179], a[252:255], v[200:203]
    ds_read_b128 a[252:255], v225 offset:9024
    v_mfma_f32_16x16x32_bf16 v[200:203], a[188:191], v[252:255], v[200:203]
    ds_read_b128 v[252:255], v225 offset:9088
    v_mfma_f32_16x16x32_bf16 v[208:211], a[192:195], a[236:239], v[208:211]
    v_permlane16_swap_b32 v248, v249
    v_mfma_f32_16x16x32_bf16 v[208:211], a[204:207], a[240:243], v[208:211]
    v_max_f32 v248, v248, v249
    v_mov_b32 v249, v248
    v_mfma_f32_16x16x32_bf16 v[204:207], a[196:199], a[236:239], v[204:207]
    v_mfma_f32_16x16x32_bf16 v[204:207], a[208:211], a[240:243], v[204:207]
    v_permlane32_swap_b32 v248, v249
    v_mfma_f32_16x16x32_bf16 v[200:203], a[200:203], a[236:239], v[200:203]
    ds_read_b128 a[236:239], v225 offset:9152
    v_max_f32 v248, v248, v249
    v_mfma_f32_16x16x32_bf16 v[200:203], a[212:215], a[240:243], v[200:203]
    s_waitcnt lgkmcnt(3)
    v_cvt_pk_bf16_f32 v138, v208, v209
    v_cvt_pk_bf16_f32 v139, v210, v211
    v_mfma_f32_16x16x32_bf16 v[220:223], a[144:147], a[244:247], 0
    v_cvt_pk_bf16_f32 v140, v204, v205
    v_cvt_pk_bf16_f32 v141, v206, v207
    v_mfma_f32_16x16x32_bf16 v[220:223], a[156:159], a[248:251], v[220:223]
    ds_read_b128 a[240:243], v225 offset:9216
    v_mul_f32 v236, s37, v248
    v_mfma_f32_16x16x32_bf16 v[216:219], a[148:151], a[244:247], 0
    v_cvt_pk_bf16_f32 v142, v200, v201
    v_cvt_pk_bf16_f32 v143, v202, v203
    v_mfma_f32_16x16x32_bf16 v[216:219], a[160:163], a[248:251], v[216:219]
    buffer_load_dwordx4 v247, s[4:7], s56 offen offset:1024 lds
    v_mfma_f32_16x16x32_bf16 v[212:215], a[152:155], a[244:247], 0
    s_add_u32 s56, s56, s42
    ds_read_b128 a[244:247], v239 offset:12288
    v_fma_f32 v164, v164, s37, -v236
    v_mfma_f32_16x16x32_bf16 v[212:215], a[164:167], a[248:251], v[212:215]
    s_add_u32 m0, s41, 0xd3c0
    ds_read_b128 a[248:251], v240 offset:12288
    v_fma_f32 v165, v165, s37, -v236
    s_waitcnt lgkmcnt(4)
    v_mfma_f32_16x16x32_bf16 v[220:223], a[168:171], a[252:255], v[220:223]
    v_fma_f32 v166, v166, s37, -v236
    v_fma_f32 v167, v167, s37, -v236
    v_mfma_f32_16x16x32_bf16 v[220:223], a[180:183], v[252:255], v[220:223]
    v_exp_f32 v164, v164
    v_mfma_f32_16x16x32_bf16 v[216:219], a[172:175], a[252:255], v[216:219]
    v_exp_f32 v165, v165
    v_mfma_f32_16x16x32_bf16 v[216:219], a[184:187], v[252:255], v[216:219]
    v_exp_f32 v166, v166
    v_mfma_f32_16x16x32_bf16 v[212:215], a[176:179], a[252:255], v[212:215]
    ds_read_b128 a[252:255], v239 offset:13312
    v_cvt_pk_bf16_f32 v180, v164, v165
    v_mfma_f32_16x16x32_bf16 v[212:215], a[188:191], v[252:255], v[212:215]
    s_waitcnt lgkmcnt(3)
    buffer_load_dwordx4 v246, s[4:7], s56 offen lds
    v_mfma_f32_16x16x32_bf16 v[220:223], a[192:195], a[236:239], v[220:223]
    ds_read_b128 v[252:255], v240 offset:13312
    v_fma_f32 v168, v168, s37, -v236
    v_mfma_f32_16x16x32_bf16 v[220:223], a[204:207], a[240:243], v[220:223]
    v_exp_f32 v167, v167
    v_mfma_f32_16x16x32_bf16 v[216:219], a[196:199], a[236:239], v[216:219]
    v_cvt_pk_bf16_f32 v181, v166, v167
    v_fma_f32 v169, v169, s37, -v236
    v_mfma_f32_16x16x32_bf16 v[216:219], a[208:211], a[240:243], v[216:219]
    ds_read_b128 v[164:167], v230 offset:640
    v_fma_f32 v170, v170, s37, -v236
    v_mfma_f32_16x16x32_bf16 v[212:215], a[200:203], a[236:239], v[212:215]
    v_cvt_pk_bf16_f32 v132, v220, v221
    v_cvt_pk_bf16_f32 v133, v222, v223
    v_mfma_f32_16x16x32_bf16 v[212:215], a[212:215], a[240:243], v[212:215]
    s_waitcnt lgkmcnt(3)
    ds_read_b128 a[236:239], v241 offset:12288
    ds_read_b128 a[240:243], v241 offset:12800
    v_mfma_f32_16x16x32_bf16 v[208:211], a[220:223], a[244:247], 0
    v_cvt_pk_bf16_f32 v134, v216, v217
    v_cvt_pk_bf16_f32 v135, v218, v219
    v_mfma_f32_16x16x32_bf16 v[200:203], a[220:223], a[248:251], 0
    buffer_load_dwordx4 v247, s[4:7], s56 offen offset:1024 lds
    v_mfma_f32_16x16x32_bf16 v[204:207], a[224:227], a[244:247], 0
    s_add_u32 s56, s56, s42
    v_cvt_pk_bf16_f32 v136, v212, v213
    v_cvt_pk_bf16_f32 v137, v214, v215
    v_mfma_f32_16x16x32_bf16 v[220:223], a[224:227], a[248:251], 0
    s_add_u32 m0, s41, 0
    ds_read_b128 a[248:251], v242 offset:12800
    v_fma_f32 v171, v171, s37, -v236
    v_mfma_f32_16x16x32_bf16 v[216:219], a[228:231], a[244:247], 0
    s_waitcnt lgkmcnt(3)
    v_exp_f32 v168, v168
    v_mfma_f32_16x16x32_bf16 v[164:167], v[36:39], v[138:141], v[164:167]
    v_exp_f32 v169, v169
    v_mfma_f32_16x16x32_bf16 v[212:215], a[232:235], a[244:247], 0
    s_waitcnt lgkmcnt(2)
    ds_read_b128 a[244:247], v242 offset:12288
    v_cvt_pk_bf16_f32 v182, v168, v169
    v_mfma_f32_16x16x32_bf16 v[208:211], a[236:239], a[252:255], v[208:211]
    v_exp_f32 v170, v170
    v_mfma_f32_16x16x16_bf16 v[164:167], v[40:41], v[142:143], v[164:167]
    v_exp_f32 v171, v171
    v_mfma_f32_16x16x32_bf16 v[200:203], a[236:239], v[252:255], v[200:203]
    s_waitcnt lgkmcnt(2)
    ds_read_b128 a[236:239], v241 offset:24576
    v_cvt_pk_bf16_f32 v183, v170, v171
    v_mfma_f32_16x16x32_bf16 v[204:207], a[240:243], a[252:255], v[204:207]
    ds_read_b128 v[168:171], v230 offset:1280
    v_fma_f32 v172, v172, s37, -v236
    v_mfma_f32_16x16x32_bf16 v[196:199], a[216:219], v[180:183], 0
    v_fma_f32 v173, v173, s37, -v236
    v_fma_f32 v174, v174, s37, -v236
    v_mfma_f32_16x16x32_bf16 v[184:187], v[74:77], v[180:183], 0
    v_fma_f32 v175, v175, s37, -v236
    v_fma_f32 v144, v144, s37, -v236
    v_mfma_f32_16x16x32_bf16 v[188:191], v[96:99], v[180:183], 0
    v_exp_f32 v172, v172
    v_mfma_f32_16x16x32_bf16 v[192:195], v[118:121], v[180:183], 0
    v_exp_f32 v173, v173
    v_mfma_f32_16x16x32_bf16 v[220:223], a[240:243], v[252:255], v[220:223]
    s_waitcnt lgkmcnt(2)
    ds_read_b128 v[252:255], v240 offset:14336
    ds_read_b128 a[240:243], v241 offset:25088
    v_mfma_f32_16x16x32_bf16 v[216:219], a[244:247], a[252:255], v[216:219]
    ds_read_b128 a[244:247], v242 offset:24576
    v_cvt_pk_bf16_f32 v176, v172, v173
    v_mfma_f32_16x16x32_bf16 v[212:215], a[248:251], a[252:255], v[212:215]
    s_waitcnt lgkmcnt(3)
    ds_read_b128 a[252:255], v239 offset:14336
    v_fma_f32 v145, v145, s37, -v236
    v_mfma_f32_16x16x32_bf16 v[168:171], v[42:45], v[138:141], v[168:171]
    ds_read_b128 a[248:251], v242 offset:25088
    v_fma_f32 v146, v146, s37, -v236
    v_exp_f32 v174, v174
    v_exp_f32 v175, v175
    v_fma_f32 v147, v147, s37, -v236
    v_cvt_pk_bf16_f32 v177, v174, v175
    v_mfma_f32_16x16x16_bf16 v[168:171], v[46:47], v[142:143], v[168:171]
    s_waitcnt lgkmcnt(4)
    ds_read_b128 v[172:175], v230 offset:1920
    v_exp_f32 v144, v144
    v_exp_f32 v145, v145
    v_mfma_f32_16x16x32_bf16 v[200:203], a[236:239], v[252:255], v[200:203]
    s_waitcnt lgkmcnt(4)
    v_exp_f32 v146, v146
    v_mfma_f32_16x16x32_bf16 v[220:223], a[240:243], v[252:255], v[220:223]
    s_waitcnt lgkmcnt(2)
    ds_read_b128 v[252:255], v240 offset:15360
    v_exp_f32 v147, v147
    v_cvt_pk_bf16_f32 v178, v144, v145
    v_cvt_pk_bf16_f32 v179, v146, v147
    v_mfma_f32_16x16x32_bf16 v[208:211], a[236:239], a[252:255], v[208:211]
    ds_read_b128 a[236:239], v241 offset:36864
    ds_read_b128 v[144:147], v230 offset:2560
    v_mfma_f32_16x16x32_bf16 v[196:199], a[216:219], v[176:179], v[196:199]
    v_fma_f32 v148, v148, s37, -v236
    v_fma_f32 v149, v149, s37, -v236
    v_mfma_f32_16x16x32_bf16 v[184:187], v[78:81], v[176:179], v[184:187]
    v_fma_f32 v150, v150, s37, -v236
    v_fma_f32 v151, v151, s37, -v236
    v_mfma_f32_16x16x32_bf16 v[188:191], v[100:103], v[176:179], v[188:191]
    v_exp_f32 v148, v148
    v_mfma_f32_16x16x32_bf16 v[192:195], v[122:125], v[176:179], v[192:195]
    s_waitcnt lgkmcnt(3)
    v_exp_f32 v149, v149
    v_mfma_f32_16x16x32_bf16 v[172:175], v[24:27], v[138:141], v[172:175]
    v_exp_f32 v150, v150
    v_mfma_f32_16x16x32_bf16 v[204:207], a[240:243], a[252:255], v[204:207]
    ds_read_b128 a[240:243], v241 offset:37376
    v_cvt_pk_bf16_f32 v180, v148, v149
    v_mfma_f32_16x16x32_bf16 v[216:219], a[244:247], a[252:255], v[216:219]
    ds_read_b128 a[244:247], v242 offset:36864
    v_fma_f32 v152, v152, s37, -v236
    v_mfma_f32_16x16x16_bf16 v[172:175], v[28:29], v[142:143], v[172:175]
    s_waitcnt lgkmcnt(2)
    v_exp_f32 v151, v151
    v_mfma_f32_16x16x32_bf16 v[144:147], v[30:33], v[138:141], v[144:147]
    v_cvt_pk_bf16_f32 v181, v150, v151
    v_fma_f32 v153, v153, s37, -v236
    v_mfma_f32_16x16x32_bf16 v[212:215], a[248:251], a[252:255], v[212:215]
    ds_read_b128 a[252:255], v239 offset:15360
    ds_read_b128 a[248:251], v242 offset:37376
    v_mfma_f32_16x16x32_bf16 v[200:203], a[236:239], v[252:255], v[200:203]
    ds_read_b128 v[148:151], v250
    v_bfe_u32 v250, s67, v233, 4
    v_mfma_f32_16x16x16_bf16 v[144:147], v[34:35], v[142:143], v[144:147]
    s_waitcnt lgkmcnt(4)
    v_mad_u32_u24 v250, v250, s40, v231
    v_fma_f32 v154, v154, s37, -v236
    v_mfma_f32_16x16x32_bf16 v[220:223], a[240:243], v[252:255], v[220:223]
    s_waitcnt lgkmcnt(2)
    ds_read_b128 v[252:255], v240 offset:16384
    v_fma_f32 v155, v155, s37, -v236
    v_exp_f32 v152, v152
    v_exp_f32 v153, v153
    v_exp_f32 v154, v154
    v_exp_f32 v155, v155
    v_cvt_pk_bf16_f32 v182, v152, v153
    v_cvt_pk_bf16_f32 v183, v154, v155
    ds_read_b128 v[152:155], v234
    v_mfma_f32_16x16x32_bf16 v[208:211], a[236:239], a[252:255], v[208:211]
    ds_read_b128 a[236:239], v241 offset:49152
    v_bfe_u32 v234, s72, v233, 4
    v_mfma_f32_16x16x32_bf16 v[196:199], a[216:219], v[180:183], v[196:199]
    v_mad_u32_u24 v234, v234, s40, v231
    v_fma_f32 v156, v156, s37, -v236
    v_mfma_f32_16x16x32_bf16 v[184:187], v[66:69], v[180:183], v[184:187]
    v_fma_f32 v157, v157, s37, -v236
    v_fma_f32 v158, v158, s37, -v236
    v_mfma_f32_16x16x32_bf16 v[188:191], v[88:91], v[180:183], v[188:191]
    v_fma_f32 v159, v159, s37, -v236
    v_fma_f32 v160, v160, s37, -v236
    v_mfma_f32_16x16x32_bf16 v[192:195], v[110:113], v[180:183], v[192:195]
    s_waitcnt lgkmcnt(3)
    v_exp_f32 v156, v156
    v_mfma_f32_16x16x32_bf16 v[148:151], v[54:57], v[138:141], v[148:151]
    v_exp_f32 v157, v157
    v_mfma_f32_16x16x32_bf16 v[204:207], a[240:243], a[252:255], v[204:207]
    s_waitcnt lgkmcnt(1)
    ds_read_b128 a[240:243], v241 offset:49664
    v_cvt_pk_bf16_f32 v176, v156, v157
    v_mfma_f32_16x16x32_bf16 v[152:155], v[60:63], v[138:141], v[152:155]
    v_exp_f32 v158, v158
    v_mfma_f32_16x16x16_bf16 v[148:151], v[58:59], v[142:143], v[148:151]
    v_exp_f32 v159, v159
    v_mfma_f32_16x16x32_bf16 v[216:219], a[244:247], a[252:255], v[216:219]
    ds_read_b128 a[244:247], v242 offset:49152
    v_cvt_pk_bf16_f32 v177, v158, v159
    v_mfma_f32_16x16x16_bf16 v[152:155], v[64:65], v[142:143], v[152:155]
    ds_read_b128 v[156:159], v229 offset:640
    v_fma_f32 v161, v161, s37, -v236
    v_mfma_f32_16x16x32_bf16 v[212:215], a[248:251], a[252:255], v[212:215]
    s_waitcnt lgkmcnt(3)
    ds_read_b128 a[252:255], v239 offset:16384
    v_fma_f32 v162, v162, s37, -v236
    v_mfma_f32_16x16x32_bf16 v[200:203], a[236:239], v[252:255], v[200:203]
    s_waitcnt lgkmcnt(3)
    ds_read_b128 a[248:251], v242 offset:49664
    v_fma_f32 v163, v163, s37, -v236
    v_mfma_f32_16x16x32_bf16 v[220:223], a[240:243], v[252:255], v[220:223]
    ds_read_b128 v[252:255], v240 offset:17408
    v_exp_f32 v160, v160
    v_exp_f32 v161, v161
    v_exp_f32 v162, v162
    v_exp_f32 v163, v163
    v_cvt_pk_bf16_f32 v178, v160, v161
    v_cvt_pk_bf16_f32 v179, v162, v163
    ds_read_b128 v[160:163], v228 offset:640
    v_max3_f32 v248, v164, v165, v166
    v_mfma_f32_16x16x32_bf16 v[196:199], a[216:219], v[176:179], v[196:199]
    v_max3_f32 v249, v167, v168, v169
    v_max3_f32 v248, v248, v170, v171
    v_mfma_f32_16x16x32_bf16 v[184:187], v[70:73], v[176:179], v[184:187]
    v_max3_f32 v249, v249, v172, v173
    v_max3_f32 v248, v248, v174, v175
    v_mfma_f32_16x16x32_bf16 v[188:191], v[92:95], v[176:179], v[188:191]
    v_max3_f32 v249, v249, v144, v145
    v_max3_f32 v248, v248, v146, v147
    v_mfma_f32_16x16x32_bf16 v[192:195], v[114:117], v[176:179], v[192:195]
    s_waitcnt lgkmcnt(3)
    v_rcp_f32 v197, v196
    v_mfma_f32_16x16x32_bf16 v[156:159], v[42:45], v[132:135], v[156:159]
    v_mul_f32 v184, v184, v197
    v_mul_f32 v185, v185, v197
    v_mfma_f32_16x16x32_bf16 v[208:211], a[236:239], a[252:255], v[208:211]
    ds_read_b128 a[236:239], v241 offset:61440
    v_cvt_pk_bf16_f32 v184, v184, v185
    v_mfma_f32_16x16x32_bf16 v[204:207], a[240:243], a[252:255], v[204:207]
    ds_read_b128 a[240:243], v241 offset:61952
    v_mul_f32 v186, v186, v197
    v_mfma_f32_16x16x16_bf16 v[156:159], v[46:47], v[136:137], v[156:159]
    s_waitcnt lgkmcnt(2)
    v_mul_f32 v187, v187, v197
    v_cvt_pk_bf16_f32 v185, v186, v187
    v_mfma_f32_16x16x32_bf16 v[160:163], v[18:21], v[132:135], v[160:163]
    v_mul_f32 v188, v188, v197
    v_mul_f32 v189, v189, v197
    v_mfma_f32_16x16x32_bf16 v[216:219], a[244:247], a[252:255], v[216:219]
    ds_read_b128 a[244:247], v242 offset:61440
    v_cvt_pk_bf16_f32 v186, v188, v189
    v_mfma_f32_16x16x32_bf16 v[212:215], a[248:251], a[252:255], v[212:215]
    ds_read_b128 a[252:255], v239 offset:17408
    ds_read_b128 a[248:251], v242 offset:61952
    v_mfma_f32_16x16x16_bf16 v[160:163], v[22:23], v[136:137], v[160:163]
    s_waitcnt lgkmcnt(4)
    v_mul_f32 v190, v190, v197
    v_mul_f32 v191, v191, v197
    v_mfma_f32_16x16x32_bf16 v[200:203], a[236:239], v[252:255], v[200:203]
    s_waitcnt lgkmcnt(3)
    v_cvt_pk_bf16_f32 v187, v190, v191
    v_mul_f32 v192, v192, v197
    v_mfma_f32_16x16x32_bf16 v[220:223], a[240:243], v[252:255], v[220:223]
    s_waitcnt lgkmcnt(1)
    ds_read_b128 v[252:255], v224 offset:31040
    v_mul_f32 v193, v193, v197
    v_cvt_pk_bf16_f32 v188, v192, v193
    v_mul_f32 v194, v194, v197
    v_mul_f32 v195, v195, v197
    v_cvt_pk_bf16_f32 v200, v200, v201
    v_cvt_pk_bf16_f32 v201, v202, v203
    v_cvt_pk_bf16_f32 v189, v194, v195
    v_cvt_pk_bf16_f32 v202, v220, v221
    v_cvt_pk_bf16_f32 v203, v222, v223
    buffer_store_dwordx4 v[200:203], v245, s[20:23], s51 offen sc0 sc1
    v_mfma_f32_16x16x32_bf16 v[208:211], a[236:239], a[252:255], v[208:211]
    ds_read_b128 a[236:239], v224 offset:31104
    v_max3_f32 v249, v249, v148, v149
    v_mfma_f32_16x16x32_bf16 v[204:207], a[240:243], a[252:255], v[204:207]
    ds_read_b128 a[240:243], v224 offset:31168
    v_max3_f32 v248, v248, v150, v151
    v_mfma_f32_16x16x32_bf16 v[216:219], a[244:247], a[252:255], v[216:219]
    s_waitcnt lgkmcnt(3)
    ds_read_b128 a[244:247], v224 offset:31232
    v_max3_f32 v249, v249, v152, v153
    v_mfma_f32_16x16x32_bf16 v[212:215], a[248:251], a[252:255], v[212:215]
    ds_read_b128 a[252:255], v224 offset:30976
    ds_read_b128 a[248:251], v224 offset:31296
    v_cvt_pk_bf16_f32 v208, v208, v209
    v_cvt_pk_bf16_f32 v209, v210, v211
    v_cvt_pk_bf16_f32 v210, v204, v205
    v_cvt_pk_bf16_f32 v211, v206, v207
    v_cvt_pk_bf16_f32 v216, v216, v217
    v_cvt_pk_bf16_f32 v217, v218, v219
    v_cvt_pk_bf16_f32 v218, v212, v213
    v_cvt_pk_bf16_f32 v219, v214, v215
    ds_write_b128 v237, v[184:187]
    ds_write_b64 v238, v[188:189]
    v_max3_f32 v248, v248, v154, v155
    v_max_f32 v248, v248, v249
    v_mov_b32 v249, v248
    s_nop 1
    v_permlane16_swap_b32 v248, v249
    s_waitcnt lgkmcnt(3)
    v_mfma_f32_16x16x32_bf16 v[204:207], a[4:7], a[252:255], 0
    buffer_store_dwordx4 v[208:211], v243, s[20:23], s51 offen sc0 sc1
    v_mfma_f32_16x16x32_bf16 v[204:207], a[16:19], v[252:255], v[204:207]
    v_max_f32 v248, v248, v249
    v_mov_b32 v249, v248
    v_mfma_f32_16x16x32_bf16 v[208:211], a[0:3], a[252:255], 0
    v_mfma_f32_16x16x32_bf16 v[208:211], a[12:15], v[252:255], v[208:211]
    v_permlane32_swap_b32 v248, v249
    v_mfma_f32_16x16x32_bf16 v[200:203], a[8:11], a[252:255], 0
    v_max_f32 v248, v248, v249
    v_mul_f32 v236, s37, v248
    v_mfma_f32_16x16x32_bf16 v[200:203], a[20:23], v[252:255], v[200:203]
    v_fma_f32 v164, v164, s37, -v236
    v_fma_f32 v165, v165, s37, -v236
    v_mfma_f32_16x16x32_bf16 v[220:223], a[252:255], a[72:75], 0
    v_fma_f32 v166, v166, s37, -v236
    v_fma_f32 v167, v167, s37, -v236
    v_mfma_f32_16x16x32_bf16 v[220:223], v[252:255], a[84:87], v[220:223]
    v_exp_f32 v164, v164
    v_mfma_f32_16x16x32_bf16 v[212:215], a[252:255], a[80:83], 0
    v_exp_f32 v165, v165
    v_mfma_f32_16x16x32_bf16 v[212:215], v[252:255], a[92:95], v[212:215]
    v_exp_f32 v166, v166
    v_mfma_f32_16x16x32_bf16 v[208:211], a[24:27], a[236:239], v[208:211]
    v_exp_f32 v167, v167
    v_mfma_f32_16x16x32_bf16 v[208:211], a[36:39], a[240:243], v[208:211]
    v_cvt_pk_bf16_f32 v180, v164, v165
    v_cvt_pk_bf16_f32 v181, v166, v167
    v_mfma_f32_16x16x32_bf16 v[204:207], a[28:31], a[236:239], v[204:207]
    buffer_store_dwordx4 v[216:219], v244, s[20:23], s51 offen sc0 sc1
    v_mfma_f32_16x16x32_bf16 v[204:207], a[40:43], a[240:243], v[204:207]
    s_add_u32 s51, s51, s48
    ds_read_b128 v[164:167], v228 offset:1280
    v_fma_f32 v168, v168, s37, -v236
    v_mfma_f32_16x16x32_bf16 v[216:219], a[252:255], a[76:79], 0
    ds_read_b128 a[252:255], v224 offset:34048
    v_fma_f32 v169, v169, s37, -v236
    v_mfma_f32_16x16x32_bf16 v[216:219], v[252:255], a[88:91], v[216:219]
    ds_read_b128 v[252:255], v224 offset:34112
    v_fma_f32 v170, v170, s37, -v236
    v_mfma_f32_16x16x32_bf16 v[200:203], a[32:35], a[236:239], v[200:203]
    v_fma_f32 v171, v171, s37, -v236
    v_fma_f32 v172, v172, s37, -v236
    v_mfma_f32_16x16x32_bf16 v[200:203], a[44:47], a[240:243], v[200:203]
    v_exp_f32 v168, v168
    v_mfma_f32_16x16x32_bf16 v[220:223], a[236:239], a[96:99], v[220:223]
    v_exp_f32 v169, v169
    v_mfma_f32_16x16x32_bf16 v[220:223], a[240:243], a[108:111], v[220:223]
    v_exp_f32 v170, v170
    v_mfma_f32_16x16x32_bf16 v[216:219], a[236:239], a[100:103], v[216:219]
    v_exp_f32 v171, v171
    v_mfma_f32_16x16x32_bf16 v[216:219], a[240:243], a[112:115], v[216:219]
    s_waitcnt lgkmcnt(2)
    v_cvt_pk_bf16_f32 v182, v168, v169
    v_cvt_pk_bf16_f32 v183, v170, v171
    v_mfma_f32_16x16x32_bf16 v[164:167], v[0:3], v[132:135], v[164:167]
    ds_read_b128 v[168:171], v229 offset:1280
    v_fma_f32 v173, v173, s37, -v236
    v_mfma_f32_16x16x32_bf16 v[196:199], a[216:219], v[180:183], 0
    v_fma_f32 v174, v174, s37, -v236
    v_fma_f32 v175, v175, s37, -v236
    v_mfma_f32_16x16x32_bf16 v[184:187], v[76:79], v[180:183], 0
    v_exp_f32 v172, v172
    v_mfma_f32_16x16x32_bf16 v[188:191], v[98:101], v[180:183], 0
    v_exp_f32 v173, v173
    v_mfma_f32_16x16x32_bf16 v[192:195], v[120:123], v[180:183], 0
    v_exp_f32 v174, v174
    v_mfma_f32_16x16x16_bf16 v[164:167], v[4:5], v[136:137], v[164:167]
    v_exp_f32 v175, v175
    v_mfma_f32_16x16x32_bf16 v[212:215], a[236:239], a[104:107], v[212:215]
    ds_read_b128 a[236:239], v224 offset:34176
    v_cvt_pk_bf16_f32 v176, v172, v173
    v_mfma_f32_16x16x32_bf16 v[212:215], a[240:243], a[116:119], v[212:215]
    s_waitcnt lgkmcnt(1)
    ds_read_b128 a[240:243], v224 offset:34240
    v_cvt_pk_bf16_f32 v177, v174, v175
    v_mfma_f32_16x16x32_bf16 v[168:171], v[24:27], v[132:135], v[168:171]
    ds_read_b128 v[172:175], v229 offset:1920
    v_fma_f32 v144, v144, s37, -v236
    v_mfma_f32_16x16x32_bf16 v[208:211], a[48:51], a[244:247], v[208:211]
    v_fma_f32 v145, v145, s37, -v236
    v_fma_f32 v146, v146, s37, -v236
    v_mfma_f32_16x16x32_bf16 v[208:211], a[60:63], a[248:251], v[208:211]
    v_fma_f32 v147, v147, s37, -v236
    v_fma_f32 v148, v148, s37, -v236
    v_mfma_f32_16x16x16_bf16 v[168:171], v[28:29], v[136:137], v[168:171]
    v_exp_f32 v144, v144
    v_mfma_f32_16x16x32_bf16 v[204:207], a[52:55], a[244:247], v[204:207]
    v_exp_f32 v145, v145
    v_mfma_f32_16x16x32_bf16 v[204:207], a[64:67], a[248:251], v[204:207]
    v_exp_f32 v146, v146
    v_mfma_f32_16x16x32_bf16 v[200:203], a[56:59], a[244:247], v[200:203]
    v_cvt_pk_bf16_f32 v12, v208, v209
    v_cvt_pk_bf16_f32 v13, v210, v211
    v_mfma_f32_16x16x32_bf16 v[200:203], a[68:71], a[248:251], v[200:203]
    s_waitcnt lgkmcnt(0)
    v_exp_f32 v147, v147
    v_mfma_f32_16x16x32_bf16 v[172:175], v[30:33], v[132:135], v[172:175]
    v_cvt_pk_bf16_f32 v178, v144, v145
    v_cvt_pk_bf16_f32 v14, v204, v205
    v_mfma_f32_16x16x32_bf16 v[220:223], a[244:247], a[120:123], v[220:223]
    v_cvt_pk_bf16_f32 v15, v206, v207
    v_cvt_pk_bf16_f32 v179, v146, v147
    v_mfma_f32_16x16x32_bf16 v[220:223], a[248:251], a[132:135], v[220:223]
    v_cvt_pk_bf16_f32 v16, v200, v201
    v_cvt_pk_bf16_f32 v17, v202, v203
    v_mfma_f32_16x16x32_bf16 v[196:199], a[216:219], v[176:179], v[196:199]
    ds_read_b128 v[144:147], v228 offset:1920
    v_fma_f32 v149, v149, s37, -v236
    v_mfma_f32_16x16x32_bf16 v[184:187], v[68:71], v[176:179], v[184:187]
    v_fma_f32 v150, v150, s37, -v236
    v_fma_f32 v151, v151, s37, -v236
    v_mfma_f32_16x16x32_bf16 v[188:191], v[90:93], v[176:179], v[188:191]
    v_cvt_pk_bf16_f32 v74, v220, v221
    v_cvt_pk_bf16_f32 v75, v222, v223
    v_mfma_f32_16x16x32_bf16 v[192:195], v[112:115], v[176:179], v[192:195]
    v_exp_f32 v148, v148
    v_mfma_f32_16x16x16_bf16 v[172:175], v[34:35], v[136:137], v[172:175]
    v_exp_f32 v149, v149
    v_mfma_f32_16x16x32_bf16 v[216:219], a[244:247], a[124:127], v[216:219]
    v_exp_f32 v150, v150
    v_mfma_f32_16x16x32_bf16 v[216:219], a[248:251], a[136:139], v[216:219]
    v_exp_f32 v151, v151
    v_mfma_f32_16x16x32_bf16 v[212:215], a[244:247], a[128:131], v[212:215]
    ds_read_b128 a[244:247], v224 offset:34304
    v_cvt_pk_bf16_f32 v180, v148, v149
    v_mfma_f32_16x16x32_bf16 v[212:215], a[248:251], a[140:143], v[212:215]
    s_waitcnt lgkmcnt(1)
    ds_read_b128 a[248:251], v224 offset:34368
    v_cvt_pk_bf16_f32 v181, v150, v151
    v_mfma_f32_16x16x32_bf16 v[144:147], v[6:9], v[132:135], v[144:147]
    v_cvt_pk_bf16_f32 v96, v216, v217
    v_cvt_pk_bf16_f32 v97, v218, v219
    v_mfma_f32_16x16x32_bf16 v[208:211], a[0:3], a[252:255], 0
    ds_read_b128 v[148:151], v228 offset:2560
    v_fma_f32 v152, v152, s37, -v236
    v_mfma_f32_16x16x32_bf16 v[208:211], a[12:15], v[252:255], v[208:211]
    v_cvt_pk_bf16_f32 v118, v212, v213
    v_cvt_pk_bf16_f32 v119, v214, v215
    v_mfma_f32_16x16x16_bf16 v[144:147], v[10:11], v[136:137], v[144:147]
    v_fma_f32 v153, v153, s37, -v236
    v_fma_f32 v154, v154, s37, -v236
    v_mfma_f32_16x16x32_bf16 v[204:207], a[4:7], a[252:255], 0
    v_fma_f32 v155, v155, s37, -v236
    v_max3_f32 v248, v156, v157, v158
    v_mfma_f32_16x16x32_bf16 v[204:207], a[16:19], v[252:255], v[204:207]
    v_exp_f32 v152, v152
    v_mfma_f32_16x16x32_bf16 v[200:203], a[8:11], a[252:255], 0
    v_exp_f32 v153, v153
    v_mfma_f32_16x16x32_bf16 v[200:203], a[20:23], v[252:255], v[200:203]
    v_exp_f32 v154, v154
    v_mfma_f32_16x16x32_bf16 v[220:223], a[252:255], a[72:75], 0
    v_exp_f32 v155, v155
    v_mfma_f32_16x16x32_bf16 v[220:223], v[252:255], a[84:87], v[220:223]
    s_waitcnt lgkmcnt(0)
    v_cvt_pk_bf16_f32 v182, v152, v153
    v_cvt_pk_bf16_f32 v183, v154, v155
    v_mfma_f32_16x16x32_bf16 v[148:151], v[12:15], v[132:135], v[148:151]
    ds_read_b128 v[152:155], v229 offset:2560
    v_max3_f32 v249, v159, v160, v161
    v_mfma_f32_16x16x32_bf16 v[196:199], a[216:219], v[180:183], v[196:199]
    v_max3_f32 v248, v248, v162, v163
    v_max3_f32 v249, v249, v164, v165
    v_mfma_f32_16x16x32_bf16 v[184:187], v[84:87], v[180:183], v[184:187]
    v_max3_f32 v248, v248, v166, v167
    v_max3_f32 v249, v249, v168, v169
    v_mfma_f32_16x16x32_bf16 v[188:191], v[106:109], v[180:183], v[188:191]
    v_max3_f32 v248, v248, v170, v171
    v_max3_f32 v249, v249, v172, v173
    v_mfma_f32_16x16x32_bf16 v[192:195], v[128:131], v[180:183], v[192:195]
    v_rcp_f32 v197, v196
    v_mfma_f32_16x16x16_bf16 v[148:151], v[16:17], v[136:137], v[148:151]
    v_mul_f32 v184, v184, v197
    v_mul_f32 v185, v185, v197
    v_mfma_f32_16x16x32_bf16 v[216:219], a[252:255], a[76:79], 0
    v_cvt_pk_bf16_f32 v184, v184, v185
    v_mul_f32 v186, v186, v197
    v_mfma_f32_16x16x32_bf16 v[216:219], v[252:255], a[88:91], v[216:219]
    v_mul_f32 v187, v187, v197
    v_cvt_pk_bf16_f32 v185, v186, v187
    v_mfma_f32_16x16x32_bf16 v[212:215], a[252:255], a[80:83], 0
    ds_read_b128 a[252:255], v225 offset:11968
    v_mul_f32 v188, v188, v197
    v_mfma_f32_16x16x32_bf16 v[212:215], v[252:255], a[92:95], v[212:215]
    ds_read_b128 v[252:255], v225 offset:12032
    v_mul_f32 v189, v189, v197
    v_mfma_f32_16x16x32_bf16 v[208:211], a[24:27], a[236:239], v[208:211]
    v_cvt_pk_bf16_f32 v186, v188, v189
    v_mul_f32 v190, v190, v197
    v_mfma_f32_16x16x32_bf16 v[208:211], a[36:39], a[240:243], v[208:211]
    v_mul_f32 v191, v191, v197
    v_cvt_pk_bf16_f32 v187, v190, v191
    v_mfma_f32_16x16x32_bf16 v[204:207], a[28:31], a[236:239], v[204:207]
    v_mul_f32 v192, v192, v197
    v_mul_f32 v193, v193, v197
    v_mfma_f32_16x16x32_bf16 v[204:207], a[40:43], a[240:243], v[204:207]
    v_cvt_pk_bf16_f32 v188, v192, v193
    v_mul_f32 v194, v194, v197
    v_mfma_f32_16x16x32_bf16 v[200:203], a[32:35], a[236:239], v[200:203]
    v_mul_f32 v195, v195, v197
    v_cvt_pk_bf16_f32 v189, v194, v195
    v_mfma_f32_16x16x32_bf16 v[200:203], a[44:47], a[240:243], v[200:203]
    ds_write_b128 v237, v[184:187] offset:6144
    v_mfma_f32_16x16x32_bf16 v[220:223], a[236:239], a[96:99], v[220:223]
    ds_write_b64 v238, v[188:189] offset:6144
    v_mfma_f32_16x16x32_bf16 v[220:223], a[240:243], a[108:111], v[220:223]
    v_max3_f32 v248, v248, v174, v175
    v_max3_f32 v249, v249, v144, v145
    v_mfma_f32_16x16x32_bf16 v[216:219], a[236:239], a[100:103], v[216:219]
    v_max3_f32 v248, v248, v146, v147
    v_max3_f32 v249, v249, v148, v149
    v_mfma_f32_16x16x32_bf16 v[216:219], a[240:243], a[112:115], v[216:219]
    v_max3_f32 v248, v248, v150, v151
    v_mfma_f32_16x16x32_bf16 v[212:215], a[236:239], a[104:107], v[212:215]
    ds_read_b128 a[236:239], v225 offset:12096
    v_mfma_f32_16x16x32_bf16 v[212:215], a[240:243], a[116:119], v[212:215]
    ds_read_b128 a[240:243], v225 offset:12160
    v_mfma_f32_16x16x32_bf16 v[208:211], a[48:51], a[244:247], v[208:211]
    v_mfma_f32_16x16x32_bf16 v[208:211], a[60:63], a[248:251], v[208:211]
    v_mfma_f32_16x16x32_bf16 v[204:207], a[52:55], a[244:247], v[204:207]
    v_mfma_f32_16x16x32_bf16 v[204:207], a[64:67], a[248:251], v[204:207]
    v_mfma_f32_16x16x32_bf16 v[200:203], a[56:59], a[244:247], v[200:203]
    v_mfma_f32_16x16x32_bf16 v[200:203], a[68:71], a[248:251], v[200:203]
    v_mfma_f32_16x16x32_bf16 v[220:223], a[244:247], a[120:123], v[220:223]
    v_mfma_f32_16x16x32_bf16 v[220:223], a[248:251], a[132:135], v[220:223]
    v_mfma_f32_16x16x32_bf16 v[216:219], a[244:247], a[124:127], v[216:219]
    v_mfma_f32_16x16x32_bf16 v[216:219], a[248:251], a[136:139], v[216:219]
    v_cvt_pk_bf16_f32 v36, v208, v209
    v_cvt_pk_bf16_f32 v37, v210, v211
    v_mfma_f32_16x16x32_bf16 v[212:215], a[244:247], a[128:131], v[212:215]
    v_cvt_pk_bf16_f32 v38, v204, v205
    v_cvt_pk_bf16_f32 v39, v206, v207
    v_mfma_f32_16x16x32_bf16 v[212:215], a[248:251], a[140:143], v[212:215]
    s_waitcnt lgkmcnt(0)
    v_cvt_pk_bf16_f32 v40, v200, v201
    v_cvt_pk_bf16_f32 v41, v202, v203
    v_mfma_f32_16x16x32_bf16 v[152:155], v[36:39], v[132:135], v[152:155]
    v_cvt_pk_bf16_f32 v76, v220, v221
    v_cvt_pk_bf16_f32 v77, v222, v223
    v_mfma_f32_16x16x32_bf16 v[208:211], a[144:147], a[252:255], 0
    v_cvt_pk_bf16_f32 v98, v216, v217
    v_cvt_pk_bf16_f32 v99, v218, v219
    v_mfma_f32_16x16x32_bf16 v[208:211], a[156:159], v[252:255], v[208:211]
    v_cvt_pk_bf16_f32 v120, v212, v213
    v_cvt_pk_bf16_f32 v121, v214, v215
    v_mfma_f32_16x16x16_bf16 v[152:155], v[40:41], v[136:137], v[152:155]
    ds_read_b128 a[244:247], v225 offset:12224
    ds_read_b128 a[248:251], v225 offset:12288
    v_mfma_f32_16x16x32_bf16 v[204:207], a[148:151], a[252:255], 0
    v_mfma_f32_16x16x32_bf16 v[204:207], a[160:163], v[252:255], v[204:207]
    v_mfma_f32_16x16x32_bf16 v[200:203], a[152:155], a[252:255], 0
    ds_read_b128 a[252:255], v225 offset:24384
    v_mfma_f32_16x16x32_bf16 v[200:203], a[164:167], v[252:255], v[200:203]
    ds_read_b128 v[252:255], v225 offset:24448
    v_max3_f32 v249, v249, v152, v153
    v_mfma_f32_16x16x32_bf16 v[208:211], a[168:171], a[236:239], v[208:211]
    v_max3_f32 v248, v248, v154, v155
    v_max_f32 v248, v248, v249
    v_mfma_f32_16x16x32_bf16 v[208:211], a[180:183], a[240:243], v[208:211]
    v_mov_b32 v249, v248
    v_mfma_f32_16x16x32_bf16 v[204:207], a[172:175], a[236:239], v[204:207]
    s_waitcnt vmcnt(3) lgkmcnt(2)
    v_mfma_f32_16x16x32_bf16 v[204:207], a[184:187], a[240:243], v[204:207]
    s_barrier
    buffer_load_dwordx4 v246, s[4:7], s56 offen lds
    v_mfma_f32_16x16x32_bf16 v[200:203], a[176:179], a[236:239], v[200:203]
    ds_read_b128 a[236:239], v225 offset:24512
    v_mfma_f32_16x16x32_bf16 v[200:203], a[188:191], a[240:243], v[200:203]
    ds_read_b128 a[240:243], v225 offset:24576
    v_mfma_f32_16x16x32_bf16 v[208:211], a[192:195], a[244:247], v[208:211]
    v_permlane16_swap_b32 v248, v249
    v_mfma_f32_16x16x32_bf16 v[208:211], a[204:207], a[248:251], v[208:211]
    v_max_f32 v248, v248, v249
    v_mov_b32 v249, v248
    v_mfma_f32_16x16x32_bf16 v[204:207], a[196:199], a[244:247], v[204:207]
    v_mfma_f32_16x16x32_bf16 v[204:207], a[208:211], a[248:251], v[204:207]
    v_permlane32_swap_b32 v248, v249
    v_mfma_f32_16x16x32_bf16 v[200:203], a[200:203], a[244:247], v[200:203]
    ds_read_b128 a[244:247], v225 offset:24640
    v_max_f32 v248, v248, v249
    v_mfma_f32_16x16x32_bf16 v[200:203], a[212:215], a[248:251], v[200:203]
    s_waitcnt lgkmcnt(3)
    v_cvt_pk_bf16_f32 v138, v208, v209
    v_cvt_pk_bf16_f32 v139, v210, v211
    v_mfma_f32_16x16x32_bf16 v[220:223], a[144:147], a[252:255], 0
    v_cvt_pk_bf16_f32 v140, v204, v205
    v_cvt_pk_bf16_f32 v141, v206, v207
    v_mfma_f32_16x16x32_bf16 v[220:223], a[156:159], v[252:255], v[220:223]
    ds_read_b128 a[248:251], v225 offset:24704
    v_mul_f32 v236, s37, v248
    v_mfma_f32_16x16x32_bf16 v[216:219], a[148:151], a[252:255], 0
    v_cvt_pk_bf16_f32 v142, v200, v201
    v_cvt_pk_bf16_f32 v143, v202, v203
    v_mfma_f32_16x16x32_bf16 v[216:219], a[160:163], v[252:255], v[216:219]
    buffer_load_dwordx4 v247, s[4:7], s56 offen offset:1024 lds
    v_mfma_f32_16x16x32_bf16 v[212:215], a[152:155], a[252:255], 0
    s_add_u32 s56, s56, s42
    ds_read_b128 a[252:255], v227 offset:37120
    v_fma_f32 v156, v156, s37, -v236
    v_mfma_f32_16x16x32_bf16 v[212:215], a[164:167], v[252:255], v[212:215]
    s_add_u32 m0, s41, 0x1e40
    ds_read_b128 v[252:255], v227 offset:37184
    v_fma_f32 v157, v157, s37, -v236
    s_waitcnt lgkmcnt(4)
    v_mfma_f32_16x16x32_bf16 v[220:223], a[168:171], a[236:239], v[220:223]
    v_fma_f32 v158, v158, s37, -v236
    v_fma_f32 v159, v159, s37, -v236
    v_mfma_f32_16x16x32_bf16 v[220:223], a[180:183], a[240:243], v[220:223]
    v_exp_f32 v156, v156
    v_mfma_f32_16x16x32_bf16 v[216:219], a[172:175], a[236:239], v[216:219]
    v_exp_f32 v157, v157
    v_mfma_f32_16x16x32_bf16 v[216:219], a[184:187], a[240:243], v[216:219]
    v_exp_f32 v158, v158
    v_mfma_f32_16x16x32_bf16 v[212:215], a[176:179], a[236:239], v[212:215]
    ds_read_b128 a[236:239], v227 offset:37248
    v_cvt_pk_bf16_f32 v176, v156, v157
    v_mfma_f32_16x16x32_bf16 v[212:215], a[188:191], a[240:243], v[212:215]
    s_waitcnt lgkmcnt(3)
    ds_read_b128 a[240:243], v227 offset:37312
    v_fma_f32 v160, v160, s37, -v236
    v_mfma_f32_16x16x32_bf16 v[220:223], a[192:195], a[244:247], v[220:223]
    buffer_load_dwordx4 v246, s[4:7], s56 offen lds
    v_mfma_f32_16x16x32_bf16 v[220:223], a[204:207], a[248:251], v[220:223]
    v_exp_f32 v159, v159
    v_mfma_f32_16x16x32_bf16 v[216:219], a[196:199], a[244:247], v[216:219]
    v_cvt_pk_bf16_f32 v177, v158, v159
    v_fma_f32 v161, v161, s37, -v236
    v_mfma_f32_16x16x32_bf16 v[216:219], a[208:211], a[248:251], v[216:219]
    ds_read_b128 v[156:159], v230 offset:2560
    v_fma_f32 v162, v162, s37, -v236
    v_mfma_f32_16x16x32_bf16 v[212:215], a[200:203], a[244:247], v[212:215]
    v_cvt_pk_bf16_f32 v132, v220, v221
    v_cvt_pk_bf16_f32 v133, v222, v223
    v_mfma_f32_16x16x32_bf16 v[212:215], a[212:215], a[248:251], v[212:215]
    s_waitcnt lgkmcnt(3)
    ds_read_b128 a[244:247], v227 offset:37376
    ds_read_b128 a[248:251], v227 offset:37440
    v_mfma_f32_16x16x32_bf16 v[208:211], a[0:3], a[252:255], 0
    v_cvt_pk_bf16_f32 v134, v216, v217
    v_cvt_pk_bf16_f32 v135, v218, v219
    v_mfma_f32_16x16x32_bf16 v[208:211], a[12:15], v[252:255], v[208:211]
    v_fma_f32 v163, v163, s37, -v236
    v_fma_f32 v164, v164, s37, -v236
    v_mfma_f32_16x16x32_bf16 v[204:207], a[4:7], a[252:255], 0
    v_cvt_pk_bf16_f32 v136, v212, v213
    v_cvt_pk_bf16_f32 v137, v214, v215
    v_mfma_f32_16x16x32_bf16 v[204:207], a[16:19], v[252:255], v[204:207]
    buffer_load_dwordx4 v247, s[4:7], s56 offen offset:1024 lds
    v_mfma_f32_16x16x32_bf16 v[200:203], a[8:11], a[252:255], 0
    s_add_u32 s56, s56, s42
    v_exp_f32 v160, v160
    v_mfma_f32_16x16x32_bf16 v[200:203], a[20:23], v[252:255], v[200:203]
    s_add_u32 m0, s41, 0x3c80
    v_exp_f32 v161, v161
    s_waitcnt lgkmcnt(2)
    v_mfma_f32_16x16x32_bf16 v[156:159], v[36:39], v[138:141], v[156:159]
    v_exp_f32 v162, v162
    v_mfma_f32_16x16x32_bf16 v[220:223], a[252:255], a[72:75], 0
    v_exp_f32 v163, v163
    v_mfma_f32_16x16x32_bf16 v[220:223], v[252:255], a[84:87], v[220:223]
    v_cvt_pk_bf16_f32 v178, v160, v161
    v_cvt_pk_bf16_f32 v179, v162, v163
    v_mfma_f32_16x16x16_bf16 v[156:159], v[40:41], v[142:143], v[156:159]
    ds_read_b128 v[160:163], v230 offset:640
    v_fma_f32 v165, v165, s37, -v236
    v_mfma_f32_16x16x32_bf16 v[196:199], a[216:219], v[176:179], 0
    v_fma_f32 v166, v166, s37, -v236
    v_fma_f32 v167, v167, s37, -v236
    v_mfma_f32_16x16x32_bf16 v[184:187], v[78:81], v[176:179], 0
    v_exp_f32 v164, v164
    v_mfma_f32_16x16x32_bf16 v[188:191], v[100:103], v[176:179], 0
    v_exp_f32 v165, v165
    v_mfma_f32_16x16x32_bf16 v[192:195], v[122:125], v[176:179], 0
    v_exp_f32 v166, v166
    v_mfma_f32_16x16x32_bf16 v[216:219], a[252:255], a[76:79], 0
    v_exp_f32 v167, v167
    v_mfma_f32_16x16x32_bf16 v[216:219], v[252:255], a[88:91], v[216:219]
    v_cvt_pk_bf16_f32 v180, v164, v165
    v_cvt_pk_bf16_f32 v181, v166, v167
    v_mfma_f32_16x16x32_bf16 v[212:215], a[252:255], a[80:83], 0
    ds_read_b128 a[252:255], v239
    ds_read_b128 v[164:167], v230 offset:1280
    v_mfma_f32_16x16x32_bf16 v[212:215], v[252:255], a[92:95], v[212:215]
    s_waitcnt lgkmcnt(2)
    v_fma_f32 v168, v168, s37, -v236
    v_fma_f32 v169, v169, s37, -v236
    v_mfma_f32_16x16x32_bf16 v[160:163], v[42:45], v[138:141], v[160:163]
    ds_read_b128 v[252:255], v240
    v_fma_f32 v170, v170, s37, -v236
    v_mfma_f32_16x16x32_bf16 v[208:211], a[24:27], a[236:239], v[208:211]
    v_fma_f32 v171, v171, s37, -v236
    v_fma_f32 v172, v172, s37, -v236
    v_mfma_f32_16x16x32_bf16 v[208:211], a[36:39], a[240:243], v[208:211]
    v_exp_f32 v168, v168
    v_mfma_f32_16x16x16_bf16 v[160:163], v[46:47], v[142:143], v[160:163]
    v_exp_f32 v169, v169
    v_mfma_f32_16x16x32_bf16 v[204:207], a[28:31], a[236:239], v[204:207]
    v_exp_f32 v170, v170
    v_mfma_f32_16x16x32_bf16 v[204:207], a[40:43], a[240:243], v[204:207]
    v_exp_f32 v171, v171
    v_mfma_f32_16x16x32_bf16 v[200:203], a[32:35], a[236:239], v[200:203]
    v_cvt_pk_bf16_f32 v182, v168, v169
    v_cvt_pk_bf16_f32 v183, v170, v171
    v_mfma_f32_16x16x32_bf16 v[200:203], a[44:47], a[240:243], v[200:203]
    ds_read_b128 v[168:171], v230 offset:1920
    v_fma_f32 v173, v173, s37, -v236
    v_mfma_f32_16x16x32_bf16 v[196:199], a[216:219], v[180:183], v[196:199]
    v_fma_f32 v174, v174, s37, -v236
    v_fma_f32 v175, v175, s37, -v236
    v_mfma_f32_16x16x32_bf16 v[184:187], v[66:69], v[180:183], v[184:187]
    v_exp_f32 v172, v172
    v_mfma_f32_16x16x32_bf16 v[188:191], v[88:91], v[180:183], v[188:191]
    v_exp_f32 v173, v173
    v_mfma_f32_16x16x32_bf16 v[192:195], v[110:113], v[180:183], v[192:195]
    s_waitcnt lgkmcnt(1)
    v_exp_f32 v174, v174
    v_mfma_f32_16x16x32_bf16 v[164:167], v[24:27], v[138:141], v[164:167]
    v_exp_f32 v175, v175
    v_mfma_f32_16x16x32_bf16 v[220:223], a[236:239], a[96:99], v[220:223]
    v_cvt_pk_bf16_f32 v176, v172, v173
    v_cvt_pk_bf16_f32 v177, v174, v175
    v_mfma_f32_16x16x32_bf16 v[220:223], a[240:243], a[108:111], v[220:223]
    ds_read_b128 v[172:175], v235
    v_bfe_u32 v235, s69, v233, 4
    v_mfma_f32_16x16x16_bf16 v[164:167], v[28:29], v[142:143], v[164:167]
    s_waitcnt lgkmcnt(1)
    v_mad_u32_u24 v235, v235, s40, v231
    v_fma_f32 v144, v144, s37, -v236
    v_mfma_f32_16x16x32_bf16 v[168:171], v[30:33], v[138:141], v[168:171]
    v_fma_f32 v145, v145, s37, -v236
    v_fma_f32 v146, v146, s37, -v236
    v_mfma_f32_16x16x32_bf16 v[216:219], a[236:239], a[100:103], v[216:219]
    v_fma_f32 v147, v147, s37, -v236
    v_fma_f32 v148, v148, s37, -v236
    v_mfma_f32_16x16x32_bf16 v[216:219], a[240:243], a[112:115], v[216:219]
    v_exp_f32 v144, v144
    v_mfma_f32_16x16x16_bf16 v[168:171], v[34:35], v[142:143], v[168:171]
    v_exp_f32 v145, v145
    v_mfma_f32_16x16x32_bf16 v[212:215], a[236:239], a[104:107], v[212:215]
    ds_read_b128 a[236:239], v239 offset:1024
    v_cvt_pk_bf16_f32 v178, v144, v145
    v_mfma_f32_16x16x32_bf16 v[212:215], a[240:243], a[116:119], v[212:215]
    s_waitcnt lgkmcnt(1)
    ds_read_b128 a[240:243], v240 offset:1024
    v_fma_f32 v149, v149, s37, -v236
    v_mfma_f32_16x16x32_bf16 v[172:175], v[54:57], v[138:141], v[172:175]
    v_exp_f32 v146, v146
    v_mfma_f32_16x16x32_bf16 v[208:211], a[48:51], a[244:247], v[208:211]
    v_exp_f32 v147, v147
    v_mfma_f32_16x16x32_bf16 v[208:211], a[60:63], a[248:251], v[208:211]
    v_cvt_pk_bf16_f32 v179, v146, v147
    v_fma_f32 v150, v150, s37, -v236
    v_mfma_f32_16x16x16_bf16 v[172:175], v[58:59], v[142:143], v[172:175]
    ds_read_b128 v[144:147], v250
    v_bfe_u32 v250, s70, v233, 4
    v_mfma_f32_16x16x32_bf16 v[196:199], a[216:219], v[176:179], v[196:199]
    v_mad_u32_u24 v250, v250, s40, v231
    v_fma_f32 v151, v151, s37, -v236
    v_mfma_f32_16x16x32_bf16 v[184:187], v[70:73], v[176:179], v[184:187]
    v_cvt_pk_bf16_f32 v48, v208, v209
    v_cvt_pk_bf16_f32 v49, v210, v211
    v_mfma_f32_16x16x32_bf16 v[188:191], v[92:95], v[176:179], v[188:191]
    v_exp_f32 v148, v148
    v_mfma_f32_16x16x32_bf16 v[192:195], v[114:117], v[176:179], v[192:195]
    v_exp_f32 v149, v149
    v_mfma_f32_16x16x32_bf16 v[204:207], a[52:55], a[244:247], v[204:207]
    v_exp_f32 v150, v150
    v_mfma_f32_16x16x32_bf16 v[204:207], a[64:67], a[248:251], v[204:207]
    v_exp_f32 v151, v151
    v_mfma_f32_16x16x32_bf16 v[200:203], a[56:59], a[244:247], v[200:203]
    v_cvt_pk_bf16_f32 v180, v148, v149
    v_cvt_pk_bf16_f32 v181, v150, v151
    v_mfma_f32_16x16x32_bf16 v[200:203], a[68:71], a[248:251], v[200:203]
    s_waitcnt lgkmcnt(0)
    ds_read_b128 v[148:151], v234
    v_bfe_u32 v234, s67, v233, 4
    v_mfma_f32_16x16x32_bf16 v[144:147], v[60:63], v[138:141], v[144:147]
    v_cvt_pk_bf16_f32 v50, v204, v205
    v_cvt_pk_bf16_f32 v51, v206, v207
    v_mfma_f32_16x16x32_bf16 v[220:223], a[244:247], a[120:123], v[220:223]
    v_mad_u32_u24 v234, v234, s40, v231
    v_fma_f32 v152, v152, s37, -v236
    v_mfma_f32_16x16x32_bf16 v[220:223], a[248:251], a[132:135], v[220:223]
    v_cvt_pk_bf16_f32 v52, v200, v201
    v_cvt_pk_bf16_f32 v53, v202, v203
    v_mfma_f32_16x16x16_bf16 v[144:147], v[64:65], v[142:143], v[144:147]
    v_fma_f32 v153, v153, s37, -v236
    v_fma_f32 v154, v154, s37, -v236
    v_mfma_f32_16x16x32_bf16 v[216:219], a[244:247], a[124:127], v[216:219]
    v_fma_f32 v155, v155, s37, -v236
    v_max3_f32 v248, v156, v157, v158
    v_mfma_f32_16x16x32_bf16 v[216:219], a[248:251], a[136:139], v[216:219]
    v_cvt_pk_bf16_f32 v82, v220, v221
    v_cvt_pk_bf16_f32 v83, v222, v223
    v_mfma_f32_16x16x32_bf16 v[212:215], a[244:247], a[128:131], v[212:215]
    ds_read_b128 a[244:247], v241 offset:12288
    v_max3_f32 v249, v159, v160, v161
    v_mfma_f32_16x16x32_bf16 v[212:215], a[248:251], a[140:143], v[212:215]
    s_waitcnt lgkmcnt(1)
    ds_read_b128 a[248:251], v241 offset:12800
    v_max3_f32 v248, v248, v162, v163
    v_mfma_f32_16x16x32_bf16 v[148:151], v[48:51], v[138:141], v[148:151]
    v_cvt_pk_bf16_f32 v104, v216, v217
    v_cvt_pk_bf16_f32 v105, v218, v219
    v_mfma_f32_16x16x32_bf16 v[208:211], a[220:223], a[252:255], 0
    v_exp_f32 v152, v152
    v_mfma_f32_16x16x32_bf16 v[200:203], a[220:223], v[252:255], 0
    v_cvt_pk_bf16_f32 v126, v212, v213
    v_cvt_pk_bf16_f32 v127, v214, v215
    v_mfma_f32_16x16x16_bf16 v[148:151], v[52:53], v[142:143], v[148:151]
    v_exp_f32 v153, v153
    v_mfma_f32_16x16x32_bf16 v[204:207], a[224:227], a[252:255], 0
    v_exp_f32 v154, v154
    v_mfma_f32_16x16x32_bf16 v[220:223], a[224:227], v[252:255], 0
    ds_read_b128 v[252:255], v242 offset:12800
    v_cvt_pk_bf16_f32 v182, v152, v153
    v_mfma_f32_16x16x32_bf16 v[216:219], a[228:231], a[252:255], 0
    v_exp_f32 v155, v155
    v_mfma_f32_16x16x32_bf16 v[212:215], a[232:235], a[252:255], 0
    s_waitcnt lgkmcnt(1)
    ds_read_b128 a[252:255], v242 offset:12288
    v_cvt_pk_bf16_f32 v183, v154, v155
    v_mfma_f32_16x16x32_bf16 v[208:211], a[244:247], a[236:239], v[208:211]
    ds_read_b128 v[152:155], v228 offset:640
    v_max3_f32 v249, v249, v164, v165
    v_mfma_f32_16x16x32_bf16 v[196:199], a[216:219], v[180:183], v[196:199]
    v_max3_f32 v248, v248, v166, v167
    v_max3_f32 v249, v249, v168, v169
    v_mfma_f32_16x16x32_bf16 v[184:187], v[74:77], v[180:183], v[184:187]
    v_max3_f32 v248, v248, v170, v171
    v_max3_f32 v249, v249, v172, v173
    v_mfma_f32_16x16x32_bf16 v[188:191], v[96:99], v[180:183], v[188:191]
    v_max3_f32 v248, v248, v174, v175
    v_max3_f32 v249, v249, v144, v145
    v_mfma_f32_16x16x32_bf16 v[192:195], v[118:121], v[180:183], v[192:195]
    v_rcp_f32 v197, v196
    v_mfma_f32_16x16x32_bf16 v[200:203], a[244:247], a[240:243], v[200:203]
    ds_read_b128 a[244:247], v241 offset:24576
    v_mul_f32 v184, v184, v197
    v_mfma_f32_16x16x32_bf16 v[204:207], a[248:251], a[236:239], v[204:207]
    v_mul_f32 v185, v185, v197
    v_cvt_pk_bf16_f32 v184, v184, v185
    v_mfma_f32_16x16x32_bf16 v[220:223], a[248:251], a[240:243], v[220:223]
    s_waitcnt lgkmcnt(1)
    ds_read_b128 a[240:243], v240 offset:2048
    ds_read_b128 a[248:251], v241 offset:25088
    v_mfma_f32_16x16x32_bf16 v[152:155], v[0:3], v[132:135], v[152:155]
    v_mul_f32 v186, v186, v197
    v_mul_f32 v187, v187, v197
    v_mfma_f32_16x16x32_bf16 v[216:219], a[252:255], a[236:239], v[216:219]
    ds_read_b128 a[252:255], v242 offset:24576
    v_cvt_pk_bf16_f32 v185, v186, v187
    v_mfma_f32_16x16x32_bf16 v[212:215], v[252:255], a[236:239], v[212:215]
    ds_read_b128 a[236:239], v239 offset:2048
    ds_read_b128 v[252:255], v242 offset:25088
    v_mfma_f32_16x16x16_bf16 v[152:155], v[4:5], v[136:137], v[152:155]
    s_waitcnt lgkmcnt(4)
    v_mul_f32 v188, v188, v197
    v_mul_f32 v189, v189, v197
    v_cvt_pk_bf16_f32 v186, v188, v189
    v_mul_f32 v190, v190, v197
    v_mul_f32 v191, v191, v197
    v_cvt_pk_bf16_f32 v187, v190, v191
    v_mul_f32 v192, v192, v197
    v_mul_f32 v193, v193, v197
    v_cvt_pk_bf16_f32 v188, v192, v193
    v_mul_f32 v194, v194, v197
    v_mfma_f32_16x16x32_bf16 v[200:203], a[244:247], a[240:243], v[200:203]
    s_waitcnt lgkmcnt(3)
    v_mul_f32 v195, v195, v197
    v_cvt_pk_bf16_f32 v189, v194, v195
    v_mfma_f32_16x16x32_bf16 v[220:223], a[248:251], a[240:243], v[220:223]
    s_waitcnt lgkmcnt(1)
    ds_read_b128 a[240:243], v240 offset:3072
    ds_write_b128 v237, v[184:187] offset:12288
    v_mfma_f32_16x16x32_bf16 v[208:211], a[244:247], a[236:239], v[208:211]
    ds_write_b64 v238, v[188:189] offset:12288
    v_mfma_f32_16x16x32_bf16 v[204:207], a[248:251], a[236:239], v[204:207]
    v_max3_f32 v248, v248, v146, v147
    v_max3_f32 v249, v249, v148, v149
    v_mfma_f32_16x16x32_bf16 v[216:219], a[252:255], a[236:239], v[216:219]
    s_waitcnt lgkmcnt(3)
    v_max3_f32 v248, v248, v150, v151
    v_max_f32 v248, v248, v249
    v_mfma_f32_16x16x32_bf16 v[212:215], v[252:255], a[236:239], v[212:215]
    v_mov_b32 v249, v248
    s_nop 1
    ds_read_b128 a[236:239], v239 offset:3072
    ds_read_b128 a[244:247], v241 offset:36864
    v_permlane16_swap_b32 v248, v249
    ds_read_b128 a[248:251], v241 offset:37376
    v_max_f32 v248, v248, v249
    ds_read_b128 a[252:255], v242 offset:36864
    v_mov_b32 v249, v248
    ds_read_b128 v[252:255], v242 offset:37376
    s_nop 0
    v_permlane32_swap_b32 v248, v249
    v_max_f32 v248, v248, v249
    v_mul_f32 v236, s37, v248
    v_fma_f32 v156, v156, s37, -v236
    v_fma_f32 v157, v157, s37, -v236
    v_fma_f32 v158, v158, s37, -v236
    v_fma_f32 v159, v159, s37, -v236
    v_exp_f32 v156, v156
    v_exp_f32 v157, v157
    v_exp_f32 v158, v158
    s_waitcnt lgkmcnt(3)
    v_mfma_f32_16x16x32_bf16 v[208:211], a[244:247], a[236:239], v[208:211]
    v_exp_f32 v159, v159
    v_mfma_f32_16x16x32_bf16 v[200:203], a[244:247], a[240:243], v[200:203]
    s_waitcnt lgkmcnt(2)
    ds_read_b128 a[244:247], v241 offset:49152
    v_cvt_pk_bf16_f32 v176, v156, v157
    v_mfma_f32_16x16x32_bf16 v[204:207], a[248:251], a[236:239], v[204:207]
    v_cvt_pk_bf16_f32 v177, v158, v159
    v_fma_f32 v160, v160, s37, -v236
    v_mfma_f32_16x16x32_bf16 v[220:223], a[248:251], a[240:243], v[220:223]
    s_waitcnt lgkmcnt(2)
    ds_read_b128 a[240:243], v240 offset:4096
    ds_read_b128 a[248:251], v241 offset:49664
    v_mfma_f32_16x16x32_bf16 v[216:219], a[252:255], a[236:239], v[216:219]
    s_waitcnt lgkmcnt(3)
    ds_read_b128 a[252:255], v242 offset:49152
    v_fma_f32 v161, v161, s37, -v236
    v_mfma_f32_16x16x32_bf16 v[212:215], v[252:255], a[236:239], v[212:215]
    s_waitcnt lgkmcnt(2)
    ds_read_b128 a[236:239], v239 offset:4096
    v_fma_f32 v162, v162, s37, -v236
    v_fma_f32 v163, v163, s37, -v236
    v_exp_f32 v160, v160
    ds_read_b128 v[252:255], v242 offset:49664
    ds_read_b128 v[156:159], v229 offset:640
    v_exp_f32 v161, v161
    v_exp_f32 v162, v162
    v_exp_f32 v163, v163
    v_cvt_pk_bf16_f32 v178, v160, v161
    v_cvt_pk_bf16_f32 v179, v162, v163
    ds_read_b128 v[160:163], v229 offset:1280
    v_mfma_f32_16x16x32_bf16 v[200:203], a[244:247], a[240:243], v[200:203]
    v_fma_f32 v164, v164, s37, -v236
    v_fma_f32 v165, v165, s37, -v236
    v_mfma_f32_16x16x32_bf16 v[196:199], a[216:219], v[176:179], 0
    v_fma_f32 v166, v166, s37, -v236
    v_fma_f32 v167, v167, s37, -v236
    v_mfma_f32_16x16x32_bf16 v[184:187], v[76:79], v[176:179], 0
    v_exp_f32 v164, v164
    v_mfma_f32_16x16x32_bf16 v[188:191], v[98:101], v[176:179], 0
    v_exp_f32 v165, v165
    v_mfma_f32_16x16x32_bf16 v[192:195], v[120:123], v[176:179], 0
    s_waitcnt lgkmcnt(1)
    v_exp_f32 v166, v166
    v_mfma_f32_16x16x32_bf16 v[156:159], v[24:27], v[132:135], v[156:159]
    v_exp_f32 v167, v167
    v_mfma_f32_16x16x32_bf16 v[208:211], a[244:247], a[236:239], v[208:211]
    s_waitcnt lgkmcnt(0)
    ds_read_b128 a[244:247], v241 offset:61440
    v_cvt_pk_bf16_f32 v180, v164, v165
    v_mfma_f32_16x16x32_bf16 v[160:163], v[30:33], v[132:135], v[160:163]
    v_cvt_pk_bf16_f32 v181, v166, v167
    v_fma_f32 v168, v168, s37, -v236
    v_mfma_f32_16x16x16_bf16 v[156:159], v[28:29], v[136:137], v[156:159]
    ds_read_b128 v[164:167], v228 offset:1280
    v_fma_f32 v169, v169, s37, -v236
    v_mfma_f32_16x16x32_bf16 v[204:207], a[248:251], a[236:239], v[204:207]
    v_fma_f32 v170, v170, s37, -v236
    v_fma_f32 v171, v171, s37, -v236
    v_mfma_f32_16x16x16_bf16 v[160:163], v[34:35], v[136:137], v[160:163]
    v_exp_f32 v168, v168
    v_mfma_f32_16x16x32_bf16 v[220:223], a[248:251], a[240:243], v[220:223]
    ds_read_b128 a[240:243], v240 offset:5120
    ds_read_b128 a[248:251], v241 offset:61952
    v_mfma_f32_16x16x32_bf16 v[216:219], a[252:255], a[236:239], v[216:219]
    ds_read_b128 a[252:255], v242 offset:61440
    v_fma_f32 v172, v172, s37, -v236
    v_mfma_f32_16x16x32_bf16 v[212:215], v[252:255], a[236:239], v[212:215]
    s_waitcnt lgkmcnt(3)
    ds_read_b128 a[236:239], v239 offset:5120
    v_exp_f32 v169, v169
    v_exp_f32 v170, v170
    ds_read_b128 v[252:255], v242 offset:61952
    v_mfma_f32_16x16x32_bf16 v[164:167], v[6:9], v[132:135], v[164:167]
    v_exp_f32 v171, v171
    v_cvt_pk_bf16_f32 v182, v168, v169
    v_cvt_pk_bf16_f32 v183, v170, v171
    ds_read_b128 v[168:171], v228 offset:1920
    v_fma_f32 v173, v173, s37, -v236
    v_mfma_f32_16x16x32_bf16 v[196:199], a[216:219], v[180:183], v[196:199]
    v_fma_f32 v174, v174, s37, -v236
    v_fma_f32 v175, v175, s37, -v236
    v_mfma_f32_16x16x32_bf16 v[184:187], v[68:71], v[180:183], v[184:187]
    v_exp_f32 v172, v172
    v_mfma_f32_16x16x32_bf16 v[188:191], v[90:93], v[180:183], v[188:191]
    v_exp_f32 v173, v173
    v_mfma_f32_16x16x32_bf16 v[192:195], v[112:115], v[180:183], v[192:195]
    v_exp_f32 v174, v174
    v_mfma_f32_16x16x16_bf16 v[164:167], v[10:11], v[136:137], v[164:167]
    s_waitcnt lgkmcnt(2)
    v_exp_f32 v175, v175
    v_mfma_f32_16x16x32_bf16 v[208:211], a[244:247], a[236:239], v[208:211]
    v_cvt_pk_bf16_f32 v176, v172, v173
    v_cvt_pk_bf16_f32 v177, v174, v175
    v_mfma_f32_16x16x32_bf16 v[200:203], a[244:247], a[240:243], v[200:203]
    s_waitcnt lgkmcnt(0)
    ds_read_b128 a[244:247], v224 offset:46592
    ds_read_b128 v[172:175], v229 offset:1920
    v_mfma_f32_16x16x32_bf16 v[168:171], v[12:15], v[132:135], v[168:171]
    v_fma_f32 v144, v144, s37, -v236
    v_fma_f32 v145, v145, s37, -v236
    v_mfma_f32_16x16x32_bf16 v[204:207], a[248:251], a[236:239], v[204:207]
    v_cvt_pk_bf16_f32 v208, v208, v209
    v_cvt_pk_bf16_f32 v209, v210, v211
    v_mfma_f32_16x16x32_bf16 v[220:223], a[248:251], a[240:243], v[220:223]
    ds_read_b128 a[240:243], v224 offset:46528
    ds_read_b128 a[248:251], v224 offset:46656
    v_mfma_f32_16x16x16_bf16 v[168:171], v[16:17], v[136:137], v[168:171]
    v_cvt_pk_bf16_f32 v200, v200, v201
    v_cvt_pk_bf16_f32 v201, v202, v203
    v_mfma_f32_16x16x32_bf16 v[216:219], a[252:255], a[236:239], v[216:219]
    ds_read_b128 a[252:255], v224 offset:46720
    v_cvt_pk_bf16_f32 v210, v204, v205
    v_mfma_f32_16x16x32_bf16 v[212:215], v[252:255], a[236:239], v[212:215]
    s_waitcnt lgkmcnt(3)
    ds_read_b128 a[236:239], v224 offset:46464
    ds_read_b128 v[252:255], v224 offset:46784
    v_cvt_pk_bf16_f32 v211, v206, v207
    buffer_store_dwordx4 v[208:211], v243, s[20:23], s51 offen sc0 sc1
    v_mfma_f32_16x16x32_bf16 v[172:175], v[36:39], v[132:135], v[172:175]
    v_cvt_pk_bf16_f32 v202, v220, v221
    v_cvt_pk_bf16_f32 v203, v222, v223
    v_cvt_pk_bf16_f32 v216, v216, v217
    v_cvt_pk_bf16_f32 v217, v218, v219
    v_cvt_pk_bf16_f32 v218, v212, v213
    v_cvt_pk_bf16_f32 v219, v214, v215
    v_mfma_f32_16x16x16_bf16 v[172:175], v[40:41], v[136:137], v[172:175]
    s_waitcnt lgkmcnt(1)
    v_fma_f32 v146, v146, s37, -v236
    v_fma_f32 v147, v147, s37, -v236
    v_exp_f32 v144, v144
    v_exp_f32 v145, v145
    v_mfma_f32_16x16x32_bf16 v[208:211], a[0:3], a[236:239], 0
    v_exp_f32 v146, v146
    v_mfma_f32_16x16x32_bf16 v[208:211], a[12:15], a[240:243], v[208:211]
    v_exp_f32 v147, v147
    v_mfma_f32_16x16x32_bf16 v[204:207], a[4:7], a[236:239], 0
    v_cvt_pk_bf16_f32 v178, v144, v145
    v_cvt_pk_bf16_f32 v179, v146, v147
    v_mfma_f32_16x16x32_bf16 v[204:207], a[16:19], a[240:243], v[204:207]
    ds_read_b128 v[144:147], v229 offset:2560
    v_fma_f32 v148, v148, s37, -v236
    v_mfma_f32_16x16x32_bf16 v[196:199], a[216:219], v[176:179], v[196:199]
    v_fma_f32 v149, v149, s37, -v236
    v_fma_f32 v150, v150, s37, -v236
    v_mfma_f32_16x16x32_bf16 v[184:187], v[84:87], v[176:179], v[184:187]
    v_fma_f32 v151, v151, s37, -v236
    v_max3_f32 v248, v152, v153, v154
    v_mfma_f32_16x16x32_bf16 v[188:191], v[106:109], v[176:179], v[188:191]
    v_exp_f32 v148, v148
    v_mfma_f32_16x16x32_bf16 v[192:195], v[128:131], v[176:179], v[192:195]
    buffer_store_dwordx4 v[200:203], v245, s[20:23], s51 offen sc0 sc1
    v_mfma_f32_16x16x32_bf16 v[220:223], a[236:239], a[72:75], 0
    v_exp_f32 v149, v149
    v_mfma_f32_16x16x32_bf16 v[220:223], a[240:243], a[84:87], v[220:223]
    v_exp_f32 v150, v150
    v_mfma_f32_16x16x32_bf16 v[200:203], a[8:11], a[236:239], 0
    v_exp_f32 v151, v151
    v_mfma_f32_16x16x32_bf16 v[200:203], a[20:23], a[240:243], v[200:203]
    v_cvt_pk_bf16_f32 v180, v148, v149
    v_cvt_pk_bf16_f32 v181, v150, v151
    v_mfma_f32_16x16x32_bf16 v[212:215], a[236:239], a[80:83], 0
    ds_read_b128 v[148:151], v228 offset:2560
    v_max3_f32 v249, v155, v156, v157
    v_mfma_f32_16x16x32_bf16 v[212:215], a[240:243], a[92:95], v[212:215]
    v_max3_f32 v248, v248, v158, v159
    v_max3_f32 v249, v249, v160, v161
    v_mfma_f32_16x16x16_bf16 v[196:199], a[216:217], v[180:181], v[196:199]
    v_max3_f32 v248, v248, v162, v163
    v_max3_f32 v249, v249, v164, v165
    v_mfma_f32_16x16x16_bf16 v[184:187], v[82:83], v[180:181], v[184:187]
    v_max3_f32 v248, v248, v166, v167
    v_max3_f32 v249, v249, v168, v169
    v_mfma_f32_16x16x16_bf16 v[188:191], v[104:105], v[180:181], v[188:191]
    v_max3_f32 v248, v248, v170, v171
    v_max3_f32 v249, v249, v172, v173
    v_mfma_f32_16x16x16_bf16 v[192:195], v[126:127], v[180:181], v[192:195]
    v_rcp_f32 v197, v196
    v_mfma_f32_16x16x32_bf16 v[208:211], a[24:27], a[244:247], v[208:211]
    v_mul_f32 v184, v184, v197
    v_mul_f32 v185, v185, v197
    v_mfma_f32_16x16x32_bf16 v[208:211], a[36:39], a[248:251], v[208:211]
    buffer_store_dwordx4 v[216:219], v244, s[20:23], s51 offen sc0 sc1
    v_mfma_f32_16x16x32_bf16 v[204:207], a[28:31], a[244:247], v[204:207]
    s_add_u32 s51, s51, s48
    v_cvt_pk_bf16_f32 v184, v184, v185
    v_mul_f32 v186, v186, v197
    v_mfma_f32_16x16x32_bf16 v[204:207], a[40:43], a[248:251], v[204:207]
    v_mul_f32 v187, v187, v197
    v_cvt_pk_bf16_f32 v185, v186, v187
    v_mfma_f32_16x16x32_bf16 v[216:219], a[236:239], a[76:79], 0
    ds_read_b128 a[236:239], v224 offset:49536
    v_mul_f32 v188, v188, v197
    v_mfma_f32_16x16x32_bf16 v[216:219], a[240:243], a[88:91], v[216:219]
    ds_read_b128 a[240:243], v224 offset:49600
    v_mul_f32 v189, v189, v197
    v_mfma_f32_16x16x32_bf16 v[200:203], a[32:35], a[244:247], v[200:203]
    v_cvt_pk_bf16_f32 v186, v188, v189
    v_mul_f32 v190, v190, v197
    v_mfma_f32_16x16x32_bf16 v[200:203], a[44:47], a[248:251], v[200:203]
    v_mul_f32 v191, v191, v197
    v_cvt_pk_bf16_f32 v187, v190, v191
    v_mfma_f32_16x16x32_bf16 v[220:223], a[244:247], a[96:99], v[220:223]
    v_mul_f32 v192, v192, v197
    v_mul_f32 v193, v193, v197
    v_mfma_f32_16x16x32_bf16 v[220:223], a[248:251], a[108:111], v[220:223]
    v_cvt_pk_bf16_f32 v188, v192, v193
    v_mul_f32 v194, v194, v197
    v_mfma_f32_16x16x32_bf16 v[216:219], a[244:247], a[100:103], v[216:219]
    v_mul_f32 v195, v195, v197
    v_cvt_pk_bf16_f32 v189, v194, v195
    v_mfma_f32_16x16x32_bf16 v[216:219], a[248:251], a[112:115], v[216:219]
    ds_write_b128 v237, v[184:187] offset:18432
    v_mfma_f32_16x16x32_bf16 v[212:215], a[244:247], a[104:107], v[212:215]
    ds_write_b64 v238, v[188:189] offset:18432
    v_mfma_f32_16x16x32_bf16 v[212:215], a[248:251], a[116:119], v[212:215]
    v_max3_f32 v248, v248, v174, v175
    v_mfma_f32_16x16x32_bf16 v[208:211], a[48:51], a[252:255], v[208:211]
    s_waitcnt lgkmcnt(2)
    v_mfma_f32_16x16x32_bf16 v[208:211], a[60:63], v[252:255], v[208:211]
    v_mfma_f32_16x16x32_bf16 v[204:207], a[52:55], a[252:255], v[204:207]
    ds_read_b128 a[244:247], v224 offset:49664
    ds_read_b128 a[248:251], v224 offset:49728
    v_mfma_f32_16x16x32_bf16 v[204:207], a[64:67], v[252:255], v[204:207]
    v_mfma_f32_16x16x32_bf16 v[200:203], a[56:59], a[252:255], v[200:203]
    v_mfma_f32_16x16x32_bf16 v[200:203], a[68:71], v[252:255], v[200:203]
    v_mfma_f32_16x16x32_bf16 v[220:223], a[252:255], a[120:123], v[220:223]
    v_mfma_f32_16x16x32_bf16 v[220:223], v[252:255], a[132:135], v[220:223]
    v_cvt_pk_bf16_f32 v18, v208, v209
    v_cvt_pk_bf16_f32 v19, v210, v211
    v_mfma_f32_16x16x32_bf16 v[216:219], a[252:255], a[124:127], v[216:219]
    v_mfma_f32_16x16x32_bf16 v[216:219], v[252:255], a[136:139], v[216:219]
    v_cvt_pk_bf16_f32 v20, v204, v205
    v_cvt_pk_bf16_f32 v21, v206, v207
    v_mfma_f32_16x16x32_bf16 v[212:215], a[252:255], a[128:131], v[212:215]
    v_cvt_pk_bf16_f32 v22, v200, v201
    v_cvt_pk_bf16_f32 v23, v202, v203
    v_mfma_f32_16x16x32_bf16 v[212:215], v[252:255], a[140:143], v[212:215]
    v_cvt_pk_bf16_f32 v80, v220, v221
    v_cvt_pk_bf16_f32 v81, v222, v223
    v_mfma_f32_16x16x32_bf16 v[148:151], v[18:21], v[132:135], v[148:151]
    v_cvt_pk_bf16_f32 v102, v216, v217
    v_cvt_pk_bf16_f32 v103, v218, v219
    v_mfma_f32_16x16x32_bf16 v[208:211], a[0:3], a[236:239], 0
    ds_read_b128 a[252:255], v224 offset:49792
    ds_read_b128 v[252:255], v224 offset:49856
    v_mfma_f32_16x16x32_bf16 v[208:211], a[12:15], a[240:243], v[208:211]
    v_cvt_pk_bf16_f32 v124, v212, v213
    v_cvt_pk_bf16_f32 v125, v214, v215
    v_mfma_f32_16x16x16_bf16 v[148:151], v[22:23], v[136:137], v[148:151]
    v_mfma_f32_16x16x32_bf16 v[204:207], a[4:7], a[236:239], 0
    v_mfma_f32_16x16x32_bf16 v[204:207], a[16:19], a[240:243], v[204:207]
    v_mfma_f32_16x16x32_bf16 v[200:203], a[8:11], a[236:239], 0
    v_mfma_f32_16x16x32_bf16 v[200:203], a[20:23], a[240:243], v[200:203]
    v_mfma_f32_16x16x32_bf16 v[220:223], a[236:239], a[72:75], 0
    v_mfma_f32_16x16x32_bf16 v[220:223], a[240:243], a[84:87], v[220:223]
    v_mfma_f32_16x16x32_bf16 v[216:219], a[236:239], a[76:79], 0
    v_mfma_f32_16x16x32_bf16 v[216:219], a[240:243], a[88:91], v[216:219]
    v_mfma_f32_16x16x32_bf16 v[212:215], a[236:239], a[80:83], 0
    ds_read_b128 a[236:239], v225 offset:27456
    v_mfma_f32_16x16x32_bf16 v[212:215], a[240:243], a[92:95], v[212:215]
    s_waitcnt lgkmcnt(1)
    ds_read_b128 a[240:243], v225 offset:27520
    v_mfma_f32_16x16x32_bf16 v[208:211], a[24:27], a[244:247], v[208:211]
    v_mfma_f32_16x16x32_bf16 v[208:211], a[36:39], a[248:251], v[208:211]
    v_mfma_f32_16x16x32_bf16 v[204:207], a[28:31], a[244:247], v[204:207]
    v_mfma_f32_16x16x32_bf16 v[204:207], a[40:43], a[248:251], v[204:207]
    v_mfma_f32_16x16x32_bf16 v[200:203], a[32:35], a[244:247], v[200:203]
    v_mfma_f32_16x16x32_bf16 v[200:203], a[44:47], a[248:251], v[200:203]
    v_mfma_f32_16x16x32_bf16 v[220:223], a[244:247], a[96:99], v[220:223]
    v_mfma_f32_16x16x32_bf16 v[220:223], a[248:251], a[108:111], v[220:223]
    v_mfma_f32_16x16x32_bf16 v[216:219], a[244:247], a[100:103], v[216:219]
    v_mfma_f32_16x16x32_bf16 v[216:219], a[248:251], a[112:115], v[216:219]
    v_mfma_f32_16x16x32_bf16 v[212:215], a[244:247], a[104:107], v[212:215]
    ds_read_b128 a[244:247], v225 offset:27584
    v_mfma_f32_16x16x32_bf16 v[212:215], a[248:251], a[116:119], v[212:215]
    ds_read_b128 a[248:251], v225 offset:27648
    v_mfma_f32_16x16x32_bf16 v[208:211], a[48:51], a[252:255], v[208:211]
    v_mfma_f32_16x16x32_bf16 v[208:211], a[60:63], v[252:255], v[208:211]
    v_mfma_f32_16x16x32_bf16 v[204:207], a[52:55], a[252:255], v[204:207]
    v_mfma_f32_16x16x32_bf16 v[204:207], a[64:67], v[252:255], v[204:207]
    v_mfma_f32_16x16x32_bf16 v[200:203], a[56:59], a[252:255], v[200:203]
    v_mfma_f32_16x16x32_bf16 v[200:203], a[68:71], v[252:255], v[200:203]
    v_mfma_f32_16x16x32_bf16 v[220:223], a[252:255], a[120:123], v[220:223]
    v_mfma_f32_16x16x32_bf16 v[220:223], v[252:255], a[132:135], v[220:223]
    v_mfma_f32_16x16x32_bf16 v[216:219], a[252:255], a[124:127], v[216:219]
    v_mfma_f32_16x16x32_bf16 v[216:219], v[252:255], a[136:139], v[216:219]
    v_cvt_pk_bf16_f32 v42, v208, v209
    v_cvt_pk_bf16_f32 v43, v210, v211
    v_mfma_f32_16x16x32_bf16 v[212:215], a[252:255], a[128:131], v[212:215]
    v_cvt_pk_bf16_f32 v44, v204, v205
    v_cvt_pk_bf16_f32 v45, v206, v207
    v_mfma_f32_16x16x32_bf16 v[212:215], v[252:255], a[140:143], v[212:215]
    v_cvt_pk_bf16_f32 v46, v200, v201
    v_cvt_pk_bf16_f32 v47, v202, v203
    v_mfma_f32_16x16x32_bf16 v[144:147], v[42:45], v[132:135], v[144:147]
    s_waitcnt lgkmcnt(0)
    v_cvt_pk_bf16_f32 v78, v220, v221
    v_cvt_pk_bf16_f32 v79, v222, v223
    v_mfma_f32_16x16x32_bf16 v[208:211], a[144:147], a[236:239], 0
    v_cvt_pk_bf16_f32 v100, v216, v217
    v_cvt_pk_bf16_f32 v101, v218, v219
    v_mfma_f32_16x16x32_bf16 v[208:211], a[156:159], a[240:243], v[208:211]
    v_cvt_pk_bf16_f32 v122, v212, v213
    v_cvt_pk_bf16_f32 v123, v214, v215
    v_mfma_f32_16x16x16_bf16 v[144:147], v[46:47], v[136:137], v[144:147]
    ds_read_b128 a[252:255], v225 offset:27712
    ds_read_b128 v[252:255], v225 offset:27776
    v_mfma_f32_16x16x32_bf16 v[204:207], a[148:151], a[236:239], 0
    v_mfma_f32_16x16x32_bf16 v[204:207], a[160:163], a[240:243], v[204:207]
    v_mfma_f32_16x16x32_bf16 v[200:203], a[152:155], a[236:239], 0
    ds_read_b128 a[236:239], v225 offset:39872
    v_mfma_f32_16x16x32_bf16 v[200:203], a[164:167], a[240:243], v[200:203]
    ds_read_b128 a[240:243], v225 offset:39936
    v_max3_f32 v249, v249, v144, v145
    v_mfma_f32_16x16x32_bf16 v[208:211], a[168:171], a[244:247], v[208:211]
    v_max3_f32 v248, v248, v146, v147
    v_max3_f32 v249, v249, v148, v149
    v_mfma_f32_16x16x32_bf16 v[208:211], a[180:183], a[248:251], v[208:211]
    v_max3_f32 v248, v248, v150, v151
    v_max_f32 v248, v248, v249
    v_mfma_f32_16x16x32_bf16 v[204:207], a[172:175], a[244:247], v[204:207]
    s_waitcnt vmcnt(3) lgkmcnt(2)
    v_mov_b32 v249, v248
    v_mfma_f32_16x16x32_bf16 v[204:207], a[184:187], a[248:251], v[204:207]
    s_barrier
    buffer_load_dwordx4 v246, s[4:7], s56 offen lds
    v_mfma_f32_16x16x32_bf16 v[200:203], a[176:179], a[244:247], v[200:203]
    ds_read_b128 a[244:247], v225 offset:40000
    v_mfma_f32_16x16x32_bf16 v[200:203], a[188:191], a[248:251], v[200:203]
    ds_read_b128 a[248:251], v225 offset:40064
    v_mfma_f32_16x16x32_bf16 v[208:211], a[192:195], a[252:255], v[208:211]
    v_permlane16_swap_b32 v248, v249
    v_mfma_f32_16x16x32_bf16 v[208:211], a[204:207], v[252:255], v[208:211]
    v_max_f32 v248, v248, v249
    v_mov_b32 v249, v248
    v_mfma_f32_16x16x32_bf16 v[204:207], a[196:199], a[252:255], v[204:207]
    v_mfma_f32_16x16x32_bf16 v[204:207], a[208:211], v[252:255], v[204:207]
    v_permlane32_swap_b32 v248, v249
    v_mfma_f32_16x16x32_bf16 v[200:203], a[200:203], a[252:255], v[200:203]
    ds_read_b128 a[252:255], v225 offset:40128
    v_max_f32 v248, v248, v249
    v_mfma_f32_16x16x32_bf16 v[200:203], a[212:215], v[252:255], v[200:203]
    s_waitcnt lgkmcnt(3)
    v_cvt_pk_bf16_f32 v138, v208, v209
    v_cvt_pk_bf16_f32 v139, v210, v211
    v_mfma_f32_16x16x32_bf16 v[220:223], a[144:147], a[236:239], 0
    v_cvt_pk_bf16_f32 v140, v204, v205
    v_cvt_pk_bf16_f32 v141, v206, v207
    v_mfma_f32_16x16x32_bf16 v[220:223], a[156:159], a[240:243], v[220:223]
    ds_read_b128 v[252:255], v225 offset:40192
    v_mul_f32 v236, s37, v248
    v_mfma_f32_16x16x32_bf16 v[216:219], a[148:151], a[236:239], 0
    v_cvt_pk_bf16_f32 v142, v200, v201
    v_cvt_pk_bf16_f32 v143, v202, v203
    v_mfma_f32_16x16x32_bf16 v[216:219], a[160:163], a[240:243], v[216:219]
    buffer_load_dwordx4 v247, s[4:7], s56 offen offset:1024 lds
    v_mfma_f32_16x16x32_bf16 v[212:215], a[152:155], a[236:239], 0
    s_add_u32 s56, s56, s42
    ds_read_b128 a[236:239], v239 offset:12288
    v_fma_f32 v152, v152, s37, -v236
    v_mfma_f32_16x16x32_bf16 v[212:215], a[164:167], a[240:243], v[212:215]
    s_add_u32 m0, s41, 0x5ac0
    ds_read_b128 a[240:243], v240 offset:12288
    v_fma_f32 v153, v153, s37, -v236
    s_waitcnt lgkmcnt(4)
    v_mfma_f32_16x16x32_bf16 v[220:223], a[168:171], a[244:247], v[220:223]
    v_fma_f32 v154, v154, s37, -v236
    v_fma_f32 v155, v155, s37, -v236
    v_mfma_f32_16x16x32_bf16 v[220:223], a[180:183], a[248:251], v[220:223]
    v_exp_f32 v152, v152
    v_mfma_f32_16x16x32_bf16 v[216:219], a[172:175], a[244:247], v[216:219]
    v_exp_f32 v153, v153
    v_mfma_f32_16x16x32_bf16 v[216:219], a[184:187], a[248:251], v[216:219]
    v_exp_f32 v154, v154
    v_mfma_f32_16x16x32_bf16 v[212:215], a[176:179], a[244:247], v[212:215]
    ds_read_b128 a[244:247], v239 offset:13312
    v_cvt_pk_bf16_f32 v176, v152, v153
    v_mfma_f32_16x16x32_bf16 v[212:215], a[188:191], a[248:251], v[212:215]
    s_waitcnt lgkmcnt(3)
    buffer_load_dwordx4 v246, s[4:7], s56 offen lds
    v_mfma_f32_16x16x32_bf16 v[220:223], a[192:195], a[252:255], v[220:223]
    ds_read_b128 a[248:251], v240 offset:13312
    v_cndmask_b32 v246, v245, v243, vcc
    v_mfma_f32_16x16x32_bf16 v[220:223], a[204:207], v[252:255], v[220:223]
    v_exp_f32 v155, v155
    v_mfma_f32_16x16x32_bf16 v[216:219], a[196:199], a[252:255], v[216:219]
    v_cvt_pk_bf16_f32 v177, v154, v155
    v_fma_f32 v156, v156, s37, -v236
    v_mfma_f32_16x16x32_bf16 v[216:219], a[208:211], v[252:255], v[216:219]
    ds_read_b128 v[152:155], v230 offset:640
    v_fma_f32 v157, v157, s37, -v236
    v_mfma_f32_16x16x32_bf16 v[212:215], a[200:203], a[252:255], v[212:215]
    v_cvt_pk_bf16_f32 v132, v220, v221
    v_cvt_pk_bf16_f32 v133, v222, v223
    v_mfma_f32_16x16x32_bf16 v[212:215], a[212:215], v[252:255], v[212:215]
    s_waitcnt lgkmcnt(3)
    ds_read_b128 a[252:255], v241 offset:12288
    ds_read_b128 v[252:255], v241 offset:12800
    v_mfma_f32_16x16x32_bf16 v[208:211], a[220:223], a[236:239], 0
    v_cvt_pk_bf16_f32 v134, v216, v217
    v_cvt_pk_bf16_f32 v135, v218, v219
    v_mfma_f32_16x16x32_bf16 v[200:203], a[220:223], a[240:243], 0
    buffer_load_dwordx4 v247, s[4:7], s56 offen offset:1024 lds
    v_mfma_f32_16x16x32_bf16 v[204:207], a[224:227], a[236:239], 0
    v_cvt_pk_bf16_f32 v136, v212, v213
    v_cvt_pk_bf16_f32 v137, v214, v215
    v_mfma_f32_16x16x32_bf16 v[220:223], a[224:227], a[240:243], 0
    ds_read_b128 a[240:243], v242 offset:12800
    v_bfrev_b32 v247, 1
    v_mfma_f32_16x16x32_bf16 v[216:219], a[228:231], a[236:239], 0
    s_waitcnt lgkmcnt(3)
    v_fma_f32 v158, v158, s37, -v236
    v_fma_f32 v159, v159, s37, -v236
    v_mfma_f32_16x16x32_bf16 v[152:155], v[24:27], v[138:141], v[152:155]
    v_exp_f32 v156, v156
    v_mfma_f32_16x16x32_bf16 v[212:215], a[232:235], a[236:239], 0
    s_waitcnt lgkmcnt(2)
    ds_read_b128 a[236:239], v242 offset:12288
    v_fma_f32 v160, v160, s37, -v236
    v_mfma_f32_16x16x32_bf16 v[208:211], a[252:255], a[244:247], v[208:211]
    v_exp_f32 v157, v157
    v_mfma_f32_16x16x16_bf16 v[152:155], v[28:29], v[142:143], v[152:155]
    v_exp_f32 v158, v158
    v_mfma_f32_16x16x32_bf16 v[200:203], a[252:255], a[248:251], v[200:203]
    s_waitcnt lgkmcnt(2)
    ds_read_b128 a[252:255], v241 offset:24576
    v_cvt_pk_bf16_f32 v178, v156, v157
    v_mfma_f32_16x16x32_bf16 v[204:207], v[252:255], a[244:247], v[204:207]
    v_exp_f32 v159, v159
    v_mfma_f32_16x16x32_bf16 v[220:223], v[252:255], a[248:251], v[220:223]
    s_waitcnt lgkmcnt(2)
    ds_read_b128 a[248:251], v240 offset:14336
    ds_read_b128 v[252:255], v241 offset:25088
    v_mfma_f32_16x16x32_bf16 v[212:215], a[240:243], a[244:247], v[212:215]
    s_waitcnt lgkmcnt(3)
    ds_read_b128 a[240:243], v242 offset:25088
    v_cvt_pk_bf16_f32 v179, v158, v159
    v_mfma_f32_16x16x32_bf16 v[216:219], a[236:239], a[244:247], v[216:219]
    ds_read_b128 a[244:247], v239 offset:14336
    v_fma_f32 v161, v161, s37, -v236
    v_mfma_f32_16x16x32_bf16 v[196:199], a[216:219], v[176:179], 0
    ds_read_b128 a[236:239], v242 offset:24576
    v_fma_f32 v162, v162, s37, -v236
    v_mfma_f32_16x16x32_bf16 v[184:187], v[66:69], v[176:179], 0
    ds_read_b128 v[156:159], v230 offset:1280
    v_fma_f32 v163, v163, s37, -v236
    v_mfma_f32_16x16x32_bf16 v[188:191], v[88:91], v[176:179], 0
    v_exp_f32 v160, v160
    v_mfma_f32_16x16x32_bf16 v[192:195], v[110:113], v[176:179], 0
    s_waitcnt lgkmcnt(5)
    v_exp_f32 v161, v161
    v_mfma_f32_16x16x32_bf16 v[200:203], a[252:255], a[248:251], v[200:203]
    s_waitcnt lgkmcnt(4)
    v_exp_f32 v162, v162
    v_mfma_f32_16x16x32_bf16 v[220:223], v[252:255], a[248:251], v[220:223]
    s_waitcnt lgkmcnt(2)
    ds_read_b128 a[248:251], v240 offset:15360
    v_exp_f32 v163, v163
    v_cvt_pk_bf16_f32 v180, v160, v161
    v_cvt_pk_bf16_f32 v181, v162, v163
    ds_read_b128 v[160:163], v230 offset:1920
    v_mfma_f32_16x16x32_bf16 v[208:211], a[252:255], a[244:247], v[208:211]
    ds_read_b128 a[252:255], v241 offset:36864
    v_fma_f32 v164, v164, s37, -v236
    v_mfma_f32_16x16x32_bf16 v[204:207], v[252:255], a[244:247], v[204:207]
    s_waitcnt lgkmcnt(3)
    ds_read_b128 v[252:255], v241 offset:37376
    v_fma_f32 v165, v165, s37, -v236
    v_mfma_f32_16x16x32_bf16 v[156:159], v[30:33], v[138:141], v[156:159]
    v_fma_f32 v166, v166, s37, -v236
    v_fma_f32 v167, v167, s37, -v236
    v_mfma_f32_16x16x32_bf16 v[216:219], a[236:239], a[244:247], v[216:219]
    ds_read_b128 a[236:239], v242 offset:36864
    v_fma_f32 v168, v168, s37, -v236
    v_mfma_f32_16x16x32_bf16 v[212:215], a[240:243], a[244:247], v[212:215]
    ds_read_b128 a[244:247], v239 offset:15360
    ds_read_b128 a[240:243], v242 offset:37376
    v_mfma_f32_16x16x16_bf16 v[156:159], v[34:35], v[142:143], v[156:159]
    s_waitcnt lgkmcnt(5)
    v_exp_f32 v164, v164
    v_exp_f32 v165, v165
    v_exp_f32 v166, v166
    v_mfma_f32_16x16x32_bf16 v[160:163], v[36:39], v[138:141], v[160:163]
    s_waitcnt lgkmcnt(4)
    v_exp_f32 v167, v167
    v_mfma_f32_16x16x32_bf16 v[200:203], a[252:255], a[248:251], v[200:203]
    s_waitcnt lgkmcnt(3)
    v_cvt_pk_bf16_f32 v182, v164, v165
    v_cvt_pk_bf16_f32 v183, v166, v167
    v_mfma_f32_16x16x32_bf16 v[220:223], v[252:255], a[248:251], v[220:223]
    ds_read_b128 a[248:251], v240 offset:16384
    ds_read_b128 v[164:167], v230 offset:2560
    v_mfma_f32_16x16x32_bf16 v[196:199], a[216:219], v[180:183], v[196:199]
    v_fma_f32 v169, v169, s37, -v236
    v_fma_f32 v170, v170, s37, -v236
    v_mfma_f32_16x16x32_bf16 v[184:187], v[70:73], v[180:183], v[184:187]
    v_fma_f32 v171, v171, s37, -v236
    v_fma_f32 v172, v172, s37, -v236
    v_mfma_f32_16x16x32_bf16 v[188:191], v[92:95], v[180:183], v[188:191]
    v_exp_f32 v168, v168
    v_mfma_f32_16x16x32_bf16 v[192:195], v[114:117], v[180:183], v[192:195]
    v_exp_f32 v169, v169
    v_mfma_f32_16x16x16_bf16 v[160:163], v[40:41], v[142:143], v[160:163]
    s_waitcnt lgkmcnt(2)
    v_exp_f32 v170, v170
    v_mfma_f32_16x16x32_bf16 v[208:211], a[252:255], a[244:247], v[208:211]
    ds_read_b128 a[252:255], v241 offset:49152
    v_cvt_pk_bf16_f32 v176, v168, v169
    v_mfma_f32_16x16x32_bf16 v[204:207], v[252:255], a[244:247], v[204:207]
    ds_read_b128 v[252:255], v241 offset:49664
    v_fma_f32 v173, v173, s37, -v236
    v_mfma_f32_16x16x32_bf16 v[216:219], a[236:239], a[244:247], v[216:219]
    s_waitcnt lgkmcnt(2)
    ds_read_b128 a[236:239], v242 offset:49152
    v_fma_f32 v174, v174, s37, -v236
    v_mfma_f32_16x16x32_bf16 v[164:167], v[42:45], v[138:141], v[164:167]
    v_exp_f32 v171, v171
    v_mfma_f32_16x16x32_bf16 v[212:215], a[240:243], a[244:247], v[212:215]
    ds_read_b128 a[244:247], v239 offset:16384
    ds_read_b128 a[240:243], v242 offset:49664
    v_cvt_pk_bf16_f32 v177, v170, v171
    v_fma_f32 v175, v175, s37, -v236
    v_mfma_f32_16x16x16_bf16 v[164:167], v[46:47], v[142:143], v[164:167]
    s_waitcnt lgkmcnt(4)
    ds_read_b128 v[168:171], v235
    v_bfe_u32 v235, s72, v233, 4
    v_mad_u32_u24 v235, v235, s40, v231
    v_exp_f32 v172, v172
    v_mfma_f32_16x16x32_bf16 v[200:203], a[252:255], a[248:251], v[200:203]
    s_waitcnt lgkmcnt(4)
    v_exp_f32 v173, v173
    v_mfma_f32_16x16x32_bf16 v[220:223], v[252:255], a[248:251], v[220:223]
    s_waitcnt lgkmcnt(2)
    ds_read_b128 a[248:251], v240 offset:17408
    v_exp_f32 v174, v174
    v_exp_f32 v175, v175
    v_cvt_pk_bf16_f32 v178, v172, v173
    v_cvt_pk_bf16_f32 v179, v174, v175
    ds_read_b128 v[172:175], v250
    v_mfma_f32_16x16x32_bf16 v[208:211], a[252:255], a[244:247], v[208:211]
    ds_read_b128 a[252:255], v241 offset:61440
    v_bfe_u32 v250, s71, v233, 4
    v_mfma_f32_16x16x32_bf16 v[196:199], a[216:219], v[176:179], v[196:199]
    v_mad_u32_u24 v250, v250, s40, v231
    v_fma_f32 v144, v144, s37, -v236
    v_mfma_f32_16x16x32_bf16 v[184:187], v[74:77], v[176:179], v[184:187]
    v_fma_f32 v145, v145, s37, -v236
    v_fma_f32 v146, v146, s37, -v236
    v_mfma_f32_16x16x32_bf16 v[188:191], v[96:99], v[176:179], v[188:191]
    v_fma_f32 v147, v147, s37, -v236
    v_fma_f32 v148, v148, s37, -v236
    v_mfma_f32_16x16x32_bf16 v[192:195], v[118:121], v[176:179], v[192:195]
    s_waitcnt lgkmcnt(3)
    v_exp_f32 v144, v144
    v_mfma_f32_16x16x32_bf16 v[168:171], v[60:63], v[138:141], v[168:171]
    v_exp_f32 v145, v145
    v_mfma_f32_16x16x32_bf16 v[204:207], v[252:255], a[244:247], v[204:207]
    s_waitcnt lgkmcnt(1)
    ds_read_b128 v[252:255], v241 offset:61952
    v_cvt_pk_bf16_f32 v180, v144, v145
    v_mfma_f32_16x16x32_bf16 v[172:175], v[48:51], v[138:141], v[172:175]
    v_exp_f32 v146, v146
    v_mfma_f32_16x16x16_bf16 v[168:171], v[64:65], v[142:143], v[168:171]
    v_exp_f32 v147, v147
    v_mfma_f32_16x16x32_bf16 v[216:219], a[236:239], a[244:247], v[216:219]
    ds_read_b128 a[236:239], v242 offset:61440
    v_cvt_pk_bf16_f32 v181, v146, v147
    v_mfma_f32_16x16x16_bf16 v[172:175], v[52:53], v[142:143], v[172:175]
    ds_read_b128 v[144:147], v229 offset:640
    v_fma_f32 v149, v149, s37, -v236
    v_mfma_f32_16x16x32_bf16 v[212:215], a[240:243], a[244:247], v[212:215]
    s_waitcnt lgkmcnt(3)
    ds_read_b128 a[244:247], v239 offset:17408
    v_fma_f32 v150, v150, s37, -v236
    v_mfma_f32_16x16x32_bf16 v[200:203], a[252:255], a[248:251], v[200:203]
    s_waitcnt lgkmcnt(3)
    ds_read_b128 a[240:243], v242 offset:61952
    v_fma_f32 v151, v151, s37, -v236
    v_mfma_f32_16x16x32_bf16 v[220:223], v[252:255], a[248:251], v[220:223]
    s_waitcnt lgkmcnt(2)
    ds_read_b128 a[248:251], v224 offset:64
    v_exp_f32 v148, v148
    v_exp_f32 v149, v149
    v_exp_f32 v150, v150
    v_exp_f32 v151, v151
    v_cvt_pk_bf16_f32 v200, v200, v201
    v_cvt_pk_bf16_f32 v201, v202, v203
    v_cvt_pk_bf16_f32 v182, v148, v149
    v_cvt_pk_bf16_f32 v202, v220, v221
    v_cvt_pk_bf16_f32 v203, v222, v223
    buffer_store_dwordx4 v[200:203], v245, s[20:23], s51 offen sc0 sc1
    v_mfma_f32_16x16x32_bf16 v[144:147], v[30:33], v[132:135], v[144:147]
    s_waitcnt lgkmcnt(2)
    v_cvt_pk_bf16_f32 v183, v150, v151
    v_max3_f32 v248, v152, v153, v154
    v_mfma_f32_16x16x32_bf16 v[208:211], a[252:255], a[244:247], v[208:211]
    ds_read_b128 a[252:255], v224 offset:128
    ds_read_b128 v[148:151], v228 offset:640
    v_mfma_f32_16x16x32_bf16 v[196:199], a[216:219], v[180:183], v[196:199]
    v_max3_f32 v249, v155, v156, v157
    v_max3_f32 v248, v248, v158, v159
    v_mfma_f32_16x16x32_bf16 v[184:187], v[78:81], v[180:183], v[184:187]
    v_max3_f32 v249, v249, v160, v161
    v_max3_f32 v248, v248, v162, v163
    v_mfma_f32_16x16x32_bf16 v[188:191], v[100:103], v[180:183], v[188:191]
    v_cvt_pk_bf16_f32 v208, v208, v209
    v_cvt_pk_bf16_f32 v209, v210, v211
    v_mfma_f32_16x16x32_bf16 v[192:195], v[122:125], v[180:183], v[192:195]
    v_rcp_f32 v197, v196
    v_mfma_f32_16x16x16_bf16 v[144:147], v[34:35], v[136:137], v[144:147]
    v_mul_f32 v184, v184, v197
    v_mul_f32 v185, v185, v197
    v_mfma_f32_16x16x32_bf16 v[204:207], v[252:255], a[244:247], v[204:207]
    ds_read_b128 v[252:255], v224 offset:192
    v_cvt_pk_bf16_f32 v184, v184, v185
    v_mfma_f32_16x16x32_bf16 v[216:219], a[236:239], a[244:247], v[216:219]
    s_waitcnt lgkmcnt(3)
    ds_read_b128 a[236:239], v224 offset:256
    v_mul_f32 v186, v186, v197
    v_mfma_f32_16x16x32_bf16 v[212:215], a[240:243], a[244:247], v[212:215]
    s_waitcnt lgkmcnt(2)
    ds_read_b128 a[244:247], v224
    ds_read_b128 a[240:243], v224 offset:320
    v_mfma_f32_16x16x32_bf16 v[148:151], v[6:9], v[132:135], v[148:151]
    v_cvt_pk_bf16_f32 v210, v204, v205
    v_cvt_pk_bf16_f32 v211, v206, v207
    buffer_store_dwordx4 v[208:211], v243, s[20:23], s51 offen sc0 sc1
    v_cvt_pk_bf16_f32 v216, v216, v217
    v_cvt_pk_bf16_f32 v217, v218, v219
    v_cvt_pk_bf16_f32 v218, v212, v213
    v_mfma_f32_16x16x16_bf16 v[148:151], v[10:11], v[136:137], v[148:151]
    s_waitcnt lgkmcnt(1)
    v_cvt_pk_bf16_f32 v219, v214, v215
    v_mul_f32 v187, v187, v197
    v_cvt_pk_bf16_f32 v185, v186, v187
    v_mul_f32 v188, v188, v197
    v_mul_f32 v189, v189, v197
    v_cvt_pk_bf16_f32 v186, v188, v189
    v_mul_f32 v190, v190, v197
    v_mul_f32 v191, v191, v197
    v_mfma_f32_16x16x32_bf16 v[208:211], a[0:3], a[244:247], 0
    v_cvt_pk_bf16_f32 v187, v190, v191
    v_mul_f32 v192, v192, v197
    v_mfma_f32_16x16x32_bf16 v[208:211], a[12:15], a[248:251], v[208:211]
    v_mul_f32 v193, v193, v197
    v_cvt_pk_bf16_f32 v188, v192, v193
    v_mfma_f32_16x16x32_bf16 v[204:207], a[4:7], a[244:247], 0
    v_mul_f32 v194, v194, v197
    v_mul_f32 v195, v195, v197
    v_mfma_f32_16x16x32_bf16 v[204:207], a[16:19], a[248:251], v[204:207]
    v_cvt_pk_bf16_f32 v189, v194, v195
    v_max3_f32 v249, v249, v164, v165
    v_mfma_f32_16x16x32_bf16 v[200:203], a[8:11], a[244:247], 0
    ds_write_b128 v237, v[184:187]
    v_mfma_f32_16x16x32_bf16 v[200:203], a[20:23], a[248:251], v[200:203]
    ds_write_b64 v238, v[188:189]
    v_mfma_f32_16x16x32_bf16 v[220:223], a[244:247], a[72:75], 0
    buffer_store_dwordx4 v[216:219], v244, s[20:23], s51 offen sc0 sc1
    v_mfma_f32_16x16x32_bf16 v[220:223], a[248:251], a[84:87], v[220:223]
    s_add_u32 s51, s51, s48
    v_max3_f32 v248, v248, v166, v167
    v_max3_f32 v249, v249, v168, v169
    v_mfma_f32_16x16x32_bf16 v[216:219], a[244:247], a[76:79], 0
    v_max3_f32 v248, v248, v170, v171
    v_max3_f32 v249, v249, v172, v173
    v_mfma_f32_16x16x32_bf16 v[216:219], a[248:251], a[88:91], v[216:219]
    v_max3_f32 v248, v248, v174, v175
    v_max_f32 v248, v248, v249
    v_mfma_f32_16x16x32_bf16 v[212:215], a[244:247], a[80:83], 0
    ds_read_b128 a[244:247], v224 offset:3072
    v_mov_b32 v249, v248
    v_mfma_f32_16x16x32_bf16 v[212:215], a[248:251], a[92:95], v[212:215]
    ds_read_b128 a[248:251], v224 offset:3136
    v_mfma_f32_16x16x32_bf16 v[208:211], a[24:27], a[252:255], v[208:211]
    v_permlane16_swap_b32 v248, v249
    v_mfma_f32_16x16x32_bf16 v[208:211], a[36:39], v[252:255], v[208:211]
    v_max_f32 v248, v248, v249
    v_mov_b32 v249, v248
    v_mfma_f32_16x16x32_bf16 v[204:207], a[28:31], a[252:255], v[204:207]
    v_mfma_f32_16x16x32_bf16 v[204:207], a[40:43], v[252:255], v[204:207]
    v_permlane32_swap_b32 v248, v249
    v_mfma_f32_16x16x32_bf16 v[200:203], a[32:35], a[252:255], v[200:203]
    v_max_f32 v248, v248, v249
    v_mul_f32 v236, s37, v248
    v_mfma_f32_16x16x32_bf16 v[200:203], a[44:47], v[252:255], v[200:203]
    v_fma_f32 v152, v152, s37, -v236
    v_fma_f32 v153, v153, s37, -v236
    v_mfma_f32_16x16x32_bf16 v[220:223], a[252:255], a[96:99], v[220:223]
    v_fma_f32 v154, v154, s37, -v236
    v_fma_f32 v155, v155, s37, -v236
    v_mfma_f32_16x16x32_bf16 v[220:223], v[252:255], a[108:111], v[220:223]
    v_exp_f32 v152, v152
    v_mfma_f32_16x16x32_bf16 v[216:219], a[252:255], a[100:103], v[216:219]
    v_exp_f32 v153, v153
    v_mfma_f32_16x16x32_bf16 v[216:219], v[252:255], a[112:115], v[216:219]
    v_exp_f32 v154, v154
    v_mfma_f32_16x16x32_bf16 v[212:215], a[252:255], a[104:107], v[212:215]
    ds_read_b128 a[252:255], v224 offset:3200
    v_cvt_pk_bf16_f32 v176, v152, v153
    v_mfma_f32_16x16x32_bf16 v[212:215], v[252:255], a[116:119], v[212:215]
    ds_read_b128 v[252:255], v224 offset:3264
    v_fma_f32 v156, v156, s37, -v236
    v_mfma_f32_16x16x32_bf16 v[208:211], a[48:51], a[236:239], v[208:211]
    s_waitcnt lgkmcnt(2)
    v_exp_f32 v155, v155
    v_mfma_f32_16x16x32_bf16 v[208:211], a[60:63], a[240:243], v[208:211]
    v_cvt_pk_bf16_f32 v177, v154, v155
    v_fma_f32 v157, v157, s37, -v236
    v_mfma_f32_16x16x32_bf16 v[204:207], a[52:55], a[236:239], v[204:207]
    ds_read_b128 v[152:155], v228 offset:1280
    v_fma_f32 v158, v158, s37, -v236
    v_mfma_f32_16x16x32_bf16 v[204:207], a[64:67], a[240:243], v[204:207]
    v_fma_f32 v159, v159, s37, -v236
    v_fma_f32 v160, v160, s37, -v236
    v_mfma_f32_16x16x32_bf16 v[200:203], a[56:59], a[236:239], v[200:203]
    v_cvt_pk_bf16_f32 v0, v208, v209
    v_cvt_pk_bf16_f32 v1, v210, v211
    v_mfma_f32_16x16x32_bf16 v[200:203], a[68:71], a[240:243], v[200:203]
    v_exp_f32 v156, v156
    v_mfma_f32_16x16x32_bf16 v[220:223], a[236:239], a[120:123], v[220:223]
    v_cvt_pk_bf16_f32 v2, v204, v205
    v_cvt_pk_bf16_f32 v3, v206, v207
    v_mfma_f32_16x16x32_bf16 v[220:223], a[240:243], a[132:135], v[220:223]
    v_exp_f32 v157, v157
    v_mfma_f32_16x16x32_bf16 v[216:219], a[236:239], a[124:127], v[216:219]
    v_exp_f32 v158, v158
    v_mfma_f32_16x16x32_bf16 v[216:219], a[240:243], a[136:139], v[216:219]
    s_waitcnt lgkmcnt(0)
    v_cvt_pk_bf16_f32 v4, v200, v201
    v_cvt_pk_bf16_f32 v5, v202, v203
    v_mfma_f32_16x16x32_bf16 v[152:155], v[12:15], v[132:135], v[152:155]
    v_exp_f32 v159, v159
    v_mfma_f32_16x16x32_bf16 v[212:215], a[236:239], a[128:131], v[212:215]
    v_cvt_pk_bf16_f32 v66, v220, v221
    v_cvt_pk_bf16_f32 v67, v222, v223
    v_mfma_f32_16x16x32_bf16 v[212:215], a[240:243], a[140:143], v[212:215]
    v_cvt_pk_bf16_f32 v88, v216, v217
    v_cvt_pk_bf16_f32 v89, v218, v219
    v_mfma_f32_16x16x16_bf16 v[152:155], v[16:17], v[136:137], v[152:155]
    ds_read_b128 a[236:239], v224 offset:3328
    ds_read_b128 a[240:243], v224 offset:3392
    v_mfma_f32_16x16x32_bf16 v[208:211], a[0:3], a[244:247], 0
    v_cvt_pk_bf16_f32 v178, v156, v157
    v_cvt_pk_bf16_f32 v179, v158, v159
    v_mfma_f32_16x16x32_bf16 v[208:211], a[12:15], a[248:251], v[208:211]
    v_cvt_pk_bf16_f32 v110, v212, v213
    v_cvt_pk_bf16_f32 v111, v214, v215
    v_mfma_f32_16x16x32_bf16 v[196:199], a[216:219], v[176:179], 0
    ds_read_b128 v[156:159], v229 offset:1280
    v_fma_f32 v161, v161, s37, -v236
    v_mfma_f32_16x16x32_bf16 v[184:187], v[68:71], v[176:179], 0
    v_fma_f32 v162, v162, s37, -v236
    v_fma_f32 v163, v163, s37, -v236
    v_mfma_f32_16x16x32_bf16 v[188:191], v[90:93], v[176:179], 0
    v_exp_f32 v160, v160
    v_mfma_f32_16x16x32_bf16 v[192:195], v[112:115], v[176:179], 0
    v_exp_f32 v161, v161
    v_mfma_f32_16x16x32_bf16 v[204:207], a[4:7], a[244:247], 0
    v_exp_f32 v162, v162
    v_mfma_f32_16x16x32_bf16 v[204:207], a[16:19], a[248:251], v[204:207]
    v_exp_f32 v163, v163
    v_mfma_f32_16x16x32_bf16 v[200:203], a[8:11], a[244:247], 0
    v_cvt_pk_bf16_f32 v180, v160, v161
    v_cvt_pk_bf16_f32 v181, v162, v163
    v_mfma_f32_16x16x32_bf16 v[200:203], a[20:23], a[248:251], v[200:203]
    s_waitcnt lgkmcnt(0)
    ds_read_b128 v[160:163], v229 offset:1920
    v_fma_f32 v164, v164, s37, -v236
    v_mfma_f32_16x16x32_bf16 v[156:159], v[36:39], v[132:135], v[156:159]
    v_fma_f32 v165, v165, s37, -v236
    v_fma_f32 v166, v166, s37, -v236
    v_mfma_f32_16x16x32_bf16 v[220:223], a[244:247], a[72:75], 0
    v_fma_f32 v167, v167, s37, -v236
    v_fma_f32 v168, v168, s37, -v236
    v_mfma_f32_16x16x32_bf16 v[220:223], a[248:251], a[84:87], v[220:223]
    v_exp_f32 v164, v164
    v_mfma_f32_16x16x16_bf16 v[156:159], v[40:41], v[136:137], v[156:159]
    v_exp_f32 v165, v165
    v_mfma_f32_16x16x32_bf16 v[216:219], a[244:247], a[76:79], 0
    v_exp_f32 v166, v166
    v_mfma_f32_16x16x32_bf16 v[216:219], a[248:251], a[88:91], v[216:219]
    v_exp_f32 v167, v167
    v_mfma_f32_16x16x32_bf16 v[212:215], a[244:247], a[80:83], 0
    ds_read_b128 a[244:247], v225 offset:42944
    v_cvt_pk_bf16_f32 v182, v164, v165
    v_mfma_f32_16x16x32_bf16 v[212:215], a[248:251], a[92:95], v[212:215]
    s_waitcnt lgkmcnt(1)
    ds_read_b128 a[248:251], v225 offset:43008
    v_cvt_pk_bf16_f32 v183, v166, v167
    v_mfma_f32_16x16x32_bf16 v[160:163], v[42:45], v[132:135], v[160:163]
    ds_read_b128 v[164:167], v228 offset:1920
    v_fma_f32 v169, v169, s37, -v236
    v_mfma_f32_16x16x32_bf16 v[196:199], a[216:219], v[180:183], v[196:199]
    v_fma_f32 v170, v170, s37, -v236
    v_fma_f32 v171, v171, s37, -v236
    v_mfma_f32_16x16x32_bf16 v[184:187], v[76:79], v[180:183], v[184:187]
    v_exp_f32 v168, v168
    v_mfma_f32_16x16x32_bf16 v[188:191], v[98:101], v[180:183], v[188:191]
    v_exp_f32 v169, v169
    v_mfma_f32_16x16x32_bf16 v[192:195], v[120:123], v[180:183], v[192:195]
    v_exp_f32 v170, v170
    v_mfma_f32_16x16x16_bf16 v[160:163], v[46:47], v[136:137], v[160:163]
    v_exp_f32 v171, v171
    v_mfma_f32_16x16x32_bf16 v[208:211], a[24:27], a[252:255], v[208:211]
    v_cvt_pk_bf16_f32 v176, v168, v169
    v_cvt_pk_bf16_f32 v177, v170, v171
    v_mfma_f32_16x16x32_bf16 v[208:211], a[36:39], v[252:255], v[208:211]
    ds_read_b128 v[168:171], v228 offset:2560
    v_fma_f32 v172, v172, s37, -v236
    v_mfma_f32_16x16x16_bf16 v[196:199], a[216:217], v[176:177], v[196:199]
    v_fma_f32 v173, v173, s37, -v236
    v_fma_f32 v174, v174, s37, -v236
    v_mfma_f32_16x16x16_bf16 v[184:187], v[86:87], v[176:177], v[184:187]
    v_fma_f32 v175, v175, s37, -v236
    v_max3_f32 v248, v144, v145, v146
    v_mfma_f32_16x16x16_bf16 v[188:191], v[108:109], v[176:177], v[188:191]
    v_exp_f32 v172, v172
    v_mfma_f32_16x16x16_bf16 v[192:195], v[130:131], v[176:177], v[192:195]
    s_waitcnt lgkmcnt(1)
    v_exp_f32 v173, v173
    v_mfma_f32_16x16x32_bf16 v[164:167], v[18:21], v[132:135], v[164:167]
    v_exp_f32 v174, v174
    v_mfma_f32_16x16x32_bf16 v[204:207], a[28:31], a[252:255], v[204:207]
    v_exp_f32 v175, v175
    v_mfma_f32_16x16x32_bf16 v[204:207], a[40:43], v[252:255], v[204:207]
    v_cvt_pk_bf16_f32 v180, v172, v173
    v_cvt_pk_bf16_f32 v181, v174, v175
    v_mfma_f32_16x16x16_bf16 v[164:167], v[22:23], v[136:137], v[164:167]
    ds_read_b128 v[172:175], v229 offset:2560
    v_max3_f32 v249, v147, v148, v149
    v_mfma_f32_16x16x16_bf16 v[196:199], a[216:217], v[180:181], v[196:199]
    v_max3_f32 v248, v248, v150, v151
    v_max3_f32 v249, v249, v152, v153
    v_mfma_f32_16x16x16_bf16 v[184:187], v[82:83], v[180:181], v[184:187]
    v_max3_f32 v248, v248, v154, v155
    v_max3_f32 v249, v249, v156, v157
    v_mfma_f32_16x16x16_bf16 v[188:191], v[104:105], v[180:181], v[188:191]
    v_max3_f32 v248, v248, v158, v159
    v_max3_f32 v249, v249, v160, v161
    v_mfma_f32_16x16x16_bf16 v[192:195], v[126:127], v[180:181], v[192:195]
    s_waitcnt lgkmcnt(1)
    v_rcp_f32 v197, v196
    v_mfma_f32_16x16x32_bf16 v[168:171], v[0:3], v[132:135], v[168:171]
    v_mul_f32 v184, v184, v197
    v_mul_f32 v185, v185, v197
    v_mfma_f32_16x16x32_bf16 v[200:203], a[32:35], a[252:255], v[200:203]
    v_cvt_pk_bf16_f32 v184, v184, v185
    v_mul_f32 v186, v186, v197
    v_mfma_f32_16x16x32_bf16 v[200:203], a[44:47], v[252:255], v[200:203]
    v_mul_f32 v187, v187, v197
    v_cvt_pk_bf16_f32 v185, v186, v187
    v_mfma_f32_16x16x16_bf16 v[168:171], v[4:5], v[136:137], v[168:171]
    v_mul_f32 v188, v188, v197
    v_mul_f32 v189, v189, v197
    v_mfma_f32_16x16x32_bf16 v[220:223], a[252:255], a[96:99], v[220:223]
    v_cvt_pk_bf16_f32 v186, v188, v189
    v_mul_f32 v190, v190, v197
    v_mfma_f32_16x16x32_bf16 v[220:223], v[252:255], a[108:111], v[220:223]
    v_mul_f32 v191, v191, v197
    v_cvt_pk_bf16_f32 v187, v190, v191
    v_mfma_f32_16x16x32_bf16 v[216:219], a[252:255], a[100:103], v[216:219]
    v_mul_f32 v192, v192, v197
    v_mul_f32 v193, v193, v197
    v_mfma_f32_16x16x32_bf16 v[216:219], v[252:255], a[112:115], v[216:219]
    v_cvt_pk_bf16_f32 v188, v192, v193
    v_mul_f32 v194, v194, v197
    v_mfma_f32_16x16x32_bf16 v[212:215], a[252:255], a[104:107], v[212:215]
    ds_read_b128 a[252:255], v225 offset:43072
    v_mul_f32 v195, v195, v197
    v_mfma_f32_16x16x32_bf16 v[212:215], v[252:255], a[116:119], v[212:215]
    ds_read_b128 v[252:255], v225 offset:43136
    v_cvt_pk_bf16_f32 v189, v194, v195
    v_mfma_f32_16x16x32_bf16 v[208:211], a[48:51], a[236:239], v[208:211]
    ds_write_b128 v237, v[184:187] offset:6144
    v_mfma_f32_16x16x32_bf16 v[208:211], a[60:63], a[240:243], v[208:211]
    ds_write_b64 v238, v[188:189] offset:6144
    v_mfma_f32_16x16x32_bf16 v[204:207], a[52:55], a[236:239], v[204:207]
    v_max3_f32 v248, v248, v162, v163
    v_max3_f32 v249, v249, v164, v165
    v_mfma_f32_16x16x32_bf16 v[204:207], a[64:67], a[240:243], v[204:207]
    v_max3_f32 v248, v248, v166, v167
    v_max3_f32 v249, v249, v168, v169
    v_mfma_f32_16x16x32_bf16 v[200:203], a[56:59], a[236:239], v[200:203]
    v_cvt_pk_bf16_f32 v24, v208, v209
    v_cvt_pk_bf16_f32 v25, v210, v211
    v_mfma_f32_16x16x32_bf16 v[200:203], a[68:71], a[240:243], v[200:203]
    v_max3_f32 v248, v248, v170, v171
    v_mfma_f32_16x16x32_bf16 v[220:223], a[236:239], a[120:123], v[220:223]
    v_cvt_pk_bf16_f32 v26, v204, v205
    v_cvt_pk_bf16_f32 v27, v206, v207
    v_mfma_f32_16x16x32_bf16 v[220:223], a[240:243], a[132:135], v[220:223]
    v_mfma_f32_16x16x32_bf16 v[216:219], a[236:239], a[124:127], v[216:219]
    v_mfma_f32_16x16x32_bf16 v[216:219], a[240:243], a[136:139], v[216:219]
    s_waitcnt lgkmcnt(2)
    v_mfma_f32_16x16x32_bf16 v[172:175], v[24:27], v[132:135], v[172:175]
    s_waitcnt vmcnt(3) lgkmcnt(0)
    v_cvt_pk_bf16_f32 v28, v200, v201
    v_cvt_pk_bf16_f32 v29, v202, v203
    v_mfma_f32_16x16x32_bf16 v[212:215], a[236:239], a[128:131], v[212:215]
    s_barrier
    ds_read_b128 a[236:239], v225 offset:43200
    v_cvt_pk_bf16_f32 v68, v220, v221
    v_mfma_f32_16x16x32_bf16 v[212:215], a[240:243], a[140:143], v[212:215]
    v_cvt_pk_bf16_f32 v69, v222, v223
    v_cvt_pk_bf16_f32 v90, v216, v217
    v_mfma_f32_16x16x16_bf16 v[172:175], v[28:29], v[136:137], v[172:175]
    ds_read_b128 a[240:243], v225 offset:43264
    v_cvt_pk_bf16_f32 v91, v218, v219
    v_mfma_f32_16x16x32_bf16 v[208:211], a[144:147], a[244:247], 0
    v_cndmask_b32 v225, v243, v245, vcc
    v_mfma_f32_16x16x32_bf16 v[208:211], a[156:159], a[248:251], v[208:211]
    v_cvt_pk_bf16_f32 v112, v212, v213
    v_cvt_pk_bf16_f32 v113, v214, v215
    v_mfma_f32_16x16x32_bf16 v[204:207], a[148:151], a[244:247], 0
    v_max3_f32 v249, v249, v172, v173
    v_max3_f32 v248, v248, v174, v175
    v_mfma_f32_16x16x32_bf16 v[204:207], a[160:163], a[248:251], v[204:207]
    v_max_f32 v248, v248, v249
    v_mov_b32 v249, v248
    v_mfma_f32_16x16x32_bf16 v[200:203], a[152:155], a[244:247], 0
    ds_read_b128 a[244:247], v226 offset:1152
    v_mfma_f32_16x16x32_bf16 v[200:203], a[164:167], a[248:251], v[200:203]
    ds_read_b128 a[248:251], v226 offset:1216
    v_mfma_f32_16x16x32_bf16 v[208:211], a[168:171], a[252:255], v[208:211]
    v_permlane16_swap_b32 v248, v249
    v_mfma_f32_16x16x32_bf16 v[208:211], a[180:183], v[252:255], v[208:211]
    v_max_f32 v248, v248, v249
    v_mov_b32 v249, v248
    v_mfma_f32_16x16x32_bf16 v[204:207], a[172:175], a[252:255], v[204:207]
    v_mfma_f32_16x16x32_bf16 v[204:207], a[184:187], v[252:255], v[204:207]
    v_permlane32_swap_b32 v248, v249
    v_mfma_f32_16x16x32_bf16 v[200:203], a[176:179], a[252:255], v[200:203]
    ds_read_b128 a[252:255], v226 offset:1280
    v_max_f32 v248, v248, v249
    v_mfma_f32_16x16x32_bf16 v[200:203], a[188:191], v[252:255], v[200:203]
    s_waitcnt lgkmcnt(3)
    ds_read_b128 v[252:255], v226 offset:1344
    v_mul_f32 v236, s37, v248
    v_mfma_f32_16x16x32_bf16 v[208:211], a[192:195], a[236:239], v[208:211]
    v_fma_f32 v144, v144, s37, -v236
    v_fma_f32 v145, v145, s37, -v236
    v_mfma_f32_16x16x32_bf16 v[208:211], a[204:207], a[240:243], v[208:211]
    v_fma_f32 v146, v146, s37, -v236
    v_fma_f32 v147, v147, s37, -v236
    v_mfma_f32_16x16x32_bf16 v[204:207], a[196:199], a[236:239], v[204:207]
    v_exp_f32 v144, v144
    v_mfma_f32_16x16x32_bf16 v[204:207], a[208:211], a[240:243], v[204:207]
    v_exp_f32 v145, v145
    v_mfma_f32_16x16x32_bf16 v[200:203], a[200:203], a[236:239], v[200:203]
    ds_read_b128 a[236:239], v226 offset:1408
    v_cvt_pk_bf16_f32 v138, v208, v209
    v_mfma_f32_16x16x32_bf16 v[200:203], a[212:215], a[240:243], v[200:203]
    s_waitcnt lgkmcnt(3)
    ds_read_b128 a[240:243], v226 offset:1472
    v_cvt_pk_bf16_f32 v139, v210, v211
    v_mfma_f32_16x16x32_bf16 v[220:223], a[144:147], a[244:247], 0
    v_cvt_pk_bf16_f32 v140, v204, v205
    v_cvt_pk_bf16_f32 v141, v206, v207
    v_mfma_f32_16x16x32_bf16 v[220:223], a[156:159], a[248:251], v[220:223]
    v_exp_f32 v146, v146
    v_mfma_f32_16x16x32_bf16 v[216:219], a[148:151], a[244:247], 0
    v_cvt_pk_bf16_f32 v142, v200, v201
    v_cvt_pk_bf16_f32 v143, v202, v203
    v_mfma_f32_16x16x32_bf16 v[216:219], a[160:163], a[248:251], v[216:219]
    v_exp_f32 v147, v147
    v_mfma_f32_16x16x32_bf16 v[212:215], a[152:155], a[244:247], 0
    ds_read_b128 a[244:247], v227 offset:6144
    v_cvt_pk_bf16_f32 v176, v144, v145
    v_mfma_f32_16x16x32_bf16 v[212:215], a[164:167], a[248:251], v[212:215]
    s_waitcnt lgkmcnt(3)
    ds_read_b128 a[248:251], v227 offset:6208
    v_cvt_pk_bf16_f32 v177, v146, v147
    v_mfma_f32_16x16x32_bf16 v[220:223], a[168:171], a[252:255], v[220:223]
    ds_read_b128 v[144:147], v230 offset:2560
    v_fma_f32 v148, v148, s37, -v236
    v_mfma_f32_16x16x32_bf16 v[220:223], a[180:183], v[252:255], v[220:223]
    v_fma_f32 v149, v149, s37, -v236
    v_fma_f32 v150, v150, s37, -v236
    v_mfma_f32_16x16x32_bf16 v[216:219], a[172:175], a[252:255], v[216:219]
    v_fma_f32 v151, v151, s37, -v236
    v_fma_f32 v152, v152, s37, -v236
    v_mfma_f32_16x16x32_bf16 v[216:219], a[184:187], v[252:255], v[216:219]
    v_exp_f32 v148, v148
    v_mfma_f32_16x16x32_bf16 v[212:215], a[176:179], a[252:255], v[212:215]
    ds_read_b128 a[252:255], v227 offset:6272
    v_fma_f32 v153, v153, s37, -v236
    v_mfma_f32_16x16x32_bf16 v[212:215], a[188:191], v[252:255], v[212:215]
    s_waitcnt lgkmcnt(4)
    ds_read_b128 v[252:255], v227 offset:6336
    v_fma_f32 v154, v154, s37, -v236
    v_mfma_f32_16x16x32_bf16 v[220:223], a[192:195], a[236:239], v[220:223]
    v_exp_f32 v149, v149
    v_mfma_f32_16x16x32_bf16 v[220:223], a[204:207], a[240:243], v[220:223]
    s_waitcnt lgkmcnt(2)
    v_exp_f32 v150, v150
    v_mfma_f32_16x16x32_bf16 v[144:147], v[24:27], v[138:141], v[144:147]
    v_exp_f32 v151, v151
    v_mfma_f32_16x16x32_bf16 v[216:219], a[196:199], a[236:239], v[216:219]
    v_cvt_pk_bf16_f32 v178, v148, v149
    v_cvt_pk_bf16_f32 v179, v150, v151
    v_mfma_f32_16x16x32_bf16 v[216:219], a[208:211], a[240:243], v[216:219]
    ds_read_b128 v[148:151], v230 offset:640
    v_cvt_pk_bf16_f32 v132, v220, v221
    v_mfma_f32_16x16x32_bf16 v[196:199], a[216:219], v[176:179], 0
    v_cvt_pk_bf16_f32 v133, v222, v223
    v_fma_f32 v155, v155, s37, -v236
    v_mfma_f32_16x16x32_bf16 v[184:187], v[70:73], v[176:179], 0
    v_exp_f32 v152, v152
    v_mfma_f32_16x16x32_bf16 v[188:191], v[92:95], v[176:179], 0
    v_cvt_pk_bf16_f32 v134, v216, v217
    v_cvt_pk_bf16_f32 v135, v218, v219
    v_mfma_f32_16x16x32_bf16 v[192:195], v[114:117], v[176:179], 0
    v_exp_f32 v153, v153
    v_mfma_f32_16x16x16_bf16 v[144:147], v[28:29], v[142:143], v[144:147]
    v_exp_f32 v154, v154
    v_mfma_f32_16x16x32_bf16 v[212:215], a[200:203], a[236:239], v[212:215]
    ds_read_b128 a[236:239], v227 offset:6400
    v_cvt_pk_bf16_f32 v180, v152, v153
    v_mfma_f32_16x16x32_bf16 v[212:215], a[212:215], a[240:243], v[212:215]
    s_waitcnt lgkmcnt(1)
    ds_read_b128 a[240:243], v227 offset:6464
    v_cndmask_b32 v227, v240, v239, vcc
    v_mfma_f32_16x16x32_bf16 v[148:151], v[30:33], v[138:141], v[148:151]
    v_exp_f32 v155, v155
    v_mfma_f32_16x16x32_bf16 v[208:211], a[0:3], a[244:247], 0
    v_cvt_pk_bf16_f32 v181, v154, v155
    v_fma_f32 v156, v156, s37, -v236
    v_mfma_f32_16x16x32_bf16 v[208:211], a[12:15], a[248:251], v[208:211]
    v_cvt_pk_bf16_f32 v136, v212, v213
    v_cvt_pk_bf16_f32 v137, v214, v215
    v_mfma_f32_16x16x16_bf16 v[148:151], v[34:35], v[142:143], v[148:151]
    ds_read_b128 v[152:155], v230 offset:1280
    v_fma_f32 v157, v157, s37, -v236
    v_mfma_f32_16x16x32_bf16 v[204:207], a[4:7], a[244:247], 0
    v_fma_f32 v158, v158, s37, -v236
    v_fma_f32 v159, v159, s37, -v236
    v_mfma_f32_16x16x32_bf16 v[204:207], a[16:19], a[248:251], v[204:207]
    v_exp_f32 v156, v156
    v_mfma_f32_16x16x32_bf16 v[200:203], a[8:11], a[244:247], 0
    v_exp_f32 v157, v157
    v_mfma_f32_16x16x32_bf16 v[200:203], a[20:23], a[248:251], v[200:203]
    v_exp_f32 v158, v158
    v_mfma_f32_16x16x32_bf16 v[220:223], a[244:247], a[72:75], 0
    v_exp_f32 v159, v159
    v_mfma_f32_16x16x32_bf16 v[220:223], a[248:251], a[84:87], v[220:223]
    v_cvt_pk_bf16_f32 v182, v156, v157
    v_cvt_pk_bf16_f32 v183, v158, v159
    v_mfma_f32_16x16x32_bf16 v[216:219], a[244:247], a[76:79], 0
    ds_read_b128 v[156:159], v230 offset:1920
    v_fma_f32 v160, v160, s37, -v236
    v_mfma_f32_16x16x32_bf16 v[216:219], a[248:251], a[88:91], v[216:219]
    v_fma_f32 v161, v161, s37, -v236
    v_fma_f32 v162, v162, s37, -v236
    v_mfma_f32_16x16x32_bf16 v[196:199], a[216:219], v[180:183], v[196:199]
    v_fma_f32 v163, v163, s37, -v236
    v_fma_f32 v164, v164, s37, -v236
    v_mfma_f32_16x16x32_bf16 v[184:187], v[74:77], v[180:183], v[184:187]
    v_exp_f32 v160, v160
    v_mfma_f32_16x16x32_bf16 v[188:191], v[96:99], v[180:183], v[188:191]
    v_exp_f32 v161, v161
    v_mfma_f32_16x16x32_bf16 v[192:195], v[118:121], v[180:183], v[192:195]
    s_waitcnt lgkmcnt(1)
    v_exp_f32 v162, v162
    v_mfma_f32_16x16x32_bf16 v[152:155], v[36:39], v[138:141], v[152:155]
    v_exp_f32 v163, v163
    v_mfma_f32_16x16x32_bf16 v[212:215], a[244:247], a[80:83], 0
    ds_read_b128 a[244:247], v239
    v_cvt_pk_bf16_f32 v176, v160, v161
    v_mfma_f32_16x16x32_bf16 v[212:215], a[248:251], a[92:95], v[212:215]
    ds_read_b128 a[248:251], v240
    v_cvt_pk_bf16_f32 v177, v162, v163
    v_mfma_f32_16x16x16_bf16 v[152:155], v[40:41], v[142:143], v[152:155]
    s_waitcnt lgkmcnt(2)
    ds_read_b128 v[160:163], v234
    v_bfe_u32 v234, s69, v233, 4
    v_mfma_f32_16x16x32_bf16 v[156:159], v[42:45], v[138:141], v[156:159]
    v_mad_u32_u24 v234, v234, s40, v231
    v_fma_f32 v165, v165, s37, -v236
    v_mfma_f32_16x16x32_bf16 v[208:211], a[24:27], a[252:255], v[208:211]
    v_fma_f32 v166, v166, s37, -v236
    v_fma_f32 v167, v167, s37, -v236
    v_mfma_f32_16x16x32_bf16 v[208:211], a[36:39], v[252:255], v[208:211]
    v_exp_f32 v164, v164
    v_mfma_f32_16x16x16_bf16 v[156:159], v[46:47], v[142:143], v[156:159]
    v_exp_f32 v165, v165
    v_mfma_f32_16x16x32_bf16 v[204:207], a[28:31], a[252:255], v[204:207]
    v_exp_f32 v166, v166
    v_mfma_f32_16x16x32_bf16 v[204:207], a[40:43], v[252:255], v[204:207]
    v_exp_f32 v167, v167
    v_mfma_f32_16x16x32_bf16 v[200:203], a[32:35], a[252:255], v[200:203]
    v_cvt_pk_bf16_f32 v178, v164, v165
    v_cvt_pk_bf16_f32 v179, v166, v167
    v_mfma_f32_16x16x32_bf16 v[200:203], a[44:47], v[252:255], v[200:203]
    ds_read_b128 v[164:167], v235
    v_bfe_u32 v235, s70, v233, 4
    v_mfma_f32_16x16x32_bf16 v[196:199], a[216:219], v[176:179], v[196:199]
    v_mad_u32_u24 v235, v235, s40, v231
    v_fma_f32 v168, v168, s37, -v236
    v_mfma_f32_16x16x32_bf16 v[184:187], v[78:81], v[176:179], v[184:187]
    v_fma_f32 v169, v169, s37, -v236
    v_fma_f32 v170, v170, s37, -v236
    v_mfma_f32_16x16x32_bf16 v[188:191], v[100:103], v[176:179], v[188:191]
    v_fma_f32 v171, v171, s37, -v236
    v_fma_f32 v172, v172, s37, -v236
    v_mfma_f32_16x16x32_bf16 v[192:195], v[122:125], v[176:179], v[192:195]
    s_waitcnt lgkmcnt(1)
    v_exp_f32 v168, v168
    v_mfma_f32_16x16x32_bf16 v[160:163], v[48:51], v[138:141], v[160:163]
    v_exp_f32 v169, v169
    v_mfma_f32_16x16x32_bf16 v[220:223], a[252:255], a[96:99], v[220:223]
    v_exp_f32 v170, v170
    v_mfma_f32_16x16x32_bf16 v[220:223], v[252:255], a[108:111], v[220:223]
    v_exp_f32 v171, v171
    v_mfma_f32_16x16x32_bf16 v[216:219], a[252:255], a[100:103], v[216:219]
    v_cvt_pk_bf16_f32 v180, v168, v169
    v_cvt_pk_bf16_f32 v181, v170, v171
    v_mfma_f32_16x16x32_bf16 v[216:219], v[252:255], a[112:115], v[216:219]
    ds_read_b128 v[168:171], v250
    v_fma_f32 v173, v173, s37, -v236
    v_mfma_f32_16x16x16_bf16 v[160:163], v[52:53], v[142:143], v[160:163]
    v_fma_f32 v174, v174, s37, -v236
    v_fma_f32 v175, v175, s37, -v236
    v_mfma_f32_16x16x32_bf16 v[212:215], a[252:255], a[104:107], v[212:215]
    ds_read_b128 a[252:255], v239 offset:1024
    v_max3_f32 v248, v144, v145, v146
    v_mfma_f32_16x16x32_bf16 v[212:215], v[252:255], a[116:119], v[212:215]
    ds_read_b128 v[252:255], v240 offset:1024
    v_max3_f32 v249, v147, v148, v149
    v_mfma_f32_16x16x32_bf16 v[208:211], a[48:51], a[236:239], v[208:211]
    v_exp_f32 v172, v172
    v_mfma_f32_16x16x32_bf16 v[208:211], a[60:63], a[240:243], v[208:211]
    v_exp_f32 v173, v173
    v_mfma_f32_16x16x32_bf16 v[204:207], a[52:55], a[236:239], v[204:207]
    v_exp_f32 v174, v174
    v_mfma_f32_16x16x32_bf16 v[204:207], a[64:67], a[240:243], v[204:207]
    s_waitcnt lgkmcnt(2)
    v_exp_f32 v175, v175
    v_mfma_f32_16x16x32_bf16 v[168:171], v[60:63], v[138:141], v[168:171]
    v_cvt_pk_bf16_f32 v182, v172, v173
    v_cvt_pk_bf16_f32 v183, v174, v175
    v_mfma_f32_16x16x32_bf16 v[200:203], a[56:59], a[236:239], v[200:203]
    v_cvt_pk_bf16_f32 v54, v208, v209
    v_cvt_pk_bf16_f32 v55, v210, v211
    v_mfma_f32_16x16x32_bf16 v[200:203], a[68:71], a[240:243], v[200:203]
    v_cvt_pk_bf16_f32 v56, v204, v205
    v_cvt_pk_bf16_f32 v57, v206, v207
    v_mfma_f32_16x16x32_bf16 v[196:199], a[216:219], v[180:183], v[196:199]
    ds_read_b128 v[172:175], v228 offset:640
    v_max3_f32 v248, v248, v150, v151
    v_mfma_f32_16x16x32_bf16 v[184:187], v[66:69], v[180:183], v[184:187]
    v_max3_f32 v249, v249, v152, v153
    v_max3_f32 v248, v248, v154, v155
    v_mfma_f32_16x16x32_bf16 v[188:191], v[88:91], v[180:183], v[188:191]
    v_cvt_pk_bf16_f32 v58, v200, v201
    v_cvt_pk_bf16_f32 v59, v202, v203
    v_mfma_f32_16x16x32_bf16 v[192:195], v[110:113], v[180:183], v[192:195]
    v_rcp_f32 v197, v196
    v_mfma_f32_16x16x32_bf16 v[164:167], v[54:57], v[138:141], v[164:167]
    v_mul_f32 v184, v184, v197
    v_mul_f32 v185, v185, v197
    v_mfma_f32_16x16x16_bf16 v[168:171], v[64:65], v[142:143], v[168:171]
    v_cvt_pk_bf16_f32 v184, v184, v185
    v_mul_f32 v186, v186, v197
    v_mfma_f32_16x16x32_bf16 v[220:223], a[236:239], a[120:123], v[220:223]
    v_mul_f32 v187, v187, v197
    v_cvt_pk_bf16_f32 v185, v186, v187
    v_mfma_f32_16x16x32_bf16 v[220:223], a[240:243], a[132:135], v[220:223]
    v_mul_f32 v188, v188, v197
    v_mul_f32 v189, v189, v197
    v_mfma_f32_16x16x16_bf16 v[164:167], v[58:59], v[142:143], v[164:167]
    s_waitcnt lgkmcnt(0)
    v_cvt_pk_bf16_f32 v186, v188, v189
    v_mul_f32 v190, v190, v197
    v_mfma_f32_16x16x32_bf16 v[172:175], v[12:15], v[132:135], v[172:175]
    v_mul_f32 v191, v191, v197
    v_cvt_pk_bf16_f32 v187, v190, v191
    v_mfma_f32_16x16x32_bf16 v[216:219], a[236:239], a[124:127], v[216:219]
    v_cvt_pk_bf16_f32 v84, v220, v221
    v_cvt_pk_bf16_f32 v85, v222, v223
    v_mfma_f32_16x16x32_bf16 v[216:219], a[240:243], a[136:139], v[216:219]
    v_mul_f32 v192, v192, v197
    v_mul_f32 v193, v193, v197
    v_mfma_f32_16x16x16_bf16 v[172:175], v[16:17], v[136:137], v[172:175]
    v_cvt_pk_bf16_f32 v188, v192, v193
    v_mul_f32 v194, v194, v197
    v_mfma_f32_16x16x32_bf16 v[212:215], a[236:239], a[128:131], v[212:215]
    ds_read_b128 a[236:239], v241 offset:12288
    v_mul_f32 v195, v195, v197
    v_mfma_f32_16x16x32_bf16 v[212:215], a[240:243], a[140:143], v[212:215]
    v_cvt_pk_bf16_f32 v106, v216, v217
    v_cvt_pk_bf16_f32 v107, v218, v219
    v_mfma_f32_16x16x32_bf16 v[208:211], a[220:223], a[244:247], 0
    ds_read_b128 a[240:243], v241 offset:12800
    v_cvt_pk_bf16_f32 v189, v194, v195
    v_mfma_f32_16x16x32_bf16 v[200:203], a[220:223], a[248:251], 0
    ds_write_b128 v237, v[184:187] offset:12288
    v_mfma_f32_16x16x32_bf16 v[204:207], a[224:227], a[244:247], 0
    v_cvt_pk_bf16_f32 v128, v212, v213
    v_cvt_pk_bf16_f32 v129, v214, v215
    v_mfma_f32_16x16x32_bf16 v[220:223], a[224:227], a[248:251], 0
    ds_write_b64 v238, v[188:189] offset:12288
    v_mfma_f32_16x16x32_bf16 v[216:219], a[228:231], a[244:247], 0
    v_max3_f32 v249, v249, v156, v157
    v_max3_f32 v248, v248, v158, v159
    v_mfma_f32_16x16x32_bf16 v[212:215], a[232:235], a[244:247], 0
    s_waitcnt lgkmcnt(3)
    v_max3_f32 v249, v249, v160, v161
    v_max3_f32 v248, v248, v162, v163
    v_mfma_f32_16x16x32_bf16 v[208:211], a[236:239], a[252:255], v[208:211]
    ds_read_b128 a[244:247], v242 offset:12288
    ds_read_b128 a[248:251], v242 offset:12800
    v_mfma_f32_16x16x32_bf16 v[200:203], a[236:239], v[252:255], v[200:203]
    s_waitcnt lgkmcnt(4)
    ds_read_b128 a[236:239], v241 offset:24576
    v_max3_f32 v249, v249, v164, v165
    v_mfma_f32_16x16x32_bf16 v[204:207], a[240:243], a[252:255], v[204:207]
    v_max3_f32 v248, v248, v166, v167
    v_max3_f32 v249, v249, v168, v169
    v_mfma_f32_16x16x32_bf16 v[220:223], a[240:243], v[252:255], v[220:223]
    s_waitcnt lgkmcnt(2)
    ds_read_b128 v[252:255], v240 offset:2048
    ds_read_b128 a[240:243], v241 offset:25088
    v_max3_f32 v248, v248, v170, v171
    v_max_f32 v248, v248, v249
    v_mov_b32 v249, v248
    s_nop 1
    v_permlane16_swap_b32 v248, v249
    v_max_f32 v248, v248, v249
    v_mov_b32 v249, v248
    s_nop 1
    v_permlane32_swap_b32 v248, v249
    v_mfma_f32_16x16x32_bf16 v[216:219], a[244:247], a[252:255], v[216:219]
    s_waitcnt lgkmcnt(3)
    ds_read_b128 a[244:247], v242 offset:24576
    v_max_f32 v248, v248, v249
    v_mfma_f32_16x16x32_bf16 v[212:215], a[248:251], a[252:255], v[212:215]
    s_waitcnt lgkmcnt(2)
    ds_read_b128 a[252:255], v239 offset:2048
    ds_read_b128 a[248:251], v242 offset:25088
    v_mul_f32 v236, s37, v248
    v_fma_f32 v144, v144, s37, -v236
    v_fma_f32 v145, v145, s37, -v236
    v_mfma_f32_16x16x32_bf16 v[200:203], a[236:239], v[252:255], v[200:203]
    s_waitcnt lgkmcnt(3)
    v_fma_f32 v146, v146, s37, -v236
    v_fma_f32 v147, v147, s37, -v236
    v_mfma_f32_16x16x32_bf16 v[220:223], a[240:243], v[252:255], v[220:223]
    s_waitcnt lgkmcnt(1)
    ds_read_b128 v[252:255], v240 offset:3072
    v_exp_f32 v144, v144
    v_exp_f32 v145, v145
    v_exp_f32 v146, v146
    v_exp_f32 v147, v147
    v_cvt_pk_bf16_f32 v176, v144, v145
    v_cvt_pk_bf16_f32 v177, v146, v147
    ds_read_b128 v[144:147], v229 offset:640
    v_fma_f32 v148, v148, s37, -v236
    v_mfma_f32_16x16x32_bf16 v[208:211], a[236:239], a[252:255], v[208:211]
    ds_read_b128 a[236:239], v241 offset:36864
    v_fma_f32 v149, v149, s37, -v236
    v_mfma_f32_16x16x32_bf16 v[204:207], a[240:243], a[252:255], v[204:207]
    ds_read_b128 a[240:243], v241 offset:37376
    v_fma_f32 v150, v150, s37, -v236
    v_mfma_f32_16x16x32_bf16 v[216:219], a[244:247], a[252:255], v[216:219]
    s_waitcnt lgkmcnt(4)
    ds_read_b128 a[244:247], v242 offset:36864
    v_fma_f32 v151, v151, s37, -v236
    v_mfma_f32_16x16x32_bf16 v[212:215], a[248:251], a[252:255], v[212:215]
    s_waitcnt lgkmcnt(3)
    ds_read_b128 a[252:255], v239 offset:3072
    v_exp_f32 v148, v148
    ds_read_b128 a[248:251], v242 offset:37376
    v_exp_f32 v149, v149
    v_exp_f32 v150, v150
    v_exp_f32 v151, v151
    v_mfma_f32_16x16x32_bf16 v[144:147], v[36:39], v[132:135], v[144:147]
    s_waitcnt lgkmcnt(4)
    v_cvt_pk_bf16_f32 v178, v148, v149
    v_cvt_pk_bf16_f32 v179, v150, v151
    v_mfma_f32_16x16x32_bf16 v[200:203], a[236:239], v[252:255], v[200:203]
    ds_read_b128 v[148:151], v229 offset:1280
    v_fma_f32 v152, v152, s37, -v236
    v_mfma_f32_16x16x32_bf16 v[196:199], a[216:219], v[176:179], 0
    v_fma_f32 v153, v153, s37, -v236
    v_fma_f32 v154, v154, s37, -v236
    v_mfma_f32_16x16x32_bf16 v[184:187], v[68:71], v[176:179], 0
    v_fma_f32 v155, v155, s37, -v236
    v_fma_f32 v156, v156, s37, -v236
    v_mfma_f32_16x16x32_bf16 v[188:191], v[90:93], v[176:179], 0
    v_exp_f32 v152, v152
    v_mfma_f32_16x16x32_bf16 v[192:195], v[112:115], v[176:179], 0
    v_exp_f32 v153, v153
    v_mfma_f32_16x16x16_bf16 v[144:147], v[40:41], v[136:137], v[144:147]
    s_waitcnt lgkmcnt(1)
    v_exp_f32 v154, v154
    v_mfma_f32_16x16x32_bf16 v[208:211], a[236:239], a[252:255], v[208:211]
    ds_read_b128 a[236:239], v241 offset:49152
    v_cvt_pk_bf16_f32 v180, v152, v153
    v_mfma_f32_16x16x32_bf16 v[204:207], a[240:243], a[252:255], v[204:207]
    s_waitcnt lgkmcnt(1)
    v_exp_f32 v155, v155
    v_mfma_f32_16x16x32_bf16 v[148:151], v[42:45], v[132:135], v[148:151]
    v_cvt_pk_bf16_f32 v181, v154, v155
    v_fma_f32 v157, v157, s37, -v236
    v_mfma_f32_16x16x32_bf16 v[220:223], a[240:243], v[252:255], v[220:223]
    ds_read_b128 v[252:255], v240 offset:4096
    ds_read_b128 a[240:243], v241 offset:49664
    v_mfma_f32_16x16x32_bf16 v[216:219], a[244:247], a[252:255], v[216:219]
    ds_read_b128 a[244:247], v242 offset:49152
    v_fma_f32 v158, v158, s37, -v236
    v_mfma_f32_16x16x16_bf16 v[148:151], v[46:47], v[136:137], v[148:151]
    ds_read_b128 v[152:155], v228 offset:1280
    v_fma_f32 v159, v159, s37, -v236
    v_mfma_f32_16x16x32_bf16 v[212:215], a[248:251], a[252:255], v[212:215]
    s_waitcnt lgkmcnt(3)
    v_exp_f32 v156, v156
    ds_read_b128 a[252:255], v239 offset:4096
    v_exp_f32 v157, v157
    ds_read_b128 a[248:251], v242 offset:49664
    v_exp_f32 v158, v158
    v_exp_f32 v159, v159
    v_mfma_f32_16x16x32_bf16 v[200:203], a[236:239], v[252:255], v[200:203]
    s_waitcnt lgkmcnt(4)
    v_cvt_pk_bf16_f32 v182, v156, v157
    v_cvt_pk_bf16_f32 v183, v158, v159
    v_mfma_f32_16x16x32_bf16 v[220:223], a[240:243], v[252:255], v[220:223]
    ds_read_b128 v[252:255], v240 offset:5120
    ds_read_b128 v[156:159], v228 offset:1920
    v_mfma_f32_16x16x32_bf16 v[196:199], a[216:219], v[180:183], v[196:199]
    v_fma_f32 v160, v160, s37, -v236
    v_fma_f32 v161, v161, s37, -v236
    v_mfma_f32_16x16x32_bf16 v[184:187], v[76:79], v[180:183], v[184:187]
    v_fma_f32 v162, v162, s37, -v236
    v_fma_f32 v163, v163, s37, -v236
    v_mfma_f32_16x16x32_bf16 v[188:191], v[98:101], v[180:183], v[188:191]
    v_exp_f32 v160, v160
    v_mfma_f32_16x16x32_bf16 v[192:195], v[120:123], v[180:183], v[192:195]
    s_waitcnt lgkmcnt(4)
    v_exp_f32 v161, v161
    v_mfma_f32_16x16x32_bf16 v[152:155], v[18:21], v[132:135], v[152:155]
    s_waitcnt lgkmcnt(3)
    v_exp_f32 v162, v162
    v_mfma_f32_16x16x32_bf16 v[208:211], a[236:239], a[252:255], v[208:211]
    ds_read_b128 a[236:239], v241 offset:61440
    v_cvt_pk_bf16_f32 v176, v160, v161
    v_mfma_f32_16x16x32_bf16 v[204:207], a[240:243], a[252:255], v[204:207]
    ds_read_b128 a[240:243], v241 offset:61952
    v_fma_f32 v164, v164, s37, -v236
    v_mfma_f32_16x16x16_bf16 v[152:155], v[22:23], v[136:137], v[152:155]
    s_waitcnt lgkmcnt(2)
    v_exp_f32 v163, v163
    v_mfma_f32_16x16x32_bf16 v[156:159], v[0:3], v[132:135], v[156:159]
    v_cvt_pk_bf16_f32 v177, v162, v163
    v_fma_f32 v165, v165, s37, -v236
    v_mfma_f32_16x16x32_bf16 v[216:219], a[244:247], a[252:255], v[216:219]
    ds_read_b128 a[244:247], v242 offset:61440
    ds_read_b128 v[160:163], v229 offset:1920
    v_mfma_f32_16x16x16_bf16 v[196:199], a[216:217], v[176:177], v[196:199]
    v_fma_f32 v166, v166, s37, -v236
    v_fma_f32 v167, v167, s37, -v236
    v_mfma_f32_16x16x16_bf16 v[184:187], v[82:83], v[176:177], v[184:187]
    v_exp_f32 v164, v164
    v_mfma_f32_16x16x16_bf16 v[188:191], v[104:105], v[176:177], v[188:191]
    v_exp_f32 v165, v165
    v_mfma_f32_16x16x16_bf16 v[192:195], v[126:127], v[176:177], v[192:195]
    v_exp_f32 v166, v166
    v_mfma_f32_16x16x16_bf16 v[156:159], v[4:5], v[136:137], v[156:159]
    v_exp_f32 v167, v167
    v_mfma_f32_16x16x32_bf16 v[212:215], a[248:251], a[252:255], v[212:215]
    s_waitcnt lgkmcnt(2)
    ds_read_b128 a[252:255], v239 offset:5120
    ds_read_b128 a[248:251], v242 offset:61952
    v_mfma_f32_16x16x32_bf16 v[200:203], a[236:239], v[252:255], v[200:203]
    v_cvt_pk_bf16_f32 v180, v164, v165
    v_cvt_pk_bf16_f32 v181, v166, v167
    v_mfma_f32_16x16x32_bf16 v[220:223], a[240:243], v[252:255], v[220:223]
    s_waitcnt lgkmcnt(2)
    ds_read_b128 v[252:255], v224 offset:15552
    ds_read_b128 v[164:167], v229 offset:2560
    v_mfma_f32_16x16x32_bf16 v[160:163], v[24:27], v[132:135], v[160:163]
    v_fma_f32 v168, v168, s37, -v236
    v_fma_f32 v169, v169, s37, -v236
    v_cvt_pk_bf16_f32 v200, v200, v201
    v_cvt_pk_bf16_f32 v201, v202, v203
    v_fma_f32 v170, v170, s37, -v236
    v_cvt_pk_bf16_f32 v202, v220, v221
    v_mfma_f32_16x16x16_bf16 v[160:163], v[28:29], v[136:137], v[160:163]
    s_waitcnt lgkmcnt(3)
    v_cvt_pk_bf16_f32 v203, v222, v223
    buffer_store_dwordx4 v[200:203], v245, s[20:23], s51 offen sc0 sc1
    v_mfma_f32_16x16x32_bf16 v[208:211], a[236:239], a[252:255], v[208:211]
    ds_read_b128 a[236:239], v224 offset:15616
    v_fma_f32 v171, v171, s37, -v236
    v_mfma_f32_16x16x32_bf16 v[204:207], a[240:243], a[252:255], v[204:207]
    ds_read_b128 a[240:243], v224 offset:15680
    v_max3_f32 v248, v172, v173, v174
    v_mfma_f32_16x16x32_bf16 v[216:219], a[244:247], a[252:255], v[216:219]
    s_waitcnt lgkmcnt(4)
    ds_read_b128 a[244:247], v224 offset:15744
    v_max3_f32 v249, v175, v144, v145
    v_mfma_f32_16x16x32_bf16 v[212:215], a[248:251], a[252:255], v[212:215]
    ds_read_b128 a[252:255], v224 offset:15488
    ds_read_b128 a[248:251], v224 offset:15808
    v_cvt_pk_bf16_f32 v208, v208, v209
    v_cvt_pk_bf16_f32 v209, v210, v211
    v_cvt_pk_bf16_f32 v210, v204, v205
    v_cvt_pk_bf16_f32 v211, v206, v207
    v_cvt_pk_bf16_f32 v216, v216, v217
    v_cvt_pk_bf16_f32 v217, v218, v219
    v_cvt_pk_bf16_f32 v218, v212, v213
    v_cvt_pk_bf16_f32 v219, v214, v215
    v_exp_f32 v168, v168
    v_exp_f32 v169, v169
    v_exp_f32 v170, v170
    v_exp_f32 v171, v171
    v_cvt_pk_bf16_f32 v182, v168, v169
    v_cvt_pk_bf16_f32 v183, v170, v171
    ds_read_b128 v[168:171], v228 offset:2560
    v_max3_f32 v248, v248, v146, v147
    v_mfma_f32_16x16x32_bf16 v[196:199], a[216:219], v[180:183], v[196:199]
    v_max3_f32 v249, v249, v148, v149
    v_max3_f32 v248, v248, v150, v151
    v_mfma_f32_16x16x32_bf16 v[184:187], v[84:87], v[180:183], v[184:187]
    buffer_store_dwordx4 v[208:211], v243, s[20:23], s51 offen sc0 sc1
    v_mfma_f32_16x16x32_bf16 v[188:191], v[106:109], v[180:183], v[188:191]
    v_max3_f32 v249, v249, v152, v153
    v_max3_f32 v248, v248, v154, v155
    v_mfma_f32_16x16x32_bf16 v[192:195], v[128:131], v[180:183], v[192:195]
    s_waitcnt lgkmcnt(1)
    v_rcp_f32 v197, v196
    v_mfma_f32_16x16x32_bf16 v[208:211], a[0:3], a[252:255], 0
    v_max3_f32 v249, v249, v156, v157
    v_mul_f32 v184, v184, v197
    v_mfma_f32_16x16x32_bf16 v[208:211], a[12:15], v[252:255], v[208:211]
    v_mul_f32 v185, v185, v197
    v_cvt_pk_bf16_f32 v184, v184, v185
    v_mfma_f32_16x16x32_bf16 v[204:207], a[4:7], a[252:255], 0
    v_mul_f32 v186, v186, v197
    v_mul_f32 v187, v187, v197
    v_mfma_f32_16x16x32_bf16 v[204:207], a[16:19], v[252:255], v[204:207]
    v_cvt_pk_bf16_f32 v185, v186, v187
    v_mul_f32 v188, v188, v197
    v_mfma_f32_16x16x32_bf16 v[200:203], a[8:11], a[252:255], 0
    v_mul_f32 v189, v189, v197
    v_cvt_pk_bf16_f32 v186, v188, v189
    v_mfma_f32_16x16x32_bf16 v[200:203], a[20:23], v[252:255], v[200:203]
    v_mul_f32 v190, v190, v197
    v_mul_f32 v191, v191, v197
    v_mfma_f32_16x16x32_bf16 v[220:223], a[252:255], a[72:75], 0
    v_cvt_pk_bf16_f32 v187, v190, v191
    v_mul_f32 v192, v192, v197
    v_mfma_f32_16x16x32_bf16 v[220:223], v[252:255], a[84:87], v[220:223]
    v_mul_f32 v193, v193, v197
    v_cvt_pk_bf16_f32 v188, v192, v193
    v_mfma_f32_16x16x32_bf16 v[212:215], a[252:255], a[80:83], 0
    v_mul_f32 v194, v194, v197
    v_mul_f32 v195, v195, v197
    v_mfma_f32_16x16x32_bf16 v[212:215], v[252:255], a[92:95], v[212:215]
    buffer_store_dwordx4 v[216:219], v244, s[20:23], s51 offen sc0 sc1
    v_mfma_f32_16x16x32_bf16 v[208:211], a[24:27], a[236:239], v[208:211]
    s_add_u32 s51, s51, s48
    v_cvt_pk_bf16_f32 v189, v194, v195
    v_max3_f32 v248, v248, v158, v159
    v_mfma_f32_16x16x32_bf16 v[208:211], a[36:39], a[240:243], v[208:211]
    ds_write_b128 v237, v[184:187] offset:18432
    v_mfma_f32_16x16x32_bf16 v[216:219], a[252:255], a[76:79], 0
    ds_write_b64 v238, v[188:189] offset:18432
    v_mfma_f32_16x16x32_bf16 v[216:219], v[252:255], a[88:91], v[216:219]
    v_max3_f32 v249, v249, v160, v161
    v_max3_f32 v248, v248, v162, v163
    v_mfma_f32_16x16x32_bf16 v[204:207], a[28:31], a[236:239], v[204:207]
    v_mfma_f32_16x16x32_bf16 v[204:207], a[40:43], a[240:243], v[204:207]
    v_mfma_f32_16x16x32_bf16 v[200:203], a[32:35], a[236:239], v[200:203]
    ds_read_b128 a[252:255], v224 offset:18560
    ds_read_b128 v[252:255], v224 offset:18624
    v_mfma_f32_16x16x32_bf16 v[200:203], a[44:47], a[240:243], v[200:203]
    v_mfma_f32_16x16x32_bf16 v[220:223], a[236:239], a[96:99], v[220:223]
    v_mfma_f32_16x16x32_bf16 v[220:223], a[240:243], a[108:111], v[220:223]
    v_mfma_f32_16x16x32_bf16 v[216:219], a[236:239], a[100:103], v[216:219]
    v_mfma_f32_16x16x32_bf16 v[216:219], a[240:243], a[112:115], v[216:219]
    s_waitcnt lgkmcnt(2)
    v_mfma_f32_16x16x32_bf16 v[212:215], a[236:239], a[104:107], v[212:215]
    s_barrier
    ds_read_b128 a[236:239], v224 offset:18688
    v_mfma_f32_16x16x32_bf16 v[212:215], a[240:243], a[116:119], v[212:215]
    ds_read_b128 a[240:243], v224 offset:18752
    v_mfma_f32_16x16x32_bf16 v[208:211], a[48:51], a[244:247], v[208:211]
    v_mfma_f32_16x16x32_bf16 v[208:211], a[60:63], a[248:251], v[208:211]
    v_mfma_f32_16x16x32_bf16 v[204:207], a[52:55], a[244:247], v[204:207]
    v_mfma_f32_16x16x32_bf16 v[204:207], a[64:67], a[248:251], v[204:207]
    v_mfma_f32_16x16x32_bf16 v[200:203], a[56:59], a[244:247], v[200:203]
    v_mfma_f32_16x16x32_bf16 v[200:203], a[68:71], a[248:251], v[200:203]
    v_mfma_f32_16x16x32_bf16 v[220:223], a[244:247], a[120:123], v[220:223]
    v_mfma_f32_16x16x32_bf16 v[220:223], a[248:251], a[132:135], v[220:223]
    v_mfma_f32_16x16x32_bf16 v[216:219], a[244:247], a[124:127], v[216:219]
    v_mfma_f32_16x16x32_bf16 v[216:219], a[248:251], a[136:139], v[216:219]
    v_cvt_pk_bf16_f32 v6, v208, v209
    v_cvt_pk_bf16_f32 v7, v210, v211
    v_mfma_f32_16x16x32_bf16 v[212:215], a[244:247], a[128:131], v[212:215]
    v_cvt_pk_bf16_f32 v8, v204, v205
    v_cvt_pk_bf16_f32 v9, v206, v207
    v_mfma_f32_16x16x32_bf16 v[212:215], a[248:251], a[140:143], v[212:215]
    v_cvt_pk_bf16_f32 v10, v200, v201
    v_cvt_pk_bf16_f32 v11, v202, v203
    v_mfma_f32_16x16x32_bf16 v[168:171], v[6:9], v[132:135], v[168:171]
    s_waitcnt lgkmcnt(0)
    v_cvt_pk_bf16_f32 v72, v220, v221
    v_cvt_pk_bf16_f32 v73, v222, v223
    v_mfma_f32_16x16x32_bf16 v[208:211], a[0:3], a[252:255], 0
    v_cvt_pk_bf16_f32 v94, v216, v217
    v_cvt_pk_bf16_f32 v95, v218, v219
    v_mfma_f32_16x16x32_bf16 v[208:211], a[12:15], v[252:255], v[208:211]
    v_cvt_pk_bf16_f32 v116, v212, v213
    v_cvt_pk_bf16_f32 v117, v214, v215
    v_mfma_f32_16x16x16_bf16 v[168:171], v[10:11], v[136:137], v[168:171]
    ds_read_b128 a[244:247], v224 offset:18816
    ds_read_b128 a[248:251], v224 offset:18880
    v_mfma_f32_16x16x32_bf16 v[204:207], a[4:7], a[252:255], 0
    ds_read_b128 a[0:3], v241 offset:12288
    v_cndmask_b32 v224, v239, v240, vcc
    v_mfma_f32_16x16x32_bf16 v[204:207], a[16:19], v[252:255], v[204:207]
    ds_read_b128 a[4:7], v241 offset:12800
    v_mfma_f32_16x16x32_bf16 v[200:203], a[8:11], a[252:255], 0
    ds_read_b128 a[8:11], v242 offset:12288
    v_mfma_f32_16x16x32_bf16 v[200:203], a[20:23], v[252:255], v[200:203]
    ds_read_b128 a[12:15], v242 offset:12800
    v_mfma_f32_16x16x32_bf16 v[220:223], a[252:255], a[72:75], 0
    ds_read_b128 a[16:19], v241 offset:24576
    v_mfma_f32_16x16x32_bf16 v[220:223], v[252:255], a[84:87], v[220:223]
    ds_read_b128 a[20:23], v241 offset:25088
    v_mfma_f32_16x16x32_bf16 v[216:219], a[252:255], a[76:79], 0
    v_mfma_f32_16x16x32_bf16 v[216:219], v[252:255], a[88:91], v[216:219]
    v_mfma_f32_16x16x32_bf16 v[212:215], a[252:255], a[80:83], 0
    ds_read_b128 a[252:255], v226 offset:4224
    v_mfma_f32_16x16x32_bf16 v[212:215], v[252:255], a[92:95], v[212:215]
    ds_read_b128 v[252:255], v226 offset:4288
    v_mfma_f32_16x16x32_bf16 v[208:211], a[24:27], a[236:239], v[208:211]
    ds_read_b128 a[24:27], v242 offset:24576
    v_mfma_f32_16x16x32_bf16 v[208:211], a[36:39], a[240:243], v[208:211]
    ds_read_b128 a[36:39], v241 offset:37376
    v_mfma_f32_16x16x32_bf16 v[204:207], a[28:31], a[236:239], v[204:207]
    ds_read_b128 a[28:31], v242 offset:25088
    v_mfma_f32_16x16x32_bf16 v[204:207], a[40:43], a[240:243], v[204:207]
    ds_read_b128 a[40:43], v242 offset:36864
    v_mfma_f32_16x16x32_bf16 v[200:203], a[32:35], a[236:239], v[200:203]
    ds_read_b128 a[32:35], v241 offset:36864
    v_mfma_f32_16x16x32_bf16 v[200:203], a[44:47], a[240:243], v[200:203]
    ds_read_b128 a[44:47], v242 offset:37376
    v_mfma_f32_16x16x32_bf16 v[220:223], a[236:239], a[96:99], v[220:223]
    v_mfma_f32_16x16x32_bf16 v[220:223], a[240:243], a[108:111], v[220:223]
    v_mfma_f32_16x16x32_bf16 v[216:219], a[236:239], a[100:103], v[216:219]
    v_mfma_f32_16x16x32_bf16 v[216:219], a[240:243], a[112:115], v[216:219]
    v_mfma_f32_16x16x32_bf16 v[212:215], a[236:239], a[104:107], v[212:215]
    ds_read_b128 a[236:239], v226 offset:4352
    v_mfma_f32_16x16x32_bf16 v[212:215], a[240:243], a[116:119], v[212:215]
    s_waitcnt lgkmcnt(3)
    ds_read_b128 a[240:243], v226 offset:4416
    v_mfma_f32_16x16x32_bf16 v[208:211], a[48:51], a[244:247], v[208:211]
    ds_read_b128 a[48:51], v241 offset:49152
    v_mfma_f32_16x16x32_bf16 v[208:211], a[60:63], a[248:251], v[208:211]
    ds_read_b128 a[60:63], v242 offset:49664
    v_mfma_f32_16x16x32_bf16 v[204:207], a[52:55], a[244:247], v[204:207]
    ds_read_b128 a[52:55], v241 offset:49664
    v_mfma_f32_16x16x32_bf16 v[204:207], a[64:67], a[248:251], v[204:207]
    ds_read_b128 a[64:67], v241 offset:61440
    v_mfma_f32_16x16x32_bf16 v[200:203], a[56:59], a[244:247], v[200:203]
    ds_read_b128 a[56:59], v242 offset:49152
    v_mfma_f32_16x16x32_bf16 v[200:203], a[68:71], a[248:251], v[200:203]
    v_cvt_pk_bf16_f32 v30, v208, v209
    v_cvt_pk_bf16_f32 v31, v210, v211
    v_mfma_f32_16x16x32_bf16 v[220:223], a[244:247], a[120:123], v[220:223]
    ds_read_b128 a[68:71], v241 offset:61952
    v_cvt_pk_bf16_f32 v32, v204, v205
    v_mfma_f32_16x16x32_bf16 v[220:223], a[248:251], a[132:135], v[220:223]
    v_cvt_pk_bf16_f32 v33, v206, v207
    v_mfma_f32_16x16x32_bf16 v[216:219], a[244:247], a[124:127], v[216:219]
    v_cvt_pk_bf16_f32 v34, v200, v201
    v_cvt_pk_bf16_f32 v35, v202, v203
    v_mfma_f32_16x16x32_bf16 v[216:219], a[248:251], a[136:139], v[216:219]
    v_mfma_f32_16x16x32_bf16 v[164:167], v[30:33], v[132:135], v[164:167]
    v_mfma_f32_16x16x32_bf16 v[212:215], a[244:247], a[128:131], v[212:215]
    ds_read_b128 a[244:247], v226 offset:4480
    v_cvt_pk_bf16_f32 v70, v220, v221
    v_mfma_f32_16x16x32_bf16 v[212:215], a[248:251], a[140:143], v[212:215]
    ds_read_b128 a[248:251], v226 offset:4544
    v_cvt_pk_bf16_f32 v71, v222, v223
    v_mfma_f32_16x16x16_bf16 v[164:167], v[34:35], v[136:137], v[164:167]
    v_cvt_pk_bf16_f32 v92, v216, v217
    v_cvt_pk_bf16_f32 v93, v218, v219
    v_mfma_f32_16x16x32_bf16 v[208:211], a[144:147], a[252:255], 0
    v_cndmask_b32 v226, v244, v247, vcc
    v_cndmask_b32 v247, v247, v244, vcc
    v_mfma_f32_16x16x32_bf16 v[208:211], a[156:159], v[252:255], v[208:211]
    v_cvt_pk_bf16_f32 v114, v212, v213
    v_cvt_pk_bf16_f32 v115, v214, v215
    v_mfma_f32_16x16x32_bf16 v[204:207], a[148:151], a[252:255], 0
    v_max3_f32 v249, v249, v164, v165
    v_max3_f32 v248, v248, v166, v167
    v_mfma_f32_16x16x32_bf16 v[204:207], a[160:163], v[252:255], v[204:207]
    v_max3_f32 v249, v249, v168, v169
    v_max3_f32 v248, v248, v170, v171
    v_mfma_f32_16x16x32_bf16 v[200:203], a[152:155], a[252:255], 0
    ds_read_b128 a[252:255], v239 offset:12288
    v_max_f32 v248, v248, v249
    v_mfma_f32_16x16x32_bf16 v[200:203], a[164:167], v[252:255], v[200:203]
    s_waitcnt lgkmcnt(2)
    ds_read_b128 v[252:255], v240 offset:12288
    v_mov_b32 v249, v248
    v_mfma_f32_16x16x32_bf16 v[208:211], a[168:171], a[236:239], v[208:211]
    v_mfma_f32_16x16x32_bf16 v[208:211], a[180:183], a[240:243], v[208:211]
    v_permlane16_swap_b32 v248, v249
    v_mfma_f32_16x16x32_bf16 v[204:207], a[172:175], a[236:239], v[204:207]
    v_max_f32 v248, v248, v249
    v_mov_b32 v249, v248
    v_mfma_f32_16x16x32_bf16 v[204:207], a[184:187], a[240:243], v[204:207]
    v_mfma_f32_16x16x32_bf16 v[200:203], a[176:179], a[236:239], v[200:203]
    ds_read_b128 a[236:239], v239 offset:13312
    v_mfma_f32_16x16x32_bf16 v[200:203], a[188:191], a[240:243], v[200:203]
    ds_read_b128 a[240:243], v240 offset:13312
    v_mfma_f32_16x16x32_bf16 v[208:211], a[192:195], a[244:247], v[208:211]
    s_waitcnt lgkmcnt(3)
    v_permlane32_swap_b32 v248, v249
    v_mfma_f32_16x16x32_bf16 v[208:211], a[204:207], a[248:251], v[208:211]
    v_max_f32 v248, v248, v249
    v_mul_f32 v236, s37, v248
    v_mfma_f32_16x16x32_bf16 v[204:207], a[196:199], a[244:247], v[204:207]
    v_fma_f32 v172, v172, s37, -v236
    v_fma_f32 v173, v173, s37, -v236
    v_mfma_f32_16x16x32_bf16 v[204:207], a[208:211], a[248:251], v[204:207]
    v_fma_f32 v174, v174, s37, -v236
    v_fma_f32 v175, v175, s37, -v236
    v_mfma_f32_16x16x32_bf16 v[200:203], a[200:203], a[244:247], v[200:203]
    v_cvt_pk_bf16_f32 v138, v208, v209
    v_cvt_pk_bf16_f32 v139, v210, v211
    v_mfma_f32_16x16x32_bf16 v[200:203], a[212:215], a[248:251], v[200:203]
    ds_read_b128 a[244:247], v239 offset:14336
    ds_read_b128 a[248:251], v240 offset:14336
    v_mfma_f32_16x16x32_bf16 v[220:223], a[220:223], a[252:255], 0
    s_waitcnt lgkmcnt(3)
    v_cvt_pk_bf16_f32 v140, v204, v205
    v_cvt_pk_bf16_f32 v141, v206, v207
    v_mfma_f32_16x16x32_bf16 v[212:215], a[220:223], v[252:255], 0
    v_exp_f32 v172, v172
    v_mfma_f32_16x16x32_bf16 v[216:219], a[224:227], a[252:255], 0
    v_cvt_pk_bf16_f32 v142, v200, v201
    v_cvt_pk_bf16_f32 v143, v202, v203
    v_mfma_f32_16x16x32_bf16 v[208:211], a[224:227], v[252:255], 0
    ds_read_b128 v[252:255], v240 offset:15360
    v_fma_f32 v144, v144, s37, -v236
    v_mfma_f32_16x16x32_bf16 v[204:207], a[228:231], a[252:255], 0
    v_exp_f32 v173, v173
    v_mfma_f32_16x16x32_bf16 v[200:203], a[232:235], a[252:255], 0
    ds_read_b128 a[252:255], v239 offset:15360
    v_cvt_pk_bf16_f32 v176, v172, v173
    v_mfma_f32_16x16x32_bf16 v[220:223], a[0:3], a[236:239], v[220:223]
    s_waitcnt lgkmcnt(4)
    v_exp_f32 v174, v174
    v_mfma_f32_16x16x32_bf16 v[212:215], a[0:3], a[240:243], v[212:215]
    v_exp_f32 v175, v175
    v_mfma_f32_16x16x32_bf16 v[216:219], a[4:7], a[236:239], v[216:219]
    v_cvt_pk_bf16_f32 v177, v174, v175
    v_fma_f32 v145, v145, s37, -v236
    v_mfma_f32_16x16x32_bf16 v[208:211], a[4:7], a[240:243], v[208:211]
    ds_read_b128 a[240:243], v240 offset:16384
    ds_read_b128 v[172:175], v230 offset:640
    v_mfma_f32_16x16x32_bf16 v[204:207], a[8:11], a[236:239], v[204:207]
    v_fma_f32 v146, v146, s37, -v236
    v_fma_f32 v147, v147, s37, -v236
    v_mfma_f32_16x16x32_bf16 v[200:203], a[12:15], a[236:239], v[200:203]
    s_waitcnt lgkmcnt(3)
    ds_read_b128 a[236:239], v239 offset:16384
    v_fma_f32 v148, v148, s37, -v236
    v_mfma_f32_16x16x32_bf16 v[220:223], a[16:19], a[244:247], v[220:223]
    v_exp_f32 v144, v144
    v_mfma_f32_16x16x32_bf16 v[212:215], a[16:19], a[248:251], v[212:215]
    v_exp_f32 v145, v145
    v_mfma_f32_16x16x32_bf16 v[216:219], a[20:23], a[244:247], v[216:219]
    v_exp_f32 v146, v146
    v_mfma_f32_16x16x32_bf16 v[208:211], a[20:23], a[248:251], v[208:211]
    ds_read_b128 a[248:251], v240 offset:17408
    v_cvt_pk_bf16_f32 v178, v144, v145
    v_mfma_f32_16x16x32_bf16 v[204:207], a[24:27], a[244:247], v[204:207]
    v_exp_f32 v147, v147
    v_mfma_f32_16x16x32_bf16 v[200:203], a[28:31], a[244:247], v[200:203]
    s_waitcnt lgkmcnt(2)
    ds_read_b128 a[244:247], v239 offset:17408
    v_cvt_pk_bf16_f32 v179, v146, v147
    v_mfma_f32_16x16x32_bf16 v[172:175], v[36:39], v[138:141], v[172:175]
    ds_read_b128 v[144:147], v230 offset:1280
    v_fma_f32 v149, v149, s37, -v236
    v_mfma_f32_16x16x32_bf16 v[196:199], a[216:219], v[176:179], 0
    v_fma_f32 v150, v150, s37, -v236
    v_fma_f32 v151, v151, s37, -v236
    v_mfma_f32_16x16x32_bf16 v[184:187], v[74:77], v[176:179], 0
    v_exp_f32 v148, v148
    v_mfma_f32_16x16x32_bf16 v[188:191], v[96:99], v[176:179], 0
    v_exp_f32 v149, v149
    v_mfma_f32_16x16x32_bf16 v[192:195], v[118:121], v[176:179], 0
    v_exp_f32 v150, v150
    v_mfma_f32_16x16x16_bf16 v[172:175], v[40:41], v[142:143], v[172:175]
    v_exp_f32 v151, v151
    v_mfma_f32_16x16x32_bf16 v[220:223], a[32:35], a[252:255], v[220:223]
    v_cvt_pk_bf16_f32 v180, v148, v149
    v_cvt_pk_bf16_f32 v181, v150, v151
    v_mfma_f32_16x16x32_bf16 v[212:215], a[32:35], v[252:255], v[212:215]
    s_waitcnt lgkmcnt(0)
    ds_read_b128 v[148:151], v230 offset:1920
    v_fma_f32 v152, v152, s37, -v236
    v_mfma_f32_16x16x32_bf16 v[144:147], v[42:45], v[138:141], v[144:147]
    v_fma_f32 v153, v153, s37, -v236
    v_fma_f32 v154, v154, s37, -v236
    v_mfma_f32_16x16x32_bf16 v[216:219], a[36:39], a[252:255], v[216:219]
    v_fma_f32 v155, v155, s37, -v236
    v_fma_f32 v156, v156, s37, -v236
    v_mfma_f32_16x16x32_bf16 v[208:211], a[36:39], v[252:255], v[208:211]
    ds_read_b128 v[252:255], v242 offset:61952
    v_fma_f32 v157, v157, s37, -v236
    v_mfma_f32_16x16x16_bf16 v[144:147], v[46:47], v[142:143], v[144:147]
    v_exp_f32 v152, v152
    v_mfma_f32_16x16x32_bf16 v[204:207], a[40:43], a[252:255], v[204:207]
    v_exp_f32 v153, v153
    v_mfma_f32_16x16x32_bf16 v[200:203], a[44:47], a[252:255], v[200:203]
    ds_read_b128 a[252:255], v242 offset:61440
    v_cvt_pk_bf16_f32 v182, v152, v153
    v_mfma_f32_16x16x32_bf16 v[220:223], a[48:51], a[236:239], v[220:223]
    s_waitcnt lgkmcnt(2)
    v_exp_f32 v154, v154
    v_mfma_f32_16x16x32_bf16 v[148:151], v[24:27], v[138:141], v[148:151]
    v_exp_f32 v155, v155
    v_mfma_f32_16x16x32_bf16 v[212:215], a[48:51], a[240:243], v[212:215]
    v_cvt_pk_bf16_f32 v183, v154, v155
    v_fma_f32 v158, v158, s37, -v236
    v_mfma_f32_16x16x32_bf16 v[216:219], a[52:55], a[236:239], v[216:219]
    ds_read_b128 v[152:155], v230 offset:2560
    v_fma_f32 v159, v159, s37, -v236
    v_mfma_f32_16x16x32_bf16 v[196:199], a[216:219], v[180:183], v[196:199]
    v_exp_f32 v156, v156
    v_mfma_f32_16x16x32_bf16 v[184:187], v[78:81], v[180:183], v[184:187]
    v_exp_f32 v157, v157
    v_mfma_f32_16x16x32_bf16 v[188:191], v[100:103], v[180:183], v[188:191]
    v_exp_f32 v158, v158
    v_mfma_f32_16x16x32_bf16 v[192:195], v[122:125], v[180:183], v[192:195]
    v_exp_f32 v159, v159
    v_mfma_f32_16x16x16_bf16 v[148:151], v[28:29], v[142:143], v[148:151]
    v_cvt_pk_bf16_f32 v176, v156, v157
    v_cvt_pk_bf16_f32 v177, v158, v159
    v_mfma_f32_16x16x32_bf16 v[208:211], a[52:55], a[240:243], v[208:211]
    ds_read_b128 v[156:159], v234
    v_fma_f32 v160, v160, s37, -v236
    v_mfma_f32_16x16x32_bf16 v[204:207], a[56:59], a[236:239], v[204:207]
    s_waitcnt lgkmcnt(1)
    v_fma_f32 v161, v161, s37, -v236
    v_fma_f32 v162, v162, s37, -v236
    v_mfma_f32_16x16x32_bf16 v[152:155], v[30:33], v[138:141], v[152:155]
    v_fma_f32 v163, v163, s37, -v236
    v_fma_f32 v164, v164, s37, -v236
    v_mfma_f32_16x16x32_bf16 v[200:203], a[60:63], a[236:239], v[200:203]
    v_exp_f32 v160, v160
    v_mfma_f32_16x16x32_bf16 v[220:223], a[64:67], a[244:247], v[220:223]
    v_exp_f32 v161, v161
    v_mfma_f32_16x16x16_bf16 v[152:155], v[34:35], v[142:143], v[152:155]
    v_exp_f32 v162, v162
    v_mfma_f32_16x16x32_bf16 v[212:215], a[64:67], a[248:251], v[212:215]
    v_exp_f32 v163, v163
    v_mfma_f32_16x16x32_bf16 v[216:219], a[68:71], a[244:247], v[216:219]
    s_waitcnt lgkmcnt(0)
    v_cvt_pk_bf16_f32 v178, v160, v161
    v_cvt_pk_bf16_f32 v179, v162, v163
    v_mfma_f32_16x16x32_bf16 v[156:159], v[48:51], v[138:141], v[156:159]
    ds_read_b128 v[160:163], v235
    v_cvt_pk_bf16_f32 v220, v220, v221
    v_mfma_f32_16x16x32_bf16 v[196:199], a[216:219], v[176:179], v[196:199]
    v_cvt_pk_bf16_f32 v221, v222, v223
    v_cvt_pk_bf16_f32 v212, v212, v213
    v_mfma_f32_16x16x32_bf16 v[184:187], v[66:69], v[176:179], v[184:187]
    v_cvt_pk_bf16_f32 v222, v216, v217
    v_cvt_pk_bf16_f32 v223, v218, v219
    v_mfma_f32_16x16x32_bf16 v[188:191], v[88:91], v[176:179], v[188:191]
    buffer_store_dwordx4 v[220:223], v243, s[20:23], s51 offen sc0 sc1
    v_mfma_f32_16x16x32_bf16 v[192:195], v[110:113], v[176:179], v[192:195]
    v_cvt_pk_bf16_f32 v213, v214, v215
    v_fma_f32 v165, v165, s37, -v236
    v_mfma_f32_16x16x16_bf16 v[156:159], v[52:53], v[142:143], v[156:159]
    v_fma_f32 v166, v166, s37, -v236
    v_fma_f32 v167, v167, s37, -v236
    v_mfma_f32_16x16x32_bf16 v[208:211], a[68:71], a[248:251], v[208:211]
    s_waitcnt lgkmcnt(0)
    v_exp_f32 v164, v164
    v_mfma_f32_16x16x32_bf16 v[160:163], v[54:57], v[138:141], v[160:163]
    v_exp_f32 v165, v165
    v_mfma_f32_16x16x32_bf16 v[204:207], a[252:255], a[244:247], v[204:207]
    v_exp_f32 v166, v166
    v_mfma_f32_16x16x32_bf16 v[200:203], v[252:255], a[244:247], v[200:203]
    v_exp_f32 v167, v167
    v_cvt_pk_bf16_f32 v180, v164, v165
    v_mfma_f32_16x16x16_bf16 v[160:163], v[58:59], v[142:143], v[160:163]
    v_cvt_pk_bf16_f32 v214, v208, v209
    v_cvt_pk_bf16_f32 v215, v210, v211
    v_cvt_pk_bf16_f32 v181, v166, v167
    v_cvt_pk_bf16_f32 v204, v204, v205
    v_cvt_pk_bf16_f32 v205, v206, v207
    v_cvt_pk_bf16_f32 v206, v200, v201
    v_cvt_pk_bf16_f32 v207, v202, v203
    v_fma_f32 v168, v168, s37, -v236
    v_fma_f32 v169, v169, s37, -v236
    v_fma_f32 v170, v170, s37, -v236
    v_fma_f32 v171, v171, s37, -v236
    v_exp_f32 v168, v168
    v_exp_f32 v169, v169
    v_exp_f32 v170, v170
    buffer_store_dwordx4 v[212:215], v245, s[20:23], s51 offen sc0 sc1
    v_exp_f32 v171, v171
    v_cvt_pk_bf16_f32 v182, v168, v169
    v_cvt_pk_bf16_f32 v183, v170, v171
    v_max3_f32 v248, v172, v173, v174
    v_max3_f32 v249, v175, v144, v145
    v_mfma_f32_16x16x32_bf16 v[196:199], a[216:219], v[180:183], v[196:199]
    v_max3_f32 v248, v248, v146, v147
    v_max3_f32 v249, v249, v148, v149
    v_mfma_f32_16x16x32_bf16 v[184:187], v[70:73], v[180:183], v[184:187]
    v_max3_f32 v248, v248, v150, v151
    v_max3_f32 v249, v249, v152, v153
    v_mfma_f32_16x16x32_bf16 v[188:191], v[92:95], v[180:183], v[188:191]
    v_max3_f32 v248, v248, v154, v155
    v_max3_f32 v249, v249, v156, v157
    v_mfma_f32_16x16x32_bf16 v[192:195], v[114:117], v[180:183], v[192:195]
    v_rcp_f32 v197, v196
    v_max3_f32 v248, v248, v158, v159
    v_mul_f32 v184, v184, v197
    v_mul_f32 v185, v185, v197
    v_cvt_pk_bf16_f32 v184, v184, v185
    v_mul_f32 v186, v186, v197
    v_mul_f32 v187, v187, v197
    v_cvt_pk_bf16_f32 v185, v186, v187
    v_mul_f32 v188, v188, v197
    v_mul_f32 v189, v189, v197
    v_cvt_pk_bf16_f32 v186, v188, v189
    v_mul_f32 v190, v190, v197
    v_mul_f32 v191, v191, v197
    v_cvt_pk_bf16_f32 v187, v190, v191
    v_mul_f32 v192, v192, v197
    v_mul_f32 v193, v193, v197
    v_cvt_pk_bf16_f32 v188, v192, v193
    v_mul_f32 v194, v194, v197
    v_mul_f32 v195, v195, v197
    v_cvt_pk_bf16_f32 v189, v194, v195
    ds_write_b128 v237, v[184:187]
    buffer_store_dwordx4 v[204:207], v244, s[20:23], s51 offen sc0 sc1
    ds_write_b64 v238, v[188:189]
    s_add_u32 s51, s51, s48
    v_max3_f32 v249, v249, v160, v161
    v_max3_f32 v248, v248, v162, v163
    v_max_f32 v248, v248, v249
    v_mov_b32 v249, v248
    s_nop 1
    v_permlane16_swap_b32 v248, v249
    v_max_f32 v248, v248, v249
    v_mov_b32 v249, v248
    s_nop 1
    v_permlane32_swap_b32 v248, v249
    v_max_f32 v248, v248, v249
    v_mul_f32 v236, s37, v248
    v_fma_f32 v172, v172, s37, -v236
    v_fma_f32 v173, v173, s37, -v236
    v_fma_f32 v174, v174, s37, -v236
    v_fma_f32 v175, v175, s37, -v236
    v_exp_f32 v172, v172
    v_exp_f32 v173, v173
    v_exp_f32 v174, v174
    v_exp_f32 v175, v175
    v_cvt_pk_bf16_f32 v176, v172, v173
    v_cvt_pk_bf16_f32 v177, v174, v175
    v_fma_f32 v144, v144, s37, -v236
    v_fma_f32 v145, v145, s37, -v236
    s_waitcnt lgkmcnt(0)
    s_barrier
    ds_read_b128 a[236:239], v224
    ds_read_b128 a[240:243], v224 offset:1024
    v_fma_f32 v146, v146, s37, -v236
    v_fma_f32 v147, v147, s37, -v236
    ds_read_b128 a[244:247], v224 offset:2048
    v_exp_f32 v144, v144
    ds_read_b128 a[248:251], v224 offset:3072
    ds_read_b128 a[252:255], v224 offset:4096
    v_exp_f32 v145, v145
    v_exp_f32 v146, v146
    ds_read_b128 v[252:255], v224 offset:5120
    v_exp_f32 v147, v147
    v_cvt_pk_bf16_f32 v178, v144, v145
    v_cvt_pk_bf16_f32 v179, v146, v147
    v_fma_f32 v148, v148, s37, -v236
    v_fma_f32 v149, v149, s37, -v236
    v_mfma_f32_16x16x32_bf16 v[196:199], a[216:219], v[176:179], 0
    v_fma_f32 v150, v150, s37, -v236
    v_fma_f32 v151, v151, s37, -v236
    v_mfma_f32_16x16x32_bf16 v[184:187], v[76:79], v[176:179], 0
    v_exp_f32 v148, v148
    v_mfma_f32_16x16x32_bf16 v[188:191], v[98:101], v[176:179], 0
    v_exp_f32 v149, v149
    v_mfma_f32_16x16x32_bf16 v[192:195], v[120:123], v[176:179], 0
    s_waitcnt lgkmcnt(3)
    v_exp_f32 v150, v150
    v_mfma_f32_16x16x32_bf16 v[220:223], a[220:223], a[236:239], 0
    v_exp_f32 v151, v151
    v_mfma_f32_16x16x32_bf16 v[216:219], a[224:227], a[236:239], 0
    v_cvt_pk_bf16_f32 v180, v148, v149
    v_cvt_pk_bf16_f32 v181, v150, v151
    v_mfma_f32_16x16x32_bf16 v[212:215], a[228:231], a[236:239], 0
    v_fma_f32 v152, v152, s37, -v236
    v_fma_f32 v153, v153, s37, -v236
    v_mfma_f32_16x16x32_bf16 v[208:211], a[232:235], a[236:239], 0
    ds_read_b128 a[236:239], v242 offset:61440
    v_fma_f32 v154, v154, s37, -v236
    v_mfma_f32_16x16x32_bf16 v[220:223], a[0:3], a[240:243], v[220:223]
    v_fma_f32 v155, v155, s37, -v236
    v_fma_f32 v156, v156, s37, -v236
    v_mfma_f32_16x16x32_bf16 v[216:219], a[4:7], a[240:243], v[216:219]
    v_exp_f32 v152, v152
    v_mfma_f32_16x16x32_bf16 v[212:215], a[8:11], a[240:243], v[212:215]
    v_exp_f32 v153, v153
    v_mfma_f32_16x16x32_bf16 v[208:211], a[12:15], a[240:243], v[208:211]
    ds_read_b128 a[240:243], v242 offset:61952
    v_cvt_pk_bf16_f32 v182, v152, v153
    v_mfma_f32_16x16x32_bf16 v[220:223], a[16:19], a[244:247], v[220:223]
    v_exp_f32 v154, v154
    v_mfma_f32_16x16x32_bf16 v[216:219], a[20:23], a[244:247], v[216:219]
    v_exp_f32 v155, v155
    v_mfma_f32_16x16x32_bf16 v[212:215], a[24:27], a[244:247], v[212:215]
    v_cvt_pk_bf16_f32 v183, v154, v155
    v_fma_f32 v157, v157, s37, -v236
    v_mfma_f32_16x16x32_bf16 v[208:211], a[28:31], a[244:247], v[208:211]
    v_fma_f32 v158, v158, s37, -v236
    v_fma_f32 v159, v159, s37, -v236
    v_mfma_f32_16x16x32_bf16 v[196:199], a[216:219], v[180:183], v[196:199]
    v_exp_f32 v156, v156
    v_mfma_f32_16x16x32_bf16 v[184:187], v[68:71], v[180:183], v[184:187]
    v_exp_f32 v157, v157
    v_mfma_f32_16x16x32_bf16 v[188:191], v[90:93], v[180:183], v[188:191]
    v_exp_f32 v158, v158
    v_mfma_f32_16x16x32_bf16 v[192:195], v[112:115], v[180:183], v[192:195]
    s_waitcnt lgkmcnt(0)
    v_exp_f32 v159, v159
    v_mfma_f32_16x16x32_bf16 v[220:223], a[32:35], a[248:251], v[220:223]
    v_cvt_pk_bf16_f32 v176, v156, v157
    v_cvt_pk_bf16_f32 v177, v158, v159
    v_mfma_f32_16x16x32_bf16 v[216:219], a[36:39], a[248:251], v[216:219]
    v_fma_f32 v160, v160, s37, -v236
    v_fma_f32 v161, v161, s37, -v236
    v_mfma_f32_16x16x32_bf16 v[212:215], a[40:43], a[248:251], v[212:215]
    v_fma_f32 v162, v162, s37, -v236
    v_fma_f32 v163, v163, s37, -v236
    v_mfma_f32_16x16x32_bf16 v[208:211], a[44:47], a[248:251], v[208:211]
    v_exp_f32 v160, v160
    v_mfma_f32_16x16x32_bf16 v[220:223], a[48:51], a[252:255], v[220:223]
    v_exp_f32 v161, v161
    v_mfma_f32_16x16x32_bf16 v[216:219], a[52:55], a[252:255], v[216:219]
    v_exp_f32 v162, v162
    v_mfma_f32_16x16x32_bf16 v[212:215], a[56:59], a[252:255], v[212:215]
    v_exp_f32 v163, v163
    v_mfma_f32_16x16x32_bf16 v[208:211], a[60:63], a[252:255], v[208:211]
    v_cvt_pk_bf16_f32 v178, v160, v161
    v_cvt_pk_bf16_f32 v179, v162, v163
    v_mfma_f32_16x16x32_bf16 v[220:223], a[64:67], v[252:255], v[220:223]
    v_mfma_f32_16x16x32_bf16 v[216:219], a[68:71], v[252:255], v[216:219]
    v_mfma_f32_16x16x32_bf16 v[196:199], a[216:219], v[176:179], v[196:199]
    v_mfma_f32_16x16x32_bf16 v[184:187], v[82:85], v[176:179], v[184:187]
    v_mfma_f32_16x16x32_bf16 v[188:191], v[104:107], v[176:179], v[188:191]
    v_mfma_f32_16x16x32_bf16 v[192:195], v[126:129], v[176:179], v[192:195]
    v_mfma_f32_16x16x32_bf16 v[212:215], a[236:239], v[252:255], v[212:215]
    v_mfma_f32_16x16x32_bf16 v[208:211], a[240:243], v[252:255], v[208:211]
    s_nop 0
    v_cvt_pk_bf16_f32 v220, v220, v221
    v_cvt_pk_bf16_f32 v221, v222, v223
    v_cvt_pk_bf16_f32 v222, v216, v217
    v_cvt_pk_bf16_f32 v223, v218, v219
    buffer_store_dwordx4 v[220:223], v225, s[20:23], s51 offen sc0 sc1
    v_rcp_f32 v197, v196
    v_cvt_pk_bf16_f32 v212, v212, v213
    v_cvt_pk_bf16_f32 v213, v214, v215
    v_cvt_pk_bf16_f32 v214, v208, v209
    v_cvt_pk_bf16_f32 v215, v210, v211
    v_mul_f32 v184, v184, v197
    v_mul_f32 v185, v185, v197
    v_cvt_pk_bf16_f32 v184, v184, v185
    v_mul_f32 v186, v186, v197
    v_mul_f32 v187, v187, v197
    v_cvt_pk_bf16_f32 v185, v186, v187
    v_mul_f32 v188, v188, v197
    v_mul_f32 v189, v189, v197
    v_cvt_pk_bf16_f32 v186, v188, v189
    v_mul_f32 v190, v190, v197
    v_mul_f32 v191, v191, v197
    v_cvt_pk_bf16_f32 v187, v190, v191
    v_mul_f32 v192, v192, v197
    v_mul_f32 v193, v193, v197
    v_cvt_pk_bf16_f32 v188, v192, v193
    v_mul_f32 v194, v194, v197
    v_mul_f32 v195, v195, v197
    v_cvt_pk_bf16_f32 v189, v194, v195
    ds_write_b128 v237, v[184:187] offset:6144
    ds_write_b64 v238, v[188:189] offset:6144
    buffer_store_dwordx4 v[212:215], v226, s[20:23], s51 offen sc0 sc1
    s_waitcnt lgkmcnt(0)
    s_barrier
    ds_read_b128 a[244:247], v227
    ds_read_b128 a[248:251], v227 offset:1024
    ds_read_b128 a[252:255], v227 offset:2048
    ds_read_b128 v[252:255], v227 offset:3072
    ds_read_b128 a[236:239], v227 offset:4096
    ds_read_b128 a[240:243], v227 offset:5120
    s_waitcnt lgkmcnt(5)
    v_mfma_f32_16x16x32_bf16 v[204:207], a[220:223], a[244:247], 0
    v_mfma_f32_16x16x32_bf16 v[200:203], a[224:227], a[244:247], 0
    v_mfma_f32_16x16x32_bf16 v[220:223], a[228:231], a[244:247], 0
    v_mfma_f32_16x16x32_bf16 v[216:219], a[232:235], a[244:247], 0
    s_waitcnt lgkmcnt(3)
    ds_read_b128 a[244:247], v242 offset:61440
    v_mfma_f32_16x16x32_bf16 v[204:207], a[0:3], a[248:251], v[204:207]
    v_mfma_f32_16x16x32_bf16 v[200:203], a[4:7], a[248:251], v[200:203]
    v_mfma_f32_16x16x32_bf16 v[220:223], a[8:11], a[248:251], v[220:223]
    v_mfma_f32_16x16x32_bf16 v[216:219], a[12:15], a[248:251], v[216:219]
    ds_read_b128 a[248:251], v242 offset:61952
    v_mfma_f32_16x16x32_bf16 v[204:207], a[16:19], a[252:255], v[204:207]
    v_mfma_f32_16x16x32_bf16 v[200:203], a[20:23], a[252:255], v[200:203]
    v_mfma_f32_16x16x32_bf16 v[220:223], a[24:27], a[252:255], v[220:223]
    v_mfma_f32_16x16x32_bf16 v[216:219], a[28:31], a[252:255], v[216:219]
    s_waitcnt lgkmcnt(1)
    v_mfma_f32_16x16x32_bf16 v[204:207], a[32:35], v[252:255], v[204:207]
    v_mfma_f32_16x16x32_bf16 v[200:203], a[36:39], v[252:255], v[200:203]
    v_mfma_f32_16x16x32_bf16 v[220:223], a[40:43], v[252:255], v[220:223]
    v_mfma_f32_16x16x32_bf16 v[216:219], a[44:47], v[252:255], v[216:219]
    v_mfma_f32_16x16x32_bf16 v[204:207], a[48:51], a[236:239], v[204:207]
    v_mfma_f32_16x16x32_bf16 v[200:203], a[52:55], a[236:239], v[200:203]
    v_mfma_f32_16x16x32_bf16 v[220:223], a[56:59], a[236:239], v[220:223]
    v_mfma_f32_16x16x32_bf16 v[216:219], a[60:63], a[236:239], v[216:219]
    v_mfma_f32_16x16x32_bf16 v[204:207], a[64:67], a[240:243], v[204:207]
    v_mfma_f32_16x16x32_bf16 v[200:203], a[68:71], a[240:243], v[200:203]
    v_mfma_f32_16x16x32_bf16 v[220:223], a[244:247], a[240:243], v[220:223]
    s_waitcnt lgkmcnt(0)
    v_mfma_f32_16x16x32_bf16 v[216:219], a[248:251], a[240:243], v[216:219]
    s_nop 4
    v_cvt_pk_bf16_f32 v204, v204, v205
    v_cvt_pk_bf16_f32 v205, v206, v207
    v_cvt_pk_bf16_f32 v206, v200, v201
    v_cvt_pk_bf16_f32 v207, v202, v203
    buffer_store_dwordx4 v[204:207], v246, s[20:23], s51 offen sc0 sc1
    v_cvt_pk_bf16_f32 v220, v220, v221
    v_cvt_pk_bf16_f32 v221, v222, v223
    v_cvt_pk_bf16_f32 v222, v216, v217
    v_cvt_pk_bf16_f32 v223, v218, v219
    buffer_store_dwordx4 v[220:223], v247, s[20:23], s51 offen sc0 sc1
    s_endpgm
.section .rodata,"a"
.p2align 6
.amdhsa_kernel standalone__neighborhood_dinat__vision_kernel
  .amdhsa_next_free_vgpr 512
  .amdhsa_next_free_sgpr 102
  .amdhsa_accum_offset 256
  .amdhsa_group_segment_fixed_size 0
  .amdhsa_kernarg_size 56
  .amdhsa_user_sgpr_count 2
  .amdhsa_user_sgpr_kernarg_segment_ptr 1
  .amdhsa_system_sgpr_workgroup_id_x 1
.end_amdhsa_kernel
```

```asm
; @launch grid=(256,1,1) block=(256,1,1) lds=163344
.amdgcn_target "amdgcn-amd-amdhsa--gfx950"
.text
.globl standalone__neighborhood_dinat__vision_kernel
.p2align 8
.type standalone__neighborhood_dinat__vision_kernel,@function
standalone__neighborhood_dinat__vision_kernel:
    s_cmp_ge_u32 s2, 256
    s_cbranch_scc1 L_exit
L_go:
    s_load_dwordx2 s[8:9], s[0:1], 8
    s_load_dwordx2 s[4:5], s[0:1], 0
    s_load_dwordx2 s[16:17], s[0:1], 24
    s_load_dwordx2 s[12:13], s[0:1], 16
    s_load_dwordx2 s[20:21], s[0:1], 32
    s_getpc_b64 s[24:25]
    s_mov_b32 s26, L_end-L_go-64
    s_mov_b32 s27, 0x20000
    s_lshl_b32 s52, s2, 10
    v_lshlrev_b32 v189, 5, v0
    s_and_b32 s53, s52, 0xe000
    buffer_load_dword v188, v189, s[24:27], s53 offen
    v_lshrrev_b32 v74, 6, v0
    v_and_b32 v60, 63, v0
    v_readfirstlane_b32 s36, v74
    v_mul_u32_u24 v76, 0x2aab, v60
    v_lshrrev_b32 v76, 16, v76
    v_mul_u32_u24 v74, 6, v76
    v_sub_u32 v77, v60, v74
    v_lshrrev_b32 v74, 1, v76
    v_and_b32 v74, 4, v74
    v_xor_b32 v76, v76, v74
    v_mul_u32_u24 v74, 0x480, v76
    v_lshl_add_u32 v251, v77, 4, v74
    v_add_u32 v79, 64, v60
    v_mul_u32_u24 v78, 0x2aab, v79
    v_lshrrev_b32 v78, 16, v78
    v_mul_u32_u24 v74, 6, v78
    v_sub_u32 v79, v60, v74
    v_lshrrev_b32 v74, 1, v78
    v_and_b32 v74, 4, v74
    v_xor_b32 v78, v78, v74
    v_mul_u32_u24 v74, 0x480, v78
    v_lshl_add_u32 v252, v79, 4, v74
    v_add_u32 v81, 0x80, v60
    v_mul_u32_u24 v80, 0x2aab, v81
    v_lshrrev_b32 v80, 16, v80
    v_mul_u32_u24 v74, 6, v80
    v_sub_u32 v81, v60, v74
    v_lshrrev_b32 v74, 1, v80
    v_and_b32 v74, 4, v74
    v_xor_b32 v80, v80, v74
    v_mul_u32_u24 v74, 0x480, v80
    v_lshl_add_u32 v253, v81, 4, v74
    s_mul_i32 s49, s36, 0x60
    s_mul_i32 s50, s36, 0xc00
    s_add_u32 s50, s50, 0x15e00
    s_mov_b32 s10, 0x36000
    s_mov_b32 s11, 0x20000
    s_mov_b32 s6, 0x1260400
    s_mov_b32 s7, 0x20000
    s_mov_b32 s18, 0x548
    s_mov_b32 s19, 0x20000
    s_mov_b32 s14, 0x12000
    s_mov_b32 s15, 0x20000
    s_mov_b32 s22, 0x1260000
    s_mov_b32 s23, 0x20000
    s_and_b32 s53, s52, 0x3e000
    s_mul_i32 s58, s36, 0x152
    v_lshlrev_b32 v199, 1, v60
    s_and_b32 s52, s52, 0x1e000
    s_add_u32 s57, s49, 0x180
    s_add_u32 m0, s50, 0
    s_bfe_u32 s35, s2, 0x30003
    s_lshr_b32 s55, s2, 6
    s_and_b32 s54, s2, 1
    s_lshl2_add_u32 s34, s54, s55
    s_and_b32 s46, s55, 1
    s_bfe_u32 s54, s2, 0x10002
    s_mul_i32 s54, s54, 0x15000
    s_bfe_u32 s55, s2, 0x10001
    s_mul_i32 s55, s55, 0x180
    s_add_u32 s38, s54, s55
    s_lshl_b32 s41, s36, 11
    s_min_u32 s41, s41, 0x1600
    s_mul_i32 s54, s35, 14
    s_sub_u32 s54, s54, 3
    s_lshr_b32 s55, s41, 4
    v_add_u32 v99, s55, v60
    v_mov_b32 v100, 0x8000
    v_mul_u32_u24 v97, 0xaab, v99
    v_lshrrev_b32 v97, 16, v97
    v_mul_u32_u24 v98, 24, v97
    v_sub_u32 v96, v99, v98
    v_and_or_b32 v98, 2, v97, 64
    v_xor_b32 v96, v96, v98
    v_add_u32 v97, s54, v97
    v_add_u32 v99, 64, v99
    s_mul_i32 s51, s34, 0x24c000
    s_add_u32 s51, s51, s38
    s_mul_i32 s55, s46, 0x222000
    s_waitcnt lgkmcnt(0)
    buffer_load_dword v188, v189, s[8:11], s53 offen
    buffer_load_ushort v196, v199, s[16:19], s58 offen
    buffer_load_ushort v197, v199, s[16:19], s58 offen offset:128
    buffer_load_ushort v198, v199, s[16:19], s58 offen offset:256
    buffer_load_dword v188, v189, s[12:15], s52 offen
    buffer_load_dwordx4 v251, s[8:11], s57 offen lds
    s_movk_i32 s53, 0x6f
    v_cmp_lt_u32 vcc, s53, v97
    s_sub_u32 s4, s4, 0x400
    s_subb_u32 s5, s5, 0
    s_add_u32 s56, s51, s55
    v_cndmask_b32 v97, v97, v100, vcc
    v_mul_u32_u24 v97, 0x300, v97
    buffer_load_dwordx4 v252, s[8:11], s57 offen offset:1024 lds
    v_lshl_add_u32 v246, v96, 4, v97
    v_mul_u32_u24 v97, 0xaab, v99
    v_lshrrev_b32 v97, 16, v97
    v_mul_u32_u24 v98, 24, v97
    v_sub_u32 v96, v99, v98
    v_and_b32 v98, 2, v97
    v_xor_b32 v96, v96, v98
    v_add_u32 v97, s54, v97
    buffer_load_dwordx4 v253, s[8:11], s57 offen offset:2048 lds
    v_cmp_lt_u32 vcc, s53, v97
    s_mul_i32 s42, s46, 0xfffac000
    s_add_u32 s42, s42, 0x2a000
    v_cndmask_b32 v97, v97, v100, vcc
    v_mul_u32_u24 v97, 0x300, v97
    v_lshl_add_u32 v247, v96, 4, v97
    s_mul_i32 s55, s46, 7
    s_cmp_eq_u32 s34, s55
    s_cselect_b32 s43, 5, -3
    s_cselect_b32 s45, 0, -1
    s_cselect_b32 s47, 1, 0
    s_mul_i32 s43, s43, s42
    s_add_u32 s43, s43, s56
    s_mul_i32 s45, s45, s42
    s_add_u32 s45, s45, s56
    s_add_u32 s44, s43, s42
    s_cmp_eq_u32 s47, 1
    s_cmov_b32 s45, 0x2000000
    s_add_u32 m0, s41, 0
    s_add_u32 s57, s49, 0x9180
    buffer_load_dwordx4 v246, s[4:7], s43 offen lds
    v_lshrrev_b32 v61, 4, v60
    v_and_b32 v62, 7, v60
    v_bfe_u32 v63, v60, 3, 1
    buffer_load_dwordx4 v247, s[4:7], s43 offen offset:1024 lds
    s_add_u32 m0, s41, 0x1e40
    v_bfe_u32 v96, v60, 2, 2
    v_and_b32 v97, 3, v60
    v_and_b32 v103, 1, v61
    v_lshl_add_u32 v99, v61, 3, v96
    v_lshl_add_u32 v99, v103, 2, v99
    v_lshl_add_u32 v101, v97, 3, s50
    buffer_load_dwordx4 v246, s[4:7], s44 offen lds
    s_movk_i32 s27, 0x60
    v_mad_u32_u24 v254, v99, s27, v101
    v_xor_b32 v99, 4, v99
    v_mad_u32_u24 v255, v99, s27, v101
    v_mul_u32_u24 v102, 0x1e40, v63
    v_and_b32 v98, 2, v60
    v_xor_b32 v98, v98, v61
    v_lshlrev_b32 v98, 4, v98
    buffer_load_dwordx4 v247, s[4:7], s44 offen offset:1024 lds
    s_add_u32 m0, s41, 0x3c80
    v_mul_u32_u24 v100, 0x180, v62
    v_add3_u32 v224, v98, v100, v102
    v_mul_u32_u24 v99, 0x1e40, v96
    v_mul_u32_u24 v227, 0x180, v97
    v_add3_u32 v227, v227, v98, v99
    s_cmp_eq_u32 s35, 0
    s_cselect_b32 s29, 3, 0
    s_cselect_b32 s30, -3, -2
    buffer_load_dwordx4 v246, s[4:7], s45 offen lds
    s_mul_i32 s32, s36, 0xf00
    s_add_u32 s32, s32, 0xf200
    s_mov_b32 s40, 0x140
    s_lshl_b32 s31, s36, 10
    s_add_u32 s31, s31, 0x12e40
    v_mul_u32_u24 v119, 13, v60
    v_lshrrev_b32 v119, 8, v119
    v_mul_u32_u24 v118, 20, v119
    v_sub_u32 v118, v60, v118
    v_add_u32 v120, -11, v118
    v_max_i32 v120, 0, v120
    buffer_load_dwordx4 v247, s[4:7], s45 offen offset:1024 lds
    s_add_u32 m0, s41, 0x5ac0
    v_mul_u32_u24 v121, 11, v120
    v_lshrrev_b32 v121, 5, v121
    v_mul_u32_u24 v122, 3, v121
    v_sub_u32 v120, v120, v122
    v_lshlrev_b32 v120, 2, v120
    v_sub_u32 v121, v120, v121
    v_cmp_lt_u32 vcc, 10, v118
    buffer_load_dwordx4 v246, s[4:7], s56 offen lds
    v_add_u32 v121, s29, v121
    v_add_u32 v120, s30, v120
    v_add_u32 v122, -3, v118
    v_cndmask_b32 v121, v118, v121, vcc
    v_cndmask_b32 v120, v122, v120, vcc
    v_cmp_gt_u32 s[60:61], 7, v120
    v_add_u32 v120, 1, v120
    buffer_load_dwordx4 v247, s[4:7], s56 offen offset:1024 lds
    s_add_u32 m0, s50, 0x3000
    s_add_u32 s56, s56, s42
    v_cmp_gt_u32 s[62:63], 7, v120
    v_add_u32 v120, 1, v120
    v_cmp_gt_u32 s[64:65], 7, v120
    v_add_u32 v120, 1, v120
    v_cmp_gt_u32 s[66:67], 7, v120
    s_cmp_eq_u32 s46, 0
    s_cselect_b32 s28, 13, -13
    s_cselect_b32 s69, 0, 39
    buffer_load_dwordx4 v251, s[8:11], s57 offen lds
    v_add_u32 v119, 2, v119
    v_mad_i32_i24 v121, v119, s28, v121
    s_lshl4_add_u32 s69, s69, s31
    v_lshl_add_u32 v121, v121, 2, s69
    s_mul_i32 s69, s28, 12
    v_add_u32 v118, s69, v121
    v_add_u32 v119, s69, v118
    s_lshl_b32 s69, s28, 3
    v_add_u32 v122, s69, v119
    v_lshl_add_u32 v123, v60, 4, s32
    buffer_load_dwordx4 v252, s[8:11], s57 offen offset:1024 lds
    v_lshl_add_u32 v125, v60, 2, s31
    s_mov_b32 s68, 0x3fb8aa3b
    v_mul_u32_u24 v74, 0x180, v76
    v_lshl_add_u32 v192, v77, 4, v74
    v_mul_u32_u24 v74, 0x180, v78
    v_lshl_add_u32 v193, v79, 4, v74
    v_mul_u32_u24 v74, 0x180, v80
    v_lshl_add_u32 v194, v81, 4, v74
    buffer_load_dwordx4 v253, s[8:11], s57 offen offset:2048 lds
    s_add_u32 s57, s49, 0x12180
    v_and_b32 v74, 16, v78
    v_mul_u32_u24 v74, 0x300, v74
    v_add_u32 v195, v74, v193
    v_add_u32 v98, 3, v62
    v_and_b32 v98, 2, v98
    v_xor_b32 v98, v98, v61
    v_lshl_add_u32 v98, v98, 4, v100
    v_add_u32 v225, v98, v102
    v_xor_b32 v99, 1, v63
    v_mul_u32_u24 v99, 0xd3c0, v99
    v_add_u32 v226, v98, v99
    s_mov_b32 s37, 0x3e553b95
    s_cmp_eq_u32 s35, 7
    s_cselect_b32 s33, 2, 64
    v_lshrrev_b32 v184, 1, v61
    v_lshl_add_u32 v185, v63, 1, v184
    v_lshlrev_b32 v232, 2, v185
    v_lshl_add_u32 v185, v63, 2, v61
    v_lshlrev_b32 v233, 2, v185
    v_sub_u32 v184, v184, v63
    v_mul_i32_i24 v184, 0x140, v184
    s_sub_u32 s24, s32, 0x140
    v_add_u32 v184, s24, v184
    v_lshl_add_u32 v185, v103, 2, 3
    v_cmp_gt_u32 vcc, s29, v62
    v_sub_u32 v186, v185, v62
    v_min_u32 v187, 10, v186
    v_mad_u32_u24 v190, v62, 3, v103
    v_add_u32 v191, 11, v190
    v_cndmask_b32 v187, v187, v191, vcc
    v_lshl_add_u32 v228, v187, 4, v184
    v_add_u32 v186, 8, v186
    v_min_u32 v187, 10, v186
    v_lshl_add_u32 v186, v103, 4, v62
    v_cmp_gt_u32 vcc, s29, v186
    v_add_u32 v191, 13, v190
    v_min_u32 v186, 5, v62
    v_cndmask_b32 v187, v187, v191, vcc
    v_lshl_add_u32 v229, v187, 4, v184
    v_cmp_lt_u32 vcc, s33, v186
    v_sub_u32 v187, v185, v186
    v_min_u32 v187, 10, v187
    v_mad_u32_u24 v190, v186, 3, 2
    v_add_u32 v191, v190, v103
    v_cndmask_b32 v185, v187, v191, vcc
    v_sub_u32 v187, 11, v186
    v_min_u32 v187, 10, v187
    v_add_u32 v191, 2, v190
    v_cndmask_b32 v187, v187, v191, vcc
    v_cmp_lt_u32 vcc, 5, v62
    v_mul_u32_u24 v191, 10, v103
    v_mov_b32 v190, 10
    v_cndmask_b32 v185, v185, v191, vcc
    v_cndmask_b32 v187, v187, v190, vcc
    v_lshl_add_u32 v230, v185, 4, v184
    v_lshl_add_u32 v231, v187, 4, s32
    v_mov_b32 v96, 0x3f803f80
    v_cmp_eq_u32 vcc, 0, v97
    v_mov_b32 v236, 1.0
    s_mov_b32 s69, 0x76540765
    v_cndmask_b32 v96, 0, v96, vcc
    v_accvgpr_write_b32 a216, v96
    v_accvgpr_write_b32 a217, v96
    v_accvgpr_write_b32 a218, v96
    v_accvgpr_write_b32 a219, v96
    s_and_b32 s24, s36, 1
    s_lshr_b32 s27, s36, 1
    v_lshlrev_b32 v163, 4, v60
    s_mul_i32 s25, s27, 0xc00
    s_add_u32 s25, s25, 0x12e00
    s_lshl_b32 s26, s24, 11
    s_add_u32 s26, s26, s25
    v_add_u32 v237, s26, v163
    s_lshl3_add_u32 s26, s24, s25
    s_add_u32 s26, s26, 0x400
    v_add_u32 v238, s26, v163
    s_mul_i32 s25, s24, 0x1800
    s_add_u32 s26, s25, 0x12e00
    v_add_u32 v239, s26, v163
    s_sub_u32 s25, 0x14600, s25
    v_add_u32 v240, s25, v163
    v_lshrrev_b32 v163, 2, v60
    v_and_b32 v161, 3, v60
    v_and_b32 v162, 2, v61
    v_lshlrev_b32 v162, 1, v162
    v_xor_b32 v163, v163, v162
    v_mul_u32_u24 v163, 0x60, v163
    v_lshl_add_u32 v108, v161, 4, v163
    v_lshrrev_b32 v162, 1, v161
    v_mul_u32_u24 v162, 0xba0, v162
    s_mul_i32 s26, s27, 0x1800
    s_add_u32 s26, s26, 0x15e40
    v_add3_u32 v109, v108, v162, s26
    s_lshl_b32 s25, s24, 5
    s_add_u32 s52, s25, s50
    v_add_u32 v108, s52, v108
    v_bfrev_b32 v162, v161
    v_lshrrev_b32 v162, 27, v162
    v_add3_u32 v86, v163, v162, s50
    v_lshlrev_b32 v163, 7, v61
    v_lshl_add_u32 v163, v62, 4, v163
    v_lshl_add_u32 v162, v63, 9, v163
    v_add_u32 v87, s50, v162
    v_lshl_add_u32 v163, v63, 10, v163
    s_add_u32 s26, s26, 0x7c0
    v_add_u32 v242, s26, v163
    s_lshl_b32 s26, s24, 10
    s_add_u32 s26, s26, s50
    v_add_u32 v241, s26, v163
    v_xor_b32 v163, s46, v63
    v_mul_u32_u24 v163, 0x2a000, v163
    v_mul_u32_u24 v162, 0x300, v62
    v_lshl_add_u32 v163, v61, 4, v163
    v_cmp_lt_u32 vcc, 5, v62
    v_add_u32 v163, v163, v162
    v_add_u32 v162, 0x1800, v163
    v_bfrev_b32 v164, 1
    v_cndmask_b32 v162, v162, v164, vcc
    s_sub_u32 s59, 0, s24
    s_mov_b32 vcc_lo, s59
    s_mov_b32 vcc_hi, s59
    v_cndmask_b32 v164, v163, v162, vcc
    v_cndmask_b32 v165, v162, v163, vcc
    s_mov_b32 vcc_lo, s59
    s_mov_b32 vcc_hi, s59
    v_lshrrev_b32 v160, 31, v164
    v_lshl_add_u32 v239, v160, 20, v239
    v_lshrrev_b32 v160, 31, v165
    v_lshl_add_u32 v240, v160, 20, v240
    s_add_u32 s25, s25, s49
    v_add_u32 v243, s25, v164
    v_add_u32 v245, s25, v165
    s_mul_i32 s26, s27, 0xc0
    s_add_u32 s26, s26, 64
    v_add_u32 v244, s26, v164
    s_mul_i32 s25, s35, 0x2a00
    s_add_u32 s51, s51, s25
    s_mul_i32 s25, s46, 0x1f8000
    s_mov_b64 exec, 0
    s_cmp_eq_u32 s36, 0
    s_cbranch_scc1 L_pg1
    s_cmp_eq_u32 s36, 1
    s_cbranch_scc1 L_pg2
    s_cmp_eq_u32 s36, 2
    s_cbranch_scc1 L_pg3
    s_branch L_pg4
    .p2align 12
L_back:
    s_mov_b64 exec, -1
    s_add_u32 m0, s50, 0x6000
    s_waitcnt vmcnt(11)
    ds_read_b64_tr_b16 a[0:1], v254
    ds_read_b64_tr_b16 a[2:3], v255
    ds_read_b64_tr_b16 a[4:5], v254 offset:32
    ds_read_b64_tr_b16 a[6:7], v255 offset:32
    ds_read_b64_tr_b16 a[8:9], v254 offset:64
    s_add_u32 s51, s51, s25
    ds_read_b64_tr_b16 a[10:11], v255 offset:64
    s_lshl_b32 s25, s36, 2
    s_add_u32 s25, s25, 0x27e00
    s_lshl_b32 s48, s42, 1
    s_mov_b32 s82, 0xff00ff
    s_mov_b32 s83, s82
    s_mov_b32 s84, -1
    s_mov_b32 s85, 0
    s_waitcnt vmcnt(3)
    s_barrier
    buffer_load_dwordx4 v251, s[8:11], s57 offen lds
    buffer_load_dwordx4 v252, s[8:11], s57 offen offset:1024 lds
    ds_read_b128 a[236:239], v224
    ds_read_b128 a[240:243], v224 offset:3072
    ds_read_b128 a[244:247], v224 offset:15488
    ds_read_b128 a[248:251], v224 offset:18560
    ds_read_b128 a[252:255], v227 offset:6144
    buffer_load_dwordx4 v253, s[8:11], s57 offen offset:2048 lds
    s_add_u32 s57, s49, 0x1b180
    s_add_u32 m0, s50, 0x9000
    ds_read_b128 a[220:223], v224 offset:64
    ds_read_b128 a[224:227], v224 offset:3136
    ds_read_b128 a[228:231], v224 offset:15552
    s_waitcnt lgkmcnt(7)
    v_mfma_f32_16x16x32_bf16 v[12:15], a[0:3], a[236:239], 0
    ds_read_b128 a[232:235], v224 offset:18624
    v_mfma_f32_16x16x32_bf16 v[16:19], a[4:7], a[236:239], 0
    buffer_load_dwordx4 v251, s[8:11], s57 offen lds
    v_mfma_f32_16x16x32_bf16 v[20:23], a[8:11], a[236:239], 0
    s_waitcnt lgkmcnt(7)
    ds_read_b128 a[236:239], v227 offset:6208
    v_mfma_f32_16x16x32_bf16 v[36:39], a[0:3], a[240:243], 0
    v_mfma_f32_16x16x32_bf16 v[40:43], a[4:7], a[240:243], 0
    s_waitcnt vmcnt(4)
    ds_read_b64_tr_b16 a[12:13], v254 offset:12288
    ds_read_b64_tr_b16 a[14:15], v255 offset:12288
    v_mfma_f32_16x16x32_bf16 v[44:47], a[8:11], a[240:243], 0
    s_waitcnt lgkmcnt(7)
    buffer_load_dwordx4 v252, s[8:11], s57 offen offset:1024 lds
    v_mfma_f32_16x16x32_bf16 v[132:135], a[0:3], a[244:247], 0
    ds_read_b64_tr_b16 a[16:17], v254 offset:12320
    ds_read_b64_tr_b16 a[18:19], v255 offset:12320
    v_mfma_f32_16x16x32_bf16 v[136:139], a[4:7], a[244:247], 0
    ds_read_b64_tr_b16 a[20:21], v254 offset:12352
    ds_read_b64_tr_b16 a[22:23], v255 offset:12352
    v_mfma_f32_16x16x32_bf16 v[140:143], a[8:11], a[244:247], 0
    ds_read_b128 a[240:243], v224 offset:128
    ds_read_b128 a[244:247], v224 offset:3200
    v_mfma_f32_16x16x32_bf16 v[220:223], a[0:3], a[248:251], 0
    v_mfma_f32_16x16x32_bf16 v[216:219], a[4:7], a[248:251], 0
    buffer_load_dwordx4 v253, s[8:11], s57 offen offset:2048 lds
    v_mfma_f32_16x16x32_bf16 v[212:215], a[8:11], a[248:251], 0
    s_add_u32 s57, s49, 0x24180
    ds_read_b128 a[248:251], v224 offset:15616
    s_add_u32 m0, s50, 0xc000
    v_mfma_f32_16x16x32_bf16 v[208:211], a[0:3], a[252:255], 0
    v_mfma_f32_16x16x32_bf16 v[204:207], a[4:7], a[252:255], 0
    v_mfma_f32_16x16x32_bf16 v[200:203], a[8:11], a[252:255], 0
    s_waitcnt lgkmcnt(5)
    buffer_load_dwordx4 v251, s[8:11], s57 offen lds
    v_mfma_f32_16x16x32_bf16 v[12:15], a[12:15], a[220:223], v[12:15]
    ds_read_b128 a[252:255], v224 offset:18688
    v_mfma_f32_16x16x32_bf16 v[16:19], a[16:19], a[220:223], v[16:19]
    s_waitcnt lgkmcnt(3)
    v_mfma_f32_16x16x32_bf16 v[20:23], a[20:23], a[220:223], v[20:23]
    ds_read_b128 a[220:223], v227 offset:6272
    v_mfma_f32_16x16x32_bf16 v[36:39], a[12:15], a[224:227], v[36:39]
    buffer_load_dwordx4 v252, s[8:11], s57 offen offset:1024 lds
    v_mfma_f32_16x16x32_bf16 v[40:43], a[16:19], a[224:227], v[40:43]
    v_mfma_f32_16x16x32_bf16 v[44:47], a[20:23], a[224:227], v[44:47]
    ds_read_b128 a[224:227], v224 offset:192
    v_mfma_f32_16x16x32_bf16 v[132:135], a[12:15], a[228:231], v[132:135]
    v_mfma_f32_16x16x32_bf16 v[136:139], a[16:19], a[228:231], v[136:139]
    buffer_load_dwordx4 v253, s[8:11], s57 offen offset:2048 lds
    v_mfma_f32_16x16x32_bf16 v[140:143], a[20:23], a[228:231], v[140:143]
    s_add_u32 s57, s49, 0x2d180
    ds_read_b128 a[228:231], v224 offset:3264
    v_lshlrev_b32 v196, 16, v196
    v_mfma_f32_16x16x32_bf16 v[220:223], a[12:15], a[232:235], v[220:223]
    s_add_u32 m0, s50, 0xf000
    v_mul_f32 v196, s68, v196
    v_lshlrev_b32 v197, 16, v197
    v_mfma_f32_16x16x32_bf16 v[216:219], a[16:19], a[232:235], v[216:219]
    s_and_b32 s72, s60, 0xfff00000
    ds_write_b32 v125, v196
    v_mfma_f32_16x16x32_bf16 v[212:215], a[20:23], a[232:235], v[212:215]
    s_and_b32 s70, s62, 0xfff00000
    ds_read_b128 a[232:235], v224 offset:15680
    v_mul_f32 v197, s68, v197
    v_mfma_f32_16x16x32_bf16 v[208:211], a[12:15], a[236:239], v[208:211]
    buffer_load_dwordx4 v251, s[8:11], s57 offen lds
    v_mfma_f32_16x16x32_bf16 v[204:207], a[16:19], a[236:239], v[204:207]
    ds_write_b32 v125, v197 offset:256
    v_mfma_f32_16x16x32_bf16 v[200:203], a[20:23], a[236:239], v[200:203]
    s_waitcnt vmcnt(7)
    ds_read_b128 a[236:239], v224 offset:18752
    v_lshlrev_b32 v198, 16, v198
    v_mul_f32 v198, s68, v198
    ds_write_b32 v125, v198 offset:512
    buffer_load_dwordx4 v252, s[8:11], s57 offen offset:1024 lds
    v_mov_b32 v124, 0xf149f2ca
    ds_read2_b32 v[144:145], v121 offset0:0 offset1:1
    ds_read_b64_tr_b16 a[24:25], v254 offset:24576
    ds_read_b64_tr_b16 a[26:27], v255 offset:24576
    ds_read_b64_tr_b16 a[28:29], v254 offset:24608
    ds_read_b64_tr_b16 a[30:31], v255 offset:24608
    s_mov_b32 s68, 0x32104321
    ds_read_b64_tr_b16 a[32:33], v254 offset:24640
    ds_read_b64_tr_b16 a[34:35], v255 offset:24640
    ds_read2_b32 v[146:147], v121 offset0:2 offset1:3
    buffer_load_dwordx4 v253, s[8:11], s57 offen offset:2048 lds
    s_add_u32 m0, s41, 0x7900
    s_add_u32 s57, s49, 0x300
    ds_read2_b32 v[148:149], v118 offset0:0 offset1:1
    ds_read2_b32 v[150:151], v118 offset0:2 offset1:3
    ds_read2_b32 v[152:153], v119 offset0:0 offset1:1
    ds_read2_b32 v[154:155], v119 offset0:2 offset1:3
    ds_read2_b32 v[156:157], v122 offset0:0 offset1:1
    ds_read2_b32 v[158:159], v122 offset0:2 offset1:3
    s_waitcnt lgkmcnt(11)
    v_mfma_f32_16x16x32_bf16 v[12:15], a[24:27], a[240:243], v[12:15]
    s_waitcnt lgkmcnt(9)
    buffer_load_dwordx4 v246, s[4:7], s56 offen lds
    v_mfma_f32_16x16x32_bf16 v[16:19], a[28:31], a[240:243], v[16:19]
    s_waitcnt lgkmcnt(7)
    v_mfma_f32_16x16x32_bf16 v[20:23], a[32:35], a[240:243], v[20:23]
    ds_read_b128 a[240:243], v227 offset:6336
    v_mfma_f32_16x16x32_bf16 v[36:39], a[24:27], a[244:247], v[36:39]
    s_waitcnt lgkmcnt(6)
    v_cndmask_b32 v148, v124, v148, s[60:61]
    v_cndmask_b32 v149, v124, v149, s[62:63]
    v_mfma_f32_16x16x32_bf16 v[40:43], a[28:31], a[244:247], v[40:43]
    s_and_b32 s61, s61, 0xfffffff
    buffer_load_dwordx4 v247, s[4:7], s56 offen offset:1024 lds
    v_mfma_f32_16x16x32_bf16 v[44:47], a[32:35], a[244:247], v[44:47]
    s_add_u32 s56, s56, s42
    s_waitcnt vmcnt(8)
    ds_read_b64_tr_b16 a[36:37], v254 offset:36864
    ds_read_b64_tr_b16 a[38:39], v255 offset:36864
    v_mfma_f32_16x16x32_bf16 v[132:135], a[24:27], a[248:251], v[132:135]
    s_add_u32 m0, s41, 0x9740
    ds_read_b64_tr_b16 a[40:41], v254 offset:36896
    ds_read_b64_tr_b16 a[42:43], v255 offset:36896
    v_mfma_f32_16x16x32_bf16 v[136:139], a[28:31], a[248:251], v[136:139]
    s_and_b32 s63, s63, 0xfffffff
    ds_read_b64_tr_b16 a[44:45], v254 offset:36928
    ds_read_b64_tr_b16 a[46:47], v255 offset:36928
    v_mfma_f32_16x16x32_bf16 v[140:143], a[32:35], a[248:251], v[140:143]
    s_mov_b32 s73, s61
    buffer_load_dwordx4 v246, s[4:7], s56 offen lds
    v_mfma_f32_16x16x32_bf16 v[220:223], a[24:27], a[252:255], v[220:223]
    s_mov_b32 s71, s63
    ds_read_b128 a[244:247], v224 offset:256
    ds_read_b128 a[248:251], v224 offset:3328
    v_mfma_f32_16x16x32_bf16 v[216:219], a[28:31], a[252:255], v[216:219]
    s_waitcnt lgkmcnt(8)
    v_cndmask_b32 v150, v124, v150, s[64:65]
    v_cndmask_b32 v151, v124, v151, s[66:67]
    v_mfma_f32_16x16x32_bf16 v[212:215], a[32:35], a[252:255], v[212:215]
    s_and_b32 s65, s65, 0xfffffff
    ds_read_b128 a[252:255], v224 offset:15744
    v_cndmask_b32 v156, v124, v156, s[60:61]
    v_mfma_f32_16x16x32_bf16 v[208:211], a[24:27], a[220:223], v[208:211]
    s_and_b32 s67, s67, 0xfffffff
    v_cndmask_b32 v157, v124, v157, s[62:63]
    v_cndmask_b32 v158, v124, v158, s[64:65]
    v_mfma_f32_16x16x32_bf16 v[204:207], a[28:31], a[220:223], v[204:207]
    s_and_b32 s61, s61, 0xff
    buffer_load_dwordx4 v247, s[4:7], s56 offen offset:1024 lds
    v_mfma_f32_16x16x32_bf16 v[200:203], a[32:35], a[220:223], v[200:203]
    s_add_u32 s56, s56, s42
    ds_read_b128 a[220:223], v224 offset:18816
    v_cndmask_b32 v159, v124, v159, s[66:67]
    s_waitcnt lgkmcnt(5)
    v_mfma_f32_16x16x32_bf16 v[12:15], a[36:39], a[224:227], v[12:15]
    s_add_u32 m0, s41, 0xb580
    v_cndmask_b32 v144, v124, v144, s[72:73]
    v_cndmask_b32 v145, v124, v145, s[70:71]
    v_mfma_f32_16x16x32_bf16 v[16:19], a[40:43], a[224:227], v[16:19]
    s_and_b32 s72, s64, 0xfff00000
    v_cndmask_b32 v152, v124, v152, s[60:61]
    s_mov_b32 s73, s65
    s_waitcnt lgkmcnt(4)
    v_mfma_f32_16x16x32_bf16 v[20:23], a[44:47], a[224:227], v[20:23]
    s_and_b32 s70, s66, 0xfff00000
    buffer_load_dwordx4 v246, s[4:7], s56 offen lds
    v_mfma_f32_16x16x32_bf16 v[36:39], a[36:39], a[228:231], v[36:39]
    s_mov_b32 s71, s67
    s_waitcnt vmcnt(8)
    ds_read_b64_tr_b16 a[48:49], v254 offset:49152
    ds_read_b64_tr_b16 a[50:51], v255 offset:49152
    v_mfma_f32_16x16x32_bf16 v[40:43], a[40:43], a[228:231], v[40:43]
    s_and_b32 s63, s63, 0xff
    ds_read_b64_tr_b16 a[52:53], v254 offset:49184
    ds_read_b64_tr_b16 a[54:55], v255 offset:49184
    v_mfma_f32_16x16x32_bf16 v[44:47], a[44:47], a[228:231], v[44:47]
    s_and_b32 s65, s65, 0xff
    ds_read_b64_tr_b16 a[56:57], v254 offset:49216
    ds_read_b64_tr_b16 a[58:59], v255 offset:49216
    v_mfma_f32_16x16x32_bf16 v[132:135], a[36:39], a[232:235], v[132:135]
    s_and_b32 s67, s67, 0xff
    buffer_load_dwordx4 v247, s[4:7], s56 offen offset:1024 lds
    v_mfma_f32_16x16x32_bf16 v[136:139], a[40:43], a[232:235], v[136:139]
    s_add_u32 s56, s56, s42
    ds_read_b128 a[224:227], v227 offset:6400
    ds_read_b128 a[228:231], v224 offset:320
    v_mfma_f32_16x16x32_bf16 v[140:143], a[44:47], a[232:235], v[140:143]
    s_add_u32 m0, s41, 0xd3c0
    ds_read_b128 a[232:235], v224 offset:3392
    v_cndmask_b32 v146, v124, v146, s[72:73]
    v_mfma_f32_16x16x32_bf16 v[220:223], a[36:39], a[236:239], v[220:223]
    s_mov_b32 s60, 0x2222
    v_cndmask_b32 v147, v124, v147, s[70:71]
    v_cndmask_b32 v153, v124, v153, s[62:63]
    v_mfma_f32_16x16x32_bf16 v[216:219], a[40:43], a[236:239], v[216:219]
    s_cmp_eq_u32 s47, 1
    s_cmov_b32 s60, 0xbbbb
    v_bfe_u32 v234, s60, v232, 4
    v_mfma_f32_16x16x32_bf16 v[212:215], a[44:47], a[236:239], v[212:215]
    s_mov_b32 s61, 0x4444
    buffer_load_dwordx4 v246, s[4:7], s56 offen lds
    v_mfma_f32_16x16x32_bf16 v[208:211], a[36:39], a[240:243], v[208:211]
    s_cmp_eq_u32 s47, 1
    s_cmov_b32 s61, 0x4241
    v_mad_u32_u24 v235, v234, s40, v228
    v_mfma_f32_16x16x32_bf16 v[204:207], a[40:43], a[240:243], v[204:207]
    s_mov_b32 s62, 0x8808
    ds_read_b128 a[236:239], v224 offset:15808
    v_mad_u32_u24 v234, v234, s40, v229
    v_mfma_f32_16x16x32_bf16 v[200:203], a[44:47], a[240:243], v[200:203]
    s_cmp_eq_u32 s47, 1
    s_cmov_b32 s62, 0x8898
    s_waitcnt vmcnt(7)
    ds_read_b64_tr_b16 a[60:61], v254 offset:61440
    s_waitcnt lgkmcnt(5)
    v_mfma_f32_16x16x32_bf16 v[12:15], a[48:51], a[244:247], v[12:15]
    s_mov_b32 s63, 0x32104321
    buffer_load_dwordx4 v247, s[4:7], s56 offen offset:1024 lds
    v_mfma_f32_16x16x32_bf16 v[16:19], a[52:55], a[244:247], v[16:19]
    s_add_u32 m0, s50, 0
    ds_read_b64_tr_b16 a[62:63], v255 offset:61440
    ds_read_b64_tr_b16 a[64:65], v254 offset:61472
    v_mfma_f32_16x16x32_bf16 v[20:23], a[56:59], a[244:247], v[20:23]
    s_add_u32 s56, s56, s42
    ds_read_b64_tr_b16 a[66:67], v255 offset:61472
    ds_read_b64_tr_b16 a[68:69], v254 offset:61504
    v_mfma_f32_16x16x32_bf16 v[36:39], a[48:51], a[248:251], v[36:39]
    s_cmp_eq_u32 s47, 1
    s_cmov_b32 s63, 0x30a940ba
    ds_read_b64_tr_b16 a[70:71], v255 offset:61504
    v_mfma_f32_16x16x32_bf16 v[40:43], a[52:55], a[248:251], v[40:43]
    s_mov_b32 s70, 0x10762107
    buffer_load_dwordx4 v251, s[8:11], s57 offen lds
    v_mfma_f32_16x16x32_bf16 v[44:47], a[56:59], a[248:251], v[44:47]
    ds_read_b128 a[240:243], v224 offset:18880
    ds_read_b128 a[244:247], v227 offset:6464
    v_mfma_f32_16x16x32_bf16 v[132:135], a[48:51], a[252:255], v[132:135]
    v_cndmask_b32 v154, v124, v154, s[64:65]
    v_cndmask_b32 v155, v124, v155, s[66:67]
    v_mfma_f32_16x16x32_bf16 v[136:139], a[52:55], a[252:255], v[136:139]
    s_mov_b32 s64, 0x76540765
    ds_write_b128 v123, v[144:147]
    v_mfma_f32_16x16x32_bf16 v[140:143], a[56:59], a[252:255], v[140:143]
    s_cmp_eq_u32 s47, 1
    s_cmov_b32 s64, 0x76549765
    s_mov_b32 s65, 0x2222
    v_mfma_f32_16x16x32_bf16 v[220:223], a[48:51], a[220:223], v[220:223]
    s_cmp_eq_u32 s47, 1
    s_cmov_b32 s65, 0x2221
    s_mov_b32 s66, 0x10762107
    v_mfma_f32_16x16x32_bf16 v[216:219], a[52:55], a[220:223], v[216:219]
    s_cmp_eq_u32 s47, 1
    s_cmov_b32 s66, 0x10762097
    s_mov_b32 s67, 0x54326543
    v_mfma_f32_16x16x32_bf16 v[212:215], a[56:59], a[220:223], v[212:215]
    s_waitcnt lgkmcnt(3)
    buffer_load_dwordx4 v252, s[8:11], s57 offen offset:1024 lds
    v_mfma_f32_16x16x32_bf16 v[208:211], a[48:51], a[224:227], v[208:211]
    buffer_load_dwordx4 v253, s[8:11], s57 offen offset:2048 lds
    v_mfma_f32_16x16x32_bf16 v[204:207], a[52:55], a[224:227], v[204:207]
    s_add_u32 s57, s49, 0x9300
    ds_write_b128 v123, v[148:151] offset:960
    v_mfma_f32_16x16x32_bf16 v[200:203], a[56:59], a[224:227], v[200:203]
    s_add_u32 m0, s50, 0x3000
    ds_write_b128 v123, v[152:155] offset:1920
    v_mfma_f32_16x16x32_bf16 v[12:15], a[60:63], a[228:231], v[12:15]
    buffer_load_dwordx4 v251, s[8:11], s57 offen lds
    v_mfma_f32_16x16x32_bf16 v[16:19], a[64:67], a[228:231], v[16:19]
    ds_write_b128 v123, v[156:159] offset:2880
    v_mfma_f32_16x16x32_bf16 v[20:23], a[68:71], a[228:231], v[20:23]
    v_mfma_f32_16x16x32_bf16 v[36:39], a[60:63], a[232:235], v[36:39]
    buffer_load_dwordx4 v252, s[8:11], s57 offen offset:1024 lds
    v_mfma_f32_16x16x32_bf16 v[40:43], a[64:67], a[232:235], v[40:43]
    v_mfma_f32_16x16x32_bf16 v[44:47], a[68:71], a[232:235], v[44:47]
    v_cvt_pk_bf16_f32 v0, v12, v13
    v_cvt_pk_bf16_f32 v1, v14, v15
    v_mfma_f32_16x16x32_bf16 v[132:135], a[60:63], a[236:239], v[132:135]
    v_cvt_pk_bf16_f32 v2, v16, v17
    v_cvt_pk_bf16_f32 v3, v18, v19
    v_mfma_f32_16x16x32_bf16 v[136:139], a[64:67], a[236:239], v[136:139]
    s_waitcnt lgkmcnt(2)
    buffer_load_dwordx4 v253, s[8:11], s57 offen offset:2048 lds
    v_mfma_f32_16x16x32_bf16 v[140:143], a[68:71], a[236:239], v[140:143]
    s_add_u32 s57, s49, 0x12300
    ds_read_b128 v[144:147], v235
    v_cvt_pk_bf16_f32 v4, v20, v21
    v_mfma_f32_16x16x32_bf16 v[220:223], a[60:63], a[240:243], v[220:223]
    s_add_u32 m0, s50, 0x6000
    ds_read_b128 v[148:151], v234
    v_bfe_u32 v234, s61, v232, 4
    v_mfma_f32_16x16x32_bf16 v[216:219], a[64:67], a[240:243], v[216:219]
    v_mad_u32_u24 v235, v234, s40, v229
    v_mad_u32_u24 v234, v234, s40, v228
    v_mfma_f32_16x16x32_bf16 v[212:215], a[68:71], a[240:243], v[212:215]
    ds_read_b128 v[152:155], v235
    v_cvt_pk_bf16_f32 v5, v22, v23
    v_mfma_f32_16x16x32_bf16 v[208:211], a[60:63], a[244:247], v[208:211]
    buffer_load_dwordx4 v251, s[8:11], s57 offen lds
    v_mfma_f32_16x16x32_bf16 v[204:207], a[64:67], a[244:247], v[204:207]
    v_cvt_pk_bf16_f32 v24, v36, v37
    v_cvt_pk_bf16_f32 v25, v38, v39
    v_mfma_f32_16x16x32_bf16 v[200:203], a[68:71], a[244:247], v[200:203]
    s_waitcnt vmcnt(11)
    v_cvt_pk_bf16_f32 v26, v40, v41
    v_cvt_pk_bf16_f32 v27, v42, v43
    v_cvt_pk_bf16_f32 v28, v44, v45
    v_cvt_pk_bf16_f32 v29, v46, v47
    v_cvt_pk_bf16_f32 v6, v132, v133
    buffer_load_dwordx4 v252, s[8:11], s57 offen offset:1024 lds
    v_cvt_pk_bf16_f32 v7, v134, v135
    v_cvt_pk_bf16_f32 v8, v136, v137
    v_cvt_pk_bf16_f32 v9, v138, v139
    v_cvt_pk_bf16_f32 v10, v140, v141
    v_cvt_pk_bf16_f32 v11, v142, v143
    v_cvt_pk_bf16_f32 v30, v220, v221
    v_cvt_pk_bf16_f32 v31, v222, v223
    v_cvt_pk_bf16_f32 v32, v216, v217
    v_cvt_pk_bf16_f32 v33, v218, v219
    v_cvt_pk_bf16_f32 v34, v212, v213
    v_cvt_pk_bf16_f32 v35, v214, v215
    v_cvt_pk_bf16_f32 v48, v208, v209
    v_cvt_pk_bf16_f32 v49, v210, v211
    buffer_load_dwordx4 v253, s[8:11], s57 offen offset:2048 lds
    s_add_u32 s57, s49, 0x1b300
    s_add_u32 m0, s50, 0x9000
    v_cvt_pk_bf16_f32 v50, v204, v205
    v_cvt_pk_bf16_f32 v51, v206, v207
    v_cvt_pk_bf16_f32 v52, v200, v201
    v_cvt_pk_bf16_f32 v53, v202, v203
    buffer_load_dwordx4 v251, s[8:11], s57 offen lds
    buffer_load_dwordx4 v252, s[8:11], s57 offen offset:1024 lds
    s_barrier
    ds_read_b128 a[248:251], v224 offset:30976
    ds_read_b128 a[252:255], v224 offset:31040
    ds_read_b128 a[220:223], v224 offset:31104
    ds_read_b128 a[224:227], v224 offset:31168
    ds_read_b128 a[228:231], v224 offset:31232
    buffer_load_dwordx4 v253, s[8:11], s57 offen offset:2048 lds
    ds_read_b128 a[232:235], v224 offset:31296
    s_add_u32 s57, s49, 0x24300
    s_add_u32 m0, s50, 0xc000
    s_nop 0
    ds_read_b128 a[236:239], v224 offset:34048
    ds_read_b128 a[240:243], v224 offset:34112
    s_waitcnt lgkmcnt(7)
    v_mfma_f32_16x16x32_bf16 v[180:183], a[0:3], a[248:251], 0
    s_waitcnt lgkmcnt(6)
    ds_read_b128 a[244:247], v224 offset:34176
    v_mfma_f32_16x16x32_bf16 v[180:183], a[12:15], a[252:255], v[180:183]
    buffer_load_dwordx4 v251, s[8:11], s57 offen lds
    v_mfma_f32_16x16x32_bf16 v[176:179], a[4:7], a[248:251], 0
    v_mfma_f32_16x16x32_bf16 v[176:179], a[16:19], a[252:255], v[176:179]
    v_mfma_f32_16x16x32_bf16 v[172:175], a[8:11], a[248:251], 0
    ds_read_b128 a[248:251], v224 offset:34240
    v_mfma_f32_16x16x32_bf16 v[172:175], a[20:23], a[252:255], v[172:175]
    s_waitcnt lgkmcnt(5)
    ds_read_b128 a[252:255], v224 offset:34304
    v_mfma_f32_16x16x32_bf16 v[180:183], a[24:27], a[220:223], v[180:183]
    buffer_load_dwordx4 v252, s[8:11], s57 offen offset:1024 lds
    v_mfma_f32_16x16x32_bf16 v[180:183], a[36:39], a[224:227], v[180:183]
    v_mfma_f32_16x16x32_bf16 v[176:179], a[28:31], a[220:223], v[176:179]
    v_mfma_f32_16x16x32_bf16 v[176:179], a[40:43], a[224:227], v[176:179]
    s_waitcnt vmcnt(14)
    v_mfma_f32_16x16x32_bf16 v[172:175], a[32:35], a[220:223], v[172:175]
    s_barrier
    ds_read_b128 a[220:223], v224 offset:34368
    v_mfma_f32_16x16x32_bf16 v[172:175], a[44:47], a[224:227], v[172:175]
    ds_read_b128 a[224:227], v224 offset:46464
    v_mfma_f32_16x16x32_bf16 v[180:183], a[48:51], a[228:231], v[180:183]
    s_waitcnt lgkmcnt(3)
    buffer_load_dwordx4 v253, s[8:11], s57 offen offset:2048 lds
    v_mfma_f32_16x16x32_bf16 v[180:183], a[60:63], a[232:235], v[180:183]
    s_add_u32 s57, s49, 0x2d300
    s_add_u32 m0, s50, 0xf000
    v_mfma_f32_16x16x32_bf16 v[176:179], a[52:55], a[228:231], v[176:179]
    buffer_load_dwordx4 v251, s[8:11], s57 offen lds
    v_mfma_f32_16x16x32_bf16 v[176:179], a[64:67], a[232:235], v[176:179]
    v_mfma_f32_16x16x32_bf16 v[172:175], a[56:59], a[228:231], v[172:175]
    ds_read_b128 a[228:231], v224 offset:46528
    v_mfma_f32_16x16x32_bf16 v[172:175], a[68:71], a[232:235], v[172:175]
    v_cvt_pk_bf16_f32 v12, v180, v181
    v_cvt_pk_bf16_f32 v13, v182, v183
    v_mfma_f32_16x16x32_bf16 v[220:223], a[0:3], a[236:239], 0
    ds_read_b128 a[232:235], v224 offset:46592
    v_mfma_f32_16x16x32_bf16 v[220:223], a[12:15], a[240:243], v[220:223]
    v_cvt_pk_bf16_f32 v14, v176, v177
    v_cvt_pk_bf16_f32 v15, v178, v179
    v_mfma_f32_16x16x32_bf16 v[216:219], a[4:7], a[236:239], 0
    v_cvt_pk_bf16_f32 v16, v172, v173
    v_cvt_pk_bf16_f32 v17, v174, v175
    v_mfma_f32_16x16x32_bf16 v[216:219], a[16:19], a[240:243], v[216:219]
    buffer_load_dwordx4 v252, s[8:11], s57 offen offset:1024 lds
    v_mfma_f32_16x16x32_bf16 v[212:215], a[8:11], a[236:239], 0
    s_waitcnt vmcnt(14)
    ds_read_b128 a[236:239], v224 offset:46656
    ds_read_b64_tr_b16 a[72:73], v254
    v_mfma_f32_16x16x32_bf16 v[212:215], a[20:23], a[240:243], v[212:215]
    ds_read_b128 a[240:243], v224 offset:46720
    v_mfma_f32_16x16x32_bf16 v[220:223], a[24:27], a[244:247], v[220:223]
    buffer_load_dwordx4 v253, s[8:11], s57 offen offset:2048 lds
    v_mfma_f32_16x16x32_bf16 v[220:223], a[36:39], a[248:251], v[220:223]
    s_add_u32 s57, s49, 0
    ds_read_b64_tr_b16 a[74:75], v255
    ds_read_b64_tr_b16 a[76:77], v254 offset:32
    v_mfma_f32_16x16x32_bf16 v[216:219], a[28:31], a[244:247], v[216:219]
    s_add_u32 m0, s50, 0
    ds_read_b64_tr_b16 a[78:79], v255 offset:32
    ds_read_b64_tr_b16 a[80:81], v254 offset:64
    v_mfma_f32_16x16x32_bf16 v[216:219], a[40:43], a[248:251], v[216:219]
    ds_read_b64_tr_b16 a[82:83], v255 offset:64
    v_mfma_f32_16x16x32_bf16 v[212:215], a[32:35], a[244:247], v[212:215]
    ds_read_b128 a[244:247], v224 offset:46784
    v_mfma_f32_16x16x32_bf16 v[212:215], a[44:47], a[248:251], v[212:215]
    s_waitcnt lgkmcnt(9)
    ds_read_b128 a[248:251], v224 offset:49536
    v_mfma_f32_16x16x32_bf16 v[220:223], a[48:51], a[252:255], v[220:223]
    v_mfma_f32_16x16x32_bf16 v[220:223], a[60:63], a[220:223], v[220:223]
    v_mfma_f32_16x16x32_bf16 v[216:219], a[52:55], a[252:255], v[216:219]
    v_mfma_f32_16x16x32_bf16 v[216:219], a[64:67], a[220:223], v[216:219]
    s_waitcnt lgkmcnt(2)
    buffer_load_dwordx4 v251, s[8:11], s57 offen lds
    v_mfma_f32_16x16x32_bf16 v[212:215], a[56:59], a[252:255], v[212:215]
    s_waitcnt vmcnt(13)
    ds_read_b128 a[252:255], v224 offset:49600
    ds_read_b64_tr_b16 a[84:85], v254 offset:12288
    v_mfma_f32_16x16x32_bf16 v[212:215], a[68:71], a[220:223], v[212:215]
    ds_read_b128 a[220:223], v224 offset:49664
    v_cvt_pk_bf16_f32 v36, v220, v221
    v_mfma_f32_16x16x32_bf16 v[208:211], a[0:3], a[224:227], 0
    v_cvt_pk_bf16_f32 v37, v222, v223
    v_cvt_pk_bf16_f32 v38, v216, v217
    v_mfma_f32_16x16x32_bf16 v[208:211], a[12:15], a[228:231], v[208:211]
    ds_read_b64_tr_b16 a[86:87], v255 offset:12288
    v_cvt_pk_bf16_f32 v39, v218, v219
    v_mfma_f32_16x16x32_bf16 v[204:207], a[4:7], a[224:227], 0
    v_cvt_pk_bf16_f32 v40, v212, v213
    v_cvt_pk_bf16_f32 v41, v214, v215
    v_mfma_f32_16x16x32_bf16 v[204:207], a[16:19], a[228:231], v[204:207]
    buffer_load_dwordx4 v252, s[8:11], s57 offen offset:1024 lds
    v_mfma_f32_16x16x32_bf16 v[200:203], a[8:11], a[224:227], 0
    ds_read_b128 a[224:227], v224 offset:49728
    ds_read_b64_tr_b16 a[88:89], v254 offset:12320
    v_mfma_f32_16x16x32_bf16 v[200:203], a[20:23], a[228:231], v[200:203]
    ds_read_b128 a[228:231], v224 offset:49792
    v_mfma_f32_16x16x32_bf16 v[208:211], a[24:27], a[232:235], v[208:211]
    buffer_load_dwordx4 v253, s[8:11], s57 offen offset:2048 lds
    v_mfma_f32_16x16x32_bf16 v[208:211], a[36:39], a[236:239], v[208:211]
    s_add_u32 s57, s49, 0x9000
    ds_read_b64_tr_b16 a[90:91], v255 offset:12320
    ds_read_b64_tr_b16 a[92:93], v254 offset:12352
    v_mfma_f32_16x16x32_bf16 v[204:207], a[28:31], a[232:235], v[204:207]
    s_add_u32 m0, s50, 0x3000
    ds_read_b64_tr_b16 a[94:95], v255 offset:12352
    v_mfma_f32_16x16x32_bf16 v[204:207], a[40:43], a[236:239], v[204:207]
    v_mfma_f32_16x16x32_bf16 v[200:203], a[32:35], a[232:235], v[200:203]
    s_waitcnt vmcnt(12)
    ds_read_b128 a[232:235], v224 offset:49856
    ds_read_b64_tr_b16 a[96:97], v254 offset:24576
    v_mfma_f32_16x16x32_bf16 v[200:203], a[44:47], a[236:239], v[200:203]
    ds_read_b128 a[236:239], v227 offset:37120
    v_mfma_f32_16x16x32_bf16 v[208:211], a[48:51], a[240:243], v[208:211]
    s_waitcnt lgkmcnt(8)
    ds_read_b64_tr_b16 a[98:99], v255 offset:24576
    ds_read_b64_tr_b16 a[100:101], v254 offset:24608
    v_mfma_f32_16x16x32_bf16 v[208:211], a[60:63], a[244:247], v[208:211]
    ds_read_b64_tr_b16 a[102:103], v255 offset:24608
    ds_read_b64_tr_b16 a[104:105], v254 offset:24640
    v_mfma_f32_16x16x32_bf16 v[204:207], a[52:55], a[240:243], v[204:207]
    s_waitcnt lgkmcnt(7)
    buffer_load_dwordx4 v251, s[8:11], s57 offen lds
    v_mfma_f32_16x16x32_bf16 v[204:207], a[64:67], a[244:247], v[204:207]
    buffer_load_dwordx4 v252, s[8:11], s57 offen offset:1024 lds
    v_mfma_f32_16x16x32_bf16 v[200:203], a[56:59], a[240:243], v[200:203]
    ds_read_b128 a[240:243], v227 offset:37184
    v_cvt_pk_bf16_f32 v18, v208, v209
    v_mfma_f32_16x16x32_bf16 v[200:203], a[68:71], a[244:247], v[200:203]
    ds_read_b128 a[244:247], v227 offset:37248
    v_cvt_pk_bf16_f32 v19, v210, v211
    v_mfma_f32_16x16x32_bf16 v[180:183], a[0:3], a[248:251], 0
    v_cvt_pk_bf16_f32 v20, v204, v205
    v_cvt_pk_bf16_f32 v21, v206, v207
    v_mfma_f32_16x16x32_bf16 v[180:183], a[12:15], a[252:255], v[180:183]
    buffer_load_dwordx4 v253, s[8:11], s57 offen offset:2048 lds
    v_mfma_f32_16x16x32_bf16 v[176:179], a[4:7], a[248:251], 0
    s_add_u32 s57, s49, 0x12000
    v_cvt_pk_bf16_f32 v22, v200, v201
    v_cvt_pk_bf16_f32 v23, v202, v203
    v_mfma_f32_16x16x32_bf16 v[176:179], a[16:19], a[252:255], v[176:179]
    s_add_u32 m0, s50, 0x6000
    ds_read_b64_tr_b16 a[106:107], v255 offset:24640
    v_mfma_f32_16x16x32_bf16 v[172:175], a[8:11], a[248:251], 0
    s_waitcnt vmcnt(12)
    ds_read_b128 a[248:251], v227 offset:37312
    ds_read_b64_tr_b16 a[108:109], v254 offset:36864
    v_mfma_f32_16x16x32_bf16 v[172:175], a[20:23], a[252:255], v[172:175]
    ds_read_b128 a[252:255], v227 offset:37376
    v_mfma_f32_16x16x32_bf16 v[180:183], a[24:27], a[220:223], v[180:183]
    ds_read_b64_tr_b16 a[110:111], v255 offset:36864
    ds_read_b64_tr_b16 a[112:113], v254 offset:36896
    v_mfma_f32_16x16x32_bf16 v[180:183], a[36:39], a[224:227], v[180:183]
    ds_read_b64_tr_b16 a[114:115], v255 offset:36896
    ds_read_b64_tr_b16 a[116:117], v254 offset:36928
    v_mfma_f32_16x16x32_bf16 v[176:179], a[28:31], a[220:223], v[176:179]
    ds_read_b64_tr_b16 a[118:119], v255 offset:36928
    v_mfma_f32_16x16x32_bf16 v[176:179], a[40:43], a[224:227], v[176:179]
    s_waitcnt lgkmcnt(8)
    buffer_load_dwordx4 v251, s[8:11], s57 offen lds
    v_mfma_f32_16x16x32_bf16 v[172:175], a[32:35], a[220:223], v[172:175]
    ds_read_b128 a[220:223], v227 offset:37440
    v_mfma_f32_16x16x32_bf16 v[172:175], a[44:47], a[224:227], v[172:175]
    ds_read_b128 a[224:227], v224
    v_mfma_f32_16x16x32_bf16 v[180:183], a[48:51], a[228:231], v[180:183]
    buffer_load_dwordx4 v252, s[8:11], s57 offen offset:1024 lds
    v_mfma_f32_16x16x32_bf16 v[180:183], a[60:63], a[232:235], v[180:183]
    v_mfma_f32_16x16x32_bf16 v[176:179], a[52:55], a[228:231], v[176:179]
    buffer_load_dwordx4 v253, s[8:11], s57 offen offset:2048 lds
    v_mfma_f32_16x16x32_bf16 v[176:179], a[64:67], a[232:235], v[176:179]
    s_add_u32 s57, s49, 0x1b000
    s_add_u32 m0, s50, 0x9000
    v_mfma_f32_16x16x32_bf16 v[172:175], a[56:59], a[228:231], v[172:175]
    s_waitcnt vmcnt(12)
    ds_read_b128 a[228:231], v224 offset:64
    ds_read_b64_tr_b16 a[120:121], v254 offset:49152
    v_mfma_f32_16x16x32_bf16 v[172:175], a[68:71], a[232:235], v[172:175]
L_pg1:
    s_cbranch_execz L_pg5
    v_cvt_pk_bf16_f32 v42, v180, v181
    v_cvt_pk_bf16_f32 v43, v182, v183
    v_mfma_f32_16x16x32_bf16 v[220:223], a[0:3], a[236:239], 0
    v_cvt_pk_bf16_f32 v44, v176, v177
    v_cvt_pk_bf16_f32 v45, v178, v179
    v_mfma_f32_16x16x32_bf16 v[220:223], a[12:15], a[240:243], v[220:223]
    ds_read_b128 a[232:235], v224 offset:128
    ds_read_b64_tr_b16 a[122:123], v255 offset:49152
    v_mfma_f32_16x16x32_bf16 v[216:219], a[4:7], a[236:239], 0
    v_cvt_pk_bf16_f32 v46, v172, v173
    v_cvt_pk_bf16_f32 v47, v174, v175
    v_mfma_f32_16x16x32_bf16 v[216:219], a[16:19], a[240:243], v[216:219]
    s_waitcnt lgkmcnt(4)
    buffer_load_dwordx4 v251, s[8:11], s57 offen lds
    v_mfma_f32_16x16x32_bf16 v[212:215], a[8:11], a[236:239], 0
    ds_read_b128 a[236:239], v224 offset:192
    ds_read_b64_tr_b16 a[124:125], v254 offset:49184
    v_mfma_f32_16x16x32_bf16 v[212:215], a[20:23], a[240:243], v[212:215]
    ds_read_b128 a[240:243], v224 offset:256
    v_mfma_f32_16x16x32_bf16 v[220:223], a[24:27], a[244:247], v[220:223]
    buffer_load_dwordx4 v252, s[8:11], s57 offen offset:1024 lds
    v_mfma_f32_16x16x32_bf16 v[220:223], a[36:39], a[248:251], v[220:223]
    ds_read_b64_tr_b16 a[126:127], v255 offset:49184
    ds_read_b64_tr_b16 a[128:129], v254 offset:49216
    v_mfma_f32_16x16x32_bf16 v[216:219], a[28:31], a[244:247], v[216:219]
    ds_read_b64_tr_b16 a[130:131], v255 offset:49216
    v_mfma_f32_16x16x32_bf16 v[216:219], a[40:43], a[248:251], v[216:219]
    s_waitcnt vmcnt(11)
    buffer_load_dwordx4 v253, s[8:11], s57 offen offset:2048 lds
    v_mfma_f32_16x16x32_bf16 v[212:215], a[32:35], a[244:247], v[212:215]
    s_add_u32 s57, s49, 0x24000
    ds_read_b128 a[244:247], v224 offset:320
    ds_read_b64_tr_b16 a[132:133], v254 offset:61440
    v_mfma_f32_16x16x32_bf16 v[212:215], a[44:47], a[248:251], v[212:215]
    s_add_u32 m0, s50, 0xc000
    ds_read_b128 a[248:251], v224 offset:3072
    v_mfma_f32_16x16x32_bf16 v[220:223], a[48:51], a[252:255], v[220:223]
    ds_read_b64_tr_b16 a[134:135], v255 offset:61440
    ds_read_b64_tr_b16 a[136:137], v254 offset:61472
    v_mfma_f32_16x16x32_bf16 v[220:223], a[60:63], a[220:223], v[220:223]
    ds_read_b64_tr_b16 a[138:139], v255 offset:61472
    ds_read_b64_tr_b16 a[140:141], v254 offset:61504
    v_mfma_f32_16x16x32_bf16 v[216:219], a[52:55], a[252:255], v[216:219]
    s_waitcnt lgkmcnt(7)
    buffer_load_dwordx4 v251, s[8:11], s57 offen lds
    v_mfma_f32_16x16x32_bf16 v[216:219], a[64:67], a[220:223], v[216:219]
    ds_read_b64_tr_b16 a[142:143], v255 offset:61504
    v_mfma_f32_16x16x32_bf16 v[212:215], a[56:59], a[252:255], v[212:215]
    ds_read_b128 a[252:255], v224 offset:3136
    v_cvt_pk_bf16_f32 v54, v220, v221
    v_mfma_f32_16x16x32_bf16 v[212:215], a[68:71], a[220:223], v[212:215]
    ds_read_b128 a[220:223], v224 offset:3200
    v_cvt_pk_bf16_f32 v55, v222, v223
    v_mfma_f32_16x16x32_bf16 v[208:211], a[224:227], a[72:75], 0
    v_cvt_pk_bf16_f32 v56, v216, v217
    v_cvt_pk_bf16_f32 v57, v218, v219
    v_mfma_f32_16x16x32_bf16 v[208:211], a[228:231], a[84:87], v[208:211]
    buffer_load_dwordx4 v252, s[8:11], s57 offen offset:1024 lds
    v_mfma_f32_16x16x32_bf16 v[204:207], a[224:227], a[76:79], 0
    v_cvt_pk_bf16_f32 v58, v212, v213
    v_cvt_pk_bf16_f32 v59, v214, v215
    v_mfma_f32_16x16x32_bf16 v[204:207], a[228:231], a[88:91], v[204:207]
    s_waitcnt vmcnt(11)
    buffer_load_dwordx4 v253, s[8:11], s57 offen offset:2048 lds
    v_mfma_f32_16x16x32_bf16 v[200:203], a[224:227], a[80:83], 0
    s_add_u32 s57, s49, 0x2d000
    ds_read_b128 a[224:227], v224 offset:3264
    ds_read_b64_tr_b16 a[144:145], v254
    v_mfma_f32_16x16x32_bf16 v[200:203], a[228:231], a[92:95], v[200:203]
    s_add_u32 m0, s50, 0xf000
    ds_read_b128 a[228:231], v224 offset:3328
    v_mfma_f32_16x16x32_bf16 v[208:211], a[232:235], a[96:99], v[208:211]
    ds_read_b64_tr_b16 a[146:147], v255
    ds_read_b64_tr_b16 a[148:149], v254 offset:32
    v_mfma_f32_16x16x32_bf16 v[208:211], a[236:239], a[108:111], v[208:211]
    ds_read_b64_tr_b16 a[150:151], v255 offset:32
    ds_read_b64_tr_b16 a[152:153], v254 offset:64
    v_mfma_f32_16x16x32_bf16 v[204:207], a[232:235], a[100:103], v[204:207]
    s_waitcnt lgkmcnt(7)
    buffer_load_dwordx4 v251, s[8:11], s57 offen lds
    v_mfma_f32_16x16x32_bf16 v[204:207], a[236:239], a[112:115], v[204:207]
    ds_read_b64_tr_b16 a[154:155], v255 offset:64
    v_mfma_f32_16x16x32_bf16 v[200:203], a[232:235], a[104:107], v[200:203]
    ds_read_b128 a[232:235], v224 offset:3392
    v_mfma_f32_16x16x32_bf16 v[200:203], a[236:239], a[116:119], v[200:203]
    ds_read_b128 a[236:239], v224 offset:15488
    v_mfma_f32_16x16x32_bf16 v[208:211], a[240:243], a[120:123], v[208:211]
    buffer_load_dwordx4 v252, s[8:11], s57 offen offset:1024 lds
    v_mfma_f32_16x16x32_bf16 v[208:211], a[244:247], a[132:135], v[208:211]
    v_mfma_f32_16x16x32_bf16 v[204:207], a[240:243], a[124:127], v[204:207]
    v_mfma_f32_16x16x32_bf16 v[204:207], a[244:247], a[136:139], v[204:207]
    v_mfma_f32_16x16x32_bf16 v[200:203], a[240:243], a[128:131], v[200:203]
    s_waitcnt vmcnt(11)
    ds_read_b128 a[240:243], v224 offset:15552
    ds_read_b64_tr_b16 a[156:157], v254 offset:12288
    v_mfma_f32_16x16x32_bf16 v[200:203], a[244:247], a[140:143], v[200:203]
    ds_read_b128 a[244:247], v224 offset:15616
    v_mfma_f32_16x16x32_bf16 v[180:183], a[248:251], a[72:75], 0
    v_cvt_pk_bf16_f32 v66, v208, v209
    v_cvt_pk_bf16_f32 v67, v210, v211
    v_mfma_f32_16x16x32_bf16 v[180:183], a[252:255], a[84:87], v[180:183]
    v_cvt_pk_bf16_f32 v88, v204, v205
    v_cvt_pk_bf16_f32 v89, v206, v207
    v_mfma_f32_16x16x32_bf16 v[176:179], a[248:251], a[76:79], 0
    v_cvt_pk_bf16_f32 v110, v200, v201
    v_cvt_pk_bf16_f32 v111, v202, v203
    v_mfma_f32_16x16x32_bf16 v[176:179], a[252:255], a[88:91], v[176:179]
    buffer_load_dwordx4 v253, s[8:11], s57 offen offset:2048 lds
    v_mfma_f32_16x16x32_bf16 v[172:175], a[248:251], a[80:83], 0
    s_add_u32 s57, s49, 0
    ds_read_b128 a[248:251], v224 offset:15680
    ds_read_b64_tr_b16 a[158:159], v255 offset:12288
    v_mfma_f32_16x16x32_bf16 v[172:175], a[252:255], a[92:95], v[172:175]
    s_add_u32 m0, s50, 0
    ds_read_b128 a[252:255], v224 offset:15744
    v_mfma_f32_16x16x32_bf16 v[180:183], a[220:223], a[96:99], v[180:183]
    s_waitcnt lgkmcnt(5)
    buffer_load_dwordx4 v192, s[12:15], s57 offen lds
    v_mfma_f32_16x16x32_bf16 v[180:183], a[224:227], a[108:111], v[180:183]
    ds_read_b64_tr_b16 a[160:161], v254 offset:12320
    ds_read_b64_tr_b16 a[162:163], v255 offset:12320
    v_mfma_f32_16x16x32_bf16 v[176:179], a[220:223], a[100:103], v[176:179]
    buffer_load_dwordx4 v193, s[12:15], s57 offen offset:1024 lds
    v_mfma_f32_16x16x32_bf16 v[176:179], a[224:227], a[112:115], v[176:179]
    ds_read_b64_tr_b16 a[164:165], v254 offset:12352
    ds_read_b64_tr_b16 a[166:167], v255 offset:12352
    v_mfma_f32_16x16x32_bf16 v[172:175], a[220:223], a[104:107], v[172:175]
    s_waitcnt vmcnt(11)
    ds_read_b128 a[220:223], v224 offset:15808
    ds_read_b64_tr_b16 a[168:169], v254 offset:24576
    v_mfma_f32_16x16x32_bf16 v[172:175], a[224:227], a[116:119], v[172:175]
    ds_read_b128 a[224:227], v224 offset:18560
    v_mfma_f32_16x16x32_bf16 v[180:183], a[228:231], a[120:123], v[180:183]
    buffer_load_dwordx4 v194, s[12:15], s57 offen offset:2048 lds
    v_mfma_f32_16x16x32_bf16 v[180:183], a[232:235], a[132:135], v[180:183]
    s_add_u32 s57, s49, 0x3000
    ds_read_b64_tr_b16 a[170:171], v255 offset:24576
    ds_read_b64_tr_b16 a[172:173], v254 offset:24608
    v_mfma_f32_16x16x32_bf16 v[176:179], a[228:231], a[124:127], v[176:179]
    s_add_u32 m0, s50, 0x3000
    ds_read_b64_tr_b16 a[174:175], v255 offset:24608
    ds_read_b64_tr_b16 a[176:177], v254 offset:24640
    v_mfma_f32_16x16x32_bf16 v[176:179], a[232:235], a[136:139], v[176:179]
    v_cvt_pk_bf16_f32 v68, v180, v181
    v_cvt_pk_bf16_f32 v69, v182, v183
    v_mfma_f32_16x16x32_bf16 v[172:175], a[228:231], a[128:131], v[172:175]
    ds_read_b128 a[228:231], v224 offset:18624
    ds_read_b64_tr_b16 a[178:179], v255 offset:24640
    v_mfma_f32_16x16x32_bf16 v[172:175], a[232:235], a[140:143], v[172:175]
    ds_read_b128 a[232:235], v224 offset:18688
    v_mfma_f32_16x16x32_bf16 v[220:223], a[236:239], a[72:75], 0
    v_cvt_pk_bf16_f32 v90, v176, v177
    v_cvt_pk_bf16_f32 v91, v178, v179
    v_mfma_f32_16x16x32_bf16 v[220:223], a[240:243], a[84:87], v[220:223]
    s_waitcnt lgkmcnt(8)
    buffer_load_dwordx4 v192, s[12:15], s57 offen lds
    v_mfma_f32_16x16x32_bf16 v[216:219], a[236:239], a[76:79], 0
    v_mfma_f32_16x16x32_bf16 v[216:219], a[240:243], a[88:91], v[216:219]
    v_cvt_pk_bf16_f32 v112, v172, v173
    v_cvt_pk_bf16_f32 v113, v174, v175
    v_mfma_f32_16x16x32_bf16 v[212:215], a[236:239], a[80:83], 0
    s_waitcnt vmcnt(10)
    ds_read_b128 a[236:239], v224 offset:18752
    ds_read_b64_tr_b16 a[180:181], v254 offset:36864
    v_mfma_f32_16x16x32_bf16 v[212:215], a[240:243], a[92:95], v[212:215]
    ds_read_b128 a[240:243], v224 offset:18816
    v_mfma_f32_16x16x32_bf16 v[220:223], a[244:247], a[96:99], v[220:223]
    buffer_load_dwordx4 v195, s[12:15], s57 offen offset:1024 lds
    v_mfma_f32_16x16x32_bf16 v[220:223], a[248:251], a[108:111], v[220:223]
    s_addk_i32 s57, 0x3000
    buffer_load_dwordx4 v194, s[12:15], s57 offen offset:2048 lds
    v_mfma_f32_16x16x32_bf16 v[216:219], a[244:247], a[100:103], v[216:219]
    s_add_u32 s57, s49, 0x4800
    ds_read_b64_tr_b16 a[182:183], v255 offset:36864
    ds_read_b64_tr_b16 a[184:185], v254 offset:36896
    v_mfma_f32_16x16x32_bf16 v[216:219], a[248:251], a[112:115], v[216:219]
    s_add_u32 m0, s50, 0x6000
    ds_read_b64_tr_b16 a[186:187], v255 offset:36896
    ds_read_b64_tr_b16 a[188:189], v254 offset:36928
    v_mfma_f32_16x16x32_bf16 v[212:215], a[244:247], a[104:107], v[212:215]
    ds_read_b128 a[244:247], v224 offset:18880
    ds_read_b64_tr_b16 a[190:191], v255 offset:36928
    v_mfma_f32_16x16x32_bf16 v[212:215], a[248:251], a[116:119], v[212:215]
    ds_read_b128 a[248:251], v227 offset:6144
    v_mfma_f32_16x16x32_bf16 v[220:223], a[252:255], a[120:123], v[220:223]
    s_waitcnt lgkmcnt(9)
    buffer_load_dwordx4 v192, s[12:15], s57 offen lds
    v_mfma_f32_16x16x32_bf16 v[220:223], a[220:223], a[132:135], v[220:223]
    v_mfma_f32_16x16x32_bf16 v[216:219], a[252:255], a[124:127], v[216:219]
    v_mfma_f32_16x16x32_bf16 v[216:219], a[220:223], a[136:139], v[216:219]
    buffer_load_dwordx4 v193, s[12:15], s57 offen offset:1024 lds
    v_mfma_f32_16x16x32_bf16 v[212:215], a[252:255], a[128:131], v[212:215]
    s_waitcnt vmcnt(11)
    ds_read_b128 a[252:255], v227 offset:6208
    ds_read_b64_tr_b16 a[192:193], v254 offset:49152
    v_mfma_f32_16x16x32_bf16 v[212:215], a[220:223], a[140:143], v[212:215]
    ds_read_b128 a[220:223], v227 offset:6272
    v_cvt_pk_bf16_f32 v72, v220, v221
    v_mfma_f32_16x16x32_bf16 v[208:211], a[224:227], a[72:75], 0
    v_cvt_pk_bf16_f32 v73, v222, v223
    v_cvt_pk_bf16_f32 v94, v216, v217
    v_mfma_f32_16x16x32_bf16 v[208:211], a[228:231], a[84:87], v[208:211]
    ds_read_b64_tr_b16 a[194:195], v255 offset:49152
    v_cvt_pk_bf16_f32 v95, v218, v219
    v_mfma_f32_16x16x32_bf16 v[204:207], a[224:227], a[76:79], 0
    v_cvt_pk_bf16_f32 v116, v212, v213
    v_cvt_pk_bf16_f32 v117, v214, v215
    v_mfma_f32_16x16x32_bf16 v[204:207], a[228:231], a[88:91], v[204:207]
    buffer_load_dwordx4 v194, s[12:15], s57 offen offset:2048 lds
    v_mfma_f32_16x16x32_bf16 v[200:203], a[224:227], a[80:83], 0
    s_add_u32 s57, s49, 0x9000
    ds_read_b128 a[224:227], v227 offset:6336
    ds_read_b64_tr_b16 a[196:197], v254 offset:49184
    v_mfma_f32_16x16x32_bf16 v[200:203], a[228:231], a[92:95], v[200:203]
    s_add_u32 m0, s50, 0x9000
    ds_read_b128 a[228:231], v227 offset:6400
    v_mfma_f32_16x16x32_bf16 v[208:211], a[232:235], a[96:99], v[208:211]
    s_waitcnt lgkmcnt(6)
    buffer_load_dwordx4 v192, s[12:15], s57 offen lds
    v_mfma_f32_16x16x32_bf16 v[208:211], a[236:239], a[108:111], v[208:211]
    ds_read_b64_tr_b16 a[198:199], v255 offset:49184
    ds_read_b64_tr_b16 a[200:201], v254 offset:49216
    v_mfma_f32_16x16x32_bf16 v[204:207], a[232:235], a[100:103], v[204:207]
    ds_read_b64_tr_b16 a[202:203], v255 offset:49216
    v_mfma_f32_16x16x32_bf16 v[204:207], a[236:239], a[112:115], v[204:207]
    v_mfma_f32_16x16x32_bf16 v[200:203], a[232:235], a[104:107], v[200:203]
    s_waitcnt vmcnt(10)
    ds_read_b128 a[232:235], v227 offset:6464
    ds_read_b64_tr_b16 a[204:205], v254 offset:61440
    v_mfma_f32_16x16x32_bf16 v[200:203], a[236:239], a[116:119], v[200:203]
    ds_read_b128 a[236:239], v225 offset:24384
    v_mfma_f32_16x16x32_bf16 v[208:211], a[240:243], a[120:123], v[208:211]
    buffer_load_dwordx4 v193, s[12:15], s57 offen offset:1024 lds
    v_mfma_f32_16x16x32_bf16 v[208:211], a[244:247], a[132:135], v[208:211]
    ds_read_b64_tr_b16 a[206:207], v255 offset:61440
    ds_read_b64_tr_b16 a[208:209], v254 offset:61472
    v_mfma_f32_16x16x32_bf16 v[204:207], a[240:243], a[124:127], v[204:207]
    buffer_load_dwordx4 v194, s[12:15], s57 offen offset:2048 lds
    v_mfma_f32_16x16x32_bf16 v[204:207], a[244:247], a[136:139], v[204:207]
    s_add_u32 s57, s49, 0xc000
    ds_read_b64_tr_b16 a[210:211], v255 offset:61472
    ds_read_b64_tr_b16 a[212:213], v254 offset:61504
    v_mfma_f32_16x16x32_bf16 v[200:203], a[240:243], a[128:131], v[200:203]
    s_add_u32 m0, s50, 0xc000
    v_cvt_pk_bf16_f32 v70, v208, v209
    v_cvt_pk_bf16_f32 v71, v210, v211
    v_mfma_f32_16x16x32_bf16 v[200:203], a[244:247], a[140:143], v[200:203]
    v_cvt_pk_bf16_f32 v92, v204, v205
    v_cvt_pk_bf16_f32 v93, v206, v207
    v_mfma_f32_16x16x32_bf16 v[180:183], a[248:251], a[72:75], 0
    ds_read_b128 a[240:243], v225 offset:24448
    ds_read_b128 a[244:247], v225 offset:24512
    v_mfma_f32_16x16x32_bf16 v[180:183], a[252:255], a[84:87], v[180:183]
    s_waitcnt lgkmcnt(7)
    buffer_load_dwordx4 v192, s[12:15], s57 offen lds
    v_mfma_f32_16x16x32_bf16 v[176:179], a[248:251], a[76:79], 0
    v_cvt_pk_bf16_f32 v114, v200, v201
    v_cvt_pk_bf16_f32 v115, v202, v203
    v_mfma_f32_16x16x32_bf16 v[176:179], a[252:255], a[88:91], v[176:179]
    ds_read_b64_tr_b16 a[214:215], v255 offset:61504
    v_mfma_f32_16x16x32_bf16 v[172:175], a[248:251], a[80:83], 0
    ds_read_b128 a[248:251], v225 offset:24576
    v_mfma_f32_16x16x32_bf16 v[172:175], a[252:255], a[92:95], v[172:175]
    ds_read_b128 a[252:255], v225 offset:24640
    v_mfma_f32_16x16x32_bf16 v[180:183], a[220:223], a[96:99], v[180:183]
    buffer_load_dwordx4 v195, s[12:15], s57 offen offset:1024 lds
    v_mfma_f32_16x16x32_bf16 v[180:183], a[224:227], a[108:111], v[180:183]
    s_addk_i32 s57, 0x3000
    v_mfma_f32_16x16x32_bf16 v[176:179], a[220:223], a[100:103], v[176:179]
    v_mfma_f32_16x16x32_bf16 v[176:179], a[224:227], a[112:115], v[176:179]
    buffer_load_dwordx4 v194, s[12:15], s57 offen offset:2048 lds
    v_mfma_f32_16x16x32_bf16 v[172:175], a[220:223], a[104:107], v[172:175]
    s_add_u32 s57, s49, 0xd800
    ds_read_b128 a[220:223], v225 offset:24704
    s_add_u32 m0, s50, 0xf000
    v_mfma_f32_16x16x32_bf16 v[172:175], a[224:227], a[116:119], v[172:175]
    ds_read_b128 a[224:227], v225 offset:27456
    v_mfma_f32_16x16x32_bf16 v[180:183], a[228:231], a[120:123], v[180:183]
    v_mfma_f32_16x16x32_bf16 v[180:183], a[232:235], a[132:135], v[180:183]
    s_waitcnt lgkmcnt(2)
    buffer_load_dwordx4 v192, s[12:15], s57 offen lds
    v_mfma_f32_16x16x32_bf16 v[176:179], a[228:231], a[124:127], v[176:179]
    v_mfma_f32_16x16x32_bf16 v[176:179], a[232:235], a[136:139], v[176:179]
    v_mfma_f32_16x16x32_bf16 v[172:175], a[228:231], a[128:131], v[172:175]
    ds_read_b128 a[228:231], v225 offset:27520
    v_mfma_f32_16x16x32_bf16 v[172:175], a[232:235], a[140:143], v[172:175]
    ds_read_b128 a[232:235], v225 offset:27584
    v_mfma_f32_16x16x32_bf16 v[220:223], a[144:147], a[236:239], 0
    v_cvt_pk_bf16_f32 v82, v180, v181
    v_cvt_pk_bf16_f32 v83, v182, v183
    v_mfma_f32_16x16x32_bf16 v[220:223], a[156:159], a[240:243], v[220:223]
    v_cvt_pk_bf16_f32 v104, v176, v177
    v_cvt_pk_bf16_f32 v105, v178, v179
    v_mfma_f32_16x16x32_bf16 v[216:219], a[148:151], a[236:239], 0
    v_cvt_pk_bf16_f32 v126, v172, v173
    v_cvt_pk_bf16_f32 v127, v174, v175
    v_mfma_f32_16x16x32_bf16 v[216:219], a[160:163], a[240:243], v[216:219]
    buffer_load_dwordx4 v193, s[12:15], s57 offen offset:1024 lds
    v_mfma_f32_16x16x32_bf16 v[212:215], a[152:155], a[236:239], 0
    ds_read_b128 a[236:239], v225 offset:27648
    v_mfma_f32_16x16x32_bf16 v[212:215], a[164:167], a[240:243], v[212:215]
    ds_read_b128 a[240:243], v225 offset:27712
    v_mfma_f32_16x16x32_bf16 v[220:223], a[168:171], a[244:247], v[220:223]
    buffer_load_dwordx4 v194, s[12:15], s57 offen offset:2048 lds
    v_mfma_f32_16x16x32_bf16 v[220:223], a[180:183], a[248:251], v[220:223]
    s_add_u32 m0, s41, 0
    v_mfma_f32_16x16x32_bf16 v[216:219], a[172:175], a[244:247], v[216:219]
    v_mfma_f32_16x16x32_bf16 v[216:219], a[184:187], a[248:251], v[216:219]
    v_mfma_f32_16x16x32_bf16 v[212:215], a[176:179], a[244:247], v[212:215]
    ds_read_b128 a[244:247], v225 offset:27776
    v_mfma_f32_16x16x32_bf16 v[212:215], a[188:191], a[248:251], v[212:215]
    ds_read_b128 a[248:251], v224 offset:30976
    v_mfma_f32_16x16x32_bf16 v[220:223], a[192:195], a[252:255], v[220:223]
    s_waitcnt lgkmcnt(3)
    v_mfma_f32_16x16x32_bf16 v[220:223], a[204:207], a[220:223], v[220:223]
    v_mfma_f32_16x16x32_bf16 v[216:219], a[196:199], a[252:255], v[216:219]
    v_mfma_f32_16x16x32_bf16 v[216:219], a[208:211], a[220:223], v[216:219]
    v_mfma_f32_16x16x32_bf16 v[212:215], a[200:203], a[252:255], v[212:215]
    s_waitcnt lgkmcnt(1)
    ds_read_b128 a[252:255], v224 offset:31040
    v_mfma_f32_16x16x32_bf16 v[212:215], a[212:215], a[220:223], v[212:215]
    s_barrier
    ds_read_b128 a[220:223], v224 offset:31104
    v_mfma_f32_16x16x32_bf16 v[208:211], a[144:147], a[224:227], 0
    v_mul_f32 v220, s37, v220
    v_mul_f32 v221, s37, v221
    v_mfma_f32_16x16x32_bf16 v[208:211], a[156:159], a[228:231], v[208:211]
    v_mul_f32 v222, s37, v222
    v_mul_f32 v223, s37, v223
    v_mfma_f32_16x16x32_bf16 v[204:207], a[148:151], a[224:227], 0
    v_cvt_pk_bf16_f32 v132, v220, v221
    v_cvt_pk_bf16_f32 v133, v222, v223
    v_mfma_f32_16x16x32_bf16 v[204:207], a[160:163], a[228:231], v[204:207]
    v_mul_f32 v216, s37, v216
    v_mul_f32 v217, s37, v217
    v_mfma_f32_16x16x32_bf16 v[200:203], a[152:155], a[224:227], 0
    v_mul_f32 v218, s37, v218
    v_mul_f32 v219, s37, v219
    v_mfma_f32_16x16x32_bf16 v[200:203], a[164:167], a[228:231], v[200:203]
    v_cvt_pk_bf16_f32 v134, v216, v217
    v_cvt_pk_bf16_f32 v135, v218, v219
    v_mfma_f32_16x16x32_bf16 v[208:211], a[168:171], a[232:235], v[208:211]
    v_mul_f32 v212, s37, v212
    v_mul_f32 v213, s37, v213
    v_mfma_f32_16x16x32_bf16 v[208:211], a[180:183], a[236:239], v[208:211]
    v_mul_f32 v214, s37, v214
    v_mul_f32 v215, s37, v215
    v_mfma_f32_16x16x32_bf16 v[144:147], v[0:3], v[132:135], v[144:147]
    v_cvt_pk_bf16_f32 v136, v212, v213
    v_cvt_pk_bf16_f32 v137, v214, v215
    v_mfma_f32_16x16x32_bf16 v[148:151], v[24:27], v[132:135], v[148:151]
    ds_read_b128 a[224:227], v224 offset:31168
    ds_read_b128 a[228:231], v224 offset:31232
    v_mfma_f32_16x16x32_bf16 v[152:155], v[30:33], v[132:135], v[152:155]
    buffer_load_dwordx4 v246, s[4:7], s56 offen lds
    v_mfma_f32_16x16x16_bf16 v[144:147], v[4:5], v[136:137], v[144:147]
    s_waitcnt vmcnt(7)
    buffer_load_dwordx4 v247, s[4:7], s56 offen offset:1024 lds
    v_mfma_f32_16x16x16_bf16 v[148:151], v[28:29], v[136:137], v[148:151]
    s_add_u32 s56, s56, s42
    ds_read_b64_tr_b16 v[160:161], v86 offset:36864
    ds_read_b64_tr_b16 v[162:163], v86 offset:38400
    v_mfma_f32_16x16x16_bf16 v[152:155], v[34:35], v[136:137], v[152:155]
    s_add_u32 m0, s41, 0x1e40
    ds_read_b64_tr_b16 v[164:165], v86 offset:36896
    ds_read_b64_tr_b16 v[166:167], v86 offset:38432
    v_mfma_f32_16x16x32_bf16 v[204:207], a[172:175], a[232:235], v[204:207]
    ds_read_b64_tr_b16 v[168:169], v86 offset:36928
    ds_read_b64_tr_b16 v[170:171], v86 offset:38464
    v_mfma_f32_16x16x32_bf16 v[204:207], a[184:187], a[236:239], v[204:207]
    buffer_load_dwordx4 v246, s[4:7], s56 offen lds
    v_mfma_f32_16x16x32_bf16 v[200:203], a[176:179], a[232:235], v[200:203]
    s_waitcnt vmcnt(6)
    ds_read_b128 a[232:235], v224 offset:31296
    ds_read_b64_tr_b16 v[248:249], v86 offset:49152
    v_mfma_f32_16x16x32_bf16 v[200:203], a[188:191], a[236:239], v[200:203]
    ds_read_b128 a[236:239], v224 offset:34048
    v_mfma_f32_16x16x32_bf16 v[208:211], a[192:195], a[240:243], v[208:211]
    ds_read_b64_tr_b16 v[250:251], v86 offset:50688
    v_mfma_f32_16x16x32_bf16 v[208:211], a[204:207], a[244:247], v[208:211]
    buffer_load_dwordx4 v247, s[4:7], s56 offen offset:1024 lds
    v_mfma_f32_16x16x32_bf16 v[204:207], a[196:199], a[240:243], v[204:207]
    s_add_u32 s56, s56, s42
    v_exp_f32 v144, v144
    v_mfma_f32_16x16x32_bf16 v[204:207], a[208:211], a[244:247], v[204:207]
    s_add_u32 m0, s41, 0x3c80
    v_exp_f32 v145, v145
    v_mfma_f32_16x16x32_bf16 v[200:203], a[200:203], a[240:243], v[200:203]
    v_mul_f32 v208, s37, v208
    v_mul_f32 v209, s37, v209
    v_mfma_f32_16x16x32_bf16 v[200:203], a[212:215], a[244:247], v[200:203]
    s_waitcnt lgkmcnt(4)
    v_mul_f32 v210, s37, v210
    v_mul_f32 v211, s37, v211
    v_mfma_f32_16x16x32_bf16 v[180:183], a[248:251], a[72:75], 0
    v_cvt_pk_bf16_f32 v138, v208, v209
    v_cvt_pk_bf16_f32 v139, v210, v211
    v_mfma_f32_16x16x32_bf16 v[180:183], a[252:255], a[84:87], v[180:183]
    v_mul_f32 v204, s37, v204
    v_mul_f32 v205, s37, v205
    v_mfma_f32_16x16x32_bf16 v[176:179], a[248:251], a[76:79], 0
    v_mul_f32 v206, s37, v206
    v_mul_f32 v207, s37, v207
    v_mfma_f32_16x16x32_bf16 v[176:179], a[252:255], a[88:91], v[176:179]
    v_cvt_pk_bf16_f32 v140, v204, v205
    v_cvt_pk_bf16_f32 v141, v206, v207
    v_mfma_f32_16x16x32_bf16 v[172:175], a[248:251], a[80:83], 0
    v_mul_f32 v200, s37, v200
    v_mul_f32 v201, s37, v201
    v_mfma_f32_16x16x32_bf16 v[172:175], a[252:255], a[92:95], v[172:175]
    v_mul_f32 v202, s37, v202
    v_mul_f32 v203, s37, v203
    v_mfma_f32_16x16x32_bf16 v[180:183], a[220:223], a[96:99], v[180:183]
    v_cvt_pk_bf16_f32 v142, v200, v201
    v_cvt_pk_bf16_f32 v143, v202, v203
    v_mfma_f32_16x16x32_bf16 v[180:183], a[224:227], a[108:111], v[180:183]
    ds_read_b128 a[240:243], v224 offset:34112
    ds_read_b128 a[244:247], v224 offset:34176
    v_mfma_f32_16x16x32_bf16 v[176:179], a[220:223], a[100:103], v[176:179]
    ds_read_b128 a[248:251], v224 offset:34240
    v_cvt_pk_bf16_f32 v156, v144, v145
    v_mfma_f32_16x16x32_bf16 v[176:179], a[224:227], a[112:115], v[176:179]
    ds_read_b128 a[252:255], v224 offset:34304
    v_mfma_f32_16x16x32_bf16 v[172:175], a[220:223], a[104:107], v[172:175]
    ds_read_b128 a[220:223], v224 offset:34368
    v_mfma_f32_16x16x32_bf16 v[172:175], a[224:227], a[116:119], v[172:175]
    ds_read_b128 a[224:227], v224 offset:46464
    v_mfma_f32_16x16x32_bf16 v[180:183], a[228:231], a[120:123], v[180:183]
    s_waitcnt lgkmcnt(6)
    buffer_load_dwordx4 v246, s[4:7], s56 offen lds
    v_mfma_f32_16x16x32_bf16 v[180:183], a[232:235], a[132:135], v[180:183]
    buffer_load_dwordx4 v247, s[4:7], s56 offen offset:1024 lds
    v_mfma_f32_16x16x32_bf16 v[176:179], a[228:231], a[124:127], v[176:179]
    s_add_u32 s56, s56, s42
    v_exp_f32 v146, v146
    v_mfma_f32_16x16x32_bf16 v[176:179], a[232:235], a[136:139], v[176:179]
    s_add_u32 m0, s41, 0x5ac0
    v_exp_f32 v147, v147
    v_mfma_f32_16x16x32_bf16 v[172:175], a[228:231], a[128:131], v[172:175]
    v_cvt_pk_bf16_f32 v74, v180, v181
    v_cvt_pk_bf16_f32 v75, v182, v183
    v_mfma_f32_16x16x32_bf16 v[172:175], a[232:235], a[140:143], v[172:175]
    ds_read_b128 a[228:231], v224 offset:46528
    ds_read_b128 a[232:235], v224 offset:46592
    v_mfma_f32_16x16x32_bf16 v[220:223], a[236:239], a[72:75], 0
    s_waitcnt lgkmcnt(4)
    v_cvt_pk_bf16_f32 v96, v176, v177
    v_cvt_pk_bf16_f32 v97, v178, v179
    v_mfma_f32_16x16x32_bf16 v[220:223], a[240:243], a[84:87], v[220:223]
    buffer_load_dwordx4 v246, s[4:7], s56 offen lds
    v_mfma_f32_16x16x32_bf16 v[216:219], a[236:239], a[76:79], 0
    v_cvt_pk_bf16_f32 v118, v172, v173
    v_cvt_pk_bf16_f32 v119, v174, v175
    v_mfma_f32_16x16x32_bf16 v[216:219], a[240:243], a[88:91], v[216:219]
    buffer_load_dwordx4 v247, s[4:7], s56 offen offset:1024 lds
    v_mfma_f32_16x16x32_bf16 v[212:215], a[236:239], a[80:83], 0
    s_add_u32 s56, s56, s42
    ds_read_b128 a[236:239], v224 offset:46656
    v_cvt_pk_bf16_f32 v157, v146, v147
    v_mfma_f32_16x16x32_bf16 v[212:215], a[240:243], a[92:95], v[212:215]
    s_add_u32 m0, s41, 0x7900
    ds_read_b128 v[144:147], v234
    v_bfe_u32 v234, s62, v232, 4
    v_mfma_f32_16x16x32_bf16 v[220:223], a[244:247], a[96:99], v[220:223]
    ds_read_b128 a[240:243], v224 offset:46720
    v_mad_u32_u24 v235, v234, s40, v229
    v_mfma_f32_16x16x32_bf16 v[220:223], a[248:251], a[108:111], v[220:223]
    v_mad_u32_u24 v234, v234, s40, v228
    v_mfma_f32_16x16x32_bf16 v[216:219], a[244:247], a[100:103], v[216:219]
    v_exp_f32 v148, v148
    v_mfma_f32_16x16x32_bf16 v[216:219], a[248:251], a[112:115], v[216:219]
    v_exp_f32 v149, v149
    v_mfma_f32_16x16x32_bf16 v[212:215], a[244:247], a[104:107], v[212:215]
    ds_read_b128 a[244:247], v224 offset:46784
    v_cvt_pk_bf16_f32 v158, v148, v149
    v_mfma_f32_16x16x32_bf16 v[212:215], a[248:251], a[116:119], v[212:215]
    ds_read_b128 a[248:251], v224 offset:49536
    v_mfma_f32_16x16x32_bf16 v[220:223], a[252:255], a[120:123], v[220:223]
    s_waitcnt lgkmcnt(4)
    v_exp_f32 v150, v150
    v_mfma_f32_16x16x32_bf16 v[220:223], a[220:223], a[132:135], v[220:223]
    s_waitcnt lgkmcnt(3)
    v_exp_f32 v151, v151
    v_mfma_f32_16x16x32_bf16 v[144:147], v[6:9], v[132:135], v[144:147]
    v_cvt_pk_bf16_f32 v159, v150, v151
    v_mfma_f32_16x16x32_bf16 v[216:219], a[252:255], a[124:127], v[216:219]
    ds_read_b128 v[148:151], v228 offset:1920
    v_mfma_f32_16x16x32_bf16 v[216:219], a[220:223], a[136:139], v[216:219]
    v_exp_f32 v152, v152
    v_mfma_f32_16x16x32_bf16 v[196:199], a[216:219], v[156:159], 0
    v_cvt_pk_bf16_f32 v76, v220, v221
    v_cvt_pk_bf16_f32 v77, v222, v223
    v_mfma_f32_16x16x32_bf16 v[184:187], v[66:69], v[156:159], 0
    v_exp_f32 v153, v153
    v_mfma_f32_16x16x32_bf16 v[188:191], v[88:91], v[156:159], 0
    v_exp_f32 v154, v154
    v_mfma_f32_16x16x32_bf16 v[192:195], v[110:113], v[156:159], 0
    v_cvt_pk_bf16_f32 v98, v216, v217
    v_cvt_pk_bf16_f32 v99, v218, v219
    v_mfma_f32_16x16x16_bf16 v[144:147], v[10:11], v[136:137], v[144:147]
    v_exp_f32 v155, v155
    v_mfma_f32_16x16x32_bf16 v[212:215], a[252:255], a[128:131], v[212:215]
    ds_read_b128 a[252:255], v224 offset:49600
    v_cvt_pk_bf16_f32 v156, v152, v153
    v_mfma_f32_16x16x32_bf16 v[212:215], a[220:223], a[140:143], v[212:215]
    s_waitcnt lgkmcnt(1)
    ds_read_b128 a[220:223], v224 offset:49664
    v_cvt_pk_bf16_f32 v157, v154, v155
    v_mfma_f32_16x16x32_bf16 v[148:151], v[12:15], v[132:135], v[148:151]
    ds_read_b128 v[152:155], v229 offset:1920
    v_mfma_f32_16x16x32_bf16 v[208:211], a[224:227], a[72:75], 0
    v_exp_f32 v144, v144
    v_mfma_f32_16x16x32_bf16 v[208:211], a[228:231], a[84:87], v[208:211]
    v_exp_f32 v145, v145
    v_mfma_f32_16x16x32_bf16 v[204:207], a[224:227], a[76:79], 0
    v_cvt_pk_bf16_f32 v120, v212, v213
    v_cvt_pk_bf16_f32 v121, v214, v215
    v_mfma_f32_16x16x32_bf16 v[204:207], a[228:231], a[88:91], v[204:207]
    v_exp_f32 v146, v146
    v_mfma_f32_16x16x16_bf16 v[148:151], v[16:17], v[136:137], v[148:151]
    v_exp_f32 v147, v147
    v_mfma_f32_16x16x32_bf16 v[200:203], a[224:227], a[80:83], 0
    ds_read_b128 a[224:227], v224 offset:49728
    v_cvt_pk_bf16_f32 v158, v144, v145
    v_mfma_f32_16x16x32_bf16 v[200:203], a[228:231], a[92:95], v[200:203]
    s_waitcnt lgkmcnt(1)
    ds_read_b128 a[228:231], v224 offset:49792
    v_cvt_pk_bf16_f32 v159, v146, v147
    v_mfma_f32_16x16x32_bf16 v[152:155], v[36:39], v[132:135], v[152:155]
    ds_read_b128 v[144:147], v235
    v_bfe_u32 v235, s61, v232, 4
    v_mfma_f32_16x16x32_bf16 v[196:199], a[216:219], v[156:159], v[196:199]
    v_mad_u32_u24 v235, v235, s40, v230
    v_mfma_f32_16x16x32_bf16 v[184:187], v[70:73], v[156:159], v[184:187]
    v_exp_f32 v148, v148
    v_mfma_f32_16x16x32_bf16 v[188:191], v[92:95], v[156:159], v[188:191]
    v_exp_f32 v149, v149
    v_mfma_f32_16x16x32_bf16 v[192:195], v[114:117], v[156:159], v[192:195]
    v_exp_f32 v150, v150
    v_mfma_f32_16x16x16_bf16 v[152:155], v[40:41], v[136:137], v[152:155]
    v_exp_f32 v151, v151
    v_mfma_f32_16x16x32_bf16 v[208:211], a[232:235], a[96:99], v[208:211]
    v_cvt_pk_bf16_f32 v156, v148, v149
    v_cvt_pk_bf16_f32 v157, v150, v151
    v_mfma_f32_16x16x32_bf16 v[208:211], a[236:239], a[108:111], v[208:211]
    s_waitcnt lgkmcnt(0)
    ds_read_b128 v[148:151], v234
    v_bfe_u32 v234, s60, v232, 4
    v_mfma_f32_16x16x32_bf16 v[144:147], v[42:45], v[132:135], v[144:147]
L_pg2:
    s_cbranch_execz L_pg6
    v_mad_u32_u24 v234, v234, s40, v230
    v_mfma_f32_16x16x32_bf16 v[204:207], a[232:235], a[100:103], v[204:207]
    v_exp_f32 v152, v152
    v_mfma_f32_16x16x32_bf16 v[204:207], a[236:239], a[112:115], v[204:207]
    v_exp_f32 v153, v153
    v_mfma_f32_16x16x32_bf16 v[200:203], a[232:235], a[104:107], v[200:203]
    s_waitcnt vmcnt(4)
    ds_read_b128 a[232:235], v224 offset:49856
    v_cvt_pk_bf16_f32 v158, v152, v153
    v_mfma_f32_16x16x32_bf16 v[200:203], a[236:239], a[116:119], v[200:203]
    s_barrier
    ds_read_b128 a[236:239], v227 offset:37120
    ds_read_b128 v[252:255], v224 offset:320
    v_mfma_f32_16x16x16_bf16 v[144:147], v[46:47], v[136:137], v[144:147]
    v_exp_f32 v154, v154
    v_mfma_f32_16x16x32_bf16 v[208:211], a[240:243], a[120:123], v[208:211]
    v_exp_f32 v155, v155
    v_mfma_f32_16x16x32_bf16 v[208:211], a[244:247], a[132:135], v[208:211]
    s_waitcnt lgkmcnt(3)
    v_cvt_pk_bf16_f32 v159, v154, v155
    v_mfma_f32_16x16x32_bf16 v[148:151], v[18:21], v[132:135], v[148:151]
    ds_read_b128 v[152:155], v234
    v_bfe_u32 v234, s62, v232, 4
    v_mfma_f32_16x16x32_bf16 v[196:199], a[216:219], v[156:159], v[196:199]
    v_mad_u32_u24 v234, v234, s40, v230
    v_mfma_f32_16x16x32_bf16 v[184:187], v[74:77], v[156:159], v[184:187]
    v_exp_f32 v144, v144
    v_mfma_f32_16x16x32_bf16 v[188:191], v[96:99], v[156:159], v[188:191]
    v_cvt_pk_bf16_f32 v80, v208, v209
    v_cvt_pk_bf16_f32 v81, v210, v211
    v_mfma_f32_16x16x32_bf16 v[192:195], v[118:121], v[156:159], v[192:195]
    v_exp_f32 v145, v145
    v_mfma_f32_16x16x16_bf16 v[148:151], v[22:23], v[136:137], v[148:151]
    v_exp_f32 v146, v146
    v_mfma_f32_16x16x32_bf16 v[204:207], a[240:243], a[124:127], v[204:207]
    v_exp_f32 v147, v147
    v_mfma_f32_16x16x32_bf16 v[204:207], a[244:247], a[136:139], v[204:207]
    s_waitcnt lgkmcnt(0)
    v_cvt_pk_bf16_f32 v156, v144, v145
    v_cvt_pk_bf16_f32 v157, v146, v147
    v_mfma_f32_16x16x32_bf16 v[152:155], v[24:27], v[138:141], v[152:155]
    ds_read_b128 v[144:147], v235
    v_bfe_u32 v235, s63, v233, 4
    v_mfma_f32_16x16x32_bf16 v[200:203], a[240:243], a[128:131], v[200:203]
    ds_read_b128 a[240:243], v227 offset:37184
    v_mad_u32_u24 v235, v235, s40, v231
    v_mfma_f32_16x16x32_bf16 v[200:203], a[244:247], a[140:143], v[200:203]
    v_cvt_pk_bf16_f32 v102, v204, v205
    v_cvt_pk_bf16_f32 v103, v206, v207
    v_mfma_f32_16x16x16_bf16 v[152:155], v[28:29], v[142:143], v[152:155]
    ds_read_b128 a[244:247], v227 offset:37248
    v_mfma_f32_16x16x32_bf16 v[180:183], a[248:251], a[72:75], 0
    v_exp_f32 v148, v148
    v_mfma_f32_16x16x32_bf16 v[180:183], a[252:255], a[84:87], v[180:183]
    v_exp_f32 v149, v149
    v_mfma_f32_16x16x32_bf16 v[176:179], a[248:251], a[76:79], 0
    v_cvt_pk_bf16_f32 v124, v200, v201
    v_cvt_pk_bf16_f32 v125, v202, v203
    v_mfma_f32_16x16x32_bf16 v[176:179], a[252:255], a[88:91], v[176:179]
    s_waitcnt lgkmcnt(2)
    v_exp_f32 v150, v150
    v_mfma_f32_16x16x32_bf16 v[144:147], v[30:33], v[138:141], v[144:147]
    v_exp_f32 v151, v151
    v_mfma_f32_16x16x32_bf16 v[172:175], a[248:251], a[80:83], 0
    ds_read_b128 a[248:251], v227 offset:37312
    v_cvt_pk_bf16_f32 v158, v148, v149
    v_mfma_f32_16x16x32_bf16 v[172:175], a[252:255], a[92:95], v[172:175]
    ds_read_b128 a[252:255], v227 offset:37376
    v_cvt_pk_bf16_f32 v159, v150, v151
    v_mfma_f32_16x16x16_bf16 v[144:147], v[34:35], v[142:143], v[144:147]
    ds_read_b128 v[148:151], v230 offset:1920
    v_mfma_f32_16x16x32_bf16 v[196:199], a[216:219], v[156:159], v[196:199]
    v_exp_f32 v152, v152
    v_mfma_f32_16x16x32_bf16 v[180:183], a[220:223], a[96:99], v[180:183]
    v_exp_f32 v153, v153
    v_mfma_f32_16x16x32_bf16 v[180:183], a[224:227], a[108:111], v[180:183]
    s_waitcnt vmcnt(0)
    ds_write_b128 v87, v[160:163] offset:36864
    v_mfma_f32_16x16x32_bf16 v[176:179], a[220:223], a[100:103], v[176:179]
    ds_write_b128 v87, v[164:167] offset:37888
    v_mfma_f32_16x16x32_bf16 v[176:179], a[224:227], a[112:115], v[176:179]
    s_waitcnt lgkmcnt(2)
    v_rcp_f32 v197, v196
    v_mfma_f32_16x16x32_bf16 v[148:151], v[36:39], v[138:141], v[148:151]
    v_max3_f32 v236, v236, v196, v197
    v_mfma_f32_16x16x32_bf16 v[172:175], a[220:223], a[104:107], v[172:175]
    ds_write_b128 v87, v[168:171] offset:38912
    v_mfma_f32_16x16x32_bf16 v[172:175], a[224:227], a[116:119], v[172:175]
    v_exp_f32 v154, v154
    v_mfma_f32_16x16x32_bf16 v[180:183], a[228:231], a[120:123], v[180:183]
    v_exp_f32 v155, v155
    v_mfma_f32_16x16x32_bf16 v[180:183], a[232:235], a[132:135], v[180:183]
    v_exp_f32 v144, v144
    v_mfma_f32_16x16x16_bf16 v[148:151], v[40:41], v[142:143], v[148:151]
    v_exp_f32 v145, v145
    v_mfma_f32_16x16x32_bf16 v[176:179], a[228:231], a[124:127], v[176:179]
    v_exp_f32 v146, v146
    v_mfma_f32_16x16x32_bf16 v[176:179], a[232:235], a[136:139], v[176:179]
    ds_read_b128 a[220:223], v227 offset:37440
    ds_read_b128 a[224:227], v225 offset:39872
    v_mfma_f32_16x16x32_bf16 v[172:175], a[228:231], a[128:131], v[172:175]
    v_cvt_pk_bf16_f32 v78, v180, v181
    v_cvt_pk_bf16_f32 v79, v182, v183
    v_mfma_f32_16x16x32_bf16 v[172:175], a[232:235], a[140:143], v[172:175]
    ds_read_b128 a[228:231], v225 offset:39936
    ds_read_b128 a[232:235], v225 offset:40000
    v_mfma_f32_16x16x32_bf16 v[184:187], v[78:81], v[156:159], v[184:187]
    v_cvt_pk_bf16_f32 v100, v176, v177
    v_cvt_pk_bf16_f32 v101, v178, v179
    v_mfma_f32_16x16x32_bf16 v[220:223], a[236:239], a[72:75], 0
    ds_read_b128 v[160:163], v224 offset:3328
    ds_read_b128 v[164:167], v224 offset:3392
    v_mfma_f32_16x16x32_bf16 v[220:223], a[240:243], a[84:87], v[220:223]
    v_cvt_pk_bf16_f32 v122, v172, v173
    v_cvt_pk_bf16_f32 v123, v174, v175
    v_mfma_f32_16x16x32_bf16 v[188:191], v[100:103], v[156:159], v[188:191]
    v_mul_f32 v184, v184, v197
    v_mul_f32 v185, v185, v197
    v_mfma_f32_16x16x32_bf16 v[192:195], v[122:125], v[156:159], v[192:195]
    v_cvt_pk_bf16_f32 v184, v184, v185
    v_mul_f32 v186, v186, v197
    v_mfma_f32_16x16x32_bf16 v[216:219], a[236:239], a[76:79], 0
    ds_read_b64_tr_b16 v[168:169], v86 offset:61440
    v_mul_f32 v187, v187, v197
    v_mfma_f32_16x16x32_bf16 v[216:219], a[240:243], a[88:91], v[216:219]
    v_cvt_pk_bf16_f32 v185, v186, v187
    v_mul_f32 v188, v188, v197
    v_mfma_f32_16x16x32_bf16 v[212:215], a[236:239], a[80:83], 0
    ds_read_b128 a[236:239], v225 offset:40064
    v_mul_f32 v189, v189, v197
    v_mfma_f32_16x16x32_bf16 v[212:215], a[240:243], a[92:95], v[212:215]
    ds_read_b128 a[240:243], v225 offset:40128
    v_cvt_pk_bf16_f32 v186, v188, v189
    v_mfma_f32_16x16x32_bf16 v[220:223], a[244:247], a[96:99], v[220:223]
    v_mul_f32 v190, v190, v197
    v_mul_f32 v191, v191, v197
    v_mfma_f32_16x16x32_bf16 v[220:223], a[248:251], a[108:111], v[220:223]
    v_cvt_pk_bf16_f32 v187, v190, v191
    v_mul_f32 v192, v192, v197
    v_mfma_f32_16x16x32_bf16 v[216:219], a[244:247], a[100:103], v[216:219]
    v_mul_f32 v193, v193, v197
    v_cvt_pk_bf16_f32 v188, v192, v193
    v_mfma_f32_16x16x32_bf16 v[216:219], a[248:251], a[112:115], v[216:219]
    v_mul_f32 v194, v194, v197
    v_mul_f32 v195, v195, v197
    v_mfma_f32_16x16x32_bf16 v[212:215], a[244:247], a[104:107], v[212:215]
    ds_read_b128 a[244:247], v225 offset:40192
    v_cvt_pk_bf16_f32 v189, v194, v195
    v_mfma_f32_16x16x32_bf16 v[212:215], a[248:251], a[116:119], v[212:215]
    ds_write_b128 v237, v[184:187]
    v_mfma_f32_16x16x32_bf16 v[220:223], a[252:255], a[120:123], v[220:223]
    s_waitcnt lgkmcnt(3)
    ds_write_b64 v238, v[188:189]
    v_mfma_f32_16x16x32_bf16 v[220:223], a[220:223], a[132:135], v[220:223]
    v_cvt_pk_bf16_f32 v156, v152, v153
    v_cvt_pk_bf16_f32 v157, v154, v155
    v_mfma_f32_16x16x32_bf16 v[216:219], a[252:255], a[124:127], v[216:219]
    v_exp_f32 v147, v147
    v_mfma_f32_16x16x32_bf16 v[216:219], a[220:223], a[136:139], v[216:219]
    v_cvt_pk_bf16_f32 v158, v144, v145
    v_cvt_pk_bf16_f32 v159, v146, v147
    v_mfma_f32_16x16x32_bf16 v[212:215], a[252:255], a[128:131], v[212:215]
    ds_read_b128 v[152:155], v234
    v_bfe_u32 v234, s64, v233, 4
    v_mfma_f32_16x16x32_bf16 v[212:215], a[220:223], a[140:143], v[212:215]
    ds_read_b128 v[144:147], v235
    v_mad_u32_u24 v234, v234, s40, v231
    v_mfma_f32_16x16x32_bf16 v[196:199], a[216:219], v[156:159], 0
    v_bfe_u32 v235, s65, v232, 4
    v_cvt_pk_bf16_f32 v84, v220, v221
    v_mfma_f32_16x16x32_bf16 v[184:187], v[68:71], v[156:159], 0
    v_cvt_pk_bf16_f32 v85, v222, v223
    v_cvt_pk_bf16_f32 v106, v216, v217
    v_mfma_f32_16x16x32_bf16 v[188:191], v[90:93], v[156:159], 0
    v_cvt_pk_bf16_f32 v107, v218, v219
    v_cvt_pk_bf16_f32 v128, v212, v213
    v_mfma_f32_16x16x32_bf16 v[192:195], v[112:115], v[156:159], 0
    ds_read_b64_tr_b16 a[248:249], v86 offset:12288
    v_cvt_pk_bf16_f32 v129, v214, v215
    v_mfma_f32_16x16x32_bf16 v[208:211], a[144:147], a[224:227], 0
    ds_read_b64_tr_b16 a[250:251], v86 offset:13824
    ds_read_b64_tr_b16 a[252:253], v86 offset:12320
    v_mfma_f32_16x16x32_bf16 v[208:211], a[156:159], a[228:231], v[208:211]
    s_waitcnt lgkmcnt(4)
    ds_read_b64_tr_b16 a[254:255], v86 offset:13856
    ds_read_b64_tr_b16 a[220:221], v86 offset:12352
    v_mfma_f32_16x16x32_bf16 v[152:155], v[42:45], v[138:141], v[152:155]
    s_waitcnt lgkmcnt(5)
    ds_read_b64_tr_b16 a[222:223], v86 offset:13888
    ds_read_b64_tr_b16 v[170:171], v86 offset:62976
    v_mfma_f32_16x16x32_bf16 v[144:147], v[48:51], v[138:141], v[144:147]
    v_exp_f32 v148, v148
    v_mfma_f32_16x16x32_bf16 v[204:207], a[148:151], a[224:227], 0
    v_exp_f32 v149, v149
    v_mfma_f32_16x16x32_bf16 v[204:207], a[160:163], a[228:231], v[204:207]
    v_exp_f32 v150, v150
    v_mfma_f32_16x16x16_bf16 v[152:155], v[46:47], v[142:143], v[152:155]
    s_waitcnt lgkmcnt(5)
    ds_write_b128 v87, a[248:251] offset:12288
    v_mfma_f32_16x16x16_bf16 v[144:147], v[52:53], v[142:143], v[144:147]
    s_waitcnt lgkmcnt(4)
    ds_write_b128 v87, a[252:255] offset:13312
    v_mfma_f32_16x16x32_bf16 v[200:203], a[152:155], a[224:227], 0
    s_waitcnt lgkmcnt(3)
    ds_write_b128 v87, a[220:223] offset:14336
    v_mfma_f32_16x16x32_bf16 v[200:203], a[164:167], a[228:231], v[200:203]
    v_exp_f32 v151, v151
    v_mfma_f32_16x16x32_bf16 v[208:211], a[168:171], a[232:235], v[208:211]
    v_cvt_pk_bf16_f32 v156, v148, v149
    v_cvt_pk_bf16_f32 v157, v150, v151
    v_mfma_f32_16x16x32_bf16 v[208:211], a[180:183], a[236:239], v[208:211]
    v_exp_f32 v152, v152
    v_mfma_f32_16x16x32_bf16 v[204:207], a[172:175], a[232:235], v[204:207]
    v_exp_f32 v153, v153
    v_mfma_f32_16x16x32_bf16 v[204:207], a[184:187], a[236:239], v[204:207]
    v_exp_f32 v154, v154
    v_mfma_f32_16x16x32_bf16 v[200:203], a[176:179], a[232:235], v[200:203]
    v_exp_f32 v155, v155
    v_mfma_f32_16x16x32_bf16 v[200:203], a[188:191], a[236:239], v[200:203]
    v_cvt_pk_bf16_f32 v158, v152, v153
    v_cvt_pk_bf16_f32 v159, v154, v155
    v_mfma_f32_16x16x32_bf16 v[208:211], a[192:195], a[240:243], v[208:211]
    ds_read_b128 v[148:151], v234
    v_mad_u32_u24 v234, v235, s40, v229
    v_mfma_f32_16x16x32_bf16 v[208:211], a[204:207], a[244:247], v[208:211]
    ds_read_b128 v[152:155], v234
    v_mad_u32_u24 v235, v235, s40, v228
    v_mfma_f32_16x16x32_bf16 v[196:199], a[216:219], v[156:159], v[196:199]
    ds_read_b128 a[236:239], v224
    v_mfma_f32_16x16x32_bf16 v[184:187], v[76:79], v[156:159], v[184:187]
    ds_read_b128 a[248:251], v224 offset:192
    v_mfma_f32_16x16x32_bf16 v[188:191], v[98:101], v[156:159], v[188:191]
    ds_read_b128 a[252:255], v224 offset:256
    v_mul_f32 v208, s37, v208
    v_mfma_f32_16x16x32_bf16 v[192:195], v[120:123], v[156:159], v[192:195]
    v_mul_f32 v209, s37, v209
    v_mul_f32 v210, s37, v210
    v_mfma_f32_16x16x32_bf16 v[204:207], a[196:199], a[240:243], v[204:207]
    v_mul_f32 v211, s37, v211
    v_cvt_pk_bf16_f32 v132, v208, v209
    v_mfma_f32_16x16x32_bf16 v[204:207], a[208:211], a[244:247], v[204:207]
    s_waitcnt lgkmcnt(4)
    ds_read_b64_tr_b16 a[220:221], v108
    v_cvt_pk_bf16_f32 v133, v210, v211
    v_mfma_f32_16x16x32_bf16 v[148:151], v[54:57], v[138:141], v[148:151]
    ds_read_b64_tr_b16 a[222:223], v108 offset:1536
    ds_read_b64_tr_b16 a[224:225], v86 offset:24576
    v_mfma_f32_16x16x32_bf16 v[200:203], a[200:203], a[240:243], v[200:203]
    ds_read_b128 a[240:243], v224 offset:64
    v_mfma_f32_16x16x32_bf16 v[200:203], a[212:215], a[244:247], v[200:203]
    v_mul_f32 v204, s37, v204
    v_mul_f32 v205, s37, v205
    v_mfma_f32_16x16x16_bf16 v[148:151], v[58:59], v[142:143], v[148:151]
    s_waitcnt lgkmcnt(6)
    v_mul_f32 v206, s37, v206
    v_mul_f32 v207, s37, v207
    v_mfma_f32_16x16x32_bf16 v[180:183], a[0:3], a[236:239], 0
    v_cvt_pk_bf16_f32 v134, v204, v205
    v_cvt_pk_bf16_f32 v135, v206, v207
    v_mfma_f32_16x16x32_bf16 v[176:179], a[4:7], a[236:239], 0
    v_mul_f32 v200, s37, v200
    v_mul_f32 v201, s37, v201
    v_mfma_f32_16x16x32_bf16 v[152:155], v[30:33], v[132:135], v[152:155]
    v_mul_f32 v202, s37, v202
    v_mul_f32 v203, s37, v203
    v_mfma_f32_16x16x32_bf16 v[172:175], a[8:11], a[236:239], 0
    v_cvt_pk_bf16_f32 v136, v200, v201
    v_cvt_pk_bf16_f32 v137, v202, v203
    v_mfma_f32_16x16x32_bf16 v[220:223], a[236:239], a[72:75], 0
    s_waitcnt lgkmcnt(0)
    ds_read_b128 a[244:247], v224 offset:128
    ds_read_b64_tr_b16 a[226:227], v86 offset:26112
    v_mfma_f32_16x16x32_bf16 v[220:223], a[240:243], a[84:87], v[220:223]
    ds_read_b64_tr_b16 a[228:229], v86 offset:24608
    ds_read_b64_tr_b16 a[230:231], v86 offset:26144
    v_mfma_f32_16x16x16_bf16 v[152:155], v[34:35], v[136:137], v[152:155]
    ds_read_b64_tr_b16 a[232:233], v86 offset:24640
    ds_read_b64_tr_b16 a[234:235], v86 offset:26176
    v_mfma_f32_16x16x32_bf16 v[180:183], a[12:15], a[240:243], v[180:183]
    v_exp_f32 v144, v144
    v_mfma_f32_16x16x32_bf16 v[176:179], a[16:19], a[240:243], v[176:179]
    v_exp_f32 v145, v145
    v_mfma_f32_16x16x32_bf16 v[172:175], a[20:23], a[240:243], v[172:175]
    v_exp_f32 v146, v146
    v_mfma_f32_16x16x32_bf16 v[216:219], a[236:239], a[76:79], 0
    v_exp_f32 v147, v147
    v_mfma_f32_16x16x32_bf16 v[216:219], a[240:243], a[88:91], v[216:219]
    s_waitcnt lgkmcnt(4)
    ds_write_b128 v87, a[224:227] offset:24576
    v_mfma_f32_16x16x32_bf16 v[212:215], a[236:239], a[80:83], 0
    s_waitcnt lgkmcnt(3)
    ds_write_b128 v87, a[228:231] offset:25600
    v_mfma_f32_16x16x32_bf16 v[212:215], a[240:243], a[92:95], v[212:215]
    s_waitcnt lgkmcnt(2)
    ds_write_b128 v87, a[232:235] offset:26624
    v_mfma_f32_16x16x32_bf16 v[180:183], a[24:27], a[244:247], v[180:183]
    v_cvt_pk_bf16_f32 v156, v144, v145
    v_cvt_pk_bf16_f32 v157, v146, v147
    v_mfma_f32_16x16x32_bf16 v[180:183], a[36:39], a[248:251], v[180:183]
    v_exp_f32 v148, v148
    v_mfma_f32_16x16x32_bf16 v[176:179], a[28:31], a[244:247], v[176:179]
    v_exp_f32 v149, v149
    v_mfma_f32_16x16x32_bf16 v[176:179], a[40:43], a[248:251], v[176:179]
    v_exp_f32 v150, v150
    v_mfma_f32_16x16x32_bf16 v[172:175], a[32:35], a[244:247], v[172:175]
    v_exp_f32 v151, v151
    v_mfma_f32_16x16x32_bf16 v[172:175], a[44:47], a[248:251], v[172:175]
    v_cvt_pk_bf16_f32 v158, v148, v149
    v_cvt_pk_bf16_f32 v159, v150, v151
    v_mfma_f32_16x16x32_bf16 v[220:223], a[244:247], a[96:99], v[220:223]
    v_exp_f32 v152, v152
    v_mfma_f32_16x16x32_bf16 v[220:223], a[248:251], a[108:111], v[220:223]
    ds_read_b128 v[144:147], v235
    v_bfe_u32 v235, s62, v232, 4
    v_mfma_f32_16x16x32_bf16 v[196:199], a[216:219], v[156:159], v[196:199]
    ds_read_b128 v[148:151], v228 offset:1280
    v_mad_u32_u24 v234, v235, s40, v228
    v_mfma_f32_16x16x32_bf16 v[184:187], v[82:85], v[156:159], v[184:187]
    ds_read_b64_tr_b16 a[224:225], v108 offset:8
    v_mad_u32_u24 v235, v235, s40, v229
    v_mfma_f32_16x16x32_bf16 v[188:191], v[104:107], v[156:159], v[188:191]
    ds_read_b64_tr_b16 a[226:227], v108 offset:1544
    v_mfma_f32_16x16x32_bf16 v[192:195], v[126:129], v[156:159], v[192:195]
    v_rcp_f32 v197, v196
    v_mfma_f32_16x16x32_bf16 v[216:219], a[244:247], a[100:103], v[216:219]
    ds_read_b64_tr_b16 a[228:229], v109
    v_mul_f32 v184, v184, v197
    v_mfma_f32_16x16x32_bf16 v[216:219], a[248:251], a[112:115], v[216:219]
    v_mul_f32 v185, v185, v197
    v_cvt_pk_bf16_f32 v184, v184, v185
    v_mfma_f32_16x16x32_bf16 v[212:215], a[244:247], a[104:107], v[212:215]
    ds_read_b128 a[244:247], v224 offset:3072
    v_mul_f32 v186, v186, v197
    v_mfma_f32_16x16x32_bf16 v[212:215], a[248:251], a[116:119], v[212:215]
    s_waitcnt lgkmcnt(5)
    ds_read_b128 a[248:251], v224 offset:3136
    v_mul_f32 v187, v187, v197
    v_mfma_f32_16x16x32_bf16 v[144:147], v[6:9], v[132:135], v[144:147]
    s_waitcnt lgkmcnt(5)
    v_cvt_pk_bf16_f32 v185, v186, v187
    v_mul_f32 v188, v188, v197
    v_mfma_f32_16x16x32_bf16 v[148:151], v[12:15], v[132:135], v[148:151]
    v_mul_f32 v189, v189, v197
    v_cvt_pk_bf16_f32 v186, v188, v189
    v_mfma_f32_16x16x32_bf16 v[180:183], a[48:51], a[252:255], v[180:183]
    v_mul_f32 v190, v190, v197
    v_mul_f32 v191, v191, v197
    v_mfma_f32_16x16x32_bf16 v[180:183], a[60:63], v[252:255], v[180:183]
    v_cvt_pk_bf16_f32 v187, v190, v191
    v_mul_f32 v192, v192, v197
    v_mfma_f32_16x16x16_bf16 v[144:147], v[10:11], v[136:137], v[144:147]
    v_mul_f32 v193, v193, v197
    v_cvt_pk_bf16_f32 v188, v192, v193
    v_mfma_f32_16x16x16_bf16 v[148:151], v[16:17], v[136:137], v[148:151]
    v_mul_f32 v194, v194, v197
    v_mul_f32 v195, v195, v197
    v_mfma_f32_16x16x32_bf16 v[176:179], a[52:55], a[252:255], v[176:179]
    v_cvt_pk_bf16_f32 v0, v180, v181
    v_cvt_pk_bf16_f32 v1, v182, v183
    v_mfma_f32_16x16x32_bf16 v[176:179], a[64:67], v[252:255], v[176:179]
    v_cvt_pk_bf16_f32 v189, v194, v195
    v_max3_f32 v236, v236, v196, v197
    v_mfma_f32_16x16x32_bf16 v[172:175], a[56:59], a[252:255], v[172:175]
    ds_write_b128 v237, v[184:187] offset:6144
    v_mfma_f32_16x16x32_bf16 v[172:175], a[68:71], v[252:255], v[172:175]
    ds_write_b64 v238, v[188:189] offset:6144
    v_mfma_f32_16x16x32_bf16 v[220:223], a[252:255], a[120:123], v[220:223]
    v_exp_f32 v153, v153
    v_mfma_f32_16x16x32_bf16 v[220:223], v[252:255], a[132:135], v[220:223]
    v_cvt_pk_bf16_f32 v2, v176, v177
    v_cvt_pk_bf16_f32 v3, v178, v179
    v_mfma_f32_16x16x32_bf16 v[216:219], a[252:255], a[124:127], v[216:219]
    v_exp_f32 v154, v154
    v_mfma_f32_16x16x32_bf16 v[216:219], v[252:255], a[136:139], v[216:219]
    v_cvt_pk_bf16_f32 v4, v172, v173
    v_cvt_pk_bf16_f32 v5, v174, v175
    v_mfma_f32_16x16x32_bf16 v[212:215], a[252:255], a[128:131], v[212:215]
    v_cvt_pk_bf16_f32 v66, v220, v221
    v_cvt_pk_bf16_f32 v67, v222, v223
    v_mfma_f32_16x16x32_bf16 v[212:215], v[252:255], a[140:143], v[212:215]
    s_waitcnt lgkmcnt(2)
    ds_read_b128 a[252:255], v224 offset:3200
    ds_read_b128 v[252:255], v224 offset:3264
    v_mfma_f32_16x16x32_bf16 v[208:211], a[0:3], a[244:247], 0
    v_cvt_pk_bf16_f32 v88, v216, v217
    v_cvt_pk_bf16_f32 v89, v218, v219
    v_mfma_f32_16x16x32_bf16 v[208:211], a[12:15], a[248:251], v[208:211]
    ds_read_b64_tr_b16 a[230:231], v109 offset:1536
    ds_read_b64_tr_b16 a[232:233], v109 offset:8
    v_mfma_f32_16x16x32_bf16 v[204:207], a[4:7], a[244:247], 0
    v_cvt_pk_bf16_f32 v110, v212, v213
    v_cvt_pk_bf16_f32 v111, v214, v215
    v_mfma_f32_16x16x32_bf16 v[204:207], a[16:19], a[248:251], v[204:207]
    ds_read_b64_tr_b16 a[234:235], v109 offset:1544
    ds_read_b64_tr_b16 a[236:237], v86 offset:49184
    v_mfma_f32_16x16x32_bf16 v[200:203], a[8:11], a[244:247], 0
    ds_read_b64_tr_b16 a[238:239], v86 offset:50720
    ds_read_b64_tr_b16 a[240:241], v86 offset:49216
    v_mfma_f32_16x16x32_bf16 v[200:203], a[20:23], a[248:251], v[200:203]
    ds_read_b64_tr_b16 a[242:243], v86 offset:50752
    v_cvt_pk_bf16_f32 v156, v152, v153
    v_mfma_f32_16x16x32_bf16 v[180:183], a[244:247], a[72:75], 0
    ds_write_b128 v87, v[248:251] offset:49152
    v_mfma_f32_16x16x32_bf16 v[180:183], a[248:251], a[84:87], v[180:183]
    v_exp_f32 v155, v155
    v_mfma_f32_16x16x32_bf16 v[176:179], a[244:247], a[76:79], 0
    v_cvt_pk_bf16_f32 v157, v154, v155
    v_mfma_f32_16x16x32_bf16 v[176:179], a[248:251], a[88:91], v[176:179]
    v_exp_f32 v144, v144
    v_mfma_f32_16x16x32_bf16 v[172:175], a[244:247], a[80:83], 0
    ds_read_b128 v[152:155], v229 offset:1280
    v_mfma_f32_16x16x32_bf16 v[172:175], a[248:251], a[92:95], v[172:175]
    s_waitcnt lgkmcnt(5)
    ds_read_b128 a[244:247], v225 offset:43008
    v_mfma_f32_16x16x32_bf16 v[208:211], a[24:27], a[252:255], v[208:211]
    ds_read_b128 a[248:251], v225 offset:43072
    v_mfma_f32_16x16x32_bf16 v[208:211], a[36:39], v[252:255], v[208:211]
    s_waitcnt lgkmcnt(4)
    ds_write_b128 v87, a[236:239] offset:50176
    v_mfma_f32_16x16x32_bf16 v[204:207], a[28:31], a[252:255], v[204:207]
    ds_write_b128 v87, a[240:243] offset:51200
    v_mfma_f32_16x16x32_bf16 v[204:207], a[40:43], v[252:255], v[204:207]
    s_waitcnt lgkmcnt(4)
    v_exp_f32 v145, v145
    v_mfma_f32_16x16x32_bf16 v[152:155], v[36:39], v[132:135], v[152:155]
    v_exp_f32 v146, v146
    v_mfma_f32_16x16x32_bf16 v[200:203], a[32:35], a[252:255], v[200:203]
    v_exp_f32 v147, v147
    v_mfma_f32_16x16x32_bf16 v[200:203], a[44:47], v[252:255], v[200:203]
    v_cvt_pk_bf16_f32 v158, v144, v145
    v_cvt_pk_bf16_f32 v159, v146, v147
    v_mfma_f32_16x16x16_bf16 v[152:155], v[40:41], v[136:137], v[152:155]
    v_exp_f32 v148, v148
    v_mfma_f32_16x16x32_bf16 v[196:199], a[216:219], v[156:159], 0
    ds_read_b128 v[144:147], v229 offset:1920
    v_mfma_f32_16x16x32_bf16 v[184:187], v[70:73], v[156:159], 0
    ds_read_b128 a[240:243], v225 offset:42944
    v_mfma_f32_16x16x32_bf16 v[188:191], v[92:95], v[156:159], 0
    ds_read_b64_tr_b16 v[248:249], v86 offset:61472
    ds_read_b64_tr_b16 v[250:251], v86 offset:63008
    v_mfma_f32_16x16x32_bf16 v[192:195], v[114:117], v[156:159], 0
    ds_read_b64_tr_b16 a[236:237], v86 offset:61504
    ds_read_b64_tr_b16 a[238:239], v86 offset:63040
    v_mfma_f32_16x16x32_bf16 v[180:183], a[252:255], a[96:99], v[180:183]
    ds_write_b128 v87, v[168:171] offset:61440
    v_mfma_f32_16x16x32_bf16 v[180:183], v[252:255], a[108:111], v[180:183]
    v_exp_f32 v149, v149
    v_mfma_f32_16x16x32_bf16 v[176:179], a[252:255], a[100:103], v[176:179]
    v_exp_f32 v150, v150
    v_mfma_f32_16x16x32_bf16 v[176:179], v[252:255], a[112:115], v[176:179]
    s_waitcnt lgkmcnt(6)
    v_exp_f32 v151, v151
    v_mfma_f32_16x16x32_bf16 v[144:147], v[42:45], v[132:135], v[144:147]
    v_cvt_pk_bf16_f32 v156, v148, v149
    v_cvt_pk_bf16_f32 v157, v150, v151
    v_mfma_f32_16x16x32_bf16 v[172:175], a[252:255], a[104:107], v[172:175]
    ds_read_b128 v[148:151], v228 offset:1920
    v_mfma_f32_16x16x32_bf16 v[172:175], v[252:255], a[116:119], v[172:175]
    ds_read_b128 a[252:255], v225 offset:43136
    v_mfma_f32_16x16x16_bf16 v[144:147], v[46:47], v[136:137], v[144:147]
    ds_read_b128 v[252:255], v225 offset:43200
    v_mfma_f32_16x16x32_bf16 v[208:211], a[48:51], v[160:163], v[208:211]
    s_waitcnt lgkmcnt(4)
    ds_write_b128 v87, v[248:251] offset:62464
    v_mfma_f32_16x16x32_bf16 v[208:211], a[60:63], v[164:167], v[208:211]
    ds_write_b128 v87, a[236:239] offset:63488
    v_mfma_f32_16x16x32_bf16 v[204:207], a[52:55], v[160:163], v[204:207]
    v_exp_f32 v152, v152
    v_mfma_f32_16x16x32_bf16 v[204:207], a[64:67], v[164:167], v[204:207]
    s_waitcnt lgkmcnt(4)
    v_exp_f32 v153, v153
    v_mfma_f32_16x16x32_bf16 v[148:151], v[18:21], v[132:135], v[148:151]
    v_exp_f32 v154, v154
    v_mfma_f32_16x16x32_bf16 v[200:203], a[56:59], v[160:163], v[200:203]
    v_cvt_pk_bf16_f32 v24, v208, v209
    v_cvt_pk_bf16_f32 v25, v210, v211
    v_mfma_f32_16x16x32_bf16 v[200:203], a[68:71], v[164:167], v[200:203]
    v_exp_f32 v155, v155
    v_mfma_f32_16x16x16_bf16 v[148:151], v[22:23], v[136:137], v[148:151]
    v_cvt_pk_bf16_f32 v26, v204, v205
    v_cvt_pk_bf16_f32 v27, v206, v207
    v_mfma_f32_16x16x32_bf16 v[180:183], v[160:163], a[120:123], v[180:183]
    v_cvt_pk_bf16_f32 v158, v152, v153
    v_cvt_pk_bf16_f32 v159, v154, v155
    v_mfma_f32_16x16x32_bf16 v[180:183], v[164:167], a[132:135], v[180:183]
    ds_read_b128 v[152:155], v234
    v_bfe_u32 v234, s65, v232, 4
    v_mfma_f32_16x16x32_bf16 v[196:199], a[216:219], v[156:159], v[196:199]
    v_mad_u32_u24 v234, v234, s40, v230
    v_cvt_pk_bf16_f32 v28, v200, v201
    v_mfma_f32_16x16x32_bf16 v[184:187], v[74:77], v[156:159], v[184:187]
    v_cvt_pk_bf16_f32 v29, v202, v203
    v_mfma_f32_16x16x32_bf16 v[188:191], v[96:99], v[156:159], v[188:191]
    v_cvt_pk_bf16_f32 v68, v180, v181
    v_cvt_pk_bf16_f32 v69, v182, v183
    v_mfma_f32_16x16x32_bf16 v[192:195], v[118:121], v[156:159], v[192:195]
    v_exp_f32 v144, v144
    v_mfma_f32_16x16x32_bf16 v[176:179], v[160:163], a[124:127], v[176:179]
    v_exp_f32 v145, v145
    v_mfma_f32_16x16x32_bf16 v[176:179], v[164:167], a[136:139], v[176:179]
    v_exp_f32 v146, v146
    v_mfma_f32_16x16x32_bf16 v[172:175], v[160:163], a[128:131], v[172:175]
    ds_read_b128 v[160:163], v225 offset:43264
    v_cvt_pk_bf16_f32 v156, v144, v145
    v_mfma_f32_16x16x32_bf16 v[172:175], v[164:167], a[140:143], v[172:175]
    s_waitcnt lgkmcnt(1)
    v_exp_f32 v147, v147
    v_mfma_f32_16x16x32_bf16 v[152:155], v[0:3], v[132:135], v[152:155]
    v_cvt_pk_bf16_f32 v157, v146, v147
    v_cvt_pk_bf16_f32 v90, v176, v177
    v_mfma_f32_16x16x32_bf16 v[220:223], a[144:147], a[240:243], 0
    ds_read_b128 v[144:147], v235
    v_bfe_u32 v235, s62, v232, 4
    v_mfma_f32_16x16x32_bf16 v[220:223], a[156:159], a[244:247], v[220:223]
    v_mad_u32_u24 v235, v235, s40, v230
    v_cvt_pk_bf16_f32 v91, v178, v179
    v_mfma_f32_16x16x16_bf16 v[152:155], v[4:5], v[136:137], v[152:155]
    v_cvt_pk_bf16_f32 v112, v172, v173
    v_cvt_pk_bf16_f32 v113, v174, v175
    v_mfma_f32_16x16x32_bf16 v[216:219], a[148:151], a[240:243], 0
    s_waitcnt lgkmcnt(1)
    v_or_b32 v232, v243, v245
    v_lshrrev_b32 v232, 31, v232
    v_mfma_f32_16x16x32_bf16 v[216:219], a[160:163], a[244:247], v[216:219]
    s_barrier
    ds_read_b128 v[164:167], v227 offset:6144
    ds_read_b128 v[168:171], v227 offset:6208
    v_mfma_f32_16x16x32_bf16 v[212:215], a[152:155], a[240:243], 0
    ds_read_b128 v[248:251], v227 offset:6272
    v_lshl_add_u32 v232, v232, 20, v226
    v_mfma_f32_16x16x32_bf16 v[212:215], a[164:167], a[244:247], v[212:215]
    ds_read_b128 a[236:239], v227 offset:6336
    v_mfma_f32_16x16x32_bf16 v[220:223], a[168:171], a[248:251], v[220:223]
    ds_read_b128 a[240:243], v227 offset:6400
    v_mfma_f32_16x16x32_bf16 v[220:223], a[180:183], a[252:255], v[220:223]
    s_waitcnt lgkmcnt(5)
    ds_read_b128 a[244:247], v227 offset:6464
    v_mfma_f32_16x16x32_bf16 v[144:147], v[24:27], v[132:135], v[144:147]
    buffer_load_dwordx4 v246, s[4:7], s56 offen lds
    v_mfma_f32_16x16x32_bf16 v[216:219], a[172:175], a[248:251], v[216:219]
    v_exp_f32 v148, v148
    v_mfma_f32_16x16x32_bf16 v[216:219], a[184:187], a[252:255], v[216:219]
    v_exp_f32 v149, v149
    v_mfma_f32_16x16x32_bf16 v[212:215], a[176:179], a[248:251], v[212:215]
    ds_read_b128 a[248:251], v239
    v_cvt_pk_bf16_f32 v158, v148, v149
    v_mfma_f32_16x16x32_bf16 v[212:215], a[188:191], a[252:255], v[212:215]
    ds_read_b128 a[252:255], v240
    v_mfma_f32_16x16x16_bf16 v[144:147], v[28:29], v[136:137], v[144:147]
    v_exp_f32 v150, v150
    v_mfma_f32_16x16x32_bf16 v[220:223], a[192:195], v[252:255], v[220:223]
    buffer_load_dwordx4 v247, s[4:7], s56 offen offset:1024 lds
    v_mfma_f32_16x16x32_bf16 v[220:223], a[204:207], v[160:163], v[220:223]
    s_add_u32 s56, s56, s42
    v_exp_f32 v151, v151
    v_mfma_f32_16x16x32_bf16 v[216:219], a[196:199], v[252:255], v[216:219]
    s_add_u32 m0, s41, 0x9740
    v_cvt_pk_bf16_f32 v159, v150, v151
    v_mfma_f32_16x16x32_bf16 v[216:219], a[208:211], v[160:163], v[216:219]
    ds_read_b128 v[148:151], v235
    v_bfe_u32 v235, s66, v233, 4
    v_mfma_f32_16x16x32_bf16 v[196:199], a[216:219], v[156:159], v[196:199]
    v_mad_u32_u24 v235, v235, s40, v231
    v_mul_f32 v220, s37, v220
    v_mfma_f32_16x16x32_bf16 v[184:187], v[78:81], v[156:159], v[184:187]
    v_mul_f32 v221, s37, v221
    v_mul_f32 v222, s37, v222
    v_mfma_f32_16x16x32_bf16 v[188:191], v[100:103], v[156:159], v[188:191]
    v_mul_f32 v223, s37, v223
    v_cvt_pk_bf16_f32 v138, v220, v221
    v_mfma_f32_16x16x32_bf16 v[192:195], v[122:125], v[156:159], v[192:195]
    v_cvt_pk_bf16_f32 v139, v222, v223
    v_mul_f32 v216, s37, v216
    v_mfma_f32_16x16x32_bf16 v[212:215], a[200:203], v[252:255], v[212:215]
    v_mul_f32 v217, s37, v217
    v_mul_f32 v218, s37, v218
    v_mfma_f32_16x16x32_bf16 v[212:215], a[212:215], v[160:163], v[212:215]
    s_waitcnt lgkmcnt(1)
    v_mul_f32 v219, s37, v219
    v_cvt_pk_bf16_f32 v140, v216, v217
    v_mfma_f32_16x16x32_bf16 v[220:223], a[0:3], v[164:167], 0
    ds_read_b128 v[252:255], v241 offset:12288
    v_cvt_pk_bf16_f32 v141, v218, v219
    v_mfma_f32_16x16x32_bf16 v[220:223], a[12:15], v[168:171], v[220:223]
    s_waitcnt lgkmcnt(1)
    ds_read_b128 v[160:163], v241 offset:12800
    v_mfma_f32_16x16x32_bf16 v[148:151], v[24:27], v[138:141], v[148:151]
L_pg3:
    s_cbranch_execz L_pg7
    v_mul_f32 v212, s37, v212
    v_mul_f32 v213, s37, v213
    v_mfma_f32_16x16x32_bf16 v[216:219], a[4:7], v[164:167], 0
    v_mul_f32 v214, s37, v214
    v_mul_f32 v215, s37, v215
    v_mfma_f32_16x16x32_bf16 v[216:219], a[16:19], v[168:171], v[216:219]
    v_cvt_pk_bf16_f32 v142, v212, v213
    v_cvt_pk_bf16_f32 v143, v214, v215
    v_mfma_f32_16x16x32_bf16 v[212:215], a[8:11], v[164:167], 0
    buffer_load_dwordx4 v246, s[4:7], s56 offen lds
    v_mfma_f32_16x16x32_bf16 v[212:215], a[20:23], v[168:171], v[212:215]
    v_exp_f32 v152, v152
    v_mfma_f32_16x16x16_bf16 v[148:151], v[28:29], v[142:143], v[148:151]
    v_exp_f32 v153, v153
    v_mfma_f32_16x16x32_bf16 v[220:223], a[24:27], v[248:251], v[220:223]
    v_exp_f32 v154, v154
    v_mfma_f32_16x16x32_bf16 v[220:223], a[36:39], a[236:239], v[220:223]
    v_exp_f32 v155, v155
    v_mfma_f32_16x16x32_bf16 v[216:219], a[28:31], v[248:251], v[216:219]
    v_cvt_pk_bf16_f32 v156, v152, v153
    v_cvt_pk_bf16_f32 v157, v154, v155
    v_mfma_f32_16x16x32_bf16 v[216:219], a[40:43], a[236:239], v[216:219]
    ds_read_b128 v[152:155], v234
    v_bfe_u32 v234, s67, v233, 4
    v_mfma_f32_16x16x32_bf16 v[212:215], a[32:35], v[248:251], v[212:215]
    v_mad_u32_u24 v234, v234, s40, v231
    v_mfma_f32_16x16x32_bf16 v[212:215], a[44:47], a[236:239], v[212:215]
    buffer_load_dwordx4 v247, s[4:7], s56 offen offset:1024 lds
    v_mfma_f32_16x16x32_bf16 v[220:223], a[48:51], a[240:243], v[220:223]
    s_add_u32 s56, s56, s42
    v_exp_f32 v144, v144
    v_mfma_f32_16x16x32_bf16 v[220:223], a[60:63], a[244:247], v[220:223]
    s_add_u32 m0, s41, 0xb580
    v_exp_f32 v145, v145
    v_mfma_f32_16x16x32_bf16 v[216:219], a[52:55], a[240:243], v[216:219]
    v_exp_f32 v146, v146
    v_mfma_f32_16x16x32_bf16 v[216:219], a[64:67], a[244:247], v[216:219]
    v_exp_f32 v147, v147
    v_mfma_f32_16x16x32_bf16 v[212:215], a[56:59], a[240:243], v[212:215]
    v_cvt_pk_bf16_f32 v158, v144, v145
    v_cvt_pk_bf16_f32 v60, v220, v221
    v_mfma_f32_16x16x32_bf16 v[212:215], a[68:71], a[244:247], v[212:215]
    s_waitcnt lgkmcnt(0)
    v_cvt_pk_bf16_f32 v61, v222, v223
    v_cndmask_b32 v48, v48, v60, s[82:83]
    v_mfma_f32_16x16x32_bf16 v[152:155], v[30:33], v[138:141], v[152:155]
    v_cndmask_b32 v49, v49, v61, s[82:83]
    v_cvt_pk_bf16_f32 v62, v216, v217
    v_mfma_f32_16x16x32_bf16 v[220:223], v[164:167], a[72:75], 0
    v_cvt_pk_bf16_f32 v63, v218, v219
    v_cndmask_b32 v50, v50, v62, s[82:83]
    v_mfma_f32_16x16x32_bf16 v[220:223], v[168:171], a[84:87], v[220:223]
    v_cndmask_b32 v51, v51, v63, s[82:83]
    v_cvt_pk_bf16_f32 v64, v212, v213
    v_mfma_f32_16x16x16_bf16 v[152:155], v[34:35], v[142:143], v[152:155]
    v_cvt_pk_bf16_f32 v65, v214, v215
    v_cndmask_b32 v52, v52, v64, s[82:83]
    v_mfma_f32_16x16x32_bf16 v[216:219], v[164:167], a[76:79], 0
    v_cndmask_b32 v53, v53, v65, s[82:83]
    v_cvt_pk_bf16_f32 v159, v146, v147
    v_mfma_f32_16x16x32_bf16 v[216:219], v[168:171], a[88:91], v[216:219]
    ds_read_b128 v[144:147], v230 offset:1280
    v_mfma_f32_16x16x32_bf16 v[196:199], a[216:219], v[156:159], v[196:199]
    v_exp_f32 v148, v148
    v_mfma_f32_16x16x32_bf16 v[184:187], v[66:69], v[156:159], v[184:187]
    v_exp_f32 v149, v149
    v_mfma_f32_16x16x32_bf16 v[188:191], v[88:91], v[156:159], v[188:191]
    v_exp_f32 v150, v150
    v_mfma_f32_16x16x32_bf16 v[192:195], v[110:113], v[156:159], v[192:195]
    v_exp_f32 v151, v151
    v_mfma_f32_16x16x32_bf16 v[212:215], v[164:167], a[80:83], 0
    ds_read_b128 v[164:167], v226 offset:1152
    v_cvt_pk_bf16_f32 v156, v148, v149
    v_mfma_f32_16x16x32_bf16 v[212:215], v[168:171], a[92:95], v[212:215]
    ds_read_b128 v[168:171], v226 offset:1216
    v_cvt_pk_bf16_f32 v157, v150, v151
    v_mfma_f32_16x16x32_bf16 v[220:223], v[248:251], a[96:99], v[220:223]
    ds_read_b128 v[148:151], v230 offset:1920
    v_mfma_f32_16x16x32_bf16 v[220:223], a[236:239], a[108:111], v[220:223]
    s_waitcnt lgkmcnt(3)
    v_rcp_f32 v197, v196
    v_mfma_f32_16x16x32_bf16 v[144:147], v[36:39], v[138:141], v[144:147]
    v_mul_f32 v184, v184, v197
    v_mul_f32 v185, v185, v197
    v_mfma_f32_16x16x32_bf16 v[216:219], v[248:251], a[100:103], v[216:219]
    v_cvt_pk_bf16_f32 v184, v184, v185
    v_mul_f32 v186, v186, v197
    v_mfma_f32_16x16x32_bf16 v[216:219], a[236:239], a[112:115], v[216:219]
    v_mul_f32 v187, v187, v197
    v_cvt_pk_bf16_f32 v185, v186, v187
    v_mfma_f32_16x16x16_bf16 v[144:147], v[40:41], v[142:143], v[144:147]
    v_mul_f32 v188, v188, v197
    v_mul_f32 v189, v189, v197
    v_mfma_f32_16x16x32_bf16 v[212:215], v[248:251], a[104:107], v[212:215]
    ds_read_b128 v[248:251], v226 offset:1280
    v_cvt_pk_bf16_f32 v186, v188, v189
    v_mfma_f32_16x16x32_bf16 v[212:215], a[236:239], a[116:119], v[212:215]
    s_waitcnt lgkmcnt(1)
    ds_read_b128 a[236:239], v226 offset:1344
    v_mul_f32 v190, v190, v197
    v_mfma_f32_16x16x32_bf16 v[148:151], v[42:45], v[138:141], v[148:151]
    v_mul_f32 v191, v191, v197
    v_cvt_pk_bf16_f32 v187, v190, v191
    v_mfma_f32_16x16x32_bf16 v[220:223], a[240:243], a[120:123], v[220:223]
    v_mul_f32 v192, v192, v197
    v_mul_f32 v193, v193, v197
    v_mfma_f32_16x16x32_bf16 v[220:223], a[244:247], a[132:135], v[220:223]
    v_cvt_pk_bf16_f32 v188, v192, v193
    v_mul_f32 v194, v194, v197
    v_mfma_f32_16x16x16_bf16 v[148:151], v[46:47], v[142:143], v[148:151]
    v_mul_f32 v195, v195, v197
    v_cvt_pk_bf16_f32 v189, v194, v195
    v_mfma_f32_16x16x32_bf16 v[216:219], a[240:243], a[124:127], v[216:219]
    v_max3_f32 v236, v236, v196, v197
    v_mfma_f32_16x16x32_bf16 v[216:219], a[244:247], a[136:139], v[216:219]
    v_cvt_pk_bf16_f32 v86, v220, v221
    v_cvt_pk_bf16_f32 v87, v222, v223
    v_mfma_f32_16x16x32_bf16 v[212:215], a[240:243], a[128:131], v[212:215]
    v_cndmask_b32 v82, v82, v86, s[84:85]
    v_cndmask_b32 v83, v83, v87, s[84:85]
    v_mfma_f32_16x16x32_bf16 v[212:215], a[244:247], a[140:143], v[212:215]
    ds_read_b128 a[240:243], v226 offset:1408
    ds_read_b128 a[244:247], v226 offset:1472
    v_mfma_f32_16x16x32_bf16 v[208:211], a[220:223], a[248:251], 0
    v_cvt_pk_bf16_f32 v108, v216, v217
    v_cvt_pk_bf16_f32 v109, v218, v219
    v_mfma_f32_16x16x32_bf16 v[200:203], a[220:223], a[252:255], 0
    v_cndmask_b32 v104, v104, v108, s[84:85]
    v_cndmask_b32 v105, v105, v109, s[84:85]
    v_mfma_f32_16x16x32_bf16 v[204:207], a[224:227], a[248:251], 0
    v_cvt_pk_bf16_f32 v130, v212, v213
    v_cvt_pk_bf16_f32 v131, v214, v215
    v_mfma_f32_16x16x32_bf16 v[180:183], a[224:227], a[252:255], 0
    v_cndmask_b32 v126, v126, v130, s[84:85]
    v_cndmask_b32 v127, v127, v131, s[84:85]
    v_mfma_f32_16x16x32_bf16 v[176:179], a[228:231], a[248:251], 0
    ds_read_b128 a[252:255], v240 offset:1024
    v_mfma_f32_16x16x32_bf16 v[172:175], a[232:235], a[248:251], 0
    ds_read_b128 a[248:251], v239 offset:1024
    v_mfma_f32_16x16x32_bf16 v[220:223], a[144:147], v[164:167], 0
    ds_write_b128 v237, v[184:187] offset:12288
    v_mfma_f32_16x16x32_bf16 v[220:223], a[156:159], v[168:171], v[220:223]
    ds_write_b64 v238, v[188:189] offset:12288
    v_mfma_f32_16x16x32_bf16 v[216:219], a[148:151], v[164:167], 0
    v_exp_f32 v152, v152
    v_mfma_f32_16x16x32_bf16 v[216:219], a[160:163], v[168:171], v[216:219]
    v_exp_f32 v153, v153
    v_mfma_f32_16x16x32_bf16 v[212:215], a[152:155], v[164:167], 0
    v_exp_f32 v154, v154
    v_mfma_f32_16x16x32_bf16 v[212:215], a[164:167], v[168:171], v[212:215]
    s_waitcnt lgkmcnt(3)
    ds_read_b128 v[164:167], v224 offset:15488
    ds_read_b128 v[168:171], v224 offset:15552
    v_mfma_f32_16x16x32_bf16 v[220:223], a[168:171], v[248:251], v[220:223]
    v_exp_f32 v155, v155
    v_mfma_f32_16x16x32_bf16 v[220:223], a[180:183], a[236:239], v[220:223]
    v_cvt_pk_bf16_f32 v158, v152, v153
    v_cvt_pk_bf16_f32 v159, v154, v155
    v_mfma_f32_16x16x32_bf16 v[216:219], a[172:175], v[248:251], v[216:219]
    ds_read_b128 v[152:155], v235
    v_bfe_u32 v235, s68, v233, 4
    v_mfma_f32_16x16x32_bf16 v[216:219], a[184:187], a[236:239], v[216:219]
    v_mad_u32_u24 v235, v235, s40, v231
    v_mfma_f32_16x16x32_bf16 v[196:199], a[216:219], v[156:159], 0
    v_exp_f32 v144, v144
    v_mfma_f32_16x16x32_bf16 v[184:187], v[68:71], v[156:159], 0
    v_exp_f32 v145, v145
    v_mfma_f32_16x16x32_bf16 v[188:191], v[90:93], v[156:159], 0
    v_exp_f32 v146, v146
    v_mfma_f32_16x16x32_bf16 v[192:195], v[112:115], v[156:159], 0
    v_exp_f32 v147, v147
    v_mfma_f32_16x16x32_bf16 v[212:215], a[176:179], v[248:251], v[212:215]
    ds_read_b128 v[248:251], v224 offset:15616
    v_cvt_pk_bf16_f32 v156, v144, v145
    v_mfma_f32_16x16x32_bf16 v[212:215], a[188:191], a[236:239], v[212:215]
    s_waitcnt lgkmcnt(1)
    ds_read_b128 a[236:239], v224 offset:15680
    v_cvt_pk_bf16_f32 v157, v146, v147
    v_mfma_f32_16x16x32_bf16 v[152:155], v[48:51], v[138:141], v[152:155]
    ds_read_b128 v[144:147], v234
    v_bfe_u32 v234, s69, v233, 4
    v_mfma_f32_16x16x32_bf16 v[220:223], a[192:195], a[240:243], v[220:223]
    v_mad_u32_u24 v234, v234, s40, v231
    v_mfma_f32_16x16x32_bf16 v[220:223], a[204:207], a[244:247], v[220:223]
    v_exp_f32 v148, v148
    v_mfma_f32_16x16x16_bf16 v[152:155], v[52:53], v[142:143], v[152:155]
    v_exp_f32 v149, v149
    v_mfma_f32_16x16x32_bf16 v[216:219], a[196:199], a[240:243], v[216:219]
    v_exp_f32 v150, v150
    v_mfma_f32_16x16x32_bf16 v[216:219], a[208:211], a[244:247], v[216:219]
    v_exp_f32 v151, v151
    v_mfma_f32_16x16x32_bf16 v[212:215], a[200:203], a[240:243], v[212:215]
    v_mul_f32 v220, s37, v220
    v_mul_f32 v221, s37, v221
    v_mfma_f32_16x16x32_bf16 v[212:215], a[212:215], a[244:247], v[212:215]
    s_waitcnt lgkmcnt(0)
    v_mul_f32 v222, s37, v222
    v_mul_f32 v223, s37, v223
    v_mfma_f32_16x16x32_bf16 v[144:147], v[54:57], v[138:141], v[144:147]
    v_cvt_pk_bf16_f32 v132, v220, v221
    v_cvt_pk_bf16_f32 v133, v222, v223
    v_mfma_f32_16x16x32_bf16 v[220:223], a[0:3], v[164:167], 0
    v_mul_f32 v216, s37, v216
    v_mul_f32 v217, s37, v217
    v_mfma_f32_16x16x32_bf16 v[220:223], a[12:15], v[168:171], v[220:223]
    v_mul_f32 v218, s37, v218
    v_mul_f32 v219, s37, v219
    v_mfma_f32_16x16x16_bf16 v[144:147], v[58:59], v[142:143], v[144:147]
    v_cvt_pk_bf16_f32 v134, v216, v217
    v_cvt_pk_bf16_f32 v135, v218, v219
    v_mfma_f32_16x16x32_bf16 v[216:219], a[4:7], v[164:167], 0
    v_mul_f32 v212, s37, v212
    v_mul_f32 v213, s37, v213
    v_mfma_f32_16x16x32_bf16 v[216:219], a[16:19], v[168:171], v[216:219]
    v_mul_f32 v214, s37, v214
    v_mul_f32 v215, s37, v215
    v_mfma_f32_16x16x32_bf16 v[220:223], a[24:27], v[248:251], v[220:223]
    v_cvt_pk_bf16_f32 v136, v212, v213
    v_cvt_pk_bf16_f32 v137, v214, v215
    v_mfma_f32_16x16x32_bf16 v[220:223], a[36:39], a[236:239], v[220:223]
    ds_read_b128 a[240:243], v224 offset:15744
    ds_read_b128 a[244:247], v224 offset:15808
    v_mfma_f32_16x16x32_bf16 v[212:215], a[8:11], v[164:167], 0
    v_cvt_pk_bf16_f32 v158, v148, v149
    v_cvt_pk_bf16_f32 v159, v150, v151
    v_mfma_f32_16x16x32_bf16 v[212:215], a[20:23], v[168:171], v[212:215]
    ds_read_b128 v[148:151], v228 offset:640
    v_mfma_f32_16x16x32_bf16 v[196:199], a[216:219], v[156:159], v[196:199]
    v_exp_f32 v152, v152
    v_mfma_f32_16x16x32_bf16 v[184:187], v[76:79], v[156:159], v[184:187]
    v_exp_f32 v153, v153
    v_mfma_f32_16x16x32_bf16 v[188:191], v[98:101], v[156:159], v[188:191]
    v_exp_f32 v154, v154
    v_mfma_f32_16x16x32_bf16 v[192:195], v[120:123], v[156:159], v[192:195]
    v_exp_f32 v155, v155
    v_mfma_f32_16x16x32_bf16 v[216:219], a[28:31], v[248:251], v[216:219]
    v_cvt_pk_bf16_f32 v156, v152, v153
    v_cvt_pk_bf16_f32 v157, v154, v155
    v_mfma_f32_16x16x32_bf16 v[216:219], a[40:43], a[236:239], v[216:219]
    ds_read_b128 v[152:155], v229 offset:640
    v_mfma_f32_16x16x32_bf16 v[212:215], a[32:35], v[248:251], v[212:215]
    v_exp_f32 v144, v144
    v_mfma_f32_16x16x32_bf16 v[212:215], a[44:47], a[236:239], v[212:215]
    s_waitcnt lgkmcnt(1)
    v_exp_f32 v145, v145
    v_mfma_f32_16x16x32_bf16 v[148:151], v[12:15], v[132:135], v[148:151]
    v_exp_f32 v146, v146
    v_mfma_f32_16x16x32_bf16 v[220:223], a[48:51], a[240:243], v[220:223]
    v_exp_f32 v147, v147
    v_mfma_f32_16x16x32_bf16 v[220:223], a[60:63], a[244:247], v[220:223]
    v_cvt_pk_bf16_f32 v158, v144, v145
    v_cvt_pk_bf16_f32 v159, v146, v147
    v_mfma_f32_16x16x16_bf16 v[148:151], v[16:17], v[136:137], v[148:151]
    ds_read_b128 v[144:147], v229 offset:1280
    v_mfma_f32_16x16x32_bf16 v[196:199], a[216:219], v[156:159], v[196:199]
    v_mfma_f32_16x16x32_bf16 v[184:187], v[82:85], v[156:159], v[184:187]
    v_mfma_f32_16x16x32_bf16 v[188:191], v[104:107], v[156:159], v[188:191]
    v_mfma_f32_16x16x32_bf16 v[192:195], v[126:129], v[156:159], v[192:195]
    s_waitcnt lgkmcnt(1)
    v_cvt_pk_bf16_f32 v6, v220, v221
    v_cvt_pk_bf16_f32 v7, v222, v223
    v_mfma_f32_16x16x32_bf16 v[152:155], v[36:39], v[132:135], v[152:155]
    v_exp_f32 v148, v148
    v_mfma_f32_16x16x32_bf16 v[216:219], a[52:55], a[240:243], v[216:219]
    v_rcp_f32 v197, v196
    v_mfma_f32_16x16x32_bf16 v[216:219], a[64:67], a[244:247], v[216:219]
    v_mul_f32 v184, v184, v197
    v_mul_f32 v185, v185, v197
    v_mfma_f32_16x16x16_bf16 v[152:155], v[40:41], v[136:137], v[152:155]
    s_waitcnt lgkmcnt(0)
    v_cvt_pk_bf16_f32 v184, v184, v185
    v_mul_f32 v186, v186, v197
    v_mfma_f32_16x16x32_bf16 v[144:147], v[42:45], v[132:135], v[144:147]
    v_mul_f32 v187, v187, v197
    v_cvt_pk_bf16_f32 v185, v186, v187
    v_mfma_f32_16x16x32_bf16 v[212:215], a[56:59], a[240:243], v[212:215]
    v_cvt_pk_bf16_f32 v8, v216, v217
    v_cvt_pk_bf16_f32 v9, v218, v219
    v_mfma_f32_16x16x32_bf16 v[212:215], a[68:71], a[244:247], v[212:215]
    v_mul_f32 v188, v188, v197
    v_mul_f32 v189, v189, v197
    v_mfma_f32_16x16x16_bf16 v[144:147], v[46:47], v[136:137], v[144:147]
    v_cvt_pk_bf16_f32 v186, v188, v189
    v_mul_f32 v190, v190, v197
    v_mfma_f32_16x16x32_bf16 v[220:223], v[164:167], a[72:75], 0
    v_mul_f32 v191, v191, v197
    v_cvt_pk_bf16_f32 v187, v190, v191
    v_mfma_f32_16x16x32_bf16 v[220:223], v[168:171], a[84:87], v[220:223]
    v_cvt_pk_bf16_f32 v10, v212, v213
    v_cvt_pk_bf16_f32 v11, v214, v215
    v_mfma_f32_16x16x32_bf16 v[216:219], v[164:167], a[76:79], 0
    v_mul_f32 v192, v192, v197
    v_mul_f32 v193, v193, v197
    v_mfma_f32_16x16x32_bf16 v[216:219], v[168:171], a[88:91], v[216:219]
    v_cvt_pk_bf16_f32 v188, v192, v193
    v_mul_f32 v194, v194, v197
    v_mfma_f32_16x16x32_bf16 v[212:215], v[164:167], a[80:83], 0
    ds_read_b128 v[164:167], v224 offset:18560
    v_mul_f32 v195, v195, v197
    v_mfma_f32_16x16x32_bf16 v[212:215], v[168:171], a[92:95], v[212:215]
    ds_read_b128 v[168:171], v224 offset:18624
    v_cvt_pk_bf16_f32 v189, v194, v195
    v_mfma_f32_16x16x32_bf16 v[220:223], v[248:251], a[96:99], v[220:223]
    v_max3_f32 v236, v236, v196, v197
    v_mfma_f32_16x16x32_bf16 v[220:223], a[236:239], a[108:111], v[220:223]
    ds_write_b128 v237, v[184:187] offset:18432
    v_mfma_f32_16x16x32_bf16 v[216:219], v[248:251], a[100:103], v[216:219]
    ds_write_b64 v238, v[188:189] offset:18432
    v_mfma_f32_16x16x32_bf16 v[216:219], a[236:239], a[112:115], v[216:219]
    v_exp_f32 v149, v149
    v_mfma_f32_16x16x32_bf16 v[212:215], v[248:251], a[104:107], v[212:215]
    v_exp_f32 v150, v150
    v_mfma_f32_16x16x32_bf16 v[212:215], a[236:239], a[116:119], v[212:215]
    v_exp_f32 v151, v151
    v_mfma_f32_16x16x32_bf16 v[220:223], a[240:243], a[120:123], v[220:223]
    ds_read_b128 v[248:251], v224 offset:18688
    ds_read_b128 a[236:239], v224 offset:18752
    v_mfma_f32_16x16x32_bf16 v[220:223], a[244:247], a[132:135], v[220:223]
    v_cvt_pk_bf16_f32 v156, v148, v149
    v_cvt_pk_bf16_f32 v157, v150, v151
    v_mfma_f32_16x16x32_bf16 v[216:219], a[240:243], a[124:127], v[216:219]
    ds_read_b128 v[148:151], v228 offset:1280
    v_mfma_f32_16x16x32_bf16 v[216:219], a[244:247], a[136:139], v[216:219]
    v_exp_f32 v152, v152
    v_mfma_f32_16x16x32_bf16 v[212:215], a[240:243], a[128:131], v[212:215]
    ds_read_b128 a[240:243], v224 offset:18816
    v_cvt_pk_bf16_f32 v72, v220, v221
    v_mfma_f32_16x16x32_bf16 v[212:215], a[244:247], a[140:143], v[212:215]
    s_waitcnt lgkmcnt(5)
    ds_read_b128 a[244:247], v224 offset:18880
    v_cvt_pk_bf16_f32 v73, v222, v223
    v_mfma_f32_16x16x32_bf16 v[220:223], a[0:3], v[164:167], 0
    v_cvt_pk_bf16_f32 v94, v216, v217
    v_cvt_pk_bf16_f32 v95, v218, v219
    v_mfma_f32_16x16x32_bf16 v[220:223], a[12:15], v[168:171], v[220:223]
    v_exp_f32 v153, v153
    v_mfma_f32_16x16x32_bf16 v[216:219], a[4:7], v[164:167], 0
    v_cvt_pk_bf16_f32 v116, v212, v213
    v_cvt_pk_bf16_f32 v117, v214, v215
    v_mfma_f32_16x16x32_bf16 v[216:219], a[16:19], v[168:171], v[216:219]
    s_waitcnt lgkmcnt(2)
    v_exp_f32 v154, v154
    v_mfma_f32_16x16x32_bf16 v[148:151], v[18:21], v[132:135], v[148:151]
    v_exp_f32 v155, v155
    v_mfma_f32_16x16x32_bf16 v[212:215], a[8:11], v[164:167], 0
    v_cvt_pk_bf16_f32 v158, v152, v153
    v_cvt_pk_bf16_f32 v159, v154, v155
    v_mfma_f32_16x16x32_bf16 v[212:215], a[20:23], v[168:171], v[212:215]
    ds_read_b128 v[152:155], v228 offset:1920
    v_mfma_f32_16x16x32_bf16 v[196:199], a[216:219], v[156:159], 0
    v_exp_f32 v144, v144
    v_mfma_f32_16x16x32_bf16 v[184:187], v[74:77], v[156:159], 0
    v_exp_f32 v145, v145
    v_mfma_f32_16x16x32_bf16 v[188:191], v[96:99], v[156:159], 0
    v_exp_f32 v146, v146
    v_mfma_f32_16x16x32_bf16 v[192:195], v[118:121], v[156:159], 0
    v_exp_f32 v147, v147
    v_mfma_f32_16x16x16_bf16 v[148:151], v[22:23], v[136:137], v[148:151]
    v_cvt_pk_bf16_f32 v156, v144, v145
    v_cvt_pk_bf16_f32 v157, v146, v147
    v_mfma_f32_16x16x32_bf16 v[220:223], a[24:27], v[248:251], v[220:223]
    ds_read_b128 v[144:147], v229 offset:1920
    v_mfma_f32_16x16x32_bf16 v[220:223], a[36:39], a[236:239], v[220:223]
    s_waitcnt lgkmcnt(1)
    v_mfma_f32_16x16x32_bf16 v[152:155], v[0:3], v[132:135], v[152:155]
    v_mfma_f32_16x16x32_bf16 v[216:219], a[28:31], v[248:251], v[216:219]
    v_mfma_f32_16x16x32_bf16 v[216:219], a[40:43], a[236:239], v[216:219]
    v_exp_f32 v148, v148
    v_mfma_f32_16x16x32_bf16 v[212:215], a[32:35], v[248:251], v[212:215]
    v_exp_f32 v149, v149
    v_mfma_f32_16x16x32_bf16 v[212:215], a[44:47], a[236:239], v[212:215]
    v_exp_f32 v150, v150
    v_mfma_f32_16x16x16_bf16 v[152:155], v[4:5], v[136:137], v[152:155]
    s_waitcnt lgkmcnt(0)
    v_exp_f32 v151, v151
    v_mfma_f32_16x16x32_bf16 v[144:147], v[24:27], v[132:135], v[144:147]
    v_cvt_pk_bf16_f32 v158, v148, v149
    v_cvt_pk_bf16_f32 v159, v150, v151
    v_mfma_f32_16x16x32_bf16 v[220:223], a[48:51], a[240:243], v[220:223]
    ds_read_b128 v[148:151], v229 offset:2560
    v_mfma_f32_16x16x32_bf16 v[220:223], a[60:63], a[244:247], v[220:223]
    v_mfma_f32_16x16x32_bf16 v[196:199], a[216:219], v[156:159], v[196:199]
    v_exp_f32 v152, v152
    v_mfma_f32_16x16x32_bf16 v[184:187], v[78:81], v[156:159], v[184:187]
    v_exp_f32 v153, v153
    v_mfma_f32_16x16x32_bf16 v[188:191], v[100:103], v[156:159], v[188:191]
    v_exp_f32 v154, v154
    v_mfma_f32_16x16x32_bf16 v[192:195], v[122:125], v[156:159], v[192:195]
    v_exp_f32 v155, v155
    v_mfma_f32_16x16x16_bf16 v[144:147], v[28:29], v[136:137], v[144:147]
    v_cvt_pk_bf16_f32 v30, v220, v221
    v_cvt_pk_bf16_f32 v31, v222, v223
    v_mfma_f32_16x16x32_bf16 v[216:219], a[52:55], a[240:243], v[216:219]
    v_cvt_pk_bf16_f32 v156, v152, v153
    v_cvt_pk_bf16_f32 v157, v154, v155
    v_mfma_f32_16x16x32_bf16 v[216:219], a[64:67], a[244:247], v[216:219]
    ds_read_b128 v[152:155], v228 offset:2560
    v_mfma_f32_16x16x32_bf16 v[212:215], a[56:59], a[240:243], v[212:215]
    v_exp_f32 v144, v144
    v_mfma_f32_16x16x32_bf16 v[212:215], a[68:71], a[244:247], v[212:215]
    v_exp_f32 v145, v145
    v_mfma_f32_16x16x32_bf16 v[208:211], v[252:255], a[248:251], v[208:211]
    v_exp_f32 v146, v146
    v_mfma_f32_16x16x32_bf16 v[200:203], v[252:255], a[252:255], v[200:203]
    v_cvt_pk_bf16_f32 v32, v216, v217
    v_cvt_pk_bf16_f32 v33, v218, v219
    v_mfma_f32_16x16x32_bf16 v[204:207], v[160:163], a[248:251], v[204:207]
    s_waitcnt lgkmcnt(1)
    ds_read_b128 v[252:255], v242 offset:12288
    v_cvt_pk_bf16_f32 v34, v212, v213
    v_mfma_f32_16x16x32_bf16 v[148:151], v[30:33], v[132:135], v[148:151]
    v_cvt_pk_bf16_f32 v35, v214, v215
    v_cvt_pk_bf16_f32 v158, v144, v145
    v_mfma_f32_16x16x32_bf16 v[180:183], v[160:163], a[252:255], v[180:183]
    s_waitcnt lgkmcnt(1)
    ds_read_b128 v[160:163], v242 offset:12800
    ds_read_b128 a[252:255], v240 offset:2048
    v_mfma_f32_16x16x32_bf16 v[152:155], v[6:9], v[132:135], v[152:155]
    v_exp_f32 v147, v147
    v_mfma_f32_16x16x16_bf16 v[148:151], v[34:35], v[136:137], v[148:151]
    v_cvt_pk_bf16_f32 v159, v146, v147
    v_mfma_f32_16x16x32_bf16 v[220:223], v[164:167], a[72:75], 0
    ds_read_b128 v[144:147], v230 offset:640
    v_mfma_f32_16x16x32_bf16 v[220:223], v[168:171], a[84:87], v[220:223]
    v_mfma_f32_16x16x32_bf16 v[196:199], a[216:219], v[156:159], v[196:199]
    v_mfma_f32_16x16x32_bf16 v[184:187], v[66:69], v[156:159], v[184:187]
    v_mfma_f32_16x16x32_bf16 v[188:191], v[88:91], v[156:159], v[188:191]
    v_mfma_f32_16x16x32_bf16 v[192:195], v[110:113], v[156:159], v[192:195]
    v_exp_f32 v148, v148
    v_mfma_f32_16x16x16_bf16 v[152:155], v[10:11], v[136:137], v[152:155]
    s_waitcnt lgkmcnt(1)
    v_exp_f32 v149, v149
    v_mfma_f32_16x16x32_bf16 v[176:179], v[252:255], a[248:251], v[176:179]
    ds_read_b128 v[252:255], v241 offset:24576
    v_cvt_pk_bf16_f32 v156, v148, v149
    v_mfma_f32_16x16x32_bf16 v[172:175], v[160:163], a[248:251], v[172:175]
    ds_read_b128 a[248:251], v239 offset:2048
    ds_read_b128 v[160:163], v241 offset:25088
    v_mfma_f32_16x16x32_bf16 v[216:219], v[164:167], a[76:79], 0
    v_exp_f32 v150, v150
    v_mfma_f32_16x16x32_bf16 v[216:219], v[168:171], a[88:91], v[216:219]
    v_exp_f32 v151, v151
    v_mfma_f32_16x16x32_bf16 v[212:215], v[164:167], a[80:83], 0
    ds_read_b128 v[164:167], v232 offset:4224
    v_cvt_pk_bf16_f32 v157, v150, v151
    v_mfma_f32_16x16x32_bf16 v[212:215], v[168:171], a[92:95], v[212:215]
    ds_read_b128 v[148:151], v230 offset:1280
    v_mfma_f32_16x16x32_bf16 v[220:223], v[248:251], a[96:99], v[220:223]
    ds_read_b128 v[168:171], v232 offset:4288
    v_mfma_f32_16x16x32_bf16 v[220:223], a[236:239], a[108:111], v[220:223]
    s_waitcnt lgkmcnt(4)
    v_exp_f32 v152, v152
    v_mfma_f32_16x16x32_bf16 v[208:211], v[252:255], a[248:251], v[208:211]
    v_exp_f32 v153, v153
    v_mfma_f32_16x16x32_bf16 v[200:203], v[252:255], a[252:255], v[200:203]
    s_waitcnt lgkmcnt(3)
    ds_read_b128 v[252:255], v242 offset:24576
    v_cvt_pk_bf16_f32 v158, v152, v153
    v_mfma_f32_16x16x32_bf16 v[204:207], v[160:163], a[248:251], v[204:207]
    v_exp_f32 v154, v154
    v_mfma_f32_16x16x32_bf16 v[180:183], v[160:163], a[252:255], v[180:183]
    ds_read_b128 v[160:163], v242 offset:25088
    ds_read_b128 a[252:255], v240 offset:3072
    v_mfma_f32_16x16x32_bf16 v[216:219], v[248:251], a[100:103], v[216:219]
    v_exp_f32 v155, v155
    v_mfma_f32_16x16x32_bf16 v[216:219], a[236:239], a[112:115], v[216:219]
    v_cvt_pk_bf16_f32 v159, v154, v155
    v_mfma_f32_16x16x32_bf16 v[212:215], v[248:251], a[104:107], v[212:215]
    ds_read_b128 v[152:155], v230 offset:1920
    v_mfma_f32_16x16x32_bf16 v[212:215], a[236:239], a[116:119], v[212:215]
    ds_read_b128 v[248:251], v232 offset:4352
    v_mfma_f32_16x16x32_bf16 v[196:199], a[216:219], v[156:159], v[196:199]
    s_waitcnt lgkmcnt(4)
    ds_read_b128 a[236:239], v232 offset:4416
    v_mfma_f32_16x16x32_bf16 v[176:179], v[252:255], a[248:251], v[176:179]
    s_waitcnt lgkmcnt(4)
    ds_read_b128 v[252:255], v241 offset:36864
    v_mfma_f32_16x16x32_bf16 v[172:175], v[160:163], a[248:251], v[172:175]
    ds_read_b128 a[248:251], v239 offset:3072
    v_mfma_f32_16x16x32_bf16 v[220:223], a[240:243], a[120:123], v[220:223]
    ds_read_b128 v[160:163], v241 offset:37376
    v_mfma_f32_16x16x32_bf16 v[220:223], a[244:247], a[132:135], v[220:223]
    v_rcp_f32 v197, v196
    v_mfma_f32_16x16x32_bf16 v[216:219], a[240:243], a[124:127], v[216:219]
    v_max3_f32 v236, v236, v196, v197
    v_mfma_f32_16x16x32_bf16 v[216:219], a[244:247], a[136:139], v[216:219]
    v_mfma_f32_16x16x32_bf16 v[212:215], a[240:243], a[128:131], v[212:215]
    ds_read_b128 a[240:243], v232 offset:4480
    v_mfma_f32_16x16x32_bf16 v[212:215], a[244:247], a[140:143], v[212:215]
    s_waitcnt lgkmcnt(3)
    ds_read_b128 a[244:247], v232 offset:4544
    v_cvt_pk_bf16_f32 v70, v220, v221
    v_mfma_f32_16x16x32_bf16 v[200:203], v[252:255], a[252:255], v[200:203]
    s_waitcnt lgkmcnt(3)
    v_cvt_pk_bf16_f32 v71, v222, v223
    v_or_b32 v232, v243, v245
    v_mfma_f32_16x16x32_bf16 v[208:211], v[252:255], a[248:251], v[208:211]
    v_cvt_pk_bf16_f32 v92, v216, v217
    v_cvt_pk_bf16_f32 v93, v218, v219
    v_mfma_f32_16x16x32_bf16 v[184:187], v[70:73], v[156:159], v[184:187]
    v_cvt_pk_bf16_f32 v114, v212, v213
    v_cvt_pk_bf16_f32 v115, v214, v215
    v_mfma_f32_16x16x32_bf16 v[188:191], v[92:95], v[156:159], v[188:191]
    ds_read_b128 v[252:255], v242 offset:36864
    v_lshrrev_b32 v232, 31, v232
    v_mfma_f32_16x16x32_bf16 v[192:195], v[114:117], v[156:159], v[192:195]
    s_waitcnt lgkmcnt(3)
    v_lshl_add_u32 v232, v232, 20, v225
    v_mfma_f32_16x16x32_bf16 v[204:207], v[160:163], a[248:251], v[204:207]
    v_mul_f32 v184, v184, v197
    v_mul_f32 v185, v185, v197
    v_mfma_f32_16x16x32_bf16 v[180:183], v[160:163], a[252:255], v[180:183]
    ds_read_b128 v[160:163], v242 offset:37376
    ds_read_b128 a[252:255], v240 offset:4096
    v_mfma_f32_16x16x32_bf16 v[220:223], a[144:147], v[164:167], 0
    v_cvt_pk_bf16_f32 v184, v184, v185
    v_mul_f32 v186, v186, v197
    v_mfma_f32_16x16x32_bf16 v[220:223], a[156:159], v[168:171], v[220:223]
    v_mul_f32 v187, v187, v197
    v_cvt_pk_bf16_f32 v185, v186, v187
    v_mfma_f32_16x16x32_bf16 v[216:219], a[148:151], v[164:167], 0
    v_mul_f32 v188, v188, v197
    v_mul_f32 v189, v189, v197
    v_mfma_f32_16x16x32_bf16 v[216:219], a[160:163], v[168:171], v[216:219]
    s_waitcnt lgkmcnt(2)
    v_cvt_pk_bf16_f32 v186, v188, v189
    v_mul_f32 v190, v190, v197
    v_mfma_f32_16x16x32_bf16 v[176:179], v[252:255], a[248:251], v[176:179]
    ds_read_b128 v[252:255], v241 offset:49152
    v_mul_f32 v191, v191, v197
    v_mfma_f32_16x16x32_bf16 v[212:215], a[152:155], v[164:167], 0
    ds_read_b128 v[164:167], v225 offset:8896
    v_cvt_pk_bf16_f32 v187, v190, v191
    v_mfma_f32_16x16x32_bf16 v[212:215], a[164:167], v[168:171], v[212:215]
    s_waitcnt lgkmcnt(3)
    ds_read_b128 v[168:171], v225 offset:8960
    v_mul_f32 v192, v192, v197
    v_mfma_f32_16x16x32_bf16 v[172:175], v[160:163], a[248:251], v[172:175]
    ds_read_b128 a[248:251], v239 offset:4096
    ds_read_b128 v[160:163], v241 offset:49664
    v_mfma_f32_16x16x32_bf16 v[220:223], a[168:171], v[248:251], v[220:223]
    v_mul_f32 v193, v193, v197
    v_cvt_pk_bf16_f32 v188, v192, v193
    v_mfma_f32_16x16x32_bf16 v[220:223], a[180:183], a[236:239], v[220:223]
    v_mul_f32 v194, v194, v197
    v_mul_f32 v195, v195, v197
    v_mfma_f32_16x16x32_bf16 v[216:219], a[172:175], v[248:251], v[216:219]
    v_cvt_pk_bf16_f32 v189, v194, v195
    v_mfma_f32_16x16x32_bf16 v[216:219], a[184:187], a[236:239], v[216:219]
    s_waitcnt lgkmcnt(4)
    v_mfma_f32_16x16x32_bf16 v[200:203], v[252:255], a[252:255], v[200:203]
    v_mfma_f32_16x16x32_bf16 v[212:215], a[176:179], v[248:251], v[212:215]
    ds_read_b128 v[248:251], v225 offset:9024
    v_mfma_f32_16x16x32_bf16 v[212:215], a[188:191], a[236:239], v[212:215]
    s_waitcnt lgkmcnt(2)
    ds_read_b128 a[236:239], v225 offset:9088
    v_mfma_f32_16x16x32_bf16 v[208:211], v[252:255], a[248:251], v[208:211]
    s_waitcnt lgkmcnt(2)
    ds_read_b128 v[252:255], v242 offset:49152
    v_mfma_f32_16x16x32_bf16 v[204:207], v[160:163], a[248:251], v[204:207]
    v_mfma_f32_16x16x32_bf16 v[180:183], v[160:163], a[252:255], v[180:183]
    ds_read_b128 v[160:163], v242 offset:49664
    ds_read_b128 a[252:255], v240 offset:5120
    v_mfma_f32_16x16x32_bf16 v[220:223], a[192:195], a[240:243], v[220:223]
    v_mfma_f32_16x16x32_bf16 v[220:223], a[204:207], a[244:247], v[220:223]
    v_mfma_f32_16x16x32_bf16 v[216:219], a[196:199], a[240:243], v[216:219]
    v_mfma_f32_16x16x32_bf16 v[216:219], a[208:211], a[244:247], v[216:219]
    s_waitcnt lgkmcnt(2)
    v_mfma_f32_16x16x32_bf16 v[176:179], v[252:255], a[248:251], v[176:179]
    ds_read_b128 v[252:255], v241 offset:61440
    v_mfma_f32_16x16x32_bf16 v[212:215], a[200:203], a[240:243], v[212:215]
    ds_read_b128 a[240:243], v225 offset:9152
    v_mfma_f32_16x16x32_bf16 v[212:215], a[212:215], a[244:247], v[212:215]
    s_waitcnt lgkmcnt(3)
    ds_read_b128 a[244:247], v225 offset:9216
    v_mul_f32 v220, s37, v220
    v_mfma_f32_16x16x32_bf16 v[172:175], v[160:163], a[248:251], v[172:175]
    v_mul_f32 v221, s37, v221
    v_mul_f32 v222, s37, v222
    v_mul_f32 v223, s37, v223
    v_cvt_pk_bf16_f32 v138, v220, v221
    v_cvt_pk_bf16_f32 v139, v222, v223
    v_mfma_f32_16x16x32_bf16 v[220:223], a[144:147], v[164:167], 0
    v_mul_f32 v216, s37, v216
    v_mul_f32 v217, s37, v217
    v_mfma_f32_16x16x32_bf16 v[220:223], a[156:159], v[168:171], v[220:223]
L_pg4:
    s_cbranch_execz L_pg8
    v_mul_f32 v218, s37, v218
    v_mul_f32 v219, s37, v219
    v_mfma_f32_16x16x32_bf16 v[220:223], a[168:171], v[248:251], v[220:223]
    v_cvt_pk_bf16_f32 v140, v216, v217
    v_cvt_pk_bf16_f32 v141, v218, v219
    v_mfma_f32_16x16x32_bf16 v[220:223], a[180:183], a[236:239], v[220:223]
    v_mul_f32 v212, s37, v212
    v_mul_f32 v213, s37, v213
    v_mfma_f32_16x16x32_bf16 v[144:147], v[36:39], v[138:141], v[144:147]
    v_mul_f32 v214, s37, v214
    v_mul_f32 v215, s37, v215
    v_mfma_f32_16x16x32_bf16 v[148:151], v[42:45], v[138:141], v[148:151]
    v_cvt_pk_bf16_f32 v142, v212, v213
    v_cvt_pk_bf16_f32 v143, v214, v215
    v_mfma_f32_16x16x32_bf16 v[152:155], v[24:27], v[138:141], v[152:155]
    ds_read_b128 a[248:251], v239 offset:5120
    ds_read_b128 v[160:163], v241 offset:61952
    v_mfma_f32_16x16x16_bf16 v[144:147], v[40:41], v[142:143], v[144:147]
    v_mfma_f32_16x16x16_bf16 v[148:151], v[46:47], v[142:143], v[148:151]
    s_waitcnt lgkmcnt(2)
    v_mfma_f32_16x16x32_bf16 v[200:203], v[252:255], a[252:255], v[200:203]
    v_mfma_f32_16x16x32_bf16 v[216:219], a[148:151], v[164:167], 0
    v_mfma_f32_16x16x32_bf16 v[216:219], a[160:163], v[168:171], v[216:219]
    v_mfma_f32_16x16x16_bf16 v[152:155], v[28:29], v[142:143], v[152:155]
    s_waitcnt vmcnt(0) lgkmcnt(0)
    v_mfma_f32_16x16x32_bf16 v[208:211], v[252:255], a[248:251], v[208:211]
    s_barrier
    ds_read_b128 v[252:255], v242 offset:61440
    v_mfma_f32_16x16x32_bf16 v[204:207], v[160:163], a[248:251], v[204:207]
    ds_write_b128 v237, v[184:187]
    v_mfma_f32_16x16x32_bf16 v[180:183], v[160:163], a[252:255], v[180:183]
    ds_write_b64 v238, v[188:189]
    v_mfma_f32_16x16x32_bf16 v[212:215], a[152:155], v[164:167], 0
    buffer_load_dwordx4 v246, s[4:7], s56 offen lds
    v_mfma_f32_16x16x32_bf16 v[212:215], a[164:167], v[168:171], v[212:215]
    v_cvt_pk_bf16_f32 v208, v208, v209
    v_cvt_pk_bf16_f32 v209, v210, v211
    v_mfma_f32_16x16x32_bf16 v[216:219], a[172:175], v[248:251], v[216:219]
    v_cvt_pk_bf16_f32 v210, v204, v205
    v_cvt_pk_bf16_f32 v211, v206, v207
    v_mfma_f32_16x16x32_bf16 v[216:219], a[184:187], a[236:239], v[216:219]
    s_waitcnt lgkmcnt(2)
    ds_read_b128 v[160:163], v242 offset:61952
    ds_read_b128 a[252:255], v240 offset:12288
    v_mfma_f32_16x16x32_bf16 v[176:179], v[252:255], a[248:251], v[176:179]
    ds_read_b128 v[252:255], v241 offset:12288
    v_cvt_pk_bf16_f32 v200, v200, v201
    v_mfma_f32_16x16x32_bf16 v[212:215], a[176:179], v[248:251], v[212:215]
    ds_read_b128 v[164:167], v224 offset:30976
    v_cvt_pk_bf16_f32 v201, v202, v203
    v_mfma_f32_16x16x32_bf16 v[212:215], a[188:191], a[236:239], v[212:215]
    ds_read_b128 v[168:171], v224 offset:31040
    v_cvt_pk_bf16_f32 v202, v180, v181
    v_mfma_f32_16x16x32_bf16 v[220:223], a[192:195], a[240:243], v[220:223]
    ds_read_b128 v[248:251], v224 offset:31104
    v_cvt_pk_bf16_f32 v203, v182, v183
    v_mfma_f32_16x16x32_bf16 v[220:223], a[204:207], a[244:247], v[220:223]
    ds_read_b128 a[236:239], v224 offset:31168
    v_cvt_pk_bf16_f32 v176, v176, v177
    v_mfma_f32_16x16x32_bf16 v[216:219], a[196:199], a[240:243], v[216:219]
    s_waitcnt lgkmcnt(6)
    buffer_load_dwordx4 v247, s[4:7], s56 offen offset:1024 lds
    v_mfma_f32_16x16x32_bf16 v[216:219], a[208:211], a[244:247], v[216:219]
    s_add_u32 s56, s56, s42
    v_cvt_pk_bf16_f32 v177, v178, v179
    s_add_u32 m0, s41, 0xd3c0
    v_mfma_f32_16x16x32_bf16 v[172:175], v[160:163], a[248:251], v[172:175]
    v_mul_f32 v220, s37, v220
    v_mul_f32 v221, s37, v221
    v_mfma_f32_16x16x32_bf16 v[212:215], a[200:203], a[240:243], v[212:215]
    v_mul_f32 v222, s37, v222
    v_mul_f32 v223, s37, v223
    v_mfma_f32_16x16x32_bf16 v[212:215], a[212:215], a[244:247], v[212:215]
    s_waitcnt lgkmcnt(4)
    v_cvt_pk_bf16_f32 v132, v220, v221
    v_cvt_pk_bf16_f32 v133, v222, v223
    v_mfma_f32_16x16x32_bf16 v[180:183], a[224:227], a[252:255], 0
    s_waitcnt lgkmcnt(3)
    v_mul_f32 v216, s37, v216
    v_mul_f32 v217, s37, v217
    v_mfma_f32_16x16x32_bf16 v[220:223], a[0:3], v[164:167], 0
    s_waitcnt lgkmcnt(2)
    v_mul_f32 v218, s37, v218
    v_mul_f32 v219, s37, v219
    v_mfma_f32_16x16x32_bf16 v[220:223], a[12:15], v[168:171], v[220:223]
    v_cvt_pk_bf16_f32 v134, v216, v217
    v_cvt_pk_bf16_f32 v135, v218, v219
    v_mfma_f32_16x16x32_bf16 v[216:219], a[4:7], v[164:167], 0
    v_mul_f32 v212, s37, v212
    v_mul_f32 v213, s37, v213
    v_mfma_f32_16x16x32_bf16 v[216:219], a[16:19], v[168:171], v[216:219]
    s_waitcnt lgkmcnt(0)
    v_mul_f32 v214, s37, v214
    v_mul_f32 v215, s37, v215
    v_mfma_f32_16x16x32_bf16 v[220:223], a[24:27], v[248:251], v[220:223]
    v_cvt_pk_bf16_f32 v136, v212, v213
    v_cvt_pk_bf16_f32 v137, v214, v215
    v_mfma_f32_16x16x32_bf16 v[220:223], a[36:39], a[236:239], v[220:223]
    ds_read_b128 a[248:251], v239 offset:12288
    ds_read_b128 v[160:163], v241 offset:12800
    v_mfma_f32_16x16x32_bf16 v[212:215], a[8:11], v[164:167], 0
    ds_read_b128 a[240:243], v224 offset:31232
    v_cvt_pk_bf16_f32 v178, v172, v173
    v_mfma_f32_16x16x32_bf16 v[212:215], a[20:23], v[168:171], v[212:215]
    ds_read_b128 a[244:247], v224 offset:31296
    v_cvt_pk_bf16_f32 v179, v174, v175
    v_mfma_f32_16x16x32_bf16 v[216:219], a[28:31], v[248:251], v[216:219]
    buffer_load_dwordx4 v246, s[4:7], s56 offen lds
    v_mfma_f32_16x16x32_bf16 v[216:219], a[40:43], a[236:239], v[216:219]
    v_exp_f32 v144, v144
    v_mfma_f32_16x16x32_bf16 v[212:215], a[32:35], v[248:251], v[212:215]
    v_exp_f32 v145, v145
    v_mfma_f32_16x16x32_bf16 v[212:215], a[44:47], a[236:239], v[212:215]
    s_waitcnt lgkmcnt(3)
    v_exp_f32 v146, v146
    v_mfma_f32_16x16x32_bf16 v[204:207], a[224:227], a[248:251], 0
    v_exp_f32 v147, v147
    v_mfma_f32_16x16x32_bf16 v[172:175], a[232:235], a[248:251], 0
    s_waitcnt lgkmcnt(1)
    v_cvt_pk_bf16_f32 v156, v144, v145
    v_cvt_pk_bf16_f32 v157, v146, v147
    v_mfma_f32_16x16x32_bf16 v[220:223], a[48:51], a[240:243], v[220:223]
    s_waitcnt lgkmcnt(0)
    ds_read_b128 v[144:147], v230 offset:2560
    v_mfma_f32_16x16x32_bf16 v[220:223], a[60:63], a[244:247], v[220:223]
    buffer_load_dwordx4 v247, s[4:7], s56 offen offset:1024 lds
    v_mfma_f32_16x16x32_bf16 v[216:219], a[52:55], a[240:243], v[216:219]
    s_add_u32 s56, s56, s42
    v_exp_f32 v148, v148
    v_mfma_f32_16x16x32_bf16 v[216:219], a[64:67], a[244:247], v[216:219]
    s_add_u32 m0, s41, 0
    v_exp_f32 v149, v149
    v_mfma_f32_16x16x32_bf16 v[212:215], a[56:59], a[240:243], v[212:215]
    v_cvt_pk_bf16_f32 v12, v220, v221
    v_cvt_pk_bf16_f32 v13, v222, v223
    v_mfma_f32_16x16x32_bf16 v[212:215], a[68:71], a[244:247], v[212:215]
    v_exp_f32 v150, v150
    v_mfma_f32_16x16x32_bf16 v[220:223], v[164:167], a[72:75], 0
    v_cvt_pk_bf16_f32 v14, v216, v217
    v_cvt_pk_bf16_f32 v15, v218, v219
    v_mfma_f32_16x16x32_bf16 v[220:223], v[168:171], a[84:87], v[220:223]
    s_waitcnt lgkmcnt(0)
    buffer_store_dwordx4 v[208:211], v243, s[20:23], s51 offen sc0 sc1
    v_mfma_f32_16x16x32_bf16 v[144:147], v[30:33], v[138:141], v[144:147]
    v_exp_f32 v151, v151
    v_mfma_f32_16x16x32_bf16 v[208:211], a[220:223], a[248:251], 0
    v_cvt_pk_bf16_f32 v16, v212, v213
    v_cvt_pk_bf16_f32 v17, v214, v215
    v_mfma_f32_16x16x32_bf16 v[216:219], v[164:167], a[76:79], 0
    v_cvt_pk_bf16_f32 v158, v148, v149
    v_cvt_pk_bf16_f32 v159, v150, v151
    v_mfma_f32_16x16x32_bf16 v[216:219], v[168:171], a[88:91], v[216:219]
    ds_read_b128 v[148:151], v235
    v_bfe_u32 v235, s70, v233, 4
    v_mfma_f32_16x16x32_bf16 v[196:199], a[216:219], v[156:159], 0
    v_mad_u32_u24 v235, v235, s40, v231
    v_mfma_f32_16x16x32_bf16 v[184:187], v[76:79], v[156:159], 0
    v_exp_f32 v152, v152
    v_mfma_f32_16x16x32_bf16 v[188:191], v[98:101], v[156:159], 0
    v_exp_f32 v153, v153
    v_mfma_f32_16x16x32_bf16 v[192:195], v[120:123], v[156:159], 0
    v_exp_f32 v154, v154
    v_mfma_f32_16x16x16_bf16 v[144:147], v[34:35], v[142:143], v[144:147]
    v_exp_f32 v155, v155
    v_mfma_f32_16x16x32_bf16 v[212:215], v[164:167], a[80:83], 0
    ds_read_b128 v[164:167], v224 offset:34048
    v_cvt_pk_bf16_f32 v156, v152, v153
    v_mfma_f32_16x16x32_bf16 v[212:215], v[168:171], a[92:95], v[212:215]
    s_waitcnt lgkmcnt(1)
    ds_read_b128 v[168:171], v224 offset:34112
    v_cvt_pk_bf16_f32 v157, v154, v155
    v_mfma_f32_16x16x32_bf16 v[148:151], v[54:57], v[138:141], v[148:151]
    ds_read_b128 v[152:155], v234
    v_bfe_u32 v234, s67, v233, 4
    v_mfma_f32_16x16x32_bf16 v[220:223], v[248:251], a[96:99], v[220:223]
    v_mad_u32_u24 v234, v234, s40, v231
    v_mfma_f32_16x16x32_bf16 v[220:223], a[236:239], a[108:111], v[220:223]
    buffer_store_dwordx4 v[200:203], v245, s[20:23], s51 offen sc0 sc1
    v_mfma_f32_16x16x16_bf16 v[148:151], v[58:59], v[142:143], v[148:151]
    v_exp_f32 v144, v144
    v_mfma_f32_16x16x32_bf16 v[200:203], a[220:223], a[252:255], 0
    ds_read_b128 a[252:255], v240 offset:13312
    v_mfma_f32_16x16x32_bf16 v[216:219], v[248:251], a[100:103], v[216:219]
    v_exp_f32 v145, v145
    v_mfma_f32_16x16x32_bf16 v[216:219], a[236:239], a[112:115], v[216:219]
    s_waitcnt lgkmcnt(1)
    v_exp_f32 v146, v146
    v_mfma_f32_16x16x32_bf16 v[152:155], v[60:63], v[138:141], v[152:155]
    v_exp_f32 v147, v147
    v_mfma_f32_16x16x32_bf16 v[212:215], v[248:251], a[104:107], v[212:215]
    ds_read_b128 v[248:251], v224 offset:34176
    v_cvt_pk_bf16_f32 v158, v144, v145
    v_mfma_f32_16x16x32_bf16 v[212:215], a[236:239], a[116:119], v[212:215]
    ds_read_b128 a[236:239], v224 offset:34240
    v_cvt_pk_bf16_f32 v159, v146, v147
    v_mfma_f32_16x16x16_bf16 v[152:155], v[64:65], v[142:143], v[152:155]
    ds_read_b128 v[144:147], v229 offset:640
    v_mfma_f32_16x16x32_bf16 v[196:199], a[216:219], v[156:159], v[196:199]
    v_exp_f32 v148, v148
    v_mfma_f32_16x16x32_bf16 v[184:187], v[68:71], v[156:159], v[184:187]
    v_exp_f32 v149, v149
    v_mfma_f32_16x16x32_bf16 v[188:191], v[90:93], v[156:159], v[188:191]
    v_exp_f32 v150, v150
    v_mfma_f32_16x16x32_bf16 v[192:195], v[112:115], v[156:159], v[192:195]
    s_waitcnt lgkmcnt(3)
    buffer_store_dwordx4 v[176:179], v244, s[20:23], s51 offen sc0 sc1
    v_mfma_f32_16x16x32_bf16 v[200:203], v[252:255], a[252:255], v[200:203]
    s_add_u32 s51, s51, s48
    v_exp_f32 v151, v151
    v_mfma_f32_16x16x32_bf16 v[176:179], a[228:231], a[248:251], 0
    s_waitcnt lgkmcnt(0)
    ds_read_b128 a[248:251], v239 offset:13312
    v_cvt_pk_bf16_f32 v156, v148, v149
    v_mfma_f32_16x16x32_bf16 v[144:147], v[42:45], v[132:135], v[144:147]
    v_cvt_pk_bf16_f32 v157, v150, v151
    v_mfma_f32_16x16x32_bf16 v[180:183], v[160:163], a[252:255], v[180:183]
    ds_read_b128 v[148:151], v228 offset:640
    v_mfma_f32_16x16x32_bf16 v[220:223], a[240:243], a[120:123], v[220:223]
    ds_read_b128 a[252:255], v240 offset:14336
    v_mfma_f32_16x16x32_bf16 v[220:223], a[244:247], a[132:135], v[220:223]
    v_exp_f32 v152, v152
    v_mfma_f32_16x16x16_bf16 v[144:147], v[46:47], v[136:137], v[144:147]
    v_exp_f32 v153, v153
    v_mfma_f32_16x16x32_bf16 v[216:219], a[240:243], a[124:127], v[216:219]
    v_exp_f32 v154, v154
    v_mfma_f32_16x16x32_bf16 v[216:219], a[244:247], a[136:139], v[216:219]
    s_waitcnt lgkmcnt(2)
    v_exp_f32 v155, v155
    v_mfma_f32_16x16x32_bf16 v[208:211], v[252:255], a[248:251], v[208:211]
    ds_read_b128 v[252:255], v242 offset:12288
    v_cvt_pk_bf16_f32 v74, v220, v221
    v_mfma_f32_16x16x32_bf16 v[204:207], v[160:163], a[248:251], v[204:207]
    s_waitcnt lgkmcnt(2)
    ds_read_b128 v[160:163], v242 offset:12800
    v_cvt_pk_bf16_f32 v75, v222, v223
    v_mfma_f32_16x16x32_bf16 v[148:151], v[18:21], v[132:135], v[148:151]
    v_cvt_pk_bf16_f32 v96, v216, v217
    v_cvt_pk_bf16_f32 v97, v218, v219
    v_mfma_f32_16x16x32_bf16 v[212:215], a[240:243], a[128:131], v[212:215]
    ds_read_b128 a[240:243], v224 offset:34304
    v_cvt_pk_bf16_f32 v158, v152, v153
    v_mfma_f32_16x16x32_bf16 v[212:215], a[244:247], a[140:143], v[212:215]
    ds_read_b128 a[244:247], v224 offset:34368
    v_cvt_pk_bf16_f32 v159, v154, v155
    v_mfma_f32_16x16x16_bf16 v[148:151], v[22:23], v[136:137], v[148:151]
    ds_read_b128 v[152:155], v228 offset:1280
    v_mfma_f32_16x16x32_bf16 v[196:199], a[216:219], v[156:159], v[196:199]
    v_exp_f32 v144, v144
    v_mfma_f32_16x16x32_bf16 v[184:187], v[84:87], v[156:159], v[184:187]
    v_exp_f32 v145, v145
    v_mfma_f32_16x16x32_bf16 v[188:191], v[106:109], v[156:159], v[188:191]
    v_cvt_pk_bf16_f32 v118, v212, v213
    v_cvt_pk_bf16_f32 v119, v214, v215
    v_mfma_f32_16x16x32_bf16 v[192:195], v[128:131], v[156:159], v[192:195]
    s_waitcnt lgkmcnt(3)
    v_exp_f32 v146, v146
    v_mfma_f32_16x16x32_bf16 v[176:179], v[252:255], a[248:251], v[176:179]
    ds_read_b128 v[252:255], v241 offset:24576
    v_cvt_pk_bf16_f32 v156, v144, v145
    v_mfma_f32_16x16x32_bf16 v[172:175], v[160:163], a[248:251], v[172:175]
    ds_read_b128 a[248:251], v239 offset:14336
    ds_read_b128 v[160:163], v241 offset:25088
    v_mfma_f32_16x16x32_bf16 v[220:223], a[0:3], v[164:167], 0
    v_rcp_f32 v197, v196
    v_mfma_f32_16x16x32_bf16 v[220:223], a[12:15], v[168:171], v[220:223]
    s_waitcnt lgkmcnt(3)
    v_mul_f32 v184, v184, v197
    v_mul_f32 v185, v185, v197
    v_mfma_f32_16x16x32_bf16 v[152:155], v[0:3], v[132:135], v[152:155]
    v_cvt_pk_bf16_f32 v184, v184, v185
    v_mul_f32 v186, v186, v197
    v_mfma_f32_16x16x32_bf16 v[216:219], a[4:7], v[164:167], 0
    v_mul_f32 v187, v187, v197
    v_cvt_pk_bf16_f32 v185, v186, v187
    v_mfma_f32_16x16x32_bf16 v[216:219], a[16:19], v[168:171], v[216:219]
    v_mul_f32 v188, v188, v197
    v_mul_f32 v189, v189, v197
    v_mfma_f32_16x16x16_bf16 v[152:155], v[4:5], v[136:137], v[152:155]
    s_waitcnt lgkmcnt(1)
    v_cvt_pk_bf16_f32 v186, v188, v189
    v_mul_f32 v190, v190, v197
    v_mfma_f32_16x16x32_bf16 v[208:211], v[252:255], a[248:251], v[208:211]
    v_mul_f32 v191, v191, v197
    v_cvt_pk_bf16_f32 v187, v190, v191
    v_mfma_f32_16x16x32_bf16 v[200:203], v[252:255], a[252:255], v[200:203]
    s_waitcnt lgkmcnt(0)
    ds_read_b128 v[252:255], v242 offset:24576
    v_mul_f32 v192, v192, v197
    v_mfma_f32_16x16x32_bf16 v[204:207], v[160:163], a[248:251], v[204:207]
    v_mul_f32 v193, v193, v197
    v_cvt_pk_bf16_f32 v188, v192, v193
    v_mfma_f32_16x16x32_bf16 v[180:183], v[160:163], a[252:255], v[180:183]
    ds_read_b128 v[160:163], v242 offset:25088
    ds_read_b128 a[252:255], v240 offset:15360
    v_mfma_f32_16x16x32_bf16 v[212:215], a[8:11], v[164:167], 0
    v_mul_f32 v194, v194, v197
    v_mul_f32 v195, v195, v197
    v_mfma_f32_16x16x32_bf16 v[212:215], a[20:23], v[168:171], v[212:215]
    v_cvt_pk_bf16_f32 v189, v194, v195
    v_max3_f32 v236, v236, v196, v197
    v_mfma_f32_16x16x32_bf16 v[220:223], a[24:27], v[248:251], v[220:223]
    ds_write_b128 v237, v[184:187] offset:6144
    v_mfma_f32_16x16x32_bf16 v[220:223], a[36:39], a[236:239], v[220:223]
    s_waitcnt lgkmcnt(3)
    ds_write_b64 v238, v[188:189] offset:6144
    v_mfma_f32_16x16x32_bf16 v[176:179], v[252:255], a[248:251], v[176:179]
    s_waitcnt lgkmcnt(3)
    v_exp_f32 v147, v147
    v_mfma_f32_16x16x32_bf16 v[172:175], v[160:163], a[248:251], v[172:175]
    v_cvt_pk_bf16_f32 v157, v146, v147
    v_mfma_f32_16x16x32_bf16 v[216:219], a[28:31], v[248:251], v[216:219]
    v_exp_f32 v148, v148
    v_mfma_f32_16x16x32_bf16 v[216:219], a[40:43], a[236:239], v[216:219]
    ds_read_b128 v[144:147], v229 offset:1280
    v_mfma_f32_16x16x32_bf16 v[212:215], a[32:35], v[248:251], v[212:215]
    ds_read_b128 a[248:251], v239 offset:15360
    v_mfma_f32_16x16x32_bf16 v[212:215], a[44:47], a[236:239], v[212:215]
    ds_read_b128 v[252:255], v241 offset:36864
    v_mfma_f32_16x16x32_bf16 v[220:223], a[48:51], a[240:243], v[220:223]
    ds_read_b128 v[160:163], v241 offset:37376
    v_mfma_f32_16x16x32_bf16 v[220:223], a[60:63], a[244:247], v[220:223]
    v_exp_f32 v149, v149
    v_mfma_f32_16x16x32_bf16 v[216:219], a[52:55], a[240:243], v[216:219]
    v_exp_f32 v150, v150
    v_mfma_f32_16x16x32_bf16 v[216:219], a[64:67], a[244:247], v[216:219]
    v_exp_f32 v151, v151
    v_mfma_f32_16x16x32_bf16 v[212:215], a[56:59], a[240:243], v[212:215]
    v_cvt_pk_bf16_f32 v158, v148, v149
    v_cvt_pk_bf16_f32 v159, v150, v151
    v_mfma_f32_16x16x32_bf16 v[212:215], a[68:71], a[244:247], v[212:215]
    ds_read_b128 v[148:151], v229 offset:1920
    v_cvt_pk_bf16_f32 v36, v220, v221
    v_mfma_f32_16x16x32_bf16 v[196:199], a[216:219], v[156:159], 0
    v_cvt_pk_bf16_f32 v37, v222, v223
    v_cvt_pk_bf16_f32 v38, v216, v217
    v_mfma_f32_16x16x32_bf16 v[184:187], v[78:81], v[156:159], 0
    v_cvt_pk_bf16_f32 v39, v218, v219
    v_mfma_f32_16x16x32_bf16 v[188:191], v[100:103], v[156:159], 0
    v_cvt_pk_bf16_f32 v40, v212, v213
    v_cvt_pk_bf16_f32 v41, v214, v215
    v_mfma_f32_16x16x32_bf16 v[192:195], v[122:125], v[156:159], 0
    s_waitcnt lgkmcnt(1)
    v_exp_f32 v152, v152
    v_mfma_f32_16x16x32_bf16 v[144:147], v[24:27], v[132:135], v[144:147]
    v_exp_f32 v153, v153
    v_mfma_f32_16x16x32_bf16 v[208:211], v[252:255], a[248:251], v[208:211]
    v_exp_f32 v154, v154
    v_mfma_f32_16x16x32_bf16 v[200:203], v[252:255], a[252:255], v[200:203]
    ds_read_b128 v[252:255], v242 offset:36864
    v_cvt_pk_bf16_f32 v156, v152, v153
    v_mfma_f32_16x16x16_bf16 v[144:147], v[28:29], v[136:137], v[144:147]
    s_waitcnt lgkmcnt(1)
    v_exp_f32 v155, v155
    v_mfma_f32_16x16x32_bf16 v[148:151], v[30:33], v[132:135], v[148:151]
    v_cvt_pk_bf16_f32 v157, v154, v155
    v_mfma_f32_16x16x32_bf16 v[204:207], v[160:163], a[248:251], v[204:207]
    ds_read_b128 v[152:155], v228 offset:1920
    v_mfma_f32_16x16x32_bf16 v[180:183], v[160:163], a[252:255], v[180:183]
    ds_read_b128 v[160:163], v242 offset:37376
    v_mfma_f32_16x16x32_bf16 v[220:223], v[164:167], a[72:75], 0
    ds_read_b128 a[252:255], v240 offset:16384
    v_mfma_f32_16x16x32_bf16 v[220:223], v[168:171], a[84:87], v[220:223]
    v_exp_f32 v144, v144
    v_mfma_f32_16x16x16_bf16 v[148:151], v[34:35], v[136:137], v[148:151]
    s_waitcnt lgkmcnt(3)
    v_exp_f32 v145, v145
    v_mfma_f32_16x16x32_bf16 v[176:179], v[252:255], a[248:251], v[176:179]
    ds_read_b128 v[252:255], v241 offset:49152
    v_cvt_pk_bf16_f32 v158, v144, v145
    v_mfma_f32_16x16x32_bf16 v[216:219], v[164:167], a[76:79], 0
    v_exp_f32 v146, v146
    v_mfma_f32_16x16x32_bf16 v[216:219], v[168:171], a[88:91], v[216:219]
    s_waitcnt lgkmcnt(3)
    v_exp_f32 v147, v147
    v_mfma_f32_16x16x32_bf16 v[152:155], v[6:9], v[132:135], v[152:155]
    s_waitcnt lgkmcnt(2)
    v_cvt_pk_bf16_f32 v159, v146, v147
    v_mfma_f32_16x16x32_bf16 v[172:175], v[160:163], a[248:251], v[172:175]
    ds_read_b128 v[144:147], v228 offset:2560
    v_mfma_f32_16x16x32_bf16 v[196:199], a[216:219], v[156:159], v[196:199]
    ds_read_b128 a[248:251], v239 offset:16384
    v_mfma_f32_16x16x32_bf16 v[184:187], v[66:69], v[156:159], v[184:187]
    ds_read_b128 v[160:163], v241 offset:49664
    v_mfma_f32_16x16x32_bf16 v[188:191], v[88:91], v[156:159], v[188:191]
    v_exp_f32 v148, v148
    v_mfma_f32_16x16x32_bf16 v[192:195], v[110:113], v[156:159], v[192:195]
    v_exp_f32 v149, v149
    v_mfma_f32_16x16x16_bf16 v[152:155], v[10:11], v[136:137], v[152:155]
    v_exp_f32 v150, v150
    v_mfma_f32_16x16x32_bf16 v[212:215], v[164:167], a[80:83], 0
    ds_read_b128 v[164:167], v232 offset:11968
    v_cvt_pk_bf16_f32 v156, v148, v149
    v_mfma_f32_16x16x32_bf16 v[212:215], v[168:171], a[92:95], v[212:215]
    s_waitcnt lgkmcnt(3)
    ds_read_b128 v[168:171], v232 offset:12032
    v_mfma_f32_16x16x32_bf16 v[144:147], v[12:15], v[132:135], v[144:147]
    v_exp_f32 v151, v151
    v_mfma_f32_16x16x32_bf16 v[220:223], v[248:251], a[96:99], v[220:223]
    v_cvt_pk_bf16_f32 v157, v150, v151
    v_mfma_f32_16x16x32_bf16 v[220:223], a[236:239], a[108:111], v[220:223]
    ds_read_b128 v[148:151], v229 offset:2560
    v_mfma_f32_16x16x32_bf16 v[216:219], v[248:251], a[100:103], v[216:219]
    v_exp_f32 v152, v152
    v_mfma_f32_16x16x32_bf16 v[216:219], a[236:239], a[112:115], v[216:219]
    v_exp_f32 v153, v153
    v_mfma_f32_16x16x16_bf16 v[144:147], v[16:17], v[136:137], v[144:147]
    v_exp_f32 v154, v154
    v_mfma_f32_16x16x32_bf16 v[212:215], v[248:251], a[104:107], v[212:215]
    ds_read_b128 v[248:251], v232 offset:12096
    v_cvt_pk_bf16_f32 v158, v152, v153
    v_mfma_f32_16x16x32_bf16 v[212:215], a[236:239], a[116:119], v[212:215]
    ds_read_b128 a[236:239], v232 offset:12160
    v_mfma_f32_16x16x32_bf16 v[220:223], a[240:243], a[120:123], v[220:223]
    v_exp_f32 v155, v155
    v_mfma_f32_16x16x32_bf16 v[220:223], a[244:247], a[132:135], v[220:223]
    s_waitcnt lgkmcnt(2)
    v_cvt_pk_bf16_f32 v159, v154, v155
    v_mfma_f32_16x16x32_bf16 v[148:151], v[36:39], v[132:135], v[148:151]
    ds_read_b128 v[152:155], v230 offset:2560
    v_mfma_f32_16x16x32_bf16 v[196:199], a[216:219], v[156:159], v[196:199]
    v_exp_f32 v144, v144
    v_mfma_f32_16x16x32_bf16 v[184:187], v[70:73], v[156:159], v[184:187]
    v_exp_f32 v145, v145
    v_mfma_f32_16x16x32_bf16 v[188:191], v[92:95], v[156:159], v[188:191]
    v_cvt_pk_bf16_f32 v76, v220, v221
    v_cvt_pk_bf16_f32 v77, v222, v223
    v_mfma_f32_16x16x32_bf16 v[192:195], v[114:117], v[156:159], v[192:195]
    v_exp_f32 v146, v146
    v_mfma_f32_16x16x16_bf16 v[148:151], v[40:41], v[136:137], v[148:151]
    v_exp_f32 v147, v147
    v_mfma_f32_16x16x32_bf16 v[216:219], a[240:243], a[124:127], v[216:219]
    v_cvt_pk_bf16_f32 v156, v144, v145
    v_cvt_pk_bf16_f32 v157, v146, v147
    v_mfma_f32_16x16x32_bf16 v[216:219], a[244:247], a[136:139], v[216:219]
    ds_read_b128 v[144:147], v230 offset:640
    v_mfma_f32_16x16x32_bf16 v[212:215], a[240:243], a[128:131], v[212:215]
    ds_read_b128 a[240:243], v232 offset:12224
    v_mfma_f32_16x16x32_bf16 v[212:215], a[244:247], a[140:143], v[212:215]
    ds_read_b128 a[244:247], v232 offset:12288
    v_mfma_f32_16x16x32_bf16 v[208:211], v[252:255], a[248:251], v[208:211]
    v_exp_f32 v148, v148
    v_mfma_f32_16x16x32_bf16 v[200:203], v[252:255], a[252:255], v[200:203]
    v_cvt_pk_bf16_f32 v98, v216, v217
    v_cvt_pk_bf16_f32 v99, v218, v219
    v_mfma_f32_16x16x32_bf16 v[204:207], v[160:163], a[248:251], v[204:207]
    ds_read_b128 v[252:255], v242 offset:49152
    v_cvt_pk_bf16_f32 v120, v212, v213
    v_mfma_f32_16x16x32_bf16 v[180:183], v[160:163], a[252:255], v[180:183]
    ds_read_b128 v[160:163], v242 offset:49664
    v_cvt_pk_bf16_f32 v121, v214, v215
    v_mfma_f32_16x16x32_bf16 v[220:223], a[144:147], v[164:167], 0
    ds_read_b128 a[252:255], v240 offset:17408
    v_mfma_f32_16x16x32_bf16 v[220:223], a[156:159], v[168:171], v[220:223]
    v_exp_f32 v149, v149
    v_mfma_f32_16x16x32_bf16 v[216:219], a[148:151], v[164:167], 0
    v_exp_f32 v150, v150
    v_mfma_f32_16x16x32_bf16 v[216:219], a[160:163], v[168:171], v[216:219]
    v_exp_f32 v151, v151
    v_mfma_f32_16x16x32_bf16 v[212:215], a[152:155], v[164:167], 0
    v_cvt_pk_bf16_f32 v158, v148, v149
    v_cvt_pk_bf16_f32 v159, v150, v151
    v_mfma_f32_16x16x32_bf16 v[212:215], a[164:167], v[168:171], v[212:215]
    ds_read_b128 v[148:151], v230 offset:1280
    v_mfma_f32_16x16x32_bf16 v[196:199], a[216:219], v[156:159], v[196:199]
    v_mfma_f32_16x16x32_bf16 v[184:187], v[74:77], v[156:159], v[184:187]
    v_mfma_f32_16x16x32_bf16 v[188:191], v[96:99], v[156:159], v[188:191]
    v_mfma_f32_16x16x32_bf16 v[192:195], v[118:121], v[156:159], v[192:195]
    s_waitcnt lgkmcnt(1)
    v_mfma_f32_16x16x32_bf16 v[176:179], v[252:255], a[248:251], v[176:179]
    ds_read_b128 v[252:255], v241 offset:61440
    v_mfma_f32_16x16x32_bf16 v[172:175], v[160:163], a[248:251], v[172:175]
    ds_read_b128 a[248:251], v239 offset:17408
    ds_read_b128 v[160:163], v241 offset:61952
    v_mfma_f32_16x16x32_bf16 v[220:223], a[168:171], v[248:251], v[220:223]
    v_rcp_f32 v197, v196
    v_mfma_f32_16x16x32_bf16 v[220:223], a[180:183], a[236:239], v[220:223]
    v_mul_f32 v184, v184, v197
    v_mul_f32 v185, v185, v197
    v_mfma_f32_16x16x32_bf16 v[216:219], a[172:175], v[248:251], v[216:219]
    v_cvt_pk_bf16_f32 v184, v184, v185
    v_mul_f32 v186, v186, v197
    v_mfma_f32_16x16x32_bf16 v[216:219], a[184:187], a[236:239], v[216:219]
    v_mul_f32 v187, v187, v197
    v_cvt_pk_bf16_f32 v185, v186, v187
    v_mfma_f32_16x16x32_bf16 v[212:215], a[176:179], v[248:251], v[212:215]
    v_mul_f32 v188, v188, v197
    v_mul_f32 v189, v189, v197
    v_mfma_f32_16x16x32_bf16 v[212:215], a[188:191], a[236:239], v[212:215]
    s_waitcnt vmcnt(3) lgkmcnt(1)
    v_cvt_pk_bf16_f32 v186, v188, v189
    v_mul_f32 v190, v190, v197
    v_mfma_f32_16x16x32_bf16 v[220:223], a[192:195], a[240:243], v[220:223]
    s_barrier
    ds_read_b128 v[164:167], v227 offset:37120
    ds_read_b128 v[168:171], v227 offset:37184
    v_mfma_f32_16x16x32_bf16 v[220:223], a[204:207], a[244:247], v[220:223]
    ds_read_b128 v[248:251], v227 offset:37248
    v_mul_f32 v191, v191, v197
    v_mfma_f32_16x16x32_bf16 v[216:219], a[196:199], a[240:243], v[216:219]
    ds_read_b128 a[236:239], v227 offset:37312
    v_cvt_pk_bf16_f32 v187, v190, v191
    v_mfma_f32_16x16x32_bf16 v[216:219], a[208:211], a[244:247], v[216:219]
    v_mul_f32 v192, v192, v197
    v_mul_f32 v193, v193, v197
    v_mfma_f32_16x16x32_bf16 v[212:215], a[200:203], a[240:243], v[212:215]
    v_mul_f32 v220, s37, v220
    v_mul_f32 v221, s37, v221
    v_mfma_f32_16x16x32_bf16 v[212:215], a[212:215], a[244:247], v[212:215]
    v_mul_f32 v222, s37, v222
    v_mul_f32 v223, s37, v223
    v_mfma_f32_16x16x32_bf16 v[208:211], v[252:255], a[248:251], v[208:211]
    v_cvt_pk_bf16_f32 v138, v220, v221
    v_cvt_pk_bf16_f32 v139, v222, v223
    v_mfma_f32_16x16x32_bf16 v[200:203], v[252:255], a[252:255], v[200:203]
    s_waitcnt lgkmcnt(4)
    v_mul_f32 v216, s37, v216
    v_mul_f32 v217, s37, v217
    v_mfma_f32_16x16x32_bf16 v[204:207], v[160:163], a[248:251], v[204:207]
    v_mul_f32 v218, s37, v218
    v_mul_f32 v219, s37, v219
    v_mfma_f32_16x16x32_bf16 v[180:183], v[160:163], a[252:255], v[180:183]
    s_waitcnt lgkmcnt(2)
    v_cvt_pk_bf16_f32 v140, v216, v217
    v_cvt_pk_bf16_f32 v141, v218, v219
    v_mfma_f32_16x16x32_bf16 v[220:223], a[0:3], v[164:167], 0
    v_mul_f32 v212, s37, v212
    v_mul_f32 v213, s37, v213
    v_mfma_f32_16x16x32_bf16 v[220:223], a[12:15], v[168:171], v[220:223]
    v_mul_f32 v214, s37, v214
    v_mul_f32 v215, s37, v215
    v_mfma_f32_16x16x32_bf16 v[152:155], v[36:39], v[138:141], v[152:155]
    v_cvt_pk_bf16_f32 v142, v212, v213
    v_cvt_pk_bf16_f32 v143, v214, v215
    v_mfma_f32_16x16x32_bf16 v[144:147], v[42:45], v[138:141], v[144:147]
    ds_read_b128 v[252:255], v242 offset:61440
    ds_read_b128 v[160:163], v242 offset:61952
    v_mfma_f32_16x16x32_bf16 v[148:151], v[24:27], v[138:141], v[148:151]
    ds_read_b128 a[252:255], v240
    v_cvt_pk_bf16_f32 v188, v192, v193
    v_mfma_f32_16x16x16_bf16 v[152:155], v[40:41], v[142:143], v[152:155]
    ds_read_b128 a[240:243], v227 offset:37376
    v_mul_f32 v194, v194, v197
    v_mfma_f32_16x16x16_bf16 v[144:147], v[46:47], v[142:143], v[144:147]
    ds_read_b128 a[244:247], v227 offset:37440
    v_mul_f32 v195, v195, v197
    v_mfma_f32_16x16x16_bf16 v[148:151], v[28:29], v[142:143], v[148:151]
    v_cvt_pk_bf16_f32 v189, v194, v195
    v_max3_f32 v236, v236, v196, v197
    v_mfma_f32_16x16x32_bf16 v[216:219], a[4:7], v[164:167], 0
    ds_write_b128 v237, v[184:187] offset:12288
    v_mfma_f32_16x16x32_bf16 v[216:219], a[16:19], v[168:171], v[216:219]
    s_waitcnt lgkmcnt(5)
    ds_write_b64 v238, v[188:189] offset:12288
    v_mfma_f32_16x16x32_bf16 v[176:179], v[252:255], a[248:251], v[176:179]
    s_waitcnt lgkmcnt(5)
    buffer_load_dwordx4 v246, s[4:7], s56 offen lds
    v_mfma_f32_16x16x32_bf16 v[172:175], v[160:163], a[248:251], v[172:175]
    v_cvt_pk_bf16_f32 v208, v208, v209
    v_cvt_pk_bf16_f32 v209, v210, v211
    v_mfma_f32_16x16x32_bf16 v[212:215], a[8:11], v[164:167], 0
    v_cvt_pk_bf16_f32 v210, v204, v205
    v_cvt_pk_bf16_f32 v211, v206, v207
    v_mfma_f32_16x16x32_bf16 v[212:215], a[20:23], v[168:171], v[212:215]
    ds_read_b128 a[248:251], v239
    ds_read_b128 v[252:255], v241 offset:12288
    v_mfma_f32_16x16x32_bf16 v[220:223], a[24:27], v[248:251], v[220:223]
    ds_read_b128 v[160:163], v241 offset:12800
    v_cvt_pk_bf16_f32 v200, v200, v201
    v_mfma_f32_16x16x32_bf16 v[220:223], a[36:39], a[236:239], v[220:223]
    v_cvt_pk_bf16_f32 v201, v202, v203
    v_cvt_pk_bf16_f32 v202, v180, v181
    v_mfma_f32_16x16x32_bf16 v[216:219], a[28:31], v[248:251], v[216:219]
    buffer_load_dwordx4 v247, s[4:7], s56 offen offset:1024 lds
    v_mfma_f32_16x16x32_bf16 v[216:219], a[40:43], a[236:239], v[216:219]
    s_add_u32 s56, s56, s42
    v_cvt_pk_bf16_f32 v203, v182, v183
    v_cvt_pk_bf16_f32 v176, v176, v177
    v_mfma_f32_16x16x32_bf16 v[212:215], a[32:35], v[248:251], v[212:215]
    s_add_u32 m0, s41, 0x1e40
    v_cvt_pk_bf16_f32 v177, v178, v179
    v_cvt_pk_bf16_f32 v178, v172, v173
    v_mfma_f32_16x16x32_bf16 v[212:215], a[44:47], a[236:239], v[212:215]
    s_waitcnt lgkmcnt(4)
    v_cvt_pk_bf16_f32 v179, v174, v175
    v_mfma_f32_16x16x32_bf16 v[220:223], a[48:51], a[240:243], v[220:223]
    v_exp_f32 v152, v152
    v_mfma_f32_16x16x32_bf16 v[220:223], a[60:63], a[244:247], v[220:223]
    v_exp_f32 v153, v153
    v_mfma_f32_16x16x32_bf16 v[216:219], a[52:55], a[240:243], v[216:219]
    buffer_load_dwordx4 v246, s[4:7], s56 offen lds
    v_mfma_f32_16x16x32_bf16 v[216:219], a[64:67], a[244:247], v[216:219]
L_pg5:
    s_cbranch_execz L_back
    v_exp_f32 v154, v154
    v_mfma_f32_16x16x32_bf16 v[212:215], a[56:59], a[240:243], v[212:215]
    v_exp_f32 v155, v155
    v_mfma_f32_16x16x32_bf16 v[212:215], a[68:71], a[244:247], v[212:215]
    s_waitcnt lgkmcnt(0)
    v_cvt_pk_bf16_f32 v48, v220, v221
    v_cvt_pk_bf16_f32 v49, v222, v223
    v_mfma_f32_16x16x32_bf16 v[204:207], a[224:227], a[248:251], 0
    v_cndmask_b32 v54, v54, v48, s[82:83]
    v_cndmask_b32 v55, v55, v49, s[82:83]
    v_mfma_f32_16x16x32_bf16 v[180:183], a[224:227], a[252:255], 0
    v_cvt_pk_bf16_f32 v50, v216, v217
    v_cvt_pk_bf16_f32 v51, v218, v219
    v_mfma_f32_16x16x32_bf16 v[172:175], a[232:235], a[248:251], 0
    v_cndmask_b32 v56, v56, v50, s[82:83]
    v_cndmask_b32 v57, v57, v51, s[82:83]
    v_mfma_f32_16x16x32_bf16 v[220:223], v[164:167], a[72:75], 0
    v_cvt_pk_bf16_f32 v52, v212, v213
    v_cvt_pk_bf16_f32 v53, v214, v215
    v_mfma_f32_16x16x32_bf16 v[220:223], v[168:171], a[84:87], v[220:223]
    v_cndmask_b32 v58, v58, v52, s[82:83]
    v_cndmask_b32 v59, v59, v53, s[82:83]
    v_mfma_f32_16x16x32_bf16 v[216:219], v[164:167], a[76:79], 0
    buffer_load_dwordx4 v247, s[4:7], s56 offen offset:1024 lds
    v_mfma_f32_16x16x32_bf16 v[216:219], v[168:171], a[88:91], v[216:219]
    s_add_u32 s56, s56, s42
    v_cvt_pk_bf16_f32 v156, v152, v153
    v_cvt_pk_bf16_f32 v157, v154, v155
    v_mfma_f32_16x16x32_bf16 v[212:215], v[164:167], a[80:83], 0
    s_add_u32 m0, s41, 0x3c80
    ds_read_b128 v[152:155], v230 offset:1920
    v_mfma_f32_16x16x32_bf16 v[212:215], v[168:171], a[92:95], v[212:215]
    ds_read_b128 v[164:167], v225 offset:24384
    v_mfma_f32_16x16x32_bf16 v[220:223], v[248:251], a[96:99], v[220:223]
    ds_read_b128 v[168:171], v225 offset:24448
    v_mfma_f32_16x16x32_bf16 v[220:223], a[236:239], a[108:111], v[220:223]
    v_exp_f32 v144, v144
    v_mfma_f32_16x16x32_bf16 v[216:219], v[248:251], a[100:103], v[216:219]
    buffer_store_dwordx4 v[208:211], v243, s[20:23], s51 offen sc0 sc1
    v_mfma_f32_16x16x32_bf16 v[216:219], a[236:239], a[112:115], v[216:219]
    v_exp_f32 v145, v145
    v_mfma_f32_16x16x32_bf16 v[208:211], a[220:223], a[248:251], 0
    s_waitcnt lgkmcnt(2)
    v_exp_f32 v146, v146
    v_mfma_f32_16x16x32_bf16 v[152:155], v[30:33], v[138:141], v[152:155]
    v_exp_f32 v147, v147
    v_mfma_f32_16x16x32_bf16 v[212:215], v[248:251], a[104:107], v[212:215]
    ds_read_b128 v[248:251], v225 offset:24512
    v_cvt_pk_bf16_f32 v158, v144, v145
    v_mfma_f32_16x16x32_bf16 v[212:215], a[236:239], a[116:119], v[212:215]
    ds_read_b128 a[236:239], v225 offset:24576
    v_cvt_pk_bf16_f32 v159, v146, v147
    v_mfma_f32_16x16x16_bf16 v[152:155], v[34:35], v[142:143], v[152:155]
    ds_read_b128 v[144:147], v235
    v_bfe_u32 v235, s69, v233, 4
    v_mfma_f32_16x16x32_bf16 v[196:199], a[216:219], v[156:159], 0
    v_mad_u32_u24 v235, v235, s40, v231
    v_mfma_f32_16x16x32_bf16 v[184:187], v[76:79], v[156:159], 0
    v_exp_f32 v148, v148
    v_mfma_f32_16x16x32_bf16 v[188:191], v[98:101], v[156:159], 0
    v_exp_f32 v149, v149
    v_mfma_f32_16x16x32_bf16 v[192:195], v[120:123], v[156:159], 0
    v_exp_f32 v150, v150
    v_mfma_f32_16x16x32_bf16 v[220:223], a[240:243], a[120:123], v[220:223]
    v_exp_f32 v151, v151
    v_mfma_f32_16x16x32_bf16 v[220:223], a[244:247], a[132:135], v[220:223]
    s_waitcnt lgkmcnt(0)
    buffer_store_dwordx4 v[200:203], v245, s[20:23], s51 offen sc0 sc1
    v_mfma_f32_16x16x32_bf16 v[144:147], v[54:57], v[138:141], v[144:147]
    v_cvt_pk_bf16_f32 v156, v148, v149
    v_cvt_pk_bf16_f32 v157, v150, v151
    v_mfma_f32_16x16x32_bf16 v[200:203], a[220:223], a[252:255], 0
    ds_read_b128 v[148:151], v234
    v_bfe_u32 v234, s68, v233, 4
    v_mfma_f32_16x16x32_bf16 v[216:219], a[240:243], a[124:127], v[216:219]
    v_mad_u32_u24 v234, v234, s40, v231
    v_cvt_pk_bf16_f32 v82, v220, v221
    v_mfma_f32_16x16x32_bf16 v[216:219], a[244:247], a[136:139], v[216:219]
    v_cvt_pk_bf16_f32 v83, v222, v223
    v_cndmask_b32 v84, v84, v82, s[84:85]
    v_mfma_f32_16x16x16_bf16 v[144:147], v[58:59], v[142:143], v[144:147]
    ds_read_b128 a[252:255], v240 offset:1024
    v_cndmask_b32 v85, v85, v83, s[84:85]
    v_mfma_f32_16x16x32_bf16 v[212:215], a[240:243], a[128:131], v[212:215]
    ds_read_b128 a[240:243], v225 offset:24640
    v_mfma_f32_16x16x32_bf16 v[212:215], a[244:247], a[140:143], v[212:215]
    v_cvt_pk_bf16_f32 v104, v216, v217
    v_cvt_pk_bf16_f32 v105, v218, v219
    v_mfma_f32_16x16x32_bf16 v[220:223], a[144:147], v[164:167], 0
    v_cndmask_b32 v106, v106, v104, s[84:85]
    v_cndmask_b32 v107, v107, v105, s[84:85]
    v_mfma_f32_16x16x32_bf16 v[220:223], a[156:159], v[168:171], v[220:223]
    s_waitcnt lgkmcnt(2)
    ds_read_b128 a[244:247], v225 offset:24704
    v_mfma_f32_16x16x32_bf16 v[148:151], v[60:63], v[138:141], v[148:151]
    v_cvt_pk_bf16_f32 v126, v212, v213
    v_cvt_pk_bf16_f32 v127, v214, v215
    v_mfma_f32_16x16x32_bf16 v[216:219], a[148:151], v[164:167], 0
    v_cndmask_b32 v128, v128, v126, s[84:85]
    v_cndmask_b32 v129, v129, v127, s[84:85]
    v_mfma_f32_16x16x32_bf16 v[216:219], a[160:163], v[168:171], v[216:219]
    buffer_store_dwordx4 v[176:179], v244, s[20:23], s51 offen sc0 sc1
    v_mfma_f32_16x16x16_bf16 v[148:151], v[64:65], v[142:143], v[148:151]
    s_add_u32 s51, s51, s48
    v_exp_f32 v152, v152
    v_mfma_f32_16x16x32_bf16 v[176:179], a[228:231], a[248:251], 0
    ds_read_b128 a[248:251], v239 offset:1024
    v_mfma_f32_16x16x32_bf16 v[212:215], a[152:155], v[164:167], 0
    ds_read_b128 v[164:167], v224 offset:46464
    v_mfma_f32_16x16x32_bf16 v[212:215], a[164:167], v[168:171], v[212:215]
    ds_read_b128 v[168:171], v224 offset:46528
    v_mfma_f32_16x16x32_bf16 v[220:223], a[168:171], v[248:251], v[220:223]
    v_exp_f32 v153, v153
    v_mfma_f32_16x16x32_bf16 v[220:223], a[180:183], a[236:239], v[220:223]
    v_exp_f32 v154, v154
    v_mfma_f32_16x16x32_bf16 v[216:219], a[172:175], v[248:251], v[216:219]
    v_exp_f32 v155, v155
    v_mfma_f32_16x16x32_bf16 v[216:219], a[184:187], a[236:239], v[216:219]
    v_cvt_pk_bf16_f32 v158, v152, v153
    v_cvt_pk_bf16_f32 v159, v154, v155
    v_mfma_f32_16x16x32_bf16 v[212:215], a[176:179], v[248:251], v[212:215]
    ds_read_b128 v[152:155], v228 offset:640
    v_mfma_f32_16x16x32_bf16 v[212:215], a[188:191], a[236:239], v[212:215]
    ds_read_b128 v[248:251], v224 offset:46592
    v_mfma_f32_16x16x32_bf16 v[196:199], a[216:219], v[156:159], v[196:199]
    ds_read_b128 a[236:239], v224 offset:46656
    v_mfma_f32_16x16x32_bf16 v[184:187], v[68:71], v[156:159], v[184:187]
    v_exp_f32 v144, v144
    v_mfma_f32_16x16x32_bf16 v[188:191], v[90:93], v[156:159], v[188:191]
    v_exp_f32 v145, v145
    v_mfma_f32_16x16x32_bf16 v[192:195], v[112:115], v[156:159], v[192:195]
    s_waitcnt lgkmcnt(3)
    v_exp_f32 v146, v146
    v_mfma_f32_16x16x32_bf16 v[220:223], a[192:195], a[240:243], v[220:223]
    v_exp_f32 v147, v147
    v_mfma_f32_16x16x32_bf16 v[220:223], a[204:207], a[244:247], v[220:223]
    v_cvt_pk_bf16_f32 v156, v144, v145
    v_cvt_pk_bf16_f32 v157, v146, v147
    v_mfma_f32_16x16x32_bf16 v[216:219], a[196:199], a[240:243], v[216:219]
    ds_read_b128 v[144:147], v229 offset:640
    v_mfma_f32_16x16x32_bf16 v[216:219], a[208:211], a[244:247], v[216:219]
    v_exp_f32 v148, v148
    v_mfma_f32_16x16x32_bf16 v[212:215], a[200:203], a[240:243], v[212:215]
    ds_read_b128 a[240:243], v224 offset:46720
    v_mul_f32 v220, s37, v220
    v_mfma_f32_16x16x32_bf16 v[212:215], a[212:215], a[244:247], v[212:215]
    v_mul_f32 v221, s37, v221
    v_mul_f32 v222, s37, v222
    v_mfma_f32_16x16x32_bf16 v[208:211], v[252:255], a[248:251], v[208:211]
    v_mul_f32 v223, s37, v223
    v_cvt_pk_bf16_f32 v132, v220, v221
    v_mfma_f32_16x16x32_bf16 v[200:203], v[252:255], a[252:255], v[200:203]
    v_cvt_pk_bf16_f32 v133, v222, v223
    v_mul_f32 v216, s37, v216
    v_mfma_f32_16x16x32_bf16 v[204:207], v[160:163], a[248:251], v[204:207]
    v_mul_f32 v217, s37, v217
    v_mul_f32 v218, s37, v218
    v_mfma_f32_16x16x32_bf16 v[180:183], v[160:163], a[252:255], v[180:183]
    v_mul_f32 v219, s37, v219
    v_cvt_pk_bf16_f32 v134, v216, v217
    v_mfma_f32_16x16x32_bf16 v[220:223], a[0:3], v[164:167], 0
    v_cvt_pk_bf16_f32 v135, v218, v219
    v_mul_f32 v212, s37, v212
    v_mfma_f32_16x16x32_bf16 v[220:223], a[12:15], v[168:171], v[220:223]
    s_waitcnt lgkmcnt(1)
    v_mul_f32 v213, s37, v213
    v_mul_f32 v214, s37, v214
    v_mfma_f32_16x16x32_bf16 v[152:155], v[0:3], v[132:135], v[152:155]
    v_mul_f32 v215, s37, v215
    v_cvt_pk_bf16_f32 v136, v212, v213
    v_mfma_f32_16x16x32_bf16 v[144:147], v[24:27], v[132:135], v[144:147]
    ds_read_b128 v[252:255], v242 offset:12288
    v_cvt_pk_bf16_f32 v137, v214, v215
    v_mfma_f32_16x16x32_bf16 v[216:219], a[4:7], v[164:167], 0
    ds_read_b128 v[160:163], v242 offset:12800
    ds_read_b128 a[252:255], v240 offset:2048
    v_mfma_f32_16x16x32_bf16 v[216:219], a[16:19], v[168:171], v[216:219]
    ds_read_b128 a[244:247], v224 offset:46784
    v_mfma_f32_16x16x16_bf16 v[152:155], v[4:5], v[136:137], v[152:155]
    v_exp_f32 v149, v149
    v_mfma_f32_16x16x16_bf16 v[144:147], v[28:29], v[136:137], v[144:147]
    v_exp_f32 v150, v150
    v_mfma_f32_16x16x32_bf16 v[212:215], a[8:11], v[164:167], 0
    v_exp_f32 v151, v151
    v_mfma_f32_16x16x32_bf16 v[212:215], a[20:23], v[168:171], v[212:215]
    s_waitcnt lgkmcnt(3)
    v_cvt_pk_bf16_f32 v158, v148, v149
    v_cvt_pk_bf16_f32 v159, v150, v151
    v_mfma_f32_16x16x32_bf16 v[176:179], v[252:255], a[248:251], v[176:179]
    ds_read_b128 v[148:151], v229 offset:1280
    v_mfma_f32_16x16x32_bf16 v[196:199], a[216:219], v[156:159], v[196:199]
    ds_read_b128 v[252:255], v241 offset:24576
    v_mfma_f32_16x16x32_bf16 v[184:187], v[84:87], v[156:159], v[184:187]
    v_mov_b32 v84, v82
    v_mov_b32 v85, v83
    v_mfma_f32_16x16x32_bf16 v[188:191], v[106:109], v[156:159], v[188:191]
    v_mov_b32 v106, v104
    v_mov_b32 v107, v105
    v_mfma_f32_16x16x32_bf16 v[192:195], v[128:131], v[156:159], v[192:195]
    s_waitcnt lgkmcnt(2)
    v_mov_b32 v128, v126
    v_mov_b32 v129, v127
    v_mfma_f32_16x16x32_bf16 v[172:175], v[160:163], a[248:251], v[172:175]
    ds_read_b128 a[248:251], v239 offset:2048
    ds_read_b128 v[160:163], v241 offset:25088
    v_mfma_f32_16x16x32_bf16 v[220:223], a[24:27], v[248:251], v[220:223]
    v_rcp_f32 v197, v196
    v_mfma_f32_16x16x32_bf16 v[220:223], a[36:39], a[236:239], v[220:223]
    s_waitcnt lgkmcnt(3)
    v_mul_f32 v184, v184, v197
    v_mul_f32 v185, v185, v197
    v_mfma_f32_16x16x32_bf16 v[148:151], v[30:33], v[132:135], v[148:151]
    v_cvt_pk_bf16_f32 v184, v184, v185
    v_mul_f32 v186, v186, v197
    v_mfma_f32_16x16x32_bf16 v[216:219], a[28:31], v[248:251], v[216:219]
    v_mul_f32 v187, v187, v197
    v_cvt_pk_bf16_f32 v185, v186, v187
    v_mfma_f32_16x16x32_bf16 v[216:219], a[40:43], a[236:239], v[216:219]
    v_mul_f32 v188, v188, v197
    v_mul_f32 v189, v189, v197
    v_mfma_f32_16x16x16_bf16 v[148:151], v[34:35], v[136:137], v[148:151]
    v_cvt_pk_bf16_f32 v186, v188, v189
    v_mul_f32 v190, v190, v197
    v_mfma_f32_16x16x32_bf16 v[212:215], a[32:35], v[248:251], v[212:215]
    v_mul_f32 v191, v191, v197
    v_cvt_pk_bf16_f32 v187, v190, v191
    v_mfma_f32_16x16x32_bf16 v[212:215], a[44:47], a[236:239], v[212:215]
    v_mul_f32 v192, v192, v197
    v_mul_f32 v193, v193, v197
    v_mfma_f32_16x16x32_bf16 v[220:223], a[48:51], a[240:243], v[220:223]
    v_cvt_pk_bf16_f32 v188, v192, v193
    v_mul_f32 v194, v194, v197
    v_mfma_f32_16x16x32_bf16 v[220:223], a[60:63], a[244:247], v[220:223]
    v_mul_f32 v195, v195, v197
    v_cvt_pk_bf16_f32 v189, v194, v195
    v_mfma_f32_16x16x32_bf16 v[216:219], a[52:55], a[240:243], v[216:219]
    v_max3_f32 v236, v236, v196, v197
    v_mfma_f32_16x16x32_bf16 v[216:219], a[64:67], a[244:247], v[216:219]
    ds_write_b128 v237, v[184:187] offset:18432
    v_mfma_f32_16x16x32_bf16 v[212:215], a[56:59], a[240:243], v[212:215]
    ds_write_b64 v238, v[188:189] offset:18432
    v_mfma_f32_16x16x32_bf16 v[212:215], a[68:71], a[244:247], v[212:215]
    s_waitcnt lgkmcnt(2)
    v_cvt_pk_bf16_f32 v18, v220, v221
    v_cvt_pk_bf16_f32 v19, v222, v223
    v_mfma_f32_16x16x32_bf16 v[208:211], v[252:255], a[248:251], v[208:211]
    v_exp_f32 v152, v152
    v_mfma_f32_16x16x32_bf16 v[200:203], v[252:255], a[252:255], v[200:203]
    v_cvt_pk_bf16_f32 v20, v216, v217
    v_cvt_pk_bf16_f32 v21, v218, v219
    v_mfma_f32_16x16x32_bf16 v[204:207], v[160:163], a[248:251], v[204:207]
    v_cvt_pk_bf16_f32 v22, v212, v213
    v_cvt_pk_bf16_f32 v23, v214, v215
    v_mfma_f32_16x16x32_bf16 v[180:183], v[160:163], a[252:255], v[180:183]
    ds_read_b128 v[252:255], v242 offset:24576
    ds_read_b128 v[160:163], v242 offset:25088
    v_mfma_f32_16x16x32_bf16 v[220:223], v[164:167], a[72:75], 0
    ds_read_b128 a[252:255], v240 offset:3072
    v_mfma_f32_16x16x32_bf16 v[220:223], v[168:171], a[84:87], v[220:223]
    v_exp_f32 v153, v153
    v_mfma_f32_16x16x32_bf16 v[216:219], v[164:167], a[76:79], 0
    v_exp_f32 v154, v154
    v_mfma_f32_16x16x32_bf16 v[216:219], v[168:171], a[88:91], v[216:219]
    v_exp_f32 v155, v155
    v_mfma_f32_16x16x32_bf16 v[212:215], v[164:167], a[80:83], 0
    ds_read_b128 v[164:167], v224 offset:49536
    v_cvt_pk_bf16_f32 v156, v152, v153
    v_mfma_f32_16x16x32_bf16 v[212:215], v[168:171], a[92:95], v[212:215]
    s_waitcnt lgkmcnt(3)
    ds_read_b128 v[168:171], v224 offset:49600
    v_cvt_pk_bf16_f32 v157, v154, v155
    v_mfma_f32_16x16x32_bf16 v[176:179], v[252:255], a[248:251], v[176:179]
    s_waitcnt lgkmcnt(3)
    ds_read_b128 v[152:155], v228 offset:1280
    v_mfma_f32_16x16x32_bf16 v[172:175], v[160:163], a[248:251], v[172:175]
    ds_read_b128 a[248:251], v239 offset:3072
    v_mfma_f32_16x16x32_bf16 v[220:223], v[248:251], a[96:99], v[220:223]
    ds_read_b128 v[252:255], v241 offset:36864
    v_mfma_f32_16x16x32_bf16 v[220:223], a[236:239], a[108:111], v[220:223]
    ds_read_b128 v[160:163], v241 offset:37376
    v_mfma_f32_16x16x32_bf16 v[216:219], v[248:251], a[100:103], v[216:219]
    v_exp_f32 v144, v144
    v_mfma_f32_16x16x32_bf16 v[216:219], a[236:239], a[112:115], v[216:219]
    v_exp_f32 v145, v145
    v_mfma_f32_16x16x32_bf16 v[212:215], v[248:251], a[104:107], v[212:215]
    ds_read_b128 v[248:251], v224 offset:49664
    v_cvt_pk_bf16_f32 v158, v144, v145
    v_mfma_f32_16x16x32_bf16 v[212:215], a[236:239], a[116:119], v[212:215]
    s_waitcnt lgkmcnt(4)
    ds_read_b128 a[236:239], v224 offset:49728
    v_mfma_f32_16x16x32_bf16 v[152:155], v[6:9], v[132:135], v[152:155]
    v_exp_f32 v146, v146
    v_mfma_f32_16x16x32_bf16 v[220:223], a[240:243], a[120:123], v[220:223]
    v_exp_f32 v147, v147
    v_mfma_f32_16x16x32_bf16 v[220:223], a[244:247], a[132:135], v[220:223]
    v_cvt_pk_bf16_f32 v159, v146, v147
    v_mfma_f32_16x16x32_bf16 v[216:219], a[240:243], a[124:127], v[216:219]
    ds_read_b128 v[144:147], v228 offset:1920
    v_mfma_f32_16x16x32_bf16 v[216:219], a[244:247], a[136:139], v[216:219]
    v_exp_f32 v148, v148
    v_mfma_f32_16x16x32_bf16 v[196:199], a[216:219], v[156:159], 0
    v_exp_f32 v149, v149
    v_mfma_f32_16x16x32_bf16 v[184:187], v[66:69], v[156:159], 0
    v_cvt_pk_bf16_f32 v80, v220, v221
    v_cvt_pk_bf16_f32 v81, v222, v223
    v_mfma_f32_16x16x32_bf16 v[188:191], v[88:91], v[156:159], 0
    v_exp_f32 v150, v150
    v_mfma_f32_16x16x32_bf16 v[192:195], v[110:113], v[156:159], 0
    v_cvt_pk_bf16_f32 v102, v216, v217
    v_cvt_pk_bf16_f32 v103, v218, v219
    v_mfma_f32_16x16x16_bf16 v[152:155], v[10:11], v[136:137], v[152:155]
    v_exp_f32 v151, v151
    v_mfma_f32_16x16x32_bf16 v[212:215], a[240:243], a[128:131], v[212:215]
    ds_read_b128 a[240:243], v224 offset:49792
    v_cvt_pk_bf16_f32 v156, v148, v149
    v_mfma_f32_16x16x32_bf16 v[212:215], a[244:247], a[140:143], v[212:215]
    s_waitcnt lgkmcnt(1)
    ds_read_b128 a[244:247], v224 offset:49856
    v_cvt_pk_bf16_f32 v157, v150, v151
    v_mfma_f32_16x16x32_bf16 v[144:147], v[12:15], v[132:135], v[144:147]
    ds_read_b128 v[148:151], v229 offset:1920
    v_mfma_f32_16x16x32_bf16 v[208:211], v[252:255], a[248:251], v[208:211]
    v_exp_f32 v152, v152
    v_mfma_f32_16x16x32_bf16 v[200:203], v[252:255], a[252:255], v[200:203]
    ds_read_b128 v[252:255], v242 offset:36864
    v_cvt_pk_bf16_f32 v124, v212, v213
    v_mfma_f32_16x16x16_bf16 v[144:147], v[16:17], v[136:137], v[144:147]
    v_cvt_pk_bf16_f32 v125, v214, v215
    v_mfma_f32_16x16x32_bf16 v[204:207], v[160:163], a[248:251], v[204:207]
    v_exp_f32 v153, v153
    v_mfma_f32_16x16x32_bf16 v[180:183], v[160:163], a[252:255], v[180:183]
    ds_read_b128 v[160:163], v242 offset:37376
    ds_read_b128 a[252:255], v240 offset:4096
    v_mfma_f32_16x16x32_bf16 v[220:223], a[0:3], v[164:167], 0
    v_exp_f32 v154, v154
    v_mfma_f32_16x16x32_bf16 v[220:223], a[12:15], v[168:171], v[220:223]
    s_waitcnt lgkmcnt(3)
    v_exp_f32 v155, v155
    v_mfma_f32_16x16x32_bf16 v[148:151], v[36:39], v[132:135], v[148:151]
    s_waitcnt lgkmcnt(2)
    v_cvt_pk_bf16_f32 v158, v152, v153
    v_cvt_pk_bf16_f32 v159, v154, v155
    v_mfma_f32_16x16x32_bf16 v[176:179], v[252:255], a[248:251], v[176:179]
    ds_read_b128 v[152:155], v229 offset:2560
    v_mfma_f32_16x16x32_bf16 v[196:199], a[216:219], v[156:159], v[196:199]
    ds_read_b128 v[252:255], v241 offset:49152
    v_mfma_f32_16x16x32_bf16 v[184:187], v[70:73], v[156:159], v[184:187]
    v_exp_f32 v144, v144
    v_mfma_f32_16x16x32_bf16 v[188:191], v[92:95], v[156:159], v[188:191]
    v_exp_f32 v145, v145
    v_mfma_f32_16x16x32_bf16 v[192:195], v[114:117], v[156:159], v[192:195]
    v_exp_f32 v146, v146
    v_mfma_f32_16x16x16_bf16 v[148:151], v[40:41], v[136:137], v[148:151]
    s_waitcnt lgkmcnt(2)
    v_exp_f32 v147, v147
    v_mfma_f32_16x16x32_bf16 v[172:175], v[160:163], a[248:251], v[172:175]
    ds_read_b128 a[248:251], v239 offset:4096
    ds_read_b128 v[160:163], v241 offset:49664
    v_mfma_f32_16x16x32_bf16 v[216:219], a[4:7], v[164:167], 0
    v_cvt_pk_bf16_f32 v156, v144, v145
    v_cvt_pk_bf16_f32 v157, v146, v147
    v_mfma_f32_16x16x32_bf16 v[216:219], a[16:19], v[168:171], v[216:219]
    ds_read_b128 v[144:147], v228 offset:2560
    v_mfma_f32_16x16x32_bf16 v[212:215], a[8:11], v[164:167], 0
    v_exp_f32 v148, v148
    v_mfma_f32_16x16x32_bf16 v[212:215], a[20:23], v[168:171], v[212:215]
    v_exp_f32 v149, v149
    v_mfma_f32_16x16x32_bf16 v[220:223], a[24:27], v[248:251], v[220:223]
    v_exp_f32 v150, v150
    v_mfma_f32_16x16x32_bf16 v[220:223], a[36:39], a[236:239], v[220:223]
    v_exp_f32 v151, v151
    v_mfma_f32_16x16x32_bf16 v[216:219], a[28:31], v[248:251], v[216:219]
    v_cvt_pk_bf16_f32 v158, v148, v149
    v_cvt_pk_bf16_f32 v159, v150, v151
    v_mfma_f32_16x16x32_bf16 v[216:219], a[40:43], a[236:239], v[216:219]
    ds_read_b128 v[148:151], v230 offset:640
    v_mfma_f32_16x16x32_bf16 v[196:199], a[216:219], v[156:159], v[196:199]
    v_mfma_f32_16x16x32_bf16 v[184:187], v[74:77], v[156:159], v[184:187]
    v_mfma_f32_16x16x32_bf16 v[188:191], v[96:99], v[156:159], v[188:191]
    v_mfma_f32_16x16x32_bf16 v[192:195], v[118:121], v[156:159], v[192:195]
    s_waitcnt lgkmcnt(1)
    v_mfma_f32_16x16x32_bf16 v[144:147], v[18:21], v[132:135], v[144:147]
    v_mfma_f32_16x16x32_bf16 v[212:215], a[32:35], v[248:251], v[212:215]
    v_mfma_f32_16x16x32_bf16 v[212:215], a[44:47], a[236:239], v[212:215]
    v_mfma_f32_16x16x32_bf16 v[220:223], a[48:51], a[240:243], v[220:223]
    v_mfma_f32_16x16x32_bf16 v[220:223], a[60:63], a[244:247], v[220:223]
    v_mfma_f32_16x16x32_bf16 v[216:219], a[52:55], a[240:243], v[216:219]
    v_mfma_f32_16x16x32_bf16 v[216:219], a[64:67], a[244:247], v[216:219]
    v_mfma_f32_16x16x16_bf16 v[144:147], v[22:23], v[136:137], v[144:147]
    v_mfma_f32_16x16x32_bf16 v[212:215], a[56:59], a[240:243], v[212:215]
    v_mfma_f32_16x16x32_bf16 v[212:215], a[68:71], a[244:247], v[212:215]
    v_mfma_f32_16x16x32_bf16 v[208:211], v[252:255], a[248:251], v[208:211]
    v_mfma_f32_16x16x32_bf16 v[200:203], v[252:255], a[252:255], v[200:203]
    ds_read_b128 v[252:255], v242 offset:49152
    v_cvt_pk_bf16_f32 v42, v220, v221
    v_mfma_f32_16x16x32_bf16 v[204:207], v[160:163], a[248:251], v[204:207]
    v_cvt_pk_bf16_f32 v43, v222, v223
    v_cvt_pk_bf16_f32 v44, v216, v217
    v_mfma_f32_16x16x32_bf16 v[180:183], v[160:163], a[252:255], v[180:183]
    v_cvt_pk_bf16_f32 v45, v218, v219
    v_cvt_pk_bf16_f32 v46, v212, v213
    v_mfma_f32_16x16x32_bf16 v[220:223], v[164:167], a[72:75], 0
    ds_read_b128 v[160:163], v242 offset:49664
    v_cvt_pk_bf16_f32 v47, v214, v215
    v_mfma_f32_16x16x32_bf16 v[220:223], v[168:171], a[84:87], v[220:223]
    ds_read_b128 a[252:255], v240 offset:5120
    v_mfma_f32_16x16x32_bf16 v[152:155], v[42:45], v[132:135], v[152:155]
    v_exp_f32 v144, v144
    v_mfma_f32_16x16x32_bf16 v[216:219], v[164:167], a[76:79], 0
    v_exp_f32 v145, v145
    v_mfma_f32_16x16x32_bf16 v[216:219], v[168:171], a[88:91], v[216:219]
    s_waitcnt lgkmcnt(2)
    v_exp_f32 v146, v146
    v_mfma_f32_16x16x32_bf16 v[176:179], v[252:255], a[248:251], v[176:179]
    ds_read_b128 v[252:255], v241 offset:61440
    v_cvt_pk_bf16_f32 v158, v144, v145
    v_mfma_f32_16x16x16_bf16 v[152:155], v[46:47], v[136:137], v[152:155]
    s_waitcnt lgkmcnt(2)
    v_exp_f32 v147, v147
    v_mfma_f32_16x16x32_bf16 v[172:175], v[160:163], a[248:251], v[172:175]
    ds_read_b128 a[248:251], v239 offset:5120
    ds_read_b128 v[160:163], v241 offset:61952
    v_mfma_f32_16x16x32_bf16 v[212:215], v[164:167], a[80:83], 0
    ds_read_b128 v[164:167], v232 offset:27456
    v_cvt_pk_bf16_f32 v159, v146, v147
    v_mfma_f32_16x16x32_bf16 v[212:215], v[168:171], a[92:95], v[212:215]
    ds_read_b128 v[144:147], v230 offset:1920
    v_mfma_f32_16x16x32_bf16 v[220:223], v[248:251], a[96:99], v[220:223]
    v_exp_f32 v152, v152
    v_mfma_f32_16x16x32_bf16 v[220:223], a[236:239], a[108:111], v[220:223]
    ds_read_b128 v[168:171], v232 offset:27520
    v_mfma_f32_16x16x32_bf16 v[216:219], v[248:251], a[100:103], v[216:219]
    v_exp_f32 v153, v153
    v_mfma_f32_16x16x32_bf16 v[216:219], a[236:239], a[112:115], v[216:219]
    v_exp_f32 v154, v154
    v_mfma_f32_16x16x32_bf16 v[212:215], v[248:251], a[104:107], v[212:215]
    ds_read_b128 v[248:251], v232 offset:27584
    v_cvt_pk_bf16_f32 v156, v152, v153
    v_mfma_f32_16x16x32_bf16 v[212:215], a[236:239], a[116:119], v[212:215]
    ds_read_b128 a[236:239], v232 offset:27648
    v_mfma_f32_16x16x32_bf16 v[220:223], a[240:243], a[120:123], v[220:223]
    v_exp_f32 v155, v155
    v_mfma_f32_16x16x32_bf16 v[220:223], a[244:247], a[132:135], v[220:223]
    v_cvt_pk_bf16_f32 v157, v154, v155
    v_mfma_f32_16x16x32_bf16 v[216:219], a[240:243], a[124:127], v[216:219]
    ds_read_b128 v[152:155], v230 offset:1280
    v_mfma_f32_16x16x32_bf16 v[216:219], a[244:247], a[136:139], v[216:219]
    v_mfma_f32_16x16x32_bf16 v[196:199], a[216:219], v[156:159], v[196:199]
    v_mfma_f32_16x16x32_bf16 v[212:215], a[240:243], a[128:131], v[212:215]
    ds_read_b128 a[240:243], v232 offset:27712
    v_mfma_f32_16x16x32_bf16 v[212:215], a[244:247], a[140:143], v[212:215]
    s_waitcnt lgkmcnt(3)
    v_cvt_pk_bf16_f32 v78, v220, v221
    v_cvt_pk_bf16_f32 v79, v222, v223
    v_mfma_f32_16x16x32_bf16 v[208:211], v[252:255], a[248:251], v[208:211]
    ds_read_b128 a[244:247], v232 offset:27776
    v_cvt_pk_bf16_f32 v100, v216, v217
    v_mfma_f32_16x16x32_bf16 v[184:187], v[78:81], v[156:159], v[184:187]
    v_cvt_pk_bf16_f32 v101, v218, v219
    v_mfma_f32_16x16x32_bf16 v[200:203], v[252:255], a[252:255], v[200:203]
    v_cvt_pk_bf16_f32 v122, v212, v213
    v_cvt_pk_bf16_f32 v123, v214, v215
    v_mfma_f32_16x16x32_bf16 v[188:191], v[100:103], v[156:159], v[188:191]
    ds_read_b128 v[252:255], v242 offset:61440
    v_cvt_pk_bf16_f32 v208, v208, v209
    v_mfma_f32_16x16x32_bf16 v[192:195], v[122:125], v[156:159], v[192:195]
    v_rcp_f32 v197, v196
    v_mfma_f32_16x16x32_bf16 v[204:207], v[160:163], a[248:251], v[204:207]
    v_mul_f32 v184, v184, v197
    v_mul_f32 v185, v185, v197
    v_mfma_f32_16x16x32_bf16 v[180:183], v[160:163], a[252:255], v[180:183]
    s_waitcnt vmcnt(3) lgkmcnt(1)
    ds_read_b128 v[160:163], v242 offset:61952
    v_cvt_pk_bf16_f32 v184, v184, v185
    v_mfma_f32_16x16x32_bf16 v[220:223], a[144:147], v[164:167], 0
    s_barrier
    ds_read_b128 a[252:255], v240 offset:12288
    v_mul_f32 v186, v186, v197
    v_mfma_f32_16x16x32_bf16 v[220:223], a[156:159], v[168:171], v[220:223]
    v_mul_f32 v187, v187, v197
    v_cvt_pk_bf16_f32 v185, v186, v187
    v_mfma_f32_16x16x32_bf16 v[216:219], a[148:151], v[164:167], 0
    v_mul_f32 v188, v188, v197
    v_mul_f32 v189, v189, v197
    v_mfma_f32_16x16x32_bf16 v[216:219], a[160:163], v[168:171], v[216:219]
    s_waitcnt lgkmcnt(2)
    v_cvt_pk_bf16_f32 v186, v188, v189
    v_mul_f32 v190, v190, v197
    v_mfma_f32_16x16x32_bf16 v[176:179], v[252:255], a[248:251], v[176:179]
    ds_read_b128 v[252:255], v241 offset:12288
    v_mul_f32 v191, v191, v197
    v_mfma_f32_16x16x32_bf16 v[212:215], a[152:155], v[164:167], 0
    ds_read_b128 v[164:167], v225 offset:39872
    v_cvt_pk_bf16_f32 v187, v190, v191
    v_mfma_f32_16x16x32_bf16 v[212:215], a[164:167], v[168:171], v[212:215]
    s_waitcnt lgkmcnt(3)
    ds_read_b128 v[168:171], v225 offset:39936
    v_mul_f32 v192, v192, v197
    v_mfma_f32_16x16x32_bf16 v[172:175], v[160:163], a[248:251], v[172:175]
    ds_read_b128 a[248:251], v239 offset:12288
    ds_read_b128 v[160:163], v241 offset:12800
    v_mfma_f32_16x16x32_bf16 v[220:223], a[168:171], v[248:251], v[220:223]
    v_mul_f32 v193, v193, v197
    v_cvt_pk_bf16_f32 v188, v192, v193
    v_mfma_f32_16x16x32_bf16 v[220:223], a[180:183], a[236:239], v[220:223]
    v_mul_f32 v194, v194, v197
    v_mul_f32 v195, v195, v197
    v_mfma_f32_16x16x32_bf16 v[216:219], a[172:175], v[248:251], v[216:219]
    v_cvt_pk_bf16_f32 v189, v194, v195
    v_max3_f32 v236, v236, v196, v197
    v_mfma_f32_16x16x32_bf16 v[216:219], a[184:187], a[236:239], v[216:219]
    ds_write_b128 v237, v[184:187]
    v_mfma_f32_16x16x32_bf16 v[212:215], a[176:179], v[248:251], v[212:215]
    ds_write_b64 v238, v[188:189]
    v_mfma_f32_16x16x32_bf16 v[212:215], a[188:191], a[236:239], v[212:215]
    buffer_load_dwordx4 v246, s[4:7], s56 offen lds
    v_mfma_f32_16x16x32_bf16 v[220:223], a[192:195], a[240:243], v[220:223]
    v_cvt_pk_bf16_f32 v209, v210, v211
    v_cvt_pk_bf16_f32 v210, v204, v205
    v_mfma_f32_16x16x32_bf16 v[220:223], a[204:207], a[244:247], v[220:223]
    v_cvt_pk_bf16_f32 v211, v206, v207
    v_cvt_pk_bf16_f32 v200, v200, v201
    v_mfma_f32_16x16x32_bf16 v[216:219], a[196:199], a[240:243], v[216:219]
    ds_read_b128 v[248:251], v225 offset:40000
    ds_read_b128 a[236:239], v225 offset:40064
    v_mfma_f32_16x16x32_bf16 v[216:219], a[208:211], a[244:247], v[216:219]
    v_cvt_pk_bf16_f32 v201, v202, v203
    v_cvt_pk_bf16_f32 v202, v180, v181
    v_mfma_f32_16x16x32_bf16 v[212:215], a[200:203], a[240:243], v[212:215]
    v_mul_f32 v220, s37, v220
    v_mul_f32 v221, s37, v221
    v_mfma_f32_16x16x32_bf16 v[212:215], a[212:215], a[244:247], v[212:215]
    s_waitcnt lgkmcnt(4)
    v_mul_f32 v222, s37, v222
    v_mul_f32 v223, s37, v223
    v_mfma_f32_16x16x32_bf16 v[204:207], a[224:227], a[248:251], 0
    v_cvt_pk_bf16_f32 v138, v220, v221
    v_cvt_pk_bf16_f32 v139, v222, v223
    v_mfma_f32_16x16x32_bf16 v[220:223], a[144:147], v[164:167], 0
    v_mul_f32 v216, s37, v216
    v_mul_f32 v217, s37, v217
    v_mfma_f32_16x16x32_bf16 v[220:223], a[156:159], v[168:171], v[220:223]
    s_waitcnt lgkmcnt(1)
    v_mul_f32 v218, s37, v218
    v_mul_f32 v219, s37, v219
    v_mfma_f32_16x16x32_bf16 v[220:223], a[168:171], v[248:251], v[220:223]
    s_waitcnt lgkmcnt(0)
    v_cvt_pk_bf16_f32 v140, v216, v217
    v_cvt_pk_bf16_f32 v141, v218, v219
    v_mfma_f32_16x16x32_bf16 v[220:223], a[180:183], a[236:239], v[220:223]
    v_mul_f32 v212, s37, v212
    v_mul_f32 v213, s37, v213
    v_mfma_f32_16x16x32_bf16 v[148:151], v[24:27], v[138:141], v[148:151]
    v_mul_f32 v214, s37, v214
    v_mul_f32 v215, s37, v215
    v_mfma_f32_16x16x32_bf16 v[152:155], v[30:33], v[138:141], v[152:155]
    v_cvt_pk_bf16_f32 v142, v212, v213
    v_cvt_pk_bf16_f32 v143, v214, v215
    v_mfma_f32_16x16x32_bf16 v[144:147], v[36:39], v[138:141], v[144:147]
    ds_read_b128 a[240:243], v225 offset:40128
    ds_read_b128 a[244:247], v225 offset:40192
    v_mfma_f32_16x16x16_bf16 v[148:151], v[28:29], v[142:143], v[148:151]
    buffer_load_dwordx4 v247, s[4:7], s56 offen offset:1024 lds
    v_mfma_f32_16x16x16_bf16 v[152:155], v[34:35], v[142:143], v[152:155]
    s_add_u32 s56, s56, s42
    v_cndmask_b32 v225, v243, v245, vcc
    v_cvt_pk_bf16_f32 v203, v182, v183
    v_mfma_f32_16x16x16_bf16 v[144:147], v[40:41], v[142:143], v[144:147]
    s_add_u32 m0, s41, 0x5ac0
    v_cvt_pk_bf16_f32 v176, v176, v177
    v_cvt_pk_bf16_f32 v177, v178, v179
    v_mfma_f32_16x16x32_bf16 v[216:219], a[148:151], v[164:167], 0
    v_cvt_pk_bf16_f32 v178, v172, v173
    v_cvt_pk_bf16_f32 v179, v174, v175
    v_mfma_f32_16x16x32_bf16 v[216:219], a[160:163], v[168:171], v[216:219]
    v_exp_f32 v148, v148
    v_mfma_f32_16x16x32_bf16 v[212:215], a[152:155], v[164:167], 0
    ds_read_b128 v[164:167], v224
    v_mfma_f32_16x16x32_bf16 v[212:215], a[164:167], v[168:171], v[212:215]
    ds_read_b128 v[168:171], v224 offset:64
    v_mfma_f32_16x16x32_bf16 v[216:219], a[172:175], v[248:251], v[216:219]
    buffer_load_dwordx4 v246, s[4:7], s56 offen lds
    v_mfma_f32_16x16x32_bf16 v[216:219], a[184:187], a[236:239], v[216:219]
L_pg6:
    s_cbranch_execz L_back
    v_cndmask_b32 v246, v245, v243, vcc
    v_mfma_f32_16x16x32_bf16 v[212:215], a[176:179], v[248:251], v[212:215]
    ds_read_b128 v[248:251], v224 offset:128
    v_mfma_f32_16x16x32_bf16 v[212:215], a[188:191], a[236:239], v[212:215]
    s_waitcnt lgkmcnt(3)
    ds_read_b128 a[236:239], v224 offset:192
    v_mfma_f32_16x16x32_bf16 v[220:223], a[192:195], a[240:243], v[220:223]
    v_exp_f32 v149, v149
    v_mfma_f32_16x16x32_bf16 v[220:223], a[204:207], a[244:247], v[220:223]
    v_exp_f32 v150, v150
    v_mfma_f32_16x16x32_bf16 v[216:219], a[196:199], a[240:243], v[216:219]
    buffer_load_dwordx4 v247, s[4:7], s56 offen offset:1024 lds
    v_mfma_f32_16x16x32_bf16 v[216:219], a[208:211], a[244:247], v[216:219]
    v_bfrev_b32 v247, 1
    v_cvt_pk_bf16_f32 v156, v148, v149
    v_mfma_f32_16x16x32_bf16 v[212:215], a[200:203], a[240:243], v[212:215]
    ds_read_b128 a[240:243], v224 offset:256
    v_mul_f32 v220, s37, v220
    v_mfma_f32_16x16x32_bf16 v[212:215], a[212:215], a[244:247], v[212:215]
    v_mul_f32 v221, s37, v221
    v_mul_f32 v222, s37, v222
    v_mfma_f32_16x16x32_bf16 v[180:183], a[224:227], a[252:255], 0
    v_mul_f32 v223, s37, v223
    v_cvt_pk_bf16_f32 v132, v220, v221
    v_mfma_f32_16x16x32_bf16 v[172:175], a[232:235], a[248:251], 0
    s_waitcnt lgkmcnt(1)
    v_cvt_pk_bf16_f32 v133, v222, v223
    v_mul_f32 v216, s37, v216
    v_mfma_f32_16x16x32_bf16 v[220:223], a[0:3], v[164:167], 0
    v_mul_f32 v217, s37, v217
    v_mul_f32 v218, s37, v218
    v_mfma_f32_16x16x32_bf16 v[220:223], a[12:15], v[168:171], v[220:223]
    v_mul_f32 v219, s37, v219
    v_cvt_pk_bf16_f32 v134, v216, v217
    v_mfma_f32_16x16x32_bf16 v[220:223], a[24:27], v[248:251], v[220:223]
    v_cvt_pk_bf16_f32 v135, v218, v219
    v_mul_f32 v212, s37, v212
    v_mfma_f32_16x16x32_bf16 v[220:223], a[36:39], a[236:239], v[220:223]
    v_mul_f32 v213, s37, v213
    v_mul_f32 v214, s37, v214
    v_mfma_f32_16x16x32_bf16 v[216:219], a[4:7], v[164:167], 0
    v_mul_f32 v215, s37, v215
    v_cvt_pk_bf16_f32 v136, v212, v213
    v_mfma_f32_16x16x32_bf16 v[216:219], a[16:19], v[168:171], v[216:219]
    ds_read_b128 a[244:247], v224 offset:320
    v_cvt_pk_bf16_f32 v137, v214, v215
    v_mfma_f32_16x16x32_bf16 v[212:215], a[8:11], v[164:167], 0
    buffer_store_dwordx4 v[208:211], v243, s[20:23], s51 offen sc0 sc1
    v_mfma_f32_16x16x32_bf16 v[212:215], a[20:23], v[168:171], v[212:215]
    v_exp_f32 v151, v151
    v_mfma_f32_16x16x32_bf16 v[208:211], a[220:223], a[248:251], 0
    v_cvt_pk_bf16_f32 v157, v150, v151
    v_mfma_f32_16x16x32_bf16 v[216:219], a[28:31], v[248:251], v[216:219]
    ds_read_b128 v[148:151], v230 offset:2560
    v_mfma_f32_16x16x32_bf16 v[216:219], a[40:43], a[236:239], v[216:219]
    v_exp_f32 v152, v152
    v_mfma_f32_16x16x32_bf16 v[212:215], a[32:35], v[248:251], v[212:215]
    v_exp_f32 v153, v153
    v_mfma_f32_16x16x32_bf16 v[212:215], a[44:47], a[236:239], v[212:215]
    s_waitcnt lgkmcnt(2)
    v_exp_f32 v154, v154
    v_mfma_f32_16x16x32_bf16 v[220:223], a[48:51], a[240:243], v[220:223]
    s_waitcnt lgkmcnt(1)
    v_exp_f32 v155, v155
    v_mfma_f32_16x16x32_bf16 v[220:223], a[60:63], a[244:247], v[220:223]
    v_cvt_pk_bf16_f32 v158, v152, v153
    v_cvt_pk_bf16_f32 v159, v154, v155
    v_mfma_f32_16x16x32_bf16 v[216:219], a[52:55], a[240:243], v[216:219]
    ds_read_b128 v[152:155], v235
    v_bfe_u32 v235, s67, v233, 4
    v_mfma_f32_16x16x32_bf16 v[216:219], a[64:67], a[244:247], v[216:219]
    v_mad_u32_u24 v235, v235, s40, v231
    v_mfma_f32_16x16x32_bf16 v[196:199], a[216:219], v[156:159], 0
    v_cvt_pk_bf16_f32 v0, v220, v221
    v_cvt_pk_bf16_f32 v1, v222, v223
    v_mfma_f32_16x16x32_bf16 v[184:187], v[68:71], v[156:159], 0
    buffer_store_dwordx4 v[200:203], v245, s[20:23], s51 offen sc0 sc1
    v_mfma_f32_16x16x32_bf16 v[188:191], v[90:93], v[156:159], 0
    v_exp_f32 v144, v144
    v_mfma_f32_16x16x32_bf16 v[192:195], v[112:115], v[156:159], 0
    s_waitcnt lgkmcnt(1)
    v_cvt_pk_bf16_f32 v2, v216, v217
    v_cvt_pk_bf16_f32 v3, v218, v219
    v_mfma_f32_16x16x32_bf16 v[148:151], v[42:45], v[138:141], v[148:151]
    s_waitcnt lgkmcnt(0)
    v_exp_f32 v145, v145
    v_mfma_f32_16x16x32_bf16 v[152:155], v[48:51], v[138:141], v[152:155]
    v_exp_f32 v146, v146
    v_mfma_f32_16x16x32_bf16 v[200:203], a[220:223], a[252:255], 0
    ds_read_b128 a[252:255], v240 offset:13312
    v_cvt_pk_bf16_f32 v156, v144, v145
    v_mfma_f32_16x16x16_bf16 v[148:151], v[46:47], v[142:143], v[148:151]
    v_exp_f32 v147, v147
    v_mfma_f32_16x16x16_bf16 v[152:155], v[52:53], v[142:143], v[152:155]
    v_cvt_pk_bf16_f32 v157, v146, v147
    v_mfma_f32_16x16x32_bf16 v[212:215], a[56:59], a[240:243], v[212:215]
    ds_read_b128 v[144:147], v234
    v_bfe_u32 v234, s70, v233, 4
    v_mfma_f32_16x16x32_bf16 v[212:215], a[68:71], a[244:247], v[212:215]
    v_mad_u32_u24 v234, v234, s40, v231
    v_mfma_f32_16x16x32_bf16 v[220:223], v[164:167], a[72:75], 0
    v_exp_f32 v148, v148
    v_mfma_f32_16x16x32_bf16 v[220:223], v[168:171], a[84:87], v[220:223]
    s_waitcnt lgkmcnt(1)
    v_exp_f32 v149, v149
    v_mfma_f32_16x16x32_bf16 v[200:203], v[252:255], a[252:255], v[200:203]
    buffer_store_dwordx4 v[176:179], v244, s[20:23], s51 offen sc0 sc1
    v_mfma_f32_16x16x32_bf16 v[180:183], v[160:163], a[252:255], v[180:183]
    s_add_u32 s51, s51, s48
    v_cvt_pk_bf16_f32 v4, v212, v213
    v_cvt_pk_bf16_f32 v5, v214, v215
    v_mfma_f32_16x16x32_bf16 v[176:179], a[228:231], a[248:251], 0
    s_waitcnt lgkmcnt(0)
    ds_read_b128 a[248:251], v239 offset:13312
    ds_read_b128 a[252:255], v240 offset:14336
    v_mfma_f32_16x16x32_bf16 v[144:147], v[60:63], v[138:141], v[144:147]
    v_exp_f32 v150, v150
    v_mfma_f32_16x16x32_bf16 v[216:219], v[164:167], a[76:79], 0
    v_exp_f32 v151, v151
    v_mfma_f32_16x16x32_bf16 v[216:219], v[168:171], a[88:91], v[216:219]
    v_cvt_pk_bf16_f32 v158, v148, v149
    v_cvt_pk_bf16_f32 v159, v150, v151
    v_mfma_f32_16x16x16_bf16 v[144:147], v[64:65], v[142:143], v[144:147]
    ds_read_b128 v[148:151], v229 offset:640
    v_mfma_f32_16x16x32_bf16 v[196:199], a[216:219], v[156:159], v[196:199]
    v_exp_f32 v152, v152
    v_mfma_f32_16x16x32_bf16 v[184:187], v[76:79], v[156:159], v[184:187]
    v_exp_f32 v153, v153
    v_mfma_f32_16x16x32_bf16 v[188:191], v[98:101], v[156:159], v[188:191]
    v_exp_f32 v154, v154
    v_mfma_f32_16x16x32_bf16 v[192:195], v[120:123], v[156:159], v[192:195]
    s_waitcnt lgkmcnt(2)
    v_exp_f32 v155, v155
    v_mfma_f32_16x16x32_bf16 v[208:211], v[252:255], a[248:251], v[208:211]
    ds_read_b128 v[252:255], v242 offset:12288
    v_cvt_pk_bf16_f32 v156, v152, v153
    v_mfma_f32_16x16x32_bf16 v[204:207], v[160:163], a[248:251], v[204:207]
    ds_read_b128 v[160:163], v242 offset:12800
    v_cvt_pk_bf16_f32 v157, v154, v155
    v_mfma_f32_16x16x32_bf16 v[212:215], v[164:167], a[80:83], 0
    ds_read_b128 v[152:155], v228 offset:640
    v_mfma_f32_16x16x32_bf16 v[212:215], v[168:171], a[92:95], v[212:215]
    s_waitcnt lgkmcnt(3)
    ds_read_b128 v[164:167], v224 offset:3072
    v_mfma_f32_16x16x32_bf16 v[148:151], v[30:33], v[132:135], v[148:151]
    ds_read_b128 v[168:171], v224 offset:3136
    v_mfma_f32_16x16x32_bf16 v[220:223], v[248:251], a[96:99], v[220:223]
    v_exp_f32 v144, v144
    v_mfma_f32_16x16x32_bf16 v[220:223], a[236:239], a[108:111], v[220:223]
    s_waitcnt lgkmcnt(4)
    v_exp_f32 v145, v145
    v_mfma_f32_16x16x32_bf16 v[176:179], v[252:255], a[248:251], v[176:179]
    ds_read_b128 v[252:255], v241 offset:24576
    v_cvt_pk_bf16_f32 v158, v144, v145
    v_mfma_f32_16x16x16_bf16 v[148:151], v[34:35], v[136:137], v[148:151]
    s_waitcnt lgkmcnt(4)
    v_exp_f32 v146, v146
    v_mfma_f32_16x16x32_bf16 v[172:175], v[160:163], a[248:251], v[172:175]
    s_waitcnt lgkmcnt(3)
    ds_read_b128 a[248:251], v239 offset:14336
    ds_read_b128 v[160:163], v241 offset:25088
    v_mfma_f32_16x16x32_bf16 v[152:155], v[6:9], v[132:135], v[152:155]
    v_exp_f32 v147, v147
    v_mfma_f32_16x16x32_bf16 v[216:219], v[248:251], a[100:103], v[216:219]
    v_cvt_pk_bf16_f32 v159, v146, v147
    v_mfma_f32_16x16x32_bf16 v[216:219], a[236:239], a[112:115], v[216:219]
    ds_read_b128 v[144:147], v228 offset:1280
    v_mfma_f32_16x16x32_bf16 v[196:199], a[216:219], v[156:159], v[196:199]
    v_exp_f32 v148, v148
    v_mfma_f32_16x16x32_bf16 v[184:187], v[84:87], v[156:159], v[184:187]
    v_exp_f32 v149, v149
    v_mfma_f32_16x16x32_bf16 v[188:191], v[106:109], v[156:159], v[188:191]
    v_exp_f32 v150, v150
    v_mfma_f32_16x16x32_bf16 v[192:195], v[128:131], v[156:159], v[192:195]
    v_exp_f32 v151, v151
    v_mfma_f32_16x16x16_bf16 v[152:155], v[10:11], v[136:137], v[152:155]
    v_rcp_f32 v197, v196
    v_mfma_f32_16x16x32_bf16 v[212:215], v[248:251], a[104:107], v[212:215]
    ds_read_b128 v[248:251], v224 offset:3200
    v_mul_f32 v184, v184, v197
    v_mfma_f32_16x16x32_bf16 v[212:215], a[236:239], a[116:119], v[212:215]
    s_waitcnt lgkmcnt(1)
    ds_read_b128 a[236:239], v224 offset:3264
    v_mul_f32 v185, v185, v197
    v_mfma_f32_16x16x32_bf16 v[144:147], v[12:15], v[132:135], v[144:147]
    v_cvt_pk_bf16_f32 v184, v184, v185
    v_mul_f32 v186, v186, v197
    v_mfma_f32_16x16x32_bf16 v[220:223], a[240:243], a[120:123], v[220:223]
    v_mul_f32 v187, v187, v197
    v_cvt_pk_bf16_f32 v185, v186, v187
    v_mfma_f32_16x16x32_bf16 v[220:223], a[244:247], a[132:135], v[220:223]
    v_mul_f32 v188, v188, v197
    v_mul_f32 v189, v189, v197
    v_mfma_f32_16x16x16_bf16 v[144:147], v[16:17], v[136:137], v[144:147]
    v_cvt_pk_bf16_f32 v186, v188, v189
    v_mul_f32 v190, v190, v197
    v_mfma_f32_16x16x32_bf16 v[216:219], a[240:243], a[124:127], v[216:219]
    v_mul_f32 v191, v191, v197
    v_cvt_pk_bf16_f32 v187, v190, v191
    v_mfma_f32_16x16x32_bf16 v[216:219], a[244:247], a[136:139], v[216:219]
    v_cvt_pk_bf16_f32 v66, v220, v221
    v_cvt_pk_bf16_f32 v67, v222, v223
    v_mfma_f32_16x16x32_bf16 v[212:215], a[240:243], a[128:131], v[212:215]
    ds_read_b128 a[240:243], v224 offset:3328
    v_mul_f32 v192, v192, v197
    v_mfma_f32_16x16x32_bf16 v[212:215], a[244:247], a[140:143], v[212:215]
    ds_read_b128 a[244:247], v224 offset:3392
    v_mul_f32 v193, v193, v197
    v_mfma_f32_16x16x32_bf16 v[208:211], v[252:255], a[248:251], v[208:211]
    v_cvt_pk_bf16_f32 v88, v216, v217
    v_cvt_pk_bf16_f32 v89, v218, v219
    v_mfma_f32_16x16x32_bf16 v[200:203], v[252:255], a[252:255], v[200:203]
    ds_read_b128 v[252:255], v242 offset:24576
    v_cvt_pk_bf16_f32 v188, v192, v193
    v_mfma_f32_16x16x32_bf16 v[204:207], v[160:163], a[248:251], v[204:207]
    v_cvt_pk_bf16_f32 v110, v212, v213
    v_cvt_pk_bf16_f32 v111, v214, v215
    v_mfma_f32_16x16x32_bf16 v[180:183], v[160:163], a[252:255], v[180:183]
    ds_read_b128 v[160:163], v242 offset:25088
    ds_read_b128 a[252:255], v240 offset:15360
    v_mfma_f32_16x16x32_bf16 v[220:223], a[0:3], v[164:167], 0
    v_mul_f32 v194, v194, v197
    v_mul_f32 v195, v195, v197
    v_mfma_f32_16x16x32_bf16 v[220:223], a[12:15], v[168:171], v[220:223]
    v_cvt_pk_bf16_f32 v189, v194, v195
    v_max3_f32 v236, v236, v196, v197
    v_mfma_f32_16x16x32_bf16 v[216:219], a[4:7], v[164:167], 0
    ds_write_b128 v237, v[184:187] offset:6144
    v_mfma_f32_16x16x32_bf16 v[216:219], a[16:19], v[168:171], v[216:219]
    s_waitcnt lgkmcnt(3)
    ds_write_b64 v238, v[188:189] offset:6144
    v_mfma_f32_16x16x32_bf16 v[176:179], v[252:255], a[248:251], v[176:179]
    s_waitcnt lgkmcnt(3)
    v_cvt_pk_bf16_f32 v156, v148, v149
    v_cvt_pk_bf16_f32 v157, v150, v151
    v_mfma_f32_16x16x32_bf16 v[172:175], v[160:163], a[248:251], v[172:175]
    v_exp_f32 v152, v152
    v_mfma_f32_16x16x32_bf16 v[212:215], a[8:11], v[164:167], 0
    v_exp_f32 v153, v153
    v_mfma_f32_16x16x32_bf16 v[212:215], a[20:23], v[168:171], v[212:215]
    ds_read_b128 v[148:151], v229 offset:1280
    v_cvt_pk_bf16_f32 v158, v152, v153
    v_mfma_f32_16x16x32_bf16 v[220:223], a[24:27], v[248:251], v[220:223]
    ds_read_b128 a[248:251], v239 offset:15360
    v_mfma_f32_16x16x32_bf16 v[220:223], a[36:39], a[236:239], v[220:223]
    ds_read_b128 v[252:255], v241 offset:36864
    v_mfma_f32_16x16x32_bf16 v[216:219], a[28:31], v[248:251], v[216:219]
    ds_read_b128 v[160:163], v241 offset:37376
    v_mfma_f32_16x16x32_bf16 v[216:219], a[40:43], a[236:239], v[216:219]
    v_exp_f32 v154, v154
    v_mfma_f32_16x16x32_bf16 v[212:215], a[32:35], v[248:251], v[212:215]
    v_exp_f32 v155, v155
    v_mfma_f32_16x16x32_bf16 v[212:215], a[44:47], a[236:239], v[212:215]
    v_cvt_pk_bf16_f32 v159, v154, v155
    v_mfma_f32_16x16x32_bf16 v[220:223], a[48:51], a[240:243], v[220:223]
    ds_read_b128 v[152:155], v229 offset:1920
    v_mfma_f32_16x16x32_bf16 v[220:223], a[60:63], a[244:247], v[220:223]
    v_exp_f32 v144, v144
    v_mfma_f32_16x16x32_bf16 v[196:199], a[216:219], v[156:159], 0
    v_exp_f32 v145, v145
    v_mfma_f32_16x16x32_bf16 v[184:187], v[70:73], v[156:159], 0
    v_exp_f32 v146, v146
    v_mfma_f32_16x16x32_bf16 v[188:191], v[92:95], v[156:159], 0
    v_exp_f32 v147, v147
    v_mfma_f32_16x16x32_bf16 v[192:195], v[114:117], v[156:159], 0
    s_waitcnt lgkmcnt(1)
    v_cvt_pk_bf16_f32 v24, v220, v221
    v_cvt_pk_bf16_f32 v25, v222, v223
    v_mfma_f32_16x16x32_bf16 v[148:151], v[36:39], v[132:135], v[148:151]
    v_cvt_pk_bf16_f32 v156, v144, v145
    v_cvt_pk_bf16_f32 v157, v146, v147
    v_mfma_f32_16x16x32_bf16 v[216:219], a[52:55], a[240:243], v[216:219]
    ds_read_b128 v[144:147], v228 offset:1920
    v_mfma_f32_16x16x32_bf16 v[216:219], a[64:67], a[244:247], v[216:219]
    s_waitcnt lgkmcnt(1)
    v_mfma_f32_16x16x32_bf16 v[152:155], v[42:45], v[132:135], v[152:155]
    v_mfma_f32_16x16x16_bf16 v[148:151], v[40:41], v[136:137], v[148:151]
    v_mfma_f32_16x16x32_bf16 v[212:215], a[56:59], a[240:243], v[212:215]
    v_mfma_f32_16x16x32_bf16 v[212:215], a[68:71], a[244:247], v[212:215]
    v_mfma_f32_16x16x32_bf16 v[208:211], v[252:255], a[248:251], v[208:211]
    v_mfma_f32_16x16x32_bf16 v[200:203], v[252:255], a[252:255], v[200:203]
    ds_read_b128 v[252:255], v242 offset:36864
    v_mfma_f32_16x16x16_bf16 v[152:155], v[46:47], v[136:137], v[152:155]
    s_waitcnt lgkmcnt(1)
    v_cvt_pk_bf16_f32 v26, v216, v217
    v_cvt_pk_bf16_f32 v27, v218, v219
    v_mfma_f32_16x16x32_bf16 v[144:147], v[18:21], v[132:135], v[144:147]
    v_exp_f32 v148, v148
    v_mfma_f32_16x16x32_bf16 v[204:207], v[160:163], a[248:251], v[204:207]
    v_cvt_pk_bf16_f32 v28, v212, v213
    v_cvt_pk_bf16_f32 v29, v214, v215
    v_mfma_f32_16x16x32_bf16 v[180:183], v[160:163], a[252:255], v[180:183]
    ds_read_b128 v[160:163], v242 offset:37376
    ds_read_b128 a[252:255], v240 offset:16384
    v_mfma_f32_16x16x16_bf16 v[144:147], v[22:23], v[136:137], v[144:147]
    v_exp_f32 v149, v149
    v_mfma_f32_16x16x32_bf16 v[220:223], v[164:167], a[72:75], 0
    v_exp_f32 v150, v150
    v_mfma_f32_16x16x32_bf16 v[220:223], v[168:171], a[84:87], v[220:223]
    s_waitcnt lgkmcnt(2)
    v_exp_f32 v151, v151
    v_mfma_f32_16x16x32_bf16 v[176:179], v[252:255], a[248:251], v[176:179]
    ds_read_b128 v[252:255], v241 offset:49152
    v_cvt_pk_bf16_f32 v158, v148, v149
    v_mfma_f32_16x16x32_bf16 v[216:219], v[164:167], a[76:79], 0
    v_cvt_pk_bf16_f32 v159, v150, v151
    v_mfma_f32_16x16x32_bf16 v[216:219], v[168:171], a[88:91], v[216:219]
    ds_read_b128 v[148:151], v228 offset:2560
    v_mfma_f32_16x16x32_bf16 v[196:199], a[216:219], v[156:159], v[196:199]
    v_exp_f32 v152, v152
    v_mfma_f32_16x16x32_bf16 v[184:187], v[74:77], v[156:159], v[184:187]
    v_exp_f32 v153, v153
    v_mfma_f32_16x16x32_bf16 v[188:191], v[96:99], v[156:159], v[188:191]
    v_exp_f32 v154, v154
    v_mfma_f32_16x16x32_bf16 v[192:195], v[118:121], v[156:159], v[192:195]
    s_waitcnt lgkmcnt(2)
    v_exp_f32 v155, v155
    v_mfma_f32_16x16x32_bf16 v[172:175], v[160:163], a[248:251], v[172:175]
    ds_read_b128 a[248:251], v239 offset:16384
    ds_read_b128 v[160:163], v241 offset:49664
    v_mfma_f32_16x16x32_bf16 v[212:215], v[164:167], a[80:83], 0
    ds_read_b128 v[164:167], v232 offset:42944
    v_cvt_pk_bf16_f32 v156, v152, v153
    v_mfma_f32_16x16x32_bf16 v[212:215], v[168:171], a[92:95], v[212:215]
    s_waitcnt lgkmcnt(3)
    ds_read_b128 v[168:171], v232 offset:43008
    v_cvt_pk_bf16_f32 v157, v154, v155
    v_mfma_f32_16x16x32_bf16 v[148:151], v[0:3], v[132:135], v[148:151]
    ds_read_b128 v[152:155], v229 offset:2560
    v_mfma_f32_16x16x32_bf16 v[220:223], v[248:251], a[96:99], v[220:223]
    v_exp_f32 v144, v144
    v_mfma_f32_16x16x32_bf16 v[220:223], a[236:239], a[108:111], v[220:223]
    v_exp_f32 v145, v145
    v_mfma_f32_16x16x32_bf16 v[216:219], v[248:251], a[100:103], v[216:219]
    v_exp_f32 v146, v146
    v_mfma_f32_16x16x32_bf16 v[216:219], a[236:239], a[112:115], v[216:219]
    v_exp_f32 v147, v147
    v_mfma_f32_16x16x16_bf16 v[148:151], v[4:5], v[136:137], v[148:151]
    v_cvt_pk_bf16_f32 v158, v144, v145
    v_cvt_pk_bf16_f32 v159, v146, v147
    v_mfma_f32_16x16x32_bf16 v[212:215], v[248:251], a[104:107], v[212:215]
    ds_read_b128 v[144:147], v230 offset:2560
    v_mfma_f32_16x16x32_bf16 v[212:215], a[236:239], a[116:119], v[212:215]
    ds_read_b128 v[248:251], v232 offset:43072
    v_mfma_f32_16x16x32_bf16 v[196:199], a[216:219], v[156:159], v[196:199]
    ds_read_b128 a[236:239], v232 offset:43136
    v_mfma_f32_16x16x32_bf16 v[184:187], v[78:81], v[156:159], v[184:187]
    v_exp_f32 v148, v148
    v_mfma_f32_16x16x32_bf16 v[188:191], v[100:103], v[156:159], v[188:191]
    v_exp_f32 v149, v149
    v_mfma_f32_16x16x32_bf16 v[192:195], v[122:125], v[156:159], v[192:195]
    s_waitcnt lgkmcnt(3)
    v_exp_f32 v150, v150
    v_mfma_f32_16x16x32_bf16 v[152:155], v[24:27], v[132:135], v[152:155]
    v_exp_f32 v151, v151
    v_mfma_f32_16x16x32_bf16 v[220:223], a[240:243], a[120:123], v[220:223]
    v_cvt_pk_bf16_f32 v156, v148, v149
    v_cvt_pk_bf16_f32 v157, v150, v151
    v_mfma_f32_16x16x32_bf16 v[220:223], a[244:247], a[132:135], v[220:223]
    ds_read_b128 v[148:151], v230 offset:640
    v_mfma_f32_16x16x16_bf16 v[152:155], v[28:29], v[136:137], v[152:155]
    v_mfma_f32_16x16x32_bf16 v[216:219], a[240:243], a[124:127], v[216:219]
    v_mfma_f32_16x16x32_bf16 v[216:219], a[244:247], a[136:139], v[216:219]
    v_mfma_f32_16x16x32_bf16 v[212:215], a[240:243], a[128:131], v[212:215]
    ds_read_b128 a[240:243], v232 offset:43200
    v_mfma_f32_16x16x32_bf16 v[212:215], a[244:247], a[140:143], v[212:215]
    ds_read_b128 a[244:247], v232 offset:43264
    v_cvt_pk_bf16_f32 v68, v220, v221
    v_mfma_f32_16x16x32_bf16 v[208:211], v[252:255], a[248:251], v[208:211]
    v_cvt_pk_bf16_f32 v69, v222, v223
    v_or_b32 v232, v243, v245
    v_mfma_f32_16x16x32_bf16 v[200:203], v[252:255], a[252:255], v[200:203]
    v_cvt_pk_bf16_f32 v90, v216, v217
    v_cvt_pk_bf16_f32 v91, v218, v219
    v_mfma_f32_16x16x32_bf16 v[204:207], v[160:163], a[248:251], v[204:207]
    v_cvt_pk_bf16_f32 v112, v212, v213
    v_cvt_pk_bf16_f32 v113, v214, v215
    v_mfma_f32_16x16x32_bf16 v[180:183], v[160:163], a[252:255], v[180:183]
    ds_read_b128 v[252:255], v242 offset:49152
    ds_read_b128 v[160:163], v242 offset:49664
    v_mfma_f32_16x16x32_bf16 v[220:223], a[144:147], v[164:167], 0
    ds_read_b128 a[252:255], v240 offset:17408
    v_lshrrev_b32 v232, 31, v232
    v_mfma_f32_16x16x32_bf16 v[220:223], a[156:159], v[168:171], v[220:223]
    v_lshl_add_u32 v232, v232, 20, v226
    v_mfma_f32_16x16x32_bf16 v[216:219], a[148:151], v[164:167], 0
    v_exp_f32 v152, v152
    v_mfma_f32_16x16x32_bf16 v[216:219], a[160:163], v[168:171], v[216:219]
    v_exp_f32 v153, v153
    v_mfma_f32_16x16x32_bf16 v[212:215], a[152:155], v[164:167], 0
    v_exp_f32 v154, v154
    v_mfma_f32_16x16x32_bf16 v[212:215], a[164:167], v[168:171], v[212:215]
    s_waitcnt lgkmcnt(2)
    v_exp_f32 v155, v155
    v_mfma_f32_16x16x32_bf16 v[176:179], v[252:255], a[248:251], v[176:179]
    s_waitcnt lgkmcnt(1)
    ds_read_b128 v[252:255], v241 offset:61440
    v_cvt_pk_bf16_f32 v158, v152, v153
    v_mfma_f32_16x16x32_bf16 v[172:175], v[160:163], a[248:251], v[172:175]
    ds_read_b128 a[248:251], v239 offset:17408
    ds_read_b128 v[160:163], v241 offset:61952
    v_mfma_f32_16x16x32_bf16 v[220:223], a[168:171], v[248:251], v[220:223]
    v_cvt_pk_bf16_f32 v159, v154, v155
    v_mfma_f32_16x16x32_bf16 v[220:223], a[180:183], a[236:239], v[220:223]
    ds_read_b128 v[152:155], v230 offset:1280
    v_mfma_f32_16x16x32_bf16 v[196:199], a[216:219], v[156:159], v[196:199]
    v_mfma_f32_16x16x32_bf16 v[184:187], v[66:69], v[156:159], v[184:187]
    v_mfma_f32_16x16x32_bf16 v[188:191], v[88:91], v[156:159], v[188:191]
    v_mfma_f32_16x16x32_bf16 v[192:195], v[110:113], v[156:159], v[192:195]
    s_waitcnt vmcnt(3) lgkmcnt(2)
    v_mfma_f32_16x16x32_bf16 v[216:219], a[172:175], v[248:251], v[216:219]
    s_barrier
    ds_read_b128 v[164:167], v227 offset:6144
    ds_read_b128 v[168:171], v227 offset:6208
    v_mfma_f32_16x16x32_bf16 v[216:219], a[184:187], a[236:239], v[216:219]
    v_rcp_f32 v197, v196
    v_mfma_f32_16x16x32_bf16 v[212:215], a[176:179], v[248:251], v[212:215]
    ds_read_b128 v[248:251], v227 offset:6272
    v_mul_f32 v184, v184, v197
    v_mfma_f32_16x16x32_bf16 v[212:215], a[188:191], a[236:239], v[212:215]
    ds_read_b128 a[236:239], v227 offset:6336
    v_mul_f32 v185, v185, v197
    v_mfma_f32_16x16x32_bf16 v[220:223], a[192:195], a[240:243], v[220:223]
    v_cvt_pk_bf16_f32 v184, v184, v185
    v_mul_f32 v186, v186, v197
    v_mfma_f32_16x16x32_bf16 v[220:223], a[204:207], a[244:247], v[220:223]
    v_mul_f32 v187, v187, v197
    v_cvt_pk_bf16_f32 v185, v186, v187
    v_mfma_f32_16x16x32_bf16 v[216:219], a[196:199], a[240:243], v[216:219]
    v_mul_f32 v188, v188, v197
    v_mul_f32 v189, v189, v197
    v_mfma_f32_16x16x32_bf16 v[216:219], a[208:211], a[244:247], v[216:219]
    v_cvt_pk_bf16_f32 v186, v188, v189
    v_mul_f32 v190, v190, v197
    v_mfma_f32_16x16x32_bf16 v[212:215], a[200:203], a[240:243], v[212:215]
    v_mul_f32 v220, s37, v220
    v_mul_f32 v221, s37, v221
    v_mfma_f32_16x16x32_bf16 v[212:215], a[212:215], a[244:247], v[212:215]
    v_mul_f32 v222, s37, v222
    v_mul_f32 v223, s37, v223
    v_mfma_f32_16x16x32_bf16 v[208:211], v[252:255], a[248:251], v[208:211]
    v_cvt_pk_bf16_f32 v138, v220, v221
    v_cvt_pk_bf16_f32 v139, v222, v223
    v_mfma_f32_16x16x32_bf16 v[200:203], v[252:255], a[252:255], v[200:203]
    s_waitcnt lgkmcnt(0)
    v_mul_f32 v216, s37, v216
    v_mul_f32 v217, s37, v217
    v_mfma_f32_16x16x32_bf16 v[204:207], v[160:163], a[248:251], v[204:207]
    v_mul_f32 v218, s37, v218
    v_mul_f32 v219, s37, v219
    v_mfma_f32_16x16x32_bf16 v[180:183], v[160:163], a[252:255], v[180:183]
    v_cvt_pk_bf16_f32 v140, v216, v217
    v_cvt_pk_bf16_f32 v141, v218, v219
    v_mfma_f32_16x16x32_bf16 v[220:223], a[0:3], v[164:167], 0
    v_mul_f32 v212, s37, v212
    v_mul_f32 v213, s37, v213
    v_mfma_f32_16x16x32_bf16 v[220:223], a[12:15], v[168:171], v[220:223]
    v_mul_f32 v214, s37, v214
    v_mul_f32 v215, s37, v215
    v_mfma_f32_16x16x32_bf16 v[144:147], v[24:27], v[138:141], v[144:147]
    v_cvt_pk_bf16_f32 v142, v212, v213
    v_cvt_pk_bf16_f32 v143, v214, v215
    v_mfma_f32_16x16x32_bf16 v[148:151], v[30:33], v[138:141], v[148:151]
    ds_read_b128 v[252:255], v242 offset:61440
    ds_read_b128 v[160:163], v242 offset:61952
    v_mfma_f32_16x16x32_bf16 v[152:155], v[36:39], v[138:141], v[152:155]
    ds_read_b128 a[252:255], v240
    v_mul_f32 v191, v191, v197
    v_mfma_f32_16x16x16_bf16 v[144:147], v[28:29], v[142:143], v[144:147]
    ds_read_b128 a[240:243], v227 offset:6400
    v_cvt_pk_bf16_f32 v187, v190, v191
    v_mfma_f32_16x16x16_bf16 v[148:151], v[34:35], v[142:143], v[148:151]
    ds_read_b128 a[244:247], v227 offset:6464
    v_mul_f32 v192, v192, v197
    v_mfma_f32_16x16x16_bf16 v[152:155], v[40:41], v[142:143], v[152:155]
    v_mul_f32 v193, v193, v197
    v_cvt_pk_bf16_f32 v188, v192, v193
    v_mfma_f32_16x16x32_bf16 v[216:219], a[4:7], v[164:167], 0
    v_mul_f32 v194, v194, v197
    v_mul_f32 v195, v195, v197
    v_mfma_f32_16x16x32_bf16 v[216:219], a[16:19], v[168:171], v[216:219]
    s_waitcnt lgkmcnt(4)
    v_cvt_pk_bf16_f32 v189, v194, v195
    v_max3_f32 v236, v236, v196, v197
    v_mfma_f32_16x16x32_bf16 v[176:179], v[252:255], a[248:251], v[176:179]
    s_waitcnt lgkmcnt(3)
    ds_read_b128 v[252:255], v241 offset:12288
    v_cndmask_b32 v227, v240, v239, vcc
    v_mfma_f32_16x16x32_bf16 v[172:175], v[160:163], a[248:251], v[172:175]
    ds_read_b128 a[248:251], v239
    ds_read_b128 v[160:163], v241 offset:12800
    v_mfma_f32_16x16x32_bf16 v[212:215], a[8:11], v[164:167], 0
    ds_write_b128 v237, v[184:187] offset:12288
    v_mfma_f32_16x16x32_bf16 v[212:215], a[20:23], v[168:171], v[212:215]
    ds_write_b64 v238, v[188:189] offset:12288
    v_mfma_f32_16x16x32_bf16 v[220:223], a[24:27], v[248:251], v[220:223]
    v_cvt_pk_bf16_f32 v208, v208, v209
    v_cvt_pk_bf16_f32 v209, v210, v211
    v_mfma_f32_16x16x32_bf16 v[220:223], a[36:39], a[236:239], v[220:223]
    v_cvt_pk_bf16_f32 v210, v204, v205
    v_cvt_pk_bf16_f32 v211, v206, v207
    v_mfma_f32_16x16x32_bf16 v[216:219], a[28:31], v[248:251], v[216:219]
    buffer_store_dwordx4 v[208:211], v243, s[20:23], s51 offen sc0 sc1
    v_mfma_f32_16x16x32_bf16 v[216:219], a[40:43], a[236:239], v[216:219]
    v_cvt_pk_bf16_f32 v200, v200, v201
    v_cvt_pk_bf16_f32 v201, v202, v203
    v_mfma_f32_16x16x32_bf16 v[212:215], a[32:35], v[248:251], v[212:215]
    v_cvt_pk_bf16_f32 v202, v180, v181
    v_cvt_pk_bf16_f32 v203, v182, v183
    v_mfma_f32_16x16x32_bf16 v[212:215], a[44:47], a[236:239], v[212:215]
    s_waitcnt lgkmcnt(2)
    v_cvt_pk_bf16_f32 v176, v176, v177
    v_cvt_pk_bf16_f32 v177, v178, v179
    v_mfma_f32_16x16x32_bf16 v[220:223], a[48:51], a[240:243], v[220:223]
    v_cvt_pk_bf16_f32 v178, v172, v173
    v_cvt_pk_bf16_f32 v179, v174, v175
    v_mfma_f32_16x16x32_bf16 v[220:223], a[60:63], a[244:247], v[220:223]
    v_exp_f32 v144, v144
    v_mfma_f32_16x16x32_bf16 v[216:219], a[52:55], a[240:243], v[216:219]
    v_exp_f32 v145, v145
    v_mfma_f32_16x16x32_bf16 v[216:219], a[64:67], a[244:247], v[216:219]
    v_exp_f32 v146, v146
    v_mfma_f32_16x16x32_bf16 v[212:215], a[56:59], a[240:243], v[212:215]
    v_exp_f32 v147, v147
    v_mfma_f32_16x16x32_bf16 v[212:215], a[68:71], a[244:247], v[212:215]
    v_cvt_pk_bf16_f32 v54, v220, v221
    v_cvt_pk_bf16_f32 v55, v222, v223
    v_mfma_f32_16x16x32_bf16 v[208:211], a[220:223], a[248:251], 0
    v_cndmask_b32 v60, v60, v54, s[82:83]
    v_cndmask_b32 v61, v61, v55, s[82:83]
    v_mfma_f32_16x16x32_bf16 v[204:207], a[224:227], a[248:251], 0
    v_cvt_pk_bf16_f32 v56, v216, v217
    v_cvt_pk_bf16_f32 v57, v218, v219
    v_mfma_f32_16x16x32_bf16 v[180:183], a[224:227], a[252:255], 0
    v_cndmask_b32 v62, v62, v56, s[82:83]
    v_cndmask_b32 v63, v63, v57, s[82:83]
    v_mfma_f32_16x16x32_bf16 v[172:175], a[232:235], a[248:251], 0
    v_cvt_pk_bf16_f32 v58, v212, v213
    v_cvt_pk_bf16_f32 v59, v214, v215
    v_mfma_f32_16x16x32_bf16 v[220:223], v[164:167], a[72:75], 0
    v_cndmask_b32 v64, v64, v58, s[82:83]
    v_cndmask_b32 v65, v65, v59, s[82:83]
    v_mfma_f32_16x16x32_bf16 v[220:223], v[168:171], a[84:87], v[220:223]
    buffer_store_dwordx4 v[200:203], v245, s[20:23], s51 offen sc0 sc1
    v_mfma_f32_16x16x32_bf16 v[216:219], v[164:167], a[76:79], 0
    v_cvt_pk_bf16_f32 v156, v144, v145
    v_cvt_pk_bf16_f32 v157, v146, v147
    v_mfma_f32_16x16x32_bf16 v[216:219], v[168:171], a[88:91], v[216:219]
    ds_read_b128 v[144:147], v230 offset:1920
    v_mfma_f32_16x16x32_bf16 v[200:203], a[220:223], a[252:255], 0
    ds_read_b128 a[252:255], v240 offset:1024
    v_mfma_f32_16x16x32_bf16 v[212:215], v[164:167], a[80:83], 0
    ds_read_b128 v[164:167], v226 offset:1152
    v_mfma_f32_16x16x32_bf16 v[212:215], v[168:171], a[92:95], v[212:215]
    ds_read_b128 v[168:171], v226 offset:1216
    v_mfma_f32_16x16x32_bf16 v[220:223], v[248:251], a[96:99], v[220:223]
    v_exp_f32 v148, v148
    v_mfma_f32_16x16x32_bf16 v[220:223], a[236:239], a[108:111], v[220:223]
    v_exp_f32 v149, v149
    v_mfma_f32_16x16x32_bf16 v[216:219], v[248:251], a[100:103], v[216:219]
    v_exp_f32 v150, v150
    v_mfma_f32_16x16x32_bf16 v[216:219], a[236:239], a[112:115], v[216:219]
    s_waitcnt lgkmcnt(3)
    v_exp_f32 v151, v151
    v_mfma_f32_16x16x32_bf16 v[144:147], v[42:45], v[138:141], v[144:147]
    s_waitcnt lgkmcnt(2)
    v_cvt_pk_bf16_f32 v158, v148, v149
    v_cvt_pk_bf16_f32 v159, v150, v151
    v_mfma_f32_16x16x32_bf16 v[200:203], v[252:255], a[252:255], v[200:203]
    ds_read_b128 v[148:151], v235
    v_bfe_u32 v235, s69, v233, 4
    v_mfma_f32_16x16x32_bf16 v[196:199], a[216:219], v[156:159], 0
    v_mad_u32_u24 v235, v235, s40, v231
    v_mfma_f32_16x16x32_bf16 v[184:187], v[68:71], v[156:159], 0
    buffer_store_dwordx4 v[176:179], v244, s[20:23], s51 offen sc0 sc1
    v_mfma_f32_16x16x32_bf16 v[188:191], v[90:93], v[156:159], 0
    s_add_u32 s51, s51, s48
    v_exp_f32 v152, v152
    v_mfma_f32_16x16x32_bf16 v[192:195], v[112:115], v[156:159], 0
    v_exp_f32 v153, v153
    v_mfma_f32_16x16x16_bf16 v[144:147], v[46:47], v[142:143], v[144:147]
    v_exp_f32 v154, v154
    v_mfma_f32_16x16x32_bf16 v[176:179], a[228:231], a[248:251], 0
    s_waitcnt lgkmcnt(0)
    ds_read_b128 a[248:251], v239 offset:1024
    v_cvt_pk_bf16_f32 v156, v152, v153
    v_mfma_f32_16x16x32_bf16 v[148:151], v[48:51], v[138:141], v[148:151]
    v_exp_f32 v155, v155
    v_mfma_f32_16x16x32_bf16 v[180:183], v[160:163], a[252:255], v[180:183]
    ds_read_b128 a[252:255], v240 offset:2048
    v_cvt_pk_bf16_f32 v157, v154, v155
    v_mfma_f32_16x16x32_bf16 v[212:215], v[248:251], a[104:107], v[212:215]
L_pg7:
    s_cbranch_execz L_back
    ds_read_b128 v[152:155], v234
    v_bfe_u32 v234, s68, v233, 4
    v_mfma_f32_16x16x32_bf16 v[212:215], a[236:239], a[116:119], v[212:215]
    ds_read_b128 v[248:251], v226 offset:1280
    v_mad_u32_u24 v234, v234, s40, v231
    v_mfma_f32_16x16x16_bf16 v[148:151], v[52:53], v[142:143], v[148:151]
    ds_read_b128 a[236:239], v226 offset:1344
    v_mfma_f32_16x16x32_bf16 v[220:223], a[240:243], a[120:123], v[220:223]
    v_exp_f32 v144, v144
    v_mfma_f32_16x16x32_bf16 v[220:223], a[244:247], a[132:135], v[220:223]
    s_waitcnt lgkmcnt(4)
    v_exp_f32 v145, v145
    v_mfma_f32_16x16x32_bf16 v[208:211], v[252:255], a[248:251], v[208:211]
    ds_read_b128 v[252:255], v242 offset:12288
    v_cvt_pk_bf16_f32 v158, v144, v145
    v_mfma_f32_16x16x32_bf16 v[204:207], v[160:163], a[248:251], v[204:207]
    ds_read_b128 v[160:163], v242 offset:12800
    v_mfma_f32_16x16x32_bf16 v[216:219], a[240:243], a[124:127], v[216:219]
    v_exp_f32 v146, v146
    v_mfma_f32_16x16x32_bf16 v[216:219], a[244:247], a[136:139], v[216:219]
    s_waitcnt lgkmcnt(4)
    v_cvt_pk_bf16_f32 v82, v220, v221
    v_cvt_pk_bf16_f32 v83, v222, v223
    v_mfma_f32_16x16x32_bf16 v[152:155], v[60:63], v[138:141], v[152:155]
    v_cndmask_b32 v86, v86, v82, s[84:85]
    v_cndmask_b32 v87, v87, v83, s[84:85]
    v_mfma_f32_16x16x32_bf16 v[212:215], a[240:243], a[128:131], v[212:215]
    ds_read_b128 a[240:243], v226 offset:1408
    v_mfma_f32_16x16x32_bf16 v[212:215], a[244:247], a[140:143], v[212:215]
    v_cvt_pk_bf16_f32 v104, v216, v217
    v_cvt_pk_bf16_f32 v105, v218, v219
    v_mfma_f32_16x16x16_bf16 v[152:155], v[64:65], v[142:143], v[152:155]
    s_waitcnt lgkmcnt(2)
    v_cndmask_b32 v108, v108, v104, s[84:85]
    v_cndmask_b32 v109, v109, v105, s[84:85]
    v_mfma_f32_16x16x32_bf16 v[176:179], v[252:255], a[248:251], v[176:179]
    s_waitcnt lgkmcnt(1)
    ds_read_b128 v[252:255], v241 offset:24576
    ds_read_b128 a[244:247], v226 offset:1472
    v_mfma_f32_16x16x32_bf16 v[172:175], v[160:163], a[248:251], v[172:175]
    v_cvt_pk_bf16_f32 v126, v212, v213
    v_cvt_pk_bf16_f32 v127, v214, v215
    v_mfma_f32_16x16x32_bf16 v[220:223], a[144:147], v[164:167], 0
    v_cndmask_b32 v130, v130, v126, s[84:85]
    v_cndmask_b32 v131, v131, v127, s[84:85]
    v_mfma_f32_16x16x32_bf16 v[220:223], a[156:159], v[168:171], v[220:223]
    ds_read_b128 a[248:251], v239 offset:2048
    ds_read_b128 v[160:163], v241 offset:25088
    v_mfma_f32_16x16x32_bf16 v[216:219], a[148:151], v[164:167], 0
    v_cndmask_b32 v226, v244, v247, vcc
    v_cndmask_b32 v247, v247, v244, vcc
    v_mfma_f32_16x16x32_bf16 v[216:219], a[160:163], v[168:171], v[216:219]
    v_exp_f32 v147, v147
    v_mfma_f32_16x16x32_bf16 v[212:215], a[152:155], v[164:167], 0
    ds_read_b128 v[164:167], v224 offset:15488
    v_cvt_pk_bf16_f32 v159, v146, v147
    v_mfma_f32_16x16x32_bf16 v[212:215], a[164:167], v[168:171], v[212:215]
    ds_read_b128 v[144:147], v228 offset:640
    v_mfma_f32_16x16x32_bf16 v[196:199], a[216:219], v[156:159], v[196:199]
    ds_read_b128 v[168:171], v224 offset:15552
    v_mfma_f32_16x16x32_bf16 v[184:187], v[76:79], v[156:159], v[184:187]
    v_exp_f32 v148, v148
    v_mfma_f32_16x16x32_bf16 v[188:191], v[98:101], v[156:159], v[188:191]
    v_exp_f32 v149, v149
    v_mfma_f32_16x16x32_bf16 v[192:195], v[120:123], v[156:159], v[192:195]
    s_waitcnt lgkmcnt(4)
    v_exp_f32 v150, v150
    v_mfma_f32_16x16x32_bf16 v[208:211], v[252:255], a[248:251], v[208:211]
    v_exp_f32 v151, v151
    v_mfma_f32_16x16x32_bf16 v[200:203], v[252:255], a[252:255], v[200:203]
    s_waitcnt lgkmcnt(3)
    ds_read_b128 v[252:255], v242 offset:24576
    v_cvt_pk_bf16_f32 v156, v148, v149
    v_mfma_f32_16x16x32_bf16 v[204:207], v[160:163], a[248:251], v[204:207]
    v_cvt_pk_bf16_f32 v157, v150, v151
    v_mfma_f32_16x16x32_bf16 v[180:183], v[160:163], a[252:255], v[180:183]
    ds_read_b128 v[148:151], v229 offset:640
    v_mfma_f32_16x16x32_bf16 v[220:223], a[168:171], v[248:251], v[220:223]
    ds_read_b128 v[160:163], v242 offset:25088
    v_mfma_f32_16x16x32_bf16 v[220:223], a[180:183], a[236:239], v[220:223]
    ds_read_b128 a[252:255], v240 offset:3072
    v_mfma_f32_16x16x32_bf16 v[216:219], a[172:175], v[248:251], v[216:219]
    v_exp_f32 v152, v152
    v_mfma_f32_16x16x32_bf16 v[216:219], a[184:187], a[236:239], v[216:219]
    s_waitcnt lgkmcnt(3)
    v_exp_f32 v153, v153
    v_mfma_f32_16x16x32_bf16 v[176:179], v[252:255], a[248:251], v[176:179]
    ds_read_b128 v[252:255], v241 offset:36864
    v_cvt_pk_bf16_f32 v158, v152, v153
    v_mfma_f32_16x16x32_bf16 v[212:215], a[176:179], v[248:251], v[212:215]
    ds_read_b128 v[248:251], v224 offset:15616
    v_mfma_f32_16x16x32_bf16 v[212:215], a[188:191], a[236:239], v[212:215]
    ds_read_b128 a[236:239], v224 offset:15680
    v_mfma_f32_16x16x32_bf16 v[220:223], a[192:195], a[240:243], v[220:223]
    v_exp_f32 v154, v154
    v_mfma_f32_16x16x32_bf16 v[220:223], a[204:207], a[244:247], v[220:223]
    s_waitcnt lgkmcnt(4)
    v_exp_f32 v155, v155
    v_mfma_f32_16x16x32_bf16 v[172:175], v[160:163], a[248:251], v[172:175]
    ds_read_b128 a[248:251], v239 offset:3072
    ds_read_b128 v[160:163], v241 offset:37376
    v_mfma_f32_16x16x32_bf16 v[216:219], a[196:199], a[240:243], v[216:219]
    v_cvt_pk_bf16_f32 v159, v154, v155
    v_mfma_f32_16x16x32_bf16 v[216:219], a[208:211], a[244:247], v[216:219]
    ds_read_b128 v[152:155], v229 offset:1280
    v_mul_f32 v220, s37, v220
    v_mfma_f32_16x16x32_bf16 v[196:199], a[216:219], v[156:159], v[196:199]
    v_mul_f32 v221, s37, v221
    v_mul_f32 v222, s37, v222
    v_mfma_f32_16x16x32_bf16 v[184:187], v[84:87], v[156:159], v[184:187]
    v_mul_f32 v223, s37, v223
    v_cvt_pk_bf16_f32 v132, v220, v221
    v_mfma_f32_16x16x32_bf16 v[188:191], v[106:109], v[156:159], v[188:191]
    v_cvt_pk_bf16_f32 v133, v222, v223
    v_mul_f32 v216, s37, v216
    v_mfma_f32_16x16x32_bf16 v[192:195], v[128:131], v[156:159], v[192:195]
    v_mul_f32 v217, s37, v217
    v_mul_f32 v218, s37, v218
    v_mfma_f32_16x16x32_bf16 v[212:215], a[200:203], a[240:243], v[212:215]
    v_mul_f32 v219, s37, v219
    v_cvt_pk_bf16_f32 v134, v216, v217
    v_mfma_f32_16x16x32_bf16 v[212:215], a[212:215], a[244:247], v[212:215]
    ds_read_b128 a[240:243], v224 offset:15744
    v_cvt_pk_bf16_f32 v135, v218, v219
    v_mfma_f32_16x16x32_bf16 v[220:223], a[0:3], v[164:167], 0
    ds_read_b128 a[244:247], v224 offset:15808
    v_mfma_f32_16x16x32_bf16 v[220:223], a[12:15], v[168:171], v[220:223]
    v_rcp_f32 v197, v196
    v_mfma_f32_16x16x32_bf16 v[144:147], v[12:15], v[132:135], v[144:147]
    v_mul_f32 v184, v184, v197
    v_mul_f32 v212, s37, v212
    v_mfma_f32_16x16x32_bf16 v[148:151], v[36:39], v[132:135], v[148:151]
    s_waitcnt lgkmcnt(2)
    v_mul_f32 v213, s37, v213
    v_mul_f32 v214, s37, v214
    v_mfma_f32_16x16x32_bf16 v[152:155], v[42:45], v[132:135], v[152:155]
    v_mul_f32 v215, s37, v215
    v_cvt_pk_bf16_f32 v136, v212, v213
    v_mfma_f32_16x16x32_bf16 v[216:219], a[4:7], v[164:167], 0
    v_cvt_pk_bf16_f32 v137, v214, v215
    v_mul_f32 v185, v185, v197
    v_mfma_f32_16x16x32_bf16 v[216:219], a[16:19], v[168:171], v[216:219]
    v_cvt_pk_bf16_f32 v184, v184, v185
    v_mul_f32 v186, v186, v197
    v_mfma_f32_16x16x16_bf16 v[144:147], v[16:17], v[136:137], v[144:147]
    v_mul_f32 v187, v187, v197
    v_cvt_pk_bf16_f32 v185, v186, v187
    v_mfma_f32_16x16x16_bf16 v[148:151], v[40:41], v[136:137], v[148:151]
    v_mul_f32 v188, v188, v197
    v_mul_f32 v189, v189, v197
    v_mfma_f32_16x16x16_bf16 v[152:155], v[46:47], v[136:137], v[152:155]
    v_cvt_pk_bf16_f32 v186, v188, v189
    v_mul_f32 v190, v190, v197
    v_mfma_f32_16x16x32_bf16 v[212:215], a[8:11], v[164:167], 0
    v_mul_f32 v191, v191, v197
    v_cvt_pk_bf16_f32 v187, v190, v191
    v_mfma_f32_16x16x32_bf16 v[212:215], a[20:23], v[168:171], v[212:215]
    v_mul_f32 v192, v192, v197
    v_mul_f32 v193, v193, v197
    v_mfma_f32_16x16x32_bf16 v[220:223], a[24:27], v[248:251], v[220:223]
    v_cvt_pk_bf16_f32 v188, v192, v193
    v_mul_f32 v194, v194, v197
    v_mfma_f32_16x16x32_bf16 v[220:223], a[36:39], a[236:239], v[220:223]
    v_mul_f32 v195, v195, v197
    v_cvt_pk_bf16_f32 v189, v194, v195
    v_mfma_f32_16x16x32_bf16 v[216:219], a[28:31], v[248:251], v[216:219]
    v_max3_f32 v236, v236, v196, v197
    v_mfma_f32_16x16x32_bf16 v[216:219], a[40:43], a[236:239], v[216:219]
    ds_write_b128 v237, v[184:187] offset:18432
    v_mfma_f32_16x16x32_bf16 v[212:215], a[32:35], v[248:251], v[212:215]
    ds_write_b64 v238, v[188:189] offset:18432
    v_mfma_f32_16x16x32_bf16 v[212:215], a[44:47], a[236:239], v[212:215]
    s_waitcnt lgkmcnt(2)
    v_exp_f32 v144, v144
    v_mfma_f32_16x16x32_bf16 v[220:223], a[48:51], a[240:243], v[220:223]
    v_exp_f32 v145, v145
    v_mfma_f32_16x16x32_bf16 v[220:223], a[60:63], a[244:247], v[220:223]
    v_exp_f32 v146, v146
    v_mfma_f32_16x16x32_bf16 v[216:219], a[52:55], a[240:243], v[216:219]
    v_exp_f32 v147, v147
    v_mfma_f32_16x16x32_bf16 v[216:219], a[64:67], a[244:247], v[216:219]
    v_cvt_pk_bf16_f32 v156, v144, v145
    v_cvt_pk_bf16_f32 v157, v146, v147
    v_mfma_f32_16x16x32_bf16 v[212:215], a[56:59], a[240:243], v[212:215]
    ds_read_b128 v[144:147], v228 offset:1280
    v_cvt_pk_bf16_f32 v6, v220, v221
    v_mfma_f32_16x16x32_bf16 v[212:215], a[68:71], a[244:247], v[212:215]
    v_cvt_pk_bf16_f32 v7, v222, v223
    v_mfma_f32_16x16x32_bf16 v[220:223], v[164:167], a[72:75], 0
    v_cvt_pk_bf16_f32 v8, v216, v217
    v_cvt_pk_bf16_f32 v9, v218, v219
    v_mfma_f32_16x16x32_bf16 v[220:223], v[168:171], a[84:87], v[220:223]
    v_exp_f32 v148, v148
    v_mfma_f32_16x16x32_bf16 v[216:219], v[164:167], a[76:79], 0
    v_exp_f32 v149, v149
    v_mfma_f32_16x16x32_bf16 v[216:219], v[168:171], a[88:91], v[216:219]
    v_cvt_pk_bf16_f32 v10, v212, v213
    v_cvt_pk_bf16_f32 v11, v214, v215
    v_mfma_f32_16x16x32_bf16 v[212:215], v[164:167], a[80:83], 0
    ds_read_b128 v[164:167], v224 offset:18560
    v_cvt_pk_bf16_f32 v158, v148, v149
    v_mfma_f32_16x16x32_bf16 v[212:215], v[168:171], a[92:95], v[212:215]
    s_waitcnt lgkmcnt(1)
    ds_read_b128 v[168:171], v224 offset:18624
    v_mfma_f32_16x16x32_bf16 v[144:147], v[18:21], v[132:135], v[144:147]
    v_exp_f32 v150, v150
    v_mfma_f32_16x16x32_bf16 v[220:223], v[248:251], a[96:99], v[220:223]
    v_exp_f32 v151, v151
    v_mfma_f32_16x16x32_bf16 v[220:223], a[236:239], a[108:111], v[220:223]
    v_cvt_pk_bf16_f32 v159, v150, v151
    v_mfma_f32_16x16x32_bf16 v[216:219], v[248:251], a[100:103], v[216:219]
    ds_read_b128 v[148:151], v228 offset:1920
    v_mfma_f32_16x16x32_bf16 v[216:219], a[236:239], a[112:115], v[216:219]
    v_exp_f32 v152, v152
    v_mfma_f32_16x16x32_bf16 v[196:199], a[216:219], v[156:159], 0
    v_exp_f32 v153, v153
    v_mfma_f32_16x16x32_bf16 v[184:187], v[74:77], v[156:159], 0
    v_exp_f32 v154, v154
    v_mfma_f32_16x16x32_bf16 v[188:191], v[96:99], v[156:159], 0
    v_exp_f32 v155, v155
    v_mfma_f32_16x16x32_bf16 v[192:195], v[118:121], v[156:159], 0
    v_cvt_pk_bf16_f32 v156, v152, v153
    v_cvt_pk_bf16_f32 v157, v154, v155
    v_mfma_f32_16x16x16_bf16 v[144:147], v[22:23], v[136:137], v[144:147]
    ds_read_b128 v[152:155], v229 offset:1920
    v_mfma_f32_16x16x32_bf16 v[212:215], v[248:251], a[104:107], v[212:215]
    ds_read_b128 v[248:251], v224 offset:18688
    v_mfma_f32_16x16x32_bf16 v[212:215], a[236:239], a[116:119], v[212:215]
    s_waitcnt lgkmcnt(2)
    ds_read_b128 a[236:239], v224 offset:18752
    v_mfma_f32_16x16x32_bf16 v[148:151], v[0:3], v[132:135], v[148:151]
    v_mfma_f32_16x16x32_bf16 v[220:223], a[240:243], a[120:123], v[220:223]
    v_mfma_f32_16x16x32_bf16 v[220:223], a[244:247], a[132:135], v[220:223]
    v_exp_f32 v144, v144
    v_mfma_f32_16x16x32_bf16 v[216:219], a[240:243], a[124:127], v[216:219]
    v_exp_f32 v145, v145
    v_mfma_f32_16x16x32_bf16 v[216:219], a[244:247], a[136:139], v[216:219]
    v_exp_f32 v146, v146
    v_mfma_f32_16x16x16_bf16 v[148:151], v[4:5], v[136:137], v[148:151]
    s_waitcnt lgkmcnt(2)
    v_mov_b32 v5, s25
    v_cvt_pk_bf16_f32 v158, v144, v145
    v_mfma_f32_16x16x32_bf16 v[152:155], v[24:27], v[132:135], v[152:155]
    v_cvt_pk_bf16_f32 v72, v220, v221
    v_cvt_pk_bf16_f32 v73, v222, v223
    v_mfma_f32_16x16x32_bf16 v[212:215], a[240:243], a[128:131], v[212:215]
    v_cvt_pk_bf16_f32 v94, v216, v217
    v_cvt_pk_bf16_f32 v95, v218, v219
    v_mfma_f32_16x16x32_bf16 v[212:215], a[244:247], a[140:143], v[212:215]
    ds_read_b128 a[240:243], v224 offset:18816
    ds_read_b128 a[244:247], v224 offset:18880
    v_mfma_f32_16x16x16_bf16 v[152:155], v[28:29], v[136:137], v[152:155]
    v_cndmask_b32 v224, v239, v240, vcc
    v_mfma_f32_16x16x32_bf16 v[208:211], v[252:255], a[248:251], v[208:211]
    v_exp_f32 v147, v147
    v_mfma_f32_16x16x32_bf16 v[200:203], v[252:255], a[252:255], v[200:203]
    ds_read_b128 v[252:255], v242 offset:36864
    v_cvt_pk_bf16_f32 v116, v212, v213
    v_mfma_f32_16x16x32_bf16 v[204:207], v[160:163], a[248:251], v[204:207]
    v_cvt_pk_bf16_f32 v117, v214, v215
    v_cvt_pk_bf16_f32 v159, v146, v147
    v_mfma_f32_16x16x32_bf16 v[180:183], v[160:163], a[252:255], v[180:183]
    ds_read_b128 v[144:147], v229 offset:2560
    v_mfma_f32_16x16x32_bf16 v[196:199], a[216:219], v[156:159], v[196:199]
    ds_read_b128 v[160:163], v242 offset:37376
    v_mfma_f32_16x16x32_bf16 v[184:187], v[78:81], v[156:159], v[184:187]
    ds_read_b128 a[252:255], v240 offset:4096
    v_mfma_f32_16x16x32_bf16 v[188:191], v[100:103], v[156:159], v[188:191]
    v_exp_f32 v148, v148
    v_mfma_f32_16x16x32_bf16 v[192:195], v[122:125], v[156:159], v[192:195]
    s_waitcnt lgkmcnt(3)
    v_exp_f32 v149, v149
    v_mfma_f32_16x16x32_bf16 v[176:179], v[252:255], a[248:251], v[176:179]
    ds_read_b128 v[252:255], v242 offset:61440
    v_cvt_pk_bf16_f32 v156, v148, v149
    v_mfma_f32_16x16x32_bf16 v[220:223], a[0:3], v[164:167], 0
    v_exp_f32 v150, v150
    v_mfma_f32_16x16x32_bf16 v[220:223], a[12:15], v[168:171], v[220:223]
    v_exp_f32 v151, v151
    v_mfma_f32_16x16x32_bf16 v[216:219], a[4:7], v[164:167], 0
    ds_read_b128 a[0:3], v241 offset:12288
    v_cvt_pk_bf16_f32 v157, v150, v151
    v_mfma_f32_16x16x32_bf16 v[216:219], a[16:19], v[168:171], v[216:219]
    s_waitcnt lgkmcnt(3)
    ds_read_b128 v[148:151], v228 offset:2560
    v_mfma_f32_16x16x32_bf16 v[172:175], v[160:163], a[248:251], v[172:175]
    ds_read_b128 a[248:251], v239 offset:4096
    v_mfma_f32_16x16x32_bf16 v[212:215], a[8:11], v[164:167], 0
    ds_read_b128 v[160:163], v242 offset:61952
    v_mfma_f32_16x16x32_bf16 v[212:215], a[20:23], v[168:171], v[212:215]
    v_exp_f32 v152, v152
    v_mfma_f32_16x16x32_bf16 v[220:223], a[24:27], v[248:251], v[220:223]
    v_exp_f32 v153, v153
    v_mfma_f32_16x16x32_bf16 v[220:223], a[36:39], a[236:239], v[220:223]
    v_exp_f32 v154, v154
    v_mfma_f32_16x16x32_bf16 v[216:219], a[28:31], v[248:251], v[216:219]
    v_exp_f32 v155, v155
    v_mfma_f32_16x16x32_bf16 v[216:219], a[40:43], a[236:239], v[216:219]
    s_waitcnt lgkmcnt(2)
    v_cvt_pk_bf16_f32 v158, v152, v153
    v_cvt_pk_bf16_f32 v159, v154, v155
    v_mfma_f32_16x16x32_bf16 v[148:151], v[6:9], v[132:135], v[148:151]
    ds_read_b128 v[152:155], v230 offset:640
    v_mov_b32 v6, 0x27e00
    v_mfma_f32_16x16x32_bf16 v[196:199], a[216:219], v[156:159], v[196:199]
    ds_read_b128 a[4:7], v241 offset:12800
    v_mfma_f32_16x16x32_bf16 v[184:187], v[66:69], v[156:159], v[184:187]
    ds_read_b128 a[8:11], v242 offset:12288
    v_mfma_f32_16x16x32_bf16 v[188:191], v[88:91], v[156:159], v[188:191]
    ds_read_b128 a[12:15], v242 offset:12800
    v_mfma_f32_16x16x32_bf16 v[192:195], v[110:113], v[156:159], v[192:195]
    ds_read_b128 a[16:19], v241 offset:24576
    v_mfma_f32_16x16x16_bf16 v[148:151], v[10:11], v[136:137], v[148:151]
    ds_read_b128 a[20:23], v241 offset:25088
    v_mfma_f32_16x16x32_bf16 v[212:215], a[32:35], v[248:251], v[212:215]
    ds_read_b128 a[24:27], v242 offset:24576
    v_mfma_f32_16x16x32_bf16 v[212:215], a[44:47], a[236:239], v[212:215]
    ds_read_b128 a[28:31], v242 offset:25088
    v_mfma_f32_16x16x32_bf16 v[220:223], a[48:51], a[240:243], v[220:223]
    ds_read_b128 a[32:35], v241 offset:36864
    v_mfma_f32_16x16x32_bf16 v[220:223], a[60:63], a[244:247], v[220:223]
    v_exp_f32 v148, v148
    v_mfma_f32_16x16x32_bf16 v[216:219], a[52:55], a[240:243], v[216:219]
    v_exp_f32 v149, v149
    v_mfma_f32_16x16x32_bf16 v[216:219], a[64:67], a[244:247], v[216:219]
    v_exp_f32 v150, v150
    v_mfma_f32_16x16x32_bf16 v[212:215], a[56:59], a[240:243], v[212:215]
    v_exp_f32 v151, v151
    v_mfma_f32_16x16x32_bf16 v[212:215], a[68:71], a[244:247], v[212:215]
    v_cvt_pk_bf16_f32 v30, v220, v221
    v_cvt_pk_bf16_f32 v31, v222, v223
    v_mfma_f32_16x16x32_bf16 v[220:223], v[164:167], a[72:75], 0
    v_cvt_pk_bf16_f32 v158, v148, v149
    v_cvt_pk_bf16_f32 v32, v216, v217
    v_mfma_f32_16x16x32_bf16 v[220:223], v[168:171], a[84:87], v[220:223]
    v_cvt_pk_bf16_f32 v33, v218, v219
    v_cvt_pk_bf16_f32 v159, v150, v151
    v_mfma_f32_16x16x32_bf16 v[216:219], v[164:167], a[76:79], 0
    ds_read_b128 v[148:151], v230 offset:1920
    v_cvt_pk_bf16_f32 v34, v212, v213
    v_mfma_f32_16x16x32_bf16 v[216:219], v[168:171], a[88:91], v[216:219]
    ds_read_b128 a[36:39], v241 offset:37376
    v_cvt_pk_bf16_f32 v35, v214, v215
    v_mfma_f32_16x16x32_bf16 v[144:147], v[30:33], v[132:135], v[144:147]
    ds_read_b128 a[40:43], v242 offset:36864
    v_mfma_f32_16x16x32_bf16 v[212:215], v[164:167], a[80:83], 0
    ds_read_b128 v[164:167], v232 offset:4224
    v_mfma_f32_16x16x32_bf16 v[212:215], v[168:171], a[92:95], v[212:215]
    ds_read_b128 v[168:171], v232 offset:4288
    v_mfma_f32_16x16x32_bf16 v[220:223], v[248:251], a[96:99], v[220:223]
    ds_read_b128 a[44:47], v242 offset:37376
    v_mfma_f32_16x16x32_bf16 v[220:223], a[236:239], a[108:111], v[220:223]
    ds_read_b128 a[48:51], v241 offset:49152
    v_mfma_f32_16x16x16_bf16 v[144:147], v[34:35], v[136:137], v[144:147]
    ds_read_b128 a[52:55], v241 offset:49664
    v_mfma_f32_16x16x32_bf16 v[216:219], v[248:251], a[100:103], v[216:219]
    ds_read_b128 a[56:59], v242 offset:49152
    v_mfma_f32_16x16x32_bf16 v[216:219], a[236:239], a[112:115], v[216:219]
    ds_read_b128 a[60:63], v242 offset:49664
    v_mfma_f32_16x16x32_bf16 v[212:215], v[248:251], a[104:107], v[212:215]
    ds_read_b128 v[248:251], v232 offset:4352
    v_mfma_f32_16x16x32_bf16 v[212:215], a[236:239], a[116:119], v[212:215]
    ds_read_b128 a[236:239], v232 offset:4416
    v_mfma_f32_16x16x32_bf16 v[220:223], a[240:243], a[120:123], v[220:223]
    v_exp_f32 v144, v144
    v_mfma_f32_16x16x32_bf16 v[220:223], a[244:247], a[132:135], v[220:223]
    v_exp_f32 v145, v145
    v_mfma_f32_16x16x32_bf16 v[216:219], a[240:243], a[124:127], v[216:219]
    v_exp_f32 v146, v146
    v_mfma_f32_16x16x32_bf16 v[216:219], a[244:247], a[136:139], v[216:219]
    v_exp_f32 v147, v147
    v_mfma_f32_16x16x32_bf16 v[212:215], a[240:243], a[128:131], v[212:215]
    ds_read_b128 a[240:243], v232 offset:4480
    v_cvt_pk_bf16_f32 v156, v144, v145
    v_mfma_f32_16x16x32_bf16 v[212:215], a[244:247], a[140:143], v[212:215]
    s_waitcnt lgkmcnt(4)
    v_cvt_pk_bf16_f32 v70, v220, v221
    v_cvt_pk_bf16_f32 v71, v222, v223
    v_mfma_f32_16x16x32_bf16 v[208:211], a[48:51], a[248:251], v[208:211]
    v_cvt_pk_bf16_f32 v92, v216, v217
    v_cvt_pk_bf16_f32 v93, v218, v219
    v_mfma_f32_16x16x32_bf16 v[200:203], a[48:51], a[252:255], v[200:203]
    ds_read_b128 a[244:247], v232 offset:4544
    v_cvt_pk_bf16_f32 v157, v146, v147
    v_mfma_f32_16x16x32_bf16 v[204:207], a[52:55], a[248:251], v[204:207]
    ds_read_b128 v[144:147], v230 offset:1280
    v_cvt_pk_bf16_f32 v114, v212, v213
    v_mfma_f32_16x16x32_bf16 v[196:199], a[216:219], v[156:159], v[196:199]
    ds_read_b128 a[64:67], v241 offset:61440
    v_cvt_pk_bf16_f32 v115, v214, v215
    v_mfma_f32_16x16x32_bf16 v[184:187], v[70:73], v[156:159], v[184:187]
    ds_read_b128 a[68:71], v241 offset:61952
    v_mfma_f32_16x16x32_bf16 v[188:191], v[92:95], v[156:159], v[188:191]
    v_mfma_f32_16x16x32_bf16 v[192:195], v[114:117], v[156:159], v[192:195]
    v_mfma_f32_16x16x32_bf16 v[180:183], a[52:55], a[252:255], v[180:183]
    ds_read_b128 a[252:255], v240 offset:5120
    v_mfma_f32_16x16x32_bf16 v[176:179], a[56:59], a[248:251], v[176:179]
    s_waitcnt lgkmcnt(5)
    v_rcp_f32 v197, v196
    v_mfma_f32_16x16x32_bf16 v[172:175], a[60:63], a[248:251], v[172:175]
    ds_read_b128 a[248:251], v239 offset:5120
    v_mul_f32 v184, v184, v197
    v_mfma_f32_16x16x32_bf16 v[220:223], a[144:147], v[164:167], 0
    v_mul_f32 v185, v185, v197
    v_cvt_pk_bf16_f32 v184, v184, v185
    v_mfma_f32_16x16x32_bf16 v[220:223], a[156:159], v[168:171], v[220:223]
    v_mul_f32 v186, v186, v197
    v_mul_f32 v187, v187, v197
    v_mfma_f32_16x16x32_bf16 v[216:219], a[148:151], v[164:167], 0
    v_cvt_pk_bf16_f32 v185, v186, v187
    v_mul_f32 v188, v188, v197
    v_mfma_f32_16x16x32_bf16 v[216:219], a[160:163], v[168:171], v[216:219]
    v_mul_f32 v189, v189, v197
    v_cvt_pk_bf16_f32 v186, v188, v189
    v_mfma_f32_16x16x32_bf16 v[212:215], a[152:155], v[164:167], 0
    v_mul_f32 v190, v190, v197
    v_mul_f32 v191, v191, v197
    v_mfma_f32_16x16x32_bf16 v[212:215], a[164:167], v[168:171], v[212:215]
    s_waitcnt lgkmcnt(0)
    v_cvt_pk_bf16_f32 v187, v190, v191
    v_mul_f32 v192, v192, v197
    v_mfma_f32_16x16x32_bf16 v[220:223], a[168:171], v[248:251], v[220:223]
    s_barrier
    ds_read_b128 v[164:167], v240 offset:13312
    ds_read_b128 v[168:171], v239 offset:14336
    v_mfma_f32_16x16x32_bf16 v[220:223], a[180:183], a[236:239], v[220:223]
    v_mul_f32 v193, v193, v197
    v_cvt_pk_bf16_f32 v188, v192, v193
    v_mfma_f32_16x16x32_bf16 v[216:219], a[172:175], v[248:251], v[216:219]
    v_mul_f32 v194, v194, v197
    v_mul_f32 v195, v195, v197
    v_mfma_f32_16x16x32_bf16 v[216:219], a[184:187], a[236:239], v[216:219]
    v_cvt_pk_bf16_f32 v189, v194, v195
    v_max3_f32 v236, v236, v196, v197
    v_mfma_f32_16x16x32_bf16 v[212:215], a[176:179], v[248:251], v[212:215]
    ds_read_b128 v[248:251], v240 offset:14336
    v_mfma_f32_16x16x32_bf16 v[212:215], a[188:191], a[236:239], v[212:215]
    ds_read_b128 a[236:239], v239 offset:12288
    v_mfma_f32_16x16x32_bf16 v[220:223], a[192:195], a[240:243], v[220:223]
    ds_write_b128 v237, v[184:187]
    v_mfma_f32_16x16x32_bf16 v[220:223], a[204:207], a[244:247], v[220:223]
    ds_write_b64 v238, v[188:189]
    v_mfma_f32_16x16x32_bf16 v[216:219], a[196:199], a[240:243], v[216:219]
    v_mfma_f32_16x16x32_bf16 v[216:219], a[208:211], a[244:247], v[216:219]
    v_mfma_f32_16x16x32_bf16 v[212:215], a[200:203], a[240:243], v[212:215]
    v_mfma_f32_16x16x32_bf16 v[212:215], a[212:215], a[244:247], v[212:215]
    ds_read_b128 a[240:243], v240 offset:12288
    ds_read_b128 a[244:247], v239 offset:13312
    v_mfma_f32_16x16x32_bf16 v[208:211], a[64:67], a[248:251], v[208:211]
    v_mul_f32 v220, s37, v220
    v_mul_f32 v221, s37, v221
    v_mfma_f32_16x16x32_bf16 v[200:203], a[64:67], a[252:255], v[200:203]
    v_mul_f32 v222, s37, v222
    v_mul_f32 v223, s37, v223
    v_mfma_f32_16x16x32_bf16 v[204:207], a[68:71], a[248:251], v[204:207]
    v_cvt_pk_bf16_f32 v138, v220, v221
    v_cvt_pk_bf16_f32 v139, v222, v223
    v_mfma_f32_16x16x32_bf16 v[180:183], a[68:71], a[252:255], v[180:183]
    v_mul_f32 v216, s37, v216
    v_mul_f32 v217, s37, v217
    v_mfma_f32_16x16x32_bf16 v[176:179], v[252:255], a[248:251], v[176:179]
    s_waitcnt lgkmcnt(2)
    v_mul_f32 v218, s37, v218
    v_mul_f32 v219, s37, v219
    v_mfma_f32_16x16x32_bf16 v[172:175], v[160:163], a[248:251], v[172:175]
    s_barrier
    v_cvt_pk_bf16_f32 v140, v216, v217
    v_cvt_pk_bf16_f32 v141, v218, v219
    v_mfma_f32_16x16x32_bf16 v[220:223], a[220:223], a[236:239], 0
    v_mul_f32 v212, s37, v212
    v_mul_f32 v213, s37, v213
    v_mfma_f32_16x16x32_bf16 v[152:155], v[36:39], v[138:141], v[152:155]
    v_mul_f32 v214, s37, v214
    v_mul_f32 v215, s37, v215
    v_mfma_f32_16x16x32_bf16 v[144:147], v[42:45], v[138:141], v[144:147]
    v_cvt_pk_bf16_f32 v142, v212, v213
    v_cvt_pk_bf16_f32 v143, v214, v215
    v_mfma_f32_16x16x32_bf16 v[148:151], v[24:27], v[138:141], v[148:151]
    ds_read_b128 a[248:251], v239 offset:15360
    ds_read_b128 a[252:255], v240 offset:15360
    v_mfma_f32_16x16x16_bf16 v[152:155], v[40:41], v[142:143], v[152:155]
    ds_read_b128 v[252:255], v242 offset:61440
    v_cvt_pk_bf16_f32 v208, v208, v209
    v_mfma_f32_16x16x16_bf16 v[144:147], v[46:47], v[142:143], v[144:147]
    ds_read_b128 v[160:163], v242 offset:61952
    v_cvt_pk_bf16_f32 v209, v210, v211
    v_mfma_f32_16x16x16_bf16 v[148:151], v[28:29], v[142:143], v[148:151]
    s_waitcnt lgkmcnt(4)
    v_cvt_pk_bf16_f32 v210, v204, v205
    v_cvt_pk_bf16_f32 v211, v206, v207
    v_mfma_f32_16x16x32_bf16 v[212:215], a[220:223], a[240:243], 0
    buffer_store_dwordx4 v[208:211], v243, s[20:23], s51 offen sc0 sc1
    v_mfma_f32_16x16x32_bf16 v[216:219], a[224:227], a[236:239], 0
    v_cvt_pk_bf16_f32 v200, v200, v201
    v_cvt_pk_bf16_f32 v201, v202, v203
    v_mfma_f32_16x16x32_bf16 v[208:211], a[224:227], a[240:243], 0
    ds_read_b128 a[240:243], v240 offset:16384
    v_cvt_pk_bf16_f32 v202, v180, v181
    v_mfma_f32_16x16x32_bf16 v[204:207], a[228:231], a[236:239], 0
    v_cvt_pk_bf16_f32 v203, v182, v183
    v_cvt_pk_bf16_f32 v176, v176, v177
    v_mfma_f32_16x16x32_bf16 v[220:223], a[0:3], a[244:247], v[220:223]
    v_cvt_pk_bf16_f32 v177, v178, v179
    v_cvt_pk_bf16_f32 v178, v172, v173
    v_mfma_f32_16x16x32_bf16 v[212:215], a[0:3], v[164:167], v[212:215]
    v_cvt_pk_bf16_f32 v179, v174, v175
    v_mfma_f32_16x16x32_bf16 v[216:219], a[4:7], a[244:247], v[216:219]
    v_exp_f32 v152, v152
    v_mfma_f32_16x16x32_bf16 v[208:211], a[4:7], v[164:167], v[208:211]
    ds_read_b128 v[164:167], v240 offset:17408
    v_mfma_f32_16x16x32_bf16 v[204:207], a[8:11], a[244:247], v[204:207]
    v_exp_f32 v153, v153
    v_mfma_f32_16x16x32_bf16 v[220:223], a[16:19], v[168:171], v[220:223]
    v_exp_f32 v154, v154
    v_mfma_f32_16x16x32_bf16 v[212:215], a[16:19], v[248:251], v[212:215]
    v_exp_f32 v155, v155
    v_mfma_f32_16x16x32_bf16 v[216:219], a[20:23], v[168:171], v[216:219]
    v_cvt_pk_bf16_f32 v156, v152, v153
    v_cvt_pk_bf16_f32 v157, v154, v155
    v_mfma_f32_16x16x32_bf16 v[208:211], a[20:23], v[248:251], v[208:211]
    ds_read_b128 v[152:155], v230 offset:2560
    v_mfma_f32_16x16x32_bf16 v[204:207], a[24:27], v[168:171], v[204:207]
    s_waitcnt lgkmcnt(2)
    ds_read_b128 v[248:251], v224 offset:1024
    v_mfma_f32_16x16x32_bf16 v[220:223], a[32:35], a[248:251], v[220:223]
    buffer_store_dwordx4 v[200:203], v245, s[20:23], s51 offen sc0 sc1
    v_mfma_f32_16x16x32_bf16 v[212:215], a[32:35], a[252:255], v[212:215]
    v_exp_f32 v144, v144
    v_mfma_f32_16x16x32_bf16 v[200:203], a[232:235], a[236:239], 0
    ds_read_b128 a[236:239], v239 offset:16384
    v_mfma_f32_16x16x32_bf16 v[200:203], a[12:15], a[244:247], v[200:203]
    ds_read_b128 a[244:247], v239 offset:17408
    v_mfma_f32_16x16x32_bf16 v[200:203], a[28:31], v[168:171], v[200:203]
    s_waitcnt lgkmcnt(3)
    ds_read_b128 v[168:171], v224
    v_mfma_f32_16x16x32_bf16 v[152:155], v[30:33], v[138:141], v[152:155]
    v_exp_f32 v145, v145
    v_mfma_f32_16x16x32_bf16 v[216:219], a[36:39], a[248:251], v[216:219]
    v_exp_f32 v146, v146
    v_mfma_f32_16x16x32_bf16 v[208:211], a[36:39], a[252:255], v[208:211]
    ds_read_b128 a[252:255], v224 offset:3072
    v_cvt_pk_bf16_f32 v158, v144, v145
    v_mfma_f32_16x16x16_bf16 v[152:155], v[34:35], v[142:143], v[152:155]
    v_exp_f32 v147, v147
    v_mfma_f32_16x16x32_bf16 v[204:207], a[40:43], a[248:251], v[204:207]
    v_cvt_pk_bf16_f32 v159, v146, v147
    v_mfma_f32_16x16x32_bf16 v[200:203], a[44:47], a[248:251], v[200:203]
    ds_read_b128 v[144:147], v235
    v_mfma_f32_16x16x32_bf16 v[196:199], a[216:219], v[156:159], 0
    ds_read_b128 a[248:251], v224 offset:2048
    v_mfma_f32_16x16x32_bf16 v[184:187], v[76:79], v[156:159], 0
    buffer_store_dwordx4 v[176:179], v244, s[20:23], s51 offen sc0 sc1
    v_mfma_f32_16x16x32_bf16 v[188:191], v[98:101], v[156:159], 0
    s_add_u32 s51, s51, s48
    v_exp_f32 v148, v148
    v_mfma_f32_16x16x32_bf16 v[192:195], v[120:123], v[156:159], 0
    s_waitcnt lgkmcnt(3)
    v_exp_f32 v149, v149
    v_mfma_f32_16x16x32_bf16 v[220:223], a[48:51], a[236:239], v[220:223]
    v_exp_f32 v150, v150
    v_mfma_f32_16x16x32_bf16 v[212:215], a[48:51], a[240:243], v[212:215]
    s_waitcnt lgkmcnt(1)
    v_exp_f32 v151, v151
    v_mfma_f32_16x16x32_bf16 v[144:147], v[54:57], v[138:141], v[144:147]
    v_cvt_pk_bf16_f32 v156, v148, v149
    v_cvt_pk_bf16_f32 v157, v150, v151
    v_mfma_f32_16x16x32_bf16 v[216:219], a[52:55], a[236:239], v[216:219]
    ds_read_b128 v[148:151], v234
    v_mfma_f32_16x16x32_bf16 v[208:211], a[52:55], a[240:243], v[208:211]
    ds_read_b128 a[240:243], v224 offset:5120
    v_mfma_f32_16x16x16_bf16 v[144:147], v[58:59], v[142:143], v[144:147]
    v_exp_f32 v152, v152
    v_mfma_f32_16x16x32_bf16 v[204:207], a[56:59], a[236:239], v[204:207]
    v_exp_f32 v153, v153
    v_mfma_f32_16x16x32_bf16 v[200:203], a[60:63], a[236:239], v[200:203]
    ds_read_b128 a[236:239], v224 offset:4096
    v_cvt_pk_bf16_f32 v158, v152, v153
    v_mfma_f32_16x16x32_bf16 v[220:223], a[64:67], a[244:247], v[220:223]
    v_exp_f32 v154, v154
    v_mfma_f32_16x16x32_bf16 v[212:215], a[64:67], v[164:167], v[212:215]
L_pg8:
    s_cbranch_execz L_back
    v_exp_f32 v155, v155
    v_mfma_f32_16x16x32_bf16 v[216:219], a[68:71], a[244:247], v[216:219]
    s_waitcnt lgkmcnt(2)
    v_cvt_pk_bf16_f32 v159, v154, v155
    v_mfma_f32_16x16x32_bf16 v[148:151], v[48:51], v[138:141], v[148:151]
    v_exp_f32 v144, v144
    v_mfma_f32_16x16x32_bf16 v[196:199], a[216:219], v[156:159], v[196:199]
    v_cvt_pk_bf16_f32 v220, v220, v221
    v_cvt_pk_bf16_f32 v221, v222, v223
    v_mfma_f32_16x16x32_bf16 v[184:187], v[68:71], v[156:159], v[184:187]
    v_cvt_pk_bf16_f32 v212, v212, v213
    v_cvt_pk_bf16_f32 v222, v216, v217
    v_mfma_f32_16x16x32_bf16 v[188:191], v[90:93], v[156:159], v[188:191]
    v_cvt_pk_bf16_f32 v223, v218, v219
    v_cvt_pk_bf16_f32 v213, v214, v215
    v_mfma_f32_16x16x32_bf16 v[192:195], v[112:115], v[156:159], v[192:195]
    buffer_store_dwordx4 v[220:223], v243, s[20:23], s51 offen sc0 sc1
    v_mfma_f32_16x16x16_bf16 v[148:151], v[52:53], v[142:143], v[148:151]
    v_exp_f32 v145, v145
    v_mfma_f32_16x16x32_bf16 v[208:211], a[68:71], v[164:167], v[208:211]
    v_exp_f32 v146, v146
    v_mfma_f32_16x16x32_bf16 v[204:207], v[252:255], a[244:247], v[204:207]
    ds_read_b128 v[252:255], v242 offset:61440
    v_cvt_pk_bf16_f32 v156, v144, v145
    v_mfma_f32_16x16x32_bf16 v[200:203], v[160:163], a[244:247], v[200:203]
    ds_read_b128 v[160:163], v242 offset:61952
    v_mfma_f32_16x16x32_bf16 v[180:183], a[220:223], v[168:171], 0
    v_exp_f32 v147, v147
    v_mfma_f32_16x16x32_bf16 v[180:183], a[0:3], v[248:251], v[180:183]
    v_cvt_pk_bf16_f32 v214, v208, v209
    v_cvt_pk_bf16_f32 v215, v210, v211
    v_mfma_f32_16x16x32_bf16 v[180:183], a[16:19], a[248:251], v[180:183]
    v_cvt_pk_bf16_f32 v204, v204, v205
    v_cvt_pk_bf16_f32 v205, v206, v207
    v_mfma_f32_16x16x32_bf16 v[180:183], a[32:35], a[252:255], v[180:183]
    s_waitcnt lgkmcnt(2)
    v_cvt_pk_bf16_f32 v206, v200, v201
    v_cvt_pk_bf16_f32 v207, v202, v203
    v_mfma_f32_16x16x32_bf16 v[180:183], a[48:51], a[236:239], v[180:183]
    v_cvt_pk_bf16_f32 v157, v146, v147
    v_mfma_f32_16x16x32_bf16 v[180:183], a[64:67], a[240:243], v[180:183]
    v_exp_f32 v148, v148
    v_mfma_f32_16x16x32_bf16 v[176:179], a[224:227], v[168:171], 0
    v_exp_f32 v149, v149
    v_mfma_f32_16x16x32_bf16 v[176:179], a[4:7], v[248:251], v[176:179]
    buffer_store_dwordx4 v[212:215], v245, s[20:23], s51 offen sc0 sc1
    v_mfma_f32_16x16x32_bf16 v[176:179], a[20:23], a[248:251], v[176:179]
    v_exp_f32 v150, v150
    v_mfma_f32_16x16x32_bf16 v[176:179], a[36:39], a[252:255], v[176:179]
    v_cvt_pk_bf16_f32 v180, v180, v181
    v_cvt_pk_bf16_f32 v181, v182, v183
    v_mfma_f32_16x16x32_bf16 v[176:179], a[52:55], a[236:239], v[176:179]
    v_exp_f32 v151, v151
    v_mfma_f32_16x16x32_bf16 v[176:179], a[68:71], a[240:243], v[176:179]
    v_cvt_pk_bf16_f32 v158, v148, v149
    v_cvt_pk_bf16_f32 v159, v150, v151
    v_mfma_f32_16x16x32_bf16 v[172:175], a[228:231], v[168:171], 0
    v_mfma_f32_16x16x32_bf16 v[172:175], a[8:11], v[248:251], v[172:175]
    v_mfma_f32_16x16x32_bf16 v[172:175], a[24:27], a[248:251], v[172:175]
    v_mfma_f32_16x16x32_bf16 v[172:175], a[40:43], a[252:255], v[172:175]
    v_mfma_f32_16x16x32_bf16 v[172:175], a[56:59], a[236:239], v[172:175]
    v_mfma_f32_16x16x32_bf16 v[196:199], a[216:219], v[156:159], v[196:199]
    v_cvt_pk_bf16_f32 v182, v176, v177
    v_cvt_pk_bf16_f32 v183, v178, v179
    v_mfma_f32_16x16x32_bf16 v[184:187], v[82:85], v[156:159], v[184:187]
    v_mfma_f32_16x16x32_bf16 v[188:191], v[104:107], v[156:159], v[188:191]
    s_waitcnt lgkmcnt(0)
    buffer_store_dwordx4 v[204:207], v244, s[20:23], s51 offen sc0 sc1
    v_mfma_f32_16x16x32_bf16 v[192:195], v[126:129], v[156:159], v[192:195]
    s_add_u32 s51, s51, s48
    v_mfma_f32_16x16x32_bf16 v[172:175], v[252:255], a[240:243], v[172:175]
    v_rcp_f32 v197, v196
    v_mfma_f32_16x16x32_bf16 v[220:223], a[232:235], v[168:171], 0
    v_max3_f32 v236, v236, v196, v197
    v_mul_f32 v184, v184, v197
    v_mfma_f32_16x16x32_bf16 v[220:223], a[12:15], v[248:251], v[220:223]
    v_mul_f32 v185, v185, v197
    v_cvt_pk_bf16_f32 v184, v184, v185
    v_mfma_f32_16x16x32_bf16 v[220:223], a[28:31], a[248:251], v[220:223]
    v_mul_f32 v186, v186, v197
    v_mul_f32 v187, v187, v197
    v_mfma_f32_16x16x32_bf16 v[220:223], a[44:47], a[252:255], v[220:223]
    v_cvt_pk_bf16_f32 v185, v186, v187
    v_mul_f32 v188, v188, v197
    v_mfma_f32_16x16x32_bf16 v[220:223], a[60:63], a[236:239], v[220:223]
    v_mul_f32 v189, v189, v197
    v_cvt_pk_bf16_f32 v186, v188, v189
    v_mfma_f32_16x16x32_bf16 v[220:223], v[160:163], a[240:243], v[220:223]
    v_mul_f32 v190, v190, v197
    v_mul_f32 v191, v191, v197
    v_cvt_pk_bf16_f32 v187, v190, v191
    v_mul_f32 v192, v192, v197
    v_mul_f32 v193, v193, v197
    v_cvt_pk_bf16_f32 v188, v192, v193
    v_mul_f32 v194, v194, v197
    v_mul_f32 v195, v195, v197
    v_cvt_pk_bf16_f32 v189, v194, v195
    ds_write_b128 v237, v[184:187] offset:6144
    ds_write_b64 v238, v[188:189] offset:6144
    v_cmp_lt_f32 vcc, 0x53800000, v236
    buffer_store_dwordx4 v[180:183], v225, s[20:23], s51 offen sc0 sc1
    v_cvt_pk_bf16_f32 v172, v172, v173
    s_or_b32 s24, vcc_lo, vcc_hi
    v_mov_b32 v4, s24
    ds_write_b32 v5, v4
    v_cvt_pk_bf16_f32 v173, v174, v175
    v_cvt_pk_bf16_f32 v174, v220, v221
    v_cvt_pk_bf16_f32 v175, v222, v223
    s_waitcnt lgkmcnt(0)
    s_barrier
    ds_read_b128 a[244:247], v227
    ds_read_b128 v[164:167], v227 offset:1024
    ds_read_b128 v[168:171], v227 offset:2048
    ds_read_b128 v[248:251], v227 offset:3072
    buffer_store_dwordx4 v[172:175], v226, s[20:23], s51 offen sc0 sc1
    ds_read_b128 a[248:251], v227 offset:4096
    ds_read_b128 a[252:255], v227 offset:5120
    ds_read_b128 v[0:3], v6
    s_waitcnt lgkmcnt(6)
    v_mfma_f32_16x16x32_bf16 v[216:219], a[220:223], a[244:247], 0
    s_waitcnt lgkmcnt(5)
    v_mfma_f32_16x16x32_bf16 v[216:219], a[0:3], v[164:167], v[216:219]
    s_waitcnt lgkmcnt(4)
    v_mfma_f32_16x16x32_bf16 v[216:219], a[16:19], v[168:171], v[216:219]
    s_waitcnt lgkmcnt(3)
    v_mfma_f32_16x16x32_bf16 v[216:219], a[32:35], v[248:251], v[216:219]
    s_waitcnt lgkmcnt(2)
    v_mfma_f32_16x16x32_bf16 v[216:219], a[48:51], a[248:251], v[216:219]
    s_waitcnt lgkmcnt(1)
    v_mfma_f32_16x16x32_bf16 v[216:219], a[64:67], a[252:255], v[216:219]
    v_mfma_f32_16x16x32_bf16 v[212:215], a[224:227], a[244:247], 0
    s_waitcnt lgkmcnt(0)
    v_or3_b32 v0, v0, v1, v2
    v_or_b32 v0, v0, v3
    v_mfma_f32_16x16x32_bf16 v[212:215], a[4:7], v[164:167], v[212:215]
    v_readfirstlane_b32 s24, v0
    v_mfma_f32_16x16x32_bf16 v[212:215], a[20:23], v[168:171], v[212:215]
    v_mfma_f32_16x16x32_bf16 v[212:215], a[36:39], v[248:251], v[212:215]
    v_mfma_f32_16x16x32_bf16 v[212:215], a[52:55], a[248:251], v[212:215]
    v_cvt_pk_bf16_f32 v216, v216, v217
    v_cvt_pk_bf16_f32 v217, v218, v219
    v_mfma_f32_16x16x32_bf16 v[212:215], a[68:71], a[252:255], v[212:215]
    v_mfma_f32_16x16x32_bf16 v[208:211], a[228:231], a[244:247], 0
    v_mfma_f32_16x16x32_bf16 v[208:211], a[8:11], v[164:167], v[208:211]
    v_mfma_f32_16x16x32_bf16 v[208:211], a[24:27], v[168:171], v[208:211]
    v_mfma_f32_16x16x32_bf16 v[208:211], a[40:43], v[248:251], v[208:211]
    v_mfma_f32_16x16x32_bf16 v[208:211], a[56:59], a[248:251], v[208:211]
    v_mfma_f32_16x16x32_bf16 v[208:211], v[252:255], a[252:255], v[208:211]
    v_mfma_f32_16x16x32_bf16 v[204:207], a[232:235], a[244:247], 0
    v_mfma_f32_16x16x32_bf16 v[204:207], a[12:15], v[164:167], v[204:207]
    v_cvt_pk_bf16_f32 v218, v212, v213
    v_cvt_pk_bf16_f32 v219, v214, v215
    v_mfma_f32_16x16x32_bf16 v[204:207], a[28:31], v[168:171], v[204:207]
    buffer_store_dwordx4 v[216:219], v246, s[20:23], s51 offen sc0 sc1
    v_mfma_f32_16x16x32_bf16 v[204:207], a[44:47], v[248:251], v[204:207]
    v_mfma_f32_16x16x32_bf16 v[204:207], a[60:63], a[248:251], v[204:207]
    v_cvt_pk_bf16_f32 v208, v208, v209
    v_cvt_pk_bf16_f32 v209, v210, v211
    v_mfma_f32_16x16x32_bf16 v[204:207], v[160:163], a[252:255], v[204:207]
    s_nop 7
    v_cvt_pk_bf16_f32 v210, v204, v205
    v_cvt_pk_bf16_f32 v211, v206, v207
    buffer_store_dwordx4 v[208:211], v247, s[20:23], s51 offen sc0 sc1
    s_nop 1
    s_cmp_lg_u32 s24, 0
    s_cbranch_scc1 L_safe
L_exit:
    s_endpgm
L_end:
L_safe:
    s_waitcnt vmcnt(0) lgkmcnt(0)
    s_barrier
    v_mbcnt_lo_u32_b32 v0, -1, 0
    v_mbcnt_hi_u32_b32 v0, -1, v0
    s_lshl_b32 s24, s36, 6
    v_add_u32 v0, s24, v0
    s_load_dwordx2 s[8:9], s[0:1], 8
    s_load_dwordx2 s[4:5], s[0:1], 0
    s_load_dwordx2 s[16:17], s[0:1], 24
    s_load_dwordx2 s[12:13], s[0:1], 16
    s_load_dwordx2 s[20:21], s[0:1], 32
    v_lshrrev_b32 v74, 6, v0
    v_and_b32 v60, 63, v0
    v_readfirstlane_b32 s36, v74
    v_mul_u32_u24 v76, 0x2aab, v60
    v_lshrrev_b32 v76, 16, v76
    v_mul_u32_u24 v74, 6, v76
    v_sub_u32 v77, v60, v74
    v_lshrrev_b32 v74, 1, v76
    v_and_b32 v74, 4, v74
    v_xor_b32 v76, v76, v74
    v_mul_u32_u24 v74, 0x480, v76
    v_lshl_add_u32 v251, v77, 4, v74
    v_add_u32 v79, 64, v60
    v_mul_u32_u24 v78, 0x2aab, v79
    v_lshrrev_b32 v78, 16, v78
    v_mul_u32_u24 v74, 6, v78
    v_sub_u32 v79, v60, v74
    v_lshrrev_b32 v74, 1, v78
    v_and_b32 v74, 4, v74
    v_xor_b32 v78, v78, v74
    v_mul_u32_u24 v74, 0x480, v78
    v_lshl_add_u32 v252, v79, 4, v74
    v_add_u32 v81, 0x80, v60
    v_mul_u32_u24 v80, 0x2aab, v81
    v_lshrrev_b32 v80, 16, v80
    v_mul_u32_u24 v74, 6, v80
    v_sub_u32 v81, v60, v74
    v_lshrrev_b32 v74, 1, v80
    v_and_b32 v74, 4, v74
    v_xor_b32 v80, v80, v74
    v_mul_u32_u24 v74, 0x480, v80
    v_lshl_add_u32 v253, v81, 4, v74
    s_mul_i32 s49, s36, 0x60
    s_mul_i32 s50, s36, 0xc00
    s_add_u32 s50, s50, 0x15e00
    s_mov_b32 s10, 0x36000
    s_mov_b32 s11, 0x20000
    s_mov_b32 s6, 0x1260400
    s_mov_b32 s7, 0x20000
    s_mov_b32 s18, 0x548
    s_mov_b32 s19, 0x20000
    s_mov_b32 s14, 0x12000
    s_mov_b32 s15, 0x20000
    s_mov_b32 s22, 0x1260000
    s_mov_b32 s23, 0x20000
    s_mul_i32 s58, s36, 0x152
    v_lshlrev_b32 v199, 1, v60
    s_add_u32 s57, s49, 0x180
    s_add_u32 m0, s50, 0
    s_bfe_u32 s35, s2, 0x30003
    s_lshr_b32 s55, s2, 6
    s_and_b32 s54, s2, 1
    s_lshl2_add_u32 s34, s54, s55
    s_and_b32 s46, s55, 1
    s_bfe_u32 s54, s2, 0x10002
    s_mul_i32 s54, s54, 0x15000
    s_bfe_u32 s55, s2, 0x10001
    s_mul_i32 s55, s55, 0x180
    s_add_u32 s38, s54, s55
    s_lshl_b32 s41, s36, 11
    s_min_u32 s41, s41, 0x1600
    s_mul_i32 s54, s35, 14
    s_sub_u32 s54, s54, 3
    s_movk_i32 s53, 0x6f
    s_lshr_b32 s55, s41, 4
    v_add_u32 v99, s55, v60
    v_mov_b32 v100, 0x8000
    v_mul_u32_u24 v97, 0xaab, v99
    v_lshrrev_b32 v97, 16, v97
    v_mul_u32_u24 v98, 24, v97
    v_sub_u32 v96, v99, v98
    v_and_or_b32 v98, 2, v97, 64
    v_xor_b32 v96, v96, v98
    v_add_u32 v97, s54, v97
    v_cmp_lt_u32 vcc, s53, v97
    v_add_u32 v99, 64, v99
    s_mul_i32 s51, s34, 0x24c000
    v_cndmask_b32 v97, v97, v100, vcc
    v_mul_u32_u24 v97, 0x300, v97
    v_lshl_add_u32 v246, v96, 4, v97
    v_mul_u32_u24 v97, 0xaab, v99
    v_lshrrev_b32 v97, 16, v97
    v_mul_u32_u24 v98, 24, v97
    s_waitcnt lgkmcnt(0)
    buffer_load_ushort v196, v199, s[16:19], s58 offen
    buffer_load_ushort v197, v199, s[16:19], s58 offen offset:128
    buffer_load_ushort v198, v199, s[16:19], s58 offen offset:256
    buffer_load_dwordx4 v251, s[8:11], s57 offen lds
    v_sub_u32 v96, v99, v98
    v_and_b32 v98, 2, v97
    v_xor_b32 v96, v96, v98
    buffer_load_dwordx4 v252, s[8:11], s57 offen offset:1024 lds
    v_add_u32 v97, s54, v97
    v_cmp_lt_u32 vcc, s53, v97
    s_sub_u32 s4, s4, 0x400
    s_subb_u32 s5, s5, 0
    s_add_u32 s51, s51, s38
    v_cndmask_b32 v97, v97, v100, vcc
    v_mul_u32_u24 v97, 0x300, v97
    v_lshl_add_u32 v247, v96, 4, v97
    s_mul_i32 s55, s46, 0x222000
    buffer_load_dwordx4 v253, s[8:11], s57 offen offset:2048 lds
    s_add_u32 s56, s51, s55
    s_mul_i32 s42, s46, 0xfffac000
    s_add_u32 s42, s42, 0x2a000
    s_mul_i32 s55, s46, 7
    s_cmp_eq_u32 s34, s55
    s_cselect_b32 s43, 5, -3
    s_cselect_b32 s45, 0, -1
    s_cselect_b32 s47, 1, 0
    s_mul_i32 s43, s43, s42
    s_add_u32 s43, s43, s56
    s_mul_i32 s45, s45, s42
    s_add_u32 s45, s45, s56
    s_add_u32 s44, s43, s42
    s_cmp_eq_u32 s47, 1
    s_cmov_b32 s45, 0x2000000
    s_add_u32 m0, s41, 0
    s_add_u32 s57, s49, 0x9180
    buffer_load_dwordx4 v246, s[4:7], s43 offen lds
    v_lshrrev_b32 v61, 4, v60
    v_and_b32 v62, 7, v60
    v_bfe_u32 v63, v60, 3, 1
    v_bfe_u32 v96, v60, 2, 2
    v_and_b32 v97, 3, v60
    v_and_b32 v103, 1, v61
    v_lshl_add_u32 v99, v61, 3, v96
    v_lshl_add_u32 v99, v103, 2, v99
    buffer_load_dwordx4 v247, s[4:7], s43 offen offset:1024 lds
    s_add_u32 m0, s41, 0x1e40
    v_lshl_add_u32 v101, v97, 3, s50
    s_movk_i32 s27, 0x60
    v_mad_u32_u24 v254, v99, s27, v101
    v_xor_b32 v99, 4, v99
    v_mad_u32_u24 v255, v99, s27, v101
    v_mul_u32_u24 v102, 0x1e40, v63
    v_and_b32 v98, 2, v60
    buffer_load_dwordx4 v246, s[4:7], s44 offen lds
    v_xor_b32 v98, v98, v61
    v_lshlrev_b32 v98, 4, v98
    v_mul_u32_u24 v100, 0x180, v62
    v_add3_u32 v224, v98, v100, v102
    v_mul_u32_u24 v99, 0x1e40, v96
    v_mul_u32_u24 v227, 0x180, v97
    v_add3_u32 v227, v227, v98, v99
    s_cmp_eq_u32 s35, 0
    s_cselect_b32 s29, 3, 0
    s_cselect_b32 s30, -3, -2
    buffer_load_dwordx4 v247, s[4:7], s44 offen offset:1024 lds
    s_add_u32 m0, s41, 0x3c80
    s_mul_i32 s32, s36, 0xf00
    s_add_u32 s32, s32, 0xf200
    s_mov_b32 s40, 0x140
    s_lshl_b32 s31, s36, 10
    s_add_u32 s31, s31, 0x12e40
    v_mul_u32_u24 v119, 13, v60
    v_lshrrev_b32 v119, 8, v119
    v_mul_u32_u24 v118, 20, v119
    v_sub_u32 v118, v60, v118
    buffer_load_dwordx4 v246, s[4:7], s45 offen lds
    v_add_u32 v120, -11, v118
    v_max_i32 v120, 0, v120
    v_mul_u32_u24 v121, 11, v120
    v_lshrrev_b32 v121, 5, v121
    v_mul_u32_u24 v122, 3, v121
    v_sub_u32 v120, v120, v122
    v_lshlrev_b32 v120, 2, v120
    buffer_load_dwordx4 v247, s[4:7], s45 offen offset:1024 lds
    s_add_u32 m0, s41, 0x5ac0
    v_sub_u32 v121, v120, v121
    v_cmp_lt_u32 vcc, 10, v118
    v_add_u32 v121, s29, v121
    v_add_u32 v120, s30, v120
    v_add_u32 v122, -3, v118
    v_cndmask_b32 v121, v118, v121, vcc
    v_cndmask_b32 v120, v122, v120, vcc
    buffer_load_dwordx4 v246, s[4:7], s56 offen lds
    v_cmp_gt_u32 s[60:61], 7, v120
    v_add_u32 v120, 1, v120
    v_cmp_gt_u32 s[62:63], 7, v120
    v_add_u32 v120, 1, v120
    v_cmp_gt_u32 s[64:65], 7, v120
    v_add_u32 v120, 1, v120
    v_cmp_gt_u32 s[66:67], 7, v120
    s_cmp_eq_u32 s46, 0
    s_cselect_b32 s28, 13, -13
    s_cselect_b32 s69, 0, 39
    buffer_load_dwordx4 v247, s[4:7], s56 offen offset:1024 lds
    s_add_u32 m0, s50, 0x3000
    s_add_u32 s56, s56, s42
    v_add_u32 v119, 2, v119
    v_mad_i32_i24 v121, v119, s28, v121
    s_lshl4_add_u32 s69, s69, s31
    v_lshl_add_u32 v121, v121, 2, s69
    s_mul_i32 s69, s28, 12
    v_add_u32 v118, s69, v121
    v_add_u32 v119, s69, v118
    buffer_load_dwordx4 v251, s[8:11], s57 offen lds
    s_lshl_b32 s69, s28, 3
    v_add_u32 v122, s69, v119
    v_lshl_add_u32 v123, v60, 4, s32
    v_lshl_add_u32 v125, v60, 2, s31
    s_mov_b32 s68, 0x40ddb3d7
    v_mov_b32 v124, 0xf149f2ca
    s_and_b32 s72, s60, 0xfff00000
    s_and_b32 s70, s62, 0xfff00000
    v_mul_u32_u24 v74, 0x180, v76
    buffer_load_dwordx4 v252, s[8:11], s57 offen offset:1024 lds
    v_lshl_add_u32 v192, v77, 4, v74
    v_mul_u32_u24 v74, 0x180, v78
    v_lshl_add_u32 v193, v79, 4, v74
    v_mul_u32_u24 v74, 0x180, v80
    v_lshl_add_u32 v194, v81, 4, v74
    v_and_b32 v74, 16, v78
    v_mul_u32_u24 v74, 0x300, v74
    v_add_u32 v195, v74, v193
    buffer_load_dwordx4 v253, s[8:11], s57 offen offset:2048 lds
    s_add_u32 s57, s49, 0x12180
    s_add_u32 m0, s50, 0x6000
    v_add_u32 v98, 3, v62
    v_and_b32 v98, 2, v98
    v_xor_b32 v98, v98, v61
    v_lshl_add_u32 v98, v98, 4, v100
    v_add_u32 v225, v98, v102
    v_xor_b32 v99, 1, v63
    v_mul_u32_u24 v99, 0xd3c0, v99
    v_add_u32 v226, v98, v99
    s_mov_b32 s37, 0x3e553b95
    s_cmp_eq_u32 s35, 7
    s_cselect_b32 s33, 2, 64
    v_lshrrev_b32 v184, 1, v61
    v_lshl_add_u32 v185, v63, 1, v184
    v_lshlrev_b32 v232, 2, v185
    v_lshl_add_u32 v185, v63, 2, v61
    v_lshlrev_b32 v233, 2, v185
    v_sub_u32 v184, v184, v63
    v_mul_i32_i24 v184, 0x140, v184
    s_sub_u32 s24, s32, 0x140
    v_add_u32 v184, s24, v184
    v_lshl_add_u32 v185, v103, 2, 3
    v_cmp_gt_u32 vcc, s29, v62
    v_sub_u32 v186, v185, v62
    v_min_u32 v187, 10, v186
    v_mad_u32_u24 v190, v62, 3, v103
    v_add_u32 v191, 11, v190
    v_cndmask_b32 v187, v187, v191, vcc
    v_lshl_add_u32 v228, v187, 4, v184
    v_add_u32 v186, 8, v186
    v_min_u32 v187, 10, v186
    v_lshl_add_u32 v186, v103, 4, v62
    v_cmp_gt_u32 vcc, s29, v186
    v_add_u32 v191, 13, v190
    v_min_u32 v186, 5, v62
    v_cndmask_b32 v187, v187, v191, vcc
    v_lshl_add_u32 v229, v187, 4, v184
    v_cmp_lt_u32 vcc, s33, v186
    v_sub_u32 v187, v185, v186
    v_min_u32 v187, 10, v187
    v_mad_u32_u24 v190, v186, 3, 2
    v_add_u32 v191, v190, v103
    v_cndmask_b32 v185, v187, v191, vcc
    v_sub_u32 v187, 11, v186
    v_min_u32 v187, 10, v187
    v_add_u32 v191, 2, v190
    v_cndmask_b32 v187, v187, v191, vcc
    v_cmp_lt_u32 vcc, 5, v62
    v_mul_u32_u24 v191, 10, v103
    v_mov_b32 v190, 10
    v_cndmask_b32 v185, v185, v191, vcc
    v_cndmask_b32 v187, v187, v190, vcc
    v_lshl_add_u32 v230, v185, 4, v184
    v_lshl_add_u32 v231, v187, 4, s32
    v_mov_b32 v96, 0x3f803f80
    v_cmp_eq_u32 vcc, 0, v97
    s_mov_b32 s69, 0x76540765
    s_and_b32 s24, s36, 1
    v_cndmask_b32 v96, 0, v96, vcc
    v_accvgpr_write_b32 a216, v96
    v_accvgpr_write_b32 a217, v96
    v_accvgpr_write_b32 a218, v96
    v_accvgpr_write_b32 a219, v96
    s_lshr_b32 s27, s36, 1
    v_lshlrev_b32 v99, 4, v60
    s_mul_i32 s25, s27, 0xc00
    s_add_u32 s25, s25, 0x12e00
    s_lshl_b32 s26, s24, 11
    s_add_u32 s26, s26, s25
    v_add_u32 v237, s26, v99
    s_lshl3_add_u32 s26, s24, s25
    s_add_u32 s26, s26, 0x400
    v_add_u32 v238, s26, v99
    s_mul_i32 s25, s24, 0x1800
    s_add_u32 s26, s25, 0x12e00
    v_add_u32 v239, s26, v99
    s_sub_u32 s25, 0x14600, s25
    v_add_u32 v240, s25, v99
    v_lshrrev_b32 v99, 2, v60
    v_and_b32 v97, 3, v60
    v_and_b32 v98, 2, v61
    v_lshlrev_b32 v98, 1, v98
    v_xor_b32 v99, v99, v98
    v_mul_u32_u24 v99, 0x60, v99
    v_lshl_add_u32 v108, v97, 4, v99
    v_lshrrev_b32 v98, 1, v97
    v_mul_u32_u24 v98, 0xba0, v98
    s_mul_i32 s26, s27, 0x1800
    s_add_u32 s26, s26, 0x15e40
    v_add3_u32 v109, v108, v98, s26
    s_lshl_b32 s25, s24, 5
    s_add_u32 s52, s25, s50
    v_add_u32 v108, s52, v108
    v_bfrev_b32 v98, v97
    v_lshrrev_b32 v98, 27, v98
    v_add3_u32 v86, v99, v98, s50
    v_lshlrev_b32 v99, 7, v61
    v_lshl_add_u32 v99, v62, 4, v99
    v_lshl_add_u32 v98, v63, 9, v99
    v_add_u32 v87, s50, v98
    v_lshl_add_u32 v99, v63, 10, v99
    s_add_u32 s26, s26, 0x7c0
    v_add_u32 v242, s26, v99
    s_lshl_b32 s26, s24, 10
    s_add_u32 s26, s26, s50
    v_add_u32 v241, s26, v99
    v_xor_b32 v99, s46, v63
    v_mul_u32_u24 v99, 0x2a000, v99
    v_mul_u32_u24 v98, 0x300, v62
    v_lshl_add_u32 v99, v61, 4, v99
    v_cmp_lt_u32 vcc, 5, v62
    v_add_u32 v99, v99, v98
    v_add_u32 v98, 0x1800, v99
    v_bfrev_b32 v100, 1
    v_cndmask_b32 v98, v98, v100, vcc
    s_sub_u32 s59, 0, s24
    s_mov_b32 vcc_lo, s59
    s_mov_b32 vcc_hi, s59
    v_cndmask_b32 v100, v99, v98, vcc
    v_cndmask_b32 v101, v98, v99, vcc
    s_mov_b32 vcc_lo, s59
    s_mov_b32 vcc_hi, s59
    v_lshrrev_b32 v96, 31, v100
    v_lshl_add_u32 v239, v96, 20, v239
    v_lshrrev_b32 v96, 31, v101
    v_lshl_add_u32 v240, v96, 20, v240
    s_add_u32 s25, s25, s49
    v_add_u32 v243, s25, v100
    v_add_u32 v245, s25, v101
    s_mul_i32 s26, s27, 0xc0
    s_add_u32 s26, s26, 64
    v_add_u32 v244, s26, v100
    s_mul_i32 s25, s35, 0x2a00
    s_add_u32 s51, s51, s25
    s_mul_i32 s25, s46, 0x1f8000
    s_add_u32 s51, s51, s25
    s_lshl_b32 s48, s42, 1
    s_mov_b32 s82, 0xff00ff
    s_mov_b32 s83, s82
    s_mov_b32 s84, -1
    s_mov_b32 s85, 0
    s_waitcnt vmcnt(16)
    v_lshlrev_b32 v196, 16, v196
    v_mul_f32 v196, s68, v196
    ds_write_b32 v125, v196
    s_waitcnt vmcnt(15)
    v_lshlrev_b32 v197, 16, v197
    v_mul_f32 v197, s68, v197
    ds_write_b32 v125, v197 offset:256
    s_waitcnt vmcnt(14)
    v_lshlrev_b32 v198, 16, v198
    v_mul_f32 v198, s68, v198
    ds_write_b32 v125, v198 offset:512
    s_mov_b32 s68, 0x32104321
    ds_read2_b32 v[144:145], v121 offset0:0 offset1:1
    ds_read2_b32 v[146:147], v121 offset0:2 offset1:3
    ds_read2_b32 v[148:149], v118 offset0:0 offset1:1
    ds_read2_b32 v[150:151], v118 offset0:2 offset1:3
    ds_read2_b32 v[152:153], v119 offset0:0 offset1:1
    ds_read2_b32 v[154:155], v119 offset0:2 offset1:3
    ds_read2_b32 v[156:157], v122 offset0:0 offset1:1
    ds_read2_b32 v[158:159], v122 offset0:2 offset1:3
    s_waitcnt lgkmcnt(5)
    v_cndmask_b32 v148, v124, v148, s[60:61]
    v_cndmask_b32 v149, v124, v149, s[62:63]
    s_waitcnt lgkmcnt(4)
    v_cndmask_b32 v150, v124, v150, s[64:65]
    v_cndmask_b32 v151, v124, v151, s[66:67]
    s_and_b32 s61, s61, 0xfffffff
    s_and_b32 s63, s63, 0xfffffff
    s_and_b32 s65, s65, 0xfffffff
    s_and_b32 s67, s67, 0xfffffff
    s_waitcnt vmcnt(11)
    ds_read_b64_tr_b16 a[0:1], v254
    ds_read_b64_tr_b16 a[2:3], v255
    ds_read_b64_tr_b16 a[4:5], v254 offset:32
    ds_read_b64_tr_b16 a[6:7], v255 offset:32
    ds_read_b64_tr_b16 a[8:9], v254 offset:64
    s_waitcnt lgkmcnt(6)
    v_cndmask_b32 v156, v124, v156, s[60:61]
    ds_read_b64_tr_b16 a[10:11], v255 offset:64
    v_cndmask_b32 v157, v124, v157, s[62:63]
    s_waitcnt lgkmcnt(6)
    v_cndmask_b32 v158, v124, v158, s[64:65]
    v_cndmask_b32 v159, v124, v159, s[66:67]
    s_mov_b32 s73, s61
    v_cndmask_b32 v144, v124, v144, s[72:73]
    s_mov_b32 s71, s63
    v_cndmask_b32 v145, v124, v145, s[70:71]
    s_and_b32 s72, s64, 0xfff00000
    s_mov_b32 s73, s65
    v_cndmask_b32 v146, v124, v146, s[72:73]
    s_and_b32 s70, s66, 0xfff00000
    s_mov_b32 s71, s67
    v_cndmask_b32 v147, v124, v147, s[70:71]
    s_and_b32 s61, s61, 0xff
    v_cndmask_b32 v152, v124, v152, s[60:61]
    s_and_b32 s63, s63, 0xff
    v_cndmask_b32 v153, v124, v153, s[62:63]
    s_and_b32 s65, s65, 0xff
    v_cndmask_b32 v154, v124, v154, s[64:65]
    s_and_b32 s67, s67, 0xff
    v_cndmask_b32 v155, v124, v155, s[66:67]
    ds_write_b128 v123, v[144:147]
    ds_write_b128 v123, v[148:151] offset:960
    ds_write_b128 v123, v[152:155] offset:1920
    ds_write_b128 v123, v[156:159] offset:2880
    s_mov_b32 s60, 0x2222
    s_cmp_eq_u32 s47, 1
    s_cmov_b32 s60, 0xbbbb
    v_bfe_u32 v234, s60, v232, 4
    v_mad_u32_u24 v235, v234, s40, v228
    v_mad_u32_u24 v234, v234, s40, v229
    s_mov_b32 s61, 0x4444
    s_cmp_eq_u32 s47, 1
    s_cmov_b32 s61, 0x4241
    v_bfe_u32 v250, s61, v232, 4
    s_mov_b32 s62, 0x8808
    s_cmp_eq_u32 s47, 1
    s_cmov_b32 s62, 0x8898
    s_mov_b32 s63, 0x32104321
    s_cmp_eq_u32 s47, 1
    s_cmov_b32 s63, 0x30a940ba
    s_mov_b32 s64, 0x76540765
    s_cmp_eq_u32 s47, 1
    s_cmov_b32 s64, 0x76549765
    s_mov_b32 s65, 0x2222
    s_cmp_eq_u32 s47, 1
    s_cmov_b32 s65, 0x2221
    s_mov_b32 s66, 0x10762107
    s_cmp_eq_u32 s47, 1
    s_cmov_b32 s66, 0x10762097
    s_mov_b32 s67, 0x54326543
    s_mov_b32 s70, 0x10762107
    ds_read_b128 v[144:147], v235
    v_bfe_u32 v235, s62, v232, 4
    ds_read_b128 v[148:151], v234
    v_mad_u32_u24 v234, v250, s40, v229
    v_mad_u32_u24 v250, v250, s40, v228
    ds_read_b128 v[152:155], v234
    v_bfe_u32 v234, s60, v232, 4
    v_mad_u32_u24 v234, v234, s40, v230
    ds_read_b128 v[156:159], v250
    v_mad_u32_u24 v250, v235, s40, v229
    v_mad_u32_u24 v235, v235, s40, v228
    ds_read_b128 v[160:163], v228 offset:1920
    ds_read_b128 v[164:167], v229 offset:1920
    ds_read_b128 v[168:171], v250
    v_bfe_u32 v250, s62, v232, 4
    v_mad_u32_u24 v250, v250, s40, v230
    s_waitcnt vmcnt(3)
    s_barrier
    buffer_load_dwordx4 v251, s[8:11], s57 offen lds
    buffer_load_dwordx4 v252, s[8:11], s57 offen offset:1024 lds
    ds_read_b128 v[172:175], v235
    v_bfe_u32 v235, s61, v232, 4
    v_mad_u32_u24 v235, v235, s40, v230
    ds_read_b128 a[236:239], v224
    ds_read_b128 a[240:243], v224 offset:64
    ds_read_b128 a[244:247], v224 offset:128
    buffer_load_dwordx4 v253, s[8:11], s57 offen offset:2048 lds
    s_add_u32 s57, s49, 0x1b180
    s_add_u32 m0, s50, 0x9000
    ds_read_b128 a[248:251], v224 offset:192
    ds_read_b128 a[252:255], v224 offset:256
    ds_read_b128 a[220:223], v224 offset:320
    ds_read_b128 a[224:227], v224 offset:3072
    buffer_load_dwordx4 v251, s[8:11], s57 offen lds
    ds_read_b128 a[228:231], v224 offset:3136
    s_waitcnt lgkmcnt(7)
    v_mfma_f32_16x16x32_bf16 v[220:223], a[0:3], a[236:239], 0
    ds_read_b128 a[232:235], v224 offset:3200
    v_mfma_f32_16x16x32_bf16 v[216:219], a[4:7], a[236:239], 0
    s_waitcnt vmcnt(4)
    ds_read_b64_tr_b16 a[12:13], v254 offset:12288
    v_mfma_f32_16x16x32_bf16 v[212:215], a[8:11], a[236:239], 0
    s_waitcnt lgkmcnt(3)
    ds_read_b128 a[236:239], v224 offset:3264
    ds_read_b64_tr_b16 a[14:15], v255 offset:12288
    buffer_load_dwordx4 v252, s[8:11], s57 offen offset:1024 lds
    ds_read_b64_tr_b16 a[16:17], v254 offset:12320
    ds_read_b64_tr_b16 a[18:19], v255 offset:12320
    ds_read_b64_tr_b16 a[20:21], v254 offset:12352
    ds_read_b64_tr_b16 a[22:23], v255 offset:12352
    v_mfma_f32_16x16x32_bf16 v[208:211], a[0:3], a[224:227], 0
    v_mfma_f32_16x16x32_bf16 v[204:207], a[4:7], a[224:227], 0
    v_mfma_f32_16x16x32_bf16 v[200:203], a[8:11], a[224:227], 0
    s_waitcnt lgkmcnt(4)
    buffer_load_dwordx4 v253, s[8:11], s57 offen offset:2048 lds
    s_add_u32 s57, s49, 0x24180
    s_add_u32 m0, s50, 0xc000
    ds_read_b128 a[224:227], v224 offset:15680
    v_mfma_f32_16x16x32_bf16 v[220:223], a[12:15], a[240:243], v[220:223]
    s_waitcnt lgkmcnt(3)
    v_mfma_f32_16x16x32_bf16 v[216:219], a[16:19], a[240:243], v[216:219]
    s_waitcnt lgkmcnt(1)
    v_mfma_f32_16x16x32_bf16 v[212:215], a[20:23], a[240:243], v[212:215]
    buffer_load_dwordx4 v251, s[8:11], s57 offen lds
    v_mfma_f32_16x16x32_bf16 v[208:211], a[12:15], a[228:231], v[208:211]
    ds_read_b128 a[240:243], v224 offset:3328
    v_mfma_f32_16x16x32_bf16 v[204:207], a[16:19], a[228:231], v[204:207]
    v_mfma_f32_16x16x32_bf16 v[200:203], a[20:23], a[228:231], v[200:203]
    s_waitcnt vmcnt(4)
    ds_read_b128 a[228:231], v224 offset:15744
    buffer_load_dwordx4 v252, s[8:11], s57 offen offset:1024 lds
    buffer_load_dwordx4 v253, s[8:11], s57 offen offset:2048 lds
    s_add_u32 s57, s49, 0x2d180
    s_add_u32 m0, s50, 0xf000
    s_nop 0
    buffer_load_dwordx4 v251, s[8:11], s57 offen lds
    buffer_load_dwordx4 v252, s[8:11], s57 offen offset:1024 lds
    ds_read_b64_tr_b16 a[24:25], v254 offset:24576
    ds_read_b64_tr_b16 a[26:27], v255 offset:24576
    ds_read_b64_tr_b16 a[28:29], v254 offset:24608
    ds_read_b64_tr_b16 a[30:31], v255 offset:24608
    ds_read_b64_tr_b16 a[32:33], v254 offset:24640
    ds_read_b64_tr_b16 a[34:35], v255 offset:24640
    buffer_load_dwordx4 v253, s[8:11], s57 offen offset:2048 lds
    s_add_u32 m0, s41, 0x7900
    s_add_u32 s57, s49, 0x300
    s_waitcnt lgkmcnt(4)
    v_mfma_f32_16x16x32_bf16 v[220:223], a[24:27], a[244:247], v[220:223]
    s_waitcnt lgkmcnt(2)
    buffer_load_dwordx4 v246, s[4:7], s56 offen lds
    v_mfma_f32_16x16x32_bf16 v[216:219], a[28:31], a[244:247], v[216:219]
    s_waitcnt lgkmcnt(0)
    v_mfma_f32_16x16x32_bf16 v[212:215], a[32:35], a[244:247], v[212:215]
    ds_read_b128 a[244:247], v224 offset:3392
    v_mfma_f32_16x16x32_bf16 v[208:211], a[24:27], a[232:235], v[208:211]
    v_mfma_f32_16x16x32_bf16 v[204:207], a[28:31], a[232:235], v[204:207]
    s_waitcnt vmcnt(7)
    buffer_load_dwordx4 v247, s[4:7], s56 offen offset:1024 lds
    v_mfma_f32_16x16x32_bf16 v[200:203], a[32:35], a[232:235], v[200:203]
    s_add_u32 s56, s56, s42
    s_add_u32 m0, s41, 0x9740
    ds_read_b128 a[232:235], v224 offset:15808
    ds_read_b64_tr_b16 a[36:37], v254 offset:36864
    ds_read_b64_tr_b16 a[38:39], v255 offset:36864
    ds_read_b64_tr_b16 a[40:41], v254 offset:36896
    ds_read_b64_tr_b16 a[42:43], v255 offset:36896
    ds_read_b64_tr_b16 a[44:45], v254 offset:36928
    ds_read_b64_tr_b16 a[46:47], v255 offset:36928
    buffer_load_dwordx4 v246, s[4:7], s56 offen lds
    buffer_load_dwordx4 v247, s[4:7], s56 offen offset:1024 lds
    s_waitcnt lgkmcnt(4)
    v_mfma_f32_16x16x32_bf16 v[220:223], a[36:39], a[248:251], v[220:223]
    s_add_u32 s56, s56, s42
    s_add_u32 m0, s41, 0xb580
    s_waitcnt lgkmcnt(2)
    v_mfma_f32_16x16x32_bf16 v[216:219], a[40:43], a[248:251], v[216:219]
    s_waitcnt lgkmcnt(0)
    v_mfma_f32_16x16x32_bf16 v[212:215], a[44:47], a[248:251], v[212:215]
    ds_read_b128 a[248:251], v224 offset:15488
    v_mfma_f32_16x16x32_bf16 v[208:211], a[36:39], a[236:239], v[208:211]
    v_mfma_f32_16x16x32_bf16 v[204:207], a[40:43], a[236:239], v[204:207]
    buffer_load_dwordx4 v246, s[4:7], s56 offen lds
    v_mfma_f32_16x16x32_bf16 v[200:203], a[44:47], a[236:239], v[200:203]
    s_waitcnt vmcnt(8)
    ds_read_b128 a[236:239], v224 offset:18560
    ds_read_b64_tr_b16 a[48:49], v254 offset:49152
    ds_read_b64_tr_b16 a[50:51], v255 offset:49152
    ds_read_b64_tr_b16 a[52:53], v254 offset:49184
    ds_read_b64_tr_b16 a[54:55], v255 offset:49184
    ds_read_b64_tr_b16 a[56:57], v254 offset:49216
    buffer_load_dwordx4 v247, s[4:7], s56 offen offset:1024 lds
    s_add_u32 s56, s56, s42
    s_add_u32 m0, s41, 0xd3c0
    ds_read_b64_tr_b16 a[58:59], v255 offset:49216
    buffer_load_dwordx4 v246, s[4:7], s56 offen lds
    s_waitcnt lgkmcnt(4)
    v_mfma_f32_16x16x32_bf16 v[220:223], a[48:51], a[252:255], v[220:223]
    s_waitcnt lgkmcnt(2)
    v_mfma_f32_16x16x32_bf16 v[216:219], a[52:55], a[252:255], v[216:219]
    s_waitcnt lgkmcnt(0)
    v_mfma_f32_16x16x32_bf16 v[212:215], a[56:59], a[252:255], v[212:215]
    ds_read_b128 a[252:255], v224 offset:15552
    v_mfma_f32_16x16x32_bf16 v[208:211], a[48:51], a[240:243], v[208:211]
    s_waitcnt vmcnt(7)
    buffer_load_dwordx4 v247, s[4:7], s56 offen offset:1024 lds
    v_mfma_f32_16x16x32_bf16 v[204:207], a[52:55], a[240:243], v[204:207]
    s_add_u32 m0, s50, 0
    ds_read_b64_tr_b16 a[60:61], v254 offset:61440
    ds_read_b64_tr_b16 a[62:63], v255 offset:61440
    v_mfma_f32_16x16x32_bf16 v[200:203], a[56:59], a[240:243], v[200:203]
    s_add_u32 s56, s56, s42
    ds_read_b128 a[240:243], v224 offset:18624
    ds_read_b64_tr_b16 a[64:65], v254 offset:61472
    ds_read_b64_tr_b16 a[66:67], v255 offset:61472
    ds_read_b64_tr_b16 a[68:69], v254 offset:61504
    ds_read_b64_tr_b16 a[70:71], v255 offset:61504
    buffer_load_dwordx4 v251, s[8:11], s57 offen lds
    s_waitcnt lgkmcnt(5)
    v_mfma_f32_16x16x32_bf16 v[220:223], a[60:63], a[220:223], v[220:223]
    v_mfma_f32_16x16x32_bf16 v[208:211], a[60:63], a[244:247], v[208:211]
    s_waitcnt lgkmcnt(2)
    buffer_load_dwordx4 v252, s[8:11], s57 offen offset:1024 lds
    v_mfma_f32_16x16x32_bf16 v[216:219], a[64:67], a[220:223], v[216:219]
    s_waitcnt lgkmcnt(0)
    v_mfma_f32_16x16x32_bf16 v[212:215], a[68:71], a[220:223], v[212:215]
    ds_read_b128 a[220:223], v224 offset:15616
    v_mfma_f32_16x16x32_bf16 v[204:207], a[64:67], a[244:247], v[204:207]
    v_mfma_f32_16x16x32_bf16 v[200:203], a[68:71], a[244:247], v[200:203]
    ds_read_b128 a[244:247], v224 offset:18688
    v_cvt_pk_bf16_f32 v0, v220, v221
    v_cvt_pk_bf16_f32 v1, v222, v223
    v_mfma_f32_16x16x32_bf16 v[220:223], a[0:3], a[248:251], 0
    v_cvt_pk_bf16_f32 v2, v216, v217
    v_cvt_pk_bf16_f32 v3, v218, v219
    v_mfma_f32_16x16x32_bf16 v[220:223], a[12:15], a[252:255], v[220:223]
    v_cvt_pk_bf16_f32 v4, v212, v213
    v_cvt_pk_bf16_f32 v5, v214, v215
    v_mfma_f32_16x16x32_bf16 v[216:219], a[4:7], a[248:251], 0
    v_cvt_pk_bf16_f32 v24, v208, v209
    v_cvt_pk_bf16_f32 v25, v210, v211
    v_mfma_f32_16x16x32_bf16 v[216:219], a[16:19], a[252:255], v[216:219]
    v_cvt_pk_bf16_f32 v26, v204, v205
    v_cvt_pk_bf16_f32 v27, v206, v207
    v_mfma_f32_16x16x32_bf16 v[212:215], a[8:11], a[248:251], 0
    v_cvt_pk_bf16_f32 v28, v200, v201
    v_cvt_pk_bf16_f32 v29, v202, v203
    v_mfma_f32_16x16x32_bf16 v[212:215], a[20:23], a[252:255], v[212:215]
    s_waitcnt lgkmcnt(1)
    ds_read_b128 a[248:251], v224 offset:18752
    ds_read_b128 a[252:255], v224 offset:18816
    v_mfma_f32_16x16x32_bf16 v[220:223], a[24:27], a[220:223], v[220:223]
    buffer_load_dwordx4 v253, s[8:11], s57 offen offset:2048 lds
    v_mfma_f32_16x16x32_bf16 v[220:223], a[36:39], a[224:227], v[220:223]
    s_add_u32 s57, s49, 0x9300
    s_add_u32 m0, s50, 0x3000
    v_mfma_f32_16x16x32_bf16 v[216:219], a[28:31], a[220:223], v[216:219]
    buffer_load_dwordx4 v251, s[8:11], s57 offen lds
    v_mfma_f32_16x16x32_bf16 v[216:219], a[40:43], a[224:227], v[216:219]
    v_mfma_f32_16x16x32_bf16 v[212:215], a[32:35], a[220:223], v[212:215]
    ds_read_b128 a[220:223], v224 offset:18880
    v_mfma_f32_16x16x32_bf16 v[212:215], a[44:47], a[224:227], v[212:215]
    ds_read_b128 a[224:227], v227 offset:6144
    v_mfma_f32_16x16x32_bf16 v[220:223], a[48:51], a[228:231], v[220:223]
    buffer_load_dwordx4 v252, s[8:11], s57 offen offset:1024 lds
    v_mfma_f32_16x16x32_bf16 v[220:223], a[60:63], a[232:235], v[220:223]
    v_mfma_f32_16x16x32_bf16 v[216:219], a[52:55], a[228:231], v[216:219]
    v_mfma_f32_16x16x32_bf16 v[216:219], a[64:67], a[232:235], v[216:219]
    buffer_load_dwordx4 v253, s[8:11], s57 offen offset:2048 lds
    v_mfma_f32_16x16x32_bf16 v[212:215], a[56:59], a[228:231], v[212:215]
    s_add_u32 s57, s49, 0x12300
    ds_read_b128 a[228:231], v227 offset:6208
    s_add_u32 m0, s50, 0x6000
    v_mfma_f32_16x16x32_bf16 v[212:215], a[68:71], a[232:235], v[212:215]
    v_cvt_pk_bf16_f32 v6, v220, v221
    v_cvt_pk_bf16_f32 v7, v222, v223
    v_mfma_f32_16x16x32_bf16 v[208:211], a[0:3], a[236:239], 0
    v_cvt_pk_bf16_f32 v8, v216, v217
    v_cvt_pk_bf16_f32 v9, v218, v219
    v_mfma_f32_16x16x32_bf16 v[208:211], a[12:15], a[240:243], v[208:211]
    ds_read_b128 a[232:235], v227 offset:6272
    v_mfma_f32_16x16x32_bf16 v[204:207], a[4:7], a[236:239], 0
    v_cvt_pk_bf16_f32 v10, v212, v213
    v_cvt_pk_bf16_f32 v11, v214, v215
    v_mfma_f32_16x16x32_bf16 v[204:207], a[16:19], a[240:243], v[204:207]
    buffer_load_dwordx4 v251, s[8:11], s57 offen lds
    v_mfma_f32_16x16x32_bf16 v[200:203], a[8:11], a[236:239], 0
    ds_read_b128 a[236:239], v227 offset:6336
    v_mfma_f32_16x16x32_bf16 v[200:203], a[20:23], a[240:243], v[200:203]
    s_waitcnt lgkmcnt(3)
    ds_read_b128 a[240:243], v227 offset:6400
    v_mfma_f32_16x16x32_bf16 v[208:211], a[24:27], a[244:247], v[208:211]
    buffer_load_dwordx4 v252, s[8:11], s57 offen offset:1024 lds
    v_mfma_f32_16x16x32_bf16 v[208:211], a[36:39], a[248:251], v[208:211]
    v_mfma_f32_16x16x32_bf16 v[204:207], a[28:31], a[244:247], v[204:207]
    v_mfma_f32_16x16x32_bf16 v[204:207], a[40:43], a[248:251], v[204:207]
    v_mfma_f32_16x16x32_bf16 v[200:203], a[32:35], a[244:247], v[200:203]
    ds_read_b128 a[244:247], v227 offset:6464
    v_mfma_f32_16x16x32_bf16 v[200:203], a[44:47], a[248:251], v[200:203]
    buffer_load_dwordx4 v253, s[8:11], s57 offen offset:2048 lds
    v_mfma_f32_16x16x32_bf16 v[208:211], a[48:51], a[252:255], v[208:211]
    s_add_u32 s57, s49, 0x1b300
    s_add_u32 m0, s50, 0x9000
    v_mfma_f32_16x16x32_bf16 v[208:211], a[60:63], a[220:223], v[208:211]
    v_mfma_f32_16x16x32_bf16 v[204:207], a[52:55], a[252:255], v[204:207]
    s_waitcnt vmcnt(13)
    buffer_load_dwordx4 v251, s[8:11], s57 offen lds
    v_mfma_f32_16x16x32_bf16 v[204:207], a[64:67], a[220:223], v[204:207]
    s_barrier
    ds_read_b128 a[248:251], v224 offset:30976
    v_mfma_f32_16x16x32_bf16 v[200:203], a[56:59], a[252:255], v[200:203]
    ds_read_b128 a[252:255], v224 offset:31040
    v_mfma_f32_16x16x32_bf16 v[200:203], a[68:71], a[220:223], v[200:203]
    v_cvt_pk_bf16_f32 v30, v208, v209
    v_cvt_pk_bf16_f32 v31, v210, v211
    v_mfma_f32_16x16x32_bf16 v[220:223], a[0:3], a[224:227], 0
    s_waitcnt lgkmcnt(2)
    v_cvt_pk_bf16_f32 v32, v204, v205
    v_cvt_pk_bf16_f32 v33, v206, v207
    v_mfma_f32_16x16x32_bf16 v[220:223], a[12:15], a[228:231], v[220:223]
    ds_read_b128 a[220:223], v224 offset:31104
    v_mfma_f32_16x16x32_bf16 v[216:219], a[4:7], a[224:227], 0
    v_cvt_pk_bf16_f32 v34, v200, v201
    v_cvt_pk_bf16_f32 v35, v202, v203
    v_mfma_f32_16x16x32_bf16 v[216:219], a[16:19], a[228:231], v[216:219]
    buffer_load_dwordx4 v252, s[8:11], s57 offen offset:1024 lds
    v_mfma_f32_16x16x32_bf16 v[212:215], a[8:11], a[224:227], 0
    ds_read_b128 a[224:227], v224 offset:31168
    v_mfma_f32_16x16x32_bf16 v[212:215], a[20:23], a[228:231], v[212:215]
    ds_read_b128 a[228:231], v224 offset:31232
    v_mfma_f32_16x16x32_bf16 v[220:223], a[24:27], a[232:235], v[220:223]
    buffer_load_dwordx4 v253, s[8:11], s57 offen offset:2048 lds
    v_mfma_f32_16x16x32_bf16 v[220:223], a[36:39], a[236:239], v[220:223]
    s_add_u32 s57, s49, 0x24300
    s_add_u32 m0, s50, 0xc000
    v_mfma_f32_16x16x32_bf16 v[216:219], a[28:31], a[232:235], v[216:219]
    v_mfma_f32_16x16x32_bf16 v[216:219], a[40:43], a[236:239], v[216:219]
    buffer_load_dwordx4 v251, s[8:11], s57 offen lds
    v_mfma_f32_16x16x32_bf16 v[212:215], a[32:35], a[232:235], v[212:215]
    ds_read_b128 a[232:235], v224 offset:31296
    v_mfma_f32_16x16x32_bf16 v[212:215], a[44:47], a[236:239], v[212:215]
    ds_read_b128 a[236:239], v224 offset:34048
    v_mfma_f32_16x16x32_bf16 v[220:223], a[48:51], a[240:243], v[220:223]
    v_mfma_f32_16x16x32_bf16 v[220:223], a[60:63], a[244:247], v[220:223]
    s_waitcnt vmcnt(13)
    buffer_load_dwordx4 v252, s[8:11], s57 offen offset:1024 lds
    v_mfma_f32_16x16x32_bf16 v[216:219], a[52:55], a[240:243], v[216:219]
    s_barrier
    v_mfma_f32_16x16x32_bf16 v[216:219], a[64:67], a[244:247], v[216:219]
    v_mfma_f32_16x16x32_bf16 v[212:215], a[56:59], a[240:243], v[212:215]
    ds_read_b128 a[240:243], v224 offset:34112
    v_mfma_f32_16x16x32_bf16 v[212:215], a[68:71], a[244:247], v[212:215]
    s_waitcnt lgkmcnt(3)
    ds_read_b128 a[244:247], v224 offset:34176
    v_cvt_pk_bf16_f32 v48, v220, v221
    v_mfma_f32_16x16x32_bf16 v[208:211], a[0:3], a[248:251], 0
    v_cvt_pk_bf16_f32 v49, v222, v223
    v_mfma_f32_16x16x32_bf16 v[208:211], a[12:15], a[252:255], v[208:211]
    v_cvt_pk_bf16_f32 v50, v216, v217
    v_cvt_pk_bf16_f32 v51, v218, v219
    v_mfma_f32_16x16x32_bf16 v[204:207], a[4:7], a[248:251], 0
    v_cvt_pk_bf16_f32 v52, v212, v213
    v_cvt_pk_bf16_f32 v53, v214, v215
    v_mfma_f32_16x16x32_bf16 v[204:207], a[16:19], a[252:255], v[204:207]
    buffer_load_dwordx4 v253, s[8:11], s57 offen offset:2048 lds
    v_mfma_f32_16x16x32_bf16 v[200:203], a[8:11], a[248:251], 0
    s_add_u32 s57, s49, 0x2d300
    ds_read_b128 a[248:251], v224 offset:34240
    s_add_u32 m0, s50, 0xf000
    v_mfma_f32_16x16x32_bf16 v[200:203], a[20:23], a[252:255], v[200:203]
    ds_read_b128 a[252:255], v224 offset:34304
    v_mfma_f32_16x16x32_bf16 v[208:211], a[24:27], a[220:223], v[208:211]
    buffer_load_dwordx4 v251, s[8:11], s57 offen lds
    v_mfma_f32_16x16x32_bf16 v[208:211], a[36:39], a[224:227], v[208:211]
    v_mfma_f32_16x16x32_bf16 v[204:207], a[28:31], a[220:223], v[204:207]
    buffer_load_dwordx4 v252, s[8:11], s57 offen offset:1024 lds
    v_mfma_f32_16x16x32_bf16 v[204:207], a[40:43], a[224:227], v[204:207]
    s_waitcnt vmcnt(14)
    ds_read_b64_tr_b16 a[72:73], v254
    ds_read_b64_tr_b16 a[74:75], v255
    v_mfma_f32_16x16x32_bf16 v[200:203], a[32:35], a[220:223], v[200:203]
    ds_read_b128 a[220:223], v224 offset:34368
    ds_read_b64_tr_b16 a[76:77], v254 offset:32
    v_mfma_f32_16x16x32_bf16 v[200:203], a[44:47], a[224:227], v[200:203]
    ds_read_b128 a[224:227], v224 offset:46464
    v_mfma_f32_16x16x32_bf16 v[208:211], a[48:51], a[228:231], v[208:211]
    s_waitcnt lgkmcnt(6)
    buffer_load_dwordx4 v253, s[8:11], s57 offen offset:2048 lds
    v_mfma_f32_16x16x32_bf16 v[208:211], a[60:63], a[232:235], v[208:211]
    s_add_u32 s57, s49, 0
    ds_read_b64_tr_b16 a[78:79], v255 offset:32
    ds_read_b64_tr_b16 a[80:81], v254 offset:64
    v_mfma_f32_16x16x32_bf16 v[204:207], a[52:55], a[228:231], v[204:207]
    s_add_u32 m0, s50, 0
    ds_read_b64_tr_b16 a[82:83], v255 offset:64
    v_mfma_f32_16x16x32_bf16 v[204:207], a[64:67], a[232:235], v[204:207]
    v_mfma_f32_16x16x32_bf16 v[200:203], a[56:59], a[228:231], v[200:203]
    v_cvt_pk_bf16_f32 v12, v208, v209
    v_cvt_pk_bf16_f32 v13, v210, v211
    v_mfma_f32_16x16x32_bf16 v[200:203], a[68:71], a[232:235], v[200:203]
    ds_read_b128 a[228:231], v224 offset:46528
    ds_read_b128 a[232:235], v224 offset:46592
    v_mfma_f32_16x16x32_bf16 v[220:223], a[0:3], a[236:239], 0
    v_mfma_f32_16x16x32_bf16 v[220:223], a[12:15], a[240:243], v[220:223]
    v_cvt_pk_bf16_f32 v14, v204, v205
    v_cvt_pk_bf16_f32 v15, v206, v207
    v_mfma_f32_16x16x32_bf16 v[216:219], a[4:7], a[236:239], 0
    s_waitcnt lgkmcnt(2)
    buffer_load_dwordx4 v251, s[8:11], s57 offen lds
    v_mfma_f32_16x16x32_bf16 v[216:219], a[16:19], a[240:243], v[216:219]
    v_cvt_pk_bf16_f32 v16, v200, v201
    v_cvt_pk_bf16_f32 v17, v202, v203
    v_mfma_f32_16x16x32_bf16 v[212:215], a[8:11], a[236:239], 0
    s_waitcnt vmcnt(13)
    ds_read_b128 a[236:239], v224 offset:46656
    ds_read_b64_tr_b16 a[84:85], v254 offset:12288
    v_mfma_f32_16x16x32_bf16 v[212:215], a[20:23], a[240:243], v[212:215]
    ds_read_b128 a[240:243], v224 offset:46720
    v_mfma_f32_16x16x32_bf16 v[220:223], a[24:27], a[244:247], v[220:223]
    buffer_load_dwordx4 v252, s[8:11], s57 offen offset:1024 lds
    v_mfma_f32_16x16x32_bf16 v[220:223], a[36:39], a[248:251], v[220:223]
    buffer_load_dwordx4 v253, s[8:11], s57 offen offset:2048 lds
    v_mfma_f32_16x16x32_bf16 v[216:219], a[28:31], a[244:247], v[216:219]
    s_add_u32 s57, s49, 0x9000
    ds_read_b64_tr_b16 a[86:87], v255 offset:12288
    ds_read_b64_tr_b16 a[88:89], v254 offset:12320
    v_mfma_f32_16x16x32_bf16 v[216:219], a[40:43], a[248:251], v[216:219]
    s_add_u32 m0, s50, 0x3000
    ds_read_b64_tr_b16 a[90:91], v255 offset:12320
    ds_read_b64_tr_b16 a[92:93], v254 offset:12352
    v_mfma_f32_16x16x32_bf16 v[212:215], a[32:35], a[244:247], v[212:215]
    ds_read_b128 a[244:247], v224 offset:46784
    ds_read_b64_tr_b16 a[94:95], v255 offset:12352
    v_mfma_f32_16x16x32_bf16 v[212:215], a[44:47], a[248:251], v[212:215]
    ds_read_b128 a[248:251], v224 offset:49536
    v_mfma_f32_16x16x32_bf16 v[220:223], a[48:51], a[252:255], v[220:223]
    v_mfma_f32_16x16x32_bf16 v[220:223], a[60:63], a[220:223], v[220:223]
    v_mfma_f32_16x16x32_bf16 v[216:219], a[52:55], a[252:255], v[216:219]
    s_waitcnt vmcnt(12)
    ds_read_b64_tr_b16 a[96:97], v254 offset:24576
    ds_read_b64_tr_b16 a[98:99], v255 offset:24576
    v_mfma_f32_16x16x32_bf16 v[216:219], a[64:67], a[220:223], v[216:219]
    ds_read_b64_tr_b16 a[100:101], v254 offset:24608
    ds_read_b64_tr_b16 a[102:103], v255 offset:24608
    v_mfma_f32_16x16x32_bf16 v[212:215], a[56:59], a[252:255], v[212:215]
    ds_read_b128 a[252:255], v224 offset:49600
    v_cvt_pk_bf16_f32 v36, v220, v221
    v_mfma_f32_16x16x32_bf16 v[212:215], a[68:71], a[220:223], v[212:215]
    ds_read_b128 a[220:223], v224 offset:49664
    v_cvt_pk_bf16_f32 v37, v222, v223
    v_mfma_f32_16x16x32_bf16 v[208:211], a[0:3], a[224:227], 0
    s_waitcnt lgkmcnt(8)
    v_cvt_pk_bf16_f32 v38, v216, v217
    v_cvt_pk_bf16_f32 v39, v218, v219
    v_mfma_f32_16x16x32_bf16 v[208:211], a[12:15], a[228:231], v[208:211]
    s_waitcnt lgkmcnt(7)
    buffer_load_dwordx4 v251, s[8:11], s57 offen lds
    v_mfma_f32_16x16x32_bf16 v[204:207], a[4:7], a[224:227], 0
    v_cvt_pk_bf16_f32 v40, v212, v213
    v_cvt_pk_bf16_f32 v41, v214, v215
    v_mfma_f32_16x16x32_bf16 v[204:207], a[16:19], a[228:231], v[204:207]
    buffer_load_dwordx4 v252, s[8:11], s57 offen offset:1024 lds
    v_mfma_f32_16x16x32_bf16 v[200:203], a[8:11], a[224:227], 0
    ds_read_b128 a[224:227], v224 offset:49728
    ds_read_b64_tr_b16 a[104:105], v254 offset:24640
    v_mfma_f32_16x16x32_bf16 v[200:203], a[20:23], a[228:231], v[200:203]
    ds_read_b128 a[228:231], v224 offset:49792
    v_mfma_f32_16x16x32_bf16 v[208:211], a[24:27], a[232:235], v[208:211]
    s_waitcnt vmcnt(11)
    buffer_load_dwordx4 v253, s[8:11], s57 offen offset:2048 lds
    v_mfma_f32_16x16x32_bf16 v[208:211], a[36:39], a[236:239], v[208:211]
    s_add_u32 s57, s49, 0x12000
    ds_read_b64_tr_b16 a[106:107], v255 offset:24640
    ds_read_b64_tr_b16 a[108:109], v254 offset:36864
    v_mfma_f32_16x16x32_bf16 v[204:207], a[28:31], a[232:235], v[204:207]
    s_add_u32 m0, s50, 0x6000
    ds_read_b64_tr_b16 a[110:111], v255 offset:36864
    ds_read_b64_tr_b16 a[112:113], v254 offset:36896
    v_mfma_f32_16x16x32_bf16 v[204:207], a[40:43], a[236:239], v[204:207]
    ds_read_b64_tr_b16 a[114:115], v255 offset:36896
    ds_read_b64_tr_b16 a[116:117], v254 offset:36928
    v_mfma_f32_16x16x32_bf16 v[200:203], a[32:35], a[232:235], v[200:203]
    ds_read_b128 a[232:235], v224 offset:49856
    ds_read_b64_tr_b16 a[118:119], v255 offset:36928
    v_mfma_f32_16x16x32_bf16 v[200:203], a[44:47], a[236:239], v[200:203]
    ds_read_b128 a[236:239], v227 offset:37120
    v_mfma_f32_16x16x32_bf16 v[208:211], a[48:51], a[240:243], v[208:211]
    v_mfma_f32_16x16x32_bf16 v[208:211], a[60:63], a[244:247], v[208:211]
    s_waitcnt lgkmcnt(8)
    buffer_load_dwordx4 v251, s[8:11], s57 offen lds
    v_mfma_f32_16x16x32_bf16 v[204:207], a[52:55], a[240:243], v[204:207]
    buffer_load_dwordx4 v252, s[8:11], s57 offen offset:1024 lds
    v_mfma_f32_16x16x32_bf16 v[204:207], a[64:67], a[244:247], v[204:207]
    v_mfma_f32_16x16x32_bf16 v[200:203], a[56:59], a[240:243], v[200:203]
    ds_read_b128 a[240:243], v227 offset:37184
    v_mfma_f32_16x16x32_bf16 v[200:203], a[68:71], a[244:247], v[200:203]
    ds_read_b128 a[244:247], v227 offset:37248
    v_cvt_pk_bf16_f32 v18, v208, v209
    v_mfma_f32_16x16x32_bf16 v[220:223], a[0:3], a[248:251], 0
    v_cvt_pk_bf16_f32 v19, v210, v211
    v_mfma_f32_16x16x32_bf16 v[220:223], a[12:15], a[252:255], v[220:223]
    v_cvt_pk_bf16_f32 v20, v204, v205
    v_cvt_pk_bf16_f32 v21, v206, v207
    v_mfma_f32_16x16x32_bf16 v[216:219], a[4:7], a[248:251], 0
    v_cvt_pk_bf16_f32 v22, v200, v201
    v_cvt_pk_bf16_f32 v23, v202, v203
    v_mfma_f32_16x16x32_bf16 v[216:219], a[16:19], a[252:255], v[216:219]
    s_waitcnt vmcnt(11)
    buffer_load_dwordx4 v253, s[8:11], s57 offen offset:2048 lds
    v_mfma_f32_16x16x32_bf16 v[212:215], a[8:11], a[248:251], 0
    s_add_u32 s57, s49, 0x1b000
    ds_read_b128 a[248:251], v227 offset:37312
    ds_read_b64_tr_b16 a[120:121], v254 offset:49152
    v_mfma_f32_16x16x32_bf16 v[212:215], a[20:23], a[252:255], v[212:215]
    s_add_u32 m0, s50, 0x9000
    ds_read_b128 a[252:255], v227 offset:37376
    v_mfma_f32_16x16x32_bf16 v[220:223], a[24:27], a[220:223], v[220:223]
    s_waitcnt lgkmcnt(4)
    buffer_load_dwordx4 v251, s[8:11], s57 offen lds
    v_mfma_f32_16x16x32_bf16 v[220:223], a[36:39], a[224:227], v[220:223]
    ds_read_b64_tr_b16 a[122:123], v255 offset:49152
    ds_read_b64_tr_b16 a[124:125], v254 offset:49184
    v_mfma_f32_16x16x32_bf16 v[216:219], a[28:31], a[220:223], v[216:219]
    ds_read_b64_tr_b16 a[126:127], v255 offset:49184
    ds_read_b64_tr_b16 a[128:129], v254 offset:49216
    v_mfma_f32_16x16x32_bf16 v[216:219], a[40:43], a[224:227], v[216:219]
    buffer_load_dwordx4 v252, s[8:11], s57 offen offset:1024 lds
    v_mfma_f32_16x16x32_bf16 v[212:215], a[32:35], a[220:223], v[212:215]
    ds_read_b128 a[220:223], v227 offset:37440
    ds_read_b64_tr_b16 a[130:131], v255 offset:49216
    v_mfma_f32_16x16x32_bf16 v[212:215], a[44:47], a[224:227], v[212:215]
    ds_read_b128 a[224:227], v224
    v_mfma_f32_16x16x32_bf16 v[220:223], a[48:51], a[228:231], v[220:223]
    v_mfma_f32_16x16x32_bf16 v[220:223], a[60:63], a[232:235], v[220:223]
    s_waitcnt vmcnt(11)
    buffer_load_dwordx4 v253, s[8:11], s57 offen offset:2048 lds
    v_mfma_f32_16x16x32_bf16 v[216:219], a[52:55], a[228:231], v[216:219]
    s_add_u32 s57, s49, 0x24000
    ds_read_b64_tr_b16 a[132:133], v254 offset:61440
    ds_read_b64_tr_b16 a[134:135], v255 offset:61440
    v_mfma_f32_16x16x32_bf16 v[216:219], a[64:67], a[232:235], v[216:219]
    s_add_u32 m0, s50, 0xc000
    ds_read_b64_tr_b16 a[136:137], v254 offset:61472
    v_cvt_pk_bf16_f32 v42, v220, v221
    v_mfma_f32_16x16x32_bf16 v[212:215], a[56:59], a[228:231], v[212:215]
    ds_read_b128 a[228:231], v224 offset:64
    v_cvt_pk_bf16_f32 v43, v222, v223
    v_mfma_f32_16x16x32_bf16 v[212:215], a[68:71], a[232:235], v[212:215]
    ds_read_b128 a[232:235], v224 offset:128
    v_cvt_pk_bf16_f32 v44, v216, v217
    v_mfma_f32_16x16x32_bf16 v[208:211], a[0:3], a[236:239], 0
    ds_read_b64_tr_b16 a[138:139], v255 offset:61472
    v_cvt_pk_bf16_f32 v45, v218, v219
    v_mfma_f32_16x16x32_bf16 v[208:211], a[12:15], a[240:243], v[208:211]
    s_waitcnt lgkmcnt(7)
    buffer_load_dwordx4 v251, s[8:11], s57 offen lds
    v_mfma_f32_16x16x32_bf16 v[204:207], a[4:7], a[236:239], 0
    v_cvt_pk_bf16_f32 v46, v212, v213
    v_cvt_pk_bf16_f32 v47, v214, v215
    v_mfma_f32_16x16x32_bf16 v[204:207], a[16:19], a[240:243], v[204:207]
    ds_read_b64_tr_b16 a[140:141], v254 offset:61504
    ds_read_b64_tr_b16 a[142:143], v255 offset:61504
    v_mfma_f32_16x16x32_bf16 v[200:203], a[8:11], a[236:239], 0
    ds_read_b128 a[236:239], v224 offset:192
    v_mfma_f32_16x16x32_bf16 v[200:203], a[20:23], a[240:243], v[200:203]
    ds_read_b128 a[240:243], v224 offset:256
    v_mfma_f32_16x16x32_bf16 v[208:211], a[24:27], a[244:247], v[208:211]
    buffer_load_dwordx4 v252, s[8:11], s57 offen offset:1024 lds
    v_mfma_f32_16x16x32_bf16 v[208:211], a[36:39], a[248:251], v[208:211]
    v_mfma_f32_16x16x32_bf16 v[204:207], a[28:31], a[244:247], v[204:207]
    s_waitcnt vmcnt(11)
    buffer_load_dwordx4 v253, s[8:11], s57 offen offset:2048 lds
    v_mfma_f32_16x16x32_bf16 v[204:207], a[40:43], a[248:251], v[204:207]
    s_add_u32 s57, s49, 0x2d000
    ds_read_b64_tr_b16 a[144:145], v254
    ds_read_b64_tr_b16 a[146:147], v255
    v_mfma_f32_16x16x32_bf16 v[200:203], a[32:35], a[244:247], v[200:203]
    s_add_u32 m0, s50, 0xf000
    ds_read_b128 a[244:247], v224 offset:320
    ds_read_b64_tr_b16 a[148:149], v254 offset:32
    v_mfma_f32_16x16x32_bf16 v[200:203], a[44:47], a[248:251], v[200:203]
    ds_read_b128 a[248:251], v224 offset:3072
    v_mfma_f32_16x16x32_bf16 v[208:211], a[48:51], a[252:255], v[208:211]
    s_waitcnt lgkmcnt(6)
    buffer_load_dwordx4 v251, s[8:11], s57 offen lds
    v_mfma_f32_16x16x32_bf16 v[208:211], a[60:63], a[220:223], v[208:211]
    ds_read_b64_tr_b16 a[150:151], v255 offset:32
    ds_read_b64_tr_b16 a[152:153], v254 offset:64
    v_mfma_f32_16x16x32_bf16 v[204:207], a[52:55], a[252:255], v[204:207]
    ds_read_b64_tr_b16 a[154:155], v255 offset:64
    v_mfma_f32_16x16x32_bf16 v[204:207], a[64:67], a[220:223], v[204:207]
    v_mfma_f32_16x16x32_bf16 v[200:203], a[56:59], a[252:255], v[200:203]
    ds_read_b128 a[252:255], v224 offset:3136
    v_mfma_f32_16x16x32_bf16 v[200:203], a[68:71], a[220:223], v[200:203]
    v_cvt_pk_bf16_f32 v54, v208, v209
    v_cvt_pk_bf16_f32 v55, v210, v211
    v_mfma_f32_16x16x32_bf16 v[220:223], a[224:227], a[72:75], 0
    ds_read_b128 a[220:223], v224 offset:3200
    v_mfma_f32_16x16x32_bf16 v[220:223], a[228:231], a[84:87], v[220:223]
    v_cvt_pk_bf16_f32 v56, v204, v205
    v_cvt_pk_bf16_f32 v57, v206, v207
    v_mfma_f32_16x16x32_bf16 v[216:219], a[224:227], a[76:79], 0
    v_cvt_pk_bf16_f32 v58, v200, v201
    v_cvt_pk_bf16_f32 v59, v202, v203
    v_mfma_f32_16x16x32_bf16 v[216:219], a[228:231], a[88:91], v[216:219]
    buffer_load_dwordx4 v252, s[8:11], s57 offen offset:1024 lds
    v_mfma_f32_16x16x32_bf16 v[212:215], a[224:227], a[80:83], 0
    s_waitcnt vmcnt(11)
    ds_read_b128 a[224:227], v224 offset:3264
    ds_read_b64_tr_b16 a[156:157], v254 offset:12288
    v_mfma_f32_16x16x32_bf16 v[212:215], a[228:231], a[92:95], v[212:215]
    ds_read_b128 a[228:231], v224 offset:3328
    v_mfma_f32_16x16x32_bf16 v[220:223], a[232:235], a[96:99], v[220:223]
    buffer_load_dwordx4 v253, s[8:11], s57 offen offset:2048 lds
    v_mfma_f32_16x16x32_bf16 v[220:223], a[236:239], a[108:111], v[220:223]
    s_add_u32 s57, s49, 0
    ds_read_b64_tr_b16 a[158:159], v255 offset:12288
    ds_read_b64_tr_b16 a[160:161], v254 offset:12320
    v_mfma_f32_16x16x32_bf16 v[216:219], a[232:235], a[100:103], v[216:219]
    s_add_u32 m0, s50, 0
    ds_read_b64_tr_b16 a[162:163], v255 offset:12320
    ds_read_b64_tr_b16 a[164:165], v254 offset:12352
    v_mfma_f32_16x16x32_bf16 v[216:219], a[236:239], a[112:115], v[216:219]
    s_waitcnt lgkmcnt(7)
    buffer_load_dwordx4 v192, s[12:15], s57 offen lds
    v_mfma_f32_16x16x32_bf16 v[212:215], a[232:235], a[104:107], v[212:215]
    ds_read_b128 a[232:235], v224 offset:3392
    ds_read_b64_tr_b16 a[166:167], v255 offset:12352
    v_mfma_f32_16x16x32_bf16 v[212:215], a[236:239], a[116:119], v[212:215]
    ds_read_b128 a[236:239], v224 offset:15488
    v_mfma_f32_16x16x32_bf16 v[220:223], a[240:243], a[120:123], v[220:223]
    buffer_load_dwordx4 v193, s[12:15], s57 offen offset:1024 lds
    v_mfma_f32_16x16x32_bf16 v[220:223], a[244:247], a[132:135], v[220:223]
    v_mfma_f32_16x16x32_bf16 v[216:219], a[240:243], a[124:127], v[216:219]
    s_waitcnt vmcnt(11)
    ds_read_b64_tr_b16 a[168:169], v254 offset:24576
    ds_read_b64_tr_b16 a[170:171], v255 offset:24576
    v_mfma_f32_16x16x32_bf16 v[216:219], a[244:247], a[136:139], v[216:219]
    ds_read_b64_tr_b16 a[172:173], v254 offset:24608
    ds_read_b64_tr_b16 a[174:175], v255 offset:24608
    v_mfma_f32_16x16x32_bf16 v[212:215], a[240:243], a[128:131], v[212:215]
    ds_read_b128 a[240:243], v224 offset:15552
    v_cvt_pk_bf16_f32 v66, v220, v221
    v_mfma_f32_16x16x32_bf16 v[212:215], a[244:247], a[140:143], v[212:215]
    ds_read_b128 a[244:247], v224 offset:15616
    v_cvt_pk_bf16_f32 v67, v222, v223
    v_mfma_f32_16x16x32_bf16 v[208:211], a[248:251], a[72:75], 0
    v_cvt_pk_bf16_f32 v88, v216, v217
    v_cvt_pk_bf16_f32 v89, v218, v219
    v_mfma_f32_16x16x32_bf16 v[208:211], a[252:255], a[84:87], v[208:211]
    buffer_load_dwordx4 v194, s[12:15], s57 offen offset:2048 lds
    v_mfma_f32_16x16x32_bf16 v[204:207], a[248:251], a[76:79], 0
    s_add_u32 s57, s49, 0x3000
    v_cvt_pk_bf16_f32 v110, v212, v213
    v_cvt_pk_bf16_f32 v111, v214, v215
    v_mfma_f32_16x16x32_bf16 v[204:207], a[252:255], a[88:91], v[204:207]
    s_add_u32 m0, s50, 0x3000
    ds_read_b64_tr_b16 a[176:177], v254 offset:24640
    ds_read_b64_tr_b16 a[178:179], v255 offset:24640
    v_mfma_f32_16x16x32_bf16 v[200:203], a[248:251], a[80:83], 0
    ds_read_b128 a[248:251], v224 offset:15680
    v_mfma_f32_16x16x32_bf16 v[200:203], a[252:255], a[92:95], v[200:203]
    ds_read_b128 a[252:255], v224 offset:15744
    v_mfma_f32_16x16x32_bf16 v[208:211], a[220:223], a[96:99], v[208:211]
    s_waitcnt lgkmcnt(5)
    buffer_load_dwordx4 v192, s[12:15], s57 offen lds
    v_mfma_f32_16x16x32_bf16 v[208:211], a[224:227], a[108:111], v[208:211]
    s_waitcnt vmcnt(10)
    buffer_load_dwordx4 v195, s[12:15], s57 offen offset:1024 lds
    v_mfma_f32_16x16x32_bf16 v[204:207], a[220:223], a[100:103], v[204:207]
    s_addk_i32 s57, 0x3000
    ds_read_b64_tr_b16 a[180:181], v254 offset:36864
    ds_read_b64_tr_b16 a[182:183], v255 offset:36864
    v_mfma_f32_16x16x32_bf16 v[204:207], a[224:227], a[112:115], v[204:207]
    ds_read_b64_tr_b16 a[184:185], v254 offset:36896
    ds_read_b64_tr_b16 a[186:187], v255 offset:36896
    v_mfma_f32_16x16x32_bf16 v[200:203], a[220:223], a[104:107], v[200:203]
    ds_read_b128 a[220:223], v224 offset:15808
    ds_read_b64_tr_b16 a[188:189], v254 offset:36928
    v_mfma_f32_16x16x32_bf16 v[200:203], a[224:227], a[116:119], v[200:203]
    ds_read_b128 a[224:227], v224 offset:18560
    v_mfma_f32_16x16x32_bf16 v[208:211], a[228:231], a[120:123], v[208:211]
    buffer_load_dwordx4 v194, s[12:15], s57 offen offset:2048 lds
    v_mfma_f32_16x16x32_bf16 v[208:211], a[232:235], a[132:135], v[208:211]
    s_add_u32 s57, s49, 0x4800
    ds_read_b64_tr_b16 a[190:191], v255 offset:36928
    s_add_u32 m0, s50, 0x6000
    v_mfma_f32_16x16x32_bf16 v[204:207], a[228:231], a[124:127], v[204:207]
    v_mfma_f32_16x16x32_bf16 v[204:207], a[232:235], a[136:139], v[204:207]
    s_waitcnt lgkmcnt(8)
    buffer_load_dwordx4 v192, s[12:15], s57 offen lds
    v_mfma_f32_16x16x32_bf16 v[200:203], a[228:231], a[128:131], v[200:203]
    ds_read_b128 a[228:231], v224 offset:18624
    v_cvt_pk_bf16_f32 v68, v208, v209
    v_mfma_f32_16x16x32_bf16 v[200:203], a[232:235], a[140:143], v[200:203]
    ds_read_b128 a[232:235], v224 offset:18688
    v_cvt_pk_bf16_f32 v69, v210, v211
    v_mfma_f32_16x16x32_bf16 v[220:223], a[236:239], a[72:75], 0
    v_cvt_pk_bf16_f32 v90, v204, v205
    v_cvt_pk_bf16_f32 v91, v206, v207
    v_mfma_f32_16x16x32_bf16 v[220:223], a[240:243], a[84:87], v[220:223]
    v_mfma_f32_16x16x32_bf16 v[216:219], a[236:239], a[76:79], 0
    buffer_load_dwordx4 v193, s[12:15], s57 offen offset:1024 lds
    v_mfma_f32_16x16x32_bf16 v[216:219], a[240:243], a[88:91], v[216:219]
    v_cvt_pk_bf16_f32 v112, v200, v201
    v_cvt_pk_bf16_f32 v113, v202, v203
    v_mfma_f32_16x16x32_bf16 v[212:215], a[236:239], a[80:83], 0
    s_waitcnt vmcnt(11)
    ds_read_b128 a[236:239], v224 offset:18752
    ds_read_b64_tr_b16 a[192:193], v254 offset:49152
    v_mfma_f32_16x16x32_bf16 v[212:215], a[240:243], a[92:95], v[212:215]
    ds_read_b128 a[240:243], v224 offset:18816
    v_mfma_f32_16x16x32_bf16 v[220:223], a[244:247], a[96:99], v[220:223]
    buffer_load_dwordx4 v194, s[12:15], s57 offen offset:2048 lds
    v_mfma_f32_16x16x32_bf16 v[220:223], a[248:251], a[108:111], v[220:223]
    s_add_u32 s57, s49, 0x9000
    ds_read_b64_tr_b16 a[194:195], v255 offset:49152
    ds_read_b64_tr_b16 a[196:197], v254 offset:49184
    v_mfma_f32_16x16x32_bf16 v[216:219], a[244:247], a[100:103], v[216:219]
    s_add_u32 m0, s50, 0x9000
    ds_read_b64_tr_b16 a[198:199], v255 offset:49184
    ds_read_b64_tr_b16 a[200:201], v254 offset:49216
    v_mfma_f32_16x16x32_bf16 v[216:219], a[248:251], a[112:115], v[216:219]
    ds_read_b64_tr_b16 a[202:203], v255 offset:49216
    v_mfma_f32_16x16x32_bf16 v[212:215], a[244:247], a[104:107], v[212:215]
    ds_read_b128 a[244:247], v224 offset:18880
    v_mfma_f32_16x16x32_bf16 v[212:215], a[248:251], a[116:119], v[212:215]
    ds_read_b128 a[248:251], v227 offset:6144
    v_mfma_f32_16x16x32_bf16 v[220:223], a[252:255], a[120:123], v[220:223]
    s_waitcnt lgkmcnt(9)
    buffer_load_dwordx4 v192, s[12:15], s57 offen lds
    v_mfma_f32_16x16x32_bf16 v[220:223], a[220:223], a[132:135], v[220:223]
    v_mfma_f32_16x16x32_bf16 v[216:219], a[252:255], a[124:127], v[216:219]
    buffer_load_dwordx4 v193, s[12:15], s57 offen offset:1024 lds
    v_mfma_f32_16x16x32_bf16 v[216:219], a[220:223], a[136:139], v[216:219]
    s_waitcnt vmcnt(11)
    ds_read_b64_tr_b16 a[204:205], v254 offset:61440
    ds_read_b64_tr_b16 a[206:207], v255 offset:61440
    v_mfma_f32_16x16x32_bf16 v[212:215], a[252:255], a[128:131], v[212:215]
    ds_read_b128 a[252:255], v227 offset:6208
    ds_read_b64_tr_b16 a[208:209], v254 offset:61472
    v_mfma_f32_16x16x32_bf16 v[212:215], a[220:223], a[140:143], v[212:215]
    v_cvt_pk_bf16_f32 v72, v220, v221
    v_cvt_pk_bf16_f32 v73, v222, v223
    v_mfma_f32_16x16x32_bf16 v[208:211], a[224:227], a[72:75], 0
    v_cvt_pk_bf16_f32 v94, v216, v217
    v_cvt_pk_bf16_f32 v95, v218, v219
    v_mfma_f32_16x16x32_bf16 v[208:211], a[228:231], a[84:87], v[208:211]
    ds_read_b128 a[220:223], v227 offset:6272
    ds_read_b64_tr_b16 a[210:211], v255 offset:61472
    v_mfma_f32_16x16x32_bf16 v[204:207], a[224:227], a[76:79], 0
    v_cvt_pk_bf16_f32 v116, v212, v213
    v_cvt_pk_bf16_f32 v117, v214, v215
    v_mfma_f32_16x16x32_bf16 v[204:207], a[228:231], a[88:91], v[204:207]
    buffer_load_dwordx4 v194, s[12:15], s57 offen offset:2048 lds
    v_mfma_f32_16x16x32_bf16 v[200:203], a[224:227], a[80:83], 0
    s_add_u32 s57, s49, 0xc000
    ds_read_b128 a[224:227], v227 offset:6336
    ds_read_b64_tr_b16 a[212:213], v254 offset:61504
    v_mfma_f32_16x16x32_bf16 v[200:203], a[228:231], a[92:95], v[200:203]
    s_add_u32 m0, s50, 0xc000
    ds_read_b128 a[228:231], v227 offset:6400
    v_mfma_f32_16x16x32_bf16 v[208:211], a[232:235], a[96:99], v[208:211]
    s_waitcnt lgkmcnt(6)
    buffer_load_dwordx4 v192, s[12:15], s57 offen lds
    v_mfma_f32_16x16x32_bf16 v[208:211], a[236:239], a[108:111], v[208:211]
    ds_read_b64_tr_b16 a[214:215], v255 offset:61504
    v_mfma_f32_16x16x32_bf16 v[204:207], a[232:235], a[100:103], v[204:207]
    v_mfma_f32_16x16x32_bf16 v[204:207], a[236:239], a[112:115], v[204:207]
    buffer_load_dwordx4 v195, s[12:15], s57 offen offset:1024 lds
    v_mfma_f32_16x16x32_bf16 v[200:203], a[232:235], a[104:107], v[200:203]
    s_addk_i32 s57, 0x3000
    ds_read_b128 a[232:235], v227 offset:6464
    v_mfma_f32_16x16x32_bf16 v[200:203], a[236:239], a[116:119], v[200:203]
    ds_read_b128 a[236:239], v225 offset:24384
    v_mfma_f32_16x16x32_bf16 v[208:211], a[240:243], a[120:123], v[208:211]
    v_mfma_f32_16x16x32_bf16 v[208:211], a[244:247], a[132:135], v[208:211]
    buffer_load_dwordx4 v194, s[12:15], s57 offen offset:2048 lds
    v_mfma_f32_16x16x32_bf16 v[204:207], a[240:243], a[124:127], v[204:207]
    s_add_u32 s57, s49, 0xd800
    s_add_u32 m0, s50, 0xf000
    v_mfma_f32_16x16x32_bf16 v[204:207], a[244:247], a[136:139], v[204:207]
    v_mfma_f32_16x16x32_bf16 v[200:203], a[240:243], a[128:131], v[200:203]
    ds_read_b128 a[240:243], v225 offset:24448
    v_mfma_f32_16x16x32_bf16 v[200:203], a[244:247], a[140:143], v[200:203]
    v_cvt_pk_bf16_f32 v70, v208, v209
    v_cvt_pk_bf16_f32 v71, v210, v211
    v_mfma_f32_16x16x32_bf16 v[220:223], a[248:251], a[72:75], 0
    ds_read_b128 a[244:247], v225 offset:24512
    v_mfma_f32_16x16x32_bf16 v[220:223], a[252:255], a[84:87], v[220:223]
    v_cvt_pk_bf16_f32 v92, v204, v205
    v_cvt_pk_bf16_f32 v93, v206, v207
    v_mfma_f32_16x16x32_bf16 v[216:219], a[248:251], a[76:79], 0
    v_cvt_pk_bf16_f32 v114, v200, v201
    v_cvt_pk_bf16_f32 v115, v202, v203
    v_mfma_f32_16x16x32_bf16 v[216:219], a[252:255], a[88:91], v[216:219]
    s_waitcnt lgkmcnt(2)
    buffer_load_dwordx4 v192, s[12:15], s57 offen lds
    v_mfma_f32_16x16x32_bf16 v[212:215], a[248:251], a[80:83], 0
    ds_read_b128 a[248:251], v225 offset:24576
    v_mfma_f32_16x16x32_bf16 v[212:215], a[252:255], a[92:95], v[212:215]
    ds_read_b128 a[252:255], v225 offset:24640
    v_mfma_f32_16x16x32_bf16 v[220:223], a[220:223], a[96:99], v[220:223]
    buffer_load_dwordx4 v193, s[12:15], s57 offen offset:1024 lds
    v_mfma_f32_16x16x32_bf16 v[220:223], a[224:227], a[108:111], v[220:223]
    v_mfma_f32_16x16x32_bf16 v[216:219], a[220:223], a[100:103], v[216:219]
    buffer_load_dwordx4 v194, s[12:15], s57 offen offset:2048 lds
    v_mfma_f32_16x16x32_bf16 v[216:219], a[224:227], a[112:115], v[216:219]
    s_add_u32 m0, s41, 0
    v_mfma_f32_16x16x32_bf16 v[212:215], a[220:223], a[104:107], v[212:215]
    ds_read_b128 a[220:223], v225 offset:24704
    v_mfma_f32_16x16x32_bf16 v[212:215], a[224:227], a[116:119], v[212:215]
    ds_read_b128 a[224:227], v225 offset:27456
    v_mfma_f32_16x16x32_bf16 v[220:223], a[228:231], a[120:123], v[220:223]
    v_mfma_f32_16x16x32_bf16 v[220:223], a[232:235], a[132:135], v[220:223]
    v_mfma_f32_16x16x32_bf16 v[216:219], a[228:231], a[124:127], v[216:219]
    v_mfma_f32_16x16x32_bf16 v[216:219], a[232:235], a[136:139], v[216:219]
    v_mfma_f32_16x16x32_bf16 v[212:215], a[228:231], a[128:131], v[212:215]
    ds_read_b128 a[228:231], v225 offset:27520
    v_mfma_f32_16x16x32_bf16 v[212:215], a[232:235], a[140:143], v[212:215]
    ds_read_b128 a[232:235], v225 offset:27584
    v_mfma_f32_16x16x32_bf16 v[208:211], a[144:147], a[236:239], 0
    s_waitcnt lgkmcnt(3)
    v_mfma_f32_16x16x32_bf16 v[208:211], a[156:159], a[240:243], v[208:211]
    v_cvt_pk_bf16_f32 v82, v220, v221
    v_cvt_pk_bf16_f32 v83, v222, v223
    v_mfma_f32_16x16x32_bf16 v[204:207], a[148:151], a[236:239], 0
    v_cvt_pk_bf16_f32 v104, v216, v217
    v_cvt_pk_bf16_f32 v105, v218, v219
    v_mfma_f32_16x16x32_bf16 v[204:207], a[160:163], a[240:243], v[204:207]
    v_cvt_pk_bf16_f32 v126, v212, v213
    v_cvt_pk_bf16_f32 v127, v214, v215
    v_mfma_f32_16x16x32_bf16 v[200:203], a[152:155], a[236:239], 0
    ds_read_b128 a[236:239], v225 offset:27648
    v_mfma_f32_16x16x32_bf16 v[200:203], a[164:167], a[240:243], v[200:203]
    ds_read_b128 a[240:243], v225 offset:27712
    v_mfma_f32_16x16x32_bf16 v[208:211], a[168:171], a[244:247], v[208:211]
    v_mfma_f32_16x16x32_bf16 v[208:211], a[180:183], a[248:251], v[208:211]
    v_mfma_f32_16x16x32_bf16 v[204:207], a[172:175], a[244:247], v[204:207]
    v_mfma_f32_16x16x32_bf16 v[204:207], a[184:187], a[248:251], v[204:207]
    v_mfma_f32_16x16x32_bf16 v[200:203], a[176:179], a[244:247], v[200:203]
    ds_read_b128 a[244:247], v225 offset:27776
    v_mfma_f32_16x16x32_bf16 v[200:203], a[188:191], a[248:251], v[200:203]
    ds_read_b128 a[248:251], v224 offset:30976
    v_mfma_f32_16x16x32_bf16 v[208:211], a[192:195], a[252:255], v[208:211]
    v_mfma_f32_16x16x32_bf16 v[208:211], a[204:207], a[220:223], v[208:211]
    v_mfma_f32_16x16x32_bf16 v[204:207], a[196:199], a[252:255], v[204:207]
    v_mfma_f32_16x16x32_bf16 v[204:207], a[208:211], a[220:223], v[204:207]
    v_mfma_f32_16x16x32_bf16 v[200:203], a[200:203], a[252:255], v[200:203]
    s_waitcnt lgkmcnt(1)
    ds_read_b128 a[252:255], v224 offset:31040
    v_mfma_f32_16x16x32_bf16 v[200:203], a[212:215], a[220:223], v[200:203]
    s_barrier
    ds_read_b128 a[220:223], v224 offset:31104
    v_mfma_f32_16x16x32_bf16 v[220:223], a[144:147], a[224:227], 0
    v_cvt_pk_bf16_f32 v132, v208, v209
    v_cvt_pk_bf16_f32 v133, v210, v211
    v_mfma_f32_16x16x32_bf16 v[220:223], a[156:159], a[228:231], v[220:223]
    v_cvt_pk_bf16_f32 v134, v204, v205
    v_cvt_pk_bf16_f32 v135, v206, v207
    v_mfma_f32_16x16x32_bf16 v[216:219], a[148:151], a[224:227], 0
    v_cvt_pk_bf16_f32 v136, v200, v201
    v_cvt_pk_bf16_f32 v137, v202, v203
    v_mfma_f32_16x16x32_bf16 v[216:219], a[160:163], a[228:231], v[216:219]
    buffer_load_dwordx4 v246, s[4:7], s56 offen lds
    v_mfma_f32_16x16x32_bf16 v[144:147], v[0:3], v[132:135], v[144:147]
    buffer_load_dwordx4 v247, s[4:7], s56 offen offset:1024 lds
    v_mfma_f32_16x16x32_bf16 v[148:151], v[24:27], v[132:135], v[148:151]
    s_add_u32 s56, s56, s42
    s_add_u32 m0, s41, 0x1e40
    v_mfma_f32_16x16x32_bf16 v[152:155], v[30:33], v[132:135], v[152:155]
    v_mfma_f32_16x16x32_bf16 v[156:159], v[6:9], v[132:135], v[156:159]
    v_mfma_f32_16x16x16_bf16 v[144:147], v[4:5], v[136:137], v[144:147]
    buffer_load_dwordx4 v246, s[4:7], s56 offen lds
    v_mfma_f32_16x16x16_bf16 v[148:151], v[28:29], v[136:137], v[148:151]
    v_mfma_f32_16x16x32_bf16 v[160:163], v[12:15], v[132:135], v[160:163]
    v_mfma_f32_16x16x32_bf16 v[164:167], v[36:39], v[132:135], v[164:167]
    v_mfma_f32_16x16x16_bf16 v[152:155], v[34:35], v[136:137], v[152:155]
    buffer_load_dwordx4 v247, s[4:7], s56 offen offset:1024 lds
    v_mfma_f32_16x16x16_bf16 v[156:159], v[10:11], v[136:137], v[156:159]
    s_add_u32 s56, s56, s42
    v_max3_f32 v248, v144, v145, v146
    s_add_u32 m0, s41, 0x3c80
    v_mfma_f32_16x16x16_bf16 v[160:163], v[16:17], v[136:137], v[160:163]
    v_max3_f32 v249, v147, v148, v149
    v_max3_f32 v248, v248, v150, v151
    v_mfma_f32_16x16x16_bf16 v[164:167], v[40:41], v[136:137], v[164:167]
    v_max3_f32 v249, v249, v152, v153
    v_max3_f32 v248, v248, v154, v155
    v_mfma_f32_16x16x32_bf16 v[168:171], v[42:45], v[132:135], v[168:171]
    buffer_load_dwordx4 v246, s[4:7], s56 offen lds
    v_mfma_f32_16x16x32_bf16 v[172:175], v[18:21], v[132:135], v[172:175]
    v_max3_f32 v249, v249, v156, v157
    v_max3_f32 v248, v248, v158, v159
    v_mfma_f32_16x16x32_bf16 v[212:215], a[152:155], a[224:227], 0
    ds_read_b128 a[224:227], v224 offset:31168
    v_max3_f32 v249, v249, v160, v161
    v_mfma_f32_16x16x32_bf16 v[212:215], a[164:167], a[228:231], v[212:215]
    ds_read_b128 a[228:231], v224 offset:31232
    v_max3_f32 v248, v248, v162, v163
    v_mfma_f32_16x16x16_bf16 v[168:171], v[46:47], v[136:137], v[168:171]
    v_max3_f32 v249, v249, v164, v165
    v_max3_f32 v248, v248, v166, v167
    v_mfma_f32_16x16x16_bf16 v[172:175], v[22:23], v[136:137], v[172:175]
    buffer_load_dwordx4 v247, s[4:7], s56 offen offset:1024 lds
    v_mfma_f32_16x16x32_bf16 v[220:223], a[168:171], a[232:235], v[220:223]
    s_add_u32 s56, s56, s42
    s_add_u32 m0, s41, 0x5ac0
    v_mfma_f32_16x16x32_bf16 v[220:223], a[180:183], a[236:239], v[220:223]
    v_max3_f32 v249, v249, v168, v169
    v_max3_f32 v248, v248, v170, v171
    v_mfma_f32_16x16x32_bf16 v[216:219], a[172:175], a[232:235], v[216:219]
    v_max3_f32 v249, v249, v172, v173
    v_max3_f32 v248, v248, v174, v175
    v_mfma_f32_16x16x32_bf16 v[216:219], a[184:187], a[236:239], v[216:219]
    buffer_load_dwordx4 v246, s[4:7], s56 offen lds
    v_mfma_f32_16x16x32_bf16 v[212:215], a[176:179], a[232:235], v[212:215]
    ds_read_b128 a[232:235], v224 offset:31296
    v_max_f32 v248, v248, v249
    v_mfma_f32_16x16x32_bf16 v[212:215], a[188:191], a[236:239], v[212:215]
    ds_read_b128 a[236:239], v224 offset:34048
    v_mov_b32 v249, v248
    v_mfma_f32_16x16x32_bf16 v[220:223], a[192:195], a[240:243], v[220:223]
    v_mfma_f32_16x16x32_bf16 v[220:223], a[204:207], a[244:247], v[220:223]
    buffer_load_dwordx4 v247, s[4:7], s56 offen offset:1024 lds
    v_mfma_f32_16x16x32_bf16 v[216:219], a[196:199], a[240:243], v[216:219]
    s_add_u32 s56, s56, s42
    v_permlane16_swap_b32 v248, v249
    v_mfma_f32_16x16x32_bf16 v[216:219], a[208:211], a[244:247], v[216:219]
    s_add_u32 m0, s41, 0x7900
    v_max_f32 v248, v248, v249
    v_mov_b32 v249, v248
    v_mfma_f32_16x16x32_bf16 v[212:215], a[200:203], a[240:243], v[212:215]
    v_cvt_pk_bf16_f32 v138, v220, v221
    v_cvt_pk_bf16_f32 v139, v222, v223
    v_mfma_f32_16x16x32_bf16 v[212:215], a[212:215], a[244:247], v[212:215]
    s_waitcnt lgkmcnt(2)
    ds_read_b128 a[240:243], v224 offset:34112
    v_cvt_pk_bf16_f32 v140, v216, v217
    v_mfma_f32_16x16x32_bf16 v[208:211], a[248:251], a[72:75], 0
    ds_read_b128 a[244:247], v224 offset:34176
    v_cvt_pk_bf16_f32 v141, v218, v219
    v_mfma_f32_16x16x32_bf16 v[208:211], a[252:255], a[84:87], v[208:211]
    v_permlane32_swap_b32 v248, v249
    v_mfma_f32_16x16x32_bf16 v[204:207], a[248:251], a[76:79], 0
    v_cvt_pk_bf16_f32 v142, v212, v213
    v_cvt_pk_bf16_f32 v143, v214, v215
    v_mfma_f32_16x16x32_bf16 v[204:207], a[252:255], a[88:91], v[204:207]
    v_max_f32 v248, v248, v249
    v_mul_f32 v236, s37, v248
    v_mfma_f32_16x16x32_bf16 v[200:203], a[248:251], a[80:83], 0
    ds_read_b128 a[248:251], v224 offset:34240
    v_fma_f32 v144, v144, s37, -v236
    v_mfma_f32_16x16x32_bf16 v[200:203], a[252:255], a[92:95], v[200:203]
    ds_read_b128 a[252:255], v224 offset:34304
    v_fma_f32 v145, v145, s37, -v236
    v_mfma_f32_16x16x32_bf16 v[208:211], a[220:223], a[96:99], v[208:211]
    v_fma_f32 v146, v146, s37, -v236
    v_fma_f32 v147, v147, s37, -v236
    v_mfma_f32_16x16x32_bf16 v[208:211], a[224:227], a[108:111], v[208:211]
    v_exp_f32 v144, v144
    v_mfma_f32_16x16x32_bf16 v[204:207], a[220:223], a[100:103], v[204:207]
    v_exp_f32 v145, v145
    v_mfma_f32_16x16x32_bf16 v[204:207], a[224:227], a[112:115], v[204:207]
    v_exp_f32 v146, v146
    v_mfma_f32_16x16x32_bf16 v[200:203], a[220:223], a[104:107], v[200:203]
    ds_read_b128 a[220:223], v224 offset:34368
    v_cvt_pk_bf16_f32 v176, v144, v145
    v_mfma_f32_16x16x32_bf16 v[200:203], a[224:227], a[116:119], v[200:203]
    ds_read_b128 a[224:227], v224 offset:46464
    v_fma_f32 v148, v148, s37, -v236
    v_mfma_f32_16x16x32_bf16 v[208:211], a[228:231], a[120:123], v[208:211]
    s_waitcnt lgkmcnt(3)
    v_exp_f32 v147, v147
    v_mfma_f32_16x16x32_bf16 v[208:211], a[232:235], a[132:135], v[208:211]
    v_cvt_pk_bf16_f32 v177, v146, v147
    v_fma_f32 v149, v149, s37, -v236
    v_mfma_f32_16x16x32_bf16 v[204:207], a[228:231], a[124:127], v[204:207]
    ds_read_b128 v[144:147], v234
    v_bfe_u32 v234, s63, v233, 4
    v_mfma_f32_16x16x32_bf16 v[204:207], a[232:235], a[136:139], v[204:207]
    v_mad_u32_u24 v234, v234, s40, v231
    v_fma_f32 v150, v150, s37, -v236
    v_mfma_f32_16x16x32_bf16 v[200:203], a[228:231], a[128:131], v[200:203]
    v_cvt_pk_bf16_f32 v74, v208, v209
    v_cvt_pk_bf16_f32 v75, v210, v211
    v_mfma_f32_16x16x32_bf16 v[200:203], a[232:235], a[140:143], v[200:203]
    ds_read_b128 a[228:231], v224 offset:46528
    ds_read_b128 a[232:235], v224 offset:46592
    v_mfma_f32_16x16x32_bf16 v[220:223], a[236:239], a[72:75], 0
    v_cvt_pk_bf16_f32 v96, v204, v205
    v_cvt_pk_bf16_f32 v97, v206, v207
    v_mfma_f32_16x16x32_bf16 v[220:223], a[240:243], a[84:87], v[220:223]
    v_fma_f32 v151, v151, s37, -v236
    v_fma_f32 v152, v152, s37, -v236
    v_mfma_f32_16x16x32_bf16 v[216:219], a[236:239], a[76:79], 0
    v_cvt_pk_bf16_f32 v118, v200, v201
    v_cvt_pk_bf16_f32 v119, v202, v203
    v_mfma_f32_16x16x32_bf16 v[216:219], a[240:243], a[88:91], v[216:219]
    s_waitcnt lgkmcnt(2)
    v_exp_f32 v148, v148
    v_mfma_f32_16x16x32_bf16 v[144:147], v[24:27], v[138:141], v[144:147]
    v_exp_f32 v149, v149
    v_mfma_f32_16x16x32_bf16 v[212:215], a[236:239], a[80:83], 0
    ds_read_b128 a[236:239], v224 offset:46656
    v_cvt_pk_bf16_f32 v178, v148, v149
    v_mfma_f32_16x16x32_bf16 v[212:215], a[240:243], a[92:95], v[212:215]
    ds_read_b128 a[240:243], v224 offset:46720
    v_fma_f32 v153, v153, s37, -v236
    v_mfma_f32_16x16x16_bf16 v[144:147], v[28:29], v[142:143], v[144:147]
    v_exp_f32 v150, v150
    v_mfma_f32_16x16x32_bf16 v[220:223], a[244:247], a[96:99], v[220:223]
    v_exp_f32 v151, v151
    v_mfma_f32_16x16x32_bf16 v[220:223], a[248:251], a[108:111], v[220:223]
    v_cvt_pk_bf16_f32 v179, v150, v151
    v_fma_f32 v154, v154, s37, -v236
    v_mfma_f32_16x16x32_bf16 v[216:219], a[244:247], a[100:103], v[216:219]
    ds_read_b128 v[148:151], v235
    v_bfe_u32 v235, s64, v233, 4
    v_mfma_f32_16x16x32_bf16 v[216:219], a[248:251], a[112:115], v[216:219]
    v_mad_u32_u24 v235, v235, s40, v231
    v_fma_f32 v155, v155, s37, -v236
    v_mfma_f32_16x16x32_bf16 v[196:199], a[216:219], v[176:179], 0
    v_exp_f32 v152, v152
    v_mfma_f32_16x16x32_bf16 v[184:187], v[66:69], v[176:179], 0
    v_exp_f32 v153, v153
    v_mfma_f32_16x16x32_bf16 v[188:191], v[88:91], v[176:179], 0
    v_exp_f32 v154, v154
    v_mfma_f32_16x16x32_bf16 v[192:195], v[110:113], v[176:179], 0
    v_exp_f32 v155, v155
    v_mfma_f32_16x16x32_bf16 v[212:215], a[244:247], a[104:107], v[212:215]
    ds_read_b128 a[244:247], v224 offset:46784
    v_cvt_pk_bf16_f32 v180, v152, v153
    v_mfma_f32_16x16x32_bf16 v[212:215], a[248:251], a[116:119], v[212:215]
    s_waitcnt vmcnt(20) lgkmcnt(1)
    ds_read_b64_tr_b16 a[248:249], v86 offset:12288
    ds_read_b64_tr_b16 a[250:251], v86 offset:13824
    v_mfma_f32_16x16x32_bf16 v[148:151], v[30:33], v[138:141], v[148:151]
    v_cvt_pk_bf16_f32 v181, v154, v155
    v_fma_f32 v156, v156, s37, -v236
    v_mfma_f32_16x16x32_bf16 v[220:223], a[252:255], a[120:123], v[220:223]
    ds_read_b128 v[152:155], v230 offset:1920
    v_fma_f32 v157, v157, s37, -v236
    v_mfma_f32_16x16x32_bf16 v[220:223], a[220:223], a[132:135], v[220:223]
    v_fma_f32 v158, v158, s37, -v236
    v_fma_f32 v159, v159, s37, -v236
    v_mfma_f32_16x16x16_bf16 v[148:151], v[34:35], v[142:143], v[148:151]
    v_exp_f32 v156, v156
    v_mfma_f32_16x16x32_bf16 v[216:219], a[252:255], a[124:127], v[216:219]
    v_exp_f32 v157, v157
    v_mfma_f32_16x16x32_bf16 v[216:219], a[220:223], a[136:139], v[216:219]
    v_exp_f32 v158, v158
    v_mfma_f32_16x16x32_bf16 v[212:215], a[252:255], a[128:131], v[212:215]
    v_cvt_pk_bf16_f32 v76, v220, v221
    v_cvt_pk_bf16_f32 v77, v222, v223
    v_mfma_f32_16x16x32_bf16 v[212:215], a[220:223], a[140:143], v[212:215]
    ds_read_b64_tr_b16 a[252:253], v86 offset:12320
    ds_read_b64_tr_b16 a[254:255], v86 offset:13856
    v_mfma_f32_16x16x32_bf16 v[208:211], a[224:227], a[72:75], 0
    s_waitcnt vmcnt(4) lgkmcnt(2)
    v_cvt_pk_bf16_f32 v98, v216, v217
    v_cvt_pk_bf16_f32 v99, v218, v219
    v_mfma_f32_16x16x32_bf16 v[208:211], a[228:231], a[84:87], v[208:211]
    s_barrier
    ds_read_b128 v[252:255], v224 offset:320
    v_cvt_pk_bf16_f32 v120, v212, v213
    v_mfma_f32_16x16x32_bf16 v[152:155], v[36:39], v[138:141], v[152:155]
    ds_read_b64_tr_b16 a[220:221], v86 offset:12352
    v_cvt_pk_bf16_f32 v121, v214, v215
    v_mfma_f32_16x16x32_bf16 v[204:207], a[224:227], a[76:79], 0
    ds_read_b64_tr_b16 a[222:223], v86 offset:13888
    v_cvt_pk_bf16_f32 v182, v156, v157
    v_mfma_f32_16x16x32_bf16 v[204:207], a[228:231], a[88:91], v[204:207]
    v_exp_f32 v159, v159
    v_mfma_f32_16x16x16_bf16 v[152:155], v[40:41], v[142:143], v[152:155]
    v_cvt_pk_bf16_f32 v183, v158, v159
    v_fma_f32 v160, v160, s37, -v236
    v_mfma_f32_16x16x32_bf16 v[200:203], a[224:227], a[80:83], 0
    ds_read_b128 v[156:159], v250
    v_bfe_u32 v250, s65, v232, 4
    v_mfma_f32_16x16x32_bf16 v[200:203], a[228:231], a[92:95], v[200:203]
    ds_read_b128 a[224:227], v224 offset:49536
    v_fma_f32 v161, v161, s37, -v236
    v_mfma_f32_16x16x32_bf16 v[196:199], a[216:219], v[180:183], v[196:199]
    ds_read_b128 a[228:231], v224 offset:49600
    v_fma_f32 v162, v162, s37, -v236
    v_mfma_f32_16x16x32_bf16 v[184:187], v[70:73], v[180:183], v[184:187]
    v_fma_f32 v163, v163, s37, -v236
    v_fma_f32 v164, v164, s37, -v236
    v_mfma_f32_16x16x32_bf16 v[188:191], v[92:95], v[180:183], v[188:191]
    v_exp_f32 v160, v160
    v_mfma_f32_16x16x32_bf16 v[192:195], v[114:117], v[180:183], v[192:195]
    v_exp_f32 v161, v161
    v_mfma_f32_16x16x32_bf16 v[208:211], a[232:235], a[96:99], v[208:211]
    v_exp_f32 v162, v162
    v_mfma_f32_16x16x32_bf16 v[208:211], a[236:239], a[108:111], v[208:211]
    s_waitcnt lgkmcnt(2)
    v_exp_f32 v163, v163
    v_mfma_f32_16x16x32_bf16 v[156:159], v[42:45], v[138:141], v[156:159]
    v_cvt_pk_bf16_f32 v176, v160, v161
    v_cvt_pk_bf16_f32 v177, v162, v163
    v_mfma_f32_16x16x32_bf16 v[204:207], a[232:235], a[100:103], v[204:207]
    ds_read_b128 v[160:163], v234
    v_mad_u32_u24 v234, v250, s40, v229
    v_mfma_f32_16x16x32_bf16 v[204:207], a[236:239], a[112:115], v[204:207]
    v_mad_u32_u24 v250, v250, s40, v228
    v_fma_f32 v165, v165, s37, -v236
    v_mfma_f32_16x16x16_bf16 v[156:159], v[46:47], v[142:143], v[156:159]
    s_waitcnt vmcnt(0)
    ds_write_b128 v87, a[248:251] offset:12288
    v_mfma_f32_16x16x32_bf16 v[200:203], a[232:235], a[104:107], v[200:203]
    ds_write_b128 v87, a[252:255] offset:13312
    v_mfma_f32_16x16x32_bf16 v[200:203], a[236:239], a[116:119], v[200:203]
    ds_write_b128 v87, a[220:223] offset:14336
    v_mfma_f32_16x16x32_bf16 v[208:211], a[240:243], a[120:123], v[208:211]
    v_fma_f32 v166, v166, s37, -v236
    v_fma_f32 v167, v167, s37, -v236
    v_mfma_f32_16x16x32_bf16 v[208:211], a[244:247], a[132:135], v[208:211]
    s_waitcnt lgkmcnt(3)
    v_exp_f32 v164, v164
    v_mfma_f32_16x16x32_bf16 v[160:163], v[48:51], v[138:141], v[160:163]
    v_exp_f32 v165, v165
    v_mfma_f32_16x16x32_bf16 v[204:207], a[240:243], a[124:127], v[204:207]
    v_exp_f32 v166, v166
    v_mfma_f32_16x16x32_bf16 v[204:207], a[244:247], a[136:139], v[204:207]
    v_exp_f32 v167, v167
    v_mfma_f32_16x16x32_bf16 v[200:203], a[240:243], a[128:131], v[200:203]
    v_cvt_pk_bf16_f32 v80, v208, v209
    v_cvt_pk_bf16_f32 v81, v210, v211
    v_mfma_f32_16x16x32_bf16 v[200:203], a[244:247], a[140:143], v[200:203]
    v_cvt_pk_bf16_f32 v178, v164, v165
    v_cvt_pk_bf16_f32 v179, v166, v167
    v_mfma_f32_16x16x16_bf16 v[160:163], v[52:53], v[142:143], v[160:163]
    ds_read_b128 v[164:167], v235
    v_bfe_u32 v235, s62, v232, 4
    v_mfma_f32_16x16x32_bf16 v[196:199], a[216:219], v[176:179], v[196:199]
    v_cvt_pk_bf16_f32 v102, v204, v205
    v_cvt_pk_bf16_f32 v103, v206, v207
    v_mfma_f32_16x16x32_bf16 v[184:187], v[74:77], v[176:179], v[184:187]
    v_cvt_pk_bf16_f32 v124, v200, v201
    v_cvt_pk_bf16_f32 v125, v202, v203
    v_mfma_f32_16x16x32_bf16 v[188:191], v[96:99], v[176:179], v[188:191]
    ds_read_b128 a[232:235], v224 offset:49664
    ds_read_b128 a[236:239], v224 offset:49728
    v_mfma_f32_16x16x32_bf16 v[192:195], v[118:121], v[176:179], v[192:195]
    ds_read_b128 a[240:243], v224 offset:49792
    v_fma_f32 v168, v168, s37, -v236
    v_mfma_f32_16x16x32_bf16 v[220:223], a[224:227], a[72:75], 0
    ds_read_b128 a[244:247], v224 offset:49856
    v_fma_f32 v169, v169, s37, -v236
    v_mfma_f32_16x16x32_bf16 v[220:223], a[228:231], a[84:87], v[220:223]
    ds_read_b64_tr_b16 a[248:249], v86 offset:24576
    v_fma_f32 v170, v170, s37, -v236
    v_mfma_f32_16x16x32_bf16 v[216:219], a[224:227], a[76:79], 0
    ds_read_b64_tr_b16 a[250:251], v86 offset:26112
    ds_read_b64_tr_b16 a[252:253], v86 offset:24608
    v_mfma_f32_16x16x32_bf16 v[216:219], a[228:231], a[88:91], v[216:219]
    s_waitcnt lgkmcnt(7)
    ds_read_b64_tr_b16 a[254:255], v86 offset:26144
    ds_read_b64_tr_b16 a[220:221], v86 offset:24640
    v_mfma_f32_16x16x32_bf16 v[164:167], v[54:57], v[138:141], v[164:167]
    ds_read_b64_tr_b16 a[222:223], v86 offset:26176
    v_fma_f32 v171, v171, s37, -v236
    v_mfma_f32_16x16x32_bf16 v[212:215], a[224:227], a[80:83], 0
    ds_read_b128 a[224:227], v225 offset:39872
    v_fma_f32 v172, v172, s37, -v236
    v_mfma_f32_16x16x32_bf16 v[212:215], a[228:231], a[92:95], v[212:215]
    ds_read_b128 a[228:231], v225 offset:39936
    v_fma_f32 v173, v173, s37, -v236
    v_mfma_f32_16x16x16_bf16 v[164:167], v[58:59], v[142:143], v[164:167]
    s_waitcnt lgkmcnt(10)
    v_exp_f32 v168, v168
    v_mfma_f32_16x16x32_bf16 v[220:223], a[232:235], a[96:99], v[220:223]
    v_exp_f32 v169, v169
    v_mfma_f32_16x16x32_bf16 v[220:223], a[236:239], a[108:111], v[220:223]
    s_waitcnt lgkmcnt(6)
    ds_write_b128 v87, a[248:251] offset:24576
    v_mfma_f32_16x16x32_bf16 v[216:219], a[232:235], a[100:103], v[216:219]
    s_waitcnt lgkmcnt(5)
    ds_write_b128 v87, a[252:255] offset:25600
    v_mfma_f32_16x16x32_bf16 v[216:219], a[236:239], a[112:115], v[216:219]
    s_waitcnt lgkmcnt(4)
    ds_write_b128 v87, a[220:223] offset:26624
    v_mfma_f32_16x16x32_bf16 v[212:215], a[232:235], a[104:107], v[212:215]
    v_exp_f32 v170, v170
    v_mfma_f32_16x16x32_bf16 v[212:215], a[236:239], a[116:119], v[212:215]
    v_exp_f32 v171, v171
    v_mfma_f32_16x16x32_bf16 v[220:223], a[240:243], a[120:123], v[220:223]
    v_cvt_pk_bf16_f32 v180, v168, v169
    v_cvt_pk_bf16_f32 v181, v170, v171
    v_mfma_f32_16x16x32_bf16 v[220:223], a[244:247], a[132:135], v[220:223]
    v_fma_f32 v174, v174, s37, -v236
    v_fma_f32 v175, v175, s37, -v236
    v_mfma_f32_16x16x32_bf16 v[216:219], a[240:243], a[124:127], v[216:219]
    v_exp_f32 v172, v172
    v_mfma_f32_16x16x32_bf16 v[216:219], a[244:247], a[136:139], v[216:219]
    v_exp_f32 v173, v173
    v_mfma_f32_16x16x32_bf16 v[212:215], a[240:243], a[128:131], v[212:215]
    v_exp_f32 v174, v174
    v_mfma_f32_16x16x32_bf16 v[212:215], a[244:247], a[140:143], v[212:215]
    s_waitcnt lgkmcnt(2)
    ds_read_b128 v[168:171], v234
    v_bfe_u32 v234, s62, v232, 4
    v_mfma_f32_16x16x32_bf16 v[208:211], a[144:147], a[224:227], 0
    v_mad_u32_u24 v234, v234, s40, v230
    v_cvt_pk_bf16_f32 v78, v220, v221
    v_mfma_f32_16x16x32_bf16 v[208:211], a[156:159], a[228:231], v[208:211]
    v_cvt_pk_bf16_f32 v79, v222, v223
    v_cvt_pk_bf16_f32 v100, v216, v217
    v_mfma_f32_16x16x32_bf16 v[204:207], a[148:151], a[224:227], 0
    v_cvt_pk_bf16_f32 v101, v218, v219
    v_cvt_pk_bf16_f32 v122, v212, v213
    v_mfma_f32_16x16x32_bf16 v[204:207], a[160:163], a[228:231], v[204:207]
    ds_read_b128 a[232:235], v225 offset:40000
    v_cvt_pk_bf16_f32 v123, v214, v215
    v_mfma_f32_16x16x32_bf16 v[200:203], a[152:155], a[224:227], 0
    ds_read_b128 a[236:239], v225 offset:40064
    ds_read_b128 a[240:243], v225 offset:40128
    v_mfma_f32_16x16x32_bf16 v[200:203], a[164:167], a[228:231], v[200:203]
    ds_read_b128 a[244:247], v225 offset:40192
    v_exp_f32 v175, v175
    v_cvt_pk_bf16_f32 v182, v172, v173
    ds_read_b128 a[248:251], v227 offset:37120
    v_cvt_pk_bf16_f32 v183, v174, v175
    ds_read_b128 v[172:175], v250
    v_mad_u32_u24 v250, v235, s40, v228
    v_mfma_f32_16x16x32_bf16 v[196:199], a[216:219], v[180:183], v[196:199]
    ds_read_b128 a[252:255], v227 offset:37184
    v_mad_u32_u24 v235, v235, s40, v229
    v_mfma_f32_16x16x32_bf16 v[184:187], v[78:81], v[180:183], v[184:187]
    ds_read_b128 a[220:223], v227 offset:37248
    v_max3_f32 v248, v144, v145, v146
    v_mfma_f32_16x16x32_bf16 v[188:191], v[100:103], v[180:183], v[188:191]
    ds_read_b128 a[224:227], v227 offset:37312
    v_max3_f32 v249, v147, v148, v149
    v_mfma_f32_16x16x32_bf16 v[192:195], v[122:125], v[180:183], v[192:195]
    s_waitcnt lgkmcnt(8)
    ds_read_b128 a[228:231], v227 offset:37376
    v_max3_f32 v248, v248, v150, v151
    v_mfma_f32_16x16x32_bf16 v[208:211], a[168:171], a[232:235], v[208:211]
    s_waitcnt lgkmcnt(8)
    v_rcp_f32 v197, v196
    v_mfma_f32_16x16x32_bf16 v[208:211], a[180:183], a[236:239], v[208:211]
    v_mul_f32 v184, v184, v197
    v_mul_f32 v185, v185, v197
    v_mfma_f32_16x16x32_bf16 v[204:207], a[172:175], a[232:235], v[204:207]
    v_cvt_pk_bf16_f32 v184, v184, v185
    v_mul_f32 v186, v186, v197
    v_mfma_f32_16x16x32_bf16 v[204:207], a[184:187], a[236:239], v[204:207]
    v_mul_f32 v187, v187, v197
    v_cvt_pk_bf16_f32 v185, v186, v187
    v_mfma_f32_16x16x32_bf16 v[200:203], a[176:179], a[232:235], v[200:203]
    ds_read_b128 a[232:235], v227 offset:37440
    v_mul_f32 v188, v188, v197
    v_mfma_f32_16x16x32_bf16 v[200:203], a[188:191], a[236:239], v[200:203]
    s_waitcnt lgkmcnt(4)
    v_mul_f32 v189, v189, v197
    v_cvt_pk_bf16_f32 v186, v188, v189
    v_mfma_f32_16x16x32_bf16 v[208:211], a[192:195], a[240:243], v[208:211]
    v_mul_f32 v190, v190, v197
    v_mul_f32 v191, v191, v197
    v_mfma_f32_16x16x32_bf16 v[208:211], a[204:207], a[244:247], v[208:211]
    v_cvt_pk_bf16_f32 v187, v190, v191
    v_mul_f32 v192, v192, v197
    v_mfma_f32_16x16x32_bf16 v[204:207], a[196:199], a[240:243], v[204:207]
    v_mul_f32 v193, v193, v197
    v_cvt_pk_bf16_f32 v188, v192, v193
    v_mfma_f32_16x16x32_bf16 v[204:207], a[208:211], a[244:247], v[204:207]
    v_mul_f32 v194, v194, v197
    v_mul_f32 v195, v195, v197
    v_mfma_f32_16x16x32_bf16 v[200:203], a[200:203], a[240:243], v[200:203]
    v_cvt_pk_bf16_f32 v132, v208, v209
    v_cvt_pk_bf16_f32 v133, v210, v211
    v_mfma_f32_16x16x32_bf16 v[200:203], a[212:215], a[244:247], v[200:203]
    ds_read_b64_tr_b16 a[236:237], v86 offset:36864
    v_cvt_pk_bf16_f32 v189, v194, v195
    v_mfma_f32_16x16x32_bf16 v[220:223], a[248:251], a[72:75], 0
    v_cvt_pk_bf16_f32 v134, v204, v205
    v_cvt_pk_bf16_f32 v135, v206, v207
    v_mfma_f32_16x16x32_bf16 v[220:223], a[252:255], a[84:87], v[220:223]
    ds_write_b128 v237, v[184:187]
    v_mfma_f32_16x16x32_bf16 v[168:171], v[30:33], v[132:135], v[168:171]
    v_cvt_pk_bf16_f32 v136, v200, v201
    v_cvt_pk_bf16_f32 v137, v202, v203
    v_mfma_f32_16x16x32_bf16 v[172:175], v[6:9], v[132:135], v[172:175]
    ds_write_b64 v238, v[188:189]
    v_mfma_f32_16x16x32_bf16 v[216:219], a[248:251], a[76:79], 0
    v_max3_f32 v249, v249, v152, v153
    v_max3_f32 v248, v248, v154, v155
    v_mfma_f32_16x16x32_bf16 v[216:219], a[252:255], a[88:91], v[216:219]
    v_max3_f32 v249, v249, v156, v157
    v_max3_f32 v248, v248, v158, v159
    v_mfma_f32_16x16x16_bf16 v[168:171], v[34:35], v[136:137], v[168:171]
    ds_read_b64_tr_b16 a[238:239], v86 offset:38400
    ds_read_b64_tr_b16 a[240:241], v86 offset:36896
    v_mfma_f32_16x16x16_bf16 v[172:175], v[10:11], v[136:137], v[172:175]
    ds_read_b64_tr_b16 a[242:243], v86 offset:38432
    ds_read_b64_tr_b16 a[244:245], v86 offset:36928
    v_mfma_f32_16x16x32_bf16 v[212:215], a[248:251], a[80:83], 0
    ds_read_b64_tr_b16 a[246:247], v86 offset:38464
    ds_read_b64_tr_b16 a[248:249], v86 offset:49152
    v_mfma_f32_16x16x32_bf16 v[212:215], a[252:255], a[92:95], v[212:215]
    s_waitcnt lgkmcnt(8)
    ds_read_b64_tr_b16 a[250:251], v86 offset:50688
    ds_read_b64_tr_b16 a[252:253], v86 offset:49184
    v_mfma_f32_16x16x32_bf16 v[220:223], a[220:223], a[96:99], v[220:223]
    ds_read_b64_tr_b16 a[254:255], v86 offset:50720
    v_max3_f32 v249, v249, v160, v161
    v_mfma_f32_16x16x32_bf16 v[220:223], a[224:227], a[108:111], v[220:223]
    v_max3_f32 v248, v248, v162, v163
    v_max3_f32 v249, v249, v164, v165
    v_mfma_f32_16x16x32_bf16 v[216:219], a[220:223], a[100:103], v[216:219]
    s_waitcnt lgkmcnt(8)
    ds_write_b128 v87, a[236:239] offset:36864
    v_mfma_f32_16x16x32_bf16 v[216:219], a[224:227], a[112:115], v[216:219]
    s_waitcnt lgkmcnt(7)
    ds_write_b128 v87, a[240:243] offset:37888
    v_mfma_f32_16x16x32_bf16 v[212:215], a[220:223], a[104:107], v[212:215]
    s_waitcnt lgkmcnt(6)
    ds_write_b128 v87, a[244:247] offset:38912
    v_mfma_f32_16x16x32_bf16 v[212:215], a[224:227], a[116:119], v[212:215]
    v_max3_f32 v248, v248, v166, v167
    v_max_f32 v248, v248, v249
    v_mfma_f32_16x16x32_bf16 v[220:223], a[228:231], a[120:123], v[220:223]
    v_mov_b32 v249, v248
    v_mfma_f32_16x16x32_bf16 v[220:223], a[232:235], a[132:135], v[220:223]
    v_mfma_f32_16x16x32_bf16 v[216:219], a[228:231], a[124:127], v[216:219]
    v_permlane16_swap_b32 v248, v249
    v_mfma_f32_16x16x32_bf16 v[216:219], a[232:235], a[136:139], v[216:219]
    v_max_f32 v248, v248, v249
    v_mov_b32 v249, v248
    v_mfma_f32_16x16x32_bf16 v[212:215], a[228:231], a[128:131], v[212:215]
    v_mfma_f32_16x16x32_bf16 v[212:215], a[232:235], a[140:143], v[212:215]
    s_waitcnt lgkmcnt(2)
    v_permlane32_swap_b32 v248, v249
    v_cvt_pk_bf16_f32 v84, v220, v221
    v_cvt_pk_bf16_f32 v85, v222, v223
    ds_read_b128 a[236:239], v224
    v_cvt_pk_bf16_f32 v106, v216, v217
    v_cvt_pk_bf16_f32 v107, v218, v219
    ds_read_b128 a[240:243], v224 offset:64
    ds_read_b128 a[244:247], v224 offset:128
    v_cvt_pk_bf16_f32 v128, v212, v213
    v_cvt_pk_bf16_f32 v129, v214, v215
    ds_read_b64_tr_b16 a[220:221], v86 offset:49216
    ds_read_b64_tr_b16 a[222:223], v86 offset:50752
    ds_write_b128 v87, a[248:251] offset:49152
    ds_write_b128 v87, a[252:255] offset:50176
    v_max_f32 v248, v248, v249
    v_mul_f32 v236, s37, v248
    v_fma_f32 v144, v144, s37, -v236
    s_waitcnt lgkmcnt(6)
    v_mfma_f32_16x16x32_bf16 v[208:211], a[0:3], a[236:239], 0
    v_fma_f32 v145, v145, s37, -v236
    v_fma_f32 v146, v146, s37, -v236
    v_mfma_f32_16x16x32_bf16 v[204:207], a[4:7], a[236:239], 0
    s_waitcnt lgkmcnt(5)
    v_fma_f32 v147, v147, s37, -v236
    v_fma_f32 v148, v148, s37, -v236
    v_mfma_f32_16x16x32_bf16 v[204:207], a[16:19], a[240:243], v[204:207]
    v_exp_f32 v144, v144
    v_mfma_f32_16x16x32_bf16 v[208:211], a[12:15], a[240:243], v[208:211]
    s_waitcnt lgkmcnt(2)
    ds_write_b128 v87, a[220:223] offset:51200
    v_mfma_f32_16x16x32_bf16 v[200:203], a[8:11], a[236:239], 0
    v_exp_f32 v145, v145
    v_mfma_f32_16x16x32_bf16 v[200:203], a[20:23], a[240:243], v[200:203]
    v_exp_f32 v146, v146
    v_mfma_f32_16x16x32_bf16 v[220:223], a[236:239], a[72:75], 0
    v_exp_f32 v147, v147
    v_mfma_f32_16x16x32_bf16 v[220:223], a[240:243], a[84:87], v[220:223]
    v_cvt_pk_bf16_f32 v176, v144, v145
    v_cvt_pk_bf16_f32 v177, v146, v147
    v_mfma_f32_16x16x32_bf16 v[216:219], a[236:239], a[76:79], 0
    ds_read_b128 v[144:147], v228 offset:1280
    v_fma_f32 v149, v149, s37, -v236
    v_mfma_f32_16x16x32_bf16 v[216:219], a[240:243], a[88:91], v[216:219]
    ds_read_b128 a[248:251], v224 offset:192
    v_fma_f32 v150, v150, s37, -v236
    v_mfma_f32_16x16x32_bf16 v[212:215], a[236:239], a[80:83], 0
    ds_read_b128 a[252:255], v224 offset:256
    v_fma_f32 v151, v151, s37, -v236
    v_mfma_f32_16x16x32_bf16 v[212:215], a[240:243], a[92:95], v[212:215]
    ds_read_b128 a[236:239], v224 offset:3072
    v_fma_f32 v152, v152, s37, -v236
    v_mfma_f32_16x16x32_bf16 v[208:211], a[24:27], a[244:247], v[208:211]
    ds_read_b128 a[240:243], v224 offset:3136
    v_fma_f32 v153, v153, s37, -v236
    v_mfma_f32_16x16x32_bf16 v[204:207], a[28:31], a[244:247], v[204:207]
    ds_read_b64_tr_b16 a[220:221], v108
    v_fma_f32 v154, v154, s37, -v236
    v_mfma_f32_16x16x32_bf16 v[200:203], a[32:35], a[244:247], v[200:203]
    ds_read_b64_tr_b16 a[222:223], v108 offset:1536
    v_fma_f32 v155, v155, s37, -v236
    v_mfma_f32_16x16x32_bf16 v[220:223], a[244:247], a[96:99], v[220:223]
    s_waitcnt lgkmcnt(6)
    ds_read_b64_tr_b16 a[224:225], v86 offset:61440
    ds_read_b64_tr_b16 a[226:227], v86 offset:62976
    v_mfma_f32_16x16x32_bf16 v[144:147], v[12:15], v[132:135], v[144:147]
    s_waitcnt lgkmcnt(7)
    ds_read_b64_tr_b16 a[228:229], v86 offset:61472
    ds_read_b64_tr_b16 a[230:231], v86 offset:63008
    v_mfma_f32_16x16x32_bf16 v[208:211], a[36:39], a[248:251], v[208:211]
    ds_read_b64_tr_b16 a[232:233], v86 offset:61504
    ds_read_b64_tr_b16 a[234:235], v86 offset:63040
    v_mfma_f32_16x16x32_bf16 v[204:207], a[40:43], a[248:251], v[204:207]
    v_exp_f32 v148, v148
    v_mfma_f32_16x16x16_bf16 v[144:147], v[16:17], v[136:137], v[144:147]
    v_exp_f32 v149, v149
    v_mfma_f32_16x16x32_bf16 v[200:203], a[44:47], a[248:251], v[200:203]
    v_exp_f32 v150, v150
    v_mfma_f32_16x16x32_bf16 v[220:223], a[248:251], a[108:111], v[220:223]
    v_exp_f32 v151, v151
    v_mfma_f32_16x16x32_bf16 v[216:219], a[244:247], a[100:103], v[216:219]
    s_waitcnt lgkmcnt(4)
    ds_write_b128 v87, a[224:227] offset:61440
    v_mfma_f32_16x16x32_bf16 v[216:219], a[248:251], a[112:115], v[216:219]
    s_waitcnt lgkmcnt(3)
    ds_write_b128 v87, a[228:231] offset:62464
    v_mfma_f32_16x16x32_bf16 v[212:215], a[244:247], a[104:107], v[212:215]
    s_waitcnt lgkmcnt(2)
    ds_write_b128 v87, a[232:235] offset:63488
    v_mfma_f32_16x16x32_bf16 v[212:215], a[248:251], a[116:119], v[212:215]
    v_cvt_pk_bf16_f32 v178, v148, v149
    v_cvt_pk_bf16_f32 v179, v150, v151
    v_mfma_f32_16x16x32_bf16 v[208:211], a[48:51], a[252:255], v[208:211]
    v_exp_f32 v152, v152
    v_mfma_f32_16x16x32_bf16 v[208:211], a[60:63], v[252:255], v[208:211]
    v_exp_f32 v153, v153
    v_mfma_f32_16x16x32_bf16 v[196:199], a[216:219], v[176:179], 0
    v_exp_f32 v154, v154
    v_mfma_f32_16x16x32_bf16 v[184:187], v[68:71], v[176:179], 0
    v_exp_f32 v155, v155
    v_mfma_f32_16x16x32_bf16 v[188:191], v[90:93], v[176:179], 0
    v_cvt_pk_bf16_f32 v180, v152, v153
    v_cvt_pk_bf16_f32 v181, v154, v155
    v_mfma_f32_16x16x32_bf16 v[192:195], v[112:115], v[176:179], 0
    v_cvt_pk_bf16_f32 v0, v208, v209
    v_cvt_pk_bf16_f32 v1, v210, v211
    v_mfma_f32_16x16x32_bf16 v[204:207], a[52:55], a[252:255], v[204:207]
    ds_read_b128 v[148:151], v229 offset:1280
    v_fma_f32 v156, v156, s37, -v236
    v_mfma_f32_16x16x32_bf16 v[204:207], a[64:67], v[252:255], v[204:207]
    ds_read_b128 v[152:155], v229 offset:1920
    v_fma_f32 v157, v157, s37, -v236
    v_mfma_f32_16x16x32_bf16 v[200:203], a[56:59], a[252:255], v[200:203]
    ds_read_b128 a[244:247], v224 offset:3200
    v_fma_f32 v158, v158, s37, -v236
    v_mfma_f32_16x16x32_bf16 v[200:203], a[68:71], v[252:255], v[200:203]
    ds_read_b128 a[248:251], v224 offset:3264
    v_fma_f32 v159, v159, s37, -v236
    v_mfma_f32_16x16x32_bf16 v[220:223], a[252:255], a[120:123], v[220:223]
    v_cvt_pk_bf16_f32 v2, v204, v205
    v_cvt_pk_bf16_f32 v3, v206, v207
    v_mfma_f32_16x16x32_bf16 v[220:223], v[252:255], a[132:135], v[220:223]
    ds_read_b64_tr_b16 a[224:225], v108 offset:8
    ds_read_b64_tr_b16 a[226:227], v108 offset:1544
    v_mfma_f32_16x16x32_bf16 v[216:219], a[252:255], a[124:127], v[216:219]
    v_cvt_pk_bf16_f32 v4, v200, v201
    v_cvt_pk_bf16_f32 v5, v202, v203
    v_mfma_f32_16x16x32_bf16 v[216:219], v[252:255], a[136:139], v[216:219]
    s_waitcnt lgkmcnt(5)
    ds_read_b64_tr_b16 a[228:229], v109
    ds_read_b64_tr_b16 a[230:231], v109 offset:1536
    v_mfma_f32_16x16x32_bf16 v[148:151], v[36:39], v[132:135], v[148:151]
    s_waitcnt lgkmcnt(6)
    v_cvt_pk_bf16_f32 v66, v220, v221
    v_cvt_pk_bf16_f32 v67, v222, v223
    v_mfma_f32_16x16x32_bf16 v[152:155], v[42:45], v[132:135], v[152:155]
    ds_read_b64_tr_b16 a[232:233], v109 offset:8
    ds_read_b64_tr_b16 a[234:235], v109 offset:1544
    v_mfma_f32_16x16x32_bf16 v[212:215], a[252:255], a[128:131], v[212:215]
    v_cvt_pk_bf16_f32 v88, v216, v217
    v_cvt_pk_bf16_f32 v89, v218, v219
    v_mfma_f32_16x16x32_bf16 v[212:215], v[252:255], a[140:143], v[212:215]
    ds_read_b128 a[252:255], v224 offset:3328
    ds_read_b128 v[252:255], v224 offset:3392
    v_mfma_f32_16x16x16_bf16 v[148:151], v[40:41], v[136:137], v[148:151]
    v_exp_f32 v156, v156
    v_mfma_f32_16x16x16_bf16 v[152:155], v[46:47], v[136:137], v[152:155]
    v_exp_f32 v157, v157
    v_mfma_f32_16x16x32_bf16 v[208:211], a[0:3], a[236:239], 0
    v_exp_f32 v158, v158
    v_mfma_f32_16x16x32_bf16 v[208:211], a[12:15], a[240:243], v[208:211]
    v_cvt_pk_bf16_f32 v110, v212, v213
    v_cvt_pk_bf16_f32 v111, v214, v215
    v_mfma_f32_16x16x32_bf16 v[204:207], a[4:7], a[236:239], 0
    v_exp_f32 v159, v159
    v_mfma_f32_16x16x32_bf16 v[204:207], a[16:19], a[240:243], v[204:207]
    v_cvt_pk_bf16_f32 v182, v156, v157
    v_cvt_pk_bf16_f32 v183, v158, v159
    v_mfma_f32_16x16x32_bf16 v[200:203], a[8:11], a[236:239], 0
    ds_read_b128 v[156:159], v228 offset:1920
    v_fma_f32 v160, v160, s37, -v236
    v_mfma_f32_16x16x32_bf16 v[200:203], a[20:23], a[240:243], v[200:203]
    v_fma_f32 v161, v161, s37, -v236
    v_fma_f32 v162, v162, s37, -v236
    v_mfma_f32_16x16x32_bf16 v[196:199], a[216:219], v[180:183], v[196:199]
    v_fma_f32 v163, v163, s37, -v236
    v_fma_f32 v164, v164, s37, -v236
    v_mfma_f32_16x16x32_bf16 v[184:187], v[76:79], v[180:183], v[184:187]
    v_exp_f32 v160, v160
    v_mfma_f32_16x16x32_bf16 v[188:191], v[98:101], v[180:183], v[188:191]
    v_exp_f32 v161, v161
    v_mfma_f32_16x16x32_bf16 v[192:195], v[120:123], v[180:183], v[192:195]
    v_exp_f32 v162, v162
    v_mfma_f32_16x16x32_bf16 v[220:223], a[236:239], a[72:75], 0
    v_exp_f32 v163, v163
    v_mfma_f32_16x16x32_bf16 v[220:223], a[240:243], a[84:87], v[220:223]
    s_waitcnt lgkmcnt(0)
    v_cvt_pk_bf16_f32 v176, v160, v161
    v_cvt_pk_bf16_f32 v177, v162, v163
    v_mfma_f32_16x16x32_bf16 v[156:159], v[18:21], v[132:135], v[156:159]
    ds_read_b128 v[160:163], v250
    v_bfe_u32 v250, s66, v233, 4
    v_mfma_f32_16x16x32_bf16 v[216:219], a[236:239], a[76:79], 0
    v_mad_u32_u24 v250, v250, s40, v231
    v_fma_f32 v165, v165, s37, -v236
    v_mfma_f32_16x16x32_bf16 v[216:219], a[240:243], a[88:91], v[216:219]
    v_fma_f32 v166, v166, s37, -v236
    v_fma_f32 v167, v167, s37, -v236
    v_mfma_f32_16x16x16_bf16 v[156:159], v[22:23], v[136:137], v[156:159]
    v_exp_f32 v164, v164
    v_mfma_f32_16x16x32_bf16 v[212:215], a[236:239], a[80:83], 0
    ds_read_b128 a[236:239], v225 offset:42944
    v_max3_f32 v248, v168, v169, v170
    v_mfma_f32_16x16x32_bf16 v[212:215], a[240:243], a[92:95], v[212:215]
    ds_read_b128 a[240:243], v225 offset:43008
    v_max3_f32 v249, v171, v172, v173
    v_mfma_f32_16x16x32_bf16 v[208:211], a[24:27], a[244:247], v[208:211]
    v_exp_f32 v165, v165
    v_mfma_f32_16x16x32_bf16 v[208:211], a[36:39], a[248:251], v[208:211]
    s_waitcnt lgkmcnt(2)
    v_exp_f32 v166, v166
    v_mfma_f32_16x16x32_bf16 v[160:163], v[0:3], v[132:135], v[160:163]
    v_exp_f32 v167, v167
    v_mfma_f32_16x16x32_bf16 v[204:207], a[28:31], a[244:247], v[204:207]
    v_cvt_pk_bf16_f32 v178, v164, v165
    v_cvt_pk_bf16_f32 v179, v166, v167
    v_mfma_f32_16x16x32_bf16 v[204:207], a[40:43], a[248:251], v[204:207]
    ds_read_b128 v[164:167], v235
    v_bfe_u32 v235, s65, v232, 4
    v_mfma_f32_16x16x32_bf16 v[196:199], a[216:219], v[176:179], v[196:199]
    v_mad_u32_u24 v235, v235, s40, v230
    v_max3_f32 v248, v248, v174, v175
    v_mfma_f32_16x16x32_bf16 v[184:187], v[82:85], v[176:179], v[184:187]
    v_max3_f32 v249, v249, v144, v145
    v_max3_f32 v248, v248, v146, v147
    v_mfma_f32_16x16x32_bf16 v[188:191], v[104:107], v[176:179], v[188:191]
    v_max3_f32 v249, v249, v148, v149
    v_max3_f32 v248, v248, v150, v151
    v_mfma_f32_16x16x32_bf16 v[192:195], v[126:129], v[176:179], v[192:195]
    v_rcp_f32 v197, v196
    v_mfma_f32_16x16x16_bf16 v[160:163], v[4:5], v[136:137], v[160:163]
    v_mul_f32 v184, v184, v197
    v_mul_f32 v185, v185, v197
    v_mfma_f32_16x16x32_bf16 v[200:203], a[32:35], a[244:247], v[200:203]
    v_cvt_pk_bf16_f32 v184, v184, v185
    v_mul_f32 v186, v186, v197
    v_mfma_f32_16x16x32_bf16 v[200:203], a[44:47], a[248:251], v[200:203]
    v_mul_f32 v187, v187, v197
    v_cvt_pk_bf16_f32 v185, v186, v187
    v_mfma_f32_16x16x32_bf16 v[220:223], a[244:247], a[96:99], v[220:223]
    v_mul_f32 v188, v188, v197
    v_mul_f32 v189, v189, v197
    v_mfma_f32_16x16x32_bf16 v[220:223], a[248:251], a[108:111], v[220:223]
    v_cvt_pk_bf16_f32 v186, v188, v189
    v_mul_f32 v190, v190, v197
    v_mfma_f32_16x16x32_bf16 v[216:219], a[244:247], a[100:103], v[216:219]
    v_mul_f32 v191, v191, v197
    v_cvt_pk_bf16_f32 v187, v190, v191
    v_mfma_f32_16x16x32_bf16 v[216:219], a[248:251], a[112:115], v[216:219]
    v_mul_f32 v192, v192, v197
    v_mul_f32 v193, v193, v197
    v_mfma_f32_16x16x32_bf16 v[212:215], a[244:247], a[104:107], v[212:215]
    ds_read_b128 a[244:247], v225 offset:43072
    v_cvt_pk_bf16_f32 v188, v192, v193
    v_mfma_f32_16x16x32_bf16 v[212:215], a[248:251], a[116:119], v[212:215]
    ds_read_b128 a[248:251], v225 offset:43136
    v_mul_f32 v194, v194, v197
    v_mfma_f32_16x16x32_bf16 v[208:211], a[48:51], a[252:255], v[208:211]
    v_mul_f32 v195, v195, v197
    v_cvt_pk_bf16_f32 v189, v194, v195
    v_mfma_f32_16x16x32_bf16 v[208:211], a[60:63], v[252:255], v[208:211]
    ds_write_b128 v237, v[184:187] offset:6144
    v_mfma_f32_16x16x32_bf16 v[204:207], a[52:55], a[252:255], v[204:207]
    ds_write_b64 v238, v[188:189] offset:6144
    v_mfma_f32_16x16x32_bf16 v[204:207], a[64:67], v[252:255], v[204:207]
    v_max3_f32 v249, v249, v152, v153
    v_max3_f32 v248, v248, v154, v155
    v_mfma_f32_16x16x32_bf16 v[200:203], a[56:59], a[252:255], v[200:203]
    v_max3_f32 v249, v249, v156, v157
    v_cvt_pk_bf16_f32 v24, v208, v209
    v_mfma_f32_16x16x32_bf16 v[200:203], a[68:71], v[252:255], v[200:203]
    v_cvt_pk_bf16_f32 v25, v210, v211
    v_max3_f32 v248, v248, v158, v159
    v_mfma_f32_16x16x32_bf16 v[220:223], a[252:255], a[120:123], v[220:223]
    v_cvt_pk_bf16_f32 v26, v204, v205
    v_cvt_pk_bf16_f32 v27, v206, v207
    v_mfma_f32_16x16x32_bf16 v[220:223], v[252:255], a[132:135], v[220:223]
    s_waitcnt lgkmcnt(2)
    v_max3_f32 v249, v249, v160, v161
    v_max3_f32 v248, v248, v162, v163
    v_mfma_f32_16x16x32_bf16 v[164:167], v[24:27], v[132:135], v[164:167]
    v_cvt_pk_bf16_f32 v28, v200, v201
    v_cvt_pk_bf16_f32 v29, v202, v203
    v_mfma_f32_16x16x32_bf16 v[216:219], a[252:255], a[124:127], v[216:219]
    v_mfma_f32_16x16x32_bf16 v[216:219], v[252:255], a[136:139], v[216:219]
    v_mfma_f32_16x16x32_bf16 v[212:215], a[252:255], a[128:131], v[212:215]
    v_cvt_pk_bf16_f32 v68, v220, v221
    v_cvt_pk_bf16_f32 v69, v222, v223
    v_mfma_f32_16x16x32_bf16 v[212:215], v[252:255], a[140:143], v[212:215]
    ds_read_b128 a[252:255], v225 offset:43200
    ds_read_b128 v[252:255], v225 offset:43264
    v_mfma_f32_16x16x16_bf16 v[164:167], v[28:29], v[136:137], v[164:167]
    v_mfma_f32_16x16x32_bf16 v[208:211], a[144:147], a[236:239], 0
    v_cvt_pk_bf16_f32 v90, v216, v217
    v_cvt_pk_bf16_f32 v91, v218, v219
    v_mfma_f32_16x16x32_bf16 v[208:211], a[156:159], a[240:243], v[208:211]
    v_mfma_f32_16x16x32_bf16 v[204:207], a[148:151], a[236:239], 0
    v_cvt_pk_bf16_f32 v112, v212, v213
    v_cvt_pk_bf16_f32 v113, v214, v215
    v_mfma_f32_16x16x32_bf16 v[204:207], a[160:163], a[240:243], v[204:207]
    v_max3_f32 v249, v249, v164, v165
    v_max3_f32 v248, v248, v166, v167
    v_mfma_f32_16x16x32_bf16 v[200:203], a[152:155], a[236:239], 0
    ds_read_b128 a[236:239], v226 offset:1152
    v_max_f32 v248, v248, v249
    v_mfma_f32_16x16x32_bf16 v[200:203], a[164:167], a[240:243], v[200:203]
    s_waitcnt lgkmcnt(1)
    ds_read_b128 a[240:243], v226 offset:1216
    v_mov_b32 v249, v248
    v_mfma_f32_16x16x32_bf16 v[208:211], a[168:171], a[244:247], v[208:211]
    s_barrier
    buffer_load_dwordx4 v246, s[4:7], s56 offen lds
    v_mfma_f32_16x16x32_bf16 v[208:211], a[180:183], a[248:251], v[208:211]
    v_permlane16_swap_b32 v248, v249
    v_mfma_f32_16x16x32_bf16 v[204:207], a[172:175], a[244:247], v[204:207]
    v_max_f32 v248, v248, v249
    v_mov_b32 v249, v248
    v_mfma_f32_16x16x32_bf16 v[204:207], a[184:187], a[248:251], v[204:207]
    v_mfma_f32_16x16x32_bf16 v[200:203], a[176:179], a[244:247], v[200:203]
    ds_read_b128 a[244:247], v226 offset:1280
    v_mfma_f32_16x16x32_bf16 v[200:203], a[188:191], a[248:251], v[200:203]
    ds_read_b128 a[248:251], v226 offset:1344
    v_mfma_f32_16x16x32_bf16 v[208:211], a[192:195], a[252:255], v[208:211]
    buffer_load_dwordx4 v247, s[4:7], s56 offen offset:1024 lds
    v_mfma_f32_16x16x32_bf16 v[208:211], a[204:207], v[252:255], v[208:211]
    s_add_u32 s56, s56, s42
    v_permlane32_swap_b32 v248, v249
    v_mfma_f32_16x16x32_bf16 v[204:207], a[196:199], a[252:255], v[204:207]
    s_add_u32 m0, s41, 0x9740
    v_max_f32 v248, v248, v249
    v_mul_f32 v236, s37, v248
    v_mfma_f32_16x16x32_bf16 v[204:207], a[208:211], v[252:255], v[204:207]
    v_fma_f32 v168, v168, s37, -v236
    v_cvt_pk_bf16_f32 v138, v208, v209
    v_mfma_f32_16x16x32_bf16 v[200:203], a[200:203], a[252:255], v[200:203]
    ds_read_b128 a[252:255], v226 offset:1408
    v_cvt_pk_bf16_f32 v139, v210, v211
    v_mfma_f32_16x16x32_bf16 v[200:203], a[212:215], v[252:255], v[200:203]
    s_waitcnt lgkmcnt(3)
    ds_read_b128 v[252:255], v226 offset:1472
    v_fma_f32 v169, v169, s37, -v236
    v_mfma_f32_16x16x32_bf16 v[220:223], a[144:147], a[236:239], 0
    v_cvt_pk_bf16_f32 v140, v204, v205
    v_cvt_pk_bf16_f32 v141, v206, v207
    v_mfma_f32_16x16x32_bf16 v[220:223], a[156:159], a[240:243], v[220:223]
    buffer_load_dwordx4 v246, s[4:7], s56 offen lds
    v_mfma_f32_16x16x32_bf16 v[216:219], a[148:151], a[236:239], 0
    v_cvt_pk_bf16_f32 v142, v200, v201
    v_cvt_pk_bf16_f32 v143, v202, v203
    v_mfma_f32_16x16x32_bf16 v[216:219], a[160:163], a[240:243], v[216:219]
    v_fma_f32 v170, v170, s37, -v236
    v_fma_f32 v171, v171, s37, -v236
    v_mfma_f32_16x16x32_bf16 v[212:215], a[152:155], a[236:239], 0
    ds_read_b128 a[236:239], v227 offset:6144
    v_fma_f32 v172, v172, s37, -v236
    v_mfma_f32_16x16x32_bf16 v[212:215], a[164:167], a[240:243], v[212:215]
    s_waitcnt lgkmcnt(3)
    ds_read_b128 a[240:243], v227 offset:6208
    v_fma_f32 v173, v173, s37, -v236
    v_mfma_f32_16x16x32_bf16 v[220:223], a[168:171], a[244:247], v[220:223]
    v_exp_f32 v168, v168
    v_mfma_f32_16x16x32_bf16 v[220:223], a[180:183], a[248:251], v[220:223]
    buffer_load_dwordx4 v247, s[4:7], s56 offen offset:1024 lds
    v_mfma_f32_16x16x32_bf16 v[216:219], a[172:175], a[244:247], v[216:219]
    s_add_u32 s56, s56, s42
    v_exp_f32 v169, v169
    v_mfma_f32_16x16x32_bf16 v[216:219], a[184:187], a[248:251], v[216:219]
    s_add_u32 m0, s41, 0xb580
    v_exp_f32 v170, v170
    v_mfma_f32_16x16x32_bf16 v[212:215], a[176:179], a[244:247], v[212:215]
    ds_read_b128 a[244:247], v227 offset:6272
    v_cvt_pk_bf16_f32 v180, v168, v169
    v_mfma_f32_16x16x32_bf16 v[212:215], a[188:191], a[248:251], v[212:215]
    s_waitcnt lgkmcnt(3)
    ds_read_b128 a[248:251], v227 offset:6336
    v_fma_f32 v174, v174, s37, -v236
    v_mfma_f32_16x16x32_bf16 v[220:223], a[192:195], a[252:255], v[220:223]
    v_exp_f32 v171, v171
    v_mfma_f32_16x16x32_bf16 v[220:223], a[204:207], v[252:255], v[220:223]
    v_cvt_pk_bf16_f32 v181, v170, v171
    v_fma_f32 v175, v175, s37, -v236
    v_mfma_f32_16x16x32_bf16 v[216:219], a[196:199], a[252:255], v[216:219]
    ds_read_b128 v[168:171], v234
    v_bfe_u32 v234, s67, v233, 4
    v_mfma_f32_16x16x32_bf16 v[216:219], a[208:211], v[252:255], v[216:219]
    v_mad_u32_u24 v234, v234, s40, v231
    v_fma_f32 v144, v144, s37, -v236
    v_mfma_f32_16x16x32_bf16 v[212:215], a[200:203], a[252:255], v[212:215]
    v_cvt_pk_bf16_f32 v132, v220, v221
    v_cvt_pk_bf16_f32 v133, v222, v223
    v_mfma_f32_16x16x32_bf16 v[212:215], a[212:215], v[252:255], v[212:215]
    s_waitcnt lgkmcnt(3)
    ds_read_b128 a[252:255], v227 offset:6400
    ds_read_b128 v[252:255], v227 offset:6464
    v_mfma_f32_16x16x32_bf16 v[208:211], a[0:3], a[236:239], 0
    v_cvt_pk_bf16_f32 v134, v216, v217
    v_cvt_pk_bf16_f32 v135, v218, v219
    v_mfma_f32_16x16x32_bf16 v[208:211], a[12:15], a[240:243], v[208:211]
    v_exp_f32 v172, v172
    v_mfma_f32_16x16x32_bf16 v[204:207], a[4:7], a[236:239], 0
    v_cvt_pk_bf16_f32 v136, v212, v213
    v_cvt_pk_bf16_f32 v137, v214, v215
    v_mfma_f32_16x16x32_bf16 v[204:207], a[16:19], a[240:243], v[204:207]
    s_waitcnt lgkmcnt(2)
    v_exp_f32 v173, v173
    v_mfma_f32_16x16x32_bf16 v[168:171], v[24:27], v[138:141], v[168:171]
    v_exp_f32 v174, v174
    v_mfma_f32_16x16x32_bf16 v[200:203], a[8:11], a[236:239], 0
    v_exp_f32 v175, v175
    v_mfma_f32_16x16x32_bf16 v[200:203], a[20:23], a[240:243], v[200:203]
    v_cvt_pk_bf16_f32 v182, v172, v173
    v_cvt_pk_bf16_f32 v183, v174, v175
    v_mfma_f32_16x16x16_bf16 v[168:171], v[28:29], v[142:143], v[168:171]
    ds_read_b128 v[172:175], v235
    v_bfe_u32 v235, s68, v233, 4
    v_mfma_f32_16x16x32_bf16 v[196:199], a[216:219], v[180:183], 0
    v_mad_u32_u24 v235, v235, s40, v231
    v_fma_f32 v145, v145, s37, -v236
    v_mfma_f32_16x16x32_bf16 v[184:187], v[70:73], v[180:183], 0
    v_fma_f32 v146, v146, s37, -v236
    v_fma_f32 v147, v147, s37, -v236
    v_mfma_f32_16x16x32_bf16 v[188:191], v[92:95], v[180:183], 0
    v_exp_f32 v144, v144
    v_mfma_f32_16x16x32_bf16 v[192:195], v[114:117], v[180:183], 0
    v_exp_f32 v145, v145
    v_mfma_f32_16x16x32_bf16 v[220:223], a[236:239], a[72:75], 0
    v_exp_f32 v146, v146
    v_mfma_f32_16x16x32_bf16 v[220:223], a[240:243], a[84:87], v[220:223]
    v_exp_f32 v147, v147
    v_mfma_f32_16x16x32_bf16 v[216:219], a[236:239], a[76:79], 0
    v_cvt_pk_bf16_f32 v176, v144, v145
    v_cvt_pk_bf16_f32 v177, v146, v147
    v_mfma_f32_16x16x32_bf16 v[216:219], a[240:243], a[88:91], v[216:219]
    s_waitcnt lgkmcnt(0)
    ds_read_b128 v[144:147], v230 offset:1280
    v_fma_f32 v148, v148, s37, -v236
    v_mfma_f32_16x16x32_bf16 v[172:175], v[30:33], v[138:141], v[172:175]
    v_fma_f32 v149, v149, s37, -v236
    v_fma_f32 v150, v150, s37, -v236
    v_mfma_f32_16x16x32_bf16 v[212:215], a[236:239], a[80:83], 0
    ds_read_b128 a[236:239], v239
    v_fma_f32 v151, v151, s37, -v236
    v_mfma_f32_16x16x32_bf16 v[212:215], a[240:243], a[92:95], v[212:215]
    ds_read_b128 a[240:243], v240
    v_fma_f32 v152, v152, s37, -v236
    v_mfma_f32_16x16x16_bf16 v[172:175], v[34:35], v[142:143], v[172:175]
    v_exp_f32 v148, v148
    v_mfma_f32_16x16x32_bf16 v[208:211], a[24:27], a[244:247], v[208:211]
    v_exp_f32 v149, v149
    v_mfma_f32_16x16x32_bf16 v[208:211], a[36:39], a[248:251], v[208:211]
    v_exp_f32 v150, v150
    v_mfma_f32_16x16x32_bf16 v[204:207], a[28:31], a[244:247], v[204:207]
    v_exp_f32 v151, v151
    v_mfma_f32_16x16x32_bf16 v[204:207], a[40:43], a[248:251], v[204:207]
    s_waitcnt lgkmcnt(2)
    v_cvt_pk_bf16_f32 v178, v148, v149
    v_cvt_pk_bf16_f32 v179, v150, v151
    v_mfma_f32_16x16x32_bf16 v[144:147], v[36:39], v[138:141], v[144:147]
    ds_read_b128 v[148:151], v230 offset:1920
    v_fma_f32 v153, v153, s37, -v236
    v_mfma_f32_16x16x32_bf16 v[196:199], a[216:219], v[176:179], v[196:199]
    v_fma_f32 v154, v154, s37, -v236
    v_fma_f32 v155, v155, s37, -v236
    v_mfma_f32_16x16x32_bf16 v[184:187], v[74:77], v[176:179], v[184:187]
    v_exp_f32 v152, v152
    v_mfma_f32_16x16x32_bf16 v[188:191], v[96:99], v[176:179], v[188:191]
    v_exp_f32 v153, v153
    v_mfma_f32_16x16x32_bf16 v[192:195], v[118:121], v[176:179], v[192:195]
    v_exp_f32 v154, v154
    v_mfma_f32_16x16x16_bf16 v[144:147], v[40:41], v[142:143], v[144:147]
    v_exp_f32 v155, v155
    v_mfma_f32_16x16x32_bf16 v[200:203], a[32:35], a[244:247], v[200:203]
    v_cvt_pk_bf16_f32 v180, v152, v153
    v_cvt_pk_bf16_f32 v181, v154, v155
    v_mfma_f32_16x16x32_bf16 v[200:203], a[44:47], a[248:251], v[200:203]
    s_waitcnt lgkmcnt(0)
    ds_read_b128 v[152:155], v250
    v_bfe_u32 v250, s69, v233, 4
    v_mfma_f32_16x16x32_bf16 v[148:151], v[42:45], v[138:141], v[148:151]
    v_mad_u32_u24 v250, v250, s40, v231
    v_fma_f32 v156, v156, s37, -v236
    v_mfma_f32_16x16x32_bf16 v[220:223], a[244:247], a[96:99], v[220:223]
    v_fma_f32 v157, v157, s37, -v236
    v_fma_f32 v158, v158, s37, -v236
    v_mfma_f32_16x16x32_bf16 v[220:223], a[248:251], a[108:111], v[220:223]
    v_fma_f32 v159, v159, s37, -v236
    v_fma_f32 v160, v160, s37, -v236
    v_mfma_f32_16x16x16_bf16 v[148:151], v[46:47], v[142:143], v[148:151]
    v_exp_f32 v156, v156
    v_mfma_f32_16x16x32_bf16 v[216:219], a[244:247], a[100:103], v[216:219]
    v_exp_f32 v157, v157
    v_mfma_f32_16x16x32_bf16 v[216:219], a[248:251], a[112:115], v[216:219]
    v_exp_f32 v158, v158
    v_mfma_f32_16x16x32_bf16 v[212:215], a[244:247], a[104:107], v[212:215]
    ds_read_b128 a[244:247], v239 offset:1024
    v_cvt_pk_bf16_f32 v182, v156, v157
    v_mfma_f32_16x16x32_bf16 v[212:215], a[248:251], a[116:119], v[212:215]
    ds_read_b128 a[248:251], v240 offset:1024
    v_fma_f32 v161, v161, s37, -v236
    v_mfma_f32_16x16x32_bf16 v[208:211], a[48:51], a[252:255], v[208:211]
    v_exp_f32 v159, v159
    v_mfma_f32_16x16x32_bf16 v[208:211], a[60:63], v[252:255], v[208:211]
    v_cvt_pk_bf16_f32 v183, v158, v159
    v_fma_f32 v162, v162, s37, -v236
    v_mfma_f32_16x16x32_bf16 v[204:207], a[52:55], a[252:255], v[204:207]
    ds_read_b128 v[156:159], v234
    v_bfe_u32 v234, s70, v233, 4
    v_mfma_f32_16x16x32_bf16 v[204:207], a[64:67], v[252:255], v[204:207]
    v_mad_u32_u24 v234, v234, s40, v231
    v_fma_f32 v163, v163, s37, -v236
    v_mfma_f32_16x16x32_bf16 v[196:199], a[216:219], v[180:183], v[196:199]
    v_cvt_pk_bf16_f32 v60, v208, v209
    v_cvt_pk_bf16_f32 v61, v210, v211
    v_mfma_f32_16x16x32_bf16 v[184:187], v[78:81], v[180:183], v[184:187]
    v_cndmask_b32 v48, v48, v60, s[82:83]
    v_cndmask_b32 v49, v49, v61, s[82:83]
    v_mfma_f32_16x16x32_bf16 v[188:191], v[100:103], v[180:183], v[188:191]
    v_cvt_pk_bf16_f32 v62, v204, v205
    v_cvt_pk_bf16_f32 v63, v206, v207
    v_mfma_f32_16x16x32_bf16 v[192:195], v[122:125], v[180:183], v[192:195]
    v_cndmask_b32 v50, v50, v62, s[82:83]
    v_cndmask_b32 v51, v51, v63, s[82:83]
    v_mfma_f32_16x16x32_bf16 v[200:203], a[56:59], a[252:255], v[200:203]
    v_exp_f32 v160, v160
    v_mfma_f32_16x16x32_bf16 v[200:203], a[68:71], v[252:255], v[200:203]
    s_waitcnt lgkmcnt(1)
    v_exp_f32 v161, v161
    v_mfma_f32_16x16x32_bf16 v[152:155], v[48:51], v[138:141], v[152:155]
    s_waitcnt lgkmcnt(0)
    v_exp_f32 v162, v162
    v_mfma_f32_16x16x32_bf16 v[156:159], v[54:57], v[138:141], v[156:159]
    v_exp_f32 v163, v163
    v_mfma_f32_16x16x32_bf16 v[220:223], a[252:255], a[120:123], v[220:223]
    v_cvt_pk_bf16_f32 v176, v160, v161
    v_cvt_pk_bf16_f32 v177, v162, v163
    v_mfma_f32_16x16x32_bf16 v[220:223], v[252:255], a[132:135], v[220:223]
    ds_read_b128 v[160:163], v228 offset:640
    v_cvt_pk_bf16_f32 v64, v200, v201
    v_mfma_f32_16x16x16_bf16 v[156:159], v[58:59], v[142:143], v[156:159]
    v_cvt_pk_bf16_f32 v65, v202, v203
    v_cndmask_b32 v52, v52, v64, s[82:83]
    v_mfma_f32_16x16x32_bf16 v[216:219], a[252:255], a[124:127], v[216:219]
    v_cndmask_b32 v53, v53, v65, s[82:83]
    v_fma_f32 v164, v164, s37, -v236
    v_mfma_f32_16x16x32_bf16 v[216:219], v[252:255], a[136:139], v[216:219]
    v_cvt_pk_bf16_f32 v86, v220, v221
    v_cvt_pk_bf16_f32 v87, v222, v223
    v_mfma_f32_16x16x16_bf16 v[152:155], v[52:53], v[142:143], v[152:155]
    v_cndmask_b32 v82, v82, v86, s[84:85]
    v_cndmask_b32 v83, v83, v87, s[84:85]
    v_mfma_f32_16x16x32_bf16 v[212:215], a[252:255], a[128:131], v[212:215]
    ds_read_b128 a[252:255], v241 offset:12288
    v_fma_f32 v165, v165, s37, -v236
    v_mfma_f32_16x16x32_bf16 v[212:215], v[252:255], a[140:143], v[212:215]
    v_cvt_pk_bf16_f32 v108, v216, v217
    v_cvt_pk_bf16_f32 v109, v218, v219
    v_mfma_f32_16x16x32_bf16 v[208:211], a[220:223], a[236:239], 0
    s_waitcnt lgkmcnt(1)
    v_cndmask_b32 v104, v104, v108, s[84:85]
    v_cndmask_b32 v105, v105, v109, s[84:85]
    v_mfma_f32_16x16x32_bf16 v[160:163], v[12:15], v[132:135], v[160:163]
    ds_read_b128 v[252:255], v241 offset:12800
    v_fma_f32 v166, v166, s37, -v236
    v_mfma_f32_16x16x32_bf16 v[200:203], a[220:223], a[240:243], 0
    v_cvt_pk_bf16_f32 v130, v212, v213
    v_cvt_pk_bf16_f32 v131, v214, v215
    v_mfma_f32_16x16x32_bf16 v[204:207], a[224:227], a[236:239], 0
    v_cndmask_b32 v126, v126, v130, s[84:85]
    v_cndmask_b32 v127, v127, v131, s[84:85]
    v_mfma_f32_16x16x16_bf16 v[160:163], v[16:17], v[136:137], v[160:163]
    v_fma_f32 v167, v167, s37, -v236
    v_max3_f32 v248, v168, v169, v170
    v_mfma_f32_16x16x32_bf16 v[220:223], a[224:227], a[240:243], 0
    ds_read_b128 a[240:243], v242 offset:12800
    v_max3_f32 v249, v171, v172, v173
    v_mfma_f32_16x16x32_bf16 v[216:219], a[228:231], a[236:239], 0
    v_exp_f32 v164, v164
    v_mfma_f32_16x16x32_bf16 v[212:215], a[232:235], a[236:239], 0
    s_waitcnt lgkmcnt(2)
    ds_read_b128 a[236:239], v242 offset:12288
    v_max3_f32 v248, v248, v174, v175
    v_mfma_f32_16x16x32_bf16 v[208:211], a[252:255], a[244:247], v[208:211]
    v_exp_f32 v165, v165
    v_mfma_f32_16x16x32_bf16 v[200:203], a[252:255], a[248:251], v[200:203]
    s_waitcnt lgkmcnt(2)
    ds_read_b128 a[252:255], v241 offset:24576
    v_cvt_pk_bf16_f32 v178, v164, v165
    v_mfma_f32_16x16x32_bf16 v[204:207], v[252:255], a[244:247], v[204:207]
    v_exp_f32 v166, v166
    v_mfma_f32_16x16x32_bf16 v[220:223], v[252:255], a[248:251], v[220:223]
    s_waitcnt lgkmcnt(2)
    ds_read_b128 a[248:251], v240 offset:2048
    ds_read_b128 v[252:255], v241 offset:25088
    v_mfma_f32_16x16x32_bf16 v[212:215], a[240:243], a[244:247], v[212:215]
    s_waitcnt lgkmcnt(3)
    ds_read_b128 a[240:243], v242 offset:25088
    v_exp_f32 v167, v167
    v_max3_f32 v249, v249, v144, v145
    v_cvt_pk_bf16_f32 v179, v166, v167
    ds_read_b128 v[164:167], v229 offset:640
    v_mfma_f32_16x16x32_bf16 v[216:219], a[236:239], a[244:247], v[216:219]
    ds_read_b128 a[244:247], v239 offset:2048
    v_max3_f32 v248, v248, v146, v147
    v_mfma_f32_16x16x32_bf16 v[196:199], a[216:219], v[176:179], v[196:199]
    ds_read_b128 a[236:239], v242 offset:24576
    v_max3_f32 v249, v249, v148, v149
    v_mfma_f32_16x16x32_bf16 v[184:187], v[66:69], v[176:179], v[184:187]
    v_max3_f32 v248, v248, v150, v151
    v_max3_f32 v249, v249, v152, v153
    v_mfma_f32_16x16x32_bf16 v[188:191], v[88:91], v[176:179], v[188:191]
    v_max3_f32 v248, v248, v154, v155
    v_max3_f32 v249, v249, v156, v157
    v_mfma_f32_16x16x32_bf16 v[192:195], v[110:113], v[176:179], v[192:195]
    s_waitcnt lgkmcnt(5)
    v_rcp_f32 v197, v196
    v_mfma_f32_16x16x32_bf16 v[200:203], a[252:255], a[248:251], v[200:203]
    s_waitcnt lgkmcnt(4)
    v_mul_f32 v184, v184, v197
    v_mul_f32 v185, v185, v197
    v_mfma_f32_16x16x32_bf16 v[220:223], v[252:255], a[248:251], v[220:223]
    s_waitcnt lgkmcnt(2)
    ds_read_b128 a[248:251], v240 offset:3072
    v_cvt_pk_bf16_f32 v184, v184, v185
    v_mfma_f32_16x16x32_bf16 v[164:167], v[36:39], v[132:135], v[164:167]
    s_waitcnt lgkmcnt(2)
    v_mul_f32 v186, v186, v197
    v_mul_f32 v187, v187, v197
    v_mfma_f32_16x16x32_bf16 v[208:211], a[252:255], a[244:247], v[208:211]
    ds_read_b128 a[252:255], v241 offset:36864
    v_cvt_pk_bf16_f32 v185, v186, v187
    v_mfma_f32_16x16x32_bf16 v[204:207], v[252:255], a[244:247], v[204:207]
    ds_read_b128 v[252:255], v241 offset:37376
    v_mul_f32 v188, v188, v197
    v_mfma_f32_16x16x16_bf16 v[164:167], v[40:41], v[136:137], v[164:167]
    s_waitcnt lgkmcnt(3)
    v_mul_f32 v189, v189, v197
    v_cvt_pk_bf16_f32 v186, v188, v189
    v_mfma_f32_16x16x32_bf16 v[216:219], a[236:239], a[244:247], v[216:219]
    ds_read_b128 a[236:239], v242 offset:36864
    v_mul_f32 v190, v190, v197
    v_mfma_f32_16x16x32_bf16 v[212:215], a[240:243], a[244:247], v[212:215]
    s_waitcnt lgkmcnt(2)
    ds_read_b128 a[244:247], v239 offset:3072
    ds_read_b128 a[240:243], v242 offset:37376
    v_mul_f32 v191, v191, v197
    v_cvt_pk_bf16_f32 v187, v190, v191
    v_mul_f32 v192, v192, v197
    v_mul_f32 v193, v193, v197
    v_cvt_pk_bf16_f32 v188, v192, v193
    v_mul_f32 v194, v194, v197
    v_mul_f32 v195, v195, v197
    v_cvt_pk_bf16_f32 v189, v194, v195
    v_mfma_f32_16x16x32_bf16 v[200:203], a[252:255], a[248:251], v[200:203]
    s_waitcnt lgkmcnt(3)
    ds_write_b128 v237, v[184:187] offset:12288
    v_mfma_f32_16x16x32_bf16 v[220:223], v[252:255], a[248:251], v[220:223]
    s_waitcnt lgkmcnt(2)
    ds_write_b64 v238, v[188:189] offset:12288
    v_max3_f32 v248, v248, v158, v159
    v_max_f32 v248, v248, v249
    v_mov_b32 v249, v248
    s_nop 1
    v_mfma_f32_16x16x32_bf16 v[208:211], a[252:255], a[244:247], v[208:211]
    v_permlane16_swap_b32 v248, v249
    v_mfma_f32_16x16x32_bf16 v[204:207], v[252:255], a[244:247], v[204:207]
    v_max_f32 v248, v248, v249
    v_mov_b32 v249, v248
    v_mfma_f32_16x16x32_bf16 v[216:219], a[236:239], a[244:247], v[216:219]
    s_waitcnt lgkmcnt(2)
    ds_read_b128 a[248:251], v240 offset:4096
    ds_read_b128 a[252:255], v241 offset:49152
    v_mfma_f32_16x16x32_bf16 v[212:215], a[240:243], a[244:247], v[212:215]
    s_waitcnt lgkmcnt(0)
    ds_read_b128 a[244:247], v239 offset:4096
    v_permlane32_swap_b32 v248, v249
    v_max_f32 v248, v248, v249
    ds_read_b128 v[252:255], v241 offset:49664
    v_mul_f32 v236, s37, v248
    ds_read_b128 a[236:239], v242 offset:49152
    v_fma_f32 v168, v168, s37, -v236
    ds_read_b128 a[240:243], v242 offset:49664
    v_fma_f32 v169, v169, s37, -v236
    v_fma_f32 v170, v170, s37, -v236
    v_fma_f32 v171, v171, s37, -v236
    v_exp_f32 v168, v168
    v_exp_f32 v169, v169
    v_exp_f32 v170, v170
    v_exp_f32 v171, v171
    v_mfma_f32_16x16x32_bf16 v[200:203], a[252:255], a[248:251], v[200:203]
    s_waitcnt lgkmcnt(3)
    v_cvt_pk_bf16_f32 v180, v168, v169
    v_cvt_pk_bf16_f32 v181, v170, v171
    v_mfma_f32_16x16x32_bf16 v[208:211], a[252:255], a[244:247], v[208:211]
    s_waitcnt lgkmcnt(2)
    ds_read_b128 v[168:171], v229 offset:1280
    v_fma_f32 v172, v172, s37, -v236
    v_mfma_f32_16x16x32_bf16 v[204:207], v[252:255], a[244:247], v[204:207]
    ds_read_b128 a[252:255], v241 offset:61440
    v_fma_f32 v173, v173, s37, -v236
    v_mfma_f32_16x16x32_bf16 v[220:223], v[252:255], a[248:251], v[220:223]
    s_waitcnt lgkmcnt(3)
    ds_read_b128 a[248:251], v240 offset:5120
    v_fma_f32 v174, v174, s37, -v236
    v_mfma_f32_16x16x32_bf16 v[216:219], a[236:239], a[244:247], v[216:219]
    s_waitcnt lgkmcnt(3)
    ds_read_b128 v[252:255], v241 offset:61952
    v_fma_f32 v175, v175, s37, -v236
    v_mfma_f32_16x16x32_bf16 v[212:215], a[240:243], a[244:247], v[212:215]
    s_waitcnt lgkmcnt(3)
    ds_read_b128 a[244:247], v239 offset:5120
    v_exp_f32 v172, v172
    ds_read_b128 a[236:239], v242 offset:61440
    ds_read_b128 a[240:243], v242 offset:61952
    v_exp_f32 v173, v173
    v_exp_f32 v174, v174
    v_exp_f32 v175, v175
    v_mfma_f32_16x16x32_bf16 v[168:171], v[42:45], v[132:135], v[168:171]
    s_waitcnt lgkmcnt(4)
    v_cvt_pk_bf16_f32 v182, v172, v173
    v_cvt_pk_bf16_f32 v183, v174, v175
    ds_read_b128 v[172:175], v228 offset:1280
    v_mfma_f32_16x16x32_bf16 v[200:203], a[252:255], a[248:251], v[200:203]
    v_fma_f32 v144, v144, s37, -v236
    v_fma_f32 v145, v145, s37, -v236
    v_mfma_f32_16x16x32_bf16 v[196:199], a[216:219], v[180:183], 0
    v_fma_f32 v146, v146, s37, -v236
    v_fma_f32 v147, v147, s37, -v236
    v_mfma_f32_16x16x32_bf16 v[184:187], v[68:71], v[180:183], 0
    v_exp_f32 v144, v144
    v_mfma_f32_16x16x32_bf16 v[188:191], v[90:93], v[180:183], 0
    v_cvt_pk_bf16_f32 v200, v200, v201
    v_cvt_pk_bf16_f32 v201, v202, v203
    v_mfma_f32_16x16x32_bf16 v[192:195], v[112:115], v[180:183], 0
    v_exp_f32 v145, v145
    v_mfma_f32_16x16x16_bf16 v[168:171], v[46:47], v[136:137], v[168:171]
    s_waitcnt lgkmcnt(1)
    v_exp_f32 v146, v146
    v_mfma_f32_16x16x32_bf16 v[208:211], a[252:255], a[244:247], v[208:211]
    s_waitcnt lgkmcnt(0)
    ds_read_b128 a[252:255], v224 offset:15616
    v_cvt_pk_bf16_f32 v176, v144, v145
    v_mfma_f32_16x16x32_bf16 v[172:175], v[18:21], v[132:135], v[172:175]
    v_exp_f32 v147, v147
    v_mfma_f32_16x16x32_bf16 v[204:207], v[252:255], a[244:247], v[204:207]
    v_cvt_pk_bf16_f32 v177, v146, v147
    v_fma_f32 v148, v148, s37, -v236
    v_mfma_f32_16x16x32_bf16 v[220:223], v[252:255], a[248:251], v[220:223]
    ds_read_b128 v[144:147], v228 offset:1920
    v_cvt_pk_bf16_f32 v208, v208, v209
    v_mfma_f32_16x16x16_bf16 v[172:175], v[22:23], v[136:137], v[172:175]
    ds_read_b128 a[248:251], v224 offset:15552
    v_cvt_pk_bf16_f32 v209, v210, v211
    v_mfma_f32_16x16x32_bf16 v[216:219], a[236:239], a[244:247], v[216:219]
    ds_read_b128 v[252:255], v224 offset:15680
    v_cvt_pk_bf16_f32 v210, v204, v205
    v_mfma_f32_16x16x32_bf16 v[212:215], a[240:243], a[244:247], v[212:215]
    s_waitcnt lgkmcnt(2)
    ds_read_b128 a[244:247], v224 offset:15488
    v_cvt_pk_bf16_f32 v211, v206, v207
    ds_read_b128 a[236:239], v224 offset:15744
    buffer_store_dwordx4 v[208:211], v243, s[20:23], s51 offen sc0 sc1
    ds_read_b128 a[240:243], v224 offset:15808
    v_cvt_pk_bf16_f32 v202, v220, v221
    v_cvt_pk_bf16_f32 v203, v222, v223
    v_cvt_pk_bf16_f32 v216, v216, v217
    v_cvt_pk_bf16_f32 v217, v218, v219
    v_cvt_pk_bf16_f32 v218, v212, v213
    v_mfma_f32_16x16x32_bf16 v[144:147], v[0:3], v[132:135], v[144:147]
    v_cvt_pk_bf16_f32 v219, v214, v215
    v_fma_f32 v149, v149, s37, -v236
    v_fma_f32 v150, v150, s37, -v236
    v_fma_f32 v151, v151, s37, -v236
    v_exp_f32 v148, v148
    v_exp_f32 v149, v149
    v_mfma_f32_16x16x16_bf16 v[144:147], v[4:5], v[136:137], v[144:147]
    s_waitcnt lgkmcnt(2)
    v_exp_f32 v150, v150
    v_mfma_f32_16x16x32_bf16 v[208:211], a[0:3], a[244:247], 0
    v_exp_f32 v151, v151
    v_mfma_f32_16x16x32_bf16 v[208:211], a[12:15], a[248:251], v[208:211]
    v_cvt_pk_bf16_f32 v178, v148, v149
    v_cvt_pk_bf16_f32 v179, v150, v151
    v_mfma_f32_16x16x32_bf16 v[204:207], a[4:7], a[244:247], 0
    ds_read_b128 v[148:151], v229 offset:1920
    v_fma_f32 v152, v152, s37, -v236
    v_mfma_f32_16x16x32_bf16 v[204:207], a[16:19], a[248:251], v[204:207]
    v_fma_f32 v153, v153, s37, -v236
    v_fma_f32 v154, v154, s37, -v236
    v_mfma_f32_16x16x32_bf16 v[196:199], a[216:219], v[176:179], v[196:199]
    v_fma_f32 v155, v155, s37, -v236
    v_fma_f32 v156, v156, s37, -v236
    v_mfma_f32_16x16x32_bf16 v[184:187], v[76:79], v[176:179], v[184:187]
    v_exp_f32 v152, v152
    v_mfma_f32_16x16x32_bf16 v[188:191], v[98:101], v[176:179], v[188:191]
    buffer_store_dwordx4 v[200:203], v245, s[20:23], s51 offen sc0 sc1
    v_mfma_f32_16x16x32_bf16 v[192:195], v[120:123], v[176:179], v[192:195]
    v_exp_f32 v153, v153
    v_mfma_f32_16x16x32_bf16 v[200:203], a[8:11], a[244:247], 0
    v_exp_f32 v154, v154
    v_mfma_f32_16x16x32_bf16 v[200:203], a[20:23], a[248:251], v[200:203]
    s_waitcnt lgkmcnt(0)
    v_exp_f32 v155, v155
    v_mfma_f32_16x16x32_bf16 v[148:151], v[24:27], v[132:135], v[148:151]
    v_cvt_pk_bf16_f32 v180, v152, v153
    v_cvt_pk_bf16_f32 v181, v154, v155
    v_mfma_f32_16x16x32_bf16 v[220:223], a[244:247], a[72:75], 0
    ds_read_b128 v[152:155], v229 offset:2560
    v_fma_f32 v157, v157, s37, -v236
    v_mfma_f32_16x16x32_bf16 v[220:223], a[248:251], a[84:87], v[220:223]
    v_fma_f32 v158, v158, s37, -v236
    v_fma_f32 v159, v159, s37, -v236
    v_mfma_f32_16x16x16_bf16 v[148:151], v[28:29], v[136:137], v[148:151]
    v_exp_f32 v156, v156
    v_mfma_f32_16x16x32_bf16 v[212:215], a[244:247], a[80:83], 0
    v_exp_f32 v157, v157
    v_mfma_f32_16x16x32_bf16 v[212:215], a[248:251], a[92:95], v[212:215]
    v_exp_f32 v158, v158
    v_mfma_f32_16x16x32_bf16 v[208:211], a[24:27], a[252:255], v[208:211]
    v_exp_f32 v159, v159
    v_mfma_f32_16x16x32_bf16 v[208:211], a[36:39], v[252:255], v[208:211]
    v_cvt_pk_bf16_f32 v182, v156, v157
    v_cvt_pk_bf16_f32 v183, v158, v159
    v_mfma_f32_16x16x32_bf16 v[204:207], a[28:31], a[252:255], v[204:207]
    ds_read_b128 v[156:159], v228 offset:2560
    v_max3_f32 v248, v160, v161, v162
    v_mfma_f32_16x16x32_bf16 v[204:207], a[40:43], v[252:255], v[204:207]
    buffer_store_dwordx4 v[216:219], v244, s[20:23], s51 offen sc0 sc1
    v_mfma_f32_16x16x32_bf16 v[196:199], a[216:219], v[180:183], v[196:199]
    s_add_u32 s51, s51, s48
    v_max3_f32 v249, v163, v164, v165
    v_max3_f32 v248, v248, v166, v167
    v_mfma_f32_16x16x32_bf16 v[184:187], v[82:85], v[180:183], v[184:187]
    v_max3_f32 v249, v249, v168, v169
    v_max3_f32 v248, v248, v170, v171
    v_mfma_f32_16x16x32_bf16 v[188:191], v[104:107], v[180:183], v[188:191]
    v_max3_f32 v249, v249, v172, v173
    v_max3_f32 v248, v248, v174, v175
    v_mfma_f32_16x16x32_bf16 v[192:195], v[126:129], v[180:183], v[192:195]
    v_rcp_f32 v197, v196
    v_mfma_f32_16x16x32_bf16 v[216:219], a[244:247], a[76:79], 0
    ds_read_b128 a[244:247], v224 offset:18560
    v_mul_f32 v184, v184, v197
    v_mfma_f32_16x16x32_bf16 v[216:219], a[248:251], a[88:91], v[216:219]
    ds_read_b128 a[248:251], v224 offset:18624
    v_mul_f32 v185, v185, v197
    v_mfma_f32_16x16x32_bf16 v[200:203], a[32:35], a[252:255], v[200:203]
    v_cvt_pk_bf16_f32 v184, v184, v185
    v_mul_f32 v186, v186, v197
    v_mfma_f32_16x16x32_bf16 v[200:203], a[44:47], v[252:255], v[200:203]
    v_mul_f32 v187, v187, v197
    v_cvt_pk_bf16_f32 v185, v186, v187
    v_mfma_f32_16x16x32_bf16 v[220:223], a[252:255], a[96:99], v[220:223]
    v_mul_f32 v188, v188, v197
    v_mul_f32 v189, v189, v197
    v_mfma_f32_16x16x32_bf16 v[220:223], v[252:255], a[108:111], v[220:223]
    v_cvt_pk_bf16_f32 v186, v188, v189
    v_mul_f32 v190, v190, v197
    v_mfma_f32_16x16x32_bf16 v[216:219], a[252:255], a[100:103], v[216:219]
    v_mul_f32 v191, v191, v197
    v_cvt_pk_bf16_f32 v187, v190, v191
    v_mfma_f32_16x16x32_bf16 v[216:219], v[252:255], a[112:115], v[216:219]
    v_mul_f32 v192, v192, v197
    v_mul_f32 v193, v193, v197
    v_mfma_f32_16x16x32_bf16 v[212:215], a[252:255], a[104:107], v[212:215]
    ds_read_b128 a[252:255], v224 offset:18688
    v_cvt_pk_bf16_f32 v188, v192, v193
    v_mfma_f32_16x16x32_bf16 v[212:215], v[252:255], a[116:119], v[212:215]
    ds_read_b128 v[252:255], v224 offset:18752
    v_mul_f32 v194, v194, v197
    v_mfma_f32_16x16x32_bf16 v[208:211], a[48:51], a[236:239], v[208:211]
    v_mul_f32 v195, v195, v197
    v_cvt_pk_bf16_f32 v189, v194, v195
    v_mfma_f32_16x16x32_bf16 v[208:211], a[60:63], a[240:243], v[208:211]
    ds_write_b128 v237, v[184:187] offset:18432
    v_mfma_f32_16x16x32_bf16 v[204:207], a[52:55], a[236:239], v[204:207]
    ds_write_b64 v238, v[188:189] offset:18432
    v_mfma_f32_16x16x32_bf16 v[204:207], a[64:67], a[240:243], v[204:207]
    v_max3_f32 v249, v249, v144, v145
    v_max3_f32 v248, v248, v146, v147
    v_mfma_f32_16x16x32_bf16 v[200:203], a[56:59], a[236:239], v[200:203]
    v_max3_f32 v249, v249, v148, v149
    v_cvt_pk_bf16_f32 v6, v208, v209
    v_mfma_f32_16x16x32_bf16 v[200:203], a[68:71], a[240:243], v[200:203]
    v_cvt_pk_bf16_f32 v7, v210, v211
    v_max3_f32 v248, v248, v150, v151
    v_mfma_f32_16x16x32_bf16 v[220:223], a[236:239], a[120:123], v[220:223]
    v_cvt_pk_bf16_f32 v8, v204, v205
    v_cvt_pk_bf16_f32 v9, v206, v207
    v_mfma_f32_16x16x32_bf16 v[220:223], a[240:243], a[132:135], v[220:223]
    v_mfma_f32_16x16x32_bf16 v[216:219], a[236:239], a[124:127], v[216:219]
    v_mfma_f32_16x16x32_bf16 v[216:219], a[240:243], a[136:139], v[216:219]
    s_waitcnt lgkmcnt(2)
    v_cvt_pk_bf16_f32 v10, v200, v201
    v_cvt_pk_bf16_f32 v11, v202, v203
    v_mfma_f32_16x16x32_bf16 v[156:159], v[6:9], v[132:135], v[156:159]
    v_mfma_f32_16x16x32_bf16 v[212:215], a[236:239], a[128:131], v[212:215]
    ds_read_b128 a[236:239], v224 offset:18816
    v_mfma_f32_16x16x32_bf16 v[212:215], a[240:243], a[140:143], v[212:215]
    v_cvt_pk_bf16_f32 v72, v220, v221
    v_cvt_pk_bf16_f32 v73, v222, v223
    v_mfma_f32_16x16x32_bf16 v[208:211], a[0:3], a[244:247], 0
    v_cvt_pk_bf16_f32 v94, v216, v217
    v_cvt_pk_bf16_f32 v95, v218, v219
    v_mfma_f32_16x16x32_bf16 v[208:211], a[12:15], a[248:251], v[208:211]
    ds_read_b128 a[240:243], v224 offset:18880
    v_mfma_f32_16x16x16_bf16 v[156:159], v[10:11], v[136:137], v[156:159]
    v_cvt_pk_bf16_f32 v116, v212, v213
    v_cvt_pk_bf16_f32 v117, v214, v215
    v_mfma_f32_16x16x32_bf16 v[204:207], a[4:7], a[244:247], 0
    v_mfma_f32_16x16x32_bf16 v[204:207], a[16:19], a[248:251], v[204:207]
    v_mfma_f32_16x16x32_bf16 v[200:203], a[8:11], a[244:247], 0
    v_mfma_f32_16x16x32_bf16 v[200:203], a[20:23], a[248:251], v[200:203]
    v_mfma_f32_16x16x32_bf16 v[220:223], a[244:247], a[72:75], 0
    v_mfma_f32_16x16x32_bf16 v[220:223], a[248:251], a[84:87], v[220:223]
    v_mfma_f32_16x16x32_bf16 v[216:219], a[244:247], a[76:79], 0
    v_mfma_f32_16x16x32_bf16 v[216:219], a[248:251], a[88:91], v[216:219]
    v_mfma_f32_16x16x32_bf16 v[212:215], a[244:247], a[80:83], 0
    ds_read_b128 a[244:247], v226 offset:4224
    v_mfma_f32_16x16x32_bf16 v[212:215], a[248:251], a[92:95], v[212:215]
    ds_read_b128 a[248:251], v226 offset:4288
    v_mfma_f32_16x16x32_bf16 v[208:211], a[24:27], a[252:255], v[208:211]
    v_mfma_f32_16x16x32_bf16 v[208:211], a[36:39], v[252:255], v[208:211]
    v_mfma_f32_16x16x32_bf16 v[204:207], a[28:31], a[252:255], v[204:207]
    v_mfma_f32_16x16x32_bf16 v[204:207], a[40:43], v[252:255], v[204:207]
    v_mfma_f32_16x16x32_bf16 v[200:203], a[32:35], a[252:255], v[200:203]
    v_mfma_f32_16x16x32_bf16 v[200:203], a[44:47], v[252:255], v[200:203]
    v_mfma_f32_16x16x32_bf16 v[220:223], a[252:255], a[96:99], v[220:223]
    v_mfma_f32_16x16x32_bf16 v[220:223], v[252:255], a[108:111], v[220:223]
    v_mfma_f32_16x16x32_bf16 v[216:219], a[252:255], a[100:103], v[216:219]
    v_mfma_f32_16x16x32_bf16 v[216:219], v[252:255], a[112:115], v[216:219]
    v_mfma_f32_16x16x32_bf16 v[212:215], a[252:255], a[104:107], v[212:215]
    ds_read_b128 a[252:255], v226 offset:4352
    v_mfma_f32_16x16x32_bf16 v[212:215], v[252:255], a[116:119], v[212:215]
    s_waitcnt lgkmcnt(1)
    ds_read_b128 v[252:255], v226 offset:4416
    v_mfma_f32_16x16x32_bf16 v[208:211], a[48:51], a[236:239], v[208:211]
    v_mfma_f32_16x16x32_bf16 v[208:211], a[60:63], a[240:243], v[208:211]
    v_mfma_f32_16x16x32_bf16 v[204:207], a[52:55], a[236:239], v[204:207]
    v_mfma_f32_16x16x32_bf16 v[204:207], a[64:67], a[240:243], v[204:207]
    v_mfma_f32_16x16x32_bf16 v[200:203], a[56:59], a[236:239], v[200:203]
    v_mfma_f32_16x16x32_bf16 v[200:203], a[68:71], a[240:243], v[200:203]
    v_mfma_f32_16x16x32_bf16 v[220:223], a[236:239], a[120:123], v[220:223]
    v_mfma_f32_16x16x32_bf16 v[220:223], a[240:243], a[132:135], v[220:223]
    v_mfma_f32_16x16x32_bf16 v[216:219], a[236:239], a[124:127], v[216:219]
    v_mfma_f32_16x16x32_bf16 v[216:219], a[240:243], a[136:139], v[216:219]
    v_cvt_pk_bf16_f32 v30, v208, v209
    v_cvt_pk_bf16_f32 v31, v210, v211
    v_mfma_f32_16x16x32_bf16 v[212:215], a[236:239], a[128:131], v[212:215]
    v_cvt_pk_bf16_f32 v32, v204, v205
    v_cvt_pk_bf16_f32 v33, v206, v207
    v_mfma_f32_16x16x32_bf16 v[212:215], a[240:243], a[140:143], v[212:215]
    v_cvt_pk_bf16_f32 v34, v200, v201
    v_cvt_pk_bf16_f32 v35, v202, v203
    v_mfma_f32_16x16x32_bf16 v[152:155], v[30:33], v[132:135], v[152:155]
    v_cvt_pk_bf16_f32 v70, v220, v221
    v_cvt_pk_bf16_f32 v71, v222, v223
    v_mfma_f32_16x16x32_bf16 v[208:211], a[144:147], a[244:247], 0
    v_cvt_pk_bf16_f32 v92, v216, v217
    v_cvt_pk_bf16_f32 v93, v218, v219
    v_mfma_f32_16x16x32_bf16 v[208:211], a[156:159], a[248:251], v[208:211]
    v_cvt_pk_bf16_f32 v114, v212, v213
    v_cvt_pk_bf16_f32 v115, v214, v215
    v_mfma_f32_16x16x16_bf16 v[152:155], v[34:35], v[136:137], v[152:155]
    ds_read_b128 a[236:239], v226 offset:4480
    ds_read_b128 a[240:243], v226 offset:4544
    v_mfma_f32_16x16x32_bf16 v[204:207], a[148:151], a[244:247], 0
    v_mfma_f32_16x16x32_bf16 v[204:207], a[160:163], a[248:251], v[204:207]
    v_mfma_f32_16x16x32_bf16 v[200:203], a[152:155], a[244:247], 0
    ds_read_b128 a[244:247], v225 offset:8896
    v_mfma_f32_16x16x32_bf16 v[200:203], a[164:167], a[248:251], v[200:203]
    s_waitcnt lgkmcnt(3)
    ds_read_b128 a[248:251], v225 offset:8960
    v_max3_f32 v249, v249, v152, v153
    v_mfma_f32_16x16x32_bf16 v[208:211], a[168:171], a[252:255], v[208:211]
    v_max3_f32 v248, v248, v154, v155
    v_max3_f32 v249, v249, v156, v157
    v_mfma_f32_16x16x32_bf16 v[208:211], a[180:183], v[252:255], v[208:211]
    v_max3_f32 v248, v248, v158, v159
    v_max_f32 v248, v248, v249
    v_mfma_f32_16x16x32_bf16 v[204:207], a[172:175], a[252:255], v[204:207]
    s_waitcnt vmcnt(3) lgkmcnt(2)
    v_mov_b32 v249, v248
    v_mfma_f32_16x16x32_bf16 v[204:207], a[184:187], v[252:255], v[204:207]
    s_barrier
    buffer_load_dwordx4 v246, s[4:7], s56 offen lds
    v_mfma_f32_16x16x32_bf16 v[200:203], a[176:179], a[252:255], v[200:203]
    ds_read_b128 a[252:255], v225 offset:9024
    v_mfma_f32_16x16x32_bf16 v[200:203], a[188:191], v[252:255], v[200:203]
    ds_read_b128 v[252:255], v225 offset:9088
    v_mfma_f32_16x16x32_bf16 v[208:211], a[192:195], a[236:239], v[208:211]
    v_permlane16_swap_b32 v248, v249
    v_mfma_f32_16x16x32_bf16 v[208:211], a[204:207], a[240:243], v[208:211]
    v_max_f32 v248, v248, v249
    v_mov_b32 v249, v248
    v_mfma_f32_16x16x32_bf16 v[204:207], a[196:199], a[236:239], v[204:207]
    v_mfma_f32_16x16x32_bf16 v[204:207], a[208:211], a[240:243], v[204:207]
    buffer_load_dwordx4 v247, s[4:7], s56 offen offset:1024 lds
    v_mfma_f32_16x16x32_bf16 v[200:203], a[200:203], a[236:239], v[200:203]
    s_add_u32 s56, s56, s42
    ds_read_b128 a[236:239], v225 offset:9152
    v_cvt_pk_bf16_f32 v138, v208, v209
    v_mfma_f32_16x16x32_bf16 v[200:203], a[212:215], a[240:243], v[200:203]
    s_add_u32 m0, s41, 0xd3c0
    ds_read_b128 a[240:243], v225 offset:9216
    v_cvt_pk_bf16_f32 v139, v210, v211
    s_waitcnt lgkmcnt(4)
    v_mfma_f32_16x16x32_bf16 v[220:223], a[144:147], a[244:247], 0
    v_cvt_pk_bf16_f32 v140, v204, v205
    v_cvt_pk_bf16_f32 v141, v206, v207
    v_mfma_f32_16x16x32_bf16 v[220:223], a[156:159], a[248:251], v[220:223]
    v_permlane32_swap_b32 v248, v249
    v_mfma_f32_16x16x32_bf16 v[216:219], a[148:151], a[244:247], 0
    v_cvt_pk_bf16_f32 v142, v200, v201
    v_cvt_pk_bf16_f32 v143, v202, v203
    v_mfma_f32_16x16x32_bf16 v[216:219], a[160:163], a[248:251], v[216:219]
    buffer_load_dwordx4 v246, s[4:7], s56 offen lds
    v_mfma_f32_16x16x32_bf16 v[212:215], a[152:155], a[244:247], 0
    ds_read_b128 a[244:247], v239 offset:12288
    v_max_f32 v248, v248, v249
    v_mfma_f32_16x16x32_bf16 v[212:215], a[164:167], a[248:251], v[212:215]
    s_waitcnt lgkmcnt(3)
    ds_read_b128 a[248:251], v240 offset:12288
    v_mul_f32 v236, s37, v248
    v_mfma_f32_16x16x32_bf16 v[220:223], a[168:171], a[252:255], v[220:223]
    v_fma_f32 v160, v160, s37, -v236
    v_fma_f32 v161, v161, s37, -v236
    v_mfma_f32_16x16x32_bf16 v[220:223], a[180:183], v[252:255], v[220:223]
    v_fma_f32 v162, v162, s37, -v236
    v_fma_f32 v163, v163, s37, -v236
    v_mfma_f32_16x16x32_bf16 v[216:219], a[172:175], a[252:255], v[216:219]
    v_exp_f32 v160, v160
    v_mfma_f32_16x16x32_bf16 v[216:219], a[184:187], v[252:255], v[216:219]
    buffer_load_dwordx4 v247, s[4:7], s56 offen offset:1024 lds
    v_mfma_f32_16x16x32_bf16 v[212:215], a[176:179], a[252:255], v[212:215]
    s_add_u32 s56, s56, s42
    ds_read_b128 a[252:255], v239 offset:13312
    v_fma_f32 v164, v164, s37, -v236
    v_mfma_f32_16x16x32_bf16 v[212:215], a[188:191], v[252:255], v[212:215]
    s_add_u32 m0, s41, 0
    ds_read_b128 v[252:255], v240 offset:13312
    v_fma_f32 v165, v165, s37, -v236
    s_waitcnt lgkmcnt(4)
    v_mfma_f32_16x16x32_bf16 v[220:223], a[192:195], a[236:239], v[220:223]
    v_exp_f32 v161, v161
    v_mfma_f32_16x16x32_bf16 v[220:223], a[204:207], a[240:243], v[220:223]
    v_exp_f32 v162, v162
    v_mfma_f32_16x16x32_bf16 v[216:219], a[196:199], a[236:239], v[216:219]
    v_exp_f32 v163, v163
    v_mfma_f32_16x16x32_bf16 v[216:219], a[208:211], a[240:243], v[216:219]
    v_cvt_pk_bf16_f32 v176, v160, v161
    v_cvt_pk_bf16_f32 v177, v162, v163
    v_mfma_f32_16x16x32_bf16 v[212:215], a[200:203], a[236:239], v[212:215]
    ds_read_b128 v[160:163], v230 offset:640
    v_cvt_pk_bf16_f32 v132, v220, v221
    v_mfma_f32_16x16x32_bf16 v[212:215], a[212:215], a[240:243], v[212:215]
    s_waitcnt lgkmcnt(3)
    ds_read_b128 a[236:239], v241 offset:12288
    v_cvt_pk_bf16_f32 v133, v222, v223
    v_mfma_f32_16x16x32_bf16 v[208:211], a[220:223], a[244:247], 0
    v_cvt_pk_bf16_f32 v134, v216, v217
    v_cvt_pk_bf16_f32 v135, v218, v219
    v_mfma_f32_16x16x32_bf16 v[200:203], a[220:223], a[248:251], 0
    ds_read_b128 a[240:243], v241 offset:12800
    v_fma_f32 v166, v166, s37, -v236
    v_mfma_f32_16x16x32_bf16 v[204:207], a[224:227], a[244:247], 0
    v_cvt_pk_bf16_f32 v136, v212, v213
    v_cvt_pk_bf16_f32 v137, v214, v215
    v_mfma_f32_16x16x32_bf16 v[220:223], a[224:227], a[248:251], 0
    ds_read_b128 a[248:251], v242 offset:12800
    v_fma_f32 v167, v167, s37, -v236
    v_mfma_f32_16x16x32_bf16 v[216:219], a[228:231], a[244:247], 0
    v_exp_f32 v164, v164
    v_mfma_f32_16x16x32_bf16 v[212:215], a[232:235], a[244:247], 0
    s_waitcnt lgkmcnt(3)
    ds_read_b128 a[244:247], v242 offset:12288
    v_fma_f32 v168, v168, s37, -v236
    v_mfma_f32_16x16x32_bf16 v[160:163], v[36:39], v[138:141], v[160:163]
    s_waitcnt lgkmcnt(3)
    v_exp_f32 v165, v165
    v_mfma_f32_16x16x32_bf16 v[208:211], a[236:239], a[252:255], v[208:211]
    v_exp_f32 v166, v166
    v_mfma_f32_16x16x32_bf16 v[200:203], a[236:239], v[252:255], v[200:203]
    ds_read_b128 a[236:239], v241 offset:24576
    v_cvt_pk_bf16_f32 v178, v164, v165
    v_mfma_f32_16x16x16_bf16 v[160:163], v[40:41], v[142:143], v[160:163]
    s_waitcnt lgkmcnt(3)
    v_exp_f32 v167, v167
    v_mfma_f32_16x16x32_bf16 v[204:207], a[240:243], a[252:255], v[204:207]
    v_cvt_pk_bf16_f32 v179, v166, v167
    v_fma_f32 v169, v169, s37, -v236
    v_mfma_f32_16x16x32_bf16 v[220:223], a[240:243], v[252:255], v[220:223]
    ds_read_b128 v[164:167], v230 offset:1280
    v_fma_f32 v170, v170, s37, -v236
    v_mfma_f32_16x16x32_bf16 v[196:199], a[216:219], v[176:179], 0
    ds_read_b128 v[252:255], v240 offset:14336
    v_fma_f32 v171, v171, s37, -v236
    v_mfma_f32_16x16x32_bf16 v[184:187], v[74:77], v[176:179], 0
    ds_read_b128 a[240:243], v241 offset:25088
    v_fma_f32 v172, v172, s37, -v236
    v_mfma_f32_16x16x32_bf16 v[188:191], v[96:99], v[176:179], 0
    v_exp_f32 v168, v168
    v_mfma_f32_16x16x32_bf16 v[192:195], v[118:121], v[176:179], 0
    s_waitcnt lgkmcnt(4)
    v_exp_f32 v169, v169
    v_mfma_f32_16x16x32_bf16 v[216:219], a[244:247], a[252:255], v[216:219]
    ds_read_b128 a[244:247], v242 offset:24576
    v_cvt_pk_bf16_f32 v180, v168, v169
    v_mfma_f32_16x16x32_bf16 v[212:215], a[248:251], a[252:255], v[212:215]
    s_waitcnt lgkmcnt(3)
    ds_read_b128 a[252:255], v239 offset:14336
    ds_read_b128 a[248:251], v242 offset:25088
    v_exp_f32 v170, v170
    v_mfma_f32_16x16x32_bf16 v[164:167], v[42:45], v[138:141], v[164:167]
    s_waitcnt lgkmcnt(4)
    v_exp_f32 v171, v171
    v_mfma_f32_16x16x32_bf16 v[200:203], a[236:239], v[252:255], v[200:203]
    s_waitcnt lgkmcnt(3)
    v_cvt_pk_bf16_f32 v181, v170, v171
    v_fma_f32 v173, v173, s37, -v236
    v_mfma_f32_16x16x32_bf16 v[220:223], a[240:243], v[252:255], v[220:223]
    ds_read_b128 v[168:171], v230 offset:1920
    v_fma_f32 v174, v174, s37, -v236
    v_mfma_f32_16x16x16_bf16 v[164:167], v[46:47], v[142:143], v[164:167]
    s_waitcnt lgkmcnt(2)
    ds_read_b128 v[252:255], v240 offset:15360
    v_fma_f32 v175, v175, s37, -v236
    v_exp_f32 v172, v172
    v_exp_f32 v173, v173
    v_exp_f32 v174, v174
    v_mfma_f32_16x16x32_bf16 v[208:211], a[236:239], a[252:255], v[208:211]
    ds_read_b128 a[236:239], v241 offset:36864
    v_cvt_pk_bf16_f32 v182, v172, v173
    v_mfma_f32_16x16x32_bf16 v[204:207], a[240:243], a[252:255], v[204:207]
    ds_read_b128 a[240:243], v241 offset:37376
    v_fma_f32 v144, v144, s37, -v236
    v_mfma_f32_16x16x32_bf16 v[216:219], a[244:247], a[252:255], v[216:219]
    s_waitcnt lgkmcnt(4)
    ds_read_b128 a[244:247], v242 offset:36864
    v_fma_f32 v145, v145, s37, -v236
    v_mfma_f32_16x16x32_bf16 v[212:215], a[248:251], a[252:255], v[212:215]
    s_waitcnt lgkmcnt(4)
    ds_read_b128 a[252:255], v239 offset:15360
    ds_read_b128 a[248:251], v242 offset:37376
    v_mfma_f32_16x16x32_bf16 v[168:171], v[24:27], v[138:141], v[168:171]
    v_exp_f32 v175, v175
    v_fma_f32 v146, v146, s37, -v236
    v_cvt_pk_bf16_f32 v183, v174, v175
    ds_read_b128 v[172:175], v230 offset:2560
    v_fma_f32 v147, v147, s37, -v236
    v_mfma_f32_16x16x32_bf16 v[196:199], a[216:219], v[180:183], v[196:199]
    v_exp_f32 v144, v144
    v_mfma_f32_16x16x32_bf16 v[184:187], v[78:81], v[180:183], v[184:187]
    v_exp_f32 v145, v145
    v_mfma_f32_16x16x32_bf16 v[188:191], v[100:103], v[180:183], v[188:191]
    v_exp_f32 v146, v146
    v_mfma_f32_16x16x32_bf16 v[192:195], v[122:125], v[180:183], v[192:195]
    v_exp_f32 v147, v147
    v_mfma_f32_16x16x16_bf16 v[168:171], v[28:29], v[142:143], v[168:171]
    s_waitcnt lgkmcnt(2)
    v_cvt_pk_bf16_f32 v176, v144, v145
    v_cvt_pk_bf16_f32 v177, v146, v147
    v_mfma_f32_16x16x32_bf16 v[208:211], a[236:239], a[252:255], v[208:211]
    ds_read_b128 v[144:147], v235
    v_bfe_u32 v235, s67, v233, 4
    v_mfma_f32_16x16x32_bf16 v[200:203], a[236:239], v[252:255], v[200:203]
    s_waitcnt lgkmcnt(1)
    ds_read_b128 a[236:239], v241 offset:49152
    v_mad_u32_u24 v235, v235, s40, v231
    v_mfma_f32_16x16x32_bf16 v[172:175], v[30:33], v[138:141], v[172:175]
    v_fma_f32 v148, v148, s37, -v236
    v_fma_f32 v149, v149, s37, -v236
    v_mfma_f32_16x16x32_bf16 v[204:207], a[240:243], a[252:255], v[204:207]
    v_fma_f32 v150, v150, s37, -v236
    v_fma_f32 v151, v151, s37, -v236
    v_mfma_f32_16x16x32_bf16 v[220:223], a[240:243], v[252:255], v[220:223]
    ds_read_b128 v[252:255], v240 offset:16384
    ds_read_b128 a[240:243], v241 offset:49664
    v_mfma_f32_16x16x16_bf16 v[172:175], v[34:35], v[142:143], v[172:175]
    v_exp_f32 v148, v148
    v_mfma_f32_16x16x32_bf16 v[216:219], a[244:247], a[252:255], v[216:219]
    ds_read_b128 a[244:247], v242 offset:49152
    v_fma_f32 v152, v152, s37, -v236
    v_mfma_f32_16x16x32_bf16 v[212:215], a[248:251], a[252:255], v[212:215]
    s_waitcnt lgkmcnt(4)
    ds_read_b128 a[252:255], v239 offset:16384
    ds_read_b128 a[248:251], v242 offset:49664
    v_mfma_f32_16x16x32_bf16 v[144:147], v[54:57], v[138:141], v[144:147]
    v_exp_f32 v149, v149
    v_exp_f32 v150, v150
    v_exp_f32 v151, v151
    v_cvt_pk_bf16_f32 v178, v148, v149
    v_cvt_pk_bf16_f32 v179, v150, v151
    ds_read_b128 v[148:151], v250
    v_mfma_f32_16x16x16_bf16 v[144:147], v[58:59], v[142:143], v[144:147]
    v_bfe_u32 v250, s69, v233, 4
    v_mad_u32_u24 v250, v250, s40, v231
    v_mfma_f32_16x16x32_bf16 v[196:199], a[216:219], v[176:179], v[196:199]
    v_fma_f32 v153, v153, s37, -v236
    v_fma_f32 v154, v154, s37, -v236
    v_mfma_f32_16x16x32_bf16 v[184:187], v[66:69], v[176:179], v[184:187]
    v_fma_f32 v155, v155, s37, -v236
    v_fma_f32 v156, v156, s37, -v236
    v_mfma_f32_16x16x32_bf16 v[188:191], v[88:91], v[176:179], v[188:191]
    v_exp_f32 v152, v152
    v_mfma_f32_16x16x32_bf16 v[192:195], v[110:113], v[176:179], v[192:195]
    s_waitcnt lgkmcnt(2)
    v_exp_f32 v153, v153
    v_mfma_f32_16x16x32_bf16 v[208:211], a[236:239], a[252:255], v[208:211]
    v_exp_f32 v154, v154
    v_mfma_f32_16x16x32_bf16 v[200:203], a[236:239], v[252:255], v[200:203]
    s_waitcnt lgkmcnt(0)
    ds_read_b128 a[236:239], v241 offset:61440
    v_cvt_pk_bf16_f32 v180, v152, v153
    v_mfma_f32_16x16x32_bf16 v[148:151], v[60:63], v[138:141], v[148:151]
    v_exp_f32 v155, v155
    v_mfma_f32_16x16x32_bf16 v[204:207], a[240:243], a[252:255], v[204:207]
    v_cvt_pk_bf16_f32 v181, v154, v155
    v_fma_f32 v157, v157, s37, -v236
    v_mfma_f32_16x16x32_bf16 v[220:223], a[240:243], v[252:255], v[220:223]
    ds_read_b128 v[152:155], v229 offset:640
    v_fma_f32 v158, v158, s37, -v236
    v_mfma_f32_16x16x16_bf16 v[148:151], v[64:65], v[142:143], v[148:151]
    ds_read_b128 v[252:255], v240 offset:17408
    v_fma_f32 v159, v159, s37, -v236
    v_mfma_f32_16x16x32_bf16 v[216:219], a[244:247], a[252:255], v[216:219]
    ds_read_b128 a[240:243], v241 offset:61952
    v_max3_f32 v248, v160, v161, v162
    v_mfma_f32_16x16x32_bf16 v[212:215], a[248:251], a[252:255], v[212:215]
    s_waitcnt lgkmcnt(2)
    ds_read_b128 a[252:255], v239 offset:17408
    v_exp_f32 v156, v156
    ds_read_b128 a[244:247], v242 offset:61440
    ds_read_b128 a[248:251], v242 offset:61952
    v_exp_f32 v157, v157
    v_exp_f32 v158, v158
    v_exp_f32 v159, v159
    v_cvt_pk_bf16_f32 v182, v156, v157
    v_cvt_pk_bf16_f32 v183, v158, v159
    ds_read_b128 v[156:159], v228 offset:640
    v_mfma_f32_16x16x32_bf16 v[152:155], v[42:45], v[132:135], v[152:155]
    v_max3_f32 v249, v163, v164, v165
    v_max3_f32 v248, v248, v166, v167
    v_mfma_f32_16x16x32_bf16 v[196:199], a[216:219], v[180:183], v[196:199]
    v_max3_f32 v249, v249, v168, v169
    v_max3_f32 v248, v248, v170, v171
    v_mfma_f32_16x16x32_bf16 v[184:187], v[70:73], v[180:183], v[184:187]
    v_max3_f32 v249, v249, v172, v173
    v_max3_f32 v248, v248, v174, v175
    v_mfma_f32_16x16x32_bf16 v[188:191], v[92:95], v[180:183], v[188:191]
    v_max3_f32 v249, v249, v144, v145
    v_max3_f32 v248, v248, v146, v147
    v_mfma_f32_16x16x32_bf16 v[192:195], v[114:117], v[180:183], v[192:195]
    v_rcp_f32 v197, v196
    v_mfma_f32_16x16x16_bf16 v[152:155], v[46:47], v[136:137], v[152:155]
    s_waitcnt lgkmcnt(2)
    v_mul_f32 v184, v184, v197
    v_mul_f32 v185, v185, v197
    v_mfma_f32_16x16x32_bf16 v[208:211], a[236:239], a[252:255], v[208:211]
    s_waitcnt lgkmcnt(0)
    v_cvt_pk_bf16_f32 v184, v184, v185
    v_mul_f32 v186, v186, v197
    v_mfma_f32_16x16x32_bf16 v[156:159], v[18:21], v[132:135], v[156:159]
    v_mul_f32 v187, v187, v197
    v_cvt_pk_bf16_f32 v185, v186, v187
    v_mfma_f32_16x16x32_bf16 v[200:203], a[236:239], v[252:255], v[200:203]
    ds_read_b128 a[236:239], v224 offset:31104
    v_mul_f32 v188, v188, v197
    v_mfma_f32_16x16x32_bf16 v[204:207], a[240:243], a[252:255], v[204:207]
    v_mul_f32 v189, v189, v197
    v_cvt_pk_bf16_f32 v186, v188, v189
    v_mfma_f32_16x16x16_bf16 v[156:159], v[22:23], v[136:137], v[156:159]
    v_mul_f32 v190, v190, v197
    v_mul_f32 v191, v191, v197
    v_mfma_f32_16x16x32_bf16 v[220:223], a[240:243], v[252:255], v[220:223]
    ds_read_b128 v[252:255], v224 offset:31040
    ds_read_b128 a[240:243], v224 offset:31168
    v_mfma_f32_16x16x32_bf16 v[216:219], a[244:247], a[252:255], v[216:219]
    ds_read_b128 a[244:247], v224 offset:31232
    v_cvt_pk_bf16_f32 v187, v190, v191
    v_mfma_f32_16x16x32_bf16 v[212:215], a[248:251], a[252:255], v[212:215]
    ds_read_b128 a[252:255], v224 offset:30976
    v_mul_f32 v192, v192, v197
    v_mul_f32 v193, v193, v197
    v_cvt_pk_bf16_f32 v188, v192, v193
    ds_read_b128 a[248:251], v224 offset:31296
    v_mul_f32 v194, v194, v197
    v_mul_f32 v195, v195, v197
    v_cvt_pk_bf16_f32 v189, v194, v195
    ds_write_b128 v237, v[184:187]
    ds_write_b64 v238, v[188:189]
    v_cvt_pk_bf16_f32 v208, v208, v209
    v_cvt_pk_bf16_f32 v209, v210, v211
    v_cvt_pk_bf16_f32 v210, v204, v205
    v_cvt_pk_bf16_f32 v211, v206, v207
    buffer_store_dwordx4 v[208:211], v243, s[20:23], s51 offen sc0 sc1
    s_waitcnt lgkmcnt(3)
    v_mfma_f32_16x16x32_bf16 v[204:207], a[4:7], a[252:255], 0
    v_cvt_pk_bf16_f32 v200, v200, v201
    v_cvt_pk_bf16_f32 v201, v202, v203
    v_mfma_f32_16x16x32_bf16 v[204:207], a[16:19], v[252:255], v[204:207]
    v_cvt_pk_bf16_f32 v202, v220, v221
    v_cvt_pk_bf16_f32 v203, v222, v223
    v_mfma_f32_16x16x32_bf16 v[208:211], a[0:3], a[252:255], 0
    v_cvt_pk_bf16_f32 v216, v216, v217
    v_cvt_pk_bf16_f32 v217, v218, v219
    v_mfma_f32_16x16x32_bf16 v[208:211], a[12:15], v[252:255], v[208:211]
    v_cvt_pk_bf16_f32 v218, v212, v213
    v_cvt_pk_bf16_f32 v219, v214, v215
    v_mfma_f32_16x16x32_bf16 v[220:223], a[252:255], a[72:75], 0
    v_max3_f32 v249, v249, v148, v149
    v_max3_f32 v248, v248, v150, v151
    v_mfma_f32_16x16x32_bf16 v[220:223], v[252:255], a[84:87], v[220:223]
    v_max_f32 v248, v248, v249
    v_mov_b32 v249, v248
    v_mfma_f32_16x16x32_bf16 v[212:215], a[252:255], a[80:83], 0
    v_mfma_f32_16x16x32_bf16 v[212:215], v[252:255], a[92:95], v[212:215]
    v_permlane16_swap_b32 v248, v249
    v_mfma_f32_16x16x32_bf16 v[208:211], a[24:27], a[236:239], v[208:211]
    v_max_f32 v248, v248, v249
    v_mov_b32 v249, v248
    v_mfma_f32_16x16x32_bf16 v[208:211], a[36:39], a[240:243], v[208:211]
    v_mfma_f32_16x16x32_bf16 v[204:207], a[28:31], a[236:239], v[204:207]
    v_permlane32_swap_b32 v248, v249
    v_mfma_f32_16x16x32_bf16 v[204:207], a[40:43], a[240:243], v[204:207]
    buffer_store_dwordx4 v[200:203], v245, s[20:23], s51 offen sc0 sc1
    v_mfma_f32_16x16x32_bf16 v[220:223], a[236:239], a[96:99], v[220:223]
    v_max_f32 v248, v248, v249
    v_mul_f32 v236, s37, v248
    v_mfma_f32_16x16x32_bf16 v[220:223], a[240:243], a[108:111], v[220:223]
    v_fma_f32 v160, v160, s37, -v236
    v_fma_f32 v161, v161, s37, -v236
    v_mfma_f32_16x16x32_bf16 v[200:203], a[8:11], a[252:255], 0
    v_fma_f32 v162, v162, s37, -v236
    v_fma_f32 v163, v163, s37, -v236
    v_mfma_f32_16x16x32_bf16 v[200:203], a[20:23], v[252:255], v[200:203]
    v_exp_f32 v160, v160
    v_mfma_f32_16x16x32_bf16 v[200:203], a[32:35], a[236:239], v[200:203]
    v_exp_f32 v161, v161
    v_mfma_f32_16x16x32_bf16 v[200:203], a[44:47], a[240:243], v[200:203]
    v_exp_f32 v162, v162
    v_mfma_f32_16x16x32_bf16 v[212:215], a[236:239], a[104:107], v[212:215]
    v_exp_f32 v163, v163
    v_mfma_f32_16x16x32_bf16 v[212:215], a[240:243], a[116:119], v[212:215]
    v_cvt_pk_bf16_f32 v176, v160, v161
    v_cvt_pk_bf16_f32 v177, v162, v163
    v_mfma_f32_16x16x32_bf16 v[208:211], a[48:51], a[244:247], v[208:211]
    s_waitcnt lgkmcnt(0)
    ds_read_b128 v[160:163], v228 offset:1280
    v_fma_f32 v164, v164, s37, -v236
    v_mfma_f32_16x16x32_bf16 v[208:211], a[60:63], a[248:251], v[208:211]
    v_fma_f32 v165, v165, s37, -v236
    v_fma_f32 v166, v166, s37, -v236
    v_mfma_f32_16x16x32_bf16 v[204:207], a[52:55], a[244:247], v[204:207]
    v_fma_f32 v167, v167, s37, -v236
    v_fma_f32 v168, v168, s37, -v236
    v_mfma_f32_16x16x32_bf16 v[204:207], a[64:67], a[248:251], v[204:207]
    buffer_store_dwordx4 v[216:219], v244, s[20:23], s51 offen sc0 sc1
    v_mfma_f32_16x16x32_bf16 v[200:203], a[56:59], a[244:247], v[200:203]
    s_add_u32 s51, s51, s48
    v_cvt_pk_bf16_f32 v12, v208, v209
    v_cvt_pk_bf16_f32 v13, v210, v211
    v_mfma_f32_16x16x32_bf16 v[200:203], a[68:71], a[248:251], v[200:203]
    v_exp_f32 v164, v164
    v_mfma_f32_16x16x32_bf16 v[216:219], a[252:255], a[76:79], 0
    v_cvt_pk_bf16_f32 v14, v204, v205
    v_cvt_pk_bf16_f32 v15, v206, v207
    v_mfma_f32_16x16x32_bf16 v[216:219], v[252:255], a[88:91], v[216:219]
    s_waitcnt lgkmcnt(0)
    ds_read_b128 a[252:255], v224 offset:34048
    ds_read_b128 v[252:255], v224 offset:34112
    v_mfma_f32_16x16x32_bf16 v[160:163], v[0:3], v[132:135], v[160:163]
    v_cvt_pk_bf16_f32 v16, v200, v201
    v_cvt_pk_bf16_f32 v17, v202, v203
    v_mfma_f32_16x16x32_bf16 v[216:219], a[236:239], a[100:103], v[216:219]
    ds_read_b128 a[236:239], v224 offset:34176
    v_fma_f32 v169, v169, s37, -v236
    v_mfma_f32_16x16x32_bf16 v[216:219], a[240:243], a[112:115], v[216:219]
    ds_read_b128 a[240:243], v224 offset:34240
    v_fma_f32 v170, v170, s37, -v236
    v_mfma_f32_16x16x16_bf16 v[160:163], v[4:5], v[136:137], v[160:163]
    v_exp_f32 v165, v165
    v_mfma_f32_16x16x32_bf16 v[220:223], a[244:247], a[120:123], v[220:223]
    v_exp_f32 v166, v166
    v_mfma_f32_16x16x32_bf16 v[220:223], a[248:251], a[132:135], v[220:223]
    v_exp_f32 v167, v167
    v_mfma_f32_16x16x32_bf16 v[216:219], a[244:247], a[124:127], v[216:219]
    v_cvt_pk_bf16_f32 v178, v164, v165
    v_cvt_pk_bf16_f32 v179, v166, v167
    v_mfma_f32_16x16x32_bf16 v[216:219], a[248:251], a[136:139], v[216:219]
    ds_read_b128 v[164:167], v229 offset:1280
    v_fma_f32 v171, v171, s37, -v236
    v_mfma_f32_16x16x32_bf16 v[196:199], a[216:219], v[176:179], 0
    v_cvt_pk_bf16_f32 v74, v220, v221
    v_cvt_pk_bf16_f32 v75, v222, v223
    v_mfma_f32_16x16x32_bf16 v[184:187], v[76:79], v[176:179], 0
    v_exp_f32 v168, v168
    v_mfma_f32_16x16x32_bf16 v[188:191], v[98:101], v[176:179], 0
    v_cvt_pk_bf16_f32 v96, v216, v217
    v_cvt_pk_bf16_f32 v97, v218, v219
    v_mfma_f32_16x16x32_bf16 v[192:195], v[120:123], v[176:179], 0
    v_exp_f32 v169, v169
    v_mfma_f32_16x16x32_bf16 v[212:215], a[244:247], a[128:131], v[212:215]
    ds_read_b128 a[244:247], v224 offset:34304
    v_cvt_pk_bf16_f32 v180, v168, v169
    v_mfma_f32_16x16x32_bf16 v[212:215], a[248:251], a[140:143], v[212:215]
    s_waitcnt lgkmcnt(2)
    ds_read_b128 a[248:251], v224 offset:34368
    v_fma_f32 v172, v172, s37, -v236
    v_mfma_f32_16x16x32_bf16 v[208:211], a[0:3], a[252:255], 0
    v_exp_f32 v170, v170
    v_mfma_f32_16x16x32_bf16 v[208:211], a[12:15], v[252:255], v[208:211]
    s_waitcnt lgkmcnt(2)
    v_exp_f32 v171, v171
    v_mfma_f32_16x16x32_bf16 v[164:167], v[24:27], v[132:135], v[164:167]
    v_cvt_pk_bf16_f32 v181, v170, v171
    v_cvt_pk_bf16_f32 v118, v212, v213
    v_mfma_f32_16x16x32_bf16 v[204:207], a[4:7], a[252:255], 0
    ds_read_b128 v[168:171], v229 offset:1920
    v_cvt_pk_bf16_f32 v119, v214, v215
    v_mfma_f32_16x16x32_bf16 v[204:207], a[16:19], v[252:255], v[204:207]
    v_fma_f32 v173, v173, s37, -v236
    v_fma_f32 v174, v174, s37, -v236
    v_mfma_f32_16x16x16_bf16 v[164:167], v[28:29], v[136:137], v[164:167]
    v_fma_f32 v175, v175, s37, -v236
    v_fma_f32 v144, v144, s37, -v236
    v_mfma_f32_16x16x32_bf16 v[200:203], a[8:11], a[252:255], 0
    v_exp_f32 v172, v172
    v_mfma_f32_16x16x32_bf16 v[200:203], a[20:23], v[252:255], v[200:203]
    v_exp_f32 v173, v173
    v_mfma_f32_16x16x32_bf16 v[220:223], a[252:255], a[72:75], 0
    v_exp_f32 v174, v174
    v_mfma_f32_16x16x32_bf16 v[220:223], v[252:255], a[84:87], v[220:223]
    v_exp_f32 v175, v175
    v_mfma_f32_16x16x32_bf16 v[216:219], a[252:255], a[76:79], 0
    v_cvt_pk_bf16_f32 v182, v172, v173
    v_cvt_pk_bf16_f32 v183, v174, v175
    v_mfma_f32_16x16x32_bf16 v[216:219], v[252:255], a[88:91], v[216:219]
    ds_read_b128 v[172:175], v228 offset:1920
    v_fma_f32 v145, v145, s37, -v236
    v_mfma_f32_16x16x32_bf16 v[196:199], a[216:219], v[180:183], v[196:199]
    v_fma_f32 v146, v146, s37, -v236
    v_fma_f32 v147, v147, s37, -v236
    v_mfma_f32_16x16x32_bf16 v[184:187], v[68:71], v[180:183], v[184:187]
    v_exp_f32 v144, v144
    v_mfma_f32_16x16x32_bf16 v[188:191], v[90:93], v[180:183], v[188:191]
    v_exp_f32 v145, v145
    v_mfma_f32_16x16x32_bf16 v[192:195], v[112:115], v[180:183], v[192:195]
    s_waitcnt lgkmcnt(1)
    v_exp_f32 v146, v146
    v_mfma_f32_16x16x32_bf16 v[168:171], v[30:33], v[132:135], v[168:171]
    v_exp_f32 v147, v147
    v_mfma_f32_16x16x32_bf16 v[212:215], a[252:255], a[80:83], 0
    ds_read_b128 a[252:255], v225 offset:11968
    v_cvt_pk_bf16_f32 v176, v144, v145
    v_mfma_f32_16x16x32_bf16 v[212:215], v[252:255], a[92:95], v[212:215]
    ds_read_b128 v[252:255], v225 offset:12032
    v_cvt_pk_bf16_f32 v177, v146, v147
    v_mfma_f32_16x16x16_bf16 v[168:171], v[34:35], v[136:137], v[168:171]
    s_waitcnt lgkmcnt(2)
    ds_read_b128 v[144:147], v228 offset:2560
    v_fma_f32 v148, v148, s37, -v236
    v_mfma_f32_16x16x32_bf16 v[172:175], v[6:9], v[132:135], v[172:175]
    v_fma_f32 v149, v149, s37, -v236
    v_fma_f32 v150, v150, s37, -v236
    v_mfma_f32_16x16x32_bf16 v[208:211], a[24:27], a[236:239], v[208:211]
    v_fma_f32 v151, v151, s37, -v236
    v_max3_f32 v248, v152, v153, v154
    v_mfma_f32_16x16x32_bf16 v[208:211], a[36:39], a[240:243], v[208:211]
    v_exp_f32 v148, v148
    v_mfma_f32_16x16x16_bf16 v[172:175], v[10:11], v[136:137], v[172:175]
    v_exp_f32 v149, v149
    v_mfma_f32_16x16x32_bf16 v[204:207], a[28:31], a[236:239], v[204:207]
    v_exp_f32 v150, v150
    v_mfma_f32_16x16x32_bf16 v[204:207], a[40:43], a[240:243], v[204:207]
    v_exp_f32 v151, v151
    v_mfma_f32_16x16x32_bf16 v[200:203], a[32:35], a[236:239], v[200:203]
    v_cvt_pk_bf16_f32 v178, v148, v149
    v_cvt_pk_bf16_f32 v179, v150, v151
    v_mfma_f32_16x16x32_bf16 v[200:203], a[44:47], a[240:243], v[200:203]
    ds_read_b128 v[148:151], v229 offset:2560
    v_max3_f32 v249, v155, v156, v157
    v_mfma_f32_16x16x32_bf16 v[196:199], a[216:219], v[176:179], v[196:199]
    v_max3_f32 v248, v248, v158, v159
    v_max3_f32 v249, v249, v160, v161
    v_mfma_f32_16x16x32_bf16 v[184:187], v[84:87], v[176:179], v[184:187]
    v_max3_f32 v248, v248, v162, v163
    v_max3_f32 v249, v249, v164, v165
    v_mfma_f32_16x16x32_bf16 v[188:191], v[106:109], v[176:179], v[188:191]
    v_max3_f32 v248, v248, v166, v167
    v_max3_f32 v249, v249, v168, v169
    v_mfma_f32_16x16x32_bf16 v[192:195], v[128:131], v[176:179], v[192:195]
    s_waitcnt lgkmcnt(1)
    v_rcp_f32 v197, v196
    v_mfma_f32_16x16x32_bf16 v[144:147], v[12:15], v[132:135], v[144:147]
    v_mul_f32 v184, v184, v197
    v_mul_f32 v185, v185, v197
    v_mfma_f32_16x16x32_bf16 v[220:223], a[236:239], a[96:99], v[220:223]
    v_cvt_pk_bf16_f32 v184, v184, v185
    v_mul_f32 v186, v186, v197
    v_mfma_f32_16x16x32_bf16 v[220:223], a[240:243], a[108:111], v[220:223]
    v_mul_f32 v187, v187, v197
    v_cvt_pk_bf16_f32 v185, v186, v187
    v_mfma_f32_16x16x16_bf16 v[144:147], v[16:17], v[136:137], v[144:147]
    v_mul_f32 v188, v188, v197
    v_mul_f32 v189, v189, v197
    v_mfma_f32_16x16x32_bf16 v[216:219], a[236:239], a[100:103], v[216:219]
    v_cvt_pk_bf16_f32 v186, v188, v189
    v_mul_f32 v190, v190, v197
    v_mfma_f32_16x16x32_bf16 v[216:219], a[240:243], a[112:115], v[216:219]
    v_mul_f32 v191, v191, v197
    v_cvt_pk_bf16_f32 v187, v190, v191
    v_mfma_f32_16x16x32_bf16 v[212:215], a[236:239], a[104:107], v[212:215]
    ds_read_b128 a[236:239], v225 offset:12096
    v_mul_f32 v192, v192, v197
    v_mfma_f32_16x16x32_bf16 v[212:215], a[240:243], a[116:119], v[212:215]
    ds_read_b128 a[240:243], v225 offset:12160
    v_mul_f32 v193, v193, v197
    v_mfma_f32_16x16x32_bf16 v[208:211], a[48:51], a[244:247], v[208:211]
    v_cvt_pk_bf16_f32 v188, v192, v193
    v_mul_f32 v194, v194, v197
    v_mfma_f32_16x16x32_bf16 v[208:211], a[60:63], a[248:251], v[208:211]
    v_mul_f32 v195, v195, v197
    v_cvt_pk_bf16_f32 v189, v194, v195
    v_mfma_f32_16x16x32_bf16 v[204:207], a[52:55], a[244:247], v[204:207]
    ds_write_b128 v237, v[184:187] offset:6144
    v_mfma_f32_16x16x32_bf16 v[204:207], a[64:67], a[248:251], v[204:207]
    ds_write_b64 v238, v[188:189] offset:6144
    v_mfma_f32_16x16x32_bf16 v[200:203], a[56:59], a[244:247], v[200:203]
    v_max3_f32 v248, v248, v170, v171
    v_cvt_pk_bf16_f32 v36, v208, v209
    v_mfma_f32_16x16x32_bf16 v[200:203], a[68:71], a[248:251], v[200:203]
    v_cvt_pk_bf16_f32 v37, v210, v211
    v_max3_f32 v249, v249, v172, v173
    v_mfma_f32_16x16x32_bf16 v[220:223], a[244:247], a[120:123], v[220:223]
    v_cvt_pk_bf16_f32 v38, v204, v205
    v_cvt_pk_bf16_f32 v39, v206, v207
    v_mfma_f32_16x16x32_bf16 v[220:223], a[248:251], a[132:135], v[220:223]
    s_waitcnt lgkmcnt(2)
    v_max3_f32 v248, v248, v174, v175
    v_max3_f32 v249, v249, v144, v145
    v_mfma_f32_16x16x32_bf16 v[148:151], v[36:39], v[132:135], v[148:151]
    v_cvt_pk_bf16_f32 v40, v200, v201
    v_cvt_pk_bf16_f32 v41, v202, v203
    v_mfma_f32_16x16x32_bf16 v[216:219], a[244:247], a[124:127], v[216:219]
    v_max3_f32 v248, v248, v146, v147
    v_mfma_f32_16x16x32_bf16 v[216:219], a[248:251], a[136:139], v[216:219]
    v_cvt_pk_bf16_f32 v76, v220, v221
    v_cvt_pk_bf16_f32 v77, v222, v223
    v_mfma_f32_16x16x16_bf16 v[148:151], v[40:41], v[136:137], v[148:151]
    v_mfma_f32_16x16x32_bf16 v[212:215], a[244:247], a[128:131], v[212:215]
    ds_read_b128 a[244:247], v225 offset:12224
    v_mfma_f32_16x16x32_bf16 v[212:215], a[248:251], a[140:143], v[212:215]
    ds_read_b128 a[248:251], v225 offset:12288
    v_mfma_f32_16x16x32_bf16 v[208:211], a[144:147], a[252:255], 0
    v_cvt_pk_bf16_f32 v98, v216, v217
    v_cvt_pk_bf16_f32 v99, v218, v219
    v_mfma_f32_16x16x32_bf16 v[208:211], a[156:159], v[252:255], v[208:211]
    v_max3_f32 v249, v249, v148, v149
    v_max3_f32 v248, v248, v150, v151
    v_mfma_f32_16x16x32_bf16 v[204:207], a[148:151], a[252:255], 0
    v_cvt_pk_bf16_f32 v120, v212, v213
    v_cvt_pk_bf16_f32 v121, v214, v215
    v_mfma_f32_16x16x32_bf16 v[204:207], a[160:163], v[252:255], v[204:207]
    v_max_f32 v248, v248, v249
    v_mov_b32 v249, v248
    v_mfma_f32_16x16x32_bf16 v[200:203], a[152:155], a[252:255], 0
    ds_read_b128 a[252:255], v225 offset:24384
    v_mfma_f32_16x16x32_bf16 v[200:203], a[164:167], v[252:255], v[200:203]
    s_waitcnt vmcnt(3) lgkmcnt(1)
    ds_read_b128 v[252:255], v225 offset:24448
    v_mfma_f32_16x16x32_bf16 v[208:211], a[168:171], a[236:239], v[208:211]
    s_barrier
    buffer_load_dwordx4 v246, s[4:7], s56 offen lds
    v_mfma_f32_16x16x32_bf16 v[208:211], a[180:183], a[240:243], v[208:211]
    v_permlane16_swap_b32 v248, v249
    v_mfma_f32_16x16x32_bf16 v[204:207], a[172:175], a[236:239], v[204:207]
    v_max_f32 v248, v248, v249
    v_mov_b32 v249, v248
    v_mfma_f32_16x16x32_bf16 v[204:207], a[184:187], a[240:243], v[204:207]
    v_mfma_f32_16x16x32_bf16 v[200:203], a[176:179], a[236:239], v[200:203]
    ds_read_b128 a[236:239], v225 offset:24512
    v_mfma_f32_16x16x32_bf16 v[200:203], a[188:191], a[240:243], v[200:203]
    ds_read_b128 a[240:243], v225 offset:24576
    v_mfma_f32_16x16x32_bf16 v[208:211], a[192:195], a[244:247], v[208:211]
    buffer_load_dwordx4 v247, s[4:7], s56 offen offset:1024 lds
    v_mfma_f32_16x16x32_bf16 v[208:211], a[204:207], a[248:251], v[208:211]
    s_add_u32 s56, s56, s42
    v_permlane32_swap_b32 v248, v249
    v_mfma_f32_16x16x32_bf16 v[204:207], a[196:199], a[244:247], v[204:207]
    s_add_u32 m0, s41, 0x1e40
    v_max_f32 v248, v248, v249
    v_mul_f32 v236, s37, v248
    v_mfma_f32_16x16x32_bf16 v[204:207], a[208:211], a[248:251], v[204:207]
    v_fma_f32 v152, v152, s37, -v236
    v_cvt_pk_bf16_f32 v138, v208, v209
    v_mfma_f32_16x16x32_bf16 v[200:203], a[200:203], a[244:247], v[200:203]
    ds_read_b128 a[244:247], v225 offset:24640
    v_cvt_pk_bf16_f32 v139, v210, v211
    v_mfma_f32_16x16x32_bf16 v[200:203], a[212:215], a[248:251], v[200:203]
    s_waitcnt lgkmcnt(3)
    ds_read_b128 a[248:251], v225 offset:24704
    v_fma_f32 v153, v153, s37, -v236
    v_mfma_f32_16x16x32_bf16 v[220:223], a[144:147], a[252:255], 0
    v_cvt_pk_bf16_f32 v140, v204, v205
    v_cvt_pk_bf16_f32 v141, v206, v207
    v_mfma_f32_16x16x32_bf16 v[220:223], a[156:159], v[252:255], v[220:223]
    buffer_load_dwordx4 v246, s[4:7], s56 offen lds
    v_mfma_f32_16x16x32_bf16 v[216:219], a[148:151], a[252:255], 0
    v_cvt_pk_bf16_f32 v142, v200, v201
    v_cvt_pk_bf16_f32 v143, v202, v203
    v_mfma_f32_16x16x32_bf16 v[216:219], a[160:163], v[252:255], v[216:219]
    v_fma_f32 v154, v154, s37, -v236
    v_fma_f32 v155, v155, s37, -v236
    v_mfma_f32_16x16x32_bf16 v[212:215], a[152:155], a[252:255], 0
    ds_read_b128 a[252:255], v227 offset:37120
    v_fma_f32 v156, v156, s37, -v236
    v_mfma_f32_16x16x32_bf16 v[212:215], a[164:167], v[252:255], v[212:215]
    s_waitcnt lgkmcnt(3)
    ds_read_b128 v[252:255], v227 offset:37184
    v_fma_f32 v157, v157, s37, -v236
    v_mfma_f32_16x16x32_bf16 v[220:223], a[168:171], a[236:239], v[220:223]
    v_exp_f32 v152, v152
    v_mfma_f32_16x16x32_bf16 v[220:223], a[180:183], a[240:243], v[220:223]
    buffer_load_dwordx4 v247, s[4:7], s56 offen offset:1024 lds
    v_mfma_f32_16x16x32_bf16 v[216:219], a[172:175], a[236:239], v[216:219]
    s_add_u32 s56, s56, s42
    v_exp_f32 v153, v153
    v_mfma_f32_16x16x32_bf16 v[216:219], a[184:187], a[240:243], v[216:219]
    s_add_u32 m0, s41, 0x3c80
    v_exp_f32 v154, v154
    v_mfma_f32_16x16x32_bf16 v[212:215], a[176:179], a[236:239], v[212:215]
    ds_read_b128 a[236:239], v227 offset:37248
    v_cvt_pk_bf16_f32 v180, v152, v153
    v_mfma_f32_16x16x32_bf16 v[212:215], a[188:191], a[240:243], v[212:215]
    s_waitcnt lgkmcnt(3)
    ds_read_b128 a[240:243], v227 offset:37312
    v_fma_f32 v158, v158, s37, -v236
    v_mfma_f32_16x16x32_bf16 v[220:223], a[192:195], a[244:247], v[220:223]
    v_exp_f32 v155, v155
    v_mfma_f32_16x16x32_bf16 v[220:223], a[204:207], a[248:251], v[220:223]
    v_cvt_pk_bf16_f32 v181, v154, v155
    v_fma_f32 v159, v159, s37, -v236
    v_mfma_f32_16x16x32_bf16 v[216:219], a[196:199], a[244:247], v[216:219]
    ds_read_b128 v[152:155], v230 offset:2560
    v_fma_f32 v160, v160, s37, -v236
    v_mfma_f32_16x16x32_bf16 v[216:219], a[208:211], a[248:251], v[216:219]
    v_exp_f32 v156, v156
    v_mfma_f32_16x16x32_bf16 v[212:215], a[200:203], a[244:247], v[212:215]
    v_cvt_pk_bf16_f32 v132, v220, v221
    v_cvt_pk_bf16_f32 v133, v222, v223
    v_mfma_f32_16x16x32_bf16 v[212:215], a[212:215], a[248:251], v[212:215]
    s_waitcnt lgkmcnt(3)
    ds_read_b128 a[244:247], v227 offset:37376
    ds_read_b128 a[248:251], v227 offset:37440
    v_mfma_f32_16x16x32_bf16 v[208:211], a[0:3], a[252:255], 0
    v_cvt_pk_bf16_f32 v134, v216, v217
    v_cvt_pk_bf16_f32 v135, v218, v219
    v_mfma_f32_16x16x32_bf16 v[208:211], a[12:15], v[252:255], v[208:211]
    v_exp_f32 v157, v157
    v_mfma_f32_16x16x32_bf16 v[204:207], a[4:7], a[252:255], 0
    v_cvt_pk_bf16_f32 v136, v212, v213
    v_cvt_pk_bf16_f32 v137, v214, v215
    v_mfma_f32_16x16x32_bf16 v[204:207], a[16:19], v[252:255], v[204:207]
    s_waitcnt lgkmcnt(2)
    v_exp_f32 v158, v158
    v_mfma_f32_16x16x32_bf16 v[152:155], v[36:39], v[138:141], v[152:155]
    v_exp_f32 v159, v159
    v_mfma_f32_16x16x32_bf16 v[200:203], a[8:11], a[252:255], 0
    v_cvt_pk_bf16_f32 v182, v156, v157
    v_cvt_pk_bf16_f32 v183, v158, v159
    v_mfma_f32_16x16x32_bf16 v[200:203], a[20:23], v[252:255], v[200:203]
    ds_read_b128 v[156:159], v230 offset:640
    v_fma_f32 v161, v161, s37, -v236
    v_mfma_f32_16x16x32_bf16 v[196:199], a[216:219], v[180:183], 0
    v_fma_f32 v162, v162, s37, -v236
    v_fma_f32 v163, v163, s37, -v236
    v_mfma_f32_16x16x32_bf16 v[184:187], v[78:81], v[180:183], 0
    v_exp_f32 v160, v160
    v_mfma_f32_16x16x32_bf16 v[188:191], v[100:103], v[180:183], 0
    v_exp_f32 v161, v161
    v_mfma_f32_16x16x32_bf16 v[192:195], v[122:125], v[180:183], 0
    v_exp_f32 v162, v162
    v_mfma_f32_16x16x16_bf16 v[152:155], v[40:41], v[142:143], v[152:155]
    v_exp_f32 v163, v163
    v_mfma_f32_16x16x32_bf16 v[220:223], a[252:255], a[72:75], 0
    v_cvt_pk_bf16_f32 v176, v160, v161
    v_cvt_pk_bf16_f32 v177, v162, v163
    v_mfma_f32_16x16x32_bf16 v[220:223], v[252:255], a[84:87], v[220:223]
    s_waitcnt lgkmcnt(0)
    ds_read_b128 v[160:163], v230 offset:1280
    v_fma_f32 v164, v164, s37, -v236
    v_mfma_f32_16x16x32_bf16 v[156:159], v[42:45], v[138:141], v[156:159]
    v_fma_f32 v165, v165, s37, -v236
    v_fma_f32 v166, v166, s37, -v236
    v_mfma_f32_16x16x32_bf16 v[216:219], a[252:255], a[76:79], 0
    v_fma_f32 v167, v167, s37, -v236
    v_fma_f32 v168, v168, s37, -v236
    v_mfma_f32_16x16x32_bf16 v[216:219], v[252:255], a[88:91], v[216:219]
    v_exp_f32 v164, v164
    v_mfma_f32_16x16x16_bf16 v[156:159], v[46:47], v[142:143], v[156:159]
    v_exp_f32 v165, v165
    v_mfma_f32_16x16x32_bf16 v[212:215], a[252:255], a[80:83], 0
    ds_read_b128 a[252:255], v239
    v_cvt_pk_bf16_f32 v178, v164, v165
    v_mfma_f32_16x16x32_bf16 v[212:215], v[252:255], a[92:95], v[212:215]
    ds_read_b128 v[252:255], v240
    v_fma_f32 v169, v169, s37, -v236
    v_mfma_f32_16x16x32_bf16 v[208:211], a[24:27], a[236:239], v[208:211]
    v_exp_f32 v166, v166
    v_mfma_f32_16x16x32_bf16 v[208:211], a[36:39], a[240:243], v[208:211]
    s_waitcnt lgkmcnt(2)
    v_exp_f32 v167, v167
    v_mfma_f32_16x16x32_bf16 v[160:163], v[24:27], v[138:141], v[160:163]
    v_cvt_pk_bf16_f32 v179, v166, v167
    v_fma_f32 v170, v170, s37, -v236
    v_mfma_f32_16x16x32_bf16 v[204:207], a[28:31], a[236:239], v[204:207]
    ds_read_b128 v[164:167], v230 offset:1920
    v_fma_f32 v171, v171, s37, -v236
    v_mfma_f32_16x16x32_bf16 v[204:207], a[40:43], a[240:243], v[204:207]
    v_exp_f32 v168, v168
    v_mfma_f32_16x16x32_bf16 v[196:199], a[216:219], v[176:179], v[196:199]
    v_exp_f32 v169, v169
    v_mfma_f32_16x16x32_bf16 v[184:187], v[66:69], v[176:179], v[184:187]
    v_exp_f32 v170, v170
    v_mfma_f32_16x16x32_bf16 v[188:191], v[88:91], v[176:179], v[188:191]
    v_exp_f32 v171, v171
    v_mfma_f32_16x16x32_bf16 v[192:195], v[110:113], v[176:179], v[192:195]
    v_cvt_pk_bf16_f32 v180, v168, v169
    v_cvt_pk_bf16_f32 v181, v170, v171
    v_mfma_f32_16x16x16_bf16 v[160:163], v[28:29], v[142:143], v[160:163]
    ds_read_b128 v[168:171], v234
    v_bfe_u32 v234, s68, v233, 4
    v_mfma_f32_16x16x32_bf16 v[200:203], a[32:35], a[236:239], v[200:203]
    v_mad_u32_u24 v234, v234, s40, v231
    v_fma_f32 v172, v172, s37, -v236
    v_mfma_f32_16x16x32_bf16 v[200:203], a[44:47], a[240:243], v[200:203]
    s_waitcnt lgkmcnt(1)
    v_fma_f32 v173, v173, s37, -v236
    v_fma_f32 v174, v174, s37, -v236
    v_mfma_f32_16x16x32_bf16 v[164:167], v[30:33], v[138:141], v[164:167]
    v_fma_f32 v175, v175, s37, -v236
    v_fma_f32 v144, v144, s37, -v236
    v_mfma_f32_16x16x32_bf16 v[220:223], a[236:239], a[96:99], v[220:223]
    v_exp_f32 v172, v172
    v_mfma_f32_16x16x32_bf16 v[220:223], a[240:243], a[108:111], v[220:223]
    v_exp_f32 v173, v173
    v_mfma_f32_16x16x16_bf16 v[164:167], v[34:35], v[142:143], v[164:167]
    v_exp_f32 v174, v174
    v_mfma_f32_16x16x32_bf16 v[216:219], a[236:239], a[100:103], v[216:219]
    v_exp_f32 v175, v175
    v_mfma_f32_16x16x32_bf16 v[216:219], a[240:243], a[112:115], v[216:219]
    v_cvt_pk_bf16_f32 v182, v172, v173
    v_cvt_pk_bf16_f32 v183, v174, v175
    v_mfma_f32_16x16x32_bf16 v[212:215], a[236:239], a[104:107], v[212:215]
    ds_read_b128 v[172:175], v235
    v_bfe_u32 v235, s67, v233, 4
    v_mfma_f32_16x16x32_bf16 v[212:215], a[240:243], a[116:119], v[212:215]
    ds_read_b128 a[236:239], v239 offset:1024
    v_mad_u32_u24 v235, v235, s40, v231
    v_mfma_f32_16x16x32_bf16 v[196:199], a[216:219], v[180:183], v[196:199]
    ds_read_b128 a[240:243], v240 offset:1024
    v_fma_f32 v145, v145, s37, -v236
    v_mfma_f32_16x16x32_bf16 v[184:187], v[70:73], v[180:183], v[184:187]
    v_fma_f32 v146, v146, s37, -v236
    v_fma_f32 v147, v147, s37, -v236
    v_mfma_f32_16x16x32_bf16 v[188:191], v[92:95], v[180:183], v[188:191]
    v_exp_f32 v144, v144
    v_mfma_f32_16x16x32_bf16 v[192:195], v[114:117], v[180:183], v[192:195]
    v_exp_f32 v145, v145
    v_mfma_f32_16x16x32_bf16 v[208:211], a[48:51], a[244:247], v[208:211]
    v_exp_f32 v146, v146
    v_mfma_f32_16x16x32_bf16 v[208:211], a[60:63], a[248:251], v[208:211]
    s_waitcnt lgkmcnt(2)
    v_exp_f32 v147, v147
    v_mfma_f32_16x16x32_bf16 v[172:175], v[60:63], v[138:141], v[172:175]
    v_cvt_pk_bf16_f32 v176, v144, v145
    v_cvt_pk_bf16_f32 v177, v146, v147
    v_mfma_f32_16x16x32_bf16 v[204:207], a[52:55], a[244:247], v[204:207]
    ds_read_b128 v[144:147], v228 offset:640
    v_fma_f32 v148, v148, s37, -v236
    v_mfma_f32_16x16x32_bf16 v[204:207], a[64:67], a[248:251], v[204:207]
    v_cvt_pk_bf16_f32 v48, v208, v209
    v_cvt_pk_bf16_f32 v49, v210, v211
    v_mfma_f32_16x16x16_bf16 v[172:175], v[64:65], v[142:143], v[172:175]
    v_cndmask_b32 v54, v54, v48, s[82:83]
    v_cndmask_b32 v55, v55, v49, s[82:83]
    v_mfma_f32_16x16x32_bf16 v[200:203], a[56:59], a[244:247], v[200:203]
    v_fma_f32 v149, v149, s37, -v236
    v_fma_f32 v150, v150, s37, -v236
    v_mfma_f32_16x16x32_bf16 v[200:203], a[68:71], a[248:251], v[200:203]
    v_cvt_pk_bf16_f32 v50, v204, v205
    v_cvt_pk_bf16_f32 v51, v206, v207
    v_mfma_f32_16x16x32_bf16 v[220:223], a[244:247], a[120:123], v[220:223]
    v_cndmask_b32 v56, v56, v50, s[82:83]
    v_cndmask_b32 v57, v57, v51, s[82:83]
    v_mfma_f32_16x16x32_bf16 v[220:223], a[248:251], a[132:135], v[220:223]
    v_fma_f32 v151, v151, s37, -v236
    v_max3_f32 v248, v152, v153, v154
    v_mfma_f32_16x16x32_bf16 v[168:171], v[54:57], v[138:141], v[168:171]
    s_waitcnt lgkmcnt(0)
    v_cvt_pk_bf16_f32 v52, v200, v201
    v_cvt_pk_bf16_f32 v53, v202, v203
    v_mfma_f32_16x16x32_bf16 v[144:147], v[0:3], v[132:135], v[144:147]
    v_cndmask_b32 v58, v58, v52, s[82:83]
    v_cndmask_b32 v59, v59, v53, s[82:83]
    v_mfma_f32_16x16x32_bf16 v[216:219], a[244:247], a[124:127], v[216:219]
    v_cvt_pk_bf16_f32 v82, v220, v221
    v_cvt_pk_bf16_f32 v83, v222, v223
    v_mfma_f32_16x16x32_bf16 v[216:219], a[248:251], a[136:139], v[216:219]
    v_cndmask_b32 v84, v84, v82, s[84:85]
    v_cndmask_b32 v85, v85, v83, s[84:85]
    v_mfma_f32_16x16x16_bf16 v[168:171], v[58:59], v[142:143], v[168:171]
    v_exp_f32 v148, v148
    v_mfma_f32_16x16x16_bf16 v[144:147], v[4:5], v[136:137], v[144:147]
    v_exp_f32 v149, v149
    v_mfma_f32_16x16x32_bf16 v[212:215], a[244:247], a[128:131], v[212:215]
    ds_read_b128 a[244:247], v241 offset:12288
    v_cvt_pk_bf16_f32 v104, v216, v217
    v_mfma_f32_16x16x32_bf16 v[212:215], a[248:251], a[140:143], v[212:215]
    v_cvt_pk_bf16_f32 v105, v218, v219
    v_cndmask_b32 v106, v106, v104, s[84:85]
    v_mfma_f32_16x16x32_bf16 v[208:211], a[220:223], a[252:255], 0
    ds_read_b128 a[248:251], v241 offset:12800
    v_cndmask_b32 v107, v107, v105, s[84:85]
    v_mfma_f32_16x16x32_bf16 v[200:203], a[220:223], v[252:255], 0
    v_exp_f32 v150, v150
    v_mfma_f32_16x16x32_bf16 v[204:207], a[224:227], a[252:255], 0
    v_cvt_pk_bf16_f32 v126, v212, v213
    v_cvt_pk_bf16_f32 v127, v214, v215
    v_mfma_f32_16x16x32_bf16 v[220:223], a[224:227], v[252:255], 0
    v_cndmask_b32 v128, v128, v126, s[84:85]
    v_cndmask_b32 v129, v129, v127, s[84:85]
    v_mfma_f32_16x16x32_bf16 v[216:219], a[228:231], a[252:255], 0
    ds_read_b128 v[252:255], v242 offset:12800
    v_cvt_pk_bf16_f32 v178, v148, v149
    v_mfma_f32_16x16x32_bf16 v[212:215], a[232:235], a[252:255], 0
    s_waitcnt lgkmcnt(2)
    ds_read_b128 a[252:255], v242 offset:12288
    v_max3_f32 v249, v155, v156, v157
    v_mfma_f32_16x16x32_bf16 v[208:211], a[244:247], a[236:239], v[208:211]
    v_exp_f32 v151, v151
    v_mfma_f32_16x16x32_bf16 v[200:203], a[244:247], a[240:243], v[200:203]
    s_waitcnt lgkmcnt(2)
    ds_read_b128 a[244:247], v241 offset:24576
    v_cvt_pk_bf16_f32 v179, v150, v151
    v_mfma_f32_16x16x32_bf16 v[204:207], a[248:251], a[236:239], v[204:207]
    ds_read_b128 v[148:151], v229 offset:640
    v_max3_f32 v248, v248, v158, v159
    v_mfma_f32_16x16x32_bf16 v[196:199], a[216:219], v[176:179], v[196:199]
    v_max3_f32 v249, v249, v160, v161
    v_max3_f32 v248, v248, v162, v163
    v_mfma_f32_16x16x32_bf16 v[184:187], v[74:77], v[176:179], v[184:187]
    v_max3_f32 v249, v249, v164, v165
    v_max3_f32 v248, v248, v166, v167
    v_mfma_f32_16x16x32_bf16 v[188:191], v[96:99], v[176:179], v[188:191]
    v_max3_f32 v249, v249, v168, v169
    v_max3_f32 v248, v248, v170, v171
    v_mfma_f32_16x16x32_bf16 v[192:195], v[118:121], v[176:179], v[192:195]
    v_rcp_f32 v197, v196
    v_mfma_f32_16x16x32_bf16 v[220:223], a[248:251], a[240:243], v[220:223]
    s_waitcnt lgkmcnt(2)
    ds_read_b128 a[240:243], v240 offset:2048
    ds_read_b128 a[248:251], v241 offset:25088
    v_mfma_f32_16x16x32_bf16 v[216:219], a[252:255], a[236:239], v[216:219]
    ds_read_b128 a[252:255], v242 offset:24576
    v_mul_f32 v184, v184, v197
    v_mfma_f32_16x16x32_bf16 v[212:215], v[252:255], a[236:239], v[212:215]
    s_waitcnt lgkmcnt(3)
    ds_read_b128 a[236:239], v239 offset:2048
    v_mul_f32 v185, v185, v197
    v_mfma_f32_16x16x32_bf16 v[148:151], v[24:27], v[132:135], v[148:151]
    ds_read_b128 v[252:255], v242 offset:25088
    v_cvt_pk_bf16_f32 v184, v184, v185
    v_mul_f32 v186, v186, v197
    v_mul_f32 v187, v187, v197
    v_cvt_pk_bf16_f32 v185, v186, v187
    v_mul_f32 v188, v188, v197
    v_mfma_f32_16x16x16_bf16 v[148:151], v[28:29], v[136:137], v[148:151]
    s_waitcnt lgkmcnt(4)
    v_mul_f32 v189, v189, v197
    v_cvt_pk_bf16_f32 v186, v188, v189
    v_mul_f32 v190, v190, v197
    v_mul_f32 v191, v191, v197
    v_cvt_pk_bf16_f32 v187, v190, v191
    v_mul_f32 v192, v192, v197
    v_mfma_f32_16x16x32_bf16 v[200:203], a[244:247], a[240:243], v[200:203]
    s_waitcnt lgkmcnt(3)
    v_mul_f32 v193, v193, v197
    v_cvt_pk_bf16_f32 v188, v192, v193
    v_mfma_f32_16x16x32_bf16 v[220:223], a[248:251], a[240:243], v[220:223]
    s_waitcnt lgkmcnt(1)
    ds_read_b128 a[240:243], v240 offset:3072
    v_mul_f32 v194, v194, v197
    v_mul_f32 v195, v195, v197
    v_cvt_pk_bf16_f32 v189, v194, v195
    ds_write_b128 v237, v[184:187] offset:12288
    v_mfma_f32_16x16x32_bf16 v[208:211], a[244:247], a[236:239], v[208:211]
    ds_write_b64 v238, v[188:189] offset:12288
    v_mfma_f32_16x16x32_bf16 v[204:207], a[248:251], a[236:239], v[204:207]
    v_max3_f32 v249, v249, v172, v173
    v_max3_f32 v248, v248, v174, v175
    v_mfma_f32_16x16x32_bf16 v[216:219], a[252:255], a[236:239], v[216:219]
    s_waitcnt lgkmcnt(3)
    v_max_f32 v248, v248, v249
    v_mov_b32 v249, v248
    v_mfma_f32_16x16x32_bf16 v[212:215], v[252:255], a[236:239], v[212:215]
    s_nop 0
    v_permlane16_swap_b32 v248, v249
    ds_read_b128 a[236:239], v239 offset:3072
    ds_read_b128 a[244:247], v241 offset:36864
    v_max_f32 v248, v248, v249
    v_mov_b32 v249, v248
    ds_read_b128 a[248:251], v241 offset:37376
    s_nop 0
    ds_read_b128 a[252:255], v242 offset:36864
    v_permlane32_swap_b32 v248, v249
    v_max_f32 v248, v248, v249
    ds_read_b128 v[252:255], v242 offset:37376
    v_mul_f32 v236, s37, v248
    v_fma_f32 v152, v152, s37, -v236
    v_fma_f32 v153, v153, s37, -v236
    v_fma_f32 v154, v154, s37, -v236
    v_fma_f32 v155, v155, s37, -v236
    v_exp_f32 v152, v152
    v_exp_f32 v153, v153
    v_exp_f32 v154, v154
    v_exp_f32 v155, v155
    v_cvt_pk_bf16_f32 v180, v152, v153
    v_cvt_pk_bf16_f32 v181, v154, v155
    s_waitcnt lgkmcnt(3)
    v_mfma_f32_16x16x32_bf16 v[208:211], a[244:247], a[236:239], v[208:211]
    ds_read_b128 v[152:155], v229 offset:1280
    v_fma_f32 v156, v156, s37, -v236
    v_mfma_f32_16x16x32_bf16 v[200:203], a[244:247], a[240:243], v[200:203]
    s_waitcnt lgkmcnt(3)
    ds_read_b128 a[244:247], v241 offset:49152
    v_fma_f32 v157, v157, s37, -v236
    v_mfma_f32_16x16x32_bf16 v[204:207], a[248:251], a[236:239], v[204:207]
    v_fma_f32 v158, v158, s37, -v236
    v_fma_f32 v159, v159, s37, -v236
    v_mfma_f32_16x16x32_bf16 v[220:223], a[248:251], a[240:243], v[220:223]
    s_waitcnt lgkmcnt(3)
    ds_read_b128 a[240:243], v240 offset:4096
    ds_read_b128 a[248:251], v241 offset:49664
    v_mfma_f32_16x16x32_bf16 v[216:219], a[252:255], a[236:239], v[216:219]
    s_waitcnt lgkmcnt(4)
    ds_read_b128 a[252:255], v242 offset:49152
    v_fma_f32 v160, v160, s37, -v236
    v_mfma_f32_16x16x32_bf16 v[212:215], v[252:255], a[236:239], v[212:215]
    s_waitcnt lgkmcnt(4)
    ds_read_b128 a[236:239], v239 offset:4096
    v_exp_f32 v156, v156
    v_exp_f32 v157, v157
    ds_read_b128 v[252:255], v242 offset:49664
    v_mfma_f32_16x16x32_bf16 v[152:155], v[30:33], v[132:135], v[152:155]
    s_waitcnt lgkmcnt(4)
    v_exp_f32 v158, v158
    v_exp_f32 v159, v159
    v_cvt_pk_bf16_f32 v182, v156, v157
    v_cvt_pk_bf16_f32 v183, v158, v159
    ds_read_b128 v[156:159], v228 offset:1280
    v_mfma_f32_16x16x32_bf16 v[200:203], a[244:247], a[240:243], v[200:203]
    v_fma_f32 v161, v161, s37, -v236
    v_fma_f32 v162, v162, s37, -v236
    v_mfma_f32_16x16x32_bf16 v[196:199], a[216:219], v[180:183], 0
    v_fma_f32 v163, v163, s37, -v236
    v_fma_f32 v164, v164, s37, -v236
    v_mfma_f32_16x16x32_bf16 v[184:187], v[76:79], v[180:183], 0
    v_exp_f32 v160, v160
    v_mfma_f32_16x16x32_bf16 v[188:191], v[98:101], v[180:183], 0
    v_exp_f32 v161, v161
    v_mfma_f32_16x16x32_bf16 v[192:195], v[120:123], v[180:183], 0
    v_exp_f32 v162, v162
    v_mfma_f32_16x16x16_bf16 v[152:155], v[34:35], v[136:137], v[152:155]
    s_waitcnt lgkmcnt(1)
    v_exp_f32 v163, v163
    v_mfma_f32_16x16x32_bf16 v[208:211], a[244:247], a[236:239], v[208:211]
    s_waitcnt lgkmcnt(0)
    ds_read_b128 a[244:247], v241 offset:61440
    v_cvt_pk_bf16_f32 v176, v160, v161
    v_mfma_f32_16x16x32_bf16 v[156:159], v[6:9], v[132:135], v[156:159]
    v_cvt_pk_bf16_f32 v177, v162, v163
    v_fma_f32 v165, v165, s37, -v236
    v_mfma_f32_16x16x32_bf16 v[204:207], a[248:251], a[236:239], v[204:207]
    ds_read_b128 v[160:163], v228 offset:1920
    v_fma_f32 v166, v166, s37, -v236
    v_mfma_f32_16x16x32_bf16 v[220:223], a[248:251], a[240:243], v[220:223]
    ds_read_b128 a[240:243], v240 offset:5120
    v_fma_f32 v167, v167, s37, -v236
    v_mfma_f32_16x16x16_bf16 v[156:159], v[10:11], v[136:137], v[156:159]
    ds_read_b128 a[248:251], v241 offset:61952
    v_fma_f32 v168, v168, s37, -v236
    v_mfma_f32_16x16x32_bf16 v[216:219], a[252:255], a[236:239], v[216:219]
    ds_read_b128 a[252:255], v242 offset:61440
    v_fma_f32 v169, v169, s37, -v236
    v_mfma_f32_16x16x32_bf16 v[212:215], v[252:255], a[236:239], v[212:215]
    s_waitcnt lgkmcnt(3)
    ds_read_b128 a[236:239], v239 offset:5120
    v_exp_f32 v164, v164
    ds_read_b128 v[252:255], v242 offset:61952
    v_exp_f32 v165, v165
    v_exp_f32 v166, v166
    v_exp_f32 v167, v167
    v_mfma_f32_16x16x32_bf16 v[160:163], v[12:15], v[132:135], v[160:163]
    s_waitcnt lgkmcnt(4)
    v_cvt_pk_bf16_f32 v178, v164, v165
    v_cvt_pk_bf16_f32 v179, v166, v167
    v_mfma_f32_16x16x32_bf16 v[200:203], a[244:247], a[240:243], v[200:203]
    ds_read_b128 v[164:167], v229 offset:1920
    v_fma_f32 v170, v170, s37, -v236
    v_mfma_f32_16x16x32_bf16 v[196:199], a[216:219], v[176:179], v[196:199]
    v_fma_f32 v171, v171, s37, -v236
    v_fma_f32 v172, v172, s37, -v236
    v_mfma_f32_16x16x32_bf16 v[184:187], v[68:71], v[176:179], v[184:187]
    v_exp_f32 v168, v168
    v_mfma_f32_16x16x32_bf16 v[188:191], v[90:93], v[176:179], v[188:191]
    v_cvt_pk_bf16_f32 v200, v200, v201
    v_cvt_pk_bf16_f32 v201, v202, v203
    v_mfma_f32_16x16x32_bf16 v[192:195], v[112:115], v[176:179], v[192:195]
    v_exp_f32 v169, v169
    v_mfma_f32_16x16x16_bf16 v[160:163], v[16:17], v[136:137], v[160:163]
    s_waitcnt lgkmcnt(1)
    v_exp_f32 v170, v170
    v_mfma_f32_16x16x32_bf16 v[208:211], a[244:247], a[236:239], v[208:211]
    ds_read_b128 a[244:247], v224 offset:46592
    v_cvt_pk_bf16_f32 v180, v168, v169
    v_mfma_f32_16x16x32_bf16 v[204:207], a[248:251], a[236:239], v[204:207]
    s_waitcnt lgkmcnt(1)
    v_exp_f32 v171, v171
    v_mfma_f32_16x16x32_bf16 v[164:167], v[36:39], v[132:135], v[164:167]
    v_cvt_pk_bf16_f32 v181, v170, v171
    v_fma_f32 v173, v173, s37, -v236
    v_mfma_f32_16x16x32_bf16 v[220:223], a[248:251], a[240:243], v[220:223]
    ds_read_b128 v[168:171], v229 offset:2560
    v_cvt_pk_bf16_f32 v208, v208, v209
    v_mfma_f32_16x16x32_bf16 v[216:219], a[252:255], a[236:239], v[216:219]
    ds_read_b128 a[240:243], v224 offset:46528
    v_cvt_pk_bf16_f32 v209, v210, v211
    v_mfma_f32_16x16x16_bf16 v[164:167], v[40:41], v[136:137], v[164:167]
    ds_read_b128 a[248:251], v224 offset:46656
    v_cvt_pk_bf16_f32 v210, v204, v205
    v_mfma_f32_16x16x32_bf16 v[212:215], v[252:255], a[236:239], v[212:215]
    ds_read_b128 a[236:239], v224 offset:46464
    v_cvt_pk_bf16_f32 v211, v206, v207
    ds_read_b128 a[252:255], v224 offset:46720
    buffer_store_dwordx4 v[208:211], v243, s[20:23], s51 offen sc0 sc1
    ds_read_b128 v[252:255], v224 offset:46784
    v_cvt_pk_bf16_f32 v202, v220, v221
    v_cvt_pk_bf16_f32 v203, v222, v223
    v_cvt_pk_bf16_f32 v216, v216, v217
    v_cvt_pk_bf16_f32 v217, v218, v219
    v_cvt_pk_bf16_f32 v218, v212, v213
    v_cvt_pk_bf16_f32 v219, v214, v215
    v_fma_f32 v174, v174, s37, -v236
    v_fma_f32 v175, v175, s37, -v236
    v_exp_f32 v172, v172
    v_exp_f32 v173, v173
    v_exp_f32 v174, v174
    v_exp_f32 v175, v175
    v_cvt_pk_bf16_f32 v182, v172, v173
    s_waitcnt lgkmcnt(2)
    v_mfma_f32_16x16x32_bf16 v[208:211], a[0:3], a[236:239], 0
    v_cvt_pk_bf16_f32 v183, v174, v175
    v_max3_f32 v248, v144, v145, v146
    v_mfma_f32_16x16x32_bf16 v[208:211], a[12:15], a[240:243], v[208:211]
    ds_read_b128 v[172:175], v228 offset:2560
    v_max3_f32 v249, v147, v148, v149
    v_mfma_f32_16x16x32_bf16 v[196:199], a[216:219], v[180:183], v[196:199]
    v_max3_f32 v248, v248, v150, v151
    v_max3_f32 v249, v249, v152, v153
    v_mfma_f32_16x16x32_bf16 v[184:187], v[84:87], v[180:183], v[184:187]
    v_mov_b32 v84, v82
    v_mov_b32 v85, v83
    v_mfma_f32_16x16x32_bf16 v[188:191], v[106:109], v[180:183], v[188:191]
    v_mov_b32 v106, v104
    v_mov_b32 v107, v105
    v_mfma_f32_16x16x32_bf16 v[192:195], v[128:131], v[180:183], v[192:195]
    v_mov_b32 v128, v126
    v_mov_b32 v129, v127
    v_mfma_f32_16x16x32_bf16 v[204:207], a[4:7], a[236:239], 0
    v_rcp_f32 v197, v196
    v_mfma_f32_16x16x32_bf16 v[204:207], a[16:19], a[240:243], v[204:207]
    v_mul_f32 v184, v184, v197
    v_mul_f32 v185, v185, v197
    v_mfma_f32_16x16x32_bf16 v[220:223], a[236:239], a[72:75], 0
    v_cvt_pk_bf16_f32 v184, v184, v185
    v_mul_f32 v186, v186, v197
    v_mfma_f32_16x16x32_bf16 v[220:223], a[240:243], a[84:87], v[220:223]
    v_mul_f32 v187, v187, v197
    v_cvt_pk_bf16_f32 v185, v186, v187
    v_mfma_f32_16x16x32_bf16 v[212:215], a[236:239], a[80:83], 0
    v_mul_f32 v188, v188, v197
    v_mul_f32 v189, v189, v197
    v_mfma_f32_16x16x32_bf16 v[212:215], a[240:243], a[92:95], v[212:215]
    v_cvt_pk_bf16_f32 v186, v188, v189
    v_mul_f32 v190, v190, v197
    v_mfma_f32_16x16x32_bf16 v[208:211], a[24:27], a[244:247], v[208:211]
    v_mul_f32 v191, v191, v197
    v_cvt_pk_bf16_f32 v187, v190, v191
    v_mfma_f32_16x16x32_bf16 v[208:211], a[36:39], a[248:251], v[208:211]
    v_mul_f32 v192, v192, v197
    v_mul_f32 v193, v193, v197
    v_mfma_f32_16x16x32_bf16 v[204:207], a[28:31], a[244:247], v[204:207]
    v_cvt_pk_bf16_f32 v188, v192, v193
    v_mul_f32 v194, v194, v197
    v_mfma_f32_16x16x32_bf16 v[204:207], a[40:43], a[248:251], v[204:207]
    v_mul_f32 v195, v195, v197
    v_cvt_pk_bf16_f32 v189, v194, v195
    v_mfma_f32_16x16x32_bf16 v[220:223], a[244:247], a[96:99], v[220:223]
    ds_write_b128 v237, v[184:187] offset:18432
    v_mfma_f32_16x16x32_bf16 v[220:223], a[248:251], a[108:111], v[220:223]
    ds_write_b64 v238, v[188:189] offset:18432
    v_mfma_f32_16x16x32_bf16 v[212:215], a[244:247], a[104:107], v[212:215]
    buffer_store_dwordx4 v[200:203], v245, s[20:23], s51 offen sc0 sc1
    v_mfma_f32_16x16x32_bf16 v[212:215], a[248:251], a[116:119], v[212:215]
    v_max3_f32 v248, v248, v154, v155
    v_max3_f32 v249, v249, v156, v157
    v_mfma_f32_16x16x32_bf16 v[200:203], a[8:11], a[236:239], 0
    v_max3_f32 v248, v248, v158, v159
    v_max3_f32 v249, v249, v160, v161
    v_mfma_f32_16x16x32_bf16 v[200:203], a[20:23], a[240:243], v[200:203]
    v_max3_f32 v248, v248, v162, v163
    v_max3_f32 v249, v249, v164, v165
    v_mfma_f32_16x16x32_bf16 v[200:203], a[32:35], a[244:247], v[200:203]
    v_max3_f32 v248, v248, v166, v167
    v_mfma_f32_16x16x32_bf16 v[200:203], a[44:47], a[248:251], v[200:203]
    s_waitcnt lgkmcnt(2)
    v_mfma_f32_16x16x32_bf16 v[208:211], a[48:51], a[252:255], v[208:211]
    v_mfma_f32_16x16x32_bf16 v[208:211], a[60:63], v[252:255], v[208:211]
    v_mfma_f32_16x16x32_bf16 v[204:207], a[52:55], a[252:255], v[204:207]
    v_mfma_f32_16x16x32_bf16 v[204:207], a[64:67], v[252:255], v[204:207]
    v_mfma_f32_16x16x32_bf16 v[200:203], a[56:59], a[252:255], v[200:203]
    v_mfma_f32_16x16x32_bf16 v[200:203], a[68:71], v[252:255], v[200:203]
    v_mfma_f32_16x16x32_bf16 v[220:223], a[252:255], a[120:123], v[220:223]
    buffer_store_dwordx4 v[216:219], v244, s[20:23], s51 offen sc0 sc1
    v_mfma_f32_16x16x32_bf16 v[220:223], v[252:255], a[132:135], v[220:223]
    s_add_u32 s51, s51, s48
    v_cvt_pk_bf16_f32 v18, v208, v209
    v_cvt_pk_bf16_f32 v19, v210, v211
    v_mfma_f32_16x16x32_bf16 v[216:219], a[236:239], a[76:79], 0
    v_cvt_pk_bf16_f32 v20, v204, v205
    v_cvt_pk_bf16_f32 v21, v206, v207
    v_mfma_f32_16x16x32_bf16 v[216:219], a[240:243], a[88:91], v[216:219]
    v_cvt_pk_bf16_f32 v22, v200, v201
    v_cvt_pk_bf16_f32 v23, v202, v203
    v_mfma_f32_16x16x32_bf16 v[172:175], v[18:21], v[132:135], v[172:175]
    v_cvt_pk_bf16_f32 v80, v220, v221
    v_cvt_pk_bf16_f32 v81, v222, v223
    v_mfma_f32_16x16x32_bf16 v[216:219], a[244:247], a[100:103], v[216:219]
    ds_read_b128 a[236:239], v224 offset:49536
    ds_read_b128 a[240:243], v224 offset:49600
    v_mfma_f32_16x16x32_bf16 v[216:219], a[248:251], a[112:115], v[216:219]
    ds_read_b128 a[244:247], v224 offset:49664
    v_mfma_f32_16x16x16_bf16 v[172:175], v[22:23], v[136:137], v[172:175]
    ds_read_b128 a[248:251], v224 offset:49728
    v_mfma_f32_16x16x32_bf16 v[216:219], a[252:255], a[124:127], v[216:219]
    v_mfma_f32_16x16x32_bf16 v[216:219], v[252:255], a[136:139], v[216:219]
    v_mfma_f32_16x16x32_bf16 v[212:215], a[252:255], a[128:131], v[212:215]
    ds_read_b128 a[252:255], v224 offset:49792
    v_mfma_f32_16x16x32_bf16 v[212:215], v[252:255], a[140:143], v[212:215]
    s_waitcnt lgkmcnt(4)
    ds_read_b128 v[252:255], v224 offset:49856
    v_mfma_f32_16x16x32_bf16 v[208:211], a[0:3], a[236:239], 0
    s_waitcnt lgkmcnt(4)
    v_mfma_f32_16x16x32_bf16 v[208:211], a[12:15], a[240:243], v[208:211]
    v_mfma_f32_16x16x32_bf16 v[204:207], a[4:7], a[236:239], 0
    v_mfma_f32_16x16x32_bf16 v[204:207], a[16:19], a[240:243], v[204:207]
    v_cvt_pk_bf16_f32 v102, v216, v217
    v_cvt_pk_bf16_f32 v103, v218, v219
    v_mfma_f32_16x16x32_bf16 v[200:203], a[8:11], a[236:239], 0
    v_cvt_pk_bf16_f32 v124, v212, v213
    v_cvt_pk_bf16_f32 v125, v214, v215
    v_mfma_f32_16x16x32_bf16 v[200:203], a[20:23], a[240:243], v[200:203]
    v_mfma_f32_16x16x32_bf16 v[220:223], a[236:239], a[72:75], 0
    v_mfma_f32_16x16x32_bf16 v[220:223], a[240:243], a[84:87], v[220:223]
    v_mfma_f32_16x16x32_bf16 v[216:219], a[236:239], a[76:79], 0
    v_mfma_f32_16x16x32_bf16 v[216:219], a[240:243], a[88:91], v[216:219]
    v_mfma_f32_16x16x32_bf16 v[212:215], a[236:239], a[80:83], 0
    ds_read_b128 a[236:239], v225 offset:27456
    v_mfma_f32_16x16x32_bf16 v[212:215], a[240:243], a[92:95], v[212:215]
    s_waitcnt lgkmcnt(1)
    ds_read_b128 a[240:243], v225 offset:27520
    v_mfma_f32_16x16x32_bf16 v[208:211], a[24:27], a[244:247], v[208:211]
    v_mfma_f32_16x16x32_bf16 v[208:211], a[36:39], a[248:251], v[208:211]
    v_mfma_f32_16x16x32_bf16 v[204:207], a[28:31], a[244:247], v[204:207]
    v_mfma_f32_16x16x32_bf16 v[204:207], a[40:43], a[248:251], v[204:207]
    v_mfma_f32_16x16x32_bf16 v[200:203], a[32:35], a[244:247], v[200:203]
    v_mfma_f32_16x16x32_bf16 v[200:203], a[44:47], a[248:251], v[200:203]
    v_mfma_f32_16x16x32_bf16 v[220:223], a[244:247], a[96:99], v[220:223]
    v_mfma_f32_16x16x32_bf16 v[220:223], a[248:251], a[108:111], v[220:223]
    v_mfma_f32_16x16x32_bf16 v[216:219], a[244:247], a[100:103], v[216:219]
    v_mfma_f32_16x16x32_bf16 v[216:219], a[248:251], a[112:115], v[216:219]
    v_mfma_f32_16x16x32_bf16 v[212:215], a[244:247], a[104:107], v[212:215]
    ds_read_b128 a[244:247], v225 offset:27584
    v_mfma_f32_16x16x32_bf16 v[212:215], a[248:251], a[116:119], v[212:215]
    ds_read_b128 a[248:251], v225 offset:27648
    v_mfma_f32_16x16x32_bf16 v[208:211], a[48:51], a[252:255], v[208:211]
    v_mfma_f32_16x16x32_bf16 v[208:211], a[60:63], v[252:255], v[208:211]
    v_mfma_f32_16x16x32_bf16 v[204:207], a[52:55], a[252:255], v[204:207]
    v_mfma_f32_16x16x32_bf16 v[204:207], a[64:67], v[252:255], v[204:207]
    v_mfma_f32_16x16x32_bf16 v[200:203], a[56:59], a[252:255], v[200:203]
    v_mfma_f32_16x16x32_bf16 v[200:203], a[68:71], v[252:255], v[200:203]
    v_mfma_f32_16x16x32_bf16 v[220:223], a[252:255], a[120:123], v[220:223]
    v_mfma_f32_16x16x32_bf16 v[220:223], v[252:255], a[132:135], v[220:223]
    v_mfma_f32_16x16x32_bf16 v[216:219], a[252:255], a[124:127], v[216:219]
    v_mfma_f32_16x16x32_bf16 v[216:219], v[252:255], a[136:139], v[216:219]
    v_cvt_pk_bf16_f32 v42, v208, v209
    v_cvt_pk_bf16_f32 v43, v210, v211
    v_mfma_f32_16x16x32_bf16 v[212:215], a[252:255], a[128:131], v[212:215]
    v_cvt_pk_bf16_f32 v44, v204, v205
    v_cvt_pk_bf16_f32 v45, v206, v207
    v_mfma_f32_16x16x32_bf16 v[212:215], v[252:255], a[140:143], v[212:215]
    v_cvt_pk_bf16_f32 v46, v200, v201
    v_cvt_pk_bf16_f32 v47, v202, v203
    v_mfma_f32_16x16x32_bf16 v[168:171], v[42:45], v[132:135], v[168:171]
    s_waitcnt lgkmcnt(0)
    v_cvt_pk_bf16_f32 v78, v220, v221
    v_cvt_pk_bf16_f32 v79, v222, v223
    v_mfma_f32_16x16x32_bf16 v[208:211], a[144:147], a[236:239], 0
    v_cvt_pk_bf16_f32 v100, v216, v217
    v_cvt_pk_bf16_f32 v101, v218, v219
    v_mfma_f32_16x16x32_bf16 v[208:211], a[156:159], a[240:243], v[208:211]
    v_cvt_pk_bf16_f32 v122, v212, v213
    v_cvt_pk_bf16_f32 v123, v214, v215
    v_mfma_f32_16x16x16_bf16 v[168:171], v[46:47], v[136:137], v[168:171]
    ds_read_b128 a[252:255], v225 offset:27712
    ds_read_b128 v[252:255], v225 offset:27776
    v_mfma_f32_16x16x32_bf16 v[204:207], a[148:151], a[236:239], 0
    v_mfma_f32_16x16x32_bf16 v[204:207], a[160:163], a[240:243], v[204:207]
    v_mfma_f32_16x16x32_bf16 v[200:203], a[152:155], a[236:239], 0
    ds_read_b128 a[236:239], v225 offset:39872
    v_mfma_f32_16x16x32_bf16 v[200:203], a[164:167], a[240:243], v[200:203]
    ds_read_b128 a[240:243], v225 offset:39936
    v_max3_f32 v249, v249, v168, v169
    v_mfma_f32_16x16x32_bf16 v[208:211], a[168:171], a[244:247], v[208:211]
    v_max3_f32 v248, v248, v170, v171
    v_max3_f32 v249, v249, v172, v173
    v_mfma_f32_16x16x32_bf16 v[208:211], a[180:183], a[248:251], v[208:211]
    v_max3_f32 v248, v248, v174, v175
    v_max_f32 v248, v248, v249
    v_mfma_f32_16x16x32_bf16 v[204:207], a[172:175], a[244:247], v[204:207]
    s_waitcnt vmcnt(3) lgkmcnt(2)
    v_mov_b32 v249, v248
    v_mfma_f32_16x16x32_bf16 v[204:207], a[184:187], a[248:251], v[204:207]
    s_barrier
    buffer_load_dwordx4 v246, s[4:7], s56 offen lds
    v_mfma_f32_16x16x32_bf16 v[200:203], a[176:179], a[244:247], v[200:203]
    ds_read_b128 a[244:247], v225 offset:40000
    v_mfma_f32_16x16x32_bf16 v[200:203], a[188:191], a[248:251], v[200:203]
    ds_read_b128 a[248:251], v225 offset:40064
    v_mfma_f32_16x16x32_bf16 v[208:211], a[192:195], a[252:255], v[208:211]
    v_permlane16_swap_b32 v248, v249
    v_mfma_f32_16x16x32_bf16 v[208:211], a[204:207], v[252:255], v[208:211]
    v_max_f32 v248, v248, v249
    v_mov_b32 v249, v248
    v_mfma_f32_16x16x32_bf16 v[204:207], a[196:199], a[252:255], v[204:207]
    v_mfma_f32_16x16x32_bf16 v[204:207], a[208:211], v[252:255], v[204:207]
    buffer_load_dwordx4 v247, s[4:7], s56 offen offset:1024 lds
    v_mfma_f32_16x16x32_bf16 v[200:203], a[200:203], a[252:255], v[200:203]
    s_add_u32 s56, s56, s42
    ds_read_b128 a[252:255], v225 offset:40128
    v_cvt_pk_bf16_f32 v138, v208, v209
    v_mfma_f32_16x16x32_bf16 v[200:203], a[212:215], v[252:255], v[200:203]
    s_add_u32 m0, s41, 0x5ac0
    ds_read_b128 v[252:255], v225 offset:40192
    v_cvt_pk_bf16_f32 v139, v210, v211
    s_waitcnt lgkmcnt(4)
    v_mfma_f32_16x16x32_bf16 v[220:223], a[144:147], a[236:239], 0
    v_cvt_pk_bf16_f32 v140, v204, v205
    v_cvt_pk_bf16_f32 v141, v206, v207
    v_mfma_f32_16x16x32_bf16 v[220:223], a[156:159], a[240:243], v[220:223]
    v_permlane32_swap_b32 v248, v249
    v_mfma_f32_16x16x32_bf16 v[216:219], a[148:151], a[236:239], 0
    v_cvt_pk_bf16_f32 v142, v200, v201
    v_cvt_pk_bf16_f32 v143, v202, v203
    v_mfma_f32_16x16x32_bf16 v[216:219], a[160:163], a[240:243], v[216:219]
    buffer_load_dwordx4 v246, s[4:7], s56 offen lds
    v_mfma_f32_16x16x32_bf16 v[212:215], a[152:155], a[236:239], 0
    ds_read_b128 a[236:239], v239 offset:12288
    v_cndmask_b32 v246, v245, v243, vcc
    v_mfma_f32_16x16x32_bf16 v[212:215], a[164:167], a[240:243], v[212:215]
    s_waitcnt lgkmcnt(3)
    ds_read_b128 a[240:243], v240 offset:12288
    v_max_f32 v248, v248, v249
    v_mfma_f32_16x16x32_bf16 v[220:223], a[168:171], a[244:247], v[220:223]
    v_mul_f32 v236, s37, v248
    v_fma_f32 v144, v144, s37, -v236
    v_mfma_f32_16x16x32_bf16 v[220:223], a[180:183], a[248:251], v[220:223]
    v_fma_f32 v145, v145, s37, -v236
    v_fma_f32 v146, v146, s37, -v236
    v_mfma_f32_16x16x32_bf16 v[216:219], a[172:175], a[244:247], v[216:219]
    v_fma_f32 v147, v147, s37, -v236
    v_fma_f32 v148, v148, s37, -v236
    v_mfma_f32_16x16x32_bf16 v[216:219], a[184:187], a[248:251], v[216:219]
    buffer_load_dwordx4 v247, s[4:7], s56 offen offset:1024 lds
    v_mfma_f32_16x16x32_bf16 v[212:215], a[176:179], a[244:247], v[212:215]
    ds_read_b128 a[244:247], v239 offset:13312
    v_bfrev_b32 v247, 1
    v_mfma_f32_16x16x32_bf16 v[212:215], a[188:191], a[248:251], v[212:215]
    s_waitcnt lgkmcnt(3)
    ds_read_b128 a[248:251], v240 offset:13312
    v_fma_f32 v149, v149, s37, -v236
    v_mfma_f32_16x16x32_bf16 v[220:223], a[192:195], a[252:255], v[220:223]
    v_exp_f32 v144, v144
    v_mfma_f32_16x16x32_bf16 v[220:223], a[204:207], v[252:255], v[220:223]
    v_exp_f32 v145, v145
    v_mfma_f32_16x16x32_bf16 v[216:219], a[196:199], a[252:255], v[216:219]
    v_exp_f32 v146, v146
    v_mfma_f32_16x16x32_bf16 v[216:219], a[208:211], v[252:255], v[216:219]
    v_exp_f32 v147, v147
    v_mfma_f32_16x16x32_bf16 v[212:215], a[200:203], a[252:255], v[212:215]
    ds_read_b128 a[252:255], v241 offset:12288
    v_cvt_pk_bf16_f32 v176, v144, v145
    v_mfma_f32_16x16x32_bf16 v[212:215], a[212:215], v[252:255], v[212:215]
    s_waitcnt lgkmcnt(3)
    v_cvt_pk_bf16_f32 v132, v220, v221
    v_cvt_pk_bf16_f32 v133, v222, v223
    v_mfma_f32_16x16x32_bf16 v[208:211], a[220:223], a[236:239], 0
    v_cvt_pk_bf16_f32 v134, v216, v217
    v_cvt_pk_bf16_f32 v135, v218, v219
    v_mfma_f32_16x16x32_bf16 v[200:203], a[220:223], a[240:243], 0
    ds_read_b128 v[252:255], v241 offset:12800
    v_cvt_pk_bf16_f32 v177, v146, v147
    v_mfma_f32_16x16x32_bf16 v[204:207], a[224:227], a[236:239], 0
    ds_read_b128 v[144:147], v230 offset:640
    v_cvt_pk_bf16_f32 v136, v212, v213
    v_mfma_f32_16x16x32_bf16 v[220:223], a[224:227], a[240:243], 0
    ds_read_b128 a[240:243], v242 offset:12800
    v_cvt_pk_bf16_f32 v137, v214, v215
    v_mfma_f32_16x16x32_bf16 v[216:219], a[228:231], a[236:239], 0
    v_fma_f32 v150, v150, s37, -v236
    v_fma_f32 v151, v151, s37, -v236
    v_mfma_f32_16x16x32_bf16 v[212:215], a[232:235], a[236:239], 0
    s_waitcnt lgkmcnt(3)
    ds_read_b128 a[236:239], v242 offset:12288
    v_fma_f32 v152, v152, s37, -v236
    v_mfma_f32_16x16x32_bf16 v[208:211], a[252:255], a[244:247], v[208:211]
    v_exp_f32 v148, v148
    v_mfma_f32_16x16x32_bf16 v[200:203], a[252:255], a[248:251], v[200:203]
    s_waitcnt lgkmcnt(3)
    ds_read_b128 a[252:255], v241 offset:24576
    v_fma_f32 v153, v153, s37, -v236
    v_mfma_f32_16x16x32_bf16 v[204:207], v[252:255], a[244:247], v[204:207]
    v_exp_f32 v149, v149
    v_mfma_f32_16x16x32_bf16 v[220:223], v[252:255], a[248:251], v[220:223]
    s_waitcnt lgkmcnt(3)
    ds_read_b128 a[248:251], v240 offset:14336
    ds_read_b128 v[252:255], v241 offset:25088
    v_mfma_f32_16x16x32_bf16 v[144:147], v[24:27], v[138:141], v[144:147]
    s_waitcnt lgkmcnt(4)
    v_exp_f32 v150, v150
    v_mfma_f32_16x16x32_bf16 v[212:215], a[240:243], a[244:247], v[212:215]
    s_waitcnt lgkmcnt(3)
    ds_read_b128 a[240:243], v242 offset:25088
    v_cvt_pk_bf16_f32 v178, v148, v149
    v_mfma_f32_16x16x32_bf16 v[216:219], a[236:239], a[244:247], v[216:219]
    ds_read_b128 a[244:247], v239 offset:14336
    ds_read_b128 a[236:239], v242 offset:24576
    v_mfma_f32_16x16x16_bf16 v[144:147], v[28:29], v[142:143], v[144:147]
    v_exp_f32 v151, v151
    v_fma_f32 v154, v154, s37, -v236
    v_cvt_pk_bf16_f32 v179, v150, v151
    ds_read_b128 v[148:151], v230 offset:1280
    v_fma_f32 v155, v155, s37, -v236
    v_mfma_f32_16x16x32_bf16 v[196:199], a[216:219], v[176:179], 0
    v_exp_f32 v152, v152
    v_mfma_f32_16x16x32_bf16 v[184:187], v[66:69], v[176:179], 0
    v_exp_f32 v153, v153
    v_mfma_f32_16x16x32_bf16 v[188:191], v[88:91], v[176:179], 0
    v_exp_f32 v154, v154
    v_mfma_f32_16x16x32_bf16 v[192:195], v[110:113], v[176:179], 0
    s_waitcnt lgkmcnt(2)
    v_exp_f32 v155, v155
    v_mfma_f32_16x16x32_bf16 v[208:211], a[252:255], a[244:247], v[208:211]
    v_cvt_pk_bf16_f32 v180, v152, v153
    v_cvt_pk_bf16_f32 v181, v154, v155
    v_mfma_f32_16x16x32_bf16 v[200:203], a[252:255], a[248:251], v[200:203]
    ds_read_b128 v[152:155], v230 offset:1920
    v_fma_f32 v156, v156, s37, -v236
    v_mfma_f32_16x16x32_bf16 v[204:207], v[252:255], a[244:247], v[204:207]
    s_waitcnt lgkmcnt(1)
    ds_read_b128 a[252:255], v241 offset:36864
    v_fma_f32 v157, v157, s37, -v236
    v_mfma_f32_16x16x32_bf16 v[148:151], v[30:33], v[138:141], v[148:151]
    v_fma_f32 v158, v158, s37, -v236
    v_fma_f32 v159, v159, s37, -v236
    v_mfma_f32_16x16x32_bf16 v[220:223], v[252:255], a[248:251], v[220:223]
    ds_read_b128 a[248:251], v240 offset:15360
    ds_read_b128 v[252:255], v241 offset:37376
    v_mfma_f32_16x16x32_bf16 v[216:219], a[236:239], a[244:247], v[216:219]
    ds_read_b128 a[236:239], v242 offset:36864
    v_fma_f32 v160, v160, s37, -v236
    v_mfma_f32_16x16x16_bf16 v[148:151], v[34:35], v[142:143], v[148:151]
    v_exp_f32 v156, v156
    v_mfma_f32_16x16x32_bf16 v[212:215], a[240:243], a[244:247], v[212:215]
    s_waitcnt lgkmcnt(4)
    ds_read_b128 a[244:247], v239 offset:15360
    ds_read_b128 a[240:243], v242 offset:37376
    v_exp_f32 v157, v157
    v_mfma_f32_16x16x32_bf16 v[152:155], v[36:39], v[138:141], v[152:155]
    s_waitcnt lgkmcnt(4)
    v_exp_f32 v158, v158
    v_exp_f32 v159, v159
    v_cvt_pk_bf16_f32 v182, v156, v157
    v_cvt_pk_bf16_f32 v183, v158, v159
    ds_read_b128 v[156:159], v230 offset:2560
    v_mfma_f32_16x16x32_bf16 v[200:203], a[252:255], a[248:251], v[200:203]
    v_fma_f32 v161, v161, s37, -v236
    v_fma_f32 v162, v162, s37, -v236
    v_mfma_f32_16x16x32_bf16 v[196:199], a[216:219], v[180:183], v[196:199]
    v_fma_f32 v163, v163, s37, -v236
    v_fma_f32 v164, v164, s37, -v236
    v_mfma_f32_16x16x32_bf16 v[184:187], v[70:73], v[180:183], v[184:187]
    v_exp_f32 v160, v160
    v_mfma_f32_16x16x32_bf16 v[188:191], v[92:95], v[180:183], v[188:191]
    v_exp_f32 v161, v161
    v_mfma_f32_16x16x32_bf16 v[192:195], v[114:117], v[180:183], v[192:195]
    v_exp_f32 v162, v162
    v_mfma_f32_16x16x16_bf16 v[152:155], v[40:41], v[142:143], v[152:155]
    s_waitcnt lgkmcnt(1)
    v_exp_f32 v163, v163
    v_mfma_f32_16x16x32_bf16 v[208:211], a[252:255], a[244:247], v[208:211]
    s_waitcnt lgkmcnt(0)
    ds_read_b128 a[252:255], v241 offset:49152
    v_cvt_pk_bf16_f32 v176, v160, v161
    v_mfma_f32_16x16x32_bf16 v[156:159], v[42:45], v[138:141], v[156:159]
    v_cvt_pk_bf16_f32 v177, v162, v163
    v_fma_f32 v165, v165, s37, -v236
    v_mfma_f32_16x16x32_bf16 v[204:207], v[252:255], a[244:247], v[204:207]
    ds_read_b128 v[160:163], v250
    v_bfe_u32 v250, s70, v233, 4
    v_mfma_f32_16x16x32_bf16 v[220:223], v[252:255], a[248:251], v[220:223]
    ds_read_b128 a[248:251], v240 offset:16384
    v_mad_u32_u24 v250, v250, s40, v231
    v_mfma_f32_16x16x16_bf16 v[156:159], v[46:47], v[142:143], v[156:159]
    ds_read_b128 v[252:255], v241 offset:49664
    v_fma_f32 v166, v166, s37, -v236
    v_mfma_f32_16x16x32_bf16 v[216:219], a[236:239], a[244:247], v[216:219]
    ds_read_b128 a[236:239], v242 offset:49152
    v_fma_f32 v167, v167, s37, -v236
    v_mfma_f32_16x16x32_bf16 v[212:215], a[240:243], a[244:247], v[212:215]
    s_waitcnt lgkmcnt(3)
    ds_read_b128 a[244:247], v239 offset:16384
    v_exp_f32 v164, v164
    ds_read_b128 a[240:243], v242 offset:49664
    v_exp_f32 v165, v165
    v_exp_f32 v166, v166
    v_exp_f32 v167, v167
    v_mfma_f32_16x16x32_bf16 v[160:163], v[48:51], v[138:141], v[160:163]
    s_waitcnt lgkmcnt(4)
    v_cvt_pk_bf16_f32 v178, v164, v165
    v_cvt_pk_bf16_f32 v179, v166, v167
    v_mfma_f32_16x16x32_bf16 v[200:203], a[252:255], a[248:251], v[200:203]
    ds_read_b128 v[164:167], v234
    v_bfe_u32 v234, s69, v233, 4
    v_mfma_f32_16x16x32_bf16 v[196:199], a[216:219], v[176:179], v[196:199]
    v_mad_u32_u24 v234, v234, s40, v231
    v_fma_f32 v168, v168, s37, -v236
    v_mfma_f32_16x16x32_bf16 v[184:187], v[74:77], v[176:179], v[184:187]
    v_fma_f32 v169, v169, s37, -v236
    v_fma_f32 v170, v170, s37, -v236
    v_mfma_f32_16x16x32_bf16 v[188:191], v[96:99], v[176:179], v[188:191]
    v_fma_f32 v171, v171, s37, -v236
    v_fma_f32 v172, v172, s37, -v236
    v_mfma_f32_16x16x32_bf16 v[192:195], v[118:121], v[176:179], v[192:195]
    v_exp_f32 v168, v168
    v_mfma_f32_16x16x16_bf16 v[160:163], v[52:53], v[142:143], v[160:163]
    s_waitcnt lgkmcnt(1)
    v_exp_f32 v169, v169
    v_mfma_f32_16x16x32_bf16 v[208:211], a[252:255], a[244:247], v[208:211]
    ds_read_b128 a[252:255], v241 offset:61440
    v_cvt_pk_bf16_f32 v180, v168, v169
    v_mfma_f32_16x16x32_bf16 v[204:207], v[252:255], a[244:247], v[204:207]
    s_waitcnt lgkmcnt(1)
    v_exp_f32 v170, v170
    v_mfma_f32_16x16x32_bf16 v[164:167], v[60:63], v[138:141], v[164:167]
    v_exp_f32 v171, v171
    v_mfma_f32_16x16x32_bf16 v[220:223], v[252:255], a[248:251], v[220:223]
    ds_read_b128 a[248:251], v240 offset:17408
    ds_read_b128 v[252:255], v241 offset:61952
    v_mfma_f32_16x16x32_bf16 v[216:219], a[236:239], a[244:247], v[216:219]
    ds_read_b128 a[236:239], v242 offset:61440
    v_cvt_pk_bf16_f32 v181, v170, v171
    v_mfma_f32_16x16x16_bf16 v[164:167], v[64:65], v[142:143], v[164:167]
    ds_read_b128 v[168:171], v229 offset:640
    v_fma_f32 v173, v173, s37, -v236
    v_mfma_f32_16x16x32_bf16 v[212:215], a[240:243], a[244:247], v[212:215]
    s_waitcnt lgkmcnt(3)
    v_fma_f32 v174, v174, s37, -v236
    v_fma_f32 v175, v175, s37, -v236
    ds_read_b128 a[244:247], v239 offset:17408
    v_exp_f32 v172, v172
    ds_read_b128 a[240:243], v242 offset:61952
    v_exp_f32 v173, v173
    v_exp_f32 v174, v174
    v_mfma_f32_16x16x32_bf16 v[200:203], a[252:255], a[248:251], v[200:203]
    s_waitcnt lgkmcnt(4)
    v_exp_f32 v175, v175
    v_mfma_f32_16x16x32_bf16 v[220:223], v[252:255], a[248:251], v[220:223]
    ds_read_b128 a[248:251], v224 offset:64
    v_cvt_pk_bf16_f32 v182, v172, v173
    v_cvt_pk_bf16_f32 v183, v174, v175
    ds_read_b128 v[172:175], v228 offset:640
    v_max3_f32 v248, v144, v145, v146
    v_mfma_f32_16x16x32_bf16 v[196:199], a[216:219], v[180:183], v[196:199]
    v_cvt_pk_bf16_f32 v200, v200, v201
    v_cvt_pk_bf16_f32 v201, v202, v203
    v_mfma_f32_16x16x32_bf16 v[184:187], v[78:81], v[180:183], v[184:187]
    v_cvt_pk_bf16_f32 v202, v220, v221
    v_cvt_pk_bf16_f32 v203, v222, v223
    v_mfma_f32_16x16x32_bf16 v[188:191], v[100:103], v[180:183], v[188:191]
    buffer_store_dwordx4 v[200:203], v245, s[20:23], s51 offen sc0 sc1
    v_mfma_f32_16x16x32_bf16 v[192:195], v[122:125], v[180:183], v[192:195]
    s_waitcnt lgkmcnt(2)
    v_rcp_f32 v197, v196
    v_mfma_f32_16x16x32_bf16 v[168:171], v[30:33], v[132:135], v[168:171]
    v_max3_f32 v249, v147, v148, v149
    v_mul_f32 v184, v184, v197
    v_mfma_f32_16x16x32_bf16 v[208:211], a[252:255], a[244:247], v[208:211]
    s_waitcnt lgkmcnt(0)
    ds_read_b128 a[252:255], v224 offset:128
    v_mul_f32 v185, v185, v197
    v_mfma_f32_16x16x32_bf16 v[172:175], v[6:9], v[132:135], v[172:175]
    v_cvt_pk_bf16_f32 v184, v184, v185
    v_mul_f32 v186, v186, v197
    v_mfma_f32_16x16x16_bf16 v[168:171], v[34:35], v[136:137], v[168:171]
    v_mul_f32 v187, v187, v197
    v_cvt_pk_bf16_f32 v185, v186, v187
    v_mfma_f32_16x16x32_bf16 v[204:207], v[252:255], a[244:247], v[204:207]
    ds_read_b128 v[252:255], v224 offset:192
    v_mul_f32 v188, v188, v197
    v_mfma_f32_16x16x16_bf16 v[172:175], v[10:11], v[136:137], v[172:175]
    v_mul_f32 v189, v189, v197
    v_cvt_pk_bf16_f32 v186, v188, v189
    v_mfma_f32_16x16x32_bf16 v[216:219], a[236:239], a[244:247], v[216:219]
    ds_read_b128 a[236:239], v224 offset:256
    v_mul_f32 v190, v190, v197
    v_mfma_f32_16x16x32_bf16 v[212:215], a[240:243], a[244:247], v[212:215]
    ds_read_b128 a[244:247], v224
    ds_read_b128 a[240:243], v224 offset:320
    v_mul_f32 v191, v191, v197
    v_cvt_pk_bf16_f32 v187, v190, v191
    v_mul_f32 v192, v192, v197
    v_mul_f32 v193, v193, v197
    v_cvt_pk_bf16_f32 v188, v192, v193
    v_mul_f32 v194, v194, v197
    v_mul_f32 v195, v195, v197
    v_cvt_pk_bf16_f32 v189, v194, v195
    ds_write_b128 v237, v[184:187]
    ds_write_b64 v238, v[188:189]
    v_cvt_pk_bf16_f32 v208, v208, v209
    v_cvt_pk_bf16_f32 v209, v210, v211
    v_cvt_pk_bf16_f32 v210, v204, v205
    v_cvt_pk_bf16_f32 v211, v206, v207
    buffer_store_dwordx4 v[208:211], v243, s[20:23], s51 offen sc0 sc1
    s_waitcnt lgkmcnt(3)
    v_mfma_f32_16x16x32_bf16 v[204:207], a[4:7], a[244:247], 0
    v_cvt_pk_bf16_f32 v216, v216, v217
    v_cvt_pk_bf16_f32 v217, v218, v219
    v_mfma_f32_16x16x32_bf16 v[204:207], a[16:19], a[248:251], v[204:207]
    v_cvt_pk_bf16_f32 v218, v212, v213
    v_cvt_pk_bf16_f32 v219, v214, v215
    v_mfma_f32_16x16x32_bf16 v[208:211], a[0:3], a[244:247], 0
    v_max3_f32 v248, v248, v150, v151
    v_max3_f32 v249, v249, v152, v153
    v_mfma_f32_16x16x32_bf16 v[208:211], a[12:15], a[248:251], v[208:211]
    v_max3_f32 v248, v248, v154, v155
    v_max3_f32 v249, v249, v156, v157
    v_mfma_f32_16x16x32_bf16 v[200:203], a[8:11], a[244:247], 0
    v_max3_f32 v248, v248, v158, v159
    v_max3_f32 v249, v249, v160, v161
    v_mfma_f32_16x16x32_bf16 v[200:203], a[20:23], a[248:251], v[200:203]
    v_max3_f32 v248, v248, v162, v163
    v_max3_f32 v249, v249, v164, v165
    v_mfma_f32_16x16x32_bf16 v[220:223], a[244:247], a[72:75], 0
    v_max3_f32 v248, v248, v166, v167
    v_max_f32 v248, v248, v249
    v_mfma_f32_16x16x32_bf16 v[220:223], a[248:251], a[84:87], v[220:223]
    v_mov_b32 v249, v248
    v_mfma_f32_16x16x32_bf16 v[212:215], a[244:247], a[80:83], 0
    v_mfma_f32_16x16x32_bf16 v[212:215], a[248:251], a[92:95], v[212:215]
    v_permlane16_swap_b32 v248, v249
    v_mfma_f32_16x16x32_bf16 v[208:211], a[24:27], a[252:255], v[208:211]
    v_max_f32 v248, v248, v249
    v_mov_b32 v249, v248
    v_mfma_f32_16x16x32_bf16 v[208:211], a[36:39], v[252:255], v[208:211]
    buffer_store_dwordx4 v[216:219], v244, s[20:23], s51 offen sc0 sc1
    v_mfma_f32_16x16x32_bf16 v[204:207], a[28:31], a[252:255], v[204:207]
    s_add_u32 s51, s51, s48
    v_permlane32_swap_b32 v248, v249
    v_mfma_f32_16x16x32_bf16 v[204:207], a[40:43], v[252:255], v[204:207]
    v_max_f32 v248, v248, v249
    v_mul_f32 v236, s37, v248
    v_mfma_f32_16x16x32_bf16 v[216:219], a[244:247], a[76:79], 0
    ds_read_b128 a[244:247], v224 offset:3072
    v_fma_f32 v144, v144, s37, -v236
    v_mfma_f32_16x16x32_bf16 v[216:219], a[248:251], a[88:91], v[216:219]
    ds_read_b128 a[248:251], v224 offset:3136
    v_fma_f32 v145, v145, s37, -v236
    v_mfma_f32_16x16x32_bf16 v[200:203], a[32:35], a[252:255], v[200:203]
    v_fma_f32 v146, v146, s37, -v236
    v_fma_f32 v147, v147, s37, -v236
    v_mfma_f32_16x16x32_bf16 v[200:203], a[44:47], v[252:255], v[200:203]
    v_exp_f32 v144, v144
    v_mfma_f32_16x16x32_bf16 v[220:223], a[252:255], a[96:99], v[220:223]
    v_exp_f32 v145, v145
    v_mfma_f32_16x16x32_bf16 v[220:223], v[252:255], a[108:111], v[220:223]
    v_exp_f32 v146, v146
    v_mfma_f32_16x16x32_bf16 v[216:219], a[252:255], a[100:103], v[216:219]
    v_exp_f32 v147, v147
    v_mfma_f32_16x16x32_bf16 v[216:219], v[252:255], a[112:115], v[216:219]
    v_cvt_pk_bf16_f32 v176, v144, v145
    v_cvt_pk_bf16_f32 v177, v146, v147
    v_mfma_f32_16x16x32_bf16 v[212:215], a[252:255], a[104:107], v[212:215]
    ds_read_b128 v[144:147], v228 offset:1280
    v_fma_f32 v148, v148, s37, -v236
    v_mfma_f32_16x16x32_bf16 v[212:215], v[252:255], a[116:119], v[212:215]
    ds_read_b128 a[252:255], v224 offset:3200
    v_fma_f32 v149, v149, s37, -v236
    v_mfma_f32_16x16x32_bf16 v[208:211], a[48:51], a[236:239], v[208:211]
    s_waitcnt lgkmcnt(2)
    ds_read_b128 v[252:255], v224 offset:3264
    v_fma_f32 v150, v150, s37, -v236
    v_mfma_f32_16x16x32_bf16 v[208:211], a[60:63], a[240:243], v[208:211]
    v_fma_f32 v151, v151, s37, -v236
    v_fma_f32 v152, v152, s37, -v236
    v_mfma_f32_16x16x32_bf16 v[204:207], a[52:55], a[236:239], v[204:207]
    v_exp_f32 v148, v148
    v_mfma_f32_16x16x32_bf16 v[204:207], a[64:67], a[240:243], v[204:207]
    v_exp_f32 v149, v149
    v_mfma_f32_16x16x32_bf16 v[200:203], a[56:59], a[236:239], v[200:203]
    v_exp_f32 v150, v150
    v_mfma_f32_16x16x32_bf16 v[200:203], a[68:71], a[240:243], v[200:203]
    s_waitcnt lgkmcnt(2)
    v_cvt_pk_bf16_f32 v0, v208, v209
    v_cvt_pk_bf16_f32 v1, v210, v211
    v_mfma_f32_16x16x32_bf16 v[144:147], v[12:15], v[132:135], v[144:147]
    v_exp_f32 v151, v151
    v_mfma_f32_16x16x32_bf16 v[220:223], a[236:239], a[120:123], v[220:223]
    v_cvt_pk_bf16_f32 v2, v204, v205
    v_cvt_pk_bf16_f32 v3, v206, v207
    v_mfma_f32_16x16x32_bf16 v[220:223], a[240:243], a[132:135], v[220:223]
    v_cvt_pk_bf16_f32 v4, v200, v201
    v_cvt_pk_bf16_f32 v5, v202, v203
    v_mfma_f32_16x16x16_bf16 v[144:147], v[16:17], v[136:137], v[144:147]
    v_cvt_pk_bf16_f32 v178, v148, v149
    v_cvt_pk_bf16_f32 v179, v150, v151
    v_mfma_f32_16x16x32_bf16 v[216:219], a[236:239], a[124:127], v[216:219]
    ds_read_b128 v[148:151], v229 offset:1280
    v_fma_f32 v153, v153, s37, -v236
    v_mfma_f32_16x16x32_bf16 v[216:219], a[240:243], a[136:139], v[216:219]
    v_cvt_pk_bf16_f32 v66, v220, v221
    v_cvt_pk_bf16_f32 v67, v222, v223
    v_mfma_f32_16x16x32_bf16 v[196:199], a[216:219], v[176:179], 0
    v_fma_f32 v154, v154, s37, -v236
    v_fma_f32 v155, v155, s37, -v236
    v_mfma_f32_16x16x32_bf16 v[184:187], v[68:71], v[176:179], 0
    v_exp_f32 v152, v152
    v_mfma_f32_16x16x32_bf16 v[188:191], v[90:93], v[176:179], 0
    v_cvt_pk_bf16_f32 v88, v216, v217
    v_cvt_pk_bf16_f32 v89, v218, v219
    v_mfma_f32_16x16x32_bf16 v[192:195], v[112:115], v[176:179], 0
    v_exp_f32 v153, v153
    v_mfma_f32_16x16x32_bf16 v[212:215], a[236:239], a[128:131], v[212:215]
    ds_read_b128 a[236:239], v224 offset:3328
    v_cvt_pk_bf16_f32 v180, v152, v153
    v_mfma_f32_16x16x32_bf16 v[212:215], a[240:243], a[140:143], v[212:215]
    s_waitcnt lgkmcnt(1)
    ds_read_b128 a[240:243], v224 offset:3392
    v_fma_f32 v156, v156, s37, -v236
    v_mfma_f32_16x16x32_bf16 v[148:151], v[36:39], v[132:135], v[148:151]
    v_exp_f32 v154, v154
    v_mfma_f32_16x16x32_bf16 v[208:211], a[0:3], a[244:247], 0
    v_exp_f32 v155, v155
    v_mfma_f32_16x16x32_bf16 v[208:211], a[12:15], a[248:251], v[208:211]
    v_cvt_pk_bf16_f32 v181, v154, v155
    v_cvt_pk_bf16_f32 v110, v212, v213
    v_mfma_f32_16x16x16_bf16 v[148:151], v[40:41], v[136:137], v[148:151]
    ds_read_b128 v[152:155], v229 offset:1920
    v_cvt_pk_bf16_f32 v111, v214, v215
    v_mfma_f32_16x16x32_bf16 v[204:207], a[4:7], a[244:247], 0
    v_fma_f32 v157, v157, s37, -v236
    v_fma_f32 v158, v158, s37, -v236
    v_mfma_f32_16x16x32_bf16 v[204:207], a[16:19], a[248:251], v[204:207]
    v_fma_f32 v159, v159, s37, -v236
    v_fma_f32 v160, v160, s37, -v236
    v_mfma_f32_16x16x32_bf16 v[200:203], a[8:11], a[244:247], 0
    v_exp_f32 v156, v156
    v_mfma_f32_16x16x32_bf16 v[200:203], a[20:23], a[248:251], v[200:203]
    v_exp_f32 v157, v157
    v_mfma_f32_16x16x32_bf16 v[220:223], a[244:247], a[72:75], 0
    v_exp_f32 v158, v158
    v_mfma_f32_16x16x32_bf16 v[220:223], a[248:251], a[84:87], v[220:223]
    v_exp_f32 v159, v159
    v_mfma_f32_16x16x32_bf16 v[216:219], a[244:247], a[76:79], 0
    v_cvt_pk_bf16_f32 v182, v156, v157
    v_cvt_pk_bf16_f32 v183, v158, v159
    v_mfma_f32_16x16x32_bf16 v[216:219], a[248:251], a[88:91], v[216:219]
    ds_read_b128 v[156:159], v228 offset:1920
    v_fma_f32 v161, v161, s37, -v236
    v_mfma_f32_16x16x32_bf16 v[196:199], a[216:219], v[180:183], v[196:199]
    v_fma_f32 v162, v162, s37, -v236
    v_fma_f32 v163, v163, s37, -v236
    v_mfma_f32_16x16x32_bf16 v[184:187], v[76:79], v[180:183], v[184:187]
    v_exp_f32 v160, v160
    v_mfma_f32_16x16x32_bf16 v[188:191], v[98:101], v[180:183], v[188:191]
    v_exp_f32 v161, v161
    v_mfma_f32_16x16x32_bf16 v[192:195], v[120:123], v[180:183], v[192:195]
    s_waitcnt lgkmcnt(1)
    v_exp_f32 v162, v162
    v_mfma_f32_16x16x32_bf16 v[152:155], v[42:45], v[132:135], v[152:155]
    v_exp_f32 v163, v163
    v_mfma_f32_16x16x32_bf16 v[212:215], a[244:247], a[80:83], 0
    ds_read_b128 a[244:247], v225 offset:42944
    v_cvt_pk_bf16_f32 v176, v160, v161
    v_mfma_f32_16x16x32_bf16 v[212:215], a[248:251], a[92:95], v[212:215]
    ds_read_b128 a[248:251], v225 offset:43008
    v_cvt_pk_bf16_f32 v177, v162, v163
    v_mfma_f32_16x16x16_bf16 v[152:155], v[46:47], v[136:137], v[152:155]
    s_waitcnt lgkmcnt(2)
    ds_read_b128 v[160:163], v228 offset:2560
    v_fma_f32 v164, v164, s37, -v236
    v_mfma_f32_16x16x32_bf16 v[156:159], v[18:21], v[132:135], v[156:159]
    v_fma_f32 v165, v165, s37, -v236
    v_fma_f32 v166, v166, s37, -v236
    v_mfma_f32_16x16x32_bf16 v[208:211], a[24:27], a[252:255], v[208:211]
    v_fma_f32 v167, v167, s37, -v236
    v_max3_f32 v248, v168, v169, v170
    v_mfma_f32_16x16x32_bf16 v[208:211], a[36:39], v[252:255], v[208:211]
    v_exp_f32 v164, v164
    v_mfma_f32_16x16x16_bf16 v[156:159], v[22:23], v[136:137], v[156:159]
    v_exp_f32 v165, v165
    v_mfma_f32_16x16x32_bf16 v[204:207], a[28:31], a[252:255], v[204:207]
    v_exp_f32 v166, v166
    v_mfma_f32_16x16x32_bf16 v[204:207], a[40:43], v[252:255], v[204:207]
    v_exp_f32 v167, v167
    v_mfma_f32_16x16x32_bf16 v[200:203], a[32:35], a[252:255], v[200:203]
    v_cvt_pk_bf16_f32 v178, v164, v165
    v_cvt_pk_bf16_f32 v179, v166, v167
    v_mfma_f32_16x16x32_bf16 v[200:203], a[44:47], v[252:255], v[200:203]
    ds_read_b128 v[164:167], v229 offset:2560
    v_max3_f32 v249, v171, v172, v173
    v_mfma_f32_16x16x32_bf16 v[196:199], a[216:219], v[176:179], v[196:199]
    v_max3_f32 v248, v248, v174, v175
    v_max3_f32 v249, v249, v144, v145
    v_mfma_f32_16x16x32_bf16 v[184:187], v[84:87], v[176:179], v[184:187]
    v_max3_f32 v248, v248, v146, v147
    v_max3_f32 v249, v249, v148, v149
    v_mfma_f32_16x16x32_bf16 v[188:191], v[106:109], v[176:179], v[188:191]
    v_max3_f32 v248, v248, v150, v151
    v_max3_f32 v249, v249, v152, v153
    v_mfma_f32_16x16x32_bf16 v[192:195], v[128:131], v[176:179], v[192:195]
    s_waitcnt lgkmcnt(1)
    v_rcp_f32 v197, v196
    v_mfma_f32_16x16x32_bf16 v[160:163], v[0:3], v[132:135], v[160:163]
    v_mul_f32 v184, v184, v197
    v_mul_f32 v185, v185, v197
    v_mfma_f32_16x16x32_bf16 v[220:223], a[252:255], a[96:99], v[220:223]
    v_cvt_pk_bf16_f32 v184, v184, v185
    v_mul_f32 v186, v186, v197
    v_mfma_f32_16x16x32_bf16 v[220:223], v[252:255], a[108:111], v[220:223]
    v_mul_f32 v187, v187, v197
    v_cvt_pk_bf16_f32 v185, v186, v187
    v_mfma_f32_16x16x16_bf16 v[160:163], v[4:5], v[136:137], v[160:163]
    v_mul_f32 v188, v188, v197
    v_mul_f32 v189, v189, v197
    v_mfma_f32_16x16x32_bf16 v[216:219], a[252:255], a[100:103], v[216:219]
    v_cvt_pk_bf16_f32 v186, v188, v189
    v_mul_f32 v190, v190, v197
    v_mfma_f32_16x16x32_bf16 v[216:219], v[252:255], a[112:115], v[216:219]
    v_mul_f32 v191, v191, v197
    v_cvt_pk_bf16_f32 v187, v190, v191
    v_mfma_f32_16x16x32_bf16 v[212:215], a[252:255], a[104:107], v[212:215]
    ds_read_b128 a[252:255], v225 offset:43072
    v_mul_f32 v192, v192, v197
    v_mfma_f32_16x16x32_bf16 v[212:215], v[252:255], a[116:119], v[212:215]
    ds_read_b128 v[252:255], v225 offset:43136
    v_mul_f32 v193, v193, v197
    v_mfma_f32_16x16x32_bf16 v[208:211], a[48:51], a[236:239], v[208:211]
    v_cvt_pk_bf16_f32 v188, v192, v193
    v_mul_f32 v194, v194, v197
    v_mfma_f32_16x16x32_bf16 v[208:211], a[60:63], a[240:243], v[208:211]
    v_mul_f32 v195, v195, v197
    v_cvt_pk_bf16_f32 v189, v194, v195
    v_mfma_f32_16x16x32_bf16 v[204:207], a[52:55], a[236:239], v[204:207]
    ds_write_b128 v237, v[184:187] offset:6144
    v_mfma_f32_16x16x32_bf16 v[204:207], a[64:67], a[240:243], v[204:207]
    ds_write_b64 v238, v[188:189] offset:6144
    v_mfma_f32_16x16x32_bf16 v[200:203], a[56:59], a[236:239], v[200:203]
    v_max3_f32 v248, v248, v154, v155
    v_cvt_pk_bf16_f32 v24, v208, v209
    v_mfma_f32_16x16x32_bf16 v[200:203], a[68:71], a[240:243], v[200:203]
    v_cvt_pk_bf16_f32 v25, v210, v211
    v_max3_f32 v249, v249, v156, v157
    v_mfma_f32_16x16x32_bf16 v[220:223], a[236:239], a[120:123], v[220:223]
    v_cvt_pk_bf16_f32 v26, v204, v205
    v_cvt_pk_bf16_f32 v27, v206, v207
    v_mfma_f32_16x16x32_bf16 v[220:223], a[240:243], a[132:135], v[220:223]
    s_waitcnt lgkmcnt(2)
    v_max3_f32 v248, v248, v158, v159
    v_max3_f32 v249, v249, v160, v161
    v_mfma_f32_16x16x32_bf16 v[164:167], v[24:27], v[132:135], v[164:167]
    v_cvt_pk_bf16_f32 v28, v200, v201
    v_cvt_pk_bf16_f32 v29, v202, v203
    v_mfma_f32_16x16x32_bf16 v[216:219], a[236:239], a[124:127], v[216:219]
    v_max3_f32 v248, v248, v162, v163
    v_mfma_f32_16x16x32_bf16 v[216:219], a[240:243], a[136:139], v[216:219]
    v_cvt_pk_bf16_f32 v68, v220, v221
    v_cvt_pk_bf16_f32 v69, v222, v223
    v_mfma_f32_16x16x16_bf16 v[164:167], v[28:29], v[136:137], v[164:167]
    v_mfma_f32_16x16x32_bf16 v[212:215], a[236:239], a[128:131], v[212:215]
    s_waitcnt vmcnt(3) lgkmcnt(0)
    ds_read_b128 a[236:239], v225 offset:43200
    v_mfma_f32_16x16x32_bf16 v[212:215], a[240:243], a[140:143], v[212:215]
    s_barrier
    ds_read_b128 a[240:243], v225 offset:43264
    v_cvt_pk_bf16_f32 v90, v216, v217
    v_mfma_f32_16x16x32_bf16 v[208:211], a[144:147], a[244:247], 0
    v_cvt_pk_bf16_f32 v91, v218, v219
    v_cndmask_b32 v225, v243, v245, vcc
    v_mfma_f32_16x16x32_bf16 v[208:211], a[156:159], a[248:251], v[208:211]
    v_max3_f32 v249, v249, v164, v165
    v_cvt_pk_bf16_f32 v112, v212, v213
    v_mfma_f32_16x16x32_bf16 v[204:207], a[148:151], a[244:247], 0
    v_cvt_pk_bf16_f32 v113, v214, v215
    v_max3_f32 v248, v248, v166, v167
    v_mfma_f32_16x16x32_bf16 v[204:207], a[160:163], a[248:251], v[204:207]
    v_max_f32 v248, v248, v249
    v_mov_b32 v249, v248
    v_mfma_f32_16x16x32_bf16 v[200:203], a[152:155], a[244:247], 0
    ds_read_b128 a[244:247], v226 offset:1152
    v_mfma_f32_16x16x32_bf16 v[200:203], a[164:167], a[248:251], v[200:203]
    ds_read_b128 a[248:251], v226 offset:1216
    v_mfma_f32_16x16x32_bf16 v[208:211], a[168:171], a[252:255], v[208:211]
    v_permlane16_swap_b32 v248, v249
    v_mfma_f32_16x16x32_bf16 v[208:211], a[180:183], v[252:255], v[208:211]
    v_max_f32 v248, v248, v249
    v_mov_b32 v249, v248
    v_mfma_f32_16x16x32_bf16 v[204:207], a[172:175], a[252:255], v[204:207]
    v_mfma_f32_16x16x32_bf16 v[204:207], a[184:187], v[252:255], v[204:207]
    v_permlane32_swap_b32 v248, v249
    v_mfma_f32_16x16x32_bf16 v[200:203], a[176:179], a[252:255], v[200:203]
    ds_read_b128 a[252:255], v226 offset:1280
    v_max_f32 v248, v248, v249
    v_mfma_f32_16x16x32_bf16 v[200:203], a[188:191], v[252:255], v[200:203]
    s_waitcnt lgkmcnt(3)
    ds_read_b128 v[252:255], v226 offset:1344
    v_mul_f32 v236, s37, v248
    v_mfma_f32_16x16x32_bf16 v[208:211], a[192:195], a[236:239], v[208:211]
    v_fma_f32 v168, v168, s37, -v236
    v_fma_f32 v169, v169, s37, -v236
    v_mfma_f32_16x16x32_bf16 v[208:211], a[204:207], a[240:243], v[208:211]
    v_fma_f32 v170, v170, s37, -v236
    v_fma_f32 v171, v171, s37, -v236
    v_mfma_f32_16x16x32_bf16 v[204:207], a[196:199], a[236:239], v[204:207]
    v_exp_f32 v168, v168
    v_mfma_f32_16x16x32_bf16 v[204:207], a[208:211], a[240:243], v[204:207]
    v_exp_f32 v169, v169
    v_mfma_f32_16x16x32_bf16 v[200:203], a[200:203], a[236:239], v[200:203]
    ds_read_b128 a[236:239], v226 offset:1408
    v_cvt_pk_bf16_f32 v138, v208, v209
    v_mfma_f32_16x16x32_bf16 v[200:203], a[212:215], a[240:243], v[200:203]
    s_waitcnt lgkmcnt(3)
    ds_read_b128 a[240:243], v226 offset:1472
    v_cvt_pk_bf16_f32 v139, v210, v211
    v_mfma_f32_16x16x32_bf16 v[220:223], a[144:147], a[244:247], 0
    v_cvt_pk_bf16_f32 v140, v204, v205
    v_cvt_pk_bf16_f32 v141, v206, v207
    v_mfma_f32_16x16x32_bf16 v[220:223], a[156:159], a[248:251], v[220:223]
    v_exp_f32 v170, v170
    v_mfma_f32_16x16x32_bf16 v[216:219], a[148:151], a[244:247], 0
    v_cvt_pk_bf16_f32 v142, v200, v201
    v_cvt_pk_bf16_f32 v143, v202, v203
    v_mfma_f32_16x16x32_bf16 v[216:219], a[160:163], a[248:251], v[216:219]
    v_exp_f32 v171, v171
    v_mfma_f32_16x16x32_bf16 v[212:215], a[152:155], a[244:247], 0
    ds_read_b128 a[244:247], v227 offset:6144
    v_cvt_pk_bf16_f32 v180, v168, v169
    v_mfma_f32_16x16x32_bf16 v[212:215], a[164:167], a[248:251], v[212:215]
    s_waitcnt lgkmcnt(3)
    ds_read_b128 a[248:251], v227 offset:6208
    v_cvt_pk_bf16_f32 v181, v170, v171
    v_mfma_f32_16x16x32_bf16 v[220:223], a[168:171], a[252:255], v[220:223]
    ds_read_b128 v[168:171], v230 offset:2560
    v_fma_f32 v172, v172, s37, -v236
    v_mfma_f32_16x16x32_bf16 v[220:223], a[180:183], v[252:255], v[220:223]
    v_fma_f32 v173, v173, s37, -v236
    v_fma_f32 v174, v174, s37, -v236
    v_mfma_f32_16x16x32_bf16 v[216:219], a[172:175], a[252:255], v[216:219]
    v_fma_f32 v175, v175, s37, -v236
    v_fma_f32 v144, v144, s37, -v236
    v_mfma_f32_16x16x32_bf16 v[216:219], a[184:187], v[252:255], v[216:219]
    v_exp_f32 v172, v172
    v_mfma_f32_16x16x32_bf16 v[212:215], a[176:179], a[252:255], v[212:215]
    ds_read_b128 a[252:255], v227 offset:6272
    v_fma_f32 v145, v145, s37, -v236
    v_mfma_f32_16x16x32_bf16 v[212:215], a[188:191], v[252:255], v[212:215]
    s_waitcnt lgkmcnt(4)
    ds_read_b128 v[252:255], v227 offset:6336
    v_fma_f32 v146, v146, s37, -v236
    v_mfma_f32_16x16x32_bf16 v[220:223], a[192:195], a[236:239], v[220:223]
    v_exp_f32 v173, v173
    v_mfma_f32_16x16x32_bf16 v[220:223], a[204:207], a[240:243], v[220:223]
    s_waitcnt lgkmcnt(2)
    v_exp_f32 v174, v174
    v_mfma_f32_16x16x32_bf16 v[168:171], v[24:27], v[138:141], v[168:171]
    v_exp_f32 v175, v175
    v_mfma_f32_16x16x32_bf16 v[216:219], a[196:199], a[236:239], v[216:219]
    v_cvt_pk_bf16_f32 v182, v172, v173
    v_cvt_pk_bf16_f32 v183, v174, v175
    v_mfma_f32_16x16x32_bf16 v[216:219], a[208:211], a[240:243], v[216:219]
    ds_read_b128 v[172:175], v230 offset:640
    v_cvt_pk_bf16_f32 v132, v220, v221
    v_mfma_f32_16x16x32_bf16 v[196:199], a[216:219], v[180:183], 0
    v_cvt_pk_bf16_f32 v133, v222, v223
    v_fma_f32 v147, v147, s37, -v236
    v_mfma_f32_16x16x32_bf16 v[184:187], v[70:73], v[180:183], 0
    v_exp_f32 v144, v144
    v_mfma_f32_16x16x32_bf16 v[188:191], v[92:95], v[180:183], 0
    v_cvt_pk_bf16_f32 v134, v216, v217
    v_cvt_pk_bf16_f32 v135, v218, v219
    v_mfma_f32_16x16x32_bf16 v[192:195], v[114:117], v[180:183], 0
    v_exp_f32 v145, v145
    v_mfma_f32_16x16x16_bf16 v[168:171], v[28:29], v[142:143], v[168:171]
    v_exp_f32 v146, v146
    v_mfma_f32_16x16x32_bf16 v[212:215], a[200:203], a[236:239], v[212:215]
    ds_read_b128 a[236:239], v227 offset:6400
    v_cvt_pk_bf16_f32 v176, v144, v145
    v_mfma_f32_16x16x32_bf16 v[212:215], a[212:215], a[240:243], v[212:215]
    s_waitcnt lgkmcnt(1)
    ds_read_b128 a[240:243], v227 offset:6464
    v_cndmask_b32 v227, v240, v239, vcc
    v_mfma_f32_16x16x32_bf16 v[172:175], v[30:33], v[138:141], v[172:175]
    v_exp_f32 v147, v147
    v_mfma_f32_16x16x32_bf16 v[208:211], a[0:3], a[244:247], 0
    v_cvt_pk_bf16_f32 v177, v146, v147
    v_fma_f32 v148, v148, s37, -v236
    v_mfma_f32_16x16x32_bf16 v[208:211], a[12:15], a[248:251], v[208:211]
    ds_read_b128 v[144:147], v230 offset:1280
    v_cvt_pk_bf16_f32 v136, v212, v213
    v_mfma_f32_16x16x16_bf16 v[172:175], v[34:35], v[142:143], v[172:175]
    v_cvt_pk_bf16_f32 v137, v214, v215
    v_fma_f32 v149, v149, s37, -v236
    v_mfma_f32_16x16x32_bf16 v[204:207], a[4:7], a[244:247], 0
    v_fma_f32 v150, v150, s37, -v236
    v_fma_f32 v151, v151, s37, -v236
    v_mfma_f32_16x16x32_bf16 v[204:207], a[16:19], a[248:251], v[204:207]
    v_exp_f32 v148, v148
    v_mfma_f32_16x16x32_bf16 v[200:203], a[8:11], a[244:247], 0
    v_exp_f32 v149, v149
    v_mfma_f32_16x16x32_bf16 v[200:203], a[20:23], a[248:251], v[200:203]
    v_exp_f32 v150, v150
    v_mfma_f32_16x16x32_bf16 v[220:223], a[244:247], a[72:75], 0
    v_exp_f32 v151, v151
    v_mfma_f32_16x16x32_bf16 v[220:223], a[248:251], a[84:87], v[220:223]
    s_waitcnt lgkmcnt(0)
    v_cvt_pk_bf16_f32 v178, v148, v149
    v_cvt_pk_bf16_f32 v179, v150, v151
    v_mfma_f32_16x16x32_bf16 v[144:147], v[36:39], v[138:141], v[144:147]
    ds_read_b128 v[148:151], v230 offset:1920
    v_fma_f32 v152, v152, s37, -v236
    v_mfma_f32_16x16x32_bf16 v[196:199], a[216:219], v[176:179], v[196:199]
    v_fma_f32 v153, v153, s37, -v236
    v_fma_f32 v154, v154, s37, -v236
    v_mfma_f32_16x16x32_bf16 v[184:187], v[74:77], v[176:179], v[184:187]
    v_fma_f32 v155, v155, s37, -v236
    v_fma_f32 v156, v156, s37, -v236
    v_mfma_f32_16x16x32_bf16 v[188:191], v[96:99], v[176:179], v[188:191]
    v_exp_f32 v152, v152
    v_mfma_f32_16x16x32_bf16 v[192:195], v[118:121], v[176:179], v[192:195]
    v_exp_f32 v153, v153
    v_mfma_f32_16x16x16_bf16 v[144:147], v[40:41], v[142:143], v[144:147]
    v_exp_f32 v154, v154
    v_mfma_f32_16x16x32_bf16 v[216:219], a[244:247], a[76:79], 0
    v_exp_f32 v155, v155
    v_mfma_f32_16x16x32_bf16 v[216:219], a[248:251], a[88:91], v[216:219]
    s_waitcnt lgkmcnt(0)
    v_cvt_pk_bf16_f32 v180, v152, v153
    v_cvt_pk_bf16_f32 v181, v154, v155
    v_mfma_f32_16x16x32_bf16 v[148:151], v[42:45], v[138:141], v[148:151]
    ds_read_b128 v[152:155], v235
    v_bfe_u32 v235, s68, v233, 4
    v_mfma_f32_16x16x32_bf16 v[212:215], a[244:247], a[80:83], 0
    ds_read_b128 a[244:247], v239
    v_mad_u32_u24 v235, v235, s40, v231
    v_mfma_f32_16x16x32_bf16 v[212:215], a[248:251], a[92:95], v[212:215]
    ds_read_b128 a[248:251], v240
    v_fma_f32 v157, v157, s37, -v236
    v_mfma_f32_16x16x16_bf16 v[148:151], v[46:47], v[142:143], v[148:151]
    v_fma_f32 v158, v158, s37, -v236
    v_fma_f32 v159, v159, s37, -v236
    v_mfma_f32_16x16x32_bf16 v[208:211], a[24:27], a[252:255], v[208:211]
    v_exp_f32 v156, v156
    v_mfma_f32_16x16x32_bf16 v[208:211], a[36:39], v[252:255], v[208:211]
    v_exp_f32 v157, v157
    v_mfma_f32_16x16x32_bf16 v[204:207], a[28:31], a[252:255], v[204:207]
    v_exp_f32 v158, v158
    v_mfma_f32_16x16x32_bf16 v[204:207], a[40:43], v[252:255], v[204:207]
    s_waitcnt lgkmcnt(2)
    v_exp_f32 v159, v159
    v_mfma_f32_16x16x32_bf16 v[152:155], v[48:51], v[138:141], v[152:155]
    v_cvt_pk_bf16_f32 v182, v156, v157
    v_cvt_pk_bf16_f32 v183, v158, v159
    v_mfma_f32_16x16x32_bf16 v[200:203], a[32:35], a[252:255], v[200:203]
    ds_read_b128 v[156:159], v250
    v_fma_f32 v160, v160, s37, -v236
    v_mfma_f32_16x16x32_bf16 v[200:203], a[44:47], v[252:255], v[200:203]
    v_fma_f32 v161, v161, s37, -v236
    v_fma_f32 v162, v162, s37, -v236
    v_mfma_f32_16x16x32_bf16 v[196:199], a[216:219], v[180:183], v[196:199]
    v_fma_f32 v163, v163, s37, -v236
    v_fma_f32 v164, v164, s37, -v236
    v_mfma_f32_16x16x32_bf16 v[184:187], v[78:81], v[180:183], v[184:187]
    v_exp_f32 v160, v160
    v_mfma_f32_16x16x32_bf16 v[188:191], v[100:103], v[180:183], v[188:191]
    v_exp_f32 v161, v161
    v_mfma_f32_16x16x32_bf16 v[192:195], v[122:125], v[180:183], v[192:195]
    v_exp_f32 v162, v162
    v_mfma_f32_16x16x16_bf16 v[152:155], v[52:53], v[142:143], v[152:155]
    v_exp_f32 v163, v163
    v_mfma_f32_16x16x32_bf16 v[220:223], a[252:255], a[96:99], v[220:223]
    v_cvt_pk_bf16_f32 v176, v160, v161
    v_cvt_pk_bf16_f32 v177, v162, v163
    v_mfma_f32_16x16x32_bf16 v[220:223], v[252:255], a[108:111], v[220:223]
    ds_read_b128 v[160:163], v228 offset:640
    v_fma_f32 v165, v165, s37, -v236
    v_mfma_f32_16x16x32_bf16 v[216:219], a[252:255], a[100:103], v[216:219]
    v_fma_f32 v166, v166, s37, -v236
    v_fma_f32 v167, v167, s37, -v236
    v_mfma_f32_16x16x32_bf16 v[216:219], v[252:255], a[112:115], v[216:219]
    v_exp_f32 v164, v164
    v_mfma_f32_16x16x32_bf16 v[212:215], a[252:255], a[104:107], v[212:215]
    ds_read_b128 a[252:255], v239 offset:1024
    v_max3_f32 v248, v168, v169, v170
    v_mfma_f32_16x16x32_bf16 v[212:215], v[252:255], a[116:119], v[212:215]
    ds_read_b128 v[252:255], v240 offset:1024
    v_max3_f32 v249, v171, v172, v173
    v_mfma_f32_16x16x32_bf16 v[208:211], a[48:51], a[236:239], v[208:211]
    v_exp_f32 v165, v165
    v_mfma_f32_16x16x32_bf16 v[208:211], a[60:63], a[240:243], v[208:211]
    v_exp_f32 v166, v166
    v_mfma_f32_16x16x32_bf16 v[204:207], a[52:55], a[236:239], v[204:207]
    v_exp_f32 v167, v167
    v_mfma_f32_16x16x32_bf16 v[204:207], a[64:67], a[240:243], v[204:207]
    s_waitcnt lgkmcnt(2)
    v_cvt_pk_bf16_f32 v178, v164, v165
    v_cvt_pk_bf16_f32 v179, v166, v167
    v_mfma_f32_16x16x32_bf16 v[160:163], v[12:15], v[132:135], v[160:163]
    ds_read_b128 v[164:167], v229 offset:640
    v_cvt_pk_bf16_f32 v54, v208, v209
    v_mfma_f32_16x16x32_bf16 v[196:199], a[216:219], v[176:179], v[196:199]
    v_cvt_pk_bf16_f32 v55, v210, v211
    v_cndmask_b32 v60, v60, v54, s[82:83]
    v_mfma_f32_16x16x32_bf16 v[184:187], v[66:69], v[176:179], v[184:187]
    v_cndmask_b32 v61, v61, v55, s[82:83]
    v_cvt_pk_bf16_f32 v56, v204, v205
    v_mfma_f32_16x16x32_bf16 v[188:191], v[88:91], v[176:179], v[188:191]
    v_cvt_pk_bf16_f32 v57, v206, v207
    v_cndmask_b32 v62, v62, v56, s[82:83]
    v_mfma_f32_16x16x32_bf16 v[192:195], v[110:113], v[176:179], v[192:195]
    v_cndmask_b32 v63, v63, v57, s[82:83]
    v_max3_f32 v248, v248, v174, v175
    v_mfma_f32_16x16x16_bf16 v[160:163], v[16:17], v[136:137], v[160:163]
    v_rcp_f32 v197, v196
    v_mfma_f32_16x16x32_bf16 v[156:159], v[60:63], v[138:141], v[156:159]
    v_mul_f32 v184, v184, v197
    v_mul_f32 v185, v185, v197
    v_mfma_f32_16x16x32_bf16 v[200:203], a[56:59], a[236:239], v[200:203]
    v_cvt_pk_bf16_f32 v184, v184, v185
    v_mul_f32 v186, v186, v197
    v_mfma_f32_16x16x32_bf16 v[200:203], a[68:71], a[240:243], v[200:203]
    s_waitcnt lgkmcnt(0)
    v_mul_f32 v187, v187, v197
    v_cvt_pk_bf16_f32 v185, v186, v187
    v_mfma_f32_16x16x32_bf16 v[164:167], v[36:39], v[132:135], v[164:167]
    v_mul_f32 v188, v188, v197
    v_mul_f32 v189, v189, v197
    v_mfma_f32_16x16x32_bf16 v[220:223], a[236:239], a[120:123], v[220:223]
    v_cvt_pk_bf16_f32 v186, v188, v189
    v_mul_f32 v190, v190, v197
    v_mfma_f32_16x16x32_bf16 v[220:223], a[240:243], a[132:135], v[220:223]
    v_cvt_pk_bf16_f32 v58, v200, v201
    v_cvt_pk_bf16_f32 v59, v202, v203
    v_mfma_f32_16x16x16_bf16 v[164:167], v[40:41], v[136:137], v[164:167]
    v_cndmask_b32 v64, v64, v58, s[82:83]
    v_cndmask_b32 v65, v65, v59, s[82:83]
    v_mfma_f32_16x16x32_bf16 v[216:219], a[236:239], a[124:127], v[216:219]
    v_mul_f32 v191, v191, v197
    v_cvt_pk_bf16_f32 v187, v190, v191
    v_mfma_f32_16x16x32_bf16 v[216:219], a[240:243], a[136:139], v[216:219]
    v_cvt_pk_bf16_f32 v82, v220, v221
    v_cvt_pk_bf16_f32 v83, v222, v223
    v_mfma_f32_16x16x16_bf16 v[156:159], v[64:65], v[142:143], v[156:159]
    v_cndmask_b32 v86, v86, v82, s[84:85]
    v_cndmask_b32 v87, v87, v83, s[84:85]
    v_mfma_f32_16x16x32_bf16 v[212:215], a[236:239], a[128:131], v[212:215]
    ds_read_b128 a[236:239], v241 offset:12288
    v_mul_f32 v192, v192, v197
    v_mfma_f32_16x16x32_bf16 v[212:215], a[240:243], a[140:143], v[212:215]
    v_cvt_pk_bf16_f32 v104, v216, v217
    v_cvt_pk_bf16_f32 v105, v218, v219
    v_mfma_f32_16x16x32_bf16 v[208:211], a[220:223], a[244:247], 0
    v_cndmask_b32 v108, v108, v104, s[84:85]
    v_cndmask_b32 v109, v109, v105, s[84:85]
    v_mfma_f32_16x16x32_bf16 v[200:203], a[220:223], a[248:251], 0
    ds_read_b128 a[240:243], v241 offset:12800
    v_mul_f32 v193, v193, v197
    v_mfma_f32_16x16x32_bf16 v[204:207], a[224:227], a[244:247], 0
    v_cvt_pk_bf16_f32 v126, v212, v213
    v_cvt_pk_bf16_f32 v127, v214, v215
    v_mfma_f32_16x16x32_bf16 v[220:223], a[224:227], a[248:251], 0
    v_cndmask_b32 v130, v130, v126, s[84:85]
    v_cndmask_b32 v131, v131, v127, s[84:85]
    v_mfma_f32_16x16x32_bf16 v[216:219], a[228:231], a[244:247], 0
    ds_read_b128 a[248:251], v242 offset:12800
    v_cvt_pk_bf16_f32 v188, v192, v193
    v_mfma_f32_16x16x32_bf16 v[212:215], a[232:235], a[244:247], 0
    s_waitcnt lgkmcnt(2)
    ds_read_b128 a[244:247], v242 offset:12288
    v_mul_f32 v194, v194, v197
    v_mfma_f32_16x16x32_bf16 v[208:211], a[236:239], a[252:255], v[208:211]
    v_mul_f32 v195, v195, v197
    v_cvt_pk_bf16_f32 v189, v194, v195
    v_mfma_f32_16x16x32_bf16 v[200:203], a[236:239], v[252:255], v[200:203]
    s_waitcnt lgkmcnt(2)
    ds_read_b128 a[236:239], v241 offset:24576
    v_max3_f32 v249, v249, v144, v145
    v_mfma_f32_16x16x32_bf16 v[204:207], a[240:243], a[252:255], v[204:207]
    ds_write_b128 v237, v[184:187] offset:12288
    v_mfma_f32_16x16x32_bf16 v[220:223], a[240:243], v[252:255], v[220:223]
    s_waitcnt lgkmcnt(3)
    ds_write_b64 v238, v[188:189] offset:12288
    v_mfma_f32_16x16x32_bf16 v[212:215], a[248:251], a[252:255], v[212:215]
    s_waitcnt lgkmcnt(3)
    v_max3_f32 v248, v248, v146, v147
    v_max3_f32 v249, v249, v148, v149
    v_mfma_f32_16x16x32_bf16 v[216:219], a[244:247], a[252:255], v[216:219]
    v_max3_f32 v248, v248, v150, v151
    v_max3_f32 v249, v249, v152, v153
    v_max3_f32 v248, v248, v154, v155
    v_max3_f32 v249, v249, v156, v157
    v_max3_f32 v248, v248, v158, v159
    v_max_f32 v248, v248, v249
    v_mov_b32 v249, v248
    s_nop 1
    ds_read_b128 a[252:255], v239 offset:2048
    ds_read_b128 v[252:255], v240 offset:2048
    v_permlane16_swap_b32 v248, v249
    ds_read_b128 a[240:243], v241 offset:25088
    v_max_f32 v248, v248, v249
    ds_read_b128 a[244:247], v242 offset:24576
    v_mov_b32 v249, v248
    ds_read_b128 a[248:251], v242 offset:25088
    s_nop 0
    v_permlane32_swap_b32 v248, v249
    v_max_f32 v248, v248, v249
    v_mul_f32 v236, s37, v248
    v_fma_f32 v168, v168, s37, -v236
    v_fma_f32 v169, v169, s37, -v236
    v_fma_f32 v170, v170, s37, -v236
    v_fma_f32 v171, v171, s37, -v236
    v_exp_f32 v168, v168
    s_waitcnt lgkmcnt(4)
    v_mfma_f32_16x16x32_bf16 v[208:211], a[236:239], a[252:255], v[208:211]
    s_waitcnt lgkmcnt(3)
    v_exp_f32 v169, v169
    v_mfma_f32_16x16x32_bf16 v[200:203], a[236:239], v[252:255], v[200:203]
    s_waitcnt lgkmcnt(2)
    ds_read_b128 a[236:239], v241 offset:36864
    v_cvt_pk_bf16_f32 v180, v168, v169
    v_mfma_f32_16x16x32_bf16 v[204:207], a[240:243], a[252:255], v[204:207]
    v_exp_f32 v170, v170
    v_mfma_f32_16x16x32_bf16 v[220:223], a[240:243], v[252:255], v[220:223]
    s_waitcnt lgkmcnt(2)
    ds_read_b128 v[252:255], v240 offset:3072
    ds_read_b128 a[240:243], v241 offset:37376
    v_mfma_f32_16x16x32_bf16 v[216:219], a[244:247], a[252:255], v[216:219]
    s_waitcnt lgkmcnt(3)
    ds_read_b128 a[244:247], v242 offset:36864
    v_fma_f32 v172, v172, s37, -v236
    v_mfma_f32_16x16x32_bf16 v[212:215], a[248:251], a[252:255], v[212:215]
    s_waitcnt lgkmcnt(2)
    ds_read_b128 a[252:255], v239 offset:3072
    v_exp_f32 v171, v171
    v_fma_f32 v173, v173, s37, -v236
    ds_read_b128 a[248:251], v242 offset:37376
    v_cvt_pk_bf16_f32 v181, v170, v171
    ds_read_b128 v[168:171], v229 offset:1280
    v_fma_f32 v174, v174, s37, -v236
    v_fma_f32 v175, v175, s37, -v236
    v_exp_f32 v172, v172
    v_exp_f32 v173, v173
    v_exp_f32 v174, v174
    v_mfma_f32_16x16x32_bf16 v[200:203], a[236:239], v[252:255], v[200:203]
    s_waitcnt lgkmcnt(4)
    v_exp_f32 v175, v175
    v_mfma_f32_16x16x32_bf16 v[220:223], a[240:243], v[252:255], v[220:223]
    s_waitcnt lgkmcnt(2)
    ds_read_b128 v[252:255], v240 offset:4096
    v_cvt_pk_bf16_f32 v182, v172, v173
    v_cvt_pk_bf16_f32 v183, v174, v175
    ds_read_b128 v[172:175], v228 offset:1280
    v_mfma_f32_16x16x32_bf16 v[208:211], a[236:239], a[252:255], v[208:211]
    ds_read_b128 a[236:239], v241 offset:49152
    v_fma_f32 v144, v144, s37, -v236
    v_mfma_f32_16x16x32_bf16 v[196:199], a[216:219], v[180:183], 0
    v_fma_f32 v145, v145, s37, -v236
    v_fma_f32 v146, v146, s37, -v236
    v_mfma_f32_16x16x32_bf16 v[184:187], v[68:71], v[180:183], 0
    v_fma_f32 v147, v147, s37, -v236
    v_fma_f32 v148, v148, s37, -v236
    v_mfma_f32_16x16x32_bf16 v[188:191], v[90:93], v[180:183], 0
    v_exp_f32 v144, v144
    v_mfma_f32_16x16x32_bf16 v[192:195], v[112:115], v[180:183], 0
    s_waitcnt lgkmcnt(3)
    v_exp_f32 v145, v145
    v_mfma_f32_16x16x32_bf16 v[168:171], v[42:45], v[132:135], v[168:171]
    v_exp_f32 v146, v146
    v_mfma_f32_16x16x32_bf16 v[204:207], a[240:243], a[252:255], v[204:207]
    s_waitcnt lgkmcnt(1)
    ds_read_b128 a[240:243], v241 offset:49664
    v_cvt_pk_bf16_f32 v176, v144, v145
    v_mfma_f32_16x16x32_bf16 v[172:175], v[18:21], v[132:135], v[172:175]
    v_exp_f32 v147, v147
    v_mfma_f32_16x16x16_bf16 v[168:171], v[46:47], v[136:137], v[168:171]
    v_cvt_pk_bf16_f32 v177, v146, v147
    v_fma_f32 v149, v149, s37, -v236
    v_mfma_f32_16x16x32_bf16 v[216:219], a[244:247], a[252:255], v[216:219]
    ds_read_b128 v[144:147], v228 offset:1920
    v_fma_f32 v150, v150, s37, -v236
    v_mfma_f32_16x16x16_bf16 v[172:175], v[22:23], v[136:137], v[172:175]
    ds_read_b128 a[244:247], v242 offset:49152
    v_fma_f32 v151, v151, s37, -v236
    v_mfma_f32_16x16x32_bf16 v[212:215], a[248:251], a[252:255], v[212:215]
    s_waitcnt lgkmcnt(3)
    ds_read_b128 a[252:255], v239 offset:4096
    v_fma_f32 v152, v152, s37, -v236
    v_mfma_f32_16x16x32_bf16 v[200:203], a[236:239], v[252:255], v[200:203]
    s_waitcnt lgkmcnt(3)
    ds_read_b128 a[248:251], v242 offset:49664
    v_fma_f32 v153, v153, s37, -v236
    v_mfma_f32_16x16x32_bf16 v[220:223], a[240:243], v[252:255], v[220:223]
    s_waitcnt lgkmcnt(3)
    ds_read_b128 v[252:255], v240 offset:5120
    v_exp_f32 v148, v148
    v_exp_f32 v149, v149
    v_exp_f32 v150, v150
    v_exp_f32 v151, v151
    v_cvt_pk_bf16_f32 v178, v148, v149
    v_cvt_pk_bf16_f32 v179, v150, v151
    ds_read_b128 v[148:151], v229 offset:1920
    v_mfma_f32_16x16x32_bf16 v[144:147], v[0:3], v[132:135], v[144:147]
    v_fma_f32 v154, v154, s37, -v236
    v_fma_f32 v155, v155, s37, -v236
    v_mfma_f32_16x16x32_bf16 v[196:199], a[216:219], v[176:179], v[196:199]
    v_exp_f32 v152, v152
    v_mfma_f32_16x16x32_bf16 v[184:187], v[76:79], v[176:179], v[184:187]
    v_exp_f32 v153, v153
    v_mfma_f32_16x16x32_bf16 v[188:191], v[98:101], v[176:179], v[188:191]
    v_exp_f32 v154, v154
    v_mfma_f32_16x16x32_bf16 v[192:195], v[120:123], v[176:179], v[192:195]
    v_exp_f32 v155, v155
    v_mfma_f32_16x16x16_bf16 v[144:147], v[4:5], v[136:137], v[144:147]
    s_waitcnt lgkmcnt(1)
    v_cvt_pk_bf16_f32 v180, v152, v153
    v_cvt_pk_bf16_f32 v181, v154, v155
    v_mfma_f32_16x16x32_bf16 v[208:211], a[236:239], a[252:255], v[208:211]
    s_waitcnt lgkmcnt(0)
    ds_read_b128 v[152:155], v229 offset:2560
    v_fma_f32 v156, v156, s37, -v236
    v_mfma_f32_16x16x32_bf16 v[148:151], v[24:27], v[132:135], v[148:151]
    ds_read_b128 a[236:239], v241 offset:61440
    v_fma_f32 v157, v157, s37, -v236
    v_mfma_f32_16x16x32_bf16 v[204:207], a[240:243], a[252:255], v[204:207]
    ds_read_b128 a[240:243], v241 offset:61952
    v_fma_f32 v158, v158, s37, -v236
    v_mfma_f32_16x16x32_bf16 v[216:219], a[244:247], a[252:255], v[216:219]
    ds_read_b128 a[244:247], v242 offset:61440
    v_fma_f32 v159, v159, s37, -v236
    v_mfma_f32_16x16x16_bf16 v[148:151], v[28:29], v[136:137], v[148:151]
    v_exp_f32 v156, v156
    v_mfma_f32_16x16x32_bf16 v[212:215], a[248:251], a[252:255], v[212:215]
    s_waitcnt lgkmcnt(2)
    ds_read_b128 a[252:255], v239 offset:5120
    ds_read_b128 a[248:251], v242 offset:61952
    v_exp_f32 v157, v157
    v_exp_f32 v158, v158
    v_exp_f32 v159, v159
    v_cvt_pk_bf16_f32 v182, v156, v157
    v_cvt_pk_bf16_f32 v183, v158, v159
    ds_read_b128 v[156:159], v228 offset:2560
    v_mfma_f32_16x16x32_bf16 v[200:203], a[236:239], v[252:255], v[200:203]
    v_max3_f32 v248, v160, v161, v162
    v_max3_f32 v249, v163, v164, v165
    v_mfma_f32_16x16x32_bf16 v[196:199], a[216:219], v[180:183], v[196:199]
    v_max3_f32 v248, v248, v166, v167
    v_max3_f32 v249, v249, v168, v169
    v_mfma_f32_16x16x32_bf16 v[184:187], v[84:87], v[180:183], v[184:187]
    v_max3_f32 v248, v248, v170, v171
    v_max3_f32 v249, v249, v172, v173
    v_mfma_f32_16x16x32_bf16 v[188:191], v[106:109], v[180:183], v[188:191]
    v_cvt_pk_bf16_f32 v200, v200, v201
    v_cvt_pk_bf16_f32 v201, v202, v203
    v_mfma_f32_16x16x32_bf16 v[192:195], v[128:131], v[180:183], v[192:195]
    s_waitcnt lgkmcnt(2)
    v_rcp_f32 v197, v196
    v_mfma_f32_16x16x32_bf16 v[208:211], a[236:239], a[252:255], v[208:211]
    ds_read_b128 a[236:239], v224 offset:15616
    v_mul_f32 v184, v184, v197
    v_mfma_f32_16x16x32_bf16 v[204:207], a[240:243], a[252:255], v[204:207]
    v_mul_f32 v185, v185, v197
    v_cvt_pk_bf16_f32 v184, v184, v185
    v_mfma_f32_16x16x32_bf16 v[220:223], a[240:243], v[252:255], v[220:223]
    ds_read_b128 v[252:255], v224 offset:15552
    ds_read_b128 a[240:243], v224 offset:15680
    v_mfma_f32_16x16x32_bf16 v[216:219], a[244:247], a[252:255], v[216:219]
    s_waitcnt lgkmcnt(3)
    ds_read_b128 a[244:247], v224 offset:15744
    v_mul_f32 v186, v186, v197
    v_mfma_f32_16x16x32_bf16 v[212:215], a[248:251], a[252:255], v[212:215]
    ds_read_b128 a[252:255], v224 offset:15488
    v_mul_f32 v187, v187, v197
    v_cvt_pk_bf16_f32 v185, v186, v187
    v_mul_f32 v188, v188, v197
    ds_read_b128 a[248:251], v224 offset:15808
    v_mul_f32 v189, v189, v197
    v_cvt_pk_bf16_f32 v186, v188, v189
    v_mul_f32 v190, v190, v197
    v_mul_f32 v191, v191, v197
    v_cvt_pk_bf16_f32 v187, v190, v191
    v_mul_f32 v192, v192, v197
    v_mul_f32 v193, v193, v197
    v_cvt_pk_bf16_f32 v188, v192, v193
    v_mul_f32 v194, v194, v197
    v_mul_f32 v195, v195, v197
    v_cvt_pk_bf16_f32 v189, v194, v195
    ds_write_b128 v237, v[184:187] offset:18432
    ds_write_b64 v238, v[188:189] offset:18432
    v_cvt_pk_bf16_f32 v208, v208, v209
    v_cvt_pk_bf16_f32 v209, v210, v211
    v_cvt_pk_bf16_f32 v210, v204, v205
    v_cvt_pk_bf16_f32 v211, v206, v207
    s_waitcnt lgkmcnt(3)
    v_mfma_f32_16x16x32_bf16 v[204:207], a[4:7], a[252:255], 0
    buffer_store_dwordx4 v[208:211], v243, s[20:23], s51 offen sc0 sc1
    v_mfma_f32_16x16x32_bf16 v[204:207], a[16:19], v[252:255], v[204:207]
    v_cvt_pk_bf16_f32 v202, v220, v221
    v_cvt_pk_bf16_f32 v203, v222, v223
    v_mfma_f32_16x16x32_bf16 v[208:211], a[0:3], a[252:255], 0
    v_cvt_pk_bf16_f32 v216, v216, v217
    v_cvt_pk_bf16_f32 v217, v218, v219
    v_mfma_f32_16x16x32_bf16 v[208:211], a[12:15], v[252:255], v[208:211]
    v_cvt_pk_bf16_f32 v218, v212, v213
    v_cvt_pk_bf16_f32 v219, v214, v215
    v_mfma_f32_16x16x32_bf16 v[220:223], a[252:255], a[72:75], 0
    v_max3_f32 v248, v248, v174, v175
    v_max3_f32 v249, v249, v144, v145
    v_mfma_f32_16x16x32_bf16 v[220:223], v[252:255], a[84:87], v[220:223]
    v_max3_f32 v248, v248, v146, v147
    v_max3_f32 v249, v249, v148, v149
    v_mfma_f32_16x16x32_bf16 v[212:215], a[252:255], a[80:83], 0
    v_max3_f32 v248, v248, v150, v151
    v_mfma_f32_16x16x32_bf16 v[212:215], v[252:255], a[92:95], v[212:215]
    s_waitcnt lgkmcnt(0)
    v_mfma_f32_16x16x32_bf16 v[208:211], a[24:27], a[236:239], v[208:211]
    s_barrier
    v_mfma_f32_16x16x32_bf16 v[208:211], a[36:39], a[240:243], v[208:211]
    v_mfma_f32_16x16x32_bf16 v[204:207], a[28:31], a[236:239], v[204:207]
    v_mfma_f32_16x16x32_bf16 v[204:207], a[40:43], a[240:243], v[204:207]
    v_mfma_f32_16x16x32_bf16 v[220:223], a[236:239], a[96:99], v[220:223]
    buffer_store_dwordx4 v[200:203], v245, s[20:23], s51 offen sc0 sc1
    v_mfma_f32_16x16x32_bf16 v[220:223], a[240:243], a[108:111], v[220:223]
    v_mfma_f32_16x16x32_bf16 v[212:215], a[236:239], a[104:107], v[212:215]
    v_mfma_f32_16x16x32_bf16 v[212:215], a[240:243], a[116:119], v[212:215]
    v_mfma_f32_16x16x32_bf16 v[200:203], a[8:11], a[252:255], 0
    v_mfma_f32_16x16x32_bf16 v[200:203], a[20:23], v[252:255], v[200:203]
    v_mfma_f32_16x16x32_bf16 v[200:203], a[32:35], a[236:239], v[200:203]
    v_mfma_f32_16x16x32_bf16 v[200:203], a[44:47], a[240:243], v[200:203]
    v_mfma_f32_16x16x32_bf16 v[208:211], a[48:51], a[244:247], v[208:211]
    v_mfma_f32_16x16x32_bf16 v[208:211], a[60:63], a[248:251], v[208:211]
    v_mfma_f32_16x16x32_bf16 v[204:207], a[52:55], a[244:247], v[204:207]
    v_mfma_f32_16x16x32_bf16 v[204:207], a[64:67], a[248:251], v[204:207]
    v_mfma_f32_16x16x32_bf16 v[200:203], a[56:59], a[244:247], v[200:203]
    buffer_store_dwordx4 v[216:219], v244, s[20:23], s51 offen sc0 sc1
    v_mfma_f32_16x16x32_bf16 v[200:203], a[68:71], a[248:251], v[200:203]
    s_add_u32 s51, s51, s48
    v_mfma_f32_16x16x32_bf16 v[216:219], a[252:255], a[76:79], 0
    ds_read_b128 a[252:255], v224 offset:18560
    v_cvt_pk_bf16_f32 v6, v208, v209
    v_mfma_f32_16x16x32_bf16 v[216:219], v[252:255], a[88:91], v[216:219]
    v_cvt_pk_bf16_f32 v7, v210, v211
    v_cvt_pk_bf16_f32 v8, v204, v205
    v_mfma_f32_16x16x32_bf16 v[216:219], a[236:239], a[100:103], v[216:219]
    v_cvt_pk_bf16_f32 v9, v206, v207
    v_cvt_pk_bf16_f32 v10, v200, v201
    v_mfma_f32_16x16x32_bf16 v[216:219], a[240:243], a[112:115], v[216:219]
    ds_read_b128 v[252:255], v224 offset:18624
    v_cvt_pk_bf16_f32 v11, v202, v203
    v_mfma_f32_16x16x32_bf16 v[156:159], v[6:9], v[132:135], v[156:159]
    ds_read_b128 a[236:239], v224 offset:18688
    ds_read_b128 a[240:243], v224 offset:18752
    v_mfma_f32_16x16x32_bf16 v[220:223], a[244:247], a[120:123], v[220:223]
    v_mfma_f32_16x16x32_bf16 v[220:223], a[248:251], a[132:135], v[220:223]
    v_mfma_f32_16x16x32_bf16 v[216:219], a[244:247], a[124:127], v[216:219]
    v_mfma_f32_16x16x32_bf16 v[216:219], a[248:251], a[136:139], v[216:219]
    v_mfma_f32_16x16x16_bf16 v[156:159], v[10:11], v[136:137], v[156:159]
    v_mfma_f32_16x16x32_bf16 v[212:215], a[244:247], a[128:131], v[212:215]
    ds_read_b128 a[244:247], v224 offset:18816
    v_mfma_f32_16x16x32_bf16 v[212:215], a[248:251], a[140:143], v[212:215]
    s_waitcnt lgkmcnt(3)
    ds_read_b128 a[248:251], v224 offset:18880
    v_cndmask_b32 v224, v239, v240, vcc
    v_mfma_f32_16x16x32_bf16 v[208:211], a[0:3], a[252:255], 0
    v_cvt_pk_bf16_f32 v72, v220, v221
    v_cvt_pk_bf16_f32 v73, v222, v223
    v_mfma_f32_16x16x32_bf16 v[208:211], a[12:15], v[252:255], v[208:211]
    v_cvt_pk_bf16_f32 v94, v216, v217
    v_cvt_pk_bf16_f32 v95, v218, v219
    v_mfma_f32_16x16x32_bf16 v[204:207], a[4:7], a[252:255], 0
    v_cvt_pk_bf16_f32 v116, v212, v213
    v_cvt_pk_bf16_f32 v117, v214, v215
    v_mfma_f32_16x16x32_bf16 v[204:207], a[16:19], v[252:255], v[204:207]
    ds_read_b128 a[0:3], v241 offset:12288
    ds_read_b128 a[4:7], v241 offset:12800
    v_mfma_f32_16x16x32_bf16 v[200:203], a[8:11], a[252:255], 0
    ds_read_b128 a[8:11], v242 offset:12288
    v_mfma_f32_16x16x32_bf16 v[200:203], a[20:23], v[252:255], v[200:203]
    ds_read_b128 a[12:15], v242 offset:12800
    v_mfma_f32_16x16x32_bf16 v[220:223], a[252:255], a[72:75], 0
    ds_read_b128 a[16:19], v241 offset:24576
    v_mfma_f32_16x16x32_bf16 v[220:223], v[252:255], a[84:87], v[220:223]
    ds_read_b128 a[20:23], v241 offset:25088
    v_mfma_f32_16x16x32_bf16 v[216:219], a[252:255], a[76:79], 0
    v_mfma_f32_16x16x32_bf16 v[216:219], v[252:255], a[88:91], v[216:219]
    v_mfma_f32_16x16x32_bf16 v[212:215], a[252:255], a[80:83], 0
    ds_read_b128 a[252:255], v226 offset:4224
    v_mfma_f32_16x16x32_bf16 v[212:215], v[252:255], a[92:95], v[212:215]
    s_waitcnt lgkmcnt(6)
    ds_read_b128 v[252:255], v226 offset:4288
    v_mfma_f32_16x16x32_bf16 v[208:211], a[24:27], a[236:239], v[208:211]
    ds_read_b128 a[24:27], v242 offset:24576
    v_mfma_f32_16x16x32_bf16 v[208:211], a[36:39], a[240:243], v[208:211]
    ds_read_b128 a[36:39], v241 offset:37376
    v_mfma_f32_16x16x32_bf16 v[204:207], a[28:31], a[236:239], v[204:207]
    ds_read_b128 a[28:31], v242 offset:25088
    v_mfma_f32_16x16x32_bf16 v[204:207], a[40:43], a[240:243], v[204:207]
    ds_read_b128 a[40:43], v242 offset:36864
    v_mfma_f32_16x16x32_bf16 v[200:203], a[32:35], a[236:239], v[200:203]
    ds_read_b128 a[32:35], v241 offset:36864
    v_mfma_f32_16x16x32_bf16 v[200:203], a[44:47], a[240:243], v[200:203]
    ds_read_b128 a[44:47], v242 offset:37376
    v_mfma_f32_16x16x32_bf16 v[220:223], a[236:239], a[96:99], v[220:223]
    v_mfma_f32_16x16x32_bf16 v[220:223], a[240:243], a[108:111], v[220:223]
    v_mfma_f32_16x16x32_bf16 v[216:219], a[236:239], a[100:103], v[216:219]
    v_mfma_f32_16x16x32_bf16 v[216:219], a[240:243], a[112:115], v[216:219]
    v_mfma_f32_16x16x32_bf16 v[212:215], a[236:239], a[104:107], v[212:215]
    ds_read_b128 a[236:239], v226 offset:4352
    v_mfma_f32_16x16x32_bf16 v[212:215], a[240:243], a[116:119], v[212:215]
    ds_read_b128 a[240:243], v226 offset:4416
    v_mfma_f32_16x16x32_bf16 v[208:211], a[48:51], a[244:247], v[208:211]
    ds_read_b128 a[48:51], v241 offset:49152
    v_mfma_f32_16x16x32_bf16 v[208:211], a[60:63], a[248:251], v[208:211]
    ds_read_b128 a[60:63], v242 offset:49664
    v_mfma_f32_16x16x32_bf16 v[204:207], a[52:55], a[244:247], v[204:207]
    ds_read_b128 a[52:55], v241 offset:49664
    v_mfma_f32_16x16x32_bf16 v[204:207], a[64:67], a[248:251], v[204:207]
    ds_read_b128 a[64:67], v241 offset:61440
    v_mfma_f32_16x16x32_bf16 v[200:203], a[56:59], a[244:247], v[200:203]
    ds_read_b128 a[56:59], v242 offset:49152
    v_mfma_f32_16x16x32_bf16 v[200:203], a[68:71], a[248:251], v[200:203]
    v_cvt_pk_bf16_f32 v30, v208, v209
    v_cvt_pk_bf16_f32 v31, v210, v211
    v_mfma_f32_16x16x32_bf16 v[220:223], a[244:247], a[120:123], v[220:223]
    ds_read_b128 a[68:71], v241 offset:61952
    v_cvt_pk_bf16_f32 v32, v204, v205
    v_mfma_f32_16x16x32_bf16 v[220:223], a[248:251], a[132:135], v[220:223]
    v_cvt_pk_bf16_f32 v33, v206, v207
    v_mfma_f32_16x16x32_bf16 v[216:219], a[244:247], a[124:127], v[216:219]
    v_cvt_pk_bf16_f32 v34, v200, v201
    v_cvt_pk_bf16_f32 v35, v202, v203
    v_mfma_f32_16x16x32_bf16 v[216:219], a[248:251], a[136:139], v[216:219]
    v_mfma_f32_16x16x32_bf16 v[152:155], v[30:33], v[132:135], v[152:155]
    v_mfma_f32_16x16x32_bf16 v[212:215], a[244:247], a[128:131], v[212:215]
    ds_read_b128 a[244:247], v226 offset:4480
    v_cvt_pk_bf16_f32 v70, v220, v221
    v_mfma_f32_16x16x32_bf16 v[212:215], a[248:251], a[140:143], v[212:215]
    ds_read_b128 a[248:251], v226 offset:4544
    v_cvt_pk_bf16_f32 v71, v222, v223
    v_mfma_f32_16x16x16_bf16 v[152:155], v[34:35], v[136:137], v[152:155]
    s_waitcnt lgkmcnt(3)
    v_cvt_pk_bf16_f32 v92, v216, v217
    v_cvt_pk_bf16_f32 v93, v218, v219
    v_mfma_f32_16x16x32_bf16 v[208:211], a[144:147], a[252:255], 0
    v_cndmask_b32 v226, v244, v247, vcc
    v_cndmask_b32 v247, v247, v244, vcc
    v_mfma_f32_16x16x32_bf16 v[208:211], a[156:159], v[252:255], v[208:211]
    v_cvt_pk_bf16_f32 v114, v212, v213
    v_cvt_pk_bf16_f32 v115, v214, v215
    v_mfma_f32_16x16x32_bf16 v[204:207], a[148:151], a[252:255], 0
    v_max3_f32 v249, v249, v152, v153
    v_max3_f32 v248, v248, v154, v155
    v_mfma_f32_16x16x32_bf16 v[204:207], a[160:163], v[252:255], v[204:207]
    v_max3_f32 v249, v249, v156, v157
    v_max3_f32 v248, v248, v158, v159
    v_mfma_f32_16x16x32_bf16 v[200:203], a[152:155], a[252:255], 0
    ds_read_b128 a[252:255], v239 offset:12288
    v_max_f32 v248, v248, v249
    v_mfma_f32_16x16x32_bf16 v[200:203], a[164:167], v[252:255], v[200:203]
    ds_read_b128 v[252:255], v240 offset:12288
    v_mov_b32 v249, v248
    v_mfma_f32_16x16x32_bf16 v[208:211], a[168:171], a[236:239], v[208:211]
    v_mfma_f32_16x16x32_bf16 v[208:211], a[180:183], a[240:243], v[208:211]
    v_permlane16_swap_b32 v248, v249
    v_mfma_f32_16x16x32_bf16 v[204:207], a[172:175], a[236:239], v[204:207]
    v_max_f32 v248, v248, v249
    v_mov_b32 v249, v248
    v_mfma_f32_16x16x32_bf16 v[204:207], a[184:187], a[240:243], v[204:207]
    v_mfma_f32_16x16x32_bf16 v[200:203], a[176:179], a[236:239], v[200:203]
    ds_read_b128 a[236:239], v239 offset:13312
    v_mfma_f32_16x16x32_bf16 v[200:203], a[188:191], a[240:243], v[200:203]
    s_waitcnt lgkmcnt(3)
    ds_read_b128 a[240:243], v240 offset:13312
    v_mfma_f32_16x16x32_bf16 v[208:211], a[192:195], a[244:247], v[208:211]
    v_permlane32_swap_b32 v248, v249
    v_mfma_f32_16x16x32_bf16 v[208:211], a[204:207], a[248:251], v[208:211]
    v_max_f32 v248, v248, v249
    v_mul_f32 v236, s37, v248
    v_mfma_f32_16x16x32_bf16 v[204:207], a[196:199], a[244:247], v[204:207]
    v_fma_f32 v160, v160, s37, -v236
    v_fma_f32 v161, v161, s37, -v236
    v_mfma_f32_16x16x32_bf16 v[204:207], a[208:211], a[248:251], v[204:207]
    v_fma_f32 v162, v162, s37, -v236
    v_fma_f32 v163, v163, s37, -v236
    v_mfma_f32_16x16x32_bf16 v[200:203], a[200:203], a[244:247], v[200:203]
    v_cvt_pk_bf16_f32 v138, v208, v209
    v_cvt_pk_bf16_f32 v139, v210, v211
    v_mfma_f32_16x16x32_bf16 v[200:203], a[212:215], a[248:251], v[200:203]
    s_waitcnt lgkmcnt(2)
    ds_read_b128 a[244:247], v239 offset:14336
    ds_read_b128 a[248:251], v240 offset:14336
    v_mfma_f32_16x16x32_bf16 v[220:223], a[220:223], a[252:255], 0
    v_cvt_pk_bf16_f32 v140, v204, v205
    v_cvt_pk_bf16_f32 v141, v206, v207
    v_mfma_f32_16x16x32_bf16 v[212:215], a[220:223], v[252:255], 0
    v_exp_f32 v160, v160
    v_mfma_f32_16x16x32_bf16 v[216:219], a[224:227], a[252:255], 0
    v_cvt_pk_bf16_f32 v142, v200, v201
    v_cvt_pk_bf16_f32 v143, v202, v203
    v_mfma_f32_16x16x32_bf16 v[208:211], a[224:227], v[252:255], 0
    ds_read_b128 v[252:255], v240 offset:15360
    v_fma_f32 v164, v164, s37, -v236
    v_mfma_f32_16x16x32_bf16 v[204:207], a[228:231], a[252:255], 0
    v_exp_f32 v161, v161
    v_mfma_f32_16x16x32_bf16 v[200:203], a[232:235], a[252:255], 0
    s_waitcnt lgkmcnt(3)
    ds_read_b128 a[252:255], v239 offset:15360
    v_cvt_pk_bf16_f32 v176, v160, v161
    v_mfma_f32_16x16x32_bf16 v[220:223], a[0:3], a[236:239], v[220:223]
    v_exp_f32 v162, v162
    v_mfma_f32_16x16x32_bf16 v[212:215], a[0:3], a[240:243], v[212:215]
    v_exp_f32 v163, v163
    v_mfma_f32_16x16x32_bf16 v[216:219], a[4:7], a[236:239], v[216:219]
    v_cvt_pk_bf16_f32 v177, v162, v163
    v_fma_f32 v165, v165, s37, -v236
    v_mfma_f32_16x16x32_bf16 v[208:211], a[4:7], a[240:243], v[208:211]
    ds_read_b128 v[160:163], v230 offset:640
    v_fma_f32 v166, v166, s37, -v236
    v_mfma_f32_16x16x32_bf16 v[204:207], a[8:11], a[236:239], v[204:207]
    ds_read_b128 a[240:243], v240 offset:16384
    v_fma_f32 v167, v167, s37, -v236
    v_mfma_f32_16x16x32_bf16 v[200:203], a[12:15], a[236:239], v[200:203]
    s_waitcnt lgkmcnt(3)
    ds_read_b128 a[236:239], v239 offset:16384
    v_fma_f32 v168, v168, s37, -v236
    v_mfma_f32_16x16x32_bf16 v[220:223], a[16:19], a[244:247], v[220:223]
    v_exp_f32 v164, v164
    v_mfma_f32_16x16x32_bf16 v[212:215], a[16:19], a[248:251], v[212:215]
    v_exp_f32 v165, v165
    v_mfma_f32_16x16x32_bf16 v[216:219], a[20:23], a[244:247], v[216:219]
    v_exp_f32 v166, v166
    v_mfma_f32_16x16x32_bf16 v[208:211], a[20:23], a[248:251], v[208:211]
    ds_read_b128 a[248:251], v240 offset:17408
    v_cvt_pk_bf16_f32 v178, v164, v165
    v_mfma_f32_16x16x32_bf16 v[204:207], a[24:27], a[244:247], v[204:207]
    s_waitcnt lgkmcnt(3)
    v_exp_f32 v167, v167
    v_mfma_f32_16x16x32_bf16 v[160:163], v[36:39], v[138:141], v[160:163]
    v_cvt_pk_bf16_f32 v179, v166, v167
    v_fma_f32 v169, v169, s37, -v236
    v_mfma_f32_16x16x32_bf16 v[200:203], a[28:31], a[244:247], v[200:203]
    ds_read_b128 v[164:167], v230 offset:1280
    v_fma_f32 v170, v170, s37, -v236
    v_mfma_f32_16x16x32_bf16 v[196:199], a[216:219], v[176:179], 0
    ds_read_b128 a[244:247], v239 offset:17408
    v_fma_f32 v171, v171, s37, -v236
    v_mfma_f32_16x16x32_bf16 v[184:187], v[74:77], v[176:179], 0
    v_exp_f32 v168, v168
    v_mfma_f32_16x16x32_bf16 v[188:191], v[96:99], v[176:179], 0
    v_exp_f32 v169, v169
    v_mfma_f32_16x16x32_bf16 v[192:195], v[118:121], v[176:179], 0
    v_exp_f32 v170, v170
    v_mfma_f32_16x16x16_bf16 v[160:163], v[40:41], v[142:143], v[160:163]
    v_exp_f32 v171, v171
    v_mfma_f32_16x16x32_bf16 v[220:223], a[32:35], a[252:255], v[220:223]
    v_cvt_pk_bf16_f32 v180, v168, v169
    v_cvt_pk_bf16_f32 v181, v170, v171
    v_mfma_f32_16x16x32_bf16 v[212:215], a[32:35], v[252:255], v[212:215]
    s_waitcnt lgkmcnt(1)
    ds_read_b128 v[168:171], v230 offset:1920
    v_fma_f32 v172, v172, s37, -v236
    v_mfma_f32_16x16x32_bf16 v[164:167], v[42:45], v[138:141], v[164:167]
    v_fma_f32 v173, v173, s37, -v236
    v_fma_f32 v174, v174, s37, -v236
    v_mfma_f32_16x16x32_bf16 v[216:219], a[36:39], a[252:255], v[216:219]
    v_fma_f32 v175, v175, s37, -v236
    v_fma_f32 v144, v144, s37, -v236
    v_mfma_f32_16x16x32_bf16 v[208:211], a[36:39], v[252:255], v[208:211]
    ds_read_b128 v[252:255], v242 offset:61952
    v_fma_f32 v145, v145, s37, -v236
    v_mfma_f32_16x16x16_bf16 v[164:167], v[46:47], v[142:143], v[164:167]
    v_exp_f32 v172, v172
    v_mfma_f32_16x16x32_bf16 v[204:207], a[40:43], a[252:255], v[204:207]
    v_exp_f32 v173, v173
    v_mfma_f32_16x16x32_bf16 v[200:203], a[44:47], a[252:255], v[200:203]
    ds_read_b128 a[252:255], v242 offset:61440
    v_cvt_pk_bf16_f32 v182, v172, v173
    v_mfma_f32_16x16x32_bf16 v[220:223], a[48:51], a[236:239], v[220:223]
    s_waitcnt lgkmcnt(2)
    v_exp_f32 v174, v174
    v_mfma_f32_16x16x32_bf16 v[168:171], v[24:27], v[138:141], v[168:171]
    v_exp_f32 v175, v175
    v_mfma_f32_16x16x32_bf16 v[212:215], a[48:51], a[240:243], v[212:215]
    v_cvt_pk_bf16_f32 v183, v174, v175
    v_fma_f32 v146, v146, s37, -v236
    v_mfma_f32_16x16x32_bf16 v[216:219], a[52:55], a[236:239], v[216:219]
    ds_read_b128 v[172:175], v230 offset:2560
    v_fma_f32 v147, v147, s37, -v236
    v_mfma_f32_16x16x32_bf16 v[196:199], a[216:219], v[180:183], v[196:199]
    v_exp_f32 v144, v144
    v_mfma_f32_16x16x32_bf16 v[184:187], v[78:81], v[180:183], v[184:187]
    v_exp_f32 v145, v145
    v_mfma_f32_16x16x32_bf16 v[188:191], v[100:103], v[180:183], v[188:191]
    v_exp_f32 v146, v146
    v_mfma_f32_16x16x32_bf16 v[192:195], v[122:125], v[180:183], v[192:195]
    v_exp_f32 v147, v147
    v_mfma_f32_16x16x16_bf16 v[168:171], v[28:29], v[142:143], v[168:171]
    v_cvt_pk_bf16_f32 v176, v144, v145
    v_cvt_pk_bf16_f32 v177, v146, v147
    v_mfma_f32_16x16x32_bf16 v[208:211], a[52:55], a[240:243], v[208:211]
    ds_read_b128 v[144:147], v234
    v_fma_f32 v148, v148, s37, -v236
    v_mfma_f32_16x16x32_bf16 v[204:207], a[56:59], a[236:239], v[204:207]
    s_waitcnt lgkmcnt(1)
    v_fma_f32 v149, v149, s37, -v236
    v_fma_f32 v150, v150, s37, -v236
    v_mfma_f32_16x16x32_bf16 v[172:175], v[30:33], v[138:141], v[172:175]
    v_fma_f32 v151, v151, s37, -v236
    v_fma_f32 v152, v152, s37, -v236
    v_mfma_f32_16x16x32_bf16 v[200:203], a[60:63], a[236:239], v[200:203]
    v_exp_f32 v148, v148
    v_mfma_f32_16x16x32_bf16 v[220:223], a[64:67], a[244:247], v[220:223]
    v_exp_f32 v149, v149
    v_mfma_f32_16x16x16_bf16 v[172:175], v[34:35], v[142:143], v[172:175]
    v_exp_f32 v150, v150
    v_mfma_f32_16x16x32_bf16 v[212:215], a[64:67], a[248:251], v[212:215]
    v_exp_f32 v151, v151
    v_mfma_f32_16x16x32_bf16 v[216:219], a[68:71], a[244:247], v[216:219]
    s_waitcnt lgkmcnt(0)
    v_cvt_pk_bf16_f32 v178, v148, v149
    v_cvt_pk_bf16_f32 v179, v150, v151
    v_mfma_f32_16x16x32_bf16 v[144:147], v[54:57], v[138:141], v[144:147]
    ds_read_b128 v[148:151], v235
    v_cvt_pk_bf16_f32 v220, v220, v221
    v_mfma_f32_16x16x32_bf16 v[196:199], a[216:219], v[176:179], v[196:199]
    v_cvt_pk_bf16_f32 v221, v222, v223
    v_cvt_pk_bf16_f32 v212, v212, v213
    v_mfma_f32_16x16x32_bf16 v[184:187], v[66:69], v[176:179], v[184:187]
    v_cvt_pk_bf16_f32 v222, v216, v217
    v_cvt_pk_bf16_f32 v223, v218, v219
    v_mfma_f32_16x16x32_bf16 v[188:191], v[88:91], v[176:179], v[188:191]
    buffer_store_dwordx4 v[220:223], v243, s[20:23], s51 offen sc0 sc1
    v_mfma_f32_16x16x32_bf16 v[192:195], v[110:113], v[176:179], v[192:195]
    v_cvt_pk_bf16_f32 v213, v214, v215
    v_fma_f32 v153, v153, s37, -v236
    v_mfma_f32_16x16x16_bf16 v[144:147], v[58:59], v[142:143], v[144:147]
    v_fma_f32 v154, v154, s37, -v236
    v_fma_f32 v155, v155, s37, -v236
    v_mfma_f32_16x16x32_bf16 v[208:211], a[68:71], a[248:251], v[208:211]
    s_waitcnt lgkmcnt(0)
    v_exp_f32 v152, v152
    v_mfma_f32_16x16x32_bf16 v[148:151], v[48:51], v[138:141], v[148:151]
    v_exp_f32 v153, v153
    v_mfma_f32_16x16x32_bf16 v[204:207], a[252:255], a[244:247], v[204:207]
    v_exp_f32 v154, v154
    v_mfma_f32_16x16x32_bf16 v[200:203], v[252:255], a[244:247], v[200:203]
    v_exp_f32 v155, v155
    v_cvt_pk_bf16_f32 v180, v152, v153
    v_mfma_f32_16x16x16_bf16 v[148:151], v[52:53], v[142:143], v[148:151]
    v_cvt_pk_bf16_f32 v214, v208, v209
    v_cvt_pk_bf16_f32 v215, v210, v211
    v_cvt_pk_bf16_f32 v181, v154, v155
    v_cvt_pk_bf16_f32 v204, v204, v205
    v_cvt_pk_bf16_f32 v205, v206, v207
    v_cvt_pk_bf16_f32 v206, v200, v201
    v_cvt_pk_bf16_f32 v207, v202, v203
    v_fma_f32 v156, v156, s37, -v236
    v_fma_f32 v157, v157, s37, -v236
    v_fma_f32 v158, v158, s37, -v236
    v_fma_f32 v159, v159, s37, -v236
    v_exp_f32 v156, v156
    v_exp_f32 v157, v157
    v_exp_f32 v158, v158
    buffer_store_dwordx4 v[212:215], v245, s[20:23], s51 offen sc0 sc1
    v_exp_f32 v159, v159
    v_cvt_pk_bf16_f32 v182, v156, v157
    v_cvt_pk_bf16_f32 v183, v158, v159
    v_max3_f32 v248, v160, v161, v162
    v_max3_f32 v249, v163, v164, v165
    v_mfma_f32_16x16x32_bf16 v[196:199], a[216:219], v[180:183], v[196:199]
    v_max3_f32 v248, v248, v166, v167
    v_max3_f32 v249, v249, v168, v169
    v_mfma_f32_16x16x32_bf16 v[184:187], v[70:73], v[180:183], v[184:187]
    v_max3_f32 v248, v248, v170, v171
    v_max3_f32 v249, v249, v172, v173
    v_mfma_f32_16x16x32_bf16 v[188:191], v[92:95], v[180:183], v[188:191]
    v_max3_f32 v248, v248, v174, v175
    v_max3_f32 v249, v249, v144, v145
    v_mfma_f32_16x16x32_bf16 v[192:195], v[114:117], v[180:183], v[192:195]
    v_rcp_f32 v197, v196
    v_max3_f32 v248, v248, v146, v147
    v_mul_f32 v184, v184, v197
    v_mul_f32 v185, v185, v197
    v_cvt_pk_bf16_f32 v184, v184, v185
    v_mul_f32 v186, v186, v197
    v_mul_f32 v187, v187, v197
    v_cvt_pk_bf16_f32 v185, v186, v187
    v_mul_f32 v188, v188, v197
    v_mul_f32 v189, v189, v197
    v_cvt_pk_bf16_f32 v186, v188, v189
    v_mul_f32 v190, v190, v197
    v_mul_f32 v191, v191, v197
    v_cvt_pk_bf16_f32 v187, v190, v191
    v_mul_f32 v192, v192, v197
    v_mul_f32 v193, v193, v197
    v_cvt_pk_bf16_f32 v188, v192, v193
    v_mul_f32 v194, v194, v197
    v_mul_f32 v195, v195, v197
    v_cvt_pk_bf16_f32 v189, v194, v195
    ds_write_b128 v237, v[184:187]
    ds_write_b64 v238, v[188:189]
    buffer_store_dwordx4 v[204:207], v244, s[20:23], s51 offen sc0 sc1
    s_add_u32 s51, s51, s48
    v_max3_f32 v249, v249, v148, v149
    v_max3_f32 v248, v248, v150, v151
    v_max_f32 v248, v248, v249
    v_mov_b32 v249, v248
    s_nop 1
    v_permlane16_swap_b32 v248, v249
    v_max_f32 v248, v248, v249
    v_mov_b32 v249, v248
    s_nop 1
    v_permlane32_swap_b32 v248, v249
    v_max_f32 v248, v248, v249
    v_mul_f32 v236, s37, v248
    v_fma_f32 v160, v160, s37, -v236
    v_fma_f32 v161, v161, s37, -v236
    v_fma_f32 v162, v162, s37, -v236
    v_fma_f32 v163, v163, s37, -v236
    v_exp_f32 v160, v160
    v_exp_f32 v161, v161
    v_exp_f32 v162, v162
    v_exp_f32 v163, v163
    v_cvt_pk_bf16_f32 v176, v160, v161
    v_cvt_pk_bf16_f32 v177, v162, v163
    v_fma_f32 v164, v164, s37, -v236
    v_fma_f32 v165, v165, s37, -v236
    s_waitcnt lgkmcnt(0)
    s_barrier
    ds_read_b128 a[236:239], v224
    ds_read_b128 a[240:243], v224 offset:1024
    v_fma_f32 v166, v166, s37, -v236
    v_fma_f32 v167, v167, s37, -v236
    ds_read_b128 a[244:247], v224 offset:2048
    v_exp_f32 v164, v164
    ds_read_b128 a[248:251], v224 offset:3072
    ds_read_b128 a[252:255], v224 offset:4096
    v_exp_f32 v165, v165
    v_exp_f32 v166, v166
    ds_read_b128 v[252:255], v224 offset:5120
    v_exp_f32 v167, v167
    v_cvt_pk_bf16_f32 v178, v164, v165
    v_cvt_pk_bf16_f32 v179, v166, v167
    v_fma_f32 v168, v168, s37, -v236
    v_fma_f32 v169, v169, s37, -v236
    v_mfma_f32_16x16x32_bf16 v[196:199], a[216:219], v[176:179], 0
    v_fma_f32 v170, v170, s37, -v236
    v_fma_f32 v171, v171, s37, -v236
    v_mfma_f32_16x16x32_bf16 v[184:187], v[76:79], v[176:179], 0
    v_exp_f32 v168, v168
    v_mfma_f32_16x16x32_bf16 v[188:191], v[98:101], v[176:179], 0
    v_exp_f32 v169, v169
    v_mfma_f32_16x16x32_bf16 v[192:195], v[120:123], v[176:179], 0
    s_waitcnt lgkmcnt(3)
    v_exp_f32 v170, v170
    v_mfma_f32_16x16x32_bf16 v[220:223], a[220:223], a[236:239], 0
    v_exp_f32 v171, v171
    v_mfma_f32_16x16x32_bf16 v[216:219], a[224:227], a[236:239], 0
    v_cvt_pk_bf16_f32 v180, v168, v169
    v_cvt_pk_bf16_f32 v181, v170, v171
    v_mfma_f32_16x16x32_bf16 v[212:215], a[228:231], a[236:239], 0
    v_fma_f32 v172, v172, s37, -v236
    v_fma_f32 v173, v173, s37, -v236
    v_mfma_f32_16x16x32_bf16 v[208:211], a[232:235], a[236:239], 0
    ds_read_b128 a[236:239], v242 offset:61440
    v_fma_f32 v174, v174, s37, -v236
    v_mfma_f32_16x16x32_bf16 v[220:223], a[0:3], a[240:243], v[220:223]
    v_fma_f32 v175, v175, s37, -v236
    v_fma_f32 v144, v144, s37, -v236
    v_mfma_f32_16x16x32_bf16 v[216:219], a[4:7], a[240:243], v[216:219]
    v_exp_f32 v172, v172
    v_mfma_f32_16x16x32_bf16 v[212:215], a[8:11], a[240:243], v[212:215]
    v_exp_f32 v173, v173
    v_mfma_f32_16x16x32_bf16 v[208:211], a[12:15], a[240:243], v[208:211]
    ds_read_b128 a[240:243], v242 offset:61952
    v_cvt_pk_bf16_f32 v182, v172, v173
    v_mfma_f32_16x16x32_bf16 v[220:223], a[16:19], a[244:247], v[220:223]
    v_exp_f32 v174, v174
    v_mfma_f32_16x16x32_bf16 v[216:219], a[20:23], a[244:247], v[216:219]
    v_exp_f32 v175, v175
    v_mfma_f32_16x16x32_bf16 v[212:215], a[24:27], a[244:247], v[212:215]
    v_cvt_pk_bf16_f32 v183, v174, v175
    v_fma_f32 v145, v145, s37, -v236
    v_mfma_f32_16x16x32_bf16 v[208:211], a[28:31], a[244:247], v[208:211]
    v_fma_f32 v146, v146, s37, -v236
    v_fma_f32 v147, v147, s37, -v236
    v_mfma_f32_16x16x32_bf16 v[196:199], a[216:219], v[180:183], v[196:199]
    v_exp_f32 v144, v144
    v_mfma_f32_16x16x32_bf16 v[184:187], v[68:71], v[180:183], v[184:187]
    v_exp_f32 v145, v145
    v_mfma_f32_16x16x32_bf16 v[188:191], v[90:93], v[180:183], v[188:191]
    v_exp_f32 v146, v146
    v_mfma_f32_16x16x32_bf16 v[192:195], v[112:115], v[180:183], v[192:195]
    s_waitcnt lgkmcnt(0)
    v_exp_f32 v147, v147
    v_mfma_f32_16x16x32_bf16 v[220:223], a[32:35], a[248:251], v[220:223]
    v_cvt_pk_bf16_f32 v176, v144, v145
    v_cvt_pk_bf16_f32 v177, v146, v147
    v_mfma_f32_16x16x32_bf16 v[216:219], a[36:39], a[248:251], v[216:219]
    v_fma_f32 v148, v148, s37, -v236
    v_fma_f32 v149, v149, s37, -v236
    v_mfma_f32_16x16x32_bf16 v[212:215], a[40:43], a[248:251], v[212:215]
    v_fma_f32 v150, v150, s37, -v236
    v_fma_f32 v151, v151, s37, -v236
    v_mfma_f32_16x16x32_bf16 v[208:211], a[44:47], a[248:251], v[208:211]
    v_exp_f32 v148, v148
    v_mfma_f32_16x16x32_bf16 v[220:223], a[48:51], a[252:255], v[220:223]
    v_exp_f32 v149, v149
    v_mfma_f32_16x16x32_bf16 v[216:219], a[52:55], a[252:255], v[216:219]
    v_exp_f32 v150, v150
    v_mfma_f32_16x16x32_bf16 v[212:215], a[56:59], a[252:255], v[212:215]
    v_exp_f32 v151, v151
    v_mfma_f32_16x16x32_bf16 v[208:211], a[60:63], a[252:255], v[208:211]
    v_cvt_pk_bf16_f32 v178, v148, v149
    v_cvt_pk_bf16_f32 v179, v150, v151
    v_mfma_f32_16x16x32_bf16 v[220:223], a[64:67], v[252:255], v[220:223]
    v_mfma_f32_16x16x32_bf16 v[216:219], a[68:71], v[252:255], v[216:219]
    v_mfma_f32_16x16x32_bf16 v[196:199], a[216:219], v[176:179], v[196:199]
    v_mfma_f32_16x16x32_bf16 v[184:187], v[82:85], v[176:179], v[184:187]
    v_mfma_f32_16x16x32_bf16 v[188:191], v[104:107], v[176:179], v[188:191]
    v_mfma_f32_16x16x32_bf16 v[192:195], v[126:129], v[176:179], v[192:195]
    v_mfma_f32_16x16x32_bf16 v[212:215], a[236:239], v[252:255], v[212:215]
    v_mfma_f32_16x16x32_bf16 v[208:211], a[240:243], v[252:255], v[208:211]
    s_nop 0
    v_cvt_pk_bf16_f32 v220, v220, v221
    v_cvt_pk_bf16_f32 v221, v222, v223
    v_rcp_f32 v197, v196
    v_cvt_pk_bf16_f32 v222, v216, v217
    v_mul_f32 v184, v184, v197
    v_mul_f32 v185, v185, v197
    v_cvt_pk_bf16_f32 v184, v184, v185
    v_mul_f32 v186, v186, v197
    v_mul_f32 v187, v187, v197
    v_cvt_pk_bf16_f32 v185, v186, v187
    v_mul_f32 v188, v188, v197
    v_mul_f32 v189, v189, v197
    v_cvt_pk_bf16_f32 v186, v188, v189
    v_mul_f32 v190, v190, v197
    v_mul_f32 v191, v191, v197
    v_cvt_pk_bf16_f32 v187, v190, v191
    v_mul_f32 v192, v192, v197
    v_mul_f32 v193, v193, v197
    v_cvt_pk_bf16_f32 v188, v192, v193
    v_mul_f32 v194, v194, v197
    v_mul_f32 v195, v195, v197
    v_cvt_pk_bf16_f32 v189, v194, v195
    ds_write_b128 v237, v[184:187] offset:6144
    ds_write_b64 v238, v[188:189] offset:6144
    v_cvt_pk_bf16_f32 v223, v218, v219
    buffer_store_dwordx4 v[220:223], v225, s[20:23], s51 offen sc0 sc1
    v_cvt_pk_bf16_f32 v212, v212, v213
    v_cvt_pk_bf16_f32 v213, v214, v215
    v_cvt_pk_bf16_f32 v214, v208, v209
    v_cvt_pk_bf16_f32 v215, v210, v211
    s_waitcnt lgkmcnt(0)
    s_barrier
    ds_read_b128 a[244:247], v227
    ds_read_b128 a[248:251], v227 offset:1024
    ds_read_b128 a[252:255], v227 offset:2048
    ds_read_b128 v[252:255], v227 offset:3072
    ds_read_b128 a[236:239], v227 offset:4096
    buffer_store_dwordx4 v[212:215], v226, s[20:23], s51 offen sc0 sc1
    ds_read_b128 a[240:243], v227 offset:5120
    s_waitcnt lgkmcnt(5)
    v_mfma_f32_16x16x32_bf16 v[204:207], a[220:223], a[244:247], 0
    v_mfma_f32_16x16x32_bf16 v[200:203], a[224:227], a[244:247], 0
    v_mfma_f32_16x16x32_bf16 v[220:223], a[228:231], a[244:247], 0
    v_mfma_f32_16x16x32_bf16 v[216:219], a[232:235], a[244:247], 0
    s_waitcnt lgkmcnt(3)
    ds_read_b128 a[244:247], v242 offset:61440
    v_mfma_f32_16x16x32_bf16 v[204:207], a[0:3], a[248:251], v[204:207]
    v_mfma_f32_16x16x32_bf16 v[200:203], a[4:7], a[248:251], v[200:203]
    v_mfma_f32_16x16x32_bf16 v[220:223], a[8:11], a[248:251], v[220:223]
    v_mfma_f32_16x16x32_bf16 v[216:219], a[12:15], a[248:251], v[216:219]
    ds_read_b128 a[248:251], v242 offset:61952
    v_mfma_f32_16x16x32_bf16 v[204:207], a[16:19], a[252:255], v[204:207]
    v_mfma_f32_16x16x32_bf16 v[200:203], a[20:23], a[252:255], v[200:203]
    v_mfma_f32_16x16x32_bf16 v[220:223], a[24:27], a[252:255], v[220:223]
    v_mfma_f32_16x16x32_bf16 v[216:219], a[28:31], a[252:255], v[216:219]
    s_waitcnt lgkmcnt(1)
    v_mfma_f32_16x16x32_bf16 v[204:207], a[32:35], v[252:255], v[204:207]
    v_mfma_f32_16x16x32_bf16 v[200:203], a[36:39], v[252:255], v[200:203]
    v_mfma_f32_16x16x32_bf16 v[220:223], a[40:43], v[252:255], v[220:223]
    v_mfma_f32_16x16x32_bf16 v[216:219], a[44:47], v[252:255], v[216:219]
    v_mfma_f32_16x16x32_bf16 v[204:207], a[48:51], a[236:239], v[204:207]
    v_mfma_f32_16x16x32_bf16 v[200:203], a[52:55], a[236:239], v[200:203]
    v_mfma_f32_16x16x32_bf16 v[220:223], a[56:59], a[236:239], v[220:223]
    v_mfma_f32_16x16x32_bf16 v[216:219], a[60:63], a[236:239], v[216:219]
    v_mfma_f32_16x16x32_bf16 v[204:207], a[64:67], a[240:243], v[204:207]
    v_mfma_f32_16x16x32_bf16 v[200:203], a[68:71], a[240:243], v[200:203]
    v_mfma_f32_16x16x32_bf16 v[220:223], a[244:247], a[240:243], v[220:223]
    s_waitcnt lgkmcnt(0)
    v_mfma_f32_16x16x32_bf16 v[216:219], a[248:251], a[240:243], v[216:219]
    s_nop 4
    v_cvt_pk_bf16_f32 v204, v204, v205
    v_cvt_pk_bf16_f32 v205, v206, v207
    v_cvt_pk_bf16_f32 v206, v200, v201
    v_cvt_pk_bf16_f32 v207, v202, v203
    buffer_store_dwordx4 v[204:207], v246, s[20:23], s51 offen sc0 sc1
    v_cvt_pk_bf16_f32 v220, v220, v221
    v_cvt_pk_bf16_f32 v221, v222, v223
    v_cvt_pk_bf16_f32 v222, v216, v217
    v_cvt_pk_bf16_f32 v223, v218, v219
    buffer_store_dwordx4 v[220:223], v247, s[20:23], s51 offen sc0 sc1
    s_endpgm
.section .rodata,"a"
.p2align 6
.amdhsa_kernel standalone__neighborhood_dinat__vision_kernel
  .amdhsa_next_free_vgpr 512
  .amdhsa_next_free_sgpr 102
  .amdhsa_accum_offset 256
  .amdhsa_group_segment_fixed_size 0
  .amdhsa_kernarg_size 56
  .amdhsa_user_sgpr_count 2
  .amdhsa_user_sgpr_kernarg_segment_ptr 1
  .amdhsa_system_sgpr_workgroup_id_x 1
.end_amdhsa_kernel
```
